```python
import torch

def _softmax(x, axis=-1):
    return torch.softmax(x, dim=axis)
def _gelu(x):
    return torch.nn.functional.gelu(x, approximate="tanh")
def _silu(x):
    return torch.nn.functional.silu(x)
def _sigmoid(x):
    return torch.sigmoid(x)
def _layernorm(x, axis=-1, eps=1e-5):
    m = x.mean(dim=axis, keepdim=True)
    v = x.var(dim=axis, keepdim=True, unbiased=False)
    return (x - m) / torch.sqrt(v + eps)
def _scatter_add(tgt, idx, src, axis=0):
    return tgt.clone().index_add_(axis, idx, src)
def _segment_sum(src, seg, n):
    out = torch.zeros((n,) + src.shape[1:], dtype=src.dtype)
    return out.index_add_(0, seg, src)
def _pad(x, pw):
    flat = tuple(v for pair in reversed(pw) for v in pair)
    return torch.nn.functional.pad(x, flat)

kernel_name = 'standalone__cheap_equivariant_egnn__graph'

def setup_inputs():

    _w = (lambda a: (lambda t: t.to(torch.bfloat16) if t.is_floating_point() else t)(torch.as_tensor(a)))
    N, deg, D, De = 50000, 16, 64, max(16, 1)
    E = N * deg
    return {
        "h": _w((lambda *s: torch.randn(*s, dtype=torch.bfloat16) * 0.2)(N, D)),
        "pos": _w((lambda *s: torch.randn(*s, dtype=torch.bfloat16) * 0.8)(N, 3)),
        "e_attr": _w((lambda *s: torch.randn(*s, dtype=torch.bfloat16) * 0.8)(E, De)),
        "src": _w((lambda lo, hi, *s: torch.randint(lo, hi, s))(0, N, E).to(torch.int64)),
        "dst": _w((lambda lo, hi, *s: torch.randint(lo, hi, s))(0, N, E).to(torch.int64)),
        "w_e": _w(0.1 * (lambda *s: torch.randn(*s, dtype=torch.bfloat16) * 0.8)(2 * D + 1 + De, D)),
        "w_x": _w(0.1 * (lambda *s: torch.randn(*s, dtype=torch.bfloat16) * 0.2)(D, 1)),
        "w_h": _w(0.1 * (lambda *s: torch.randn(*s, dtype=torch.bfloat16) * 0.2)(2 * D, D)),
    }

def reference(h, pos, e_attr, src, dst, w_e, w_x, w_h):
    N, D = h.shape[0], h.shape[1]
    diff = pos[dst] - pos[src]
    dist2 = torch.sum(diff * diff, axis=-1, keepdims=True)
    e_in = torch.concatenate([h[dst], h[src], dist2, e_attr], axis=-1)
    m_ij = _silu(e_in @ w_e)
    coord_scale = m_ij @ w_x
    pos_new = pos + _segment_sum(diff * coord_scale, dst, N)
    m_i = _segment_sum(m_ij, dst, N)
    h_new = h + _silu(torch.concatenate([h, m_i], axis=-1) @ w_h)
    return h_new, pos_new
```

```asm
; @launch kernel=part_kernel grid=(250,1,1) block=(640,1,1) lds=27648
; @launch kernel=main_kernel grid=(256,1,1) block=(512,1,1) lds=161792
.amdgcn_target "amdgcn-amd-amdhsa--gfx950"
.text
.globl part_kernel
.p2align 8
.type part_kernel,@function
part_kernel:
  s_cmp_ge_u32 s2, 250
  s_cbranch_scc1 K1END
  s_load_dwordx4 s[4:7], s[0:1], 24
  s_load_dwordx2 s[8:9], s[0:1], 80
  v_and_b32 v1, 255, v0
  v_lshlrev_b32 v1, 2, v1
  v_mov_b32 v2, 0
  ds_write_b32 v1, v2 offset:25600
  s_mul_i32 s3, s2, 12800
  v_lshlrev_b32 v2, 4, v0
  v_lshlrev_b32 v3, 2, v0
  v_add_u32 v3, 10240, v3
  s_waitcnt lgkmcnt(0)
  s_mov_b32 s12, s4
  s_mov_b32 s13, s5
  s_mov_b32 s14, 3200000
  s_mov_b32 s15, 0x20000
  s_mov_b32 s16, s6
  s_mov_b32 s17, s7
  s_mov_b32 s18, 3200000
  s_mov_b32 s19, 0x20000
  buffer_load_dwordx4 v[4:7], v2, s[16:19], s3 offen
  buffer_load_dword v8, v3, s[16:19], s3 offen
  buffer_load_dwordx4 v[12:15], v2, s[12:15], s3 offen
  buffer_load_dword v16, v3, s[12:15], s3 offen
  s_mov_b32 s20, s8
  s_mov_b32 s21, s9
  s_mov_b32 s22, 6400000
  s_mov_b32 s23, 0x20000
  s_add_u32 s24, s8, 6815744
  s_addc_u32 s25, s9, 0
  s_mov_b32 s26, 256000
  s_mov_b32 s27, 0x20000
  s_mov_b32 s28, 83887
  s_mov_b32 s29, -25
  s_mul_i32 s30, s2, 3200
  v_mov_b32 v50, 1
  v_lshl_add_u32 v51, v0, 2, s30
  s_add_u32 s30, s30, 2560
  v_add_u32 v52, s30, v0
  v_readfirstlane_b32 s31, v0
  s_barrier
  s_waitcnt vmcnt(2)
  v_mul_u32_u24 v37, s28, v4
  v_lshrrev_b32 v37, 21, v37
  v_lshrrev_b32 v20, 1, v37
  v_and_b32 v20, 0x3fc, v20
  ds_add_rtn_u32 v28, v20, v50 offset:25600
  v_mul_u32_u24 v39, s28, v5
  v_lshrrev_b32 v39, 21, v39
  v_lshrrev_b32 v21, 1, v39
  v_and_b32 v21, 0x3fc, v21
  ds_add_rtn_u32 v29, v21, v50 offset:25600
  v_mul_u32_u24 v41, s28, v6
  v_lshrrev_b32 v41, 21, v41
  v_lshrrev_b32 v22, 1, v41
  v_and_b32 v22, 0x3fc, v22
  ds_add_rtn_u32 v30, v22, v50 offset:25600
  v_mul_u32_u24 v43, s28, v7
  v_lshrrev_b32 v43, 21, v43
  v_lshrrev_b32 v23, 1, v43
  v_and_b32 v23, 0x3fc, v23
  ds_add_rtn_u32 v31, v23, v50 offset:25600
  v_mul_u32_u24 v45, s28, v8
  v_lshrrev_b32 v45, 21, v45
  v_lshrrev_b32 v24, 1, v45
  v_and_b32 v24, 0x3fc, v24
  ds_add_rtn_u32 v32, v24, v50 offset:25600
  s_waitcnt vmcnt(0)
  v_mad_i32_i24 v4, v37, s29, v4
  v_lshl_or_b32 v36, v4, 27, v12
  v_and_b32 v37, 7, v37
  v_lshrrev_b32 v12, 12, v12
  v_lshl_or_b32 v37, v37, 4, v12
  v_lshl_or_b32 v37, v37, 24, v51
  v_mad_i32_i24 v5, v39, s29, v5
  v_lshl_or_b32 v38, v5, 27, v13
  v_and_b32 v39, 7, v39
  v_lshrrev_b32 v13, 12, v13
  v_lshl_or_b32 v39, v39, 4, v13
  v_add_u32 v51, 1, v51
  v_lshl_or_b32 v39, v39, 24, v51
  v_mad_i32_i24 v6, v41, s29, v6
  v_lshl_or_b32 v40, v6, 27, v14
  v_and_b32 v41, 7, v41
  v_lshrrev_b32 v14, 12, v14
  v_lshl_or_b32 v41, v41, 4, v14
  v_add_u32 v51, 1, v51
  v_lshl_or_b32 v41, v41, 24, v51
  v_mad_i32_i24 v7, v43, s29, v7
  v_lshl_or_b32 v42, v7, 27, v15
  v_and_b32 v43, 7, v43
  v_lshrrev_b32 v15, 12, v15
  v_lshl_or_b32 v43, v43, 4, v15
  v_add_u32 v51, 1, v51
  v_lshl_or_b32 v43, v43, 24, v51
  v_mad_i32_i24 v8, v45, s29, v8
  v_lshl_or_b32 v44, v8, 27, v16
  v_and_b32 v45, 7, v45
  v_lshrrev_b32 v16, 12, v16
  v_lshl_or_b32 v45, v45, 4, v16
  v_lshl_or_b32 v45, v45, 24, v52
  v_and_b32 v1, 63, v0
  v_lshlrev_b32 v1, 4, v1
  s_waitcnt lgkmcnt(0)
  s_barrier
  ds_read_b128 v[4:7], v1 offset:25600
  s_waitcnt lgkmcnt(0)
  v_add_u32 v8, v4, v5
  v_add_u32 v9, v8, v6
  v_add_u32 v10, v9, v7
  v_mov_b32 v11, v10
  s_nop 1
  v_add_u32_dpp v11, v11, v11 row_shr:1 row_mask:0xf bank_mask:0xf
  s_nop 1
  v_add_u32_dpp v11, v11, v11 row_shr:2 row_mask:0xf bank_mask:0xf
  s_nop 1
  v_add_u32_dpp v11, v11, v11 row_shr:4 row_mask:0xf bank_mask:0xf
  s_nop 1
  v_add_u32_dpp v11, v11, v11 row_shr:8 row_mask:0xf bank_mask:0xf
  s_nop 1
  v_add_u32_dpp v11, v11, v11 row_bcast:15 row_mask:0xa bank_mask:0xf
  s_nop 1
  v_add_u32_dpp v11, v11, v11 row_bcast:31 row_mask:0xc bank_mask:0xf
  v_sub_u32 v12, v11, v10
  v_add_u32 v13, v12, v4
  v_add_u32 v14, v12, v8
  v_add_u32 v15, v12, v9
  ds_write_b128 v1, v[12:15] offset:26624
  ds_read_b32 v20, v20 offset:26624
  ds_read_b32 v21, v21 offset:26624
  ds_read_b32 v22, v22 offset:26624
  ds_read_b32 v23, v23 offset:26624
  ds_read_b32 v24, v24 offset:26624
  s_cmp_ge_u32 s31, 64
  s_cbranch_scc1 K1NOOFS
  v_lshl_or_b32 v16, v4, 16, v12
  v_lshl_or_b32 v17, v5, 16, v13
  v_lshl_or_b32 v18, v6, 16, v14
  v_lshl_or_b32 v19, v7, 16, v15
  s_lshl_b32 s3, s2, 10
  buffer_store_dwordx4 v[16:19], v1, s[24:27], s3 offen
K1NOOFS:
  s_waitcnt lgkmcnt(4)
  v_add_lshl_u32 v20, v20, v28, 3
  ds_write_b64 v20, v[36:37]
  s_waitcnt lgkmcnt(4)
  v_add_lshl_u32 v21, v21, v29, 3
  ds_write_b64 v21, v[38:39]
  s_waitcnt lgkmcnt(4)
  v_add_lshl_u32 v22, v22, v30, 3
  ds_write_b64 v22, v[40:41]
  s_waitcnt lgkmcnt(4)
  v_add_lshl_u32 v23, v23, v31, 3
  ds_write_b64 v23, v[42:43]
  s_waitcnt lgkmcnt(4)
  v_add_lshl_u32 v24, v24, v32, 3
  ds_write_b64 v24, v[44:45]
  v_lshlrev_b32 v3, 3, v0
  s_mul_i32 s3, s2, 25600
  s_add_u32 s4, s3, 10240
  s_add_u32 s5, s3, 20480
  s_waitcnt lgkmcnt(0)
  s_barrier
  ds_read_b128 v[4:7], v2
  ds_read_b128 v[8:11], v2 offset:10240
  ds_read_b64 v[12:13], v3 offset:20480
  s_waitcnt lgkmcnt(2)
  buffer_store_dwordx4 v[4:7], v2, s[20:23], s3 offen
  s_waitcnt lgkmcnt(1)
  buffer_store_dwordx4 v[8:11], v2, s[20:23], s4 offen
  s_waitcnt lgkmcnt(0)
  buffer_store_dwordx2 v[12:13], v3, s[20:23], s5 offen
K1END:
  s_endpgm
.globl main_kernel
.p2align 8
.type main_kernel,@function
main_kernel:
  s_cmp_ge_u32 s2, 256
  s_cbranch_scc1 K2END
  s_and_b32 s3, s2, 7
  s_lshl_b32 s3, s3, 5
  s_lshr_b32 s56, s2, 3
  s_add_u32 s56, s56, s3
  s_cmp_ge_u32 s56, 250
  s_cbranch_scc1 K2END
  s_load_dwordx16 s[32:47], s[0:1], 0
  s_load_dwordx2 s[48:49], s[0:1], 64
  s_load_dwordx2 s[52:53], s[0:1], 80
  v_lshrrev_b32 v2, 6, v0
  v_and_b32 v1, 63, v0
  v_readfirstlane_b32 s57, v2
  s_mov_b32 s60, 40
  s_mov_b32 s61, 0
  s_mov_b32 s63, 1
  s_movk_i32 s64, 128
  s_mov_b32 s65, 0xffff0000
  s_mov_b32 s70, 0xbfb8aa3b
  s_mov_b32 s71, 0xbfb8aa3b
  s_mov_b32 s72, 1.0
  s_mov_b32 s73, 1.0
  s_mov_b32 s74, -1
  s_mov_b32 s75, 0
  s_mul_i32 s58, s56, 200
  s_mul_i32 s3, s57, 25
  s_add_u32 s58, s58, s3
  s_lshl_b32 s66, s57, 13
  s_add_u32 s66, s66, 79872
  s_lshl_b32 s67, s57, 10
  s_add_u32 s67, s67, 34816
  s_waitcnt lgkmcnt(0)
  s_mov_b32 s4, s32
  s_mov_b32 s5, s33
  s_mov_b32 s6, 6400000
  s_mov_b32 s7, 0x20000
  s_mov_b32 s12, s34
  s_mov_b32 s13, s35
  s_mov_b32 s14, 300000
  s_mov_b32 s15, 0x20000
  s_mov_b32 s8, s36
  s_mov_b32 s9, s37
  s_mov_b32 s10, 25600000
  s_mov_b32 s11, 0x20000
  s_mov_b32 s16, s52
  s_mov_b32 s17, s53
  s_mov_b32 s18, 6400000
  s_mov_b32 s19, 0x20000
  s_mov_b32 s28, s48
  s_mov_b32 s29, s49
  s_mov_b32 s30, 6700000
  s_mov_b32 s31, 0x20000
  s_mov_b32 s24, s42
  s_mov_b32 s25, s43
  s_mov_b32 s26, 18560
  s_mov_b32 s27, 0x20000
  s_add_u32 s20, s52, 6815744
  s_addc_u32 s21, s53, 0
  s_mov_b32 s22, 256000
  s_mov_b32 s23, 0x20000
ROUND:
  v_lshrrev_b32 v2, 2, v1
  s_lshl_b32 s3, s57, 5
  v_add_u32 v2, s3, v2
  s_lshl_b32 s3, s56, 2
  v_lshl_add_u32 v3, v2, 10, s3
  v_add_u32 v4, 0x4000, v3
  buffer_load_dword v224, v3, s[20:23], 0 offen
  buffer_load_dword v225, v4, s[20:23], 0 offen
  s_movk_i32 s3, 25600
  v_mul_u32_u24 v226, s3, v2
  v_and_b32 v3, 3, v1
  v_lshl_add_u32 v226, v3, 4, v226
  v_add_u32 v227, 409600, v226
  v_and_b32 v4, 255, v0
  v_lshlrev_b32 v4, 2, v4
  v_mov_b32 v5, 0
  ds_write_b32 v4, v5 offset:32768
  s_cmp_eq_u32 s63, 0
  s_cbranch_scc1 NOTFIRST1
  v_and_b32 v2, 7, v1
  v_lshrrev_b32 v3, 4, v1
  v_and_b32 v3, 1, v3
  v_lshlrev_b32 v4, 2, v3
  v_xor_b32 v4, v4, v2
  v_lshlrev_b32 v4, 4, v4
  v_lshrrev_b32 v5, 3, v1
  v_lshl_or_b32 v4, v5, 7, v4
  s_lshl_b32 s3, s57, 10
  v_add_u32 v4, s3, v4
  s_add_u32 m0, s3, 43008
  s_nop 0
  buffer_load_dwordx4 v4, s[24:27], 0 offen lds
  v_add_u32 v4, 0x2000, v4
  s_add_u32 m0, s3, 51200
  s_nop 0
  buffer_load_dwordx4 v4, s[24:27], 0 offen lds
  v_add_u32 v4, 0x2000, v4
  s_add_u32 m0, s3, 59392
  s_nop 0
  buffer_load_dwordx4 v4, s[24:27], 0 offen lds
  v_lshrrev_b32 v6, 5, v1
  v_lshl_add_u32 v238, v6, 2, 0
  v_xor_b32 v238, v238, v2
  v_lshlrev_b32 v238, 4, v238
  v_lshl_add_u32 v7, v5, 2, s58
  v_add_u32 v7, 0, v7
  v_mad_u32_u24 v7, v7, s64, v238
  s_add_u32 m0, s66, 0
  s_nop 0
  buffer_load_dwordx4 v7, s[4:7], 0 offen lds
  v_lshl_add_u32 v239, v6, 2, 1
  v_xor_b32 v239, v239, v2
  v_lshlrev_b32 v239, 4, v239
  v_lshl_add_u32 v7, v5, 2, s58
  v_add_u32 v7, 1, v7
  v_mad_u32_u24 v7, v7, s64, v239
  s_add_u32 m0, s66, 1024
  s_nop 0
  buffer_load_dwordx4 v7, s[4:7], 0 offen lds
  v_lshl_add_u32 v240, v6, 2, 2
  v_xor_b32 v240, v240, v2
  v_lshlrev_b32 v240, 4, v240
  v_lshl_add_u32 v7, v5, 2, s58
  v_add_u32 v7, 2, v7
  v_mad_u32_u24 v7, v7, s64, v240
  s_add_u32 m0, s66, 2048
  s_nop 0
  buffer_load_dwordx4 v7, s[4:7], 0 offen lds
  v_lshl_add_u32 v241, v6, 2, 3
  v_xor_b32 v241, v241, v2
  v_lshlrev_b32 v241, 4, v241
  v_lshl_add_u32 v7, v5, 2, s58
  v_add_u32 v7, 3, v7
  v_mad_u32_u24 v7, v7, s64, v241
  s_add_u32 m0, s66, 3072
  s_nop 0
  buffer_load_dwordx4 v7, s[4:7], 0 offen lds
  v_add_u32 v236, s58, v1
  v_mul_u32_u24 v7, 6, v236
  v_and_b32 v7, -4, v7
  buffer_load_dwordx2 v[232:233], v7, s[12:15], 0 offen
  s_mov_b32 s24, s44
  s_mov_b32 s25, s45
  s_mov_b32 s26, 128
  s_mov_b32 s27, 0x20000
  v_lshlrev_b32 v7, 3, v6
  buffer_load_dwordx2 v[72:73], v7, s[24:27], 0 offen offset:0
  buffer_load_dwordx2 v[74:75], v7, s[24:27], 0 offen offset:16
  buffer_load_dwordx2 v[76:77], v7, s[24:27], 0 offen offset:32
  buffer_load_dwordx2 v[78:79], v7, s[24:27], 0 offen offset:48
  buffer_load_dwordx2 v[80:81], v7, s[24:27], 0 offen offset:64
  buffer_load_dwordx2 v[82:83], v7, s[24:27], 0 offen offset:80
  buffer_load_dwordx2 v[84:85], v7, s[24:27], 0 offen offset:96
  buffer_load_dwordx2 v[86:87], v7, s[24:27], 0 offen offset:112
  s_mov_b32 s24, s46
  s_mov_b32 s25, s47
  s_mov_b32 s26, 16384
  s_mov_b32 s27, 0x20000
  v_lshlrev_b32 v4, 1, v3
  v_xor_b32 v4, v4, v2
  v_lshlrev_b32 v4, 4, v4
  v_lshl_or_b32 v4, v5, 7, v4
  v_add_u32 v4, s3, v4
  s_add_u32 m0, s3, 145408
  s_nop 0
  buffer_load_dwordx4 v4, s[24:27], 0 offen lds
  v_add_u32 v4, 0x2000, v4
  s_add_u32 m0, s3, 153600
  s_nop 0
  buffer_load_dwordx4 v4, s[24:27], 0 offen lds
  v_lshlrev_b32 v15, 4, v6
  v_and_b32 v2, 3, v1
  v_bfe_u32 v4, v1, 2, 3
  v_lshl_add_u32 v4, v2, 3, v4
  v_xor_b32 v7, v3, v6
  v_lshlrev_b32 v7, 6, v7
  v_lshl_add_u32 v4, v4, 7, v7
  v_add_u32 v4, s66, v4
  v_xor_b32 v7, 0, v2
  v_lshl_add_u32 v242, v7, 4, v4
  v_xor_b32 v7, 1, v2
  v_lshl_add_u32 v243, v7, 4, v4
  v_xor_b32 v7, 2, v2
  v_lshl_add_u32 v244, v7, 4, v4
  v_xor_b32 v7, 3, v2
  v_lshl_add_u32 v245, v7, 4, v4
  s_add_u32 s3, s67, 32
  v_lshlrev_b32 v7, 5, v6
  v_sub_u32 v246, s3, v7
  s_add_u32 s3, s67, 224
  v_lshl_add_u32 v7, v3, 2, v2
  v_lshlrev_b32 v7, 5, v7
  v_sub_u32 v249, s3, v7
  s_mul_i32 s3, s57, 4608
  s_add_u32 s3, s3, 43008
  v_and_b32 v7, 31, v1
  s_movk_i32 s68, 144
  v_mul_u32_u24 v8, s68, v7
  v_add_u32 v8, s3, v8
  v_lshl_add_u32 v247, v6, 6, v8
  v_lshl_add_u32 v248, v6, 3, v8
  v_add_u32 v248, 128, v248
  v_bfe_u32 v4, v1, 2, 2
  v_lshl_add_u32 v8, v6, 2, v4
  s_movk_i32 s68, 576
  v_mul_u32_u24 v9, s68, v8
  v_add_u32 v9, s3, v9
  v_add_u32 v251, 128, v9
  v_lshl_add_u32 v250, v3, 5, v9
  v_lshl_add_u32 v250, v2, 3, v250
  v_mov_b32 v152, 0
  v_mov_b32 v153, 0
  v_mov_b32 v154, 0x3f80
  v_mov_b32 v155, 1.0
  v_cmp_eq_u32 vcc, 28, v1
  s_nop 1
  v_cndmask_b32 v152, v152, v154, vcc
  v_cmp_eq_u32 vcc, 29, v1
  s_nop 1
  v_cndmask_b32 v152, v152, v155, vcc
  v_cmp_eq_u32 vcc, 30, v1
  s_nop 1
  v_cndmask_b32 v153, v153, v154, vcc
  v_cmp_eq_u32 vcc, 31, v1
  s_nop 1
  v_cndmask_b32 v153, v153, v155, vcc
  v_lshl_add_u32 v9, v1, 3, s67
  ds_write_b64 v9, v[152:153]
  v_mov_b32 v88, 0
  v_mov_b32 v89, 0
  v_mov_b32 v90, 0
  v_mov_b32 v91, 0
  v_mov_b32 v92, 0
  v_mov_b32 v93, 0
  v_mov_b32 v94, 0
  v_mov_b32 v95, 0
  v_mov_b32 v96, 0
  v_mov_b32 v97, 0
  v_mov_b32 v98, 0
  v_mov_b32 v99, 0
  v_mov_b32 v100, 0
  v_mov_b32 v101, 0
  v_mov_b32 v102, 0
  v_mov_b32 v103, 0
  v_mov_b32 v104, 0
  v_mov_b32 v105, 0
  v_mov_b32 v106, 0
  v_mov_b32 v107, 0
  v_mov_b32 v108, 0
  v_mov_b32 v109, 0
  v_mov_b32 v110, 0
  v_mov_b32 v111, 0
  v_mov_b32 v112, 0
  v_mov_b32 v113, 0
  v_mov_b32 v114, 0
  v_mov_b32 v115, 0
  v_mov_b32 v116, 0
  v_mov_b32 v117, 0
  v_mov_b32 v118, 0
  v_mov_b32 v119, 0
  v_mov_b32 v120, 0
  v_mov_b32 v121, 0
  v_mov_b32 v122, 0
  v_mov_b32 v123, 0
  v_mov_b32 v124, 0
  v_mov_b32 v125, 0
  v_mov_b32 v126, 0
  v_mov_b32 v127, 0
  v_mov_b32 v128, 0
  v_mov_b32 v129, 0
  v_mov_b32 v130, 0
  v_mov_b32 v131, 0
  v_mov_b32 v132, 0
  v_mov_b32 v133, 0
  v_mov_b32 v134, 0
  v_mov_b32 v135, 0
  s_waitcnt vmcnt(18)
  s_branch FIRST1
NOTFIRST1:
  s_waitcnt vmcnt(0)
FIRST1:
  v_lshrrev_b32 v2, 16, v224
  v_and_b32 v3, 0xffff, v224
  v_add_u32 v3, s61, v3
  v_lshl_add_u32 v226, v3, 3, v226
  v_subrev_u32 v224, s61, v2
  v_min_i32 v2, s60, v224
  v_and_b32 v3, 3, v1
  v_lshlrev_b32 v3, 1, v3
  v_sub_u32 v228, v2, v3
  v_cmpx_lt_i32 vcc, 0, v228
  s_cbranch_execz LDDONE0
  buffer_load_dwordx4 v[152:155], v226, s[16:19], 0 offen offset:0
  v_cmpx_lt_i32 vcc, 8, v228
  s_cbranch_execz LDDONE0
  buffer_load_dwordx4 v[156:159], v226, s[16:19], 0 offen offset:64
  v_cmpx_lt_i32 vcc, 16, v228
  s_cbranch_execz LDDONE0
  buffer_load_dwordx4 v[160:163], v226, s[16:19], 0 offen offset:128
  v_cmpx_lt_i32 vcc, 24, v228
  s_cbranch_execz LDDONE0
  buffer_load_dwordx4 v[164:167], v226, s[16:19], 0 offen offset:192
  v_cmpx_lt_i32 vcc, 32, v228
  s_cbranch_execz LDDONE0
  buffer_load_dwordx4 v[168:171], v226, s[16:19], 0 offen offset:256
LDDONE0:
  s_mov_b64 exec, -1
  v_lshrrev_b32 v2, 16, v225
  v_and_b32 v3, 0xffff, v225
  v_add_u32 v3, s61, v3
  v_lshl_add_u32 v227, v3, 3, v227
  v_subrev_u32 v225, s61, v2
  v_min_i32 v2, s60, v225
  v_and_b32 v3, 3, v1
  v_lshlrev_b32 v3, 1, v3
  v_sub_u32 v229, v2, v3
  v_cmpx_lt_i32 vcc, 0, v229
  s_cbranch_execz LDDONE1
  buffer_load_dwordx4 v[172:175], v227, s[16:19], 0 offen offset:0
  v_cmpx_lt_i32 vcc, 8, v229
  s_cbranch_execz LDDONE1
  buffer_load_dwordx4 v[176:179], v227, s[16:19], 0 offen offset:64
  v_cmpx_lt_i32 vcc, 16, v229
  s_cbranch_execz LDDONE1
  buffer_load_dwordx4 v[180:183], v227, s[16:19], 0 offen offset:128
  v_cmpx_lt_i32 vcc, 24, v229
  s_cbranch_execz LDDONE1
  buffer_load_dwordx4 v[184:187], v227, s[16:19], 0 offen offset:192
  v_cmpx_lt_i32 vcc, 32, v229
  s_cbranch_execz LDDONE1
  buffer_load_dwordx4 v[188:191], v227, s[16:19], 0 offen offset:256
LDDONE1:
  s_mov_b64 exec, -1
  v_max_i32 v2, v224, v225
  v_cmp_lt_i32 vcc, s60, v2
  s_mov_b64 s[68:69], vcc
  s_waitcnt vmcnt(0) lgkmcnt(0)
  s_barrier
  s_cmp_eq_u64 s[68:69], 0
  s_cbranch_scc1 NOFLAG
  v_mov_b32 v2, 33280
  ds_write_b32 v2, v2
NOFLAG:
  v_mov_b32 v3, 1
  v_cmpx_lt_i32 vcc, 0, v228
  s_cbranch_execz RKDONE0
  v_lshlrev_b32_sdwa v2, 2, v153 dst_sel:DWORD dst_unused:UNUSED_PAD src0_sel:DWORD src1_sel:BYTE_3
  ds_add_rtn_u32 v192, v2, v3 offset:32768
  v_cmpx_lt_i32 vcc, 1, v228
  s_cbranch_execz RKDONE0
  v_lshlrev_b32_sdwa v2, 2, v155 dst_sel:DWORD dst_unused:UNUSED_PAD src0_sel:DWORD src1_sel:BYTE_3
  ds_add_rtn_u32 v193, v2, v3 offset:32768
  v_cmpx_lt_i32 vcc, 8, v228
  s_cbranch_execz RKDONE0
  v_lshlrev_b32_sdwa v2, 2, v157 dst_sel:DWORD dst_unused:UNUSED_PAD src0_sel:DWORD src1_sel:BYTE_3
  ds_add_rtn_u32 v194, v2, v3 offset:32768
  v_cmpx_lt_i32 vcc, 9, v228
  s_cbranch_execz RKDONE0
  v_lshlrev_b32_sdwa v2, 2, v159 dst_sel:DWORD dst_unused:UNUSED_PAD src0_sel:DWORD src1_sel:BYTE_3
  ds_add_rtn_u32 v195, v2, v3 offset:32768
  v_cmpx_lt_i32 vcc, 16, v228
  s_cbranch_execz RKDONE0
  v_lshlrev_b32_sdwa v2, 2, v161 dst_sel:DWORD dst_unused:UNUSED_PAD src0_sel:DWORD src1_sel:BYTE_3
  ds_add_rtn_u32 v196, v2, v3 offset:32768
  v_cmpx_lt_i32 vcc, 17, v228
  s_cbranch_execz RKDONE0
  v_lshlrev_b32_sdwa v2, 2, v163 dst_sel:DWORD dst_unused:UNUSED_PAD src0_sel:DWORD src1_sel:BYTE_3
  ds_add_rtn_u32 v197, v2, v3 offset:32768
  v_cmpx_lt_i32 vcc, 24, v228
  s_cbranch_execz RKDONE0
  v_lshlrev_b32_sdwa v2, 2, v165 dst_sel:DWORD dst_unused:UNUSED_PAD src0_sel:DWORD src1_sel:BYTE_3
  ds_add_rtn_u32 v198, v2, v3 offset:32768
  v_cmpx_lt_i32 vcc, 25, v228
  s_cbranch_execz RKDONE0
  v_lshlrev_b32_sdwa v2, 2, v167 dst_sel:DWORD dst_unused:UNUSED_PAD src0_sel:DWORD src1_sel:BYTE_3
  ds_add_rtn_u32 v199, v2, v3 offset:32768
  v_cmpx_lt_i32 vcc, 32, v228
  s_cbranch_execz RKDONE0
  v_lshlrev_b32_sdwa v2, 2, v169 dst_sel:DWORD dst_unused:UNUSED_PAD src0_sel:DWORD src1_sel:BYTE_3
  ds_add_rtn_u32 v200, v2, v3 offset:32768
  v_cmpx_lt_i32 vcc, 33, v228
  s_cbranch_execz RKDONE0
  v_lshlrev_b32_sdwa v2, 2, v171 dst_sel:DWORD dst_unused:UNUSED_PAD src0_sel:DWORD src1_sel:BYTE_3
  ds_add_rtn_u32 v201, v2, v3 offset:32768
RKDONE0:
  s_mov_b64 exec, -1
  v_cmpx_lt_i32 vcc, 0, v229
  s_cbranch_execz RKDONE1
  v_lshlrev_b32_sdwa v2, 2, v173 dst_sel:DWORD dst_unused:UNUSED_PAD src0_sel:DWORD src1_sel:BYTE_3
  ds_add_rtn_u32 v202, v2, v3 offset:32768
  v_cmpx_lt_i32 vcc, 1, v229
  s_cbranch_execz RKDONE1
  v_lshlrev_b32_sdwa v2, 2, v175 dst_sel:DWORD dst_unused:UNUSED_PAD src0_sel:DWORD src1_sel:BYTE_3
  ds_add_rtn_u32 v203, v2, v3 offset:32768
  v_cmpx_lt_i32 vcc, 8, v229
  s_cbranch_execz RKDONE1
  v_lshlrev_b32_sdwa v2, 2, v177 dst_sel:DWORD dst_unused:UNUSED_PAD src0_sel:DWORD src1_sel:BYTE_3
  ds_add_rtn_u32 v204, v2, v3 offset:32768
  v_cmpx_lt_i32 vcc, 9, v229
  s_cbranch_execz RKDONE1
  v_lshlrev_b32_sdwa v2, 2, v179 dst_sel:DWORD dst_unused:UNUSED_PAD src0_sel:DWORD src1_sel:BYTE_3
  ds_add_rtn_u32 v205, v2, v3 offset:32768
  v_cmpx_lt_i32 vcc, 16, v229
  s_cbranch_execz RKDONE1
  v_lshlrev_b32_sdwa v2, 2, v181 dst_sel:DWORD dst_unused:UNUSED_PAD src0_sel:DWORD src1_sel:BYTE_3
  ds_add_rtn_u32 v206, v2, v3 offset:32768
  v_cmpx_lt_i32 vcc, 17, v229
  s_cbranch_execz RKDONE1
  v_lshlrev_b32_sdwa v2, 2, v183 dst_sel:DWORD dst_unused:UNUSED_PAD src0_sel:DWORD src1_sel:BYTE_3
  ds_add_rtn_u32 v207, v2, v3 offset:32768
  v_cmpx_lt_i32 vcc, 24, v229
  s_cbranch_execz RKDONE1
  v_lshlrev_b32_sdwa v2, 2, v185 dst_sel:DWORD dst_unused:UNUSED_PAD src0_sel:DWORD src1_sel:BYTE_3
  ds_add_rtn_u32 v208, v2, v3 offset:32768
  v_cmpx_lt_i32 vcc, 25, v229
  s_cbranch_execz RKDONE1
  v_lshlrev_b32_sdwa v2, 2, v187 dst_sel:DWORD dst_unused:UNUSED_PAD src0_sel:DWORD src1_sel:BYTE_3
  ds_add_rtn_u32 v209, v2, v3 offset:32768
  v_cmpx_lt_i32 vcc, 32, v229
  s_cbranch_execz RKDONE1
  v_lshlrev_b32_sdwa v2, 2, v189 dst_sel:DWORD dst_unused:UNUSED_PAD src0_sel:DWORD src1_sel:BYTE_3
  ds_add_rtn_u32 v210, v2, v3 offset:32768
  v_cmpx_lt_i32 vcc, 33, v229
  s_cbranch_execz RKDONE1
  v_lshlrev_b32_sdwa v2, 2, v191 dst_sel:DWORD dst_unused:UNUSED_PAD src0_sel:DWORD src1_sel:BYTE_3
  ds_add_rtn_u32 v211, v2, v3 offset:32768
RKDONE1:
  s_mov_b64 exec, -1
  s_cmp_eq_u32 s63, 0
  s_cbranch_scc1 NOTFIRST2
  v_lshlrev_b32 v5, 4, v236
  v_alignbit_b32 v6, v233, v232, v5
  v_lshrrev_b32 v7, v5, v233
  v_lshlrev_b32 v4, 16, v6
  v_and_b32 v5, s65, v6
  v_lshlrev_b32 v6, 16, v7
  v_lshl_add_u32 v9, v1, 3, s67
  s_mov_b64 exec, s[74:75]
  ds_write_b64 v9, v[4:5] offset:512
  ds_write_b32 v9, v6 offset:768
  s_mov_b64 exec, -1
  v_mov_b32 v232, 0
  v_mov_b32 v233, 0
  v_mov_b32 v234, 0
  v_mov_b32 v235, 0
  ds_read_b128 v[136:139], v242
  ds_read_b128 v[140:143], v243
  ds_read_b128 v[144:147], v244
  ds_read_b128 v[148:151], v245
  v_and_b32 v2, 3, v1
  v_bfe_u32 v3, v1, 4, 1
  v_bfe_u32 v4, v1, 2, 2
  v_lshrrev_b32 v5, 5, v1
  v_lshlrev_b32 v2, 3, v2
  v_lshl_add_u32 v2, v3, 5, v2
  v_add_u32 v2, 43008, v2
  v_lshl_add_u32 v2, v4, 7, v2
  v_lshl_add_u32 v6, v5, 12, v2
  v_lshrrev_b32 v3, 1, v4
  v_lshl_add_u32 v6, v3, 6, v6
  v_xor_b32 v7, 64, v6
  v_lshl_add_u32 v8, v5, 10, v2
  v_add_u32 v3, 1, v4
  v_bfe_u32 v3, v3, 1, 1
  v_lshl_add_u32 v8, v3, 6, v8
  v_xor_b32 v9, 64, v8
  ds_read_b64_tr_b16 v[16:17], v6 offset:0
  ds_read_b64_tr_b16 v[18:19], v6 offset:512
  ds_read_b64_tr_b16 v[20:21], v6 offset:1024
  ds_read_b64_tr_b16 v[22:23], v6 offset:1536
  ds_read_b64_tr_b16 v[24:25], v6 offset:2048
  ds_read_b64_tr_b16 v[26:27], v6 offset:2560
  ds_read_b64_tr_b16 v[28:29], v6 offset:3072
  ds_read_b64_tr_b16 v[30:31], v6 offset:3584
  ds_read_b64_tr_b16 v[32:33], v7 offset:0
  ds_read_b64_tr_b16 v[34:35], v7 offset:512
  ds_read_b64_tr_b16 v[36:37], v7 offset:1024
  ds_read_b64_tr_b16 v[38:39], v7 offset:1536
  ds_read_b64_tr_b16 v[40:41], v7 offset:2048
  ds_read_b64_tr_b16 v[42:43], v7 offset:2560
  ds_read_b64_tr_b16 v[44:45], v7 offset:3072
  ds_read_b64_tr_b16 v[46:47], v7 offset:3584
  ds_read_b64_tr_b16 v[48:49], v8 offset:16512
  ds_read_b64_tr_b16 v[50:51], v8 offset:17024
  ds_read_b64_tr_b16 v[52:53], v9 offset:16512
  ds_read_b64_tr_b16 v[54:55], v9 offset:17024
  v_and_b32 v2, 31, v1
  v_lshlrev_b32 v2, 1, v2
  v_add_u32 v2, 59392, v2
  ds_read_u16 v10, v2
  ds_read_u16 v11, v2 offset:64
  s_waitcnt lgkmcnt(0)
  v_mfma_f32_32x32x16_bf16 v[88:103], v[136:139], v[16:19], v[88:103]
  v_mfma_f32_32x32x16_bf16 v[88:103], v[140:143], v[20:23], v[88:103]
  v_mfma_f32_32x32x16_bf16 v[88:103], v[144:147], v[24:27], v[88:103]
  v_mfma_f32_32x32x16_bf16 v[88:103], v[148:151], v[28:31], v[88:103]
  v_mfma_f32_32x32x16_bf16 v[104:119], v[136:139], v[32:35], v[104:119]
  v_mfma_f32_32x32x16_bf16 v[104:119], v[140:143], v[36:39], v[104:119]
  v_mfma_f32_32x32x16_bf16 v[104:119], v[144:147], v[40:43], v[104:119]
  v_mfma_f32_32x32x16_bf16 v[104:119], v[148:151], v[44:47], v[104:119]
  ds_read_b64_tr_b16 v[16:17], v6 offset:8192
  ds_read_b64_tr_b16 v[18:19], v6 offset:8704
  ds_read_b64_tr_b16 v[20:21], v6 offset:9216
  ds_read_b64_tr_b16 v[22:23], v6 offset:9728
  ds_read_b64_tr_b16 v[24:25], v6 offset:10240
  ds_read_b64_tr_b16 v[26:27], v6 offset:10752
  ds_read_b64_tr_b16 v[28:29], v6 offset:11264
  ds_read_b64_tr_b16 v[30:31], v6 offset:11776
  ds_read_b64_tr_b16 v[32:33], v7 offset:8192
  ds_read_b64_tr_b16 v[34:35], v7 offset:8704
  ds_read_b64_tr_b16 v[36:37], v7 offset:9216
  ds_read_b64_tr_b16 v[38:39], v7 offset:9728
  ds_read_b64_tr_b16 v[40:41], v7 offset:10240
  ds_read_b64_tr_b16 v[42:43], v7 offset:10752
  ds_read_b64_tr_b16 v[44:45], v7 offset:11264
  ds_read_b64_tr_b16 v[46:47], v7 offset:11776
  v_subrev_u32 v5, 1, v5
  v_cvt_pk_bf16_f32 v56, v88, v89
  v_cvt_pk_bf16_f32 v57, v90, v91
  v_cvt_pk_bf16_f32 v58, v92, v93
  v_cvt_pk_bf16_f32 v59, v94, v95
  v_cvt_pk_bf16_f32 v60, v96, v97
  v_cvt_pk_bf16_f32 v61, v98, v99
  v_cvt_pk_bf16_f32 v62, v100, v101
  v_and_b32 v63, v5, v10
  v_cvt_pk_bf16_f32 v64, v104, v105
  v_cvt_pk_bf16_f32 v65, v106, v107
  v_cvt_pk_bf16_f32 v66, v108, v109
  v_cvt_pk_bf16_f32 v67, v110, v111
  v_cvt_pk_bf16_f32 v68, v112, v113
  v_cvt_pk_bf16_f32 v69, v114, v115
  v_cvt_pk_bf16_f32 v70, v116, v117
  v_and_b32 v71, v5, v11
  v_mov_b32 v88, 0
  v_mov_b32 v89, 0
  v_mov_b32 v90, 0
  v_mov_b32 v91, 0
  v_mov_b32 v92, 0
  v_mov_b32 v93, 0
  v_mov_b32 v94, 0
  v_mov_b32 v95, 0
  v_mov_b32 v96, 0
  v_mov_b32 v97, 0
  v_mov_b32 v98, 0
  v_mov_b32 v99, 0
  v_mov_b32 v100, 0
  v_mov_b32 v101, 0
  v_mov_b32 v102, 0
  v_mov_b32 v103, 0
  v_mov_b32 v104, 0
  v_mov_b32 v105, 0
  v_mov_b32 v106, 0
  v_mov_b32 v107, 0
  v_mov_b32 v108, 0
  v_mov_b32 v109, 0
  v_mov_b32 v110, 0
  v_mov_b32 v111, 0
  v_mov_b32 v112, 0
  v_mov_b32 v113, 0
  v_mov_b32 v114, 0
  v_mov_b32 v115, 0
  v_mov_b32 v116, 0
  v_mov_b32 v117, 0
  v_mov_b32 v118, 0
  v_mov_b32 v119, 0
  s_mov_b32 s63, 0
NOTFIRST2:
  v_lshlrev_b32 v2, 2, v1
  v_mov_b32 v3, 33280
  s_waitcnt lgkmcnt(0)
  s_barrier
  ds_read2st64_b32 v[4:5], v2 offset0:128 offset1:129
  ds_read_b32 v8, v3
  s_waitcnt lgkmcnt(0)
  v_readfirstlane_b32 s62, v8
  v_mov_b32 v6, v4
  v_mov_b32 v7, v5
  s_nop 0
  v_add_u32_dpp v6, v6, v6 row_shr:1 row_mask:0xf bank_mask:0xf
  v_add_u32_dpp v7, v7, v7 row_shr:1 row_mask:0xf bank_mask:0xf
  s_nop 0
  v_add_u32_dpp v6, v6, v6 row_shr:2 row_mask:0xf bank_mask:0xf
  v_add_u32_dpp v7, v7, v7 row_shr:2 row_mask:0xf bank_mask:0xf
  s_nop 0
  v_add_u32_dpp v6, v6, v6 row_shr:4 row_mask:0xf bank_mask:0xf
  v_add_u32_dpp v7, v7, v7 row_shr:4 row_mask:0xf bank_mask:0xf
  s_nop 0
  v_add_u32_dpp v6, v6, v6 row_shr:8 row_mask:0xf bank_mask:0xf
  v_add_u32_dpp v7, v7, v7 row_shr:8 row_mask:0xf bank_mask:0xf
  v_max_u32 v8, v6, v7
  v_cmp_lt_u32 vcc, 0x200, v8
  s_cbranch_vccz NOOVF
  s_lshr_b32 s60, s60, 1
  s_barrier
  s_branch ROUND
NOOVF:
  s_and_b32 s3, s57, 3
  s_lshl_b32 s3, s3, 4
  s_add_u32 s3, s3, 15
  v_readlane_b32 s68, v6, s3
  v_readlane_b32 s69, v7, s3
  v_lshrrev_b32 v8, 4, v1
  v_lshlrev_b32 v8, 9, v8
  v_sub_u32 v6, v6, v4
  v_sub_u32 v7, v7, v5
  v_add_u32 v6, v6, v8
  v_add_u32 v7, v7, v8
  v_add_u32 v7, 0x800, v7
  ds_write2st64_b32 v2, v6, v7 offset0:132 offset1:133
  s_cmp_ge_u32 s57, 4
  s_cselect_b32 s68, s69, s68
  s_add_u32 s59, s68, 31
  s_lshr_b32 s59, s59, 5
  v_cmpx_lt_i32 vcc, 0, v228
  s_cbranch_execz BSDONE0
  v_lshlrev_b32_sdwa v2, 2, v153 dst_sel:DWORD dst_unused:UNUSED_PAD src0_sel:DWORD src1_sel:BYTE_3
  ds_read_b32 v212, v2 offset:33792
  v_cmpx_lt_i32 vcc, 1, v228
  s_cbranch_execz BSDONE0
  v_lshlrev_b32_sdwa v2, 2, v155 dst_sel:DWORD dst_unused:UNUSED_PAD src0_sel:DWORD src1_sel:BYTE_3
  ds_read_b32 v213, v2 offset:33792
  v_cmpx_lt_i32 vcc, 8, v228
  s_cbranch_execz BSDONE0
  v_lshlrev_b32_sdwa v2, 2, v157 dst_sel:DWORD dst_unused:UNUSED_PAD src0_sel:DWORD src1_sel:BYTE_3
  ds_read_b32 v214, v2 offset:33792
  v_cmpx_lt_i32 vcc, 9, v228
  s_cbranch_execz BSDONE0
  v_lshlrev_b32_sdwa v2, 2, v159 dst_sel:DWORD dst_unused:UNUSED_PAD src0_sel:DWORD src1_sel:BYTE_3
  ds_read_b32 v215, v2 offset:33792
  v_cmpx_lt_i32 vcc, 16, v228
  s_cbranch_execz BSDONE0
  v_lshlrev_b32_sdwa v2, 2, v161 dst_sel:DWORD dst_unused:UNUSED_PAD src0_sel:DWORD src1_sel:BYTE_3
  ds_read_b32 v216, v2 offset:33792
  v_cmpx_lt_i32 vcc, 17, v228
  s_cbranch_execz BSDONE0
  v_lshlrev_b32_sdwa v2, 2, v163 dst_sel:DWORD dst_unused:UNUSED_PAD src0_sel:DWORD src1_sel:BYTE_3
  ds_read_b32 v217, v2 offset:33792
  v_cmpx_lt_i32 vcc, 24, v228
  s_cbranch_execz BSDONE0
  v_lshlrev_b32_sdwa v2, 2, v165 dst_sel:DWORD dst_unused:UNUSED_PAD src0_sel:DWORD src1_sel:BYTE_3
  ds_read_b32 v218, v2 offset:33792
  v_cmpx_lt_i32 vcc, 25, v228
  s_cbranch_execz BSDONE0
  v_lshlrev_b32_sdwa v2, 2, v167 dst_sel:DWORD dst_unused:UNUSED_PAD src0_sel:DWORD src1_sel:BYTE_3
  ds_read_b32 v219, v2 offset:33792
  v_cmpx_lt_i32 vcc, 32, v228
  s_cbranch_execz BSDONE0
  v_lshlrev_b32_sdwa v2, 2, v169 dst_sel:DWORD dst_unused:UNUSED_PAD src0_sel:DWORD src1_sel:BYTE_3
  ds_read_b32 v220, v2 offset:33792
  v_cmpx_lt_i32 vcc, 33, v228
  s_cbranch_execz BSDONE0
  v_lshlrev_b32_sdwa v2, 2, v171 dst_sel:DWORD dst_unused:UNUSED_PAD src0_sel:DWORD src1_sel:BYTE_3
  ds_read_b32 v221, v2 offset:33792
BSDONE0:
  s_mov_b64 exec, -1
  s_waitcnt lgkmcnt(0)
  v_cmpx_lt_i32 vcc, 0, v228
  s_cbranch_execz SCDONE0
  v_add_lshl_u32 v2, v212, v192, 2
  ds_write2st64_b32 v2, v152, v153 offset0:0 offset1:64
  v_cmpx_lt_i32 vcc, 1, v228
  s_cbranch_execz SCDONE0
  v_add_lshl_u32 v2, v213, v193, 2
  ds_write2st64_b32 v2, v154, v155 offset0:0 offset1:64
  v_cmpx_lt_i32 vcc, 8, v228
  s_cbranch_execz SCDONE0
  v_add_lshl_u32 v2, v214, v194, 2
  ds_write2st64_b32 v2, v156, v157 offset0:0 offset1:64
  v_cmpx_lt_i32 vcc, 9, v228
  s_cbranch_execz SCDONE0
  v_add_lshl_u32 v2, v215, v195, 2
  ds_write2st64_b32 v2, v158, v159 offset0:0 offset1:64
  v_cmpx_lt_i32 vcc, 16, v228
  s_cbranch_execz SCDONE0
  v_add_lshl_u32 v2, v216, v196, 2
  ds_write2st64_b32 v2, v160, v161 offset0:0 offset1:64
  v_cmpx_lt_i32 vcc, 17, v228
  s_cbranch_execz SCDONE0
  v_add_lshl_u32 v2, v217, v197, 2
  ds_write2st64_b32 v2, v162, v163 offset0:0 offset1:64
  v_cmpx_lt_i32 vcc, 24, v228
  s_cbranch_execz SCDONE0
  v_add_lshl_u32 v2, v218, v198, 2
  ds_write2st64_b32 v2, v164, v165 offset0:0 offset1:64
  v_cmpx_lt_i32 vcc, 25, v228
  s_cbranch_execz SCDONE0
  v_add_lshl_u32 v2, v219, v199, 2
  ds_write2st64_b32 v2, v166, v167 offset0:0 offset1:64
  v_cmpx_lt_i32 vcc, 32, v228
  s_cbranch_execz SCDONE0
  v_add_lshl_u32 v2, v220, v200, 2
  ds_write2st64_b32 v2, v168, v169 offset0:0 offset1:64
  v_cmpx_lt_i32 vcc, 33, v228
  s_cbranch_execz SCDONE0
  v_add_lshl_u32 v2, v221, v201, 2
  ds_write2st64_b32 v2, v170, v171 offset0:0 offset1:64
SCDONE0:
  s_mov_b64 exec, -1
  v_cmpx_lt_i32 vcc, 0, v229
  s_cbranch_execz BSDONE1
  v_lshlrev_b32_sdwa v2, 2, v173 dst_sel:DWORD dst_unused:UNUSED_PAD src0_sel:DWORD src1_sel:BYTE_3
  ds_read_b32 v212, v2 offset:33792
  v_cmpx_lt_i32 vcc, 1, v229
  s_cbranch_execz BSDONE1
  v_lshlrev_b32_sdwa v2, 2, v175 dst_sel:DWORD dst_unused:UNUSED_PAD src0_sel:DWORD src1_sel:BYTE_3
  ds_read_b32 v213, v2 offset:33792
  v_cmpx_lt_i32 vcc, 8, v229
  s_cbranch_execz BSDONE1
  v_lshlrev_b32_sdwa v2, 2, v177 dst_sel:DWORD dst_unused:UNUSED_PAD src0_sel:DWORD src1_sel:BYTE_3
  ds_read_b32 v214, v2 offset:33792
  v_cmpx_lt_i32 vcc, 9, v229
  s_cbranch_execz BSDONE1
  v_lshlrev_b32_sdwa v2, 2, v179 dst_sel:DWORD dst_unused:UNUSED_PAD src0_sel:DWORD src1_sel:BYTE_3
  ds_read_b32 v215, v2 offset:33792
  v_cmpx_lt_i32 vcc, 16, v229
  s_cbranch_execz BSDONE1
  v_lshlrev_b32_sdwa v2, 2, v181 dst_sel:DWORD dst_unused:UNUSED_PAD src0_sel:DWORD src1_sel:BYTE_3
  ds_read_b32 v216, v2 offset:33792
  v_cmpx_lt_i32 vcc, 17, v229
  s_cbranch_execz BSDONE1
  v_lshlrev_b32_sdwa v2, 2, v183 dst_sel:DWORD dst_unused:UNUSED_PAD src0_sel:DWORD src1_sel:BYTE_3
  ds_read_b32 v217, v2 offset:33792
  v_cmpx_lt_i32 vcc, 24, v229
  s_cbranch_execz BSDONE1
  v_lshlrev_b32_sdwa v2, 2, v185 dst_sel:DWORD dst_unused:UNUSED_PAD src0_sel:DWORD src1_sel:BYTE_3
  ds_read_b32 v218, v2 offset:33792
  v_cmpx_lt_i32 vcc, 25, v229
  s_cbranch_execz BSDONE1
  v_lshlrev_b32_sdwa v2, 2, v187 dst_sel:DWORD dst_unused:UNUSED_PAD src0_sel:DWORD src1_sel:BYTE_3
  ds_read_b32 v219, v2 offset:33792
  v_cmpx_lt_i32 vcc, 32, v229
  s_cbranch_execz BSDONE1
  v_lshlrev_b32_sdwa v2, 2, v189 dst_sel:DWORD dst_unused:UNUSED_PAD src0_sel:DWORD src1_sel:BYTE_3
  ds_read_b32 v220, v2 offset:33792
  v_cmpx_lt_i32 vcc, 33, v229
  s_cbranch_execz BSDONE1
  v_lshlrev_b32_sdwa v2, 2, v191 dst_sel:DWORD dst_unused:UNUSED_PAD src0_sel:DWORD src1_sel:BYTE_3
  ds_read_b32 v221, v2 offset:33792
BSDONE1:
  s_mov_b64 exec, -1
  s_waitcnt lgkmcnt(0)
  v_cmpx_lt_i32 vcc, 0, v229
  s_cbranch_execz SCDONE1
  v_add_lshl_u32 v2, v212, v202, 2
  ds_write2st64_b32 v2, v172, v173 offset0:0 offset1:64
  v_cmpx_lt_i32 vcc, 1, v229
  s_cbranch_execz SCDONE1
  v_add_lshl_u32 v2, v213, v203, 2
  ds_write2st64_b32 v2, v174, v175 offset0:0 offset1:64
  v_cmpx_lt_i32 vcc, 8, v229
  s_cbranch_execz SCDONE1
  v_add_lshl_u32 v2, v214, v204, 2
  ds_write2st64_b32 v2, v176, v177 offset0:0 offset1:64
  v_cmpx_lt_i32 vcc, 9, v229
  s_cbranch_execz SCDONE1
  v_add_lshl_u32 v2, v215, v205, 2
  ds_write2st64_b32 v2, v178, v179 offset0:0 offset1:64
  v_cmpx_lt_i32 vcc, 16, v229
  s_cbranch_execz SCDONE1
  v_add_lshl_u32 v2, v216, v206, 2
  ds_write2st64_b32 v2, v180, v181 offset0:0 offset1:64
  v_cmpx_lt_i32 vcc, 17, v229
  s_cbranch_execz SCDONE1
  v_add_lshl_u32 v2, v217, v207, 2
  ds_write2st64_b32 v2, v182, v183 offset0:0 offset1:64
  v_cmpx_lt_i32 vcc, 24, v229
  s_cbranch_execz SCDONE1
  v_add_lshl_u32 v2, v218, v208, 2
  ds_write2st64_b32 v2, v184, v185 offset0:0 offset1:64
  v_cmpx_lt_i32 vcc, 25, v229
  s_cbranch_execz SCDONE1
  v_add_lshl_u32 v2, v219, v209, 2
  ds_write2st64_b32 v2, v186, v187 offset0:0 offset1:64
  v_cmpx_lt_i32 vcc, 32, v229
  s_cbranch_execz SCDONE1
  v_add_lshl_u32 v2, v220, v210, 2
  ds_write2st64_b32 v2, v188, v189 offset0:0 offset1:64
  v_cmpx_lt_i32 vcc, 33, v229
  s_cbranch_execz SCDONE1
  v_add_lshl_u32 v2, v221, v211, 2
  ds_write2st64_b32 v2, v190, v191 offset0:0 offset1:64
SCDONE1:
  s_mov_b64 exec, -1
  s_lshl_b32 s3, s57, 11
  v_lshrrev_b32 v2, 3, v1
  v_lshl_add_u32 v252, v2, 4, s3
  v_and_b32 v2, 31, v1
  v_lshl_add_u32 v253, v2, 2, s3
  v_bfe_u32 v2, v1, 2, 2
  v_lshl_add_u32 v2, v2, 4, s3
  v_lshl_add_u32 v254, v15, 2, v2
  v_add_u32 v2, s68, v1
  s_lshl_b32 s69, s59, 5
  v_mov_b32 v4, 0xf800ffff
  v_mov_b32 v5, 0x00ffffff
  v_lshl_add_u32 v3, v2, 2, s3
  v_cmpx_gt_u32 vcc, s69, v2
  s_cbranch_execz NOPAD
  ds_write2st64_b32 v3, v4, v5 offset0:0 offset1:64
NOPAD:
  s_mov_b64 exec, -1
  s_waitcnt lgkmcnt(0)
  s_barrier
  s_cmp_eq_u32 s59, 0
  s_cbranch_scc1 LOOPEND
  ds_read_b128 v[224:227], v252 offset:0
  ds_read_b32 v236, v253 offset:0
  ds_read_b32 v13, v253 offset:16384
  s_waitcnt lgkmcnt(0)
  s_cmp_gt_u32 s59, 0
  s_cselect_b32 s6, 6400000, 0
  s_cselect_b32 s10, 25600000, 0
  s_cselect_b32 s14, 300000, 0
  v_mad_u32_u24 v13, v13, 32, v15
  buffer_load_dwordx4 v[216:219], v13, s[8:11], 0 offen
  s_add_u32 m0, s66, 0
  v_mad_u32_u24 v224, v224, s64, v238
  buffer_load_dwordx4 v224, s[4:7], 0 offen  lds
  s_add_u32 m0, s66, 1024
  v_mad_u32_u24 v225, v225, s64, v239
  buffer_load_dwordx4 v225, s[4:7], 0 offen  lds
  s_add_u32 m0, s66, 2048
  v_mad_u32_u24 v226, v226, s64, v240
  buffer_load_dwordx4 v226, s[4:7], 0 offen  lds
  s_add_u32 m0, s66, 3072
  v_mad_u32_u24 v227, v227, s64, v241
  buffer_load_dwordx4 v227, s[4:7], 0 offen  lds
  v_mul_u32_u24 v13, 6, v236
  v_and_b32 v13, -4, v13
  s_mov_b64 exec, s[74:75]
  buffer_load_dwordx2 v[232:233], v13, s[12:15], 0 offen
  s_mov_b64 exec, -1
  ds_read_b128 v[224:227], v252 offset:128
  ds_read_b32 v237, v253 offset:128
  ds_read_b32 v13, v253 offset:16512
  s_waitcnt lgkmcnt(0)
  s_cmp_gt_u32 s59, 1
  s_cselect_b32 s6, 6400000, 0
  s_cselect_b32 s10, 25600000, 0
  s_cselect_b32 s14, 300000, 0
  v_mad_u32_u24 v13, v13, 32, v15
  buffer_load_dwordx4 v[220:223], v13, s[8:11], 0 offen
  s_add_u32 m0, s66, 4096
  v_mad_u32_u24 v224, v224, s64, v238
  buffer_load_dwordx4 v224, s[4:7], 0 offen  lds
  s_add_u32 m0, s66, 5120
  v_mad_u32_u24 v225, v225, s64, v239
  buffer_load_dwordx4 v225, s[4:7], 0 offen  lds
  s_add_u32 m0, s66, 6144
  v_mad_u32_u24 v226, v226, s64, v240
  buffer_load_dwordx4 v226, s[4:7], 0 offen  lds
  s_add_u32 m0, s66, 7168
  v_mad_u32_u24 v227, v227, s64, v241
  buffer_load_dwordx4 v227, s[4:7], 0 offen  lds
  v_mul_u32_u24 v13, 6, v237
  v_and_b32 v13, -4, v13
  s_mov_b64 exec, s[74:75]
  buffer_load_dwordx2 v[234:235], v13, s[12:15], 0 offen
  s_mov_b64 exec, -1
LOOP:
  s_waitcnt vmcnt(6)
  v_add_u32_sdwa v14, v246, v236 dst_sel:DWORD dst_unused:UNUSED_PAD src0_sel:DWORD src1_sel:BYTE_3
  ds_read_b64 v[2:3], v14 offset:480
  ds_read_b32 v4, v14 offset:736
  ds_read_b128 v[184:187], v242 offset:0
  ds_read_b128 v[188:191], v243 offset:0
  ds_read_b128 v[192:195], v244 offset:0
  ds_read_b128 v[196:199], v245 offset:0
  ds_read_b64 v[200:201], v14 offset:192
  ds_read_b64 v[202:203], v14 offset:128
  ds_read_b64 v[204:205], v14 offset:64
  ds_read_b32 v206, v14
  v_lshlrev_b32 v5, 4, v236
  v_mfma_f32_32x32x16_bf16 v[152:167], v[48:51], v[216:219], 0
  ds_read_b128 v[224:227], v252 offset:256
  ds_read_b32 v236, v253 offset:256
  ds_read_b32 v13, v253 offset:16640
  ds_read_b128 v[228:231], v254 offset:0
  v_alignbit_b32 v6, v233, v232, v5
  v_lshrrev_b32 v7, v5, v233
  v_mfma_f32_32x32x16_bf16 v[168:183], v[52:55], v[216:219], 0
  v_lshlrev_b32 v5, 16, v6
  v_and_b32 v6, s65, v6
  v_lshlrev_b32 v7, 16, v7
  s_waitcnt lgkmcnt(12)
  v_sub_f32 v2, v2, v5
  v_sub_f32 v3, v3, v6
  v_sub_f32 v4, v4, v7
  s_waitcnt lgkmcnt(11)
  v_mfma_f32_32x32x16_bf16 v[152:167], v[16:19], v[184:187], v[152:167]
  v_cvt_pk_bf16_f32 v2, v2, v3
  v_cvt_pk_bf16_f32 v4, v4, v4
  v_lshlrev_b32 v10, 16, v2
  s_waitcnt lgkmcnt(10)
  v_mfma_f32_32x32x16_bf16 v[152:167], v[20:23], v[188:191], v[152:167]
  v_and_b32 v11, s65, v2
  v_lshlrev_b32 v12, 16, v4
  v_mul_f32 v2, v10, v10
  s_waitcnt lgkmcnt(9)
  v_mfma_f32_32x32x16_bf16 v[152:167], v[24:27], v[192:195], v[152:167]
  v_fmac_f32 v2, v11, v11
  v_fmac_f32 v2, v12, v12
  v_cvt_pk_bf16_f32 v207, v2, v2
  s_waitcnt lgkmcnt(8)
  v_mfma_f32_32x32x16_bf16 v[152:167], v[28:31], v[196:199], v[152:167]
  s_waitcnt lgkmcnt(4)
  v_mfma_f32_32x32x16_bf16 v[152:167], v[56:59], v[200:203], v[152:167]
  v_mfma_f32_32x32x16_bf16 v[152:167], v[60:63], v[204:207], v[152:167]
  s_waitcnt lgkmcnt(0)
  v_mfma_f32_32x32x16_bf16 v[168:183], v[32:35], v[184:187], v[168:183]
  s_cmp_gt_u32 s59, 2
  s_cselect_b32 s6, 6400000, 0
  s_cselect_b32 s10, 25600000, 0
  s_cselect_b32 s14, 300000, 0
  v_mad_u32_u24 v13, v13, 32, v15
  buffer_load_dwordx4 v[216:219], v13, s[8:11], 0 offen
  s_add_u32 m0, s66, 0
  v_mad_u32_u24 v224, v224, s64, v238
  buffer_load_dwordx4 v224, s[4:7], 0 offen  lds
  s_add_u32 m0, s66, 1024
  v_mad_u32_u24 v225, v225, s64, v239
  buffer_load_dwordx4 v225, s[4:7], 0 offen  lds
  s_add_u32 m0, s66, 2048
  v_mad_u32_u24 v226, v226, s64, v240
  buffer_load_dwordx4 v226, s[4:7], 0 offen  lds
  s_add_u32 m0, s66, 3072
  v_mad_u32_u24 v227, v227, s64, v241
  buffer_load_dwordx4 v227, s[4:7], 0 offen  lds
  v_mul_u32_u24 v13, 6, v236
  v_and_b32 v13, -4, v13
  s_mov_b64 exec, s[74:75]
  buffer_load_dwordx2 v[232:233], v13, s[12:15], 0 offen
  s_mov_b64 exec, -1
  v_mfma_f32_32x32x16_bf16 v[168:183], v[36:39], v[188:191], v[168:183]
  v_add_u32_sdwa v228, v249, v228 dst_sel:DWORD dst_unused:UNUSED_PAD src0_sel:DWORD src1_sel:BYTE_3
  ds_read_b64_tr_b16 v[208:209], v228
  v_add_u32_sdwa v229, v249, v229 dst_sel:DWORD dst_unused:UNUSED_PAD src0_sel:DWORD src1_sel:BYTE_3
  ds_read_b64_tr_b16 v[210:211], v229
  v_add_u32_sdwa v230, v249, v230 dst_sel:DWORD dst_unused:UNUSED_PAD src0_sel:DWORD src1_sel:BYTE_3
  ds_read_b64_tr_b16 v[212:213], v230
  v_add_u32_sdwa v231, v249, v231 dst_sel:DWORD dst_unused:UNUSED_PAD src0_sel:DWORD src1_sel:BYTE_3
  ds_read_b64_tr_b16 v[214:215], v231
  v_pk_mul_f32 v[2:3], v[152:153], s[70:71]
  v_pk_mul_f32 v[4:5], v[154:155], s[70:71]
  v_pk_mul_f32 v[6:7], v[156:157], s[70:71]
  v_pk_mul_f32 v[8:9], v[158:159], s[70:71]
  v_mfma_f32_32x32x16_bf16 v[168:183], v[40:43], v[192:195], v[168:183]
  v_exp_f32 v2, v2
  v_exp_f32 v3, v3
  v_exp_f32 v4, v4
  v_exp_f32 v5, v5
  v_mfma_f32_32x32x16_bf16 v[168:183], v[44:47], v[196:199], v[168:183]
  v_exp_f32 v6, v6
  v_exp_f32 v7, v7
  v_exp_f32 v8, v8
  v_exp_f32 v9, v9
  v_pk_add_f32 v[2:3], v[2:3], s[72:73]
  v_pk_add_f32 v[4:5], v[4:5], s[72:73]
  v_pk_add_f32 v[6:7], v[6:7], s[72:73]
  v_pk_add_f32 v[8:9], v[8:9], s[72:73]
  v_mfma_f32_32x32x16_bf16 v[168:183], v[64:67], v[200:203], v[168:183]
  v_rcp_f32 v2, v2
  v_rcp_f32 v3, v3
  v_rcp_f32 v4, v4
  v_rcp_f32 v5, v5
  v_mfma_f32_32x32x16_bf16 v[168:183], v[68:71], v[204:207], v[168:183]
  v_rcp_f32 v6, v6
  v_rcp_f32 v7, v7
  v_rcp_f32 v8, v8
  v_rcp_f32 v9, v9
  v_pk_mul_f32 v[2:3], v[2:3], v[152:153]
  v_pk_mul_f32 v[4:5], v[4:5], v[154:155]
  v_pk_mul_f32 v[6:7], v[6:7], v[156:157]
  v_pk_mul_f32 v[8:9], v[8:9], v[158:159]
  v_cvt_pk_bf16_f32 v152, v2, v3
  v_cvt_pk_bf16_f32 v153, v4, v5
  v_cvt_pk_bf16_f32 v154, v6, v7
  v_cvt_pk_bf16_f32 v155, v8, v9
  ds_write_b128 v247, v[152:155]
  v_pk_mul_f32 v[2:3], v[160:161], s[70:71]
  v_pk_mul_f32 v[4:5], v[162:163], s[70:71]
  v_pk_mul_f32 v[6:7], v[164:165], s[70:71]
  v_pk_mul_f32 v[8:9], v[166:167], s[70:71]
  v_mfma_f32_32x32x16_bf16 v[184:199], v[72:75], v[152:155], 0
  v_exp_f32 v2, v2
  v_exp_f32 v3, v3
  v_exp_f32 v4, v4
  v_exp_f32 v5, v5
  v_exp_f32 v6, v6
  v_exp_f32 v7, v7
  v_exp_f32 v8, v8
  v_exp_f32 v9, v9
  v_pk_add_f32 v[2:3], v[2:3], s[72:73]
  v_pk_add_f32 v[4:5], v[4:5], s[72:73]
  v_pk_add_f32 v[6:7], v[6:7], s[72:73]
  v_pk_add_f32 v[8:9], v[8:9], s[72:73]
  v_rcp_f32 v2, v2
  v_rcp_f32 v3, v3
  v_rcp_f32 v4, v4
  v_rcp_f32 v5, v5
  v_rcp_f32 v6, v6
  v_rcp_f32 v7, v7
  v_rcp_f32 v8, v8
  v_rcp_f32 v9, v9
  v_pk_mul_f32 v[2:3], v[2:3], v[160:161]
  v_pk_mul_f32 v[4:5], v[4:5], v[162:163]
  v_pk_mul_f32 v[6:7], v[6:7], v[164:165]
  v_pk_mul_f32 v[8:9], v[8:9], v[166:167]
  v_cvt_pk_bf16_f32 v156, v2, v3
  v_cvt_pk_bf16_f32 v157, v4, v5
  v_cvt_pk_bf16_f32 v158, v6, v7
  v_cvt_pk_bf16_f32 v159, v8, v9
  ds_write_b128 v247, v[156:159] offset:16
  v_pk_mul_f32 v[2:3], v[168:169], s[70:71]
  v_pk_mul_f32 v[4:5], v[170:171], s[70:71]
  v_pk_mul_f32 v[6:7], v[172:173], s[70:71]
  v_pk_mul_f32 v[8:9], v[174:175], s[70:71]
  v_mfma_f32_32x32x16_bf16 v[184:199], v[76:79], v[156:159], v[184:199]
  v_exp_f32 v2, v2
  v_exp_f32 v3, v3
  v_exp_f32 v4, v4
  v_exp_f32 v5, v5
  v_exp_f32 v6, v6
  v_exp_f32 v7, v7
  v_exp_f32 v8, v8
  v_exp_f32 v9, v9
  v_pk_add_f32 v[2:3], v[2:3], s[72:73]
  v_pk_add_f32 v[4:5], v[4:5], s[72:73]
  v_pk_add_f32 v[6:7], v[6:7], s[72:73]
  v_pk_add_f32 v[8:9], v[8:9], s[72:73]
  v_rcp_f32 v2, v2
  v_rcp_f32 v3, v3
  v_rcp_f32 v4, v4
  v_rcp_f32 v5, v5
  v_rcp_f32 v6, v6
  v_rcp_f32 v7, v7
  v_rcp_f32 v8, v8
  v_rcp_f32 v9, v9
  v_pk_mul_f32 v[2:3], v[2:3], v[168:169]
  v_pk_mul_f32 v[4:5], v[4:5], v[170:171]
  v_pk_mul_f32 v[6:7], v[6:7], v[172:173]
  v_pk_mul_f32 v[8:9], v[8:9], v[174:175]
  v_cvt_pk_bf16_f32 v160, v2, v3
  v_cvt_pk_bf16_f32 v161, v4, v5
  v_cvt_pk_bf16_f32 v162, v6, v7
  v_cvt_pk_bf16_f32 v163, v8, v9
  ds_write_b128 v247, v[160:163] offset:32
  v_pk_mul_f32 v[2:3], v[176:177], s[70:71]
  v_pk_mul_f32 v[4:5], v[178:179], s[70:71]
  v_pk_mul_f32 v[6:7], v[180:181], s[70:71]
  v_pk_mul_f32 v[8:9], v[182:183], s[70:71]
  v_mfma_f32_32x32x16_bf16 v[184:199], v[80:83], v[160:163], v[184:199]
  v_exp_f32 v2, v2
  v_exp_f32 v3, v3
  v_exp_f32 v4, v4
  v_exp_f32 v5, v5
  v_exp_f32 v6, v6
  v_exp_f32 v7, v7
  v_exp_f32 v8, v8
  v_exp_f32 v9, v9
  v_pk_add_f32 v[2:3], v[2:3], s[72:73]
  v_pk_add_f32 v[4:5], v[4:5], s[72:73]
  v_pk_add_f32 v[6:7], v[6:7], s[72:73]
  v_pk_add_f32 v[8:9], v[8:9], s[72:73]
  v_rcp_f32 v2, v2
  v_rcp_f32 v3, v3
  v_rcp_f32 v4, v4
  v_rcp_f32 v5, v5
  v_rcp_f32 v6, v6
  v_rcp_f32 v7, v7
  v_rcp_f32 v8, v8
  v_rcp_f32 v9, v9
  v_pk_mul_f32 v[2:3], v[2:3], v[176:177]
  v_pk_mul_f32 v[4:5], v[4:5], v[178:179]
  v_pk_mul_f32 v[6:7], v[6:7], v[180:181]
  v_pk_mul_f32 v[8:9], v[8:9], v[182:183]
  v_cvt_pk_bf16_f32 v164, v2, v3
  v_cvt_pk_bf16_f32 v165, v4, v5
  v_cvt_pk_bf16_f32 v166, v6, v7
  v_cvt_pk_bf16_f32 v167, v8, v9
  ds_write_b128 v247, v[164:167] offset:48
  s_nop 0
  v_mfma_f32_32x32x16_bf16 v[184:199], v[84:87], v[164:167], v[184:199]
  ds_read_b64_tr_b16 v[168:169], v250 offset:0
  ds_read_b64_tr_b16 v[170:171], v250 offset:144
  ds_read_b64_tr_b16 v[172:173], v250 offset:288
  ds_read_b64_tr_b16 v[174:175], v250 offset:432
  ds_read_b64_tr_b16 v[176:177], v250 offset:64
  ds_read_b64_tr_b16 v[178:179], v250 offset:208
  ds_read_b64_tr_b16 v[180:181], v250 offset:352
  ds_read_b64_tr_b16 v[182:183], v250 offset:496
  s_nop 3
  v_mul_f32 v2, v10, v184
  v_mul_f32 v3, v11, v184
  v_mul_f32 v4, v12, v184
  v_cvt_pk_bf16_f32 v2, v2, v3
  v_cvt_pk_bf16_f32 v3, v4, v4
  ds_write_b64 v248, v[2:3]
  ds_read_b64_tr_b16 v[200:201], v251 offset:0
  ds_read_b64_tr_b16 v[202:203], v251 offset:144
  ds_read_b64_tr_b16 v[204:205], v251 offset:288
  ds_read_b64_tr_b16 v[206:207], v251 offset:432
  s_waitcnt lgkmcnt(11)
  v_mfma_f32_32x32x16_bf16 v[88:103], v[168:171], v[208:211], v[88:103]
  s_waitcnt lgkmcnt(9)
  v_mfma_f32_32x32x16_bf16 v[88:103], v[172:175], v[212:215], v[88:103]
  s_waitcnt lgkmcnt(7)
  v_mfma_f32_32x32x16_bf16 v[104:119], v[176:179], v[208:211], v[104:119]
  s_waitcnt lgkmcnt(5)
  v_mfma_f32_32x32x16_bf16 v[104:119], v[180:183], v[212:215], v[104:119]
  s_waitcnt lgkmcnt(2)
  v_mfma_f32_32x32x16_bf16 v[120:135], v[200:203], v[208:211], v[120:135]
  s_waitcnt lgkmcnt(0)
  v_mfma_f32_32x32x16_bf16 v[120:135], v[204:207], v[212:215], v[120:135]
  s_sub_u32 s59, s59, 1
  s_cmp_eq_u32 s59, 0
  s_cbranch_scc1 LOOPEND
  s_waitcnt vmcnt(6)
  v_add_u32_sdwa v14, v246, v237 dst_sel:DWORD dst_unused:UNUSED_PAD src0_sel:DWORD src1_sel:BYTE_3
  ds_read_b64 v[2:3], v14 offset:480
  ds_read_b32 v4, v14 offset:736
  ds_read_b128 v[184:187], v242 offset:4096
  ds_read_b128 v[188:191], v243 offset:4096
  ds_read_b128 v[192:195], v244 offset:4096
  ds_read_b128 v[196:199], v245 offset:4096
  ds_read_b64 v[200:201], v14 offset:192
  ds_read_b64 v[202:203], v14 offset:128
  ds_read_b64 v[204:205], v14 offset:64
  ds_read_b32 v206, v14
  v_lshlrev_b32 v5, 4, v237
  v_mfma_f32_32x32x16_bf16 v[152:167], v[48:51], v[220:223], 0
  ds_read_b128 v[224:227], v252 offset:384
  ds_read_b32 v237, v253 offset:384
  ds_read_b32 v13, v253 offset:16768
  ds_read_b128 v[228:231], v254 offset:128
  v_alignbit_b32 v6, v235, v234, v5
  v_lshrrev_b32 v7, v5, v235
  v_mfma_f32_32x32x16_bf16 v[168:183], v[52:55], v[220:223], 0
  v_lshlrev_b32 v5, 16, v6
  v_and_b32 v6, s65, v6
  v_lshlrev_b32 v7, 16, v7
  s_waitcnt lgkmcnt(12)
  v_sub_f32 v2, v2, v5
  v_sub_f32 v3, v3, v6
  v_sub_f32 v4, v4, v7
  s_waitcnt lgkmcnt(11)
  v_mfma_f32_32x32x16_bf16 v[152:167], v[16:19], v[184:187], v[152:167]
  v_cvt_pk_bf16_f32 v2, v2, v3
  v_cvt_pk_bf16_f32 v4, v4, v4
  v_lshlrev_b32 v10, 16, v2
  s_waitcnt lgkmcnt(10)
  v_mfma_f32_32x32x16_bf16 v[152:167], v[20:23], v[188:191], v[152:167]
  v_and_b32 v11, s65, v2
  v_lshlrev_b32 v12, 16, v4
  v_mul_f32 v2, v10, v10
  s_waitcnt lgkmcnt(9)
  v_mfma_f32_32x32x16_bf16 v[152:167], v[24:27], v[192:195], v[152:167]
  v_fmac_f32 v2, v11, v11
  v_fmac_f32 v2, v12, v12
  v_cvt_pk_bf16_f32 v207, v2, v2
  s_waitcnt lgkmcnt(8)
  v_mfma_f32_32x32x16_bf16 v[152:167], v[28:31], v[196:199], v[152:167]
  s_waitcnt lgkmcnt(4)
  v_mfma_f32_32x32x16_bf16 v[152:167], v[56:59], v[200:203], v[152:167]
  v_mfma_f32_32x32x16_bf16 v[152:167], v[60:63], v[204:207], v[152:167]
  s_waitcnt lgkmcnt(0)
  v_mfma_f32_32x32x16_bf16 v[168:183], v[32:35], v[184:187], v[168:183]
  s_cmp_gt_u32 s59, 2
  s_cselect_b32 s6, 6400000, 0
  s_cselect_b32 s10, 25600000, 0
  s_cselect_b32 s14, 300000, 0
  v_mad_u32_u24 v13, v13, 32, v15
  buffer_load_dwordx4 v[220:223], v13, s[8:11], 0 offen
  s_add_u32 m0, s66, 4096
  v_mad_u32_u24 v224, v224, s64, v238
  buffer_load_dwordx4 v224, s[4:7], 0 offen  lds
  s_add_u32 m0, s66, 5120
  v_mad_u32_u24 v225, v225, s64, v239
  buffer_load_dwordx4 v225, s[4:7], 0 offen  lds
  s_add_u32 m0, s66, 6144
  v_mad_u32_u24 v226, v226, s64, v240
  buffer_load_dwordx4 v226, s[4:7], 0 offen  lds
  s_add_u32 m0, s66, 7168
  v_mad_u32_u24 v227, v227, s64, v241
  buffer_load_dwordx4 v227, s[4:7], 0 offen  lds
  v_mul_u32_u24 v13, 6, v237
  v_and_b32 v13, -4, v13
  s_mov_b64 exec, s[74:75]
  buffer_load_dwordx2 v[234:235], v13, s[12:15], 0 offen
  s_mov_b64 exec, -1
  v_mfma_f32_32x32x16_bf16 v[168:183], v[36:39], v[188:191], v[168:183]
  v_add_u32_sdwa v228, v249, v228 dst_sel:DWORD dst_unused:UNUSED_PAD src0_sel:DWORD src1_sel:BYTE_3
  ds_read_b64_tr_b16 v[208:209], v228
  v_add_u32_sdwa v229, v249, v229 dst_sel:DWORD dst_unused:UNUSED_PAD src0_sel:DWORD src1_sel:BYTE_3
  ds_read_b64_tr_b16 v[210:211], v229
  v_add_u32_sdwa v230, v249, v230 dst_sel:DWORD dst_unused:UNUSED_PAD src0_sel:DWORD src1_sel:BYTE_3
  ds_read_b64_tr_b16 v[212:213], v230
  v_add_u32_sdwa v231, v249, v231 dst_sel:DWORD dst_unused:UNUSED_PAD src0_sel:DWORD src1_sel:BYTE_3
  ds_read_b64_tr_b16 v[214:215], v231
  v_pk_mul_f32 v[2:3], v[152:153], s[70:71]
  v_pk_mul_f32 v[4:5], v[154:155], s[70:71]
  v_pk_mul_f32 v[6:7], v[156:157], s[70:71]
  v_pk_mul_f32 v[8:9], v[158:159], s[70:71]
  v_mfma_f32_32x32x16_bf16 v[168:183], v[40:43], v[192:195], v[168:183]
  v_exp_f32 v2, v2
  v_exp_f32 v3, v3
  v_exp_f32 v4, v4
  v_exp_f32 v5, v5
  v_mfma_f32_32x32x16_bf16 v[168:183], v[44:47], v[196:199], v[168:183]
  v_exp_f32 v6, v6
  v_exp_f32 v7, v7
  v_exp_f32 v8, v8
  v_exp_f32 v9, v9
  v_pk_add_f32 v[2:3], v[2:3], s[72:73]
  v_pk_add_f32 v[4:5], v[4:5], s[72:73]
  v_pk_add_f32 v[6:7], v[6:7], s[72:73]
  v_pk_add_f32 v[8:9], v[8:9], s[72:73]
  v_mfma_f32_32x32x16_bf16 v[168:183], v[64:67], v[200:203], v[168:183]
  v_rcp_f32 v2, v2
  v_rcp_f32 v3, v3
  v_rcp_f32 v4, v4
  v_rcp_f32 v5, v5
  v_mfma_f32_32x32x16_bf16 v[168:183], v[68:71], v[204:207], v[168:183]
  v_rcp_f32 v6, v6
  v_rcp_f32 v7, v7
  v_rcp_f32 v8, v8
  v_rcp_f32 v9, v9
  v_pk_mul_f32 v[2:3], v[2:3], v[152:153]
  v_pk_mul_f32 v[4:5], v[4:5], v[154:155]
  v_pk_mul_f32 v[6:7], v[6:7], v[156:157]
  v_pk_mul_f32 v[8:9], v[8:9], v[158:159]
  v_cvt_pk_bf16_f32 v152, v2, v3
  v_cvt_pk_bf16_f32 v153, v4, v5
  v_cvt_pk_bf16_f32 v154, v6, v7
  v_cvt_pk_bf16_f32 v155, v8, v9
  ds_write_b128 v247, v[152:155]
  v_pk_mul_f32 v[2:3], v[160:161], s[70:71]
  v_pk_mul_f32 v[4:5], v[162:163], s[70:71]
  v_pk_mul_f32 v[6:7], v[164:165], s[70:71]
  v_pk_mul_f32 v[8:9], v[166:167], s[70:71]
  v_mfma_f32_32x32x16_bf16 v[184:199], v[72:75], v[152:155], 0
  v_exp_f32 v2, v2
  v_exp_f32 v3, v3
  v_exp_f32 v4, v4
  v_exp_f32 v5, v5
  v_exp_f32 v6, v6
  v_exp_f32 v7, v7
  v_exp_f32 v8, v8
  v_exp_f32 v9, v9
  v_pk_add_f32 v[2:3], v[2:3], s[72:73]
  v_pk_add_f32 v[4:5], v[4:5], s[72:73]
  v_pk_add_f32 v[6:7], v[6:7], s[72:73]
  v_pk_add_f32 v[8:9], v[8:9], s[72:73]
  v_rcp_f32 v2, v2
  v_rcp_f32 v3, v3
  v_rcp_f32 v4, v4
  v_rcp_f32 v5, v5
  v_rcp_f32 v6, v6
  v_rcp_f32 v7, v7
  v_rcp_f32 v8, v8
  v_rcp_f32 v9, v9
  v_pk_mul_f32 v[2:3], v[2:3], v[160:161]
  v_pk_mul_f32 v[4:5], v[4:5], v[162:163]
  v_pk_mul_f32 v[6:7], v[6:7], v[164:165]
  v_pk_mul_f32 v[8:9], v[8:9], v[166:167]
  v_cvt_pk_bf16_f32 v156, v2, v3
  v_cvt_pk_bf16_f32 v157, v4, v5
  v_cvt_pk_bf16_f32 v158, v6, v7
  v_cvt_pk_bf16_f32 v159, v8, v9
  ds_write_b128 v247, v[156:159] offset:16
  v_pk_mul_f32 v[2:3], v[168:169], s[70:71]
  v_pk_mul_f32 v[4:5], v[170:171], s[70:71]
  v_pk_mul_f32 v[6:7], v[172:173], s[70:71]
  v_pk_mul_f32 v[8:9], v[174:175], s[70:71]
  v_mfma_f32_32x32x16_bf16 v[184:199], v[76:79], v[156:159], v[184:199]
  v_exp_f32 v2, v2
  v_exp_f32 v3, v3
  v_exp_f32 v4, v4
  v_exp_f32 v5, v5
  v_exp_f32 v6, v6
  v_exp_f32 v7, v7
  v_exp_f32 v8, v8
  v_exp_f32 v9, v9
  v_pk_add_f32 v[2:3], v[2:3], s[72:73]
  v_pk_add_f32 v[4:5], v[4:5], s[72:73]
  v_pk_add_f32 v[6:7], v[6:7], s[72:73]
  v_pk_add_f32 v[8:9], v[8:9], s[72:73]
  v_rcp_f32 v2, v2
  v_rcp_f32 v3, v3
  v_rcp_f32 v4, v4
  v_rcp_f32 v5, v5
  v_rcp_f32 v6, v6
  v_rcp_f32 v7, v7
  v_rcp_f32 v8, v8
  v_rcp_f32 v9, v9
  v_pk_mul_f32 v[2:3], v[2:3], v[168:169]
  v_pk_mul_f32 v[4:5], v[4:5], v[170:171]
  v_pk_mul_f32 v[6:7], v[6:7], v[172:173]
  v_pk_mul_f32 v[8:9], v[8:9], v[174:175]
  v_cvt_pk_bf16_f32 v160, v2, v3
  v_cvt_pk_bf16_f32 v161, v4, v5
  v_cvt_pk_bf16_f32 v162, v6, v7
  v_cvt_pk_bf16_f32 v163, v8, v9
  ds_write_b128 v247, v[160:163] offset:32
  v_pk_mul_f32 v[2:3], v[176:177], s[70:71]
  v_pk_mul_f32 v[4:5], v[178:179], s[70:71]
  v_pk_mul_f32 v[6:7], v[180:181], s[70:71]
  v_pk_mul_f32 v[8:9], v[182:183], s[70:71]
  v_mfma_f32_32x32x16_bf16 v[184:199], v[80:83], v[160:163], v[184:199]
  v_exp_f32 v2, v2
  v_exp_f32 v3, v3
  v_exp_f32 v4, v4
  v_exp_f32 v5, v5
  v_exp_f32 v6, v6
  v_exp_f32 v7, v7
  v_exp_f32 v8, v8
  v_exp_f32 v9, v9
  v_pk_add_f32 v[2:3], v[2:3], s[72:73]
  v_pk_add_f32 v[4:5], v[4:5], s[72:73]
  v_pk_add_f32 v[6:7], v[6:7], s[72:73]
  v_pk_add_f32 v[8:9], v[8:9], s[72:73]
  v_rcp_f32 v2, v2
  v_rcp_f32 v3, v3
  v_rcp_f32 v4, v4
  v_rcp_f32 v5, v5
  v_rcp_f32 v6, v6
  v_rcp_f32 v7, v7
  v_rcp_f32 v8, v8
  v_rcp_f32 v9, v9
  v_pk_mul_f32 v[2:3], v[2:3], v[176:177]
  v_pk_mul_f32 v[4:5], v[4:5], v[178:179]
  v_pk_mul_f32 v[6:7], v[6:7], v[180:181]
  v_pk_mul_f32 v[8:9], v[8:9], v[182:183]
  v_cvt_pk_bf16_f32 v164, v2, v3
  v_cvt_pk_bf16_f32 v165, v4, v5
  v_cvt_pk_bf16_f32 v166, v6, v7
  v_cvt_pk_bf16_f32 v167, v8, v9
  ds_write_b128 v247, v[164:167] offset:48
  s_nop 0
  v_mfma_f32_32x32x16_bf16 v[184:199], v[84:87], v[164:167], v[184:199]
  ds_read_b64_tr_b16 v[168:169], v250 offset:0
  ds_read_b64_tr_b16 v[170:171], v250 offset:144
  ds_read_b64_tr_b16 v[172:173], v250 offset:288
  ds_read_b64_tr_b16 v[174:175], v250 offset:432
  ds_read_b64_tr_b16 v[176:177], v250 offset:64
  ds_read_b64_tr_b16 v[178:179], v250 offset:208
  ds_read_b64_tr_b16 v[180:181], v250 offset:352
  ds_read_b64_tr_b16 v[182:183], v250 offset:496
  s_nop 3
  v_mul_f32 v2, v10, v184
  v_mul_f32 v3, v11, v184
  v_mul_f32 v4, v12, v184
  v_cvt_pk_bf16_f32 v2, v2, v3
  v_cvt_pk_bf16_f32 v3, v4, v4
  ds_write_b64 v248, v[2:3]
  ds_read_b64_tr_b16 v[200:201], v251 offset:0
  ds_read_b64_tr_b16 v[202:203], v251 offset:144
  ds_read_b64_tr_b16 v[204:205], v251 offset:288
  ds_read_b64_tr_b16 v[206:207], v251 offset:432
  s_waitcnt lgkmcnt(11)
  v_mfma_f32_32x32x16_bf16 v[88:103], v[168:171], v[208:211], v[88:103]
  s_waitcnt lgkmcnt(9)
  v_mfma_f32_32x32x16_bf16 v[88:103], v[172:175], v[212:215], v[88:103]
  s_waitcnt lgkmcnt(7)
  v_mfma_f32_32x32x16_bf16 v[104:119], v[176:179], v[208:211], v[104:119]
  s_waitcnt lgkmcnt(5)
  v_mfma_f32_32x32x16_bf16 v[104:119], v[180:183], v[212:215], v[104:119]
  s_waitcnt lgkmcnt(2)
  v_mfma_f32_32x32x16_bf16 v[120:135], v[200:203], v[208:211], v[120:135]
  s_waitcnt lgkmcnt(0)
  v_mfma_f32_32x32x16_bf16 v[120:135], v[204:207], v[212:215], v[120:135]
  s_sub_u32 s59, s59, 1
  s_cmp_eq_u32 s59, 0
  v_add_u32 v252, 0x100, v252
  v_add_u32 v253, 0x100, v253
  v_add_u32 v254, 0x100, v254
  s_cbranch_scc0 LOOP
LOOPEND:
  s_cmp_eq_u32 s62, 0
  s_cbranch_scc1 EPI
  s_add_u32 s61, s61, s60
  s_waitcnt vmcnt(0)
  s_barrier
  s_branch ROUND
EPI:
  v_and_b32 v2, 1, v1
  v_bfe_u32 v3, v1, 1, 1
  v_bfe_u32 v4, v1, 2, 2
  v_bfe_u32 v5, v1, 4, 1
  v_lshlrev_b32 v2, 6, v2
  v_lshl_add_u32 v2, v3, 3, v2
  v_lshl_add_u32 v2, v5, 4, v2
  v_lshrrev_b32 v3, 1, v4
  v_lshl_add_u32 v2, v3, 5, v2
  v_lshl_add_u32 v2, v4, 7, v2
  v_add_u32 v2, 145408, v2
  v_lshl_add_u32 v6, v15, 8, v2
  v_xor_b32 v7, 32, v6
  v_lshl_add_u32 v8, v15, 6, v2
  v_xor_b32 v9, 32, v8
  ds_read_b64_tr_b16 v[16:17], v6 offset:0
  ds_read_b64_tr_b16 v[18:19], v6 offset:512
  ds_read_b64_tr_b16 v[20:21], v6 offset:1024
  ds_read_b64_tr_b16 v[22:23], v6 offset:1536
  ds_read_b64_tr_b16 v[24:25], v6 offset:2048
  ds_read_b64_tr_b16 v[26:27], v6 offset:2560
  ds_read_b64_tr_b16 v[28:29], v6 offset:3072
  ds_read_b64_tr_b16 v[30:31], v6 offset:3584
  ds_read_b64_tr_b16 v[32:33], v8 offset:8192
  ds_read_b64_tr_b16 v[34:35], v8 offset:10240
  ds_read_b64_tr_b16 v[36:37], v8 offset:12288
  ds_read_b64_tr_b16 v[38:39], v8 offset:14336
  ds_read_b64_tr_b16 v[40:41], v8 offset:8704
  ds_read_b64_tr_b16 v[42:43], v8 offset:10752
  ds_read_b64_tr_b16 v[44:45], v8 offset:12800
  ds_read_b64_tr_b16 v[46:47], v8 offset:14848
  s_waitcnt lgkmcnt(0)
  ds_read_b64_tr_b16 v[48:49], v7 offset:0
  ds_read_b64_tr_b16 v[50:51], v7 offset:512
  ds_read_b64_tr_b16 v[52:53], v7 offset:1024
  ds_read_b64_tr_b16 v[54:55], v7 offset:1536
  ds_read_b64_tr_b16 v[56:57], v7 offset:2048
  ds_read_b64_tr_b16 v[58:59], v7 offset:2560
  ds_read_b64_tr_b16 v[60:61], v7 offset:3072
  ds_read_b64_tr_b16 v[62:63], v7 offset:3584
  ds_read_b64_tr_b16 v[64:65], v9 offset:8192
  ds_read_b64_tr_b16 v[66:67], v9 offset:10240
  ds_read_b64_tr_b16 v[68:69], v9 offset:12288
  ds_read_b64_tr_b16 v[70:71], v9 offset:14336
  ds_read_b64_tr_b16 v[72:73], v9 offset:8704
  ds_read_b64_tr_b16 v[74:75], v9 offset:10752
  ds_read_b64_tr_b16 v[76:77], v9 offset:12800
  ds_read_b64_tr_b16 v[78:79], v9 offset:14848
  v_lshl_add_u32 v14, v1, 3, s67
  ds_read_b64 v[224:225], v14 offset:512
  ds_read_b32 v226, v14 offset:768
  v_cvt_pk_bf16_f32 v184, v88, v89
  v_cvt_pk_bf16_f32 v185, v90, v91
  v_cvt_pk_bf16_f32 v186, v92, v93
  v_cvt_pk_bf16_f32 v187, v94, v95
  v_cvt_pk_bf16_f32 v188, v96, v97
  v_cvt_pk_bf16_f32 v189, v98, v99
  v_cvt_pk_bf16_f32 v190, v100, v101
  v_cvt_pk_bf16_f32 v191, v102, v103
  v_cvt_pk_bf16_f32 v192, v104, v105
  v_cvt_pk_bf16_f32 v193, v106, v107
  v_cvt_pk_bf16_f32 v194, v108, v109
  v_cvt_pk_bf16_f32 v195, v110, v111
  v_cvt_pk_bf16_f32 v196, v112, v113
  v_cvt_pk_bf16_f32 v197, v114, v115
  v_cvt_pk_bf16_f32 v198, v116, v117
  v_cvt_pk_bf16_f32 v199, v118, v119
  v_mfma_f32_32x32x16_bf16 v[152:167], v[16:19], v[136:139], 0
  v_mfma_f32_32x32x16_bf16 v[152:167], v[20:23], v[140:143], v[152:167]
  v_mfma_f32_32x32x16_bf16 v[152:167], v[24:27], v[144:147], v[152:167]
  v_mfma_f32_32x32x16_bf16 v[152:167], v[28:31], v[148:151], v[152:167]
  v_mfma_f32_32x32x16_bf16 v[152:167], v[32:35], v[184:187], v[152:167]
  v_mfma_f32_32x32x16_bf16 v[152:167], v[36:39], v[188:191], v[152:167]
  v_mfma_f32_32x32x16_bf16 v[152:167], v[40:43], v[192:195], v[152:167]
  v_mfma_f32_32x32x16_bf16 v[152:167], v[44:47], v[196:199], v[152:167]
  s_waitcnt lgkmcnt(0)
  v_mfma_f32_32x32x16_bf16 v[168:183], v[48:51], v[136:139], 0
  v_mfma_f32_32x32x16_bf16 v[168:183], v[52:55], v[140:143], v[168:183]
  v_mfma_f32_32x32x16_bf16 v[168:183], v[56:59], v[144:147], v[168:183]
  v_mfma_f32_32x32x16_bf16 v[168:183], v[60:63], v[148:151], v[168:183]
  v_mfma_f32_32x32x16_bf16 v[168:183], v[64:67], v[184:187], v[168:183]
  v_mfma_f32_32x32x16_bf16 v[168:183], v[68:71], v[188:191], v[168:183]
  v_mfma_f32_32x32x16_bf16 v[168:183], v[72:75], v[192:195], v[168:183]
  v_mfma_f32_32x32x16_bf16 v[168:183], v[76:79], v[196:199], v[168:183]
  v_add_f32 v224, v224, v120
  v_add_f32 v225, v225, v121
  v_add_f32 v226, v226, v122
  v_cvt_pk_bf16_f32 v224, v224, v225
  v_cvt_pk_bf16_f32 v226, v226, v226
  v_add_u32 v228, s58, v1
  v_mul_u32_u24 v228, 6, v228
  v_add_u32 v228, 6400000, v228
  s_mov_b64 exec, 0x1ffffff
  buffer_store_short v224, v228, s[28:31], 0 offen
  buffer_store_short_d16_hi v224, v228, s[28:31], 0 offen offset:2
  buffer_store_short v226, v228, s[28:31], 0 offen offset:4
  s_mov_b64 exec, -1
  v_and_b32 v229, 31, v1
  v_add_u32 v229, s58, v229
  v_lshlrev_b32 v229, 7, v229
  v_lshl_add_u32 v229, v15, 2, v229
  s_mov_b32 s68, 0x1ffffff
  s_mov_b32 s69, 0x1ffffff
  v_pk_mul_f32 v[2:3], v[152:153], s[70:71]
  v_pk_mul_f32 v[4:5], v[154:155], s[70:71]
  v_pk_mul_f32 v[6:7], v[156:157], s[70:71]
  v_pk_mul_f32 v[8:9], v[158:159], s[70:71]
  v_exp_f32 v2, v2
  v_exp_f32 v3, v3
  v_exp_f32 v4, v4
  v_exp_f32 v5, v5
  v_exp_f32 v6, v6
  v_exp_f32 v7, v7
  v_exp_f32 v8, v8
  v_exp_f32 v9, v9
  v_pk_add_f32 v[2:3], v[2:3], s[72:73]
  v_pk_add_f32 v[4:5], v[4:5], s[72:73]
  v_pk_add_f32 v[6:7], v[6:7], s[72:73]
  v_pk_add_f32 v[8:9], v[8:9], s[72:73]
  v_rcp_f32 v2, v2
  v_rcp_f32 v3, v3
  v_rcp_f32 v4, v4
  v_rcp_f32 v5, v5
  v_rcp_f32 v6, v6
  v_rcp_f32 v7, v7
  v_rcp_f32 v8, v8
  v_rcp_f32 v9, v9
  v_pk_mul_f32 v[2:3], v[2:3], v[152:153]
  v_pk_mul_f32 v[4:5], v[4:5], v[154:155]
  v_pk_mul_f32 v[6:7], v[6:7], v[156:157]
  v_pk_mul_f32 v[8:9], v[8:9], v[158:159]
  v_cvt_pk_bf16_f32 v200, v2, v3
  v_cvt_pk_bf16_f32 v201, v4, v5
  v_cvt_pk_bf16_f32 v202, v6, v7
  v_cvt_pk_bf16_f32 v203, v8, v9
  v_lshlrev_b32 v2, 16, v200
  v_and_b32 v3, s65, v200
  v_lshlrev_b32 v4, 16, v136
  v_and_b32 v5, s65, v136
  v_pk_add_f32 v[2:3], v[2:3], v[4:5]
  v_cvt_pk_bf16_f32 v184, v2, v3
  v_lshlrev_b32 v2, 16, v201
  v_and_b32 v3, s65, v201
  v_lshlrev_b32 v4, 16, v137
  v_and_b32 v5, s65, v137
  v_pk_add_f32 v[2:3], v[2:3], v[4:5]
  v_cvt_pk_bf16_f32 v185, v2, v3
  v_lshlrev_b32 v2, 16, v202
  v_and_b32 v3, s65, v202
  v_lshlrev_b32 v4, 16, v138
  v_and_b32 v5, s65, v138
  v_pk_add_f32 v[2:3], v[2:3], v[4:5]
  v_cvt_pk_bf16_f32 v186, v2, v3
  v_lshlrev_b32 v2, 16, v203
  v_and_b32 v3, s65, v203
  v_lshlrev_b32 v4, 16, v139
  v_and_b32 v5, s65, v139
  v_pk_add_f32 v[2:3], v[2:3], v[4:5]
  v_cvt_pk_bf16_f32 v187, v2, v3
  s_mov_b64 exec, s[68:69]
  buffer_store_dwordx4 v[184:187], v229, s[28:31], 0 offen offset:0
  s_mov_b64 exec, -1
  v_pk_mul_f32 v[2:3], v[160:161], s[70:71]
  v_pk_mul_f32 v[4:5], v[162:163], s[70:71]
  v_pk_mul_f32 v[6:7], v[164:165], s[70:71]
  v_pk_mul_f32 v[8:9], v[166:167], s[70:71]
  v_exp_f32 v2, v2
  v_exp_f32 v3, v3
  v_exp_f32 v4, v4
  v_exp_f32 v5, v5
  v_exp_f32 v6, v6
  v_exp_f32 v7, v7
  v_exp_f32 v8, v8
  v_exp_f32 v9, v9
  v_pk_add_f32 v[2:3], v[2:3], s[72:73]
  v_pk_add_f32 v[4:5], v[4:5], s[72:73]
  v_pk_add_f32 v[6:7], v[6:7], s[72:73]
  v_pk_add_f32 v[8:9], v[8:9], s[72:73]
  v_rcp_f32 v2, v2
  v_rcp_f32 v3, v3
  v_rcp_f32 v4, v4
  v_rcp_f32 v5, v5
  v_rcp_f32 v6, v6
  v_rcp_f32 v7, v7
  v_rcp_f32 v8, v8
  v_rcp_f32 v9, v9
  v_pk_mul_f32 v[2:3], v[2:3], v[160:161]
  v_pk_mul_f32 v[4:5], v[4:5], v[162:163]
  v_pk_mul_f32 v[6:7], v[6:7], v[164:165]
  v_pk_mul_f32 v[8:9], v[8:9], v[166:167]
  v_cvt_pk_bf16_f32 v200, v2, v3
  v_cvt_pk_bf16_f32 v201, v4, v5
  v_cvt_pk_bf16_f32 v202, v6, v7
  v_cvt_pk_bf16_f32 v203, v8, v9
  v_lshlrev_b32 v2, 16, v200
  v_and_b32 v3, s65, v200
  v_lshlrev_b32 v4, 16, v140
  v_and_b32 v5, s65, v140
  v_pk_add_f32 v[2:3], v[2:3], v[4:5]
  v_cvt_pk_bf16_f32 v188, v2, v3
  v_lshlrev_b32 v2, 16, v201
  v_and_b32 v3, s65, v201
  v_lshlrev_b32 v4, 16, v141
  v_and_b32 v5, s65, v141
  v_pk_add_f32 v[2:3], v[2:3], v[4:5]
  v_cvt_pk_bf16_f32 v189, v2, v3
  v_lshlrev_b32 v2, 16, v202
  v_and_b32 v3, s65, v202
  v_lshlrev_b32 v4, 16, v142
  v_and_b32 v5, s65, v142
  v_pk_add_f32 v[2:3], v[2:3], v[4:5]
  v_cvt_pk_bf16_f32 v190, v2, v3
  v_lshlrev_b32 v2, 16, v203
  v_and_b32 v3, s65, v203
  v_lshlrev_b32 v4, 16, v143
  v_and_b32 v5, s65, v143
  v_pk_add_f32 v[2:3], v[2:3], v[4:5]
  v_cvt_pk_bf16_f32 v191, v2, v3
  s_mov_b64 exec, s[68:69]
  buffer_store_dwordx4 v[188:191], v229, s[28:31], 0 offen offset:16
  s_mov_b64 exec, -1
  v_pk_mul_f32 v[2:3], v[168:169], s[70:71]
  v_pk_mul_f32 v[4:5], v[170:171], s[70:71]
  v_pk_mul_f32 v[6:7], v[172:173], s[70:71]
  v_pk_mul_f32 v[8:9], v[174:175], s[70:71]
  v_exp_f32 v2, v2
  v_exp_f32 v3, v3
  v_exp_f32 v4, v4
  v_exp_f32 v5, v5
  v_exp_f32 v6, v6
  v_exp_f32 v7, v7
  v_exp_f32 v8, v8
  v_exp_f32 v9, v9
  v_pk_add_f32 v[2:3], v[2:3], s[72:73]
  v_pk_add_f32 v[4:5], v[4:5], s[72:73]
  v_pk_add_f32 v[6:7], v[6:7], s[72:73]
  v_pk_add_f32 v[8:9], v[8:9], s[72:73]
  v_rcp_f32 v2, v2
  v_rcp_f32 v3, v3
  v_rcp_f32 v4, v4
  v_rcp_f32 v5, v5
  v_rcp_f32 v6, v6
  v_rcp_f32 v7, v7
  v_rcp_f32 v8, v8
  v_rcp_f32 v9, v9
  v_pk_mul_f32 v[2:3], v[2:3], v[168:169]
  v_pk_mul_f32 v[4:5], v[4:5], v[170:171]
  v_pk_mul_f32 v[6:7], v[6:7], v[172:173]
  v_pk_mul_f32 v[8:9], v[8:9], v[174:175]
  v_cvt_pk_bf16_f32 v200, v2, v3
  v_cvt_pk_bf16_f32 v201, v4, v5
  v_cvt_pk_bf16_f32 v202, v6, v7
  v_cvt_pk_bf16_f32 v203, v8, v9
  v_lshlrev_b32 v2, 16, v200
  v_and_b32 v3, s65, v200
  v_lshlrev_b32 v4, 16, v144
  v_and_b32 v5, s65, v144
  v_pk_add_f32 v[2:3], v[2:3], v[4:5]
  v_cvt_pk_bf16_f32 v192, v2, v3
  v_lshlrev_b32 v2, 16, v201
  v_and_b32 v3, s65, v201
  v_lshlrev_b32 v4, 16, v145
  v_and_b32 v5, s65, v145
  v_pk_add_f32 v[2:3], v[2:3], v[4:5]
  v_cvt_pk_bf16_f32 v193, v2, v3
  v_lshlrev_b32 v2, 16, v202
  v_and_b32 v3, s65, v202
  v_lshlrev_b32 v4, 16, v146
  v_and_b32 v5, s65, v146
  v_pk_add_f32 v[2:3], v[2:3], v[4:5]
  v_cvt_pk_bf16_f32 v194, v2, v3
  v_lshlrev_b32 v2, 16, v203
  v_and_b32 v3, s65, v203
  v_lshlrev_b32 v4, 16, v147
  v_and_b32 v5, s65, v147
  v_pk_add_f32 v[2:3], v[2:3], v[4:5]
  v_cvt_pk_bf16_f32 v195, v2, v3
  s_mov_b64 exec, s[68:69]
  buffer_store_dwordx4 v[192:195], v229, s[28:31], 0 offen offset:32
  s_mov_b64 exec, -1
  v_pk_mul_f32 v[2:3], v[176:177], s[70:71]
  v_pk_mul_f32 v[4:5], v[178:179], s[70:71]
  v_pk_mul_f32 v[6:7], v[180:181], s[70:71]
  v_pk_mul_f32 v[8:9], v[182:183], s[70:71]
  v_exp_f32 v2, v2
  v_exp_f32 v3, v3
  v_exp_f32 v4, v4
  v_exp_f32 v5, v5
  v_exp_f32 v6, v6
  v_exp_f32 v7, v7
  v_exp_f32 v8, v8
  v_exp_f32 v9, v9
  v_pk_add_f32 v[2:3], v[2:3], s[72:73]
  v_pk_add_f32 v[4:5], v[4:5], s[72:73]
  v_pk_add_f32 v[6:7], v[6:7], s[72:73]
  v_pk_add_f32 v[8:9], v[8:9], s[72:73]
  v_rcp_f32 v2, v2
  v_rcp_f32 v3, v3
  v_rcp_f32 v4, v4
  v_rcp_f32 v5, v5
  v_rcp_f32 v6, v6
  v_rcp_f32 v7, v7
  v_rcp_f32 v8, v8
  v_rcp_f32 v9, v9
  v_pk_mul_f32 v[2:3], v[2:3], v[176:177]
  v_pk_mul_f32 v[4:5], v[4:5], v[178:179]
  v_pk_mul_f32 v[6:7], v[6:7], v[180:181]
  v_pk_mul_f32 v[8:9], v[8:9], v[182:183]
  v_cvt_pk_bf16_f32 v200, v2, v3
  v_cvt_pk_bf16_f32 v201, v4, v5
  v_cvt_pk_bf16_f32 v202, v6, v7
  v_cvt_pk_bf16_f32 v203, v8, v9
  v_lshlrev_b32 v2, 16, v200
  v_and_b32 v3, s65, v200
  v_lshlrev_b32 v4, 16, v148
  v_and_b32 v5, s65, v148
  v_pk_add_f32 v[2:3], v[2:3], v[4:5]
  v_cvt_pk_bf16_f32 v196, v2, v3
  v_lshlrev_b32 v2, 16, v201
  v_and_b32 v3, s65, v201
  v_lshlrev_b32 v4, 16, v149
  v_and_b32 v5, s65, v149
  v_pk_add_f32 v[2:3], v[2:3], v[4:5]
  v_cvt_pk_bf16_f32 v197, v2, v3
  v_lshlrev_b32 v2, 16, v202
  v_and_b32 v3, s65, v202
  v_lshlrev_b32 v4, 16, v150
  v_and_b32 v5, s65, v150
  v_pk_add_f32 v[2:3], v[2:3], v[4:5]
  v_cvt_pk_bf16_f32 v198, v2, v3
  v_lshlrev_b32 v2, 16, v203
  v_and_b32 v3, s65, v203
  v_lshlrev_b32 v4, 16, v151
  v_and_b32 v5, s65, v151
  v_pk_add_f32 v[2:3], v[2:3], v[4:5]
  v_cvt_pk_bf16_f32 v199, v2, v3
  s_mov_b64 exec, s[68:69]
  buffer_store_dwordx4 v[196:199], v229, s[28:31], 0 offen offset:48
  s_mov_b64 exec, -1
  s_waitcnt vmcnt(0)
K2END:
  s_endpgm
.section .rodata,"a"
.p2align 6
.amdhsa_kernel part_kernel
  .amdhsa_next_free_vgpr 56
  .amdhsa_next_free_sgpr 96
  .amdhsa_accum_offset 56
  .amdhsa_group_segment_fixed_size 0
  .amdhsa_kernarg_size 88
  .amdhsa_user_sgpr_count 2
  .amdhsa_user_sgpr_kernarg_segment_ptr 1
  .amdhsa_system_sgpr_workgroup_id_x 1
.end_amdhsa_kernel
.p2align 6
.amdhsa_kernel main_kernel
  .amdhsa_next_free_vgpr 256
  .amdhsa_next_free_sgpr 96
  .amdhsa_accum_offset 256
  .amdhsa_group_segment_fixed_size 0
  .amdhsa_kernarg_size 88
  .amdhsa_user_sgpr_count 2
  .amdhsa_user_sgpr_kernarg_segment_ptr 1
  .amdhsa_system_sgpr_workgroup_id_x 1
.end_amdhsa_kernel
```

```asm
; @launch kernel=part_kernel grid=(250,1,1) block=(640,1,1) lds=27648
; @launch kernel=main_kernel grid=(256,1,1) block=(512,1,1) lds=163328
.amdgcn_target "amdgcn-amd-amdhsa--gfx950"
.text
.globl part_kernel
.p2align 8
.type part_kernel,@function
part_kernel:
  s_cmp_ge_u32 s2, 250
  s_cbranch_scc1 K1END
  s_load_dwordx4 s[4:7], s[0:1], 24
  s_load_dwordx2 s[8:9], s[0:1], 80
  v_and_b32 v1, 255, v0
  v_lshlrev_b32 v1, 2, v1
  v_mov_b32 v2, 0
  ds_write_b32 v1, v2 offset:25600
  s_mul_i32 s3, s2, 12800
  v_lshlrev_b32 v2, 4, v0
  v_lshlrev_b32 v3, 2, v0
  v_add_u32 v3, 10240, v3
  s_waitcnt lgkmcnt(0)
  s_mov_b32 s12, s4
  s_mov_b32 s13, s5
  s_mov_b32 s14, 3200000
  s_mov_b32 s15, 0x20000
  s_mov_b32 s16, s6
  s_mov_b32 s17, s7
  s_mov_b32 s18, 3200000
  s_mov_b32 s19, 0x20000
  buffer_load_dwordx4 v[4:7], v2, s[16:19], s3 offen
  buffer_load_dword v8, v3, s[16:19], s3 offen
  buffer_load_dwordx4 v[12:15], v2, s[12:15], s3 offen
  buffer_load_dword v16, v3, s[12:15], s3 offen
  s_mov_b32 s20, s8
  s_mov_b32 s21, s9
  s_mov_b32 s22, 6400000
  s_mov_b32 s23, 0x20000
  s_add_u32 s24, s8, 6815744
  s_addc_u32 s25, s9, 0
  s_mov_b32 s26, 256000
  s_mov_b32 s27, 0x20000
  s_mov_b32 s28, 83887
  s_mov_b32 s29, -25
  s_mul_i32 s30, s2, 3200
  v_mov_b32 v50, 1
  v_lshl_add_u32 v51, v0, 2, s30
  s_add_u32 s30, s30, 2560
  v_add_u32 v52, s30, v0
  v_readfirstlane_b32 s31, v0
  s_barrier
  s_waitcnt vmcnt(2)
  v_mul_u32_u24 v37, s28, v4
  v_lshrrev_b32 v37, 21, v37
  v_lshrrev_b32 v20, 1, v37
  v_and_b32 v20, 0x3fc, v20
  ds_add_rtn_u32 v28, v20, v50 offset:25600
  v_mul_u32_u24 v39, s28, v5
  v_lshrrev_b32 v39, 21, v39
  v_lshrrev_b32 v21, 1, v39
  v_and_b32 v21, 0x3fc, v21
  ds_add_rtn_u32 v29, v21, v50 offset:25600
  v_mul_u32_u24 v41, s28, v6
  v_lshrrev_b32 v41, 21, v41
  v_lshrrev_b32 v22, 1, v41
  v_and_b32 v22, 0x3fc, v22
  ds_add_rtn_u32 v30, v22, v50 offset:25600
  v_mul_u32_u24 v43, s28, v7
  v_lshrrev_b32 v43, 21, v43
  v_lshrrev_b32 v23, 1, v43
  v_and_b32 v23, 0x3fc, v23
  ds_add_rtn_u32 v31, v23, v50 offset:25600
  v_mul_u32_u24 v45, s28, v8
  v_lshrrev_b32 v45, 21, v45
  v_lshrrev_b32 v24, 1, v45
  v_and_b32 v24, 0x3fc, v24
  ds_add_rtn_u32 v32, v24, v50 offset:25600
  s_waitcnt vmcnt(0)
  v_mad_i32_i24 v4, v37, s29, v4
  v_lshl_or_b32 v36, v4, 27, v12
  v_and_b32 v37, 7, v37
  v_lshrrev_b32 v12, 12, v12
  v_lshl_or_b32 v37, v37, 4, v12
  v_lshl_or_b32 v37, v37, 24, v51
  v_mad_i32_i24 v5, v39, s29, v5
  v_lshl_or_b32 v38, v5, 27, v13
  v_and_b32 v39, 7, v39
  v_lshrrev_b32 v13, 12, v13
  v_lshl_or_b32 v39, v39, 4, v13
  v_add_u32 v51, 1, v51
  v_lshl_or_b32 v39, v39, 24, v51
  v_mad_i32_i24 v6, v41, s29, v6
  v_lshl_or_b32 v40, v6, 27, v14
  v_and_b32 v41, 7, v41
  v_lshrrev_b32 v14, 12, v14
  v_lshl_or_b32 v41, v41, 4, v14
  v_add_u32 v51, 1, v51
  v_lshl_or_b32 v41, v41, 24, v51
  v_mad_i32_i24 v7, v43, s29, v7
  v_lshl_or_b32 v42, v7, 27, v15
  v_and_b32 v43, 7, v43
  v_lshrrev_b32 v15, 12, v15
  v_lshl_or_b32 v43, v43, 4, v15
  v_add_u32 v51, 1, v51
  v_lshl_or_b32 v43, v43, 24, v51
  v_mad_i32_i24 v8, v45, s29, v8
  v_lshl_or_b32 v44, v8, 27, v16
  v_and_b32 v45, 7, v45
  v_lshrrev_b32 v16, 12, v16
  v_lshl_or_b32 v45, v45, 4, v16
  v_lshl_or_b32 v45, v45, 24, v52
  v_and_b32 v1, 63, v0
  v_lshlrev_b32 v1, 4, v1
  s_waitcnt lgkmcnt(0)
  s_barrier
  ds_read_b128 v[4:7], v1 offset:25600
  s_waitcnt lgkmcnt(0)
  v_add_u32 v8, v4, v5
  v_add_u32 v9, v8, v6
  v_add_u32 v10, v9, v7
  v_mov_b32 v11, v10
  s_nop 1
  v_add_u32_dpp v11, v11, v11 row_shr:1 row_mask:0xf bank_mask:0xf
  s_nop 1
  v_add_u32_dpp v11, v11, v11 row_shr:2 row_mask:0xf bank_mask:0xf
  s_nop 1
  v_add_u32_dpp v11, v11, v11 row_shr:4 row_mask:0xf bank_mask:0xf
  s_nop 1
  v_add_u32_dpp v11, v11, v11 row_shr:8 row_mask:0xf bank_mask:0xf
  s_nop 1
  v_add_u32_dpp v11, v11, v11 row_bcast:15 row_mask:0xa bank_mask:0xf
  s_nop 1
  v_add_u32_dpp v11, v11, v11 row_bcast:31 row_mask:0xc bank_mask:0xf
  v_sub_u32 v12, v11, v10
  v_add_u32 v13, v12, v4
  v_add_u32 v14, v12, v8
  v_add_u32 v15, v12, v9
  ds_write_b128 v1, v[12:15] offset:26624
  ds_read_b32 v20, v20 offset:26624
  ds_read_b32 v21, v21 offset:26624
  ds_read_b32 v22, v22 offset:26624
  ds_read_b32 v23, v23 offset:26624
  ds_read_b32 v24, v24 offset:26624
  s_cmp_ge_u32 s31, 64
  s_cbranch_scc1 K1NOOFS
  v_lshl_or_b32 v16, v4, 16, v12
  v_lshl_or_b32 v17, v5, 16, v13
  v_lshl_or_b32 v18, v6, 16, v14
  v_lshl_or_b32 v19, v7, 16, v15
  s_lshl_b32 s3, s2, 10
  buffer_store_dwordx4 v[16:19], v1, s[24:27], s3 offen
K1NOOFS:
  s_waitcnt lgkmcnt(4)
  v_add_lshl_u32 v20, v20, v28, 3
  ds_write_b64 v20, v[36:37]
  s_waitcnt lgkmcnt(4)
  v_add_lshl_u32 v21, v21, v29, 3
  ds_write_b64 v21, v[38:39]
  s_waitcnt lgkmcnt(4)
  v_add_lshl_u32 v22, v22, v30, 3
  ds_write_b64 v22, v[40:41]
  s_waitcnt lgkmcnt(4)
  v_add_lshl_u32 v23, v23, v31, 3
  ds_write_b64 v23, v[42:43]
  s_waitcnt lgkmcnt(4)
  v_add_lshl_u32 v24, v24, v32, 3
  ds_write_b64 v24, v[44:45]
  v_lshlrev_b32 v3, 3, v0
  s_mul_i32 s3, s2, 25600
  s_add_u32 s4, s3, 10240
  s_add_u32 s5, s3, 20480
  s_waitcnt lgkmcnt(0)
  s_barrier
  ds_read_b128 v[4:7], v2
  ds_read_b128 v[8:11], v2 offset:10240
  ds_read_b64 v[12:13], v3 offset:20480
  s_waitcnt lgkmcnt(2)
  buffer_store_dwordx4 v[4:7], v2, s[20:23], s3 offen
  s_waitcnt lgkmcnt(1)
  buffer_store_dwordx4 v[8:11], v2, s[20:23], s4 offen
  s_waitcnt lgkmcnt(0)
  buffer_store_dwordx2 v[12:13], v3, s[20:23], s5 offen
K1END:
  s_endpgm
.globl main_kernel
.p2align 8
.type main_kernel,@function
main_kernel:
  s_cmp_ge_u32 s2, 256
  s_cbranch_scc1 K2END
  s_and_b32 s3, s2, 7
  s_lshl_b32 s3, s3, 5
  s_lshr_b32 s56, s2, 3
  s_add_u32 s56, s56, s3
  s_cmp_ge_u32 s56, 250
  s_cbranch_scc1 K2END
  s_load_dwordx16 s[32:47], s[0:1], 0
  s_load_dwordx2 s[48:49], s[0:1], 64
  s_load_dwordx2 s[52:53], s[0:1], 80
  v_lshrrev_b32 v2, 6, v0
  v_and_b32 v0, 63, v0
  v_readfirstlane_b32 s57, v2
  s_mov_b32 s60, 40
  s_mov_b32 s61, 0
  s_mov_b32 s63, 1
  s_movk_i32 s64, 128
  s_mov_b32 s65, 0xffff0000
  s_mov_b32 s70, 0xbfb8aa3b
  s_mov_b32 s71, 0xbfb8aa3b
  s_mov_b32 s72, 1.0
  s_mov_b32 s73, 1.0
  s_mov_b32 s76, 0xbdc5bdc5
  s_mov_b32 s74, -1
  s_mov_b32 s75, 0
  s_mul_i32 s58, s56, 200
  s_mul_i32 s3, s57, 25
  s_add_u32 s58, s58, s3
  s_lshl_b32 s66, s57, 13
  s_add_u32 s66, s66, 81408
  s_lshl_b32 s67, s57, 10
  s_add_u32 s67, s67, 36352
  s_waitcnt lgkmcnt(0)
  s_mov_b32 s4, s32
  s_mov_b32 s5, s33
  s_mov_b32 s6, 6400000
  s_mov_b32 s7, 0x20000
  s_mov_b32 s12, s34
  s_mov_b32 s13, s35
  s_mov_b32 s14, 300000
  s_mov_b32 s15, 0x20000
  s_mov_b32 s8, s36
  s_mov_b32 s9, s37
  s_mov_b32 s10, 25600000
  s_mov_b32 s11, 0x20000
  s_mov_b32 s16, s52
  s_mov_b32 s17, s53
  s_mov_b32 s18, 6400000
  s_mov_b32 s19, 0x20000
  s_mov_b32 s28, s48
  s_mov_b32 s29, s49
  s_mov_b32 s30, 6700000
  s_mov_b32 s31, 0x20000
  s_mov_b32 s24, s42
  s_mov_b32 s25, s43
  s_mov_b32 s26, 18560
  s_mov_b32 s27, 0x20000
  s_add_u32 s20, s52, 6815744
  s_addc_u32 s21, s53, 0
  s_mov_b32 s22, 256000
  s_mov_b32 s23, 0x20000
ROUND:
  v_lshrrev_b32 v2, 2, v0
  s_lshl_b32 s3, s57, 5
  v_add_u32 v2, s3, v2
  s_lshl_b32 s3, s56, 2
  v_lshl_add_u32 v3, v2, 10, s3
  v_add_u32 v4, 0x4000, v3
  buffer_load_dword v224, v3, s[20:23], 0 offen
  buffer_load_dword v225, v4, s[20:23], 0 offen
  s_movk_i32 s3, 25600
  v_mul_u32_u24 v226, s3, v2
  v_and_b32 v3, 3, v0
  v_lshl_add_u32 v226, v3, 4, v226
  v_add_u32 v227, 409600, v226
  s_and_b32 s3, s57, 3
  s_lshl_b32 s3, s3, 8
  v_lshl_add_u32 v4, v0, 2, s3
  v_mov_b32 v5, 0
  ds_write_b32 v4, v5 offset:34816
  s_cmp_eq_u32 s63, 0
  s_cbranch_scc1 NOTFIRST1
  v_and_b32 v2, 7, v0
  v_lshrrev_b32 v3, 4, v0
  v_and_b32 v3, 1, v3
  v_lshlrev_b32 v4, 2, v3
  v_xor_b32 v4, v4, v2
  v_lshlrev_b32 v4, 4, v4
  v_lshrrev_b32 v5, 3, v0
  v_lshl_or_b32 v4, v5, 7, v4
  s_lshl_b32 s3, s57, 10
  v_add_u32 v4, s3, v4
  s_add_u32 m0, s3, 44544
  s_nop 0
  buffer_load_dwordx4 v4, s[24:27], 0 offen lds
  v_add_u32 v4, 0x2000, v4
  s_add_u32 m0, s3, 52736
  s_nop 0
  buffer_load_dwordx4 v4, s[24:27], 0 offen lds
  v_add_u32 v4, 0x2000, v4
  s_add_u32 m0, s3, 60928
  s_nop 0
  buffer_load_dwordx4 v4, s[24:27], 0 offen lds
  v_lshrrev_b32 v6, 5, v0
  v_lshl_add_u32 v237, v6, 2, 0
  v_xor_b32 v237, v237, v2
  v_lshlrev_b32 v237, 4, v237
  v_lshl_add_u32 v7, v5, 2, s58
  v_add_u32 v7, 0, v7
  v_mad_u32_u24 v7, v7, s64, v237
  s_add_u32 m0, s66, 0
  s_nop 0
  buffer_load_dwordx4 v7, s[4:7], 0 offen lds
  v_lshl_add_u32 v238, v6, 2, 1
  v_xor_b32 v238, v238, v2
  v_lshlrev_b32 v238, 4, v238
  v_lshl_add_u32 v7, v5, 2, s58
  v_add_u32 v7, 1, v7
  v_mad_u32_u24 v7, v7, s64, v238
  s_add_u32 m0, s66, 1024
  s_nop 0
  buffer_load_dwordx4 v7, s[4:7], 0 offen lds
  v_lshl_add_u32 v239, v6, 2, 2
  v_xor_b32 v239, v239, v2
  v_lshlrev_b32 v239, 4, v239
  v_lshl_add_u32 v7, v5, 2, s58
  v_add_u32 v7, 2, v7
  v_mad_u32_u24 v7, v7, s64, v239
  s_add_u32 m0, s66, 2048
  s_nop 0
  buffer_load_dwordx4 v7, s[4:7], 0 offen lds
  v_lshl_add_u32 v240, v6, 2, 3
  v_xor_b32 v240, v240, v2
  v_lshlrev_b32 v240, 4, v240
  v_lshl_add_u32 v7, v5, 2, s58
  v_add_u32 v7, 3, v7
  v_mad_u32_u24 v7, v7, s64, v240
  s_add_u32 m0, s66, 3072
  s_nop 0
  buffer_load_dwordx4 v7, s[4:7], 0 offen lds
  v_add_u32 v232, s58, v0
  v_mul_u32_u24 v7, 6, v232
  v_and_b32 v7, -4, v7
  buffer_load_dwordx2 v[228:229], v7, s[12:15], 0 offen
  s_mov_b32 s24, s44
  s_mov_b32 s25, s45
  s_mov_b32 s26, 128
  s_mov_b32 s27, 0x20000
  v_lshlrev_b32 v7, 3, v6
  buffer_load_dwordx2 v[72:73], v7, s[24:27], 0 offen offset:0
  buffer_load_dwordx2 v[74:75], v7, s[24:27], 0 offen offset:16
  buffer_load_dwordx2 v[76:77], v7, s[24:27], 0 offen offset:32
  buffer_load_dwordx2 v[78:79], v7, s[24:27], 0 offen offset:48
  buffer_load_dwordx2 v[80:81], v7, s[24:27], 0 offen offset:64
  buffer_load_dwordx2 v[82:83], v7, s[24:27], 0 offen offset:80
  buffer_load_dwordx2 v[84:85], v7, s[24:27], 0 offen offset:96
  buffer_load_dwordx2 v[86:87], v7, s[24:27], 0 offen offset:112
  s_mov_b32 s24, s46
  s_mov_b32 s25, s47
  s_mov_b32 s26, 16384
  s_mov_b32 s27, 0x20000
  v_lshlrev_b32 v4, 1, v3
  v_xor_b32 v4, v4, v2
  v_lshlrev_b32 v4, 4, v4
  v_lshl_or_b32 v4, v5, 7, v4
  v_add_u32 v4, s3, v4
  s_add_u32 m0, s3, 146944
  s_nop 0
  buffer_load_dwordx4 v4, s[24:27], 0 offen lds
  v_add_u32 v4, 0x2000, v4
  s_add_u32 m0, s3, 155136
  s_nop 0
  buffer_load_dwordx4 v4, s[24:27], 0 offen lds
  v_lshlrev_b32 v254, 4, v6
  v_and_b32 v2, 3, v0
  v_bfe_u32 v4, v0, 2, 3
  v_lshl_add_u32 v4, v2, 3, v4
  v_xor_b32 v7, v3, v6
  v_lshlrev_b32 v7, 6, v7
  v_lshl_add_u32 v4, v4, 7, v7
  v_add_u32 v4, s66, v4
  v_xor_b32 v7, 0, v2
  v_lshl_add_u32 v241, v7, 4, v4
  v_xor_b32 v7, 1, v2
  v_lshl_add_u32 v242, v7, 4, v4
  v_xor_b32 v7, 2, v2
  v_lshl_add_u32 v243, v7, 4, v4
  v_xor_b32 v7, 3, v2
  v_lshl_add_u32 v244, v7, 4, v4
  s_add_u32 s3, s67, 32
  v_lshlrev_b32 v7, 5, v6
  v_sub_u32 v245, s3, v7
  s_add_u32 s3, s67, 224
  v_lshl_add_u32 v7, v3, 2, v2
  v_lshlrev_b32 v7, 5, v7
  v_sub_u32 v247, s3, v7
  s_mul_i32 s3, s57, 4608
  s_add_u32 s3, s3, 44544
  v_and_b32 v7, 31, v0
  s_movk_i32 s68, 144
  v_mul_u32_u24 v8, s68, v7
  v_add_u32 v8, s3, v8
  v_lshl_add_u32 v246, v6, 5, v8
  v_bfe_u32 v4, v0, 2, 2
  v_lshl_add_u32 v8, v6, 2, v4
  s_movk_i32 s68, 576
  v_mul_u32_u24 v9, s68, v8
  v_add_u32 v9, s3, v9
  v_xor_b32 v249, v3, v0
  v_and_b32 v249, 1, v249
  v_lshl_add_u32 v249, v249, 3, v9
  v_add_u32 v249, 128, v249
  v_lshl_add_u32 v248, v3, 5, v9
  v_lshl_add_u32 v248, v2, 3, v248
  v_mov_b32 v128, 0
  v_mov_b32 v129, 0
  v_mov_b32 v130, 0x3c00
  v_mov_b32 v131, 0x3c000000
  v_cmp_eq_u32 vcc, 28, v0
  s_nop 1
  v_cndmask_b32 v128, v128, v130, vcc
  v_cmp_eq_u32 vcc, 29, v0
  s_nop 1
  v_cndmask_b32 v128, v128, v131, vcc
  v_cmp_eq_u32 vcc, 30, v0
  s_nop 1
  v_cndmask_b32 v129, v129, v130, vcc
  v_cmp_eq_u32 vcc, 31, v0
  s_nop 1
  v_cndmask_b32 v129, v129, v131, vcc
  v_lshl_add_u32 v9, v0, 3, s67
  ds_write_b64 v9, v[128:129]
  v_mov_b32 v88, 0
  v_mov_b32 v89, 0
  v_mov_b32 v90, 0
  v_mov_b32 v91, 0
  v_mov_b32 v92, 0
  v_mov_b32 v93, 0
  v_mov_b32 v94, 0
  v_mov_b32 v95, 0
  v_mov_b32 v96, 0
  v_mov_b32 v97, 0
  v_mov_b32 v98, 0
  v_mov_b32 v99, 0
  v_mov_b32 v100, 0
  v_mov_b32 v101, 0
  v_mov_b32 v102, 0
  v_mov_b32 v103, 0
  v_mov_b32 v104, 0
  v_mov_b32 v105, 0
  v_mov_b32 v106, 0
  v_mov_b32 v107, 0
  v_mov_b32 v108, 0
  v_mov_b32 v109, 0
  v_mov_b32 v110, 0
  v_mov_b32 v111, 0
  v_mov_b32 v112, 0
  v_mov_b32 v113, 0
  v_mov_b32 v114, 0
  v_mov_b32 v115, 0
  v_mov_b32 v116, 0
  v_mov_b32 v117, 0
  v_mov_b32 v118, 0
  v_mov_b32 v119, 0
  v_mov_b32 v120, 0
  v_mov_b32 v121, 0
  v_mov_b32 v122, 0
  v_mov_b32 v123, 0
  s_waitcnt vmcnt(18)
  s_branch FIRST1
NOTFIRST1:
  s_waitcnt vmcnt(0)
FIRST1:
  v_lshrrev_b32 v2, 16, v224
  v_and_b32 v3, 0xffff, v224
  v_add_u32 v3, s61, v3
  v_lshl_add_u32 v226, v3, 3, v226
  v_subrev_u32 v224, s61, v2
  v_min_i32 v2, s60, v224
  v_and_b32 v3, 3, v0
  v_lshlrev_b32 v3, 1, v3
  v_sub_u32 v234, v2, v3
  v_cmpx_lt_i32 vcc, 0, v234
  buffer_load_dwordx4 v[128:131], v226, s[16:19], 0 offen offset:0
  v_cmpx_lt_i32 vcc, 8, v234
  buffer_load_dwordx4 v[132:135], v226, s[16:19], 0 offen offset:64
  v_cmpx_lt_i32 vcc, 16, v234
  buffer_load_dwordx4 v[136:139], v226, s[16:19], 0 offen offset:128
  v_cmpx_lt_i32 vcc, 24, v234
  buffer_load_dwordx4 v[140:143], v226, s[16:19], 0 offen offset:192
  v_cmpx_lt_i32 vcc, 32, v234
  buffer_load_dwordx4 v[144:147], v226, s[16:19], 0 offen offset:256
  s_mov_b64 exec, -1
  v_lshrrev_b32 v2, 16, v225
  v_and_b32 v3, 0xffff, v225
  v_add_u32 v3, s61, v3
  v_lshl_add_u32 v227, v3, 3, v227
  v_subrev_u32 v225, s61, v2
  v_min_i32 v2, s60, v225
  v_and_b32 v3, 3, v0
  v_lshlrev_b32 v3, 1, v3
  v_sub_u32 v235, v2, v3
  v_cmpx_lt_i32 vcc, 0, v235
  buffer_load_dwordx4 v[148:151], v227, s[16:19], 0 offen offset:0
  v_cmpx_lt_i32 vcc, 8, v235
  buffer_load_dwordx4 v[152:155], v227, s[16:19], 0 offen offset:64
  v_cmpx_lt_i32 vcc, 16, v235
  buffer_load_dwordx4 v[156:159], v227, s[16:19], 0 offen offset:128
  v_cmpx_lt_i32 vcc, 24, v235
  buffer_load_dwordx4 v[160:163], v227, s[16:19], 0 offen offset:192
  v_cmpx_lt_i32 vcc, 32, v235
  buffer_load_dwordx4 v[164:167], v227, s[16:19], 0 offen offset:256
  s_mov_b64 exec, -1
  v_max_i32 v2, v224, v225
  v_cmp_lt_i32 vcc, s60, v2
  s_mov_b64 s[68:69], vcc
  s_waitcnt vmcnt(10) lgkmcnt(0)
  s_barrier
  s_cmp_eq_u64 s[68:69], 0
  s_cbranch_scc1 NOFLAG
  v_mov_b32 v2, 35328
  ds_write_b32 v2, v2
NOFLAG:
  s_cmp_eq_u32 s63, 0
  s_cbranch_scc1 NOTFIRST2
  v_lshlrev_b32 v5, 4, v232
  v_alignbit_b32 v6, v229, v228, v5
  v_lshrrev_b32 v7, v5, v229
  v_lshlrev_b32 v4, 16, v6
  v_and_b32 v5, s65, v6
  v_lshlrev_b32 v6, 16, v7
  v_lshl_add_u32 v9, v0, 3, s67
  s_mov_b64 exec, s[74:75]
  ds_write_b64 v9, v[4:5] offset:512
  ds_write_b32 v9, v6 offset:768
  s_mov_b64 exec, -1
  v_mov_b32 v228, 0
  v_mov_b32 v229, 0
  v_mov_b32 v230, 0
  v_mov_b32 v231, 0
  ds_read_b128 v[200:203], v241
  ds_read_b128 v[204:207], v242
  ds_read_b128 v[208:211], v243
  ds_read_b128 v[212:215], v244
  v_and_b32 v2, 3, v0
  v_bfe_u32 v3, v0, 4, 1
  v_bfe_u32 v4, v0, 2, 2
  v_lshrrev_b32 v5, 5, v0
  v_lshlrev_b32 v2, 3, v2
  v_lshl_add_u32 v2, v3, 5, v2
  v_add_u32 v2, 44544, v2
  v_lshl_add_u32 v2, v4, 7, v2
  v_lshl_add_u32 v6, v5, 12, v2
  v_lshrrev_b32 v3, 1, v4
  v_lshl_add_u32 v6, v3, 6, v6
  v_xor_b32 v7, 64, v6
  v_lshl_add_u32 v8, v5, 10, v2
  v_add_u32 v3, 1, v4
  v_bfe_u32 v3, v3, 1, 1
  v_lshl_add_u32 v8, v3, 6, v8
  v_xor_b32 v9, 64, v8
  ds_read_b64_tr_b16 v[16:17], v6 offset:0
  ds_read_b64_tr_b16 v[18:19], v6 offset:512
  ds_read_b64_tr_b16 v[20:21], v6 offset:1024
  ds_read_b64_tr_b16 v[22:23], v6 offset:1536
  ds_read_b64_tr_b16 v[24:25], v6 offset:2048
  ds_read_b64_tr_b16 v[26:27], v6 offset:2560
  ds_read_b64_tr_b16 v[28:29], v6 offset:3072
  ds_read_b64_tr_b16 v[30:31], v6 offset:3584
  ds_read_b64_tr_b16 v[32:33], v7 offset:0
  ds_read_b64_tr_b16 v[34:35], v7 offset:512
  ds_read_b64_tr_b16 v[36:37], v7 offset:1024
  ds_read_b64_tr_b16 v[38:39], v7 offset:1536
  ds_read_b64_tr_b16 v[40:41], v7 offset:2048
  ds_read_b64_tr_b16 v[42:43], v7 offset:2560
  ds_read_b64_tr_b16 v[44:45], v7 offset:3072
  ds_read_b64_tr_b16 v[46:47], v7 offset:3584
  ds_read_b64_tr_b16 v[48:49], v8 offset:16512
  ds_read_b64_tr_b16 v[50:51], v8 offset:17024
  ds_read_b64_tr_b16 v[52:53], v9 offset:16512
  ds_read_b64_tr_b16 v[54:55], v9 offset:17024
  v_and_b32 v2, 31, v0
  v_lshlrev_b32 v2, 1, v2
  v_add_u32 v2, 60928, v2
  ds_read_u16 v10, v2
  ds_read_u16 v11, v2 offset:64
  s_waitcnt lgkmcnt(0)
  v_mfma_f32_32x32x16_bf16 v[88:103], v[200:203], v[16:19], v[88:103]
  v_mfma_f32_32x32x16_bf16 v[88:103], v[204:207], v[20:23], v[88:103]
  v_mfma_f32_32x32x16_bf16 v[88:103], v[208:211], v[24:27], v[88:103]
  v_mfma_f32_32x32x16_bf16 v[88:103], v[212:215], v[28:31], v[88:103]
  v_mfma_f32_32x32x16_bf16 v[104:119], v[200:203], v[32:35], v[104:119]
  v_mfma_f32_32x32x16_bf16 v[104:119], v[204:207], v[36:39], v[104:119]
  v_mfma_f32_32x32x16_bf16 v[104:119], v[208:211], v[40:43], v[104:119]
  v_mfma_f32_32x32x16_bf16 v[104:119], v[212:215], v[44:47], v[104:119]
  ds_read_b64_tr_b16 v[16:17], v6 offset:8192
  ds_read_b64_tr_b16 v[18:19], v6 offset:8704
  ds_read_b64_tr_b16 v[20:21], v6 offset:9216
  ds_read_b64_tr_b16 v[22:23], v6 offset:9728
  ds_read_b64_tr_b16 v[24:25], v6 offset:10240
  ds_read_b64_tr_b16 v[26:27], v6 offset:10752
  ds_read_b64_tr_b16 v[28:29], v6 offset:11264
  ds_read_b64_tr_b16 v[30:31], v6 offset:11776
  ds_read_b64_tr_b16 v[32:33], v7 offset:8192
  ds_read_b64_tr_b16 v[34:35], v7 offset:8704
  ds_read_b64_tr_b16 v[36:37], v7 offset:9216
  ds_read_b64_tr_b16 v[38:39], v7 offset:9728
  ds_read_b64_tr_b16 v[40:41], v7 offset:10240
  ds_read_b64_tr_b16 v[42:43], v7 offset:10752
  ds_read_b64_tr_b16 v[44:45], v7 offset:11264
  ds_read_b64_tr_b16 v[46:47], v7 offset:11776
  v_subrev_u32 v5, 1, v5
  v_lshrrev_b32 v4, 2, v0
  v_lshrrev_b32 v8, 4, v0
  v_xor_b32 v4, v4, v8
  v_and_b32 v4, 1, v4
  v_subrev_u32 v4, 1, v4
  v_lshlrev_b32 v2, 16, v72
  v_and_b32 v3, s65, v72
  v_cvt_pk_f16_f32 v2, v2, v3
  v_and_b32 v72, v4, v2
  v_lshlrev_b32 v2, 16, v73
  v_and_b32 v3, s65, v73
  v_cvt_pk_f16_f32 v2, v2, v3
  v_and_b32 v73, v4, v2
  v_lshlrev_b32 v2, 16, v74
  v_and_b32 v3, s65, v74
  v_cvt_pk_f16_f32 v2, v2, v3
  v_and_b32 v74, v4, v2
  v_lshlrev_b32 v2, 16, v75
  v_and_b32 v3, s65, v75
  v_cvt_pk_f16_f32 v2, v2, v3
  v_and_b32 v75, v4, v2
  v_lshlrev_b32 v2, 16, v76
  v_and_b32 v3, s65, v76
  v_cvt_pk_f16_f32 v2, v2, v3
  v_and_b32 v76, v4, v2
  v_lshlrev_b32 v2, 16, v77
  v_and_b32 v3, s65, v77
  v_cvt_pk_f16_f32 v2, v2, v3
  v_and_b32 v77, v4, v2
  v_lshlrev_b32 v2, 16, v78
  v_and_b32 v3, s65, v78
  v_cvt_pk_f16_f32 v2, v2, v3
  v_and_b32 v78, v4, v2
  v_lshlrev_b32 v2, 16, v79
  v_and_b32 v3, s65, v79
  v_cvt_pk_f16_f32 v2, v2, v3
  v_and_b32 v79, v4, v2
  v_lshlrev_b32 v2, 16, v80
  v_and_b32 v3, s65, v80
  v_cvt_pk_f16_f32 v2, v2, v3
  v_and_b32 v80, v4, v2
  v_lshlrev_b32 v2, 16, v81
  v_and_b32 v3, s65, v81
  v_cvt_pk_f16_f32 v2, v2, v3
  v_and_b32 v81, v4, v2
  v_lshlrev_b32 v2, 16, v82
  v_and_b32 v3, s65, v82
  v_cvt_pk_f16_f32 v2, v2, v3
  v_and_b32 v82, v4, v2
  v_lshlrev_b32 v2, 16, v83
  v_and_b32 v3, s65, v83
  v_cvt_pk_f16_f32 v2, v2, v3
  v_and_b32 v83, v4, v2
  v_lshlrev_b32 v2, 16, v84
  v_and_b32 v3, s65, v84
  v_cvt_pk_f16_f32 v2, v2, v3
  v_and_b32 v84, v4, v2
  v_lshlrev_b32 v2, 16, v85
  v_and_b32 v3, s65, v85
  v_cvt_pk_f16_f32 v2, v2, v3
  v_and_b32 v85, v4, v2
  v_lshlrev_b32 v2, 16, v86
  v_and_b32 v3, s65, v86
  v_cvt_pk_f16_f32 v2, v2, v3
  v_and_b32 v86, v4, v2
  v_lshlrev_b32 v2, 16, v87
  v_and_b32 v3, s65, v87
  v_cvt_pk_f16_f32 v2, v2, v3
  v_and_b32 v87, v4, v2
  v_lshlrev_b32 v2, 16, v48
  v_and_b32 v3, s65, v48
  v_pk_mul_f32 v[2:3], v[2:3], s[70:71]
  v_cvt_pk_bf16_f32 v48, v2, v3
  v_lshlrev_b32 v2, 16, v49
  v_and_b32 v3, s65, v49
  v_pk_mul_f32 v[2:3], v[2:3], s[70:71]
  v_cvt_pk_bf16_f32 v49, v2, v3
  v_lshlrev_b32 v2, 16, v50
  v_and_b32 v3, s65, v50
  v_pk_mul_f32 v[2:3], v[2:3], s[70:71]
  v_cvt_pk_bf16_f32 v50, v2, v3
  v_lshlrev_b32 v2, 16, v51
  v_and_b32 v3, s65, v51
  v_pk_mul_f32 v[2:3], v[2:3], s[70:71]
  v_cvt_pk_bf16_f32 v51, v2, v3
  v_lshlrev_b32 v2, 16, v52
  v_and_b32 v3, s65, v52
  v_pk_mul_f32 v[2:3], v[2:3], s[70:71]
  v_cvt_pk_bf16_f32 v52, v2, v3
  v_lshlrev_b32 v2, 16, v53
  v_and_b32 v3, s65, v53
  v_pk_mul_f32 v[2:3], v[2:3], s[70:71]
  v_cvt_pk_bf16_f32 v53, v2, v3
  v_lshlrev_b32 v2, 16, v54
  v_and_b32 v3, s65, v54
  v_pk_mul_f32 v[2:3], v[2:3], s[70:71]
  v_cvt_pk_bf16_f32 v54, v2, v3
  v_lshlrev_b32 v2, 16, v55
  v_and_b32 v3, s65, v55
  v_pk_mul_f32 v[2:3], v[2:3], s[70:71]
  v_cvt_pk_bf16_f32 v55, v2, v3
  v_pk_mul_f32 v[88:89], v[88:89], s[70:71]
  v_cvt_pk_f16_f32 v56, v88, v89
  v_pk_mul_f32 v[90:91], v[90:91], s[70:71]
  v_cvt_pk_f16_f32 v57, v90, v91
  v_pk_mul_f32 v[92:93], v[92:93], s[70:71]
  v_cvt_pk_f16_f32 v58, v92, v93
  v_pk_mul_f32 v[94:95], v[94:95], s[70:71]
  v_cvt_pk_f16_f32 v59, v94, v95
  v_pk_mul_f32 v[96:97], v[96:97], s[70:71]
  v_cvt_pk_f16_f32 v60, v96, v97
  v_pk_mul_f32 v[98:99], v[98:99], s[70:71]
  v_cvt_pk_f16_f32 v61, v98, v99
  v_pk_mul_f32 v[100:101], v[100:101], s[70:71]
  v_cvt_pk_f16_f32 v62, v100, v101
  v_lshlrev_b32 v10, 16, v10
  v_mul_f32 v10, s70, v10
  v_cvt_pk_f16_f32 v10, v10, 0
  v_and_b32 v63, v5, v10
  v_pk_mul_f32 v[104:105], v[104:105], s[70:71]
  v_cvt_pk_f16_f32 v64, v104, v105
  v_pk_mul_f32 v[106:107], v[106:107], s[70:71]
  v_cvt_pk_f16_f32 v65, v106, v107
  v_pk_mul_f32 v[108:109], v[108:109], s[70:71]
  v_cvt_pk_f16_f32 v66, v108, v109
  v_pk_mul_f32 v[110:111], v[110:111], s[70:71]
  v_cvt_pk_f16_f32 v67, v110, v111
  v_pk_mul_f32 v[112:113], v[112:113], s[70:71]
  v_cvt_pk_f16_f32 v68, v112, v113
  v_pk_mul_f32 v[114:115], v[114:115], s[70:71]
  v_cvt_pk_f16_f32 v69, v114, v115
  v_pk_mul_f32 v[116:117], v[116:117], s[70:71]
  v_cvt_pk_f16_f32 v70, v116, v117
  v_lshlrev_b32 v11, 16, v11
  v_mul_f32 v11, s70, v11
  v_cvt_pk_f16_f32 v11, v11, 0
  v_and_b32 v71, v5, v11
  s_waitcnt lgkmcnt(0)
  v_lshlrev_b32 v2, 16, v16
  v_and_b32 v3, s65, v16
  v_pk_mul_f32 v[2:3], v[2:3], s[70:71]
  v_cvt_pk_bf16_f32 v16, v2, v3
  v_lshlrev_b32 v2, 16, v17
  v_and_b32 v3, s65, v17
  v_pk_mul_f32 v[2:3], v[2:3], s[70:71]
  v_cvt_pk_bf16_f32 v17, v2, v3
  v_lshlrev_b32 v2, 16, v18
  v_and_b32 v3, s65, v18
  v_pk_mul_f32 v[2:3], v[2:3], s[70:71]
  v_cvt_pk_bf16_f32 v18, v2, v3
  v_lshlrev_b32 v2, 16, v19
  v_and_b32 v3, s65, v19
  v_pk_mul_f32 v[2:3], v[2:3], s[70:71]
  v_cvt_pk_bf16_f32 v19, v2, v3
  v_lshlrev_b32 v2, 16, v20
  v_and_b32 v3, s65, v20
  v_pk_mul_f32 v[2:3], v[2:3], s[70:71]
  v_cvt_pk_bf16_f32 v20, v2, v3
  v_lshlrev_b32 v2, 16, v21
  v_and_b32 v3, s65, v21
  v_pk_mul_f32 v[2:3], v[2:3], s[70:71]
  v_cvt_pk_bf16_f32 v21, v2, v3
  v_lshlrev_b32 v2, 16, v22
  v_and_b32 v3, s65, v22
  v_pk_mul_f32 v[2:3], v[2:3], s[70:71]
  v_cvt_pk_bf16_f32 v22, v2, v3
  v_lshlrev_b32 v2, 16, v23
  v_and_b32 v3, s65, v23
  v_pk_mul_f32 v[2:3], v[2:3], s[70:71]
  v_cvt_pk_bf16_f32 v23, v2, v3
  v_lshlrev_b32 v2, 16, v24
  v_and_b32 v3, s65, v24
  v_pk_mul_f32 v[2:3], v[2:3], s[70:71]
  v_cvt_pk_bf16_f32 v24, v2, v3
  v_lshlrev_b32 v2, 16, v25
  v_and_b32 v3, s65, v25
  v_pk_mul_f32 v[2:3], v[2:3], s[70:71]
  v_cvt_pk_bf16_f32 v25, v2, v3
  v_lshlrev_b32 v2, 16, v26
  v_and_b32 v3, s65, v26
  v_pk_mul_f32 v[2:3], v[2:3], s[70:71]
  v_cvt_pk_bf16_f32 v26, v2, v3
  v_lshlrev_b32 v2, 16, v27
  v_and_b32 v3, s65, v27
  v_pk_mul_f32 v[2:3], v[2:3], s[70:71]
  v_cvt_pk_bf16_f32 v27, v2, v3
  v_lshlrev_b32 v2, 16, v28
  v_and_b32 v3, s65, v28
  v_pk_mul_f32 v[2:3], v[2:3], s[70:71]
  v_cvt_pk_bf16_f32 v28, v2, v3
  v_lshlrev_b32 v2, 16, v29
  v_and_b32 v3, s65, v29
  v_pk_mul_f32 v[2:3], v[2:3], s[70:71]
  v_cvt_pk_bf16_f32 v29, v2, v3
  v_lshlrev_b32 v2, 16, v30
  v_and_b32 v3, s65, v30
  v_pk_mul_f32 v[2:3], v[2:3], s[70:71]
  v_cvt_pk_bf16_f32 v30, v2, v3
  v_lshlrev_b32 v2, 16, v31
  v_and_b32 v3, s65, v31
  v_pk_mul_f32 v[2:3], v[2:3], s[70:71]
  v_cvt_pk_bf16_f32 v31, v2, v3
  v_lshlrev_b32 v2, 16, v32
  v_and_b32 v3, s65, v32
  v_pk_mul_f32 v[2:3], v[2:3], s[70:71]
  v_cvt_pk_bf16_f32 v32, v2, v3
  v_lshlrev_b32 v2, 16, v33
  v_and_b32 v3, s65, v33
  v_pk_mul_f32 v[2:3], v[2:3], s[70:71]
  v_cvt_pk_bf16_f32 v33, v2, v3
  v_lshlrev_b32 v2, 16, v34
  v_and_b32 v3, s65, v34
  v_pk_mul_f32 v[2:3], v[2:3], s[70:71]
  v_cvt_pk_bf16_f32 v34, v2, v3
  v_lshlrev_b32 v2, 16, v35
  v_and_b32 v3, s65, v35
  v_pk_mul_f32 v[2:3], v[2:3], s[70:71]
  v_cvt_pk_bf16_f32 v35, v2, v3
  v_lshlrev_b32 v2, 16, v36
  v_and_b32 v3, s65, v36
  v_pk_mul_f32 v[2:3], v[2:3], s[70:71]
  v_cvt_pk_bf16_f32 v36, v2, v3
  v_lshlrev_b32 v2, 16, v37
  v_and_b32 v3, s65, v37
  v_pk_mul_f32 v[2:3], v[2:3], s[70:71]
  v_cvt_pk_bf16_f32 v37, v2, v3
  v_lshlrev_b32 v2, 16, v38
  v_and_b32 v3, s65, v38
  v_pk_mul_f32 v[2:3], v[2:3], s[70:71]
  v_cvt_pk_bf16_f32 v38, v2, v3
  v_lshlrev_b32 v2, 16, v39
  v_and_b32 v3, s65, v39
  v_pk_mul_f32 v[2:3], v[2:3], s[70:71]
  v_cvt_pk_bf16_f32 v39, v2, v3
  v_lshlrev_b32 v2, 16, v40
  v_and_b32 v3, s65, v40
  v_pk_mul_f32 v[2:3], v[2:3], s[70:71]
  v_cvt_pk_bf16_f32 v40, v2, v3
  v_lshlrev_b32 v2, 16, v41
  v_and_b32 v3, s65, v41
  v_pk_mul_f32 v[2:3], v[2:3], s[70:71]
  v_cvt_pk_bf16_f32 v41, v2, v3
  v_lshlrev_b32 v2, 16, v42
  v_and_b32 v3, s65, v42
  v_pk_mul_f32 v[2:3], v[2:3], s[70:71]
  v_cvt_pk_bf16_f32 v42, v2, v3
  v_lshlrev_b32 v2, 16, v43
  v_and_b32 v3, s65, v43
  v_pk_mul_f32 v[2:3], v[2:3], s[70:71]
  v_cvt_pk_bf16_f32 v43, v2, v3
  v_lshlrev_b32 v2, 16, v44
  v_and_b32 v3, s65, v44
  v_pk_mul_f32 v[2:3], v[2:3], s[70:71]
  v_cvt_pk_bf16_f32 v44, v2, v3
  v_lshlrev_b32 v2, 16, v45
  v_and_b32 v3, s65, v45
  v_pk_mul_f32 v[2:3], v[2:3], s[70:71]
  v_cvt_pk_bf16_f32 v45, v2, v3
  v_lshlrev_b32 v2, 16, v46
  v_and_b32 v3, s65, v46
  v_pk_mul_f32 v[2:3], v[2:3], s[70:71]
  v_cvt_pk_bf16_f32 v46, v2, v3
  v_lshlrev_b32 v2, 16, v47
  v_and_b32 v3, s65, v47
  v_pk_mul_f32 v[2:3], v[2:3], s[70:71]
  v_cvt_pk_bf16_f32 v47, v2, v3
  v_mov_b32 v88, 0
  v_mov_b32 v89, 0
  v_mov_b32 v90, 0
  v_mov_b32 v91, 0
  v_mov_b32 v92, 0
  v_mov_b32 v93, 0
  v_mov_b32 v94, 0
  v_mov_b32 v95, 0
  v_mov_b32 v96, 0
  v_mov_b32 v97, 0
  v_mov_b32 v98, 0
  v_mov_b32 v99, 0
  v_mov_b32 v100, 0
  v_mov_b32 v101, 0
  v_mov_b32 v102, 0
  v_mov_b32 v103, 0
  v_mov_b32 v104, 0
  v_mov_b32 v105, 0
  v_mov_b32 v106, 0
  v_mov_b32 v107, 0
  v_mov_b32 v108, 0
  v_mov_b32 v109, 0
  v_mov_b32 v110, 0
  v_mov_b32 v111, 0
  v_mov_b32 v112, 0
  v_mov_b32 v113, 0
  v_mov_b32 v114, 0
  v_mov_b32 v115, 0
  v_mov_b32 v116, 0
  v_mov_b32 v117, 0
  v_mov_b32 v118, 0
  v_mov_b32 v119, 0
  s_mov_b32 s63, 0
NOTFIRST2:
  v_mov_b32 v3, 1
  s_waitcnt vmcnt(0)
  v_cmpx_lt_i32 vcc, 0, v234
  s_cbranch_execz RKDONE0
  v_lshlrev_b32_sdwa v2, 2, v129 dst_sel:DWORD dst_unused:UNUSED_PAD src0_sel:DWORD src1_sel:BYTE_3
  ds_add_rtn_u32 v168, v2, v3 offset:34816
  v_cmpx_lt_i32 vcc, 1, v234
  s_cbranch_execz RKDONE0
  v_lshlrev_b32_sdwa v2, 2, v131 dst_sel:DWORD dst_unused:UNUSED_PAD src0_sel:DWORD src1_sel:BYTE_3
  ds_add_rtn_u32 v169, v2, v3 offset:34816
  v_cmpx_lt_i32 vcc, 8, v234
  s_cbranch_execz RKDONE0
  v_lshlrev_b32_sdwa v2, 2, v133 dst_sel:DWORD dst_unused:UNUSED_PAD src0_sel:DWORD src1_sel:BYTE_3
  ds_add_rtn_u32 v170, v2, v3 offset:34816
  v_cmpx_lt_i32 vcc, 9, v234
  s_cbranch_execz RKDONE0
  v_lshlrev_b32_sdwa v2, 2, v135 dst_sel:DWORD dst_unused:UNUSED_PAD src0_sel:DWORD src1_sel:BYTE_3
  ds_add_rtn_u32 v171, v2, v3 offset:34816
  v_cmpx_lt_i32 vcc, 16, v234
  s_cbranch_execz RKDONE0
  v_lshlrev_b32_sdwa v2, 2, v137 dst_sel:DWORD dst_unused:UNUSED_PAD src0_sel:DWORD src1_sel:BYTE_3
  ds_add_rtn_u32 v172, v2, v3 offset:34816
  v_cmpx_lt_i32 vcc, 17, v234
  s_cbranch_execz RKDONE0
  v_lshlrev_b32_sdwa v2, 2, v139 dst_sel:DWORD dst_unused:UNUSED_PAD src0_sel:DWORD src1_sel:BYTE_3
  ds_add_rtn_u32 v173, v2, v3 offset:34816
  v_cmpx_lt_i32 vcc, 24, v234
  s_cbranch_execz RKDONE0
  v_lshlrev_b32_sdwa v2, 2, v141 dst_sel:DWORD dst_unused:UNUSED_PAD src0_sel:DWORD src1_sel:BYTE_3
  ds_add_rtn_u32 v174, v2, v3 offset:34816
  v_cmpx_lt_i32 vcc, 25, v234
  s_cbranch_execz RKDONE0
  v_lshlrev_b32_sdwa v2, 2, v143 dst_sel:DWORD dst_unused:UNUSED_PAD src0_sel:DWORD src1_sel:BYTE_3
  ds_add_rtn_u32 v175, v2, v3 offset:34816
  v_cmpx_lt_i32 vcc, 32, v234
  s_cbranch_execz RKDONE0
  v_lshlrev_b32_sdwa v2, 2, v145 dst_sel:DWORD dst_unused:UNUSED_PAD src0_sel:DWORD src1_sel:BYTE_3
  ds_add_rtn_u32 v176, v2, v3 offset:34816
  v_cmpx_lt_i32 vcc, 33, v234
  s_cbranch_execz RKDONE0
  v_lshlrev_b32_sdwa v2, 2, v147 dst_sel:DWORD dst_unused:UNUSED_PAD src0_sel:DWORD src1_sel:BYTE_3
  ds_add_rtn_u32 v177, v2, v3 offset:34816
RKDONE0:
  s_mov_b64 exec, -1
  v_cmpx_lt_i32 vcc, 0, v235
  s_cbranch_execz RKDONE1
  v_lshlrev_b32_sdwa v2, 2, v149 dst_sel:DWORD dst_unused:UNUSED_PAD src0_sel:DWORD src1_sel:BYTE_3
  ds_add_rtn_u32 v178, v2, v3 offset:34816
  v_cmpx_lt_i32 vcc, 1, v235
  s_cbranch_execz RKDONE1
  v_lshlrev_b32_sdwa v2, 2, v151 dst_sel:DWORD dst_unused:UNUSED_PAD src0_sel:DWORD src1_sel:BYTE_3
  ds_add_rtn_u32 v179, v2, v3 offset:34816
  v_cmpx_lt_i32 vcc, 8, v235
  s_cbranch_execz RKDONE1
  v_lshlrev_b32_sdwa v2, 2, v153 dst_sel:DWORD dst_unused:UNUSED_PAD src0_sel:DWORD src1_sel:BYTE_3
  ds_add_rtn_u32 v180, v2, v3 offset:34816
  v_cmpx_lt_i32 vcc, 9, v235
  s_cbranch_execz RKDONE1
  v_lshlrev_b32_sdwa v2, 2, v155 dst_sel:DWORD dst_unused:UNUSED_PAD src0_sel:DWORD src1_sel:BYTE_3
  ds_add_rtn_u32 v181, v2, v3 offset:34816
  v_cmpx_lt_i32 vcc, 16, v235
  s_cbranch_execz RKDONE1
  v_lshlrev_b32_sdwa v2, 2, v157 dst_sel:DWORD dst_unused:UNUSED_PAD src0_sel:DWORD src1_sel:BYTE_3
  ds_add_rtn_u32 v182, v2, v3 offset:34816
  v_cmpx_lt_i32 vcc, 17, v235
  s_cbranch_execz RKDONE1
  v_lshlrev_b32_sdwa v2, 2, v159 dst_sel:DWORD dst_unused:UNUSED_PAD src0_sel:DWORD src1_sel:BYTE_3
  ds_add_rtn_u32 v183, v2, v3 offset:34816
  v_cmpx_lt_i32 vcc, 24, v235
  s_cbranch_execz RKDONE1
  v_lshlrev_b32_sdwa v2, 2, v161 dst_sel:DWORD dst_unused:UNUSED_PAD src0_sel:DWORD src1_sel:BYTE_3
  ds_add_rtn_u32 v184, v2, v3 offset:34816
  v_cmpx_lt_i32 vcc, 25, v235
  s_cbranch_execz RKDONE1
  v_lshlrev_b32_sdwa v2, 2, v163 dst_sel:DWORD dst_unused:UNUSED_PAD src0_sel:DWORD src1_sel:BYTE_3
  ds_add_rtn_u32 v185, v2, v3 offset:34816
  v_cmpx_lt_i32 vcc, 32, v235
  s_cbranch_execz RKDONE1
  v_lshlrev_b32_sdwa v2, 2, v165 dst_sel:DWORD dst_unused:UNUSED_PAD src0_sel:DWORD src1_sel:BYTE_3
  ds_add_rtn_u32 v186, v2, v3 offset:34816
  v_cmpx_lt_i32 vcc, 33, v235
  s_cbranch_execz RKDONE1
  v_lshlrev_b32_sdwa v2, 2, v167 dst_sel:DWORD dst_unused:UNUSED_PAD src0_sel:DWORD src1_sel:BYTE_3
  ds_add_rtn_u32 v187, v2, v3 offset:34816
RKDONE1:
  s_mov_b64 exec, -1
  v_lshlrev_b32 v2, 2, v0
  v_mov_b32 v3, 35328
  s_waitcnt lgkmcnt(0)
  s_barrier
  ds_read2st64_b32 v[4:5], v2 offset0:136 offset1:137
  ds_read_b32 v8, v3
  s_waitcnt lgkmcnt(0)
  v_readfirstlane_b32 s62, v8
  v_mov_b32 v6, v4
  v_mov_b32 v7, v5
  s_nop 0
  v_add_u32_dpp v6, v6, v6 row_shr:1 row_mask:0xf bank_mask:0xf
  v_add_u32_dpp v7, v7, v7 row_shr:1 row_mask:0xf bank_mask:0xf
  s_nop 0
  v_add_u32_dpp v6, v6, v6 row_shr:2 row_mask:0xf bank_mask:0xf
  v_add_u32_dpp v7, v7, v7 row_shr:2 row_mask:0xf bank_mask:0xf
  s_nop 0
  v_add_u32_dpp v6, v6, v6 row_shr:4 row_mask:0xf bank_mask:0xf
  v_add_u32_dpp v7, v7, v7 row_shr:4 row_mask:0xf bank_mask:0xf
  s_nop 0
  v_add_u32_dpp v6, v6, v6 row_shr:8 row_mask:0xf bank_mask:0xf
  v_add_u32_dpp v7, v7, v7 row_shr:8 row_mask:0xf bank_mask:0xf
  v_max_u32 v8, v6, v7
  v_cmp_lt_u32 vcc, 0x200, v8
  s_cbranch_vccz NOOVF
  s_lshr_b32 s60, s60, 1
  s_barrier
  s_branch ROUND
NOOVF:
  s_and_b32 s3, s57, 3
  s_lshl_b32 s3, s3, 4
  s_add_u32 s3, s3, 15
  v_readlane_b32 s68, v6, s3
  v_readlane_b32 s69, v7, s3
  v_lshrrev_b32 v8, 4, v0
  v_mul_u32_u24 v8, 544, v8
  v_sub_u32 v6, v6, v4
  v_sub_u32 v7, v7, v5
  v_add_u32 v6, v6, v8
  v_add_u32 v7, v7, v8
  v_add_u32 v7, 2176, v7
  ds_write2st64_b32 v2, v6, v7 offset0:140 offset1:141
  s_cmp_ge_u32 s57, 4
  s_cselect_b32 s68, s69, s68
  s_add_u32 s59, s68, 31
  s_lshr_b32 s59, s59, 5
  v_cmpx_lt_i32 vcc, 0, v234
  s_cbranch_execz BSDONE0
  v_lshlrev_b32_sdwa v2, 2, v129 dst_sel:DWORD dst_unused:UNUSED_PAD src0_sel:DWORD src1_sel:BYTE_3
  ds_read_b32 v188, v2 offset:35840
  v_cmpx_lt_i32 vcc, 1, v234
  s_cbranch_execz BSDONE0
  v_lshlrev_b32_sdwa v2, 2, v131 dst_sel:DWORD dst_unused:UNUSED_PAD src0_sel:DWORD src1_sel:BYTE_3
  ds_read_b32 v189, v2 offset:35840
  v_cmpx_lt_i32 vcc, 8, v234
  s_cbranch_execz BSDONE0
  v_lshlrev_b32_sdwa v2, 2, v133 dst_sel:DWORD dst_unused:UNUSED_PAD src0_sel:DWORD src1_sel:BYTE_3
  ds_read_b32 v190, v2 offset:35840
  v_cmpx_lt_i32 vcc, 9, v234
  s_cbranch_execz BSDONE0
  v_lshlrev_b32_sdwa v2, 2, v135 dst_sel:DWORD dst_unused:UNUSED_PAD src0_sel:DWORD src1_sel:BYTE_3
  ds_read_b32 v191, v2 offset:35840
  v_cmpx_lt_i32 vcc, 16, v234
  s_cbranch_execz BSDONE0
  v_lshlrev_b32_sdwa v2, 2, v137 dst_sel:DWORD dst_unused:UNUSED_PAD src0_sel:DWORD src1_sel:BYTE_3
  ds_read_b32 v192, v2 offset:35840
  v_cmpx_lt_i32 vcc, 17, v234
  s_cbranch_execz BSDONE0
  v_lshlrev_b32_sdwa v2, 2, v139 dst_sel:DWORD dst_unused:UNUSED_PAD src0_sel:DWORD src1_sel:BYTE_3
  ds_read_b32 v193, v2 offset:35840
  v_cmpx_lt_i32 vcc, 24, v234
  s_cbranch_execz BSDONE0
  v_lshlrev_b32_sdwa v2, 2, v141 dst_sel:DWORD dst_unused:UNUSED_PAD src0_sel:DWORD src1_sel:BYTE_3
  ds_read_b32 v194, v2 offset:35840
  v_cmpx_lt_i32 vcc, 25, v234
  s_cbranch_execz BSDONE0
  v_lshlrev_b32_sdwa v2, 2, v143 dst_sel:DWORD dst_unused:UNUSED_PAD src0_sel:DWORD src1_sel:BYTE_3
  ds_read_b32 v195, v2 offset:35840
  v_cmpx_lt_i32 vcc, 32, v234
  s_cbranch_execz BSDONE0
  v_lshlrev_b32_sdwa v2, 2, v145 dst_sel:DWORD dst_unused:UNUSED_PAD src0_sel:DWORD src1_sel:BYTE_3
  ds_read_b32 v196, v2 offset:35840
  v_cmpx_lt_i32 vcc, 33, v234
  s_cbranch_execz BSDONE0
  v_lshlrev_b32_sdwa v2, 2, v147 dst_sel:DWORD dst_unused:UNUSED_PAD src0_sel:DWORD src1_sel:BYTE_3
  ds_read_b32 v197, v2 offset:35840
BSDONE0:
  s_mov_b64 exec, -1
  s_waitcnt lgkmcnt(0)
  v_cmpx_lt_i32 vcc, 0, v234
  s_cbranch_execz SCDONE0
  v_add_lshl_u32 v2, v188, v168, 2
  ds_write2st64_b32 v2, v128, v129 offset0:0 offset1:68
  v_cmpx_lt_i32 vcc, 1, v234
  s_cbranch_execz SCDONE0
  v_add_lshl_u32 v2, v189, v169, 2
  ds_write2st64_b32 v2, v130, v131 offset0:0 offset1:68
  v_cmpx_lt_i32 vcc, 8, v234
  s_cbranch_execz SCDONE0
  v_add_lshl_u32 v2, v190, v170, 2
  ds_write2st64_b32 v2, v132, v133 offset0:0 offset1:68
  v_cmpx_lt_i32 vcc, 9, v234
  s_cbranch_execz SCDONE0
  v_add_lshl_u32 v2, v191, v171, 2
  ds_write2st64_b32 v2, v134, v135 offset0:0 offset1:68
  v_cmpx_lt_i32 vcc, 16, v234
  s_cbranch_execz SCDONE0
  v_add_lshl_u32 v2, v192, v172, 2
  ds_write2st64_b32 v2, v136, v137 offset0:0 offset1:68
  v_cmpx_lt_i32 vcc, 17, v234
  s_cbranch_execz SCDONE0
  v_add_lshl_u32 v2, v193, v173, 2
  ds_write2st64_b32 v2, v138, v139 offset0:0 offset1:68
  v_cmpx_lt_i32 vcc, 24, v234
  s_cbranch_execz SCDONE0
  v_add_lshl_u32 v2, v194, v174, 2
  ds_write2st64_b32 v2, v140, v141 offset0:0 offset1:68
  v_cmpx_lt_i32 vcc, 25, v234
  s_cbranch_execz SCDONE0
  v_add_lshl_u32 v2, v195, v175, 2
  ds_write2st64_b32 v2, v142, v143 offset0:0 offset1:68
  v_cmpx_lt_i32 vcc, 32, v234
  s_cbranch_execz SCDONE0
  v_add_lshl_u32 v2, v196, v176, 2
  ds_write2st64_b32 v2, v144, v145 offset0:0 offset1:68
  v_cmpx_lt_i32 vcc, 33, v234
  s_cbranch_execz SCDONE0
  v_add_lshl_u32 v2, v197, v177, 2
  ds_write2st64_b32 v2, v146, v147 offset0:0 offset1:68
SCDONE0:
  s_mov_b64 exec, -1
  v_cmpx_lt_i32 vcc, 0, v235
  s_cbranch_execz BSDONE1
  v_lshlrev_b32_sdwa v2, 2, v149 dst_sel:DWORD dst_unused:UNUSED_PAD src0_sel:DWORD src1_sel:BYTE_3
  ds_read_b32 v188, v2 offset:35840
  v_cmpx_lt_i32 vcc, 1, v235
  s_cbranch_execz BSDONE1
  v_lshlrev_b32_sdwa v2, 2, v151 dst_sel:DWORD dst_unused:UNUSED_PAD src0_sel:DWORD src1_sel:BYTE_3
  ds_read_b32 v189, v2 offset:35840
  v_cmpx_lt_i32 vcc, 8, v235
  s_cbranch_execz BSDONE1
  v_lshlrev_b32_sdwa v2, 2, v153 dst_sel:DWORD dst_unused:UNUSED_PAD src0_sel:DWORD src1_sel:BYTE_3
  ds_read_b32 v190, v2 offset:35840
  v_cmpx_lt_i32 vcc, 9, v235
  s_cbranch_execz BSDONE1
  v_lshlrev_b32_sdwa v2, 2, v155 dst_sel:DWORD dst_unused:UNUSED_PAD src0_sel:DWORD src1_sel:BYTE_3
  ds_read_b32 v191, v2 offset:35840
  v_cmpx_lt_i32 vcc, 16, v235
  s_cbranch_execz BSDONE1
  v_lshlrev_b32_sdwa v2, 2, v157 dst_sel:DWORD dst_unused:UNUSED_PAD src0_sel:DWORD src1_sel:BYTE_3
  ds_read_b32 v192, v2 offset:35840
  v_cmpx_lt_i32 vcc, 17, v235
  s_cbranch_execz BSDONE1
  v_lshlrev_b32_sdwa v2, 2, v159 dst_sel:DWORD dst_unused:UNUSED_PAD src0_sel:DWORD src1_sel:BYTE_3
  ds_read_b32 v193, v2 offset:35840
  v_cmpx_lt_i32 vcc, 24, v235
  s_cbranch_execz BSDONE1
  v_lshlrev_b32_sdwa v2, 2, v161 dst_sel:DWORD dst_unused:UNUSED_PAD src0_sel:DWORD src1_sel:BYTE_3
  ds_read_b32 v194, v2 offset:35840
  v_cmpx_lt_i32 vcc, 25, v235
  s_cbranch_execz BSDONE1
  v_lshlrev_b32_sdwa v2, 2, v163 dst_sel:DWORD dst_unused:UNUSED_PAD src0_sel:DWORD src1_sel:BYTE_3
  ds_read_b32 v195, v2 offset:35840
  v_cmpx_lt_i32 vcc, 32, v235
  s_cbranch_execz BSDONE1
  v_lshlrev_b32_sdwa v2, 2, v165 dst_sel:DWORD dst_unused:UNUSED_PAD src0_sel:DWORD src1_sel:BYTE_3
  ds_read_b32 v196, v2 offset:35840
  v_cmpx_lt_i32 vcc, 33, v235
  s_cbranch_execz BSDONE1
  v_lshlrev_b32_sdwa v2, 2, v167 dst_sel:DWORD dst_unused:UNUSED_PAD src0_sel:DWORD src1_sel:BYTE_3
  ds_read_b32 v197, v2 offset:35840
BSDONE1:
  s_mov_b64 exec, -1
  s_waitcnt lgkmcnt(0)
  v_cmpx_lt_i32 vcc, 0, v235
  s_cbranch_execz SCDONE1
  v_add_lshl_u32 v2, v188, v178, 2
  ds_write2st64_b32 v2, v148, v149 offset0:0 offset1:68
  v_cmpx_lt_i32 vcc, 1, v235
  s_cbranch_execz SCDONE1
  v_add_lshl_u32 v2, v189, v179, 2
  ds_write2st64_b32 v2, v150, v151 offset0:0 offset1:68
  v_cmpx_lt_i32 vcc, 8, v235
  s_cbranch_execz SCDONE1
  v_add_lshl_u32 v2, v190, v180, 2
  ds_write2st64_b32 v2, v152, v153 offset0:0 offset1:68
  v_cmpx_lt_i32 vcc, 9, v235
  s_cbranch_execz SCDONE1
  v_add_lshl_u32 v2, v191, v181, 2
  ds_write2st64_b32 v2, v154, v155 offset0:0 offset1:68
  v_cmpx_lt_i32 vcc, 16, v235
  s_cbranch_execz SCDONE1
  v_add_lshl_u32 v2, v192, v182, 2
  ds_write2st64_b32 v2, v156, v157 offset0:0 offset1:68
  v_cmpx_lt_i32 vcc, 17, v235
  s_cbranch_execz SCDONE1
  v_add_lshl_u32 v2, v193, v183, 2
  ds_write2st64_b32 v2, v158, v159 offset0:0 offset1:68
  v_cmpx_lt_i32 vcc, 24, v235
  s_cbranch_execz SCDONE1
  v_add_lshl_u32 v2, v194, v184, 2
  ds_write2st64_b32 v2, v160, v161 offset0:0 offset1:68
  v_cmpx_lt_i32 vcc, 25, v235
  s_cbranch_execz SCDONE1
  v_add_lshl_u32 v2, v195, v185, 2
  ds_write2st64_b32 v2, v162, v163 offset0:0 offset1:68
  v_cmpx_lt_i32 vcc, 32, v235
  s_cbranch_execz SCDONE1
  v_add_lshl_u32 v2, v196, v186, 2
  ds_write2st64_b32 v2, v164, v165 offset0:0 offset1:68
  v_cmpx_lt_i32 vcc, 33, v235
  s_cbranch_execz SCDONE1
  v_add_lshl_u32 v2, v197, v187, 2
  ds_write2st64_b32 v2, v166, v167 offset0:0 offset1:68
SCDONE1:
  s_mov_b64 exec, -1
  s_mul_i32 s3, s57, 2176
  v_lshrrev_b32 v2, 3, v0
  v_lshl_add_u32 v250, v2, 4, s3
  v_and_b32 v2, 31, v0
  v_lshl_add_u32 v251, v2, 2, s3
  v_bfe_u32 v2, v0, 2, 2
  v_lshl_add_u32 v2, v2, 4, s3
  v_lshl_add_u32 v252, v254, 2, v2
  v_add_u32 v2, s68, v0
  s_lshl_b32 s69, s59, 5
  v_lshl_add_u32 v3, v2, 2, s3
  s_sub_u32 s3, s58, s69
  v_add_u32 v4, s3, v2
  v_mov_b32 v5, 0xffff
  v_cmp_gt_u32 vcc, s69, v2
  s_nop 1
  v_cndmask_b32 v4, v4, v5, vcc
  v_or_b32 v4, 0xf8000000, v4
  v_mov_b32 v5, 0x00ffffff
  s_add_u32 s69, s69, 32
  v_cmpx_gt_u32 vcc, s69, v2
  ds_write2st64_b32 v3, v4, v5 offset0:0 offset1:68
  s_mov_b64 exec, -1
  s_waitcnt lgkmcnt(0)
  s_barrier
  ds_read_b128 v[224:227], v250 offset:0
  ds_read_b32 v232, v251 offset:0
  ds_read_b32 v1, v251 offset:17408
  s_cmp_gt_i32 s59, -1
  s_cselect_b32 s6, 6400000, 0
  s_cselect_b32 s10, 25600000, 0
  s_cselect_b32 s14, 300000, 0
  s_waitcnt lgkmcnt(0)
  v_mad_u32_u24 v1, v1, 32, v254
  buffer_load_dwordx4 v[216:219], v1, s[8:11], 0 offen
  s_add_u32 m0, s66, 0
  v_mad_u32_u24 v224, v224, s64, v237
  buffer_load_dwordx4 v224, s[4:7], 0 offen  lds
  s_add_u32 m0, s66, 1024
  v_mad_u32_u24 v225, v225, s64, v238
  buffer_load_dwordx4 v225, s[4:7], 0 offen  lds
  s_add_u32 m0, s66, 2048
  v_mad_u32_u24 v226, v226, s64, v239
  buffer_load_dwordx4 v226, s[4:7], 0 offen  lds
  s_add_u32 m0, s66, 3072
  v_mad_u32_u24 v227, v227, s64, v240
  buffer_load_dwordx4 v227, s[4:7], 0 offen  lds
  v_mul_u32_u24 v1, 6, v232
  v_and_b32 v1, -4, v1
  s_mov_b64 exec, s[74:75]
  buffer_load_dwordx2 v[228:229], v1, s[12:15], 0 offen
  s_mov_b64 exec, -1
  ds_read_b128 v[224:227], v250 offset:128
  ds_read_b32 v233, v251 offset:128
  ds_read_b32 v1, v251 offset:17536
  s_cmp_gt_i32 s59, 0
  s_cselect_b32 s6, 6400000, 0
  s_cselect_b32 s10, 25600000, 0
  s_cselect_b32 s14, 300000, 0
  s_waitcnt lgkmcnt(0)
  v_mad_u32_u24 v1, v1, 32, v254
  buffer_load_dwordx4 v[220:223], v1, s[8:11], 0 offen
  s_add_u32 m0, s66, 4096
  v_mad_u32_u24 v224, v224, s64, v237
  buffer_load_dwordx4 v224, s[4:7], 0 offen  lds
  s_add_u32 m0, s66, 5120
  v_mad_u32_u24 v225, v225, s64, v238
  buffer_load_dwordx4 v225, s[4:7], 0 offen  lds
  s_add_u32 m0, s66, 6144
  v_mad_u32_u24 v226, v226, s64, v239
  buffer_load_dwordx4 v226, s[4:7], 0 offen  lds
  s_add_u32 m0, s66, 7168
  v_mad_u32_u24 v227, v227, s64, v240
  buffer_load_dwordx4 v227, s[4:7], 0 offen  lds
  v_mul_u32_u24 v1, 6, v233
  v_and_b32 v1, -4, v1
  s_mov_b64 exec, s[74:75]
  buffer_load_dwordx2 v[230:231], v1, s[12:15], 0 offen
  s_mov_b64 exec, -1
  v_mov_b32 v184, 0
  v_mov_b32 v168, 0
  v_mov_b32 v185, 0
  v_mov_b32 v169, 0
  v_mov_b32 v186, 0
  v_mov_b32 v170, 0
  v_mov_b32 v187, 0
  v_mov_b32 v171, 0
  v_mov_b32 v188, 0
  v_mov_b32 v172, 0
  v_mov_b32 v189, 0
  v_mov_b32 v173, 0
  v_mov_b32 v190, 0
  v_mov_b32 v174, 0
  v_mov_b32 v191, 0
  v_mov_b32 v175, 0
  v_mov_b32 v124, 0
  v_mov_b32 v125, 0
  v_mov_b32 v126, 0
  v_mov_b32 v127, 0
  v_mov_b32 v13, 0
  v_mov_b32 v14, 0
  v_mov_b32 v15, 0
  s_mul_i32 s3, s57, 4608
  s_add_u32 s3, s3, 44544
  v_lshl_add_u32 v2, v0, 3, s3
  ds_write_b64 v2, v[184:185] offset:0
  ds_write_b64 v2, v[184:185] offset:512
  ds_write_b64 v2, v[184:185] offset:1024
  ds_write_b64 v2, v[184:185] offset:1536
  ds_write_b64 v2, v[184:185] offset:2048
  ds_write_b64 v2, v[184:185] offset:2560
  ds_write_b64 v2, v[184:185] offset:3072
  ds_write_b64 v2, v[184:185] offset:3584
  ds_write_b64 v2, v[184:185] offset:4096
  s_waitcnt vmcnt(6)
  ds_read_b128 v[200:203], v241 offset:0
  ds_read_b128 v[204:207], v242 offset:0
  ds_read_b128 v[208:211], v243 offset:0
  ds_read_b128 v[212:215], v244 offset:0
  v_add_u32_sdwa v253, v245, v232 dst_sel:DWORD dst_unused:UNUSED_PAD src0_sel:DWORD src1_sel:BYTE_3
  ds_read_b64 v[234:235], v253 offset:480
  ds_read_b32 v236, v253 offset:736
  v_lshlrev_b32 v125, 4, v232
  v_alignbit_b32 v126, v229, v228, v125
  v_lshrrev_b32 v127, v125, v229
  ds_read_b64 v[176:177], v253 offset:192
  ds_read_b64 v[178:179], v253 offset:128
  ds_read_b64 v[180:181], v253 offset:64
  ds_read_b32 v182, v253
  ds_read_b128 v[224:227], v250 offset:256
  ds_read_b32 v232, v251 offset:256
  ds_read_b32 v1, v251 offset:17664
  v_lshlrev_b32 v125, 16, v126
  v_and_b32 v126, s65, v126
  v_lshlrev_b32 v127, 16, v127
  s_waitcnt lgkmcnt(8)
  v_sub_f32 v234, v234, v125
  v_sub_f32 v235, v235, v126
  s_waitcnt lgkmcnt(7)
  v_sub_f32 v236, v236, v127
  v_cvt_pk_bf16_f32 v234, v234, v235
  v_cvt_pk_bf16_f32 v236, v236, v236
  v_lshlrev_b32 v10, 16, v234
  v_and_b32 v11, s65, v234
  v_lshlrev_b32 v12, 16, v236
  v_mul_f32 v234, v10, v10
  v_fmac_f32 v234, v11, v11
  v_fmac_f32 v234, v12, v12
  v_cvt_pk_f16_f32 v183, v234, v234
  v_mfma_f32_32x32x16_bf16 v[128:143], v[48:51], v[216:219], 0
  v_mfma_f32_32x32x16_bf16 v[144:159], v[52:55], v[216:219], 0
  v_mfma_f32_32x32x16_bf16 v[128:143], v[16:19], v[200:203], v[128:143]
  v_mfma_f32_32x32x16_bf16 v[128:143], v[20:23], v[204:207], v[128:143]
  v_mfma_f32_32x32x16_bf16 v[128:143], v[24:27], v[208:211], v[128:143]
  v_mfma_f32_32x32x16_bf16 v[128:143], v[28:31], v[212:215], v[128:143]
  s_waitcnt lgkmcnt(5)
  v_mfma_f32_32x32x16_f16 v[128:143], v[56:59], v[176:179], v[128:143]
  s_waitcnt lgkmcnt(3)
  v_mfma_f32_32x32x16_f16 v[128:143], v[60:63], v[180:183], v[128:143]
  s_cmp_gt_i32 s59, 1
  s_cselect_b32 s6, 6400000, 0
  s_cselect_b32 s10, 25600000, 0
  s_cselect_b32 s14, 300000, 0
  s_waitcnt lgkmcnt(0)
  v_mad_u32_u24 v1, v1, 32, v254
  buffer_load_dwordx4 v[216:219], v1, s[8:11], 0 offen
  s_add_u32 m0, s66, 0
  v_mad_u32_u24 v224, v224, s64, v237
  buffer_load_dwordx4 v224, s[4:7], 0 offen  lds
  s_add_u32 m0, s66, 1024
  v_mad_u32_u24 v225, v225, s64, v238
  buffer_load_dwordx4 v225, s[4:7], 0 offen  lds
  s_add_u32 m0, s66, 2048
  v_mad_u32_u24 v226, v226, s64, v239
  buffer_load_dwordx4 v226, s[4:7], 0 offen  lds
  s_add_u32 m0, s66, 3072
  v_mad_u32_u24 v227, v227, s64, v240
  buffer_load_dwordx4 v227, s[4:7], 0 offen  lds
  v_mul_u32_u24 v1, 6, v232
  v_and_b32 v1, -4, v1
  s_mov_b64 exec, s[74:75]
  buffer_load_dwordx2 v[228:229], v1, s[12:15], 0 offen
  s_mov_b64 exec, -1
  s_waitcnt lgkmcnt(0)
  s_cmp_eq_u32 s59, 0
  s_cbranch_scc1 LOOPEND
LOOP:
  ds_read_b64_tr_b16 v[192:193], v248 offset:64
  ds_read_b64_tr_b16 v[194:195], v248 offset:208
  ds_read_b64_tr_b16 v[196:197], v248 offset:352
  ds_read_b64_tr_b16 v[198:199], v248 offset:496
  v_cvt_pk_f16_f32 v160, v128, v129
  v_cvt_pk_f16_f32 v161, v130, v131
  v_cvt_pk_f16_f32 v162, v132, v133
  v_cvt_pk_f16_f32 v163, v134, v135
  v_cvt_pk_f16_f32 v164, v136, v137
  v_cvt_pk_f16_f32 v165, v138, v139
  v_cvt_pk_f16_f32 v166, v140, v141
  v_cvt_pk_f16_f32 v167, v142, v143
  v_mfma_f32_16x16x32_f16 v[124:127], v[80:83], v[168:171], v[124:127]
  v_exp_f16_sdwa v2, v160 dst_sel:WORD_0 dst_unused:UNUSED_PAD src0_sel:WORD_0
  v_exp_f16_sdwa v3, v161 dst_sel:WORD_0 dst_unused:UNUSED_PAD src0_sel:WORD_0
  v_mfma_f32_16x16x32_f16 v[124:127], v[84:87], v[172:175], v[124:127]
  v_exp_f16_sdwa v4, v162 dst_sel:WORD_0 dst_unused:UNUSED_PAD src0_sel:WORD_0
  v_exp_f16_sdwa v5, v163 dst_sel:WORD_0 dst_unused:UNUSED_PAD src0_sel:WORD_0
  v_mfma_f32_32x32x16_bf16 v[144:159], v[32:35], v[200:203], v[144:159]
  s_waitcnt vmcnt(6)
  ds_read_b128 v[200:203], v241 offset:4096
  v_exp_f16_sdwa v2, v160 dst_sel:WORD_1 dst_unused:UNUSED_PRESERVE src0_sel:WORD_1
  v_exp_f16_sdwa v3, v161 dst_sel:WORD_1 dst_unused:UNUSED_PRESERVE src0_sel:WORD_1
  v_exp_f16_sdwa v4, v162 dst_sel:WORD_1 dst_unused:UNUSED_PRESERVE src0_sel:WORD_1
  s_waitcnt lgkmcnt(3)
  v_mfma_f32_32x32x16_f16 v[104:119], v[192:195], v[184:187], v[104:119]
  v_exp_f16_sdwa v5, v163 dst_sel:WORD_1 dst_unused:UNUSED_PRESERVE src0_sel:WORD_1
  v_pk_add_f16 v2, v2, 1.0 op_sel_hi:[1,0]
  v_pk_add_f16 v3, v3, 1.0 op_sel_hi:[1,0]
  v_pk_add_f16 v4, v4, 1.0 op_sel_hi:[1,0]
  v_pk_add_f16 v5, v5, 1.0 op_sel_hi:[1,0]
  v_mul_f32 v234, v13, v124
  v_mul_f32 v235, v14, v124
  v_mul_f32 v236, v15, v124
  v_cvt_pk_f16_f32 v234, v234, v235
  v_cvt_pk_f16_f32 v235, v236, v236
  s_mov_b64 exec, s[74:75]
  ds_write_b64 v246, v[234:235] offset:128
  s_mov_b64 exec, -1
  v_rcp_f16_sdwa v6, v2 dst_sel:WORD_0 dst_unused:UNUSED_PAD src0_sel:WORD_0
  v_rcp_f16_sdwa v7, v3 dst_sel:WORD_0 dst_unused:UNUSED_PAD src0_sel:WORD_0
  s_waitcnt lgkmcnt(2)
  v_mfma_f32_32x32x16_f16 v[104:119], v[196:199], v[188:191], v[104:119]
  ds_read_b64_tr_b16 v[192:193], v249 offset:0
  ds_read_b64_tr_b16 v[194:195], v249 offset:144
  ds_read_b64_tr_b16 v[196:197], v249 offset:288
  ds_read_b64_tr_b16 v[198:199], v249 offset:432
  v_rcp_f16_sdwa v8, v4 dst_sel:WORD_0 dst_unused:UNUSED_PAD src0_sel:WORD_0
  v_rcp_f16_sdwa v9, v5 dst_sel:WORD_0 dst_unused:UNUSED_PAD src0_sel:WORD_0
  v_add_u32_sdwa v253, v245, v233 dst_sel:DWORD dst_unused:UNUSED_PAD src0_sel:DWORD src1_sel:BYTE_3
  ds_read_b64 v[234:235], v253 offset:480
  ds_read_b32 v236, v253 offset:736
  v_lshlrev_b32 v125, 4, v233
  v_alignbit_b32 v126, v231, v230, v125
  v_lshrrev_b32 v127, v125, v231
  v_rcp_f16_sdwa v6, v2 dst_sel:WORD_1 dst_unused:UNUSED_PRESERVE src0_sel:WORD_1
  v_mfma_f32_32x32x16_bf16 v[144:159], v[36:39], v[204:207], v[144:159]
  ds_read_b128 v[204:207], v242 offset:4096
  v_rcp_f16_sdwa v7, v3 dst_sel:WORD_1 dst_unused:UNUSED_PRESERVE src0_sel:WORD_1
  v_rcp_f16_sdwa v8, v4 dst_sel:WORD_1 dst_unused:UNUSED_PRESERVE src0_sel:WORD_1
  v_rcp_f16_sdwa v9, v5 dst_sel:WORD_1 dst_unused:UNUSED_PRESERVE src0_sel:WORD_1
  v_pk_mul_f16 v160, v160, v6
  v_pk_mul_f16 v161, v161, v7
  v_pk_mul_f16 v162, v162, v8
  v_pk_mul_f16 v163, v163, v9
  ds_write_b128 v246, v[160:163] offset:0
  v_mfma_f32_32x32x16_bf16 v[144:159], v[40:43], v[208:211], v[144:159]
  ds_read_b128 v[208:211], v243 offset:4096
  ds_read_b128 v[224:227], v250 offset:384
  ds_read_b32 v233, v251 offset:384
  ds_read_b32 v1, v251 offset:17792
  v_exp_f16_sdwa v2, v164 dst_sel:WORD_0 dst_unused:UNUSED_PAD src0_sel:WORD_0
  v_exp_f16_sdwa v3, v165 dst_sel:WORD_0 dst_unused:UNUSED_PAD src0_sel:WORD_0
  v_lshlrev_b32 v125, 16, v126
  v_and_b32 v126, s65, v126
  v_lshlrev_b32 v127, 16, v127
  v_exp_f16_sdwa v4, v166 dst_sel:WORD_0 dst_unused:UNUSED_PAD src0_sel:WORD_0
  v_mfma_f32_32x32x16_bf16 v[144:159], v[44:47], v[212:215], v[144:159]
  ds_read_b128 v[212:215], v244 offset:4096
  v_exp_f16_sdwa v5, v167 dst_sel:WORD_0 dst_unused:UNUSED_PAD src0_sel:WORD_0
  v_exp_f16_sdwa v2, v164 dst_sel:WORD_1 dst_unused:UNUSED_PRESERVE src0_sel:WORD_1
  v_exp_f16_sdwa v3, v165 dst_sel:WORD_1 dst_unused:UNUSED_PRESERVE src0_sel:WORD_1
  v_mfma_f32_32x32x16_f16 v[144:159], v[64:67], v[176:179], v[144:159]
  v_exp_f16_sdwa v4, v166 dst_sel:WORD_1 dst_unused:UNUSED_PRESERVE src0_sel:WORD_1
  s_waitcnt lgkmcnt(8)
  v_sub_f32 v234, v234, v125
  v_sub_f32 v235, v235, v126
  s_waitcnt lgkmcnt(7)
  v_sub_f32 v236, v236, v127
  v_cvt_pk_bf16_f32 v234, v234, v235
  v_cvt_pk_bf16_f32 v236, v236, v236
  v_lshlrev_b32 v13, 16, v234
  v_and_b32 v14, s65, v234
  v_lshlrev_b32 v15, 16, v236
  v_exp_f16_sdwa v5, v167 dst_sel:WORD_1 dst_unused:UNUSED_PRESERVE src0_sel:WORD_1
  v_pk_add_f16 v2, v2, 1.0 op_sel_hi:[1,0]
  v_pk_add_f16 v3, v3, 1.0 op_sel_hi:[1,0]
  v_pk_add_f16 v4, v4, 1.0 op_sel_hi:[1,0]
  v_pk_add_f16 v5, v5, 1.0 op_sel_hi:[1,0]
  v_rcp_f16_sdwa v6, v2 dst_sel:WORD_0 dst_unused:UNUSED_PAD src0_sel:WORD_0
  v_mfma_f32_32x32x16_f16 v[144:159], v[68:71], v[180:183], v[144:159]
  ds_read_b64 v[176:177], v253 offset:192
  ds_read_b64 v[178:179], v253 offset:128
  ds_read_b64 v[180:181], v253 offset:64
  ds_read_b32 v182, v253
  v_rcp_f16_sdwa v7, v3 dst_sel:WORD_0 dst_unused:UNUSED_PAD src0_sel:WORD_0
  v_rcp_f16_sdwa v8, v4 dst_sel:WORD_0 dst_unused:UNUSED_PAD src0_sel:WORD_0
  v_rcp_f16_sdwa v9, v5 dst_sel:WORD_0 dst_unused:UNUSED_PAD src0_sel:WORD_0
  v_mfma_f32_16x16x32_f16 v[120:123], v[192:195], v[184:187], v[120:123]
  v_rcp_f16_sdwa v6, v2 dst_sel:WORD_1 dst_unused:UNUSED_PRESERVE src0_sel:WORD_1
  v_rcp_f16_sdwa v7, v3 dst_sel:WORD_1 dst_unused:UNUSED_PRESERVE src0_sel:WORD_1
  v_mfma_f32_16x16x32_f16 v[120:123], v[196:199], v[188:191], v[120:123]
  ds_read_b128 v[184:187], v252 offset:0
  v_rcp_f16_sdwa v8, v4 dst_sel:WORD_1 dst_unused:UNUSED_PRESERVE src0_sel:WORD_1
  v_rcp_f16_sdwa v9, v5 dst_sel:WORD_1 dst_unused:UNUSED_PRESERVE src0_sel:WORD_1
  v_pk_mul_f16 v164, v164, v6
  v_pk_mul_f16 v165, v165, v7
  v_pk_mul_f16 v166, v166, v8
  v_pk_mul_f16 v167, v167, v9
  ds_write_b128 v246, v[164:167] offset:16
  ds_read_b64_tr_b16 v[192:193], v248 offset:0
  ds_read_b64_tr_b16 v[194:195], v248 offset:144
  ds_read_b64_tr_b16 v[196:197], v248 offset:288
  ds_read_b64_tr_b16 v[198:199], v248 offset:432
  v_cvt_pk_f16_f32 v168, v144, v145
  v_cvt_pk_f16_f32 v169, v146, v147
  v_cvt_pk_f16_f32 v170, v148, v149
  v_cvt_pk_f16_f32 v171, v150, v151
  v_cvt_pk_f16_f32 v172, v152, v153
  v_cvt_pk_f16_f32 v173, v154, v155
  v_cvt_pk_f16_f32 v174, v156, v157
  v_cvt_pk_f16_f32 v175, v158, v159
  v_mfma_f32_32x32x16_bf16 v[128:143], v[48:51], v[220:223], 0
  v_exp_f16_sdwa v2, v168 dst_sel:WORD_0 dst_unused:UNUSED_PAD src0_sel:WORD_0
  v_exp_f16_sdwa v3, v169 dst_sel:WORD_0 dst_unused:UNUSED_PAD src0_sel:WORD_0
  v_exp_f16_sdwa v4, v170 dst_sel:WORD_0 dst_unused:UNUSED_PAD src0_sel:WORD_0
  v_mfma_f32_32x32x16_bf16 v[144:159], v[52:55], v[220:223], 0
  s_cmp_gt_i32 s59, 2
  s_cselect_b32 s6, 6400000, 0
  s_cselect_b32 s10, 25600000, 0
  s_cselect_b32 s14, 300000, 0
  s_waitcnt lgkmcnt(11)
  v_mad_u32_u24 v1, v1, 32, v254
  buffer_load_dwordx4 v[220:223], v1, s[8:11], 0 offen
  v_exp_f16_sdwa v5, v171 dst_sel:WORD_0 dst_unused:UNUSED_PAD src0_sel:WORD_0
  v_exp_f16_sdwa v2, v168 dst_sel:WORD_1 dst_unused:UNUSED_PRESERVE src0_sel:WORD_1
  v_mfma_f32_32x32x16_bf16 v[128:143], v[16:19], v[200:203], v[128:143]
  s_add_u32 m0, s66, 4096
  v_mad_u32_u24 v224, v224, s64, v237
  s_waitcnt lgkmcnt(10)
  buffer_load_dwordx4 v224, s[4:7], 0 offen  lds
  v_exp_f16_sdwa v3, v169 dst_sel:WORD_1 dst_unused:UNUSED_PRESERVE src0_sel:WORD_1
  v_exp_f16_sdwa v4, v170 dst_sel:WORD_1 dst_unused:UNUSED_PRESERVE src0_sel:WORD_1
  s_waitcnt lgkmcnt(5)
  v_add_u32_sdwa v184, v247, v184 dst_sel:DWORD dst_unused:UNUSED_PAD src0_sel:DWORD src1_sel:BYTE_3
  v_add_u32_sdwa v185, v247, v185 dst_sel:DWORD dst_unused:UNUSED_PAD src0_sel:DWORD src1_sel:BYTE_3
  v_add_u32_sdwa v186, v247, v186 dst_sel:DWORD dst_unused:UNUSED_PAD src0_sel:DWORD src1_sel:BYTE_3
  v_add_u32_sdwa v187, v247, v187 dst_sel:DWORD dst_unused:UNUSED_PAD src0_sel:DWORD src1_sel:BYTE_3
  ds_read_b64_tr_b16 v[190:191], v187
  ds_read_b64_tr_b16 v[188:189], v186
  ds_read_b64_tr_b16 v[186:187], v185
  ds_read_b64_tr_b16 v[184:185], v184
  v_exp_f16_sdwa v5, v171 dst_sel:WORD_1 dst_unused:UNUSED_PRESERVE src0_sel:WORD_1
  v_pk_add_f16 v2, v2, 1.0 op_sel_hi:[1,0]
  v_pk_add_f16 v3, v3, 1.0 op_sel_hi:[1,0]
  v_pk_add_f16 v4, v4, 1.0 op_sel_hi:[1,0]
  v_pk_add_f16 v5, v5, 1.0 op_sel_hi:[1,0]
  v_mfma_f32_32x32x16_bf16 v[128:143], v[20:23], v[204:207], v[128:143]
  s_add_u32 m0, s66, 5120
  v_mad_u32_u24 v225, v225, s64, v238
  buffer_load_dwordx4 v225, s[4:7], 0 offen  lds
  v_rcp_f16_sdwa v6, v2 dst_sel:WORD_0 dst_unused:UNUSED_PAD src0_sel:WORD_0
  v_rcp_f16_sdwa v7, v3 dst_sel:WORD_0 dst_unused:UNUSED_PAD src0_sel:WORD_0
  v_rcp_f16_sdwa v8, v4 dst_sel:WORD_0 dst_unused:UNUSED_PAD src0_sel:WORD_0
  v_mfma_f32_32x32x16_bf16 v[128:143], v[24:27], v[208:211], v[128:143]
  s_add_u32 m0, s66, 6144
  v_mad_u32_u24 v226, v226, s64, v239
  buffer_load_dwordx4 v226, s[4:7], 0 offen  lds
  v_rcp_f16_sdwa v9, v5 dst_sel:WORD_0 dst_unused:UNUSED_PAD src0_sel:WORD_0
  v_rcp_f16_sdwa v6, v2 dst_sel:WORD_1 dst_unused:UNUSED_PRESERVE src0_sel:WORD_1
  v_mfma_f32_32x32x16_bf16 v[128:143], v[28:31], v[212:215], v[128:143]
  s_add_u32 m0, s66, 7168
  v_mad_u32_u24 v227, v227, s64, v240
  buffer_load_dwordx4 v227, s[4:7], 0 offen  lds
  v_rcp_f16_sdwa v7, v3 dst_sel:WORD_1 dst_unused:UNUSED_PRESERVE src0_sel:WORD_1
  v_rcp_f16_sdwa v8, v4 dst_sel:WORD_1 dst_unused:UNUSED_PRESERVE src0_sel:WORD_1
  v_mul_f32 v234, v13, v13
  v_fmac_f32 v234, v14, v14
  v_fmac_f32 v234, v15, v15
  v_cvt_pk_f16_f32 v183, v234, v234
  v_rcp_f16_sdwa v9, v5 dst_sel:WORD_1 dst_unused:UNUSED_PRESERVE src0_sel:WORD_1
  v_pk_mul_f16 v168, v168, v6
  v_pk_mul_f16 v169, v169, v7
  v_pk_mul_f16 v170, v170, v8
  v_pk_mul_f16 v171, v171, v9
  ds_write_b128 v246, v[168:171] offset:64
  v_mfma_f32_16x16x32_f16 v[124:127], v[72:75], v[160:163], 0
  v_exp_f16_sdwa v2, v172 dst_sel:WORD_0 dst_unused:UNUSED_PAD src0_sel:WORD_0
  v_mul_u32_u24 v1, 6, v233
  v_and_b32 v1, -4, v1
  s_mov_b64 exec, s[74:75]
  buffer_load_dwordx2 v[230:231], v1, s[12:15], 0 offen
  s_mov_b64 exec, -1
  v_exp_f16_sdwa v3, v173 dst_sel:WORD_0 dst_unused:UNUSED_PAD src0_sel:WORD_0
  v_mfma_f32_16x16x32_f16 v[124:127], v[76:79], v[164:167], v[124:127]
  v_exp_f16_sdwa v4, v174 dst_sel:WORD_0 dst_unused:UNUSED_PAD src0_sel:WORD_0
  v_exp_f16_sdwa v5, v175 dst_sel:WORD_0 dst_unused:UNUSED_PAD src0_sel:WORD_0
  v_mfma_f32_32x32x16_f16 v[128:143], v[56:59], v[176:179], v[128:143]
  v_exp_f16_sdwa v2, v172 dst_sel:WORD_1 dst_unused:UNUSED_PRESERVE src0_sel:WORD_1
  v_exp_f16_sdwa v3, v173 dst_sel:WORD_1 dst_unused:UNUSED_PRESERVE src0_sel:WORD_1
  v_exp_f16_sdwa v4, v174 dst_sel:WORD_1 dst_unused:UNUSED_PRESERVE src0_sel:WORD_1
  v_mfma_f32_32x32x16_f16 v[128:143], v[60:63], v[180:183], v[128:143]
  v_exp_f16_sdwa v5, v175 dst_sel:WORD_1 dst_unused:UNUSED_PRESERVE src0_sel:WORD_1
  v_pk_add_f16 v2, v2, 1.0 op_sel_hi:[1,0]
  v_pk_add_f16 v3, v3, 1.0 op_sel_hi:[1,0]
  v_pk_add_f16 v4, v4, 1.0 op_sel_hi:[1,0]
  v_pk_add_f16 v5, v5, 1.0 op_sel_hi:[1,0]
  v_rcp_f16_sdwa v6, v2 dst_sel:WORD_0 dst_unused:UNUSED_PAD src0_sel:WORD_0
  v_rcp_f16_sdwa v7, v3 dst_sel:WORD_0 dst_unused:UNUSED_PAD src0_sel:WORD_0
  s_waitcnt lgkmcnt(1)
  v_mfma_f32_32x32x16_f16 v[88:103], v[192:195], v[184:187], v[88:103]
  v_rcp_f16_sdwa v8, v4 dst_sel:WORD_0 dst_unused:UNUSED_PAD src0_sel:WORD_0
  v_rcp_f16_sdwa v9, v5 dst_sel:WORD_0 dst_unused:UNUSED_PAD src0_sel:WORD_0
  v_rcp_f16_sdwa v6, v2 dst_sel:WORD_1 dst_unused:UNUSED_PRESERVE src0_sel:WORD_1
  v_mfma_f32_32x32x16_f16 v[88:103], v[196:199], v[188:191], v[88:103]
  v_rcp_f16_sdwa v7, v3 dst_sel:WORD_1 dst_unused:UNUSED_PRESERVE src0_sel:WORD_1
  v_rcp_f16_sdwa v8, v4 dst_sel:WORD_1 dst_unused:UNUSED_PRESERVE src0_sel:WORD_1
  v_rcp_f16_sdwa v9, v5 dst_sel:WORD_1 dst_unused:UNUSED_PRESERVE src0_sel:WORD_1
  v_pk_mul_f16 v172, v172, v6
  v_pk_mul_f16 v173, v173, v7
  v_pk_mul_f16 v174, v174, v8
  v_pk_mul_f16 v175, v175, v9
  ds_write_b128 v246, v[172:175] offset:80
  s_sub_u32 s59, s59, 1
  s_cmp_eq_u32 s59, 0
  s_cbranch_scc1 TAIL0
  ds_read_b64_tr_b16 v[192:193], v248 offset:64
  ds_read_b64_tr_b16 v[194:195], v248 offset:208
  ds_read_b64_tr_b16 v[196:197], v248 offset:352
  ds_read_b64_tr_b16 v[198:199], v248 offset:496
  v_cvt_pk_f16_f32 v160, v128, v129
  v_cvt_pk_f16_f32 v161, v130, v131
  v_cvt_pk_f16_f32 v162, v132, v133
  v_cvt_pk_f16_f32 v163, v134, v135
  v_cvt_pk_f16_f32 v164, v136, v137
  v_cvt_pk_f16_f32 v165, v138, v139
  v_cvt_pk_f16_f32 v166, v140, v141
  v_cvt_pk_f16_f32 v167, v142, v143
  v_mfma_f32_16x16x32_f16 v[124:127], v[80:83], v[168:171], v[124:127]
  v_exp_f16_sdwa v2, v160 dst_sel:WORD_0 dst_unused:UNUSED_PAD src0_sel:WORD_0
  v_exp_f16_sdwa v3, v161 dst_sel:WORD_0 dst_unused:UNUSED_PAD src0_sel:WORD_0
  v_mfma_f32_16x16x32_f16 v[124:127], v[84:87], v[172:175], v[124:127]
  v_exp_f16_sdwa v4, v162 dst_sel:WORD_0 dst_unused:UNUSED_PAD src0_sel:WORD_0
  v_exp_f16_sdwa v5, v163 dst_sel:WORD_0 dst_unused:UNUSED_PAD src0_sel:WORD_0
  v_mfma_f32_32x32x16_bf16 v[144:159], v[32:35], v[200:203], v[144:159]
  s_waitcnt vmcnt(6)
  ds_read_b128 v[200:203], v241 offset:0
  v_exp_f16_sdwa v2, v160 dst_sel:WORD_1 dst_unused:UNUSED_PRESERVE src0_sel:WORD_1
  v_exp_f16_sdwa v3, v161 dst_sel:WORD_1 dst_unused:UNUSED_PRESERVE src0_sel:WORD_1
  v_exp_f16_sdwa v4, v162 dst_sel:WORD_1 dst_unused:UNUSED_PRESERVE src0_sel:WORD_1
  s_waitcnt lgkmcnt(3)
  v_mfma_f32_32x32x16_f16 v[104:119], v[192:195], v[184:187], v[104:119]
  v_exp_f16_sdwa v5, v163 dst_sel:WORD_1 dst_unused:UNUSED_PRESERVE src0_sel:WORD_1
  v_pk_add_f16 v2, v2, 1.0 op_sel_hi:[1,0]
  v_pk_add_f16 v3, v3, 1.0 op_sel_hi:[1,0]
  v_pk_add_f16 v4, v4, 1.0 op_sel_hi:[1,0]
  v_pk_add_f16 v5, v5, 1.0 op_sel_hi:[1,0]
  v_mul_f32 v234, v10, v124
  v_mul_f32 v235, v11, v124
  v_mul_f32 v236, v12, v124
  v_cvt_pk_f16_f32 v234, v234, v235
  v_cvt_pk_f16_f32 v235, v236, v236
  s_mov_b64 exec, s[74:75]
  ds_write_b64 v246, v[234:235] offset:128
  s_mov_b64 exec, -1
  v_rcp_f16_sdwa v6, v2 dst_sel:WORD_0 dst_unused:UNUSED_PAD src0_sel:WORD_0
  v_rcp_f16_sdwa v7, v3 dst_sel:WORD_0 dst_unused:UNUSED_PAD src0_sel:WORD_0
  s_waitcnt lgkmcnt(2)
  v_mfma_f32_32x32x16_f16 v[104:119], v[196:199], v[188:191], v[104:119]
  ds_read_b64_tr_b16 v[192:193], v249 offset:0
  ds_read_b64_tr_b16 v[194:195], v249 offset:144
  ds_read_b64_tr_b16 v[196:197], v249 offset:288
  ds_read_b64_tr_b16 v[198:199], v249 offset:432
  v_rcp_f16_sdwa v8, v4 dst_sel:WORD_0 dst_unused:UNUSED_PAD src0_sel:WORD_0
  v_rcp_f16_sdwa v9, v5 dst_sel:WORD_0 dst_unused:UNUSED_PAD src0_sel:WORD_0
  v_add_u32_sdwa v253, v245, v232 dst_sel:DWORD dst_unused:UNUSED_PAD src0_sel:DWORD src1_sel:BYTE_3
  ds_read_b64 v[234:235], v253 offset:480
  ds_read_b32 v236, v253 offset:736
  v_lshlrev_b32 v125, 4, v232
  v_alignbit_b32 v126, v229, v228, v125
  v_lshrrev_b32 v127, v125, v229
  v_rcp_f16_sdwa v6, v2 dst_sel:WORD_1 dst_unused:UNUSED_PRESERVE src0_sel:WORD_1
  v_mfma_f32_32x32x16_bf16 v[144:159], v[36:39], v[204:207], v[144:159]
  ds_read_b128 v[204:207], v242 offset:0
  v_rcp_f16_sdwa v7, v3 dst_sel:WORD_1 dst_unused:UNUSED_PRESERVE src0_sel:WORD_1
  v_rcp_f16_sdwa v8, v4 dst_sel:WORD_1 dst_unused:UNUSED_PRESERVE src0_sel:WORD_1
  v_rcp_f16_sdwa v9, v5 dst_sel:WORD_1 dst_unused:UNUSED_PRESERVE src0_sel:WORD_1
  v_pk_mul_f16 v160, v160, v6
  v_pk_mul_f16 v161, v161, v7
  v_pk_mul_f16 v162, v162, v8
  v_pk_mul_f16 v163, v163, v9
  ds_write_b128 v246, v[160:163] offset:0
  v_mfma_f32_32x32x16_bf16 v[144:159], v[40:43], v[208:211], v[144:159]
  ds_read_b128 v[208:211], v243 offset:0
  ds_read_b128 v[224:227], v250 offset:512
  ds_read_b32 v232, v251 offset:512
  ds_read_b32 v1, v251 offset:17920
  v_exp_f16_sdwa v2, v164 dst_sel:WORD_0 dst_unused:UNUSED_PAD src0_sel:WORD_0
  v_exp_f16_sdwa v3, v165 dst_sel:WORD_0 dst_unused:UNUSED_PAD src0_sel:WORD_0
  v_lshlrev_b32 v125, 16, v126
  v_and_b32 v126, s65, v126
  v_lshlrev_b32 v127, 16, v127
  v_exp_f16_sdwa v4, v166 dst_sel:WORD_0 dst_unused:UNUSED_PAD src0_sel:WORD_0
  v_mfma_f32_32x32x16_bf16 v[144:159], v[44:47], v[212:215], v[144:159]
  ds_read_b128 v[212:215], v244 offset:0
  v_exp_f16_sdwa v5, v167 dst_sel:WORD_0 dst_unused:UNUSED_PAD src0_sel:WORD_0
  v_exp_f16_sdwa v2, v164 dst_sel:WORD_1 dst_unused:UNUSED_PRESERVE src0_sel:WORD_1
  v_exp_f16_sdwa v3, v165 dst_sel:WORD_1 dst_unused:UNUSED_PRESERVE src0_sel:WORD_1
  v_mfma_f32_32x32x16_f16 v[144:159], v[64:67], v[176:179], v[144:159]
  v_exp_f16_sdwa v4, v166 dst_sel:WORD_1 dst_unused:UNUSED_PRESERVE src0_sel:WORD_1
  s_waitcnt lgkmcnt(8)
  v_sub_f32 v234, v234, v125
  v_sub_f32 v235, v235, v126
  s_waitcnt lgkmcnt(7)
  v_sub_f32 v236, v236, v127
  v_cvt_pk_bf16_f32 v234, v234, v235
  v_cvt_pk_bf16_f32 v236, v236, v236
  v_lshlrev_b32 v10, 16, v234
  v_and_b32 v11, s65, v234
  v_lshlrev_b32 v12, 16, v236
  v_exp_f16_sdwa v5, v167 dst_sel:WORD_1 dst_unused:UNUSED_PRESERVE src0_sel:WORD_1
  v_pk_add_f16 v2, v2, 1.0 op_sel_hi:[1,0]
  v_pk_add_f16 v3, v3, 1.0 op_sel_hi:[1,0]
  v_pk_add_f16 v4, v4, 1.0 op_sel_hi:[1,0]
  v_pk_add_f16 v5, v5, 1.0 op_sel_hi:[1,0]
  v_rcp_f16_sdwa v6, v2 dst_sel:WORD_0 dst_unused:UNUSED_PAD src0_sel:WORD_0
  v_mfma_f32_32x32x16_f16 v[144:159], v[68:71], v[180:183], v[144:159]
  ds_read_b64 v[176:177], v253 offset:192
  ds_read_b64 v[178:179], v253 offset:128
  ds_read_b64 v[180:181], v253 offset:64
  ds_read_b32 v182, v253
  v_rcp_f16_sdwa v7, v3 dst_sel:WORD_0 dst_unused:UNUSED_PAD src0_sel:WORD_0
  v_rcp_f16_sdwa v8, v4 dst_sel:WORD_0 dst_unused:UNUSED_PAD src0_sel:WORD_0
  v_rcp_f16_sdwa v9, v5 dst_sel:WORD_0 dst_unused:UNUSED_PAD src0_sel:WORD_0
  v_mfma_f32_16x16x32_f16 v[120:123], v[192:195], v[184:187], v[120:123]
  v_rcp_f16_sdwa v6, v2 dst_sel:WORD_1 dst_unused:UNUSED_PRESERVE src0_sel:WORD_1
  v_rcp_f16_sdwa v7, v3 dst_sel:WORD_1 dst_unused:UNUSED_PRESERVE src0_sel:WORD_1
  v_mfma_f32_16x16x32_f16 v[120:123], v[196:199], v[188:191], v[120:123]
  ds_read_b128 v[184:187], v252 offset:128
  v_rcp_f16_sdwa v8, v4 dst_sel:WORD_1 dst_unused:UNUSED_PRESERVE src0_sel:WORD_1
  v_rcp_f16_sdwa v9, v5 dst_sel:WORD_1 dst_unused:UNUSED_PRESERVE src0_sel:WORD_1
  v_pk_mul_f16 v164, v164, v6
  v_pk_mul_f16 v165, v165, v7
  v_pk_mul_f16 v166, v166, v8
  v_pk_mul_f16 v167, v167, v9
  ds_write_b128 v246, v[164:167] offset:16
  ds_read_b64_tr_b16 v[192:193], v248 offset:0
  ds_read_b64_tr_b16 v[194:195], v248 offset:144
  ds_read_b64_tr_b16 v[196:197], v248 offset:288
  ds_read_b64_tr_b16 v[198:199], v248 offset:432
  v_cvt_pk_f16_f32 v168, v144, v145
  v_cvt_pk_f16_f32 v169, v146, v147
  v_cvt_pk_f16_f32 v170, v148, v149
  v_cvt_pk_f16_f32 v171, v150, v151
  v_cvt_pk_f16_f32 v172, v152, v153
  v_cvt_pk_f16_f32 v173, v154, v155
  v_cvt_pk_f16_f32 v174, v156, v157
  v_cvt_pk_f16_f32 v175, v158, v159
  v_mfma_f32_32x32x16_bf16 v[128:143], v[48:51], v[216:219], 0
  v_exp_f16_sdwa v2, v168 dst_sel:WORD_0 dst_unused:UNUSED_PAD src0_sel:WORD_0
  v_exp_f16_sdwa v3, v169 dst_sel:WORD_0 dst_unused:UNUSED_PAD src0_sel:WORD_0
  v_exp_f16_sdwa v4, v170 dst_sel:WORD_0 dst_unused:UNUSED_PAD src0_sel:WORD_0
  v_mfma_f32_32x32x16_bf16 v[144:159], v[52:55], v[216:219], 0
  s_cmp_gt_i32 s59, 2
  s_cselect_b32 s6, 6400000, 0
  s_cselect_b32 s10, 25600000, 0
  s_cselect_b32 s14, 300000, 0
  s_waitcnt lgkmcnt(11)
  v_mad_u32_u24 v1, v1, 32, v254
  buffer_load_dwordx4 v[216:219], v1, s[8:11], 0 offen
  v_exp_f16_sdwa v5, v171 dst_sel:WORD_0 dst_unused:UNUSED_PAD src0_sel:WORD_0
  v_exp_f16_sdwa v2, v168 dst_sel:WORD_1 dst_unused:UNUSED_PRESERVE src0_sel:WORD_1
  v_mfma_f32_32x32x16_bf16 v[128:143], v[16:19], v[200:203], v[128:143]
  s_add_u32 m0, s66, 0
  v_mad_u32_u24 v224, v224, s64, v237
  s_waitcnt lgkmcnt(10)
  buffer_load_dwordx4 v224, s[4:7], 0 offen  lds
  v_exp_f16_sdwa v3, v169 dst_sel:WORD_1 dst_unused:UNUSED_PRESERVE src0_sel:WORD_1
  v_exp_f16_sdwa v4, v170 dst_sel:WORD_1 dst_unused:UNUSED_PRESERVE src0_sel:WORD_1
  s_waitcnt lgkmcnt(5)
  v_add_u32_sdwa v184, v247, v184 dst_sel:DWORD dst_unused:UNUSED_PAD src0_sel:DWORD src1_sel:BYTE_3
  v_add_u32_sdwa v185, v247, v185 dst_sel:DWORD dst_unused:UNUSED_PAD src0_sel:DWORD src1_sel:BYTE_3
  v_add_u32_sdwa v186, v247, v186 dst_sel:DWORD dst_unused:UNUSED_PAD src0_sel:DWORD src1_sel:BYTE_3
  v_add_u32_sdwa v187, v247, v187 dst_sel:DWORD dst_unused:UNUSED_PAD src0_sel:DWORD src1_sel:BYTE_3
  ds_read_b64_tr_b16 v[190:191], v187
  ds_read_b64_tr_b16 v[188:189], v186
  ds_read_b64_tr_b16 v[186:187], v185
  ds_read_b64_tr_b16 v[184:185], v184
  v_exp_f16_sdwa v5, v171 dst_sel:WORD_1 dst_unused:UNUSED_PRESERVE src0_sel:WORD_1
  v_pk_add_f16 v2, v2, 1.0 op_sel_hi:[1,0]
  v_pk_add_f16 v3, v3, 1.0 op_sel_hi:[1,0]
  v_pk_add_f16 v4, v4, 1.0 op_sel_hi:[1,0]
  v_pk_add_f16 v5, v5, 1.0 op_sel_hi:[1,0]
  v_mfma_f32_32x32x16_bf16 v[128:143], v[20:23], v[204:207], v[128:143]
  s_add_u32 m0, s66, 1024
  v_mad_u32_u24 v225, v225, s64, v238
  buffer_load_dwordx4 v225, s[4:7], 0 offen  lds
  v_rcp_f16_sdwa v6, v2 dst_sel:WORD_0 dst_unused:UNUSED_PAD src0_sel:WORD_0
  v_rcp_f16_sdwa v7, v3 dst_sel:WORD_0 dst_unused:UNUSED_PAD src0_sel:WORD_0
  v_rcp_f16_sdwa v8, v4 dst_sel:WORD_0 dst_unused:UNUSED_PAD src0_sel:WORD_0
  v_mfma_f32_32x32x16_bf16 v[128:143], v[24:27], v[208:211], v[128:143]
  s_add_u32 m0, s66, 2048
  v_mad_u32_u24 v226, v226, s64, v239
  buffer_load_dwordx4 v226, s[4:7], 0 offen  lds
  v_rcp_f16_sdwa v9, v5 dst_sel:WORD_0 dst_unused:UNUSED_PAD src0_sel:WORD_0
  v_rcp_f16_sdwa v6, v2 dst_sel:WORD_1 dst_unused:UNUSED_PRESERVE src0_sel:WORD_1
  v_mfma_f32_32x32x16_bf16 v[128:143], v[28:31], v[212:215], v[128:143]
  s_add_u32 m0, s66, 3072
  v_mad_u32_u24 v227, v227, s64, v240
  buffer_load_dwordx4 v227, s[4:7], 0 offen  lds
  v_rcp_f16_sdwa v7, v3 dst_sel:WORD_1 dst_unused:UNUSED_PRESERVE src0_sel:WORD_1
  v_rcp_f16_sdwa v8, v4 dst_sel:WORD_1 dst_unused:UNUSED_PRESERVE src0_sel:WORD_1
  v_mul_f32 v234, v10, v10
  v_fmac_f32 v234, v11, v11
  v_fmac_f32 v234, v12, v12
  v_cvt_pk_f16_f32 v183, v234, v234
  v_rcp_f16_sdwa v9, v5 dst_sel:WORD_1 dst_unused:UNUSED_PRESERVE src0_sel:WORD_1
  v_pk_mul_f16 v168, v168, v6
  v_pk_mul_f16 v169, v169, v7
  v_pk_mul_f16 v170, v170, v8
  v_pk_mul_f16 v171, v171, v9
  ds_write_b128 v246, v[168:171] offset:64
  v_mfma_f32_16x16x32_f16 v[124:127], v[72:75], v[160:163], 0
  v_exp_f16_sdwa v2, v172 dst_sel:WORD_0 dst_unused:UNUSED_PAD src0_sel:WORD_0
  v_mul_u32_u24 v1, 6, v232
  v_and_b32 v1, -4, v1
  s_mov_b64 exec, s[74:75]
  buffer_load_dwordx2 v[228:229], v1, s[12:15], 0 offen
  s_mov_b64 exec, -1
  v_exp_f16_sdwa v3, v173 dst_sel:WORD_0 dst_unused:UNUSED_PAD src0_sel:WORD_0
  v_mfma_f32_16x16x32_f16 v[124:127], v[76:79], v[164:167], v[124:127]
  v_exp_f16_sdwa v4, v174 dst_sel:WORD_0 dst_unused:UNUSED_PAD src0_sel:WORD_0
  v_exp_f16_sdwa v5, v175 dst_sel:WORD_0 dst_unused:UNUSED_PAD src0_sel:WORD_0
  v_mfma_f32_32x32x16_f16 v[128:143], v[56:59], v[176:179], v[128:143]
  v_exp_f16_sdwa v2, v172 dst_sel:WORD_1 dst_unused:UNUSED_PRESERVE src0_sel:WORD_1
  v_exp_f16_sdwa v3, v173 dst_sel:WORD_1 dst_unused:UNUSED_PRESERVE src0_sel:WORD_1
  v_exp_f16_sdwa v4, v174 dst_sel:WORD_1 dst_unused:UNUSED_PRESERVE src0_sel:WORD_1
  v_mfma_f32_32x32x16_f16 v[128:143], v[60:63], v[180:183], v[128:143]
  v_exp_f16_sdwa v5, v175 dst_sel:WORD_1 dst_unused:UNUSED_PRESERVE src0_sel:WORD_1
  v_pk_add_f16 v2, v2, 1.0 op_sel_hi:[1,0]
  v_pk_add_f16 v3, v3, 1.0 op_sel_hi:[1,0]
  v_pk_add_f16 v4, v4, 1.0 op_sel_hi:[1,0]
  v_pk_add_f16 v5, v5, 1.0 op_sel_hi:[1,0]
  v_rcp_f16_sdwa v6, v2 dst_sel:WORD_0 dst_unused:UNUSED_PAD src0_sel:WORD_0
  v_rcp_f16_sdwa v7, v3 dst_sel:WORD_0 dst_unused:UNUSED_PAD src0_sel:WORD_0
  s_waitcnt lgkmcnt(1)
  v_mfma_f32_32x32x16_f16 v[88:103], v[192:195], v[184:187], v[88:103]
  v_rcp_f16_sdwa v8, v4 dst_sel:WORD_0 dst_unused:UNUSED_PAD src0_sel:WORD_0
  v_rcp_f16_sdwa v9, v5 dst_sel:WORD_0 dst_unused:UNUSED_PAD src0_sel:WORD_0
  v_rcp_f16_sdwa v6, v2 dst_sel:WORD_1 dst_unused:UNUSED_PRESERVE src0_sel:WORD_1
  v_mfma_f32_32x32x16_f16 v[88:103], v[196:199], v[188:191], v[88:103]
  v_rcp_f16_sdwa v7, v3 dst_sel:WORD_1 dst_unused:UNUSED_PRESERVE src0_sel:WORD_1
  v_rcp_f16_sdwa v8, v4 dst_sel:WORD_1 dst_unused:UNUSED_PRESERVE src0_sel:WORD_1
  v_rcp_f16_sdwa v9, v5 dst_sel:WORD_1 dst_unused:UNUSED_PRESERVE src0_sel:WORD_1
  v_pk_mul_f16 v172, v172, v6
  v_pk_mul_f16 v173, v173, v7
  v_pk_mul_f16 v174, v174, v8
  v_pk_mul_f16 v175, v175, v9
  ds_write_b128 v246, v[172:175] offset:80
  s_sub_u32 s59, s59, 1
  s_cmp_eq_u32 s59, 0
  v_add_u32 v250, 0x100, v250
  v_add_u32 v251, 0x100, v251
  v_add_u32 v252, 0x100, v252
  s_cbranch_scc0 LOOP
  v_mov_b32 v10, v13
  v_mov_b32 v11, v14
  v_mov_b32 v12, v15
TAIL0:
  s_waitcnt lgkmcnt(0)
  ds_read_b64_tr_b16 v[192:193], v248 offset:64
  ds_read_b64_tr_b16 v[194:195], v248 offset:208
  ds_read_b64_tr_b16 v[196:197], v248 offset:352
  ds_read_b64_tr_b16 v[198:199], v248 offset:496
  v_mfma_f32_16x16x32_f16 v[124:127], v[80:83], v[168:171], v[124:127]
  v_mfma_f32_16x16x32_f16 v[124:127], v[84:87], v[172:175], v[124:127]
  s_waitcnt lgkmcnt(2)
  v_mfma_f32_32x32x16_f16 v[104:119], v[192:195], v[184:187], v[104:119]
  s_waitcnt lgkmcnt(0)
  v_mfma_f32_32x32x16_f16 v[104:119], v[196:199], v[188:191], v[104:119]
  s_nop 3
  v_mul_f32 v234, v10, v124
  v_mul_f32 v235, v11, v124
  v_mul_f32 v236, v12, v124
  v_cvt_pk_f16_f32 v234, v234, v235
  v_cvt_pk_f16_f32 v235, v236, v236
  s_mov_b64 exec, s[74:75]
  ds_write_b64 v246, v[234:235] offset:128
  s_mov_b64 exec, -1
  ds_read_b64_tr_b16 v[192:193], v249 offset:0
  ds_read_b64_tr_b16 v[194:195], v249 offset:144
  ds_read_b64_tr_b16 v[196:197], v249 offset:288
  ds_read_b64_tr_b16 v[198:199], v249 offset:432
  s_waitcnt lgkmcnt(2)
  v_mfma_f32_16x16x32_f16 v[120:123], v[192:195], v[184:187], v[120:123]
  s_waitcnt lgkmcnt(0)
  v_mfma_f32_16x16x32_f16 v[120:123], v[196:199], v[188:191], v[120:123]
LOOPEND:
  s_cmp_eq_u32 s62, 0
  s_cbranch_scc1 EPI
  s_add_u32 s61, s61, s60
  s_waitcnt vmcnt(0)
  s_barrier
  s_branch ROUND
EPI:
  v_and_b32 v2, 1, v0
  v_bfe_u32 v3, v0, 1, 1
  v_bfe_u32 v4, v0, 2, 2
  v_bfe_u32 v5, v0, 4, 1
  v_lshlrev_b32 v2, 6, v2
  v_lshl_add_u32 v2, v3, 3, v2
  v_lshl_add_u32 v2, v5, 4, v2
  v_lshrrev_b32 v3, 1, v4
  v_lshl_add_u32 v2, v3, 5, v2
  v_lshl_add_u32 v2, v4, 7, v2
  v_add_u32 v2, 146944, v2
  v_lshl_add_u32 v6, v254, 8, v2
  v_xor_b32 v7, 32, v6
  v_lshl_add_u32 v8, v254, 6, v2
  v_xor_b32 v9, 32, v8
  ds_read_b64_tr_b16 v[16:17], v6 offset:0
  ds_read_b64_tr_b16 v[18:19], v6 offset:512
  ds_read_b64_tr_b16 v[20:21], v6 offset:1024
  ds_read_b64_tr_b16 v[22:23], v6 offset:1536
  ds_read_b64_tr_b16 v[24:25], v6 offset:2048
  ds_read_b64_tr_b16 v[26:27], v6 offset:2560
  ds_read_b64_tr_b16 v[28:29], v6 offset:3072
  ds_read_b64_tr_b16 v[30:31], v6 offset:3584
  ds_read_b64_tr_b16 v[32:33], v8 offset:8192
  ds_read_b64_tr_b16 v[34:35], v8 offset:10240
  ds_read_b64_tr_b16 v[36:37], v8 offset:8704
  ds_read_b64_tr_b16 v[38:39], v8 offset:10752
  ds_read_b64_tr_b16 v[40:41], v8 offset:12288
  ds_read_b64_tr_b16 v[42:43], v8 offset:14336
  ds_read_b64_tr_b16 v[44:45], v8 offset:12800
  ds_read_b64_tr_b16 v[46:47], v8 offset:14848
  s_waitcnt lgkmcnt(0)
  ds_read_b64_tr_b16 v[48:49], v7 offset:0
  ds_read_b64_tr_b16 v[50:51], v7 offset:512
  ds_read_b64_tr_b16 v[52:53], v7 offset:1024
  ds_read_b64_tr_b16 v[54:55], v7 offset:1536
  ds_read_b64_tr_b16 v[56:57], v7 offset:2048
  ds_read_b64_tr_b16 v[58:59], v7 offset:2560
  ds_read_b64_tr_b16 v[60:61], v7 offset:3072
  ds_read_b64_tr_b16 v[62:63], v7 offset:3584
  ds_read_b64_tr_b16 v[64:65], v9 offset:8192
  ds_read_b64_tr_b16 v[66:67], v9 offset:10240
  ds_read_b64_tr_b16 v[68:69], v9 offset:8704
  ds_read_b64_tr_b16 v[70:71], v9 offset:10752
  ds_read_b64_tr_b16 v[72:73], v9 offset:12288
  ds_read_b64_tr_b16 v[74:75], v9 offset:14336
  ds_read_b64_tr_b16 v[76:77], v9 offset:12800
  ds_read_b64_tr_b16 v[78:79], v9 offset:14848
  v_lshl_add_u32 v253, v0, 3, s67
  ds_read_b64 v[224:225], v253 offset:512
  ds_read_b32 v226, v253 offset:768
  s_mov_b32 s68, 0xbf317218
  s_mov_b32 s69, 0xbf317218
  v_pk_mul_f32 v[88:89], v[88:89], s[68:69]
  v_pk_mul_f32 v[90:91], v[90:91], s[68:69]
  v_pk_mul_f32 v[92:93], v[92:93], s[68:69]
  v_pk_mul_f32 v[94:95], v[94:95], s[68:69]
  v_pk_mul_f32 v[96:97], v[96:97], s[68:69]
  v_pk_mul_f32 v[98:99], v[98:99], s[68:69]
  v_pk_mul_f32 v[100:101], v[100:101], s[68:69]
  v_pk_mul_f32 v[102:103], v[102:103], s[68:69]
  v_pk_mul_f32 v[104:105], v[104:105], s[68:69]
  v_pk_mul_f32 v[106:107], v[106:107], s[68:69]
  v_pk_mul_f32 v[108:109], v[108:109], s[68:69]
  v_pk_mul_f32 v[110:111], v[110:111], s[68:69]
  v_pk_mul_f32 v[112:113], v[112:113], s[68:69]
  v_pk_mul_f32 v[114:115], v[114:115], s[68:69]
  v_pk_mul_f32 v[116:117], v[116:117], s[68:69]
  v_pk_mul_f32 v[118:119], v[118:119], s[68:69]
  v_pk_mul_f32 v[120:121], v[120:121], s[68:69]
  v_pk_mul_f32 v[122:123], v[122:123], s[68:69]
  v_cvt_pk_bf16_f32 v160, v88, v89
  v_cvt_pk_bf16_f32 v161, v90, v91
  v_cvt_pk_bf16_f32 v162, v92, v93
  v_cvt_pk_bf16_f32 v163, v94, v95
  v_cvt_pk_bf16_f32 v164, v96, v97
  v_cvt_pk_bf16_f32 v165, v98, v99
  v_cvt_pk_bf16_f32 v166, v100, v101
  v_cvt_pk_bf16_f32 v167, v102, v103
  v_cvt_pk_bf16_f32 v168, v104, v105
  v_cvt_pk_bf16_f32 v169, v106, v107
  v_cvt_pk_bf16_f32 v170, v108, v109
  v_cvt_pk_bf16_f32 v171, v110, v111
  v_cvt_pk_bf16_f32 v172, v112, v113
  v_cvt_pk_bf16_f32 v173, v114, v115
  v_cvt_pk_bf16_f32 v174, v116, v117
  v_cvt_pk_bf16_f32 v175, v118, v119
  v_mfma_f32_32x32x16_bf16 v[128:143], v[16:19], v[200:203], 0
  v_mfma_f32_32x32x16_bf16 v[128:143], v[20:23], v[204:207], v[128:143]
  v_mfma_f32_32x32x16_bf16 v[128:143], v[24:27], v[208:211], v[128:143]
  v_mfma_f32_32x32x16_bf16 v[128:143], v[28:31], v[212:215], v[128:143]
  v_mfma_f32_32x32x16_bf16 v[128:143], v[32:35], v[160:163], v[128:143]
  v_mfma_f32_32x32x16_bf16 v[128:143], v[36:39], v[164:167], v[128:143]
  v_mfma_f32_32x32x16_bf16 v[128:143], v[40:43], v[168:171], v[128:143]
  v_mfma_f32_32x32x16_bf16 v[128:143], v[44:47], v[172:175], v[128:143]
  s_waitcnt lgkmcnt(0)
  v_mfma_f32_32x32x16_bf16 v[144:159], v[48:51], v[200:203], 0
  v_mfma_f32_32x32x16_bf16 v[144:159], v[52:55], v[204:207], v[144:159]
  v_mfma_f32_32x32x16_bf16 v[144:159], v[56:59], v[208:211], v[144:159]
  v_mfma_f32_32x32x16_bf16 v[144:159], v[60:63], v[212:215], v[144:159]
  v_mfma_f32_32x32x16_bf16 v[144:159], v[64:67], v[160:163], v[144:159]
  v_mfma_f32_32x32x16_bf16 v[144:159], v[68:71], v[164:167], v[144:159]
  v_mfma_f32_32x32x16_bf16 v[144:159], v[72:75], v[168:171], v[144:159]
  v_mfma_f32_32x32x16_bf16 v[144:159], v[76:79], v[172:175], v[144:159]
  v_add_f32 v224, v224, v120
  v_add_f32 v225, v225, v121
  v_add_f32 v226, v226, v122
  v_cvt_pk_bf16_f32 v224, v224, v225
  v_cvt_pk_bf16_f32 v226, v226, v226
  v_add_u32 v234, s58, v0
  v_mul_u32_u24 v234, 6, v234
  v_add_u32 v234, 6400000, v234
  s_mov_b64 exec, 0x1ffffff
  buffer_store_short v224, v234, s[28:31], 0 offen
  buffer_store_short_d16_hi v224, v234, s[28:31], 0 offen offset:2
  buffer_store_short v226, v234, s[28:31], 0 offen offset:4
  s_mov_b64 exec, -1
  v_and_b32 v235, 31, v0
  v_add_u32 v235, s58, v235
  v_lshlrev_b32 v235, 7, v235
  v_lshl_add_u32 v235, v254, 2, v235
  s_mov_b32 s68, 0x1ffffff
  s_mov_b32 s69, 0x1ffffff
  v_pk_mul_f32 v[2:3], v[128:129], s[70:71]
  v_pk_mul_f32 v[4:5], v[130:131], s[70:71]
  v_pk_mul_f32 v[6:7], v[132:133], s[70:71]
  v_pk_mul_f32 v[8:9], v[134:135], s[70:71]
  v_exp_f32 v2, v2
  v_exp_f32 v3, v3
  v_exp_f32 v4, v4
  v_exp_f32 v5, v5
  v_exp_f32 v6, v6
  v_exp_f32 v7, v7
  v_exp_f32 v8, v8
  v_exp_f32 v9, v9
  v_pk_add_f32 v[2:3], v[2:3], s[72:73]
  v_pk_add_f32 v[4:5], v[4:5], s[72:73]
  v_pk_add_f32 v[6:7], v[6:7], s[72:73]
  v_pk_add_f32 v[8:9], v[8:9], s[72:73]
  v_rcp_f32 v2, v2
  v_rcp_f32 v3, v3
  v_rcp_f32 v4, v4
  v_rcp_f32 v5, v5
  v_rcp_f32 v6, v6
  v_rcp_f32 v7, v7
  v_rcp_f32 v8, v8
  v_rcp_f32 v9, v9
  v_pk_mul_f32 v[2:3], v[2:3], v[128:129]
  v_pk_mul_f32 v[4:5], v[4:5], v[130:131]
  v_pk_mul_f32 v[6:7], v[6:7], v[132:133]
  v_pk_mul_f32 v[8:9], v[8:9], v[134:135]
  v_cvt_pk_bf16_f32 v176, v2, v3
  v_cvt_pk_bf16_f32 v177, v4, v5
  v_cvt_pk_bf16_f32 v178, v6, v7
  v_cvt_pk_bf16_f32 v179, v8, v9
  v_lshlrev_b32 v2, 16, v176
  v_and_b32 v3, s65, v176
  v_lshlrev_b32 v4, 16, v200
  v_and_b32 v5, s65, v200
  v_pk_add_f32 v[2:3], v[2:3], v[4:5]
  v_cvt_pk_bf16_f32 v160, v2, v3
  v_lshlrev_b32 v2, 16, v177
  v_and_b32 v3, s65, v177
  v_lshlrev_b32 v4, 16, v201
  v_and_b32 v5, s65, v201
  v_pk_add_f32 v[2:3], v[2:3], v[4:5]
  v_cvt_pk_bf16_f32 v161, v2, v3
  v_lshlrev_b32 v2, 16, v178
  v_and_b32 v3, s65, v178
  v_lshlrev_b32 v4, 16, v202
  v_and_b32 v5, s65, v202
  v_pk_add_f32 v[2:3], v[2:3], v[4:5]
  v_cvt_pk_bf16_f32 v162, v2, v3
  v_lshlrev_b32 v2, 16, v179
  v_and_b32 v3, s65, v179
  v_lshlrev_b32 v4, 16, v203
  v_and_b32 v5, s65, v203
  v_pk_add_f32 v[2:3], v[2:3], v[4:5]
  v_cvt_pk_bf16_f32 v163, v2, v3
  s_mov_b64 exec, s[68:69]
  buffer_store_dwordx4 v[160:163], v235, s[28:31], 0 offen offset:0
  s_mov_b64 exec, -1
  v_pk_mul_f32 v[2:3], v[136:137], s[70:71]
  v_pk_mul_f32 v[4:5], v[138:139], s[70:71]
  v_pk_mul_f32 v[6:7], v[140:141], s[70:71]
  v_pk_mul_f32 v[8:9], v[142:143], s[70:71]
  v_exp_f32 v2, v2
  v_exp_f32 v3, v3
  v_exp_f32 v4, v4
  v_exp_f32 v5, v5
  v_exp_f32 v6, v6
  v_exp_f32 v7, v7
  v_exp_f32 v8, v8
  v_exp_f32 v9, v9
  v_pk_add_f32 v[2:3], v[2:3], s[72:73]
  v_pk_add_f32 v[4:5], v[4:5], s[72:73]
  v_pk_add_f32 v[6:7], v[6:7], s[72:73]
  v_pk_add_f32 v[8:9], v[8:9], s[72:73]
  v_rcp_f32 v2, v2
  v_rcp_f32 v3, v3
  v_rcp_f32 v4, v4
  v_rcp_f32 v5, v5
  v_rcp_f32 v6, v6
  v_rcp_f32 v7, v7
  v_rcp_f32 v8, v8
  v_rcp_f32 v9, v9
  v_pk_mul_f32 v[2:3], v[2:3], v[136:137]
  v_pk_mul_f32 v[4:5], v[4:5], v[138:139]
  v_pk_mul_f32 v[6:7], v[6:7], v[140:141]
  v_pk_mul_f32 v[8:9], v[8:9], v[142:143]
  v_cvt_pk_bf16_f32 v176, v2, v3
  v_cvt_pk_bf16_f32 v177, v4, v5
  v_cvt_pk_bf16_f32 v178, v6, v7
  v_cvt_pk_bf16_f32 v179, v8, v9
  v_lshlrev_b32 v2, 16, v176
  v_and_b32 v3, s65, v176
  v_lshlrev_b32 v4, 16, v204
  v_and_b32 v5, s65, v204
  v_pk_add_f32 v[2:3], v[2:3], v[4:5]
  v_cvt_pk_bf16_f32 v164, v2, v3
  v_lshlrev_b32 v2, 16, v177
  v_and_b32 v3, s65, v177
  v_lshlrev_b32 v4, 16, v205
  v_and_b32 v5, s65, v205
  v_pk_add_f32 v[2:3], v[2:3], v[4:5]
  v_cvt_pk_bf16_f32 v165, v2, v3
  v_lshlrev_b32 v2, 16, v178
  v_and_b32 v3, s65, v178
  v_lshlrev_b32 v4, 16, v206
  v_and_b32 v5, s65, v206
  v_pk_add_f32 v[2:3], v[2:3], v[4:5]
  v_cvt_pk_bf16_f32 v166, v2, v3
  v_lshlrev_b32 v2, 16, v179
  v_and_b32 v3, s65, v179
  v_lshlrev_b32 v4, 16, v207
  v_and_b32 v5, s65, v207
  v_pk_add_f32 v[2:3], v[2:3], v[4:5]
  v_cvt_pk_bf16_f32 v167, v2, v3
  s_mov_b64 exec, s[68:69]
  buffer_store_dwordx4 v[164:167], v235, s[28:31], 0 offen offset:16
  s_mov_b64 exec, -1
  v_pk_mul_f32 v[2:3], v[144:145], s[70:71]
  v_pk_mul_f32 v[4:5], v[146:147], s[70:71]
  v_pk_mul_f32 v[6:7], v[148:149], s[70:71]
  v_pk_mul_f32 v[8:9], v[150:151], s[70:71]
  v_exp_f32 v2, v2
  v_exp_f32 v3, v3
  v_exp_f32 v4, v4
  v_exp_f32 v5, v5
  v_exp_f32 v6, v6
  v_exp_f32 v7, v7
  v_exp_f32 v8, v8
  v_exp_f32 v9, v9
  v_pk_add_f32 v[2:3], v[2:3], s[72:73]
  v_pk_add_f32 v[4:5], v[4:5], s[72:73]
  v_pk_add_f32 v[6:7], v[6:7], s[72:73]
  v_pk_add_f32 v[8:9], v[8:9], s[72:73]
  v_rcp_f32 v2, v2
  v_rcp_f32 v3, v3
  v_rcp_f32 v4, v4
  v_rcp_f32 v5, v5
  v_rcp_f32 v6, v6
  v_rcp_f32 v7, v7
  v_rcp_f32 v8, v8
  v_rcp_f32 v9, v9
  v_pk_mul_f32 v[2:3], v[2:3], v[144:145]
  v_pk_mul_f32 v[4:5], v[4:5], v[146:147]
  v_pk_mul_f32 v[6:7], v[6:7], v[148:149]
  v_pk_mul_f32 v[8:9], v[8:9], v[150:151]
  v_cvt_pk_bf16_f32 v176, v2, v3
  v_cvt_pk_bf16_f32 v177, v4, v5
  v_cvt_pk_bf16_f32 v178, v6, v7
  v_cvt_pk_bf16_f32 v179, v8, v9
  v_lshlrev_b32 v2, 16, v176
  v_and_b32 v3, s65, v176
  v_lshlrev_b32 v4, 16, v208
  v_and_b32 v5, s65, v208
  v_pk_add_f32 v[2:3], v[2:3], v[4:5]
  v_cvt_pk_bf16_f32 v168, v2, v3
  v_lshlrev_b32 v2, 16, v177
  v_and_b32 v3, s65, v177
  v_lshlrev_b32 v4, 16, v209
  v_and_b32 v5, s65, v209
  v_pk_add_f32 v[2:3], v[2:3], v[4:5]
  v_cvt_pk_bf16_f32 v169, v2, v3
  v_lshlrev_b32 v2, 16, v178
  v_and_b32 v3, s65, v178
  v_lshlrev_b32 v4, 16, v210
  v_and_b32 v5, s65, v210
  v_pk_add_f32 v[2:3], v[2:3], v[4:5]
  v_cvt_pk_bf16_f32 v170, v2, v3
  v_lshlrev_b32 v2, 16, v179
  v_and_b32 v3, s65, v179
  v_lshlrev_b32 v4, 16, v211
  v_and_b32 v5, s65, v211
  v_pk_add_f32 v[2:3], v[2:3], v[4:5]
  v_cvt_pk_bf16_f32 v171, v2, v3
  s_mov_b64 exec, s[68:69]
  buffer_store_dwordx4 v[168:171], v235, s[28:31], 0 offen offset:32
  s_mov_b64 exec, -1
  v_pk_mul_f32 v[2:3], v[152:153], s[70:71]
  v_pk_mul_f32 v[4:5], v[154:155], s[70:71]
  v_pk_mul_f32 v[6:7], v[156:157], s[70:71]
  v_pk_mul_f32 v[8:9], v[158:159], s[70:71]
  v_exp_f32 v2, v2
  v_exp_f32 v3, v3
  v_exp_f32 v4, v4
  v_exp_f32 v5, v5
  v_exp_f32 v6, v6
  v_exp_f32 v7, v7
  v_exp_f32 v8, v8
  v_exp_f32 v9, v9
  v_pk_add_f32 v[2:3], v[2:3], s[72:73]
  v_pk_add_f32 v[4:5], v[4:5], s[72:73]
  v_pk_add_f32 v[6:7], v[6:7], s[72:73]
  v_pk_add_f32 v[8:9], v[8:9], s[72:73]
  v_rcp_f32 v2, v2
  v_rcp_f32 v3, v3
  v_rcp_f32 v4, v4
  v_rcp_f32 v5, v5
  v_rcp_f32 v6, v6
  v_rcp_f32 v7, v7
  v_rcp_f32 v8, v8
  v_rcp_f32 v9, v9
  v_pk_mul_f32 v[2:3], v[2:3], v[152:153]
  v_pk_mul_f32 v[4:5], v[4:5], v[154:155]
  v_pk_mul_f32 v[6:7], v[6:7], v[156:157]
  v_pk_mul_f32 v[8:9], v[8:9], v[158:159]
  v_cvt_pk_bf16_f32 v176, v2, v3
  v_cvt_pk_bf16_f32 v177, v4, v5
  v_cvt_pk_bf16_f32 v178, v6, v7
  v_cvt_pk_bf16_f32 v179, v8, v9
  v_lshlrev_b32 v2, 16, v176
  v_and_b32 v3, s65, v176
  v_lshlrev_b32 v4, 16, v212
  v_and_b32 v5, s65, v212
  v_pk_add_f32 v[2:3], v[2:3], v[4:5]
  v_cvt_pk_bf16_f32 v172, v2, v3
  v_lshlrev_b32 v2, 16, v177
  v_and_b32 v3, s65, v177
  v_lshlrev_b32 v4, 16, v213
  v_and_b32 v5, s65, v213
  v_pk_add_f32 v[2:3], v[2:3], v[4:5]
  v_cvt_pk_bf16_f32 v173, v2, v3
  v_lshlrev_b32 v2, 16, v178
  v_and_b32 v3, s65, v178
  v_lshlrev_b32 v4, 16, v214
  v_and_b32 v5, s65, v214
  v_pk_add_f32 v[2:3], v[2:3], v[4:5]
  v_cvt_pk_bf16_f32 v174, v2, v3
  v_lshlrev_b32 v2, 16, v179
  v_and_b32 v3, s65, v179
  v_lshlrev_b32 v4, 16, v215
  v_and_b32 v5, s65, v215
  v_pk_add_f32 v[2:3], v[2:3], v[4:5]
  v_cvt_pk_bf16_f32 v175, v2, v3
  s_mov_b64 exec, s[68:69]
  buffer_store_dwordx4 v[172:175], v235, s[28:31], 0 offen offset:48
  s_mov_b64 exec, -1
  s_waitcnt vmcnt(0)
K2END:
  s_endpgm
.section .rodata,"a"
.p2align 6
.amdhsa_kernel part_kernel
  .amdhsa_next_free_vgpr 56
  .amdhsa_next_free_sgpr 96
  .amdhsa_accum_offset 56
  .amdhsa_group_segment_fixed_size 0
  .amdhsa_kernarg_size 88
  .amdhsa_user_sgpr_count 2
  .amdhsa_user_sgpr_kernarg_segment_ptr 1
  .amdhsa_system_sgpr_workgroup_id_x 1
.end_amdhsa_kernel
.p2align 6
.amdhsa_kernel main_kernel
  .amdhsa_next_free_vgpr 256
  .amdhsa_next_free_sgpr 96
  .amdhsa_accum_offset 256
  .amdhsa_group_segment_fixed_size 0
  .amdhsa_kernarg_size 88
  .amdhsa_user_sgpr_count 2
  .amdhsa_user_sgpr_kernarg_segment_ptr 1
  .amdhsa_system_sgpr_workgroup_id_x 1
.end_amdhsa_kernel
```

```asm
; @launch kernel=part_kernel grid=(251,1,1) block=(640,1,1) lds=60416
; @launch kernel=main_kernel grid=(256,1,1) block=(512,1,1) lds=163328
.amdgcn_target "amdgcn-amd-amdhsa--gfx950"
.text
.globl part_kernel
.p2align 8
.type part_kernel,@function
part_kernel:
  s_cmp_gt_u32 s2, 250
  s_cbranch_scc1 K1END
  s_load_dwordx2 s[8:9], s[0:1], 80
  s_cmp_eq_u32 s2, 250
  s_cbranch_scc1 WPREP
  s_load_dwordx4 s[4:7], s[0:1], 24
  s_load_dwordx2 s[32:33], s[0:1], 0
  s_mul_i32 s3, s2, 12800
  v_lshlrev_b32 v2, 4, v0
  v_lshlrev_b32 v3, 2, v0
  v_add_u32 v3, 10240, v3
  v_and_b32 v1, 255, v0
  v_lshlrev_b32 v1, 2, v1
  v_mov_b32 v20, 0
  v_mov_b32 v21, 0
  v_mov_b32 v22, 0
  v_mov_b32 v23, 0
  s_waitcnt lgkmcnt(0)
  s_mov_b32 s12, s4
  s_mov_b32 s13, s5
  s_mov_b32 s14, 3200000
  s_mov_b32 s15, 0x20000
  s_mov_b32 s16, s6
  s_mov_b32 s17, s7
  s_mov_b32 s18, 3200000
  s_mov_b32 s19, 0x20000
  buffer_load_dwordx4 v[4:7], v2, s[16:19], s3 offen
  buffer_load_dword v8, v3, s[16:19], s3 offen
  buffer_load_dwordx4 v[12:15], v2, s[12:15], s3 offen
  buffer_load_dword v16, v3, s[12:15], s3 offen
  ds_write_b32 v1, v20 offset:58368
  ds_write_b128 v2, v[20:23] offset:0
  ds_write_b128 v2, v[20:23] offset:10240
  ds_write_b128 v2, v[20:23] offset:20480
  ds_write_b128 v2, v[20:23] offset:30720
  s_mov_b32 s20, s8
  s_mov_b32 s21, s9
  s_mov_b32 s22, 8192000
  s_mov_b32 s23, 0x20000
  s_add_u32 s24, s8, 8388608
  s_addc_u32 s25, s9, 0
  s_mov_b32 s26, 6400000
  s_mov_b32 s27, 0x20000
  s_mov_b32 s28, 175921861
  s_movk_i32 s29, 3125
  s_mul_i32 s30, s2, 3200
  s_or_b32 s30, s30, 0x80000000
  v_mov_b32 v50, 1
  v_mov_b32 v49, 127
  v_lshl_add_u32 v51, v0, 2, s30
  s_add_u32 s30, s30, 2560
  v_add_u32 v52, s30, v0
  v_readfirstlane_b32 s31, v0
  s_waitcnt lgkmcnt(0)
  s_barrier
  s_waitcnt vmcnt(2)
  v_mul_hi_u32 v37, s28, v4
  v_lshrrev_b32 v20, 1, v37
  v_and_b32 v20, 0x3fc, v20
  ds_add_rtn_u32 v28, v20, v50 offset:58368
  v_mul_hi_u32 v39, s28, v5
  v_lshrrev_b32 v21, 1, v39
  v_and_b32 v21, 0x3fc, v21
  ds_add_rtn_u32 v29, v21, v50 offset:58368
  v_mul_hi_u32 v41, s28, v6
  v_lshrrev_b32 v22, 1, v41
  v_and_b32 v22, 0x3fc, v22
  ds_add_rtn_u32 v30, v22, v50 offset:58368
  v_mul_hi_u32 v43, s28, v7
  v_lshrrev_b32 v23, 1, v43
  v_and_b32 v23, 0x3fc, v23
  ds_add_rtn_u32 v31, v23, v50 offset:58368
  v_mul_hi_u32 v45, s28, v8
  v_lshrrev_b32 v24, 1, v45
  v_and_b32 v24, 0x3fc, v24
  ds_add_rtn_u32 v32, v24, v50 offset:58368
  v_mad_u32_u24 v36, v37, s29, v49
  v_lshrrev_b32 v36, 7, v36
  v_sub_u32 v4, v4, v36
  v_and_b32 v37, 7, v37
  v_mad_u32_u24 v38, v39, s29, v49
  v_lshrrev_b32 v38, 7, v38
  v_sub_u32 v5, v5, v38
  v_and_b32 v39, 7, v39
  v_mad_u32_u24 v40, v41, s29, v49
  v_lshrrev_b32 v40, 7, v40
  v_sub_u32 v6, v6, v40
  v_and_b32 v41, 7, v41
  v_mad_u32_u24 v42, v43, s29, v49
  v_lshrrev_b32 v42, 7, v42
  v_sub_u32 v7, v7, v42
  v_and_b32 v43, 7, v43
  v_mad_u32_u24 v44, v45, s29, v49
  v_lshrrev_b32 v44, 7, v44
  v_sub_u32 v8, v8, v44
  v_and_b32 v45, 7, v45
  s_waitcnt vmcnt(0)
  v_lshl_or_b32 v36, v4, 27, v12
  v_lshrrev_b32 v12, 12, v12
  v_lshl_or_b32 v37, v37, 4, v12
  v_lshl_or_b32 v37, v37, 24, v51
  v_lshl_or_b32 v38, v5, 27, v13
  v_lshrrev_b32 v13, 12, v13
  v_lshl_or_b32 v39, v39, 4, v13
  v_add_u32 v51, 1, v51
  v_lshl_or_b32 v39, v39, 24, v51
  v_lshl_or_b32 v40, v6, 27, v14
  v_lshrrev_b32 v14, 12, v14
  v_lshl_or_b32 v41, v41, 4, v14
  v_add_u32 v51, 1, v51
  v_lshl_or_b32 v41, v41, 24, v51
  v_lshl_or_b32 v42, v7, 27, v15
  v_lshrrev_b32 v15, 12, v15
  v_lshl_or_b32 v43, v43, 4, v15
  v_add_u32 v51, 1, v51
  v_lshl_or_b32 v43, v43, 24, v51
  v_lshl_or_b32 v44, v8, 27, v16
  v_lshrrev_b32 v16, 12, v16
  v_lshl_or_b32 v45, v45, 4, v16
  v_lshl_or_b32 v45, v45, 24, v52
  v_and_b32 v1, 63, v0
  v_lshlrev_b32 v3, 9, v1
  v_lshlrev_b32 v1, 4, v1
  v_mov_b32 v48, 0x100ff1
  v_mov_b32 v49, 0xf0ff1
  s_waitcnt lgkmcnt(0)
  s_barrier
  ds_read_b128 v[4:7], v1 offset:58368
  s_waitcnt lgkmcnt(0)
  v_cmp_lt_u32 s[40:41], 16, v4
  v_subrev_u32 v4, 15, v4
  v_cmp_lt_u32 s[42:43], 16, v5
  v_subrev_u32 v5, 15, v5
  v_cmp_lt_u32 s[44:45], 16, v6
  v_subrev_u32 v6, 15, v6
  v_cmp_lt_u32 s[46:47], 16, v7
  v_subrev_u32 v7, 15, v7
  v_cndmask_b32 v4, 0, v4, s[40:41]
  v_cndmask_b32 v5, 0, v5, s[42:43]
  v_cndmask_b32 v6, 0, v6, s[44:45]
  v_cndmask_b32 v7, 0, v7, s[46:47]
  v_add_u32 v8, v4, v5
  v_add_u32 v9, v8, v6
  v_add_u32 v10, v9, v7
  v_mov_b32 v11, v10
  s_nop 1
  v_add_u32_dpp v11, v11, v11 row_shr:1 row_mask:0xf bank_mask:0xf
  s_nop 1
  v_add_u32_dpp v11, v11, v11 row_shr:2 row_mask:0xf bank_mask:0xf
  s_nop 1
  v_add_u32_dpp v11, v11, v11 row_shr:4 row_mask:0xf bank_mask:0xf
  s_nop 1
  v_add_u32_dpp v11, v11, v11 row_shr:8 row_mask:0xf bank_mask:0xf
  s_nop 1
  v_add_u32_dpp v11, v11, v11 row_bcast:15 row_mask:0xa bank_mask:0xf
  s_nop 1
  v_add_u32_dpp v11, v11, v11 row_bcast:31 row_mask:0xc bank_mask:0xf
  v_cndmask_b32 v16, v48, v49, s[40:41]
  v_cndmask_b32 v17, v48, v49, s[42:43]
  v_cndmask_b32 v18, v48, v49, s[44:45]
  v_cndmask_b32 v19, v48, v49, s[46:47]
  v_sub_u32 v12, v11, v10
  v_add_u32 v13, v12, v4
  v_add_u32 v14, v12, v8
  v_add_u32 v15, v12, v9
  v_readlane_b32 s33, v11, 63
  v_add_u32 v16, v16, v12
  v_add_u32 v17, v17, v13
  v_add_u32 v18, v18, v14
  v_add_u32 v19, v19, v15
  ds_write_b128 v1, v[16:19] offset:59392
  ds_read_b32 v17, v20 offset:59392
  ds_read_b32 v18, v21 offset:59392
  ds_read_b32 v19, v22 offset:59392
  ds_read_b32 v25, v23 offset:59392
  ds_read_b32 v26, v24 offset:59392
  s_cmp_ge_u32 s31, 64
  s_cbranch_scc1 K1NOPTR
  v_lshl_or_b32 v4, v4, 16, v12
  s_mov_b64 exec, s[40:41]
  ds_write_b32 v3, v4 offset:120
  s_mov_b64 exec, -1
  v_lshl_or_b32 v5, v5, 16, v13
  s_mov_b64 exec, s[42:43]
  ds_write_b32 v3, v5 offset:248
  s_mov_b64 exec, -1
  v_lshl_or_b32 v6, v6, 16, v14
  s_mov_b64 exec, s[44:45]
  ds_write_b32 v3, v6 offset:376
  s_mov_b64 exec, -1
  v_lshl_or_b32 v7, v7, 16, v15
  s_mov_b64 exec, s[46:47]
  ds_write_b32 v3, v7 offset:504
  s_mov_b64 exec, -1
K1NOPTR:
  v_lshlrev_b32 v20, 2, v20
  v_lshlrev_b32 v21, 2, v21
  v_lshlrev_b32 v22, 2, v22
  v_lshlrev_b32 v23, 2, v23
  v_lshlrev_b32 v24, 2, v24
  s_waitcnt lgkmcnt(0)
  v_cmp_lt_u32_sdwa vcc, v28, v17 src0_sel:DWORD src1_sel:WORD_1
  s_nop 1
  v_cndmask_b32_sdwa v20, v17, v20, vcc dst_sel:DWORD dst_unused:UNUSED_PAD src0_sel:WORD_0 src1_sel:DWORD
  v_add_lshl_u32 v20, v20, v28, 3
  ds_write_b64 v20, v[36:37]
  v_cmp_lt_u32_sdwa vcc, v29, v18 src0_sel:DWORD src1_sel:WORD_1
  s_nop 1
  v_cndmask_b32_sdwa v21, v18, v21, vcc dst_sel:DWORD dst_unused:UNUSED_PAD src0_sel:WORD_0 src1_sel:DWORD
  v_add_lshl_u32 v21, v21, v29, 3
  ds_write_b64 v21, v[38:39]
  v_cmp_lt_u32_sdwa vcc, v30, v19 src0_sel:DWORD src1_sel:WORD_1
  s_nop 1
  v_cndmask_b32_sdwa v22, v19, v22, vcc dst_sel:DWORD dst_unused:UNUSED_PAD src0_sel:WORD_0 src1_sel:DWORD
  v_add_lshl_u32 v22, v22, v30, 3
  ds_write_b64 v22, v[40:41]
  v_cmp_lt_u32_sdwa vcc, v31, v25 src0_sel:DWORD src1_sel:WORD_1
  s_nop 1
  v_cndmask_b32_sdwa v23, v25, v23, vcc dst_sel:DWORD dst_unused:UNUSED_PAD src0_sel:WORD_0 src1_sel:DWORD
  v_add_lshl_u32 v23, v23, v31, 3
  ds_write_b64 v23, v[42:43]
  v_cmp_lt_u32_sdwa vcc, v32, v26 src0_sel:DWORD src1_sel:WORD_1
  s_nop 1
  v_cndmask_b32_sdwa v24, v26, v24, vcc dst_sel:DWORD dst_unused:UNUSED_PAD src0_sel:WORD_0 src1_sel:DWORD
  v_add_lshl_u32 v24, v24, v32, 3
  ds_write_b64 v24, v[44:45]
  v_lshrrev_b32 v3, 3, v0
  s_movk_i32 s3, 32000
  v_mul_u32_u24 v3, s3, v3
  v_and_b32 v1, 7, v0
  v_lshl_add_u32 v3, v1, 4, v3
  s_lshl_b32 s3, s2, 7
  s_add_u32 s4, s3, 2560000
  s_add_u32 s5, s3, 5120000
  s_add_u32 s6, s3, 7680000
  s_mul_i32 s7, s2, 25600
  s_lshl_b32 s33, s33, 3
  s_waitcnt lgkmcnt(0)
  s_barrier
  ds_read_b128 v[4:7], v2
  ds_read_b128 v[8:11], v2 offset:10240
  ds_read_b128 v[12:15], v2 offset:20480
  ds_read_b128 v[16:19], v2 offset:30720
  s_waitcnt lgkmcnt(3)
  buffer_store_dwordx4 v[4:7], v3, s[20:23], s3 offen
  s_waitcnt lgkmcnt(2)
  buffer_store_dwordx4 v[8:11], v3, s[20:23], s4 offen
  s_waitcnt lgkmcnt(1)
  buffer_store_dwordx4 v[12:15], v3, s[20:23], s5 offen
  s_cmp_ge_u32 s31, 128
  s_cbranch_scc1 K1OV
  s_waitcnt lgkmcnt(0)
  buffer_store_dwordx4 v[16:19], v3, s[20:23], s6 offen
K1OV:
  v_cmpx_gt_u32 vcc, s33, v2
  s_cbranch_execz K1END
  ds_read_b128 v[20:23], v2 offset:32768
  s_waitcnt lgkmcnt(0)
  buffer_store_dwordx4 v[20:23], v2, s[24:27], s7 offen
  v_add_u32 v2, 10240, v2
  s_waitcnt vmcnt(0)
  s_branch K1OV
K1END:
  s_endpgm
WPREP:
  s_load_dwordx4 s[4:7], s[0:1], 40
  v_lshrrev_b32 v2, 6, v0
  v_and_b32 v1, 63, v0
  v_readfirstlane_b32 s31, v2
  s_mov_b32 s28, 0xbfb8aa3b
  s_mov_b32 s29, 0xbfb8aa3b
  s_mov_b32 s30, 0xffff0000
  s_waitcnt lgkmcnt(0)
  s_mov_b32 s12, s4
  s_mov_b32 s13, s5
  s_mov_b32 s14, 18560
  s_mov_b32 s15, 0x20000
  s_mov_b32 s16, s6
  s_mov_b32 s17, s7
  s_mov_b32 s18, 128
  s_mov_b32 s19, 0x20000
  s_add_u32 s20, s8, 15728640
  s_addc_u32 s21, s9, 0
  s_mov_b32 s22, 24576
  s_mov_b32 s23, 0x20000
  v_and_b32 v2, 7, v1
  v_bfe_u32 v3, v1, 4, 1
  v_lshlrev_b32 v4, 2, v3
  v_xor_b32 v4, v4, v2
  v_lshlrev_b32 v4, 4, v4
  v_lshrrev_b32 v5, 3, v1
  v_lshl_or_b32 v4, v5, 7, v4
  s_lshl_b32 s3, s31, 10
  s_add_u32 s4, s3, 10240
  v_add_u32 v4, s3, v4
  s_mov_b32 m0, s3
  s_nop 0
  buffer_load_dwordx4 v4, s[12:15], 0 offen lds
  v_add_u32 v4, 10240, v4
  s_mov_b32 m0, s4
  s_nop 0
  buffer_load_dwordx4 v4, s[12:15], 0 offen lds
  v_lshrrev_b32 v5, 5, v1
  v_lshlrev_b32 v7, 3, v5
  buffer_load_dwordx2 v[28:29], v7, s[16:19], 0 offen offset:0
  buffer_load_dwordx2 v[30:31], v7, s[16:19], 0 offen offset:16
  buffer_load_dwordx2 v[32:33], v7, s[16:19], 0 offen offset:32
  buffer_load_dwordx2 v[34:35], v7, s[16:19], 0 offen offset:48
  buffer_load_dwordx2 v[36:37], v7, s[16:19], 0 offen offset:64
  buffer_load_dwordx2 v[38:39], v7, s[16:19], 0 offen offset:80
  buffer_load_dwordx2 v[40:41], v7, s[16:19], 0 offen offset:96
  buffer_load_dwordx2 v[42:43], v7, s[16:19], 0 offen offset:112
  v_and_b32 v2, 3, v1
  v_bfe_u32 v4, v1, 2, 2
  v_lshlrev_b32 v2, 3, v2
  v_lshl_add_u32 v2, v3, 5, v2
  v_lshl_add_u32 v2, v4, 7, v2
  v_lshl_add_u32 v6, v5, 12, v2
  v_lshrrev_b32 v3, 1, v4
  v_lshl_add_u32 v6, v3, 6, v6
  v_lshl_add_u32 v8, v5, 10, v2
  v_add_u32 v3, 1, v4
  v_bfe_u32 v3, v3, 1, 1
  v_lshl_add_u32 v8, v3, 6, v8
  v_xor_b32 v9, 64, v8
  s_and_b32 s3, s31, 1
  s_lshl_b32 s3, s3, 6
  v_xor_b32 v6, s3, v6
  s_lshr_b32 s3, s31, 1
  s_lshl_b32 s3, s3, 13
  v_add_u32 v6, s3, v6
  v_lshlrev_b32 v10, 4, v1
  s_lshl_b32 s3, s31, 12
  s_waitcnt vmcnt(0)
  s_barrier
  s_cmp_eq_u32 s31, 4
  s_cbranch_scc1 WP4
  s_cmp_eq_u32 s31, 5
  s_cbranch_scc1 WP5
  s_cmp_gt_u32 s31, 5
  s_cbranch_scc1 WPEND
  ds_read_b64_tr_b16 v[12:13], v6 offset:0
  ds_read_b64_tr_b16 v[14:15], v6 offset:512
  ds_read_b64_tr_b16 v[16:17], v6 offset:1024
  ds_read_b64_tr_b16 v[18:19], v6 offset:1536
  ds_read_b64_tr_b16 v[20:21], v6 offset:2048
  ds_read_b64_tr_b16 v[22:23], v6 offset:2560
  ds_read_b64_tr_b16 v[24:25], v6 offset:3072
  ds_read_b64_tr_b16 v[26:27], v6 offset:3584
  s_waitcnt lgkmcnt(0)
  s_cmp_lt_u32 s31, 2
  s_cbranch_scc1 WPST
  v_lshlrev_b32 v2, 16, v12
  v_and_b32 v3, s30, v12
  v_pk_mul_f32 v[2:3], v[2:3], s[28:29]
  v_cvt_pk_bf16_f32 v12, v2, v3
  v_lshlrev_b32 v2, 16, v13
  v_and_b32 v3, s30, v13
  v_pk_mul_f32 v[2:3], v[2:3], s[28:29]
  v_cvt_pk_bf16_f32 v13, v2, v3
  v_lshlrev_b32 v2, 16, v14
  v_and_b32 v3, s30, v14
  v_pk_mul_f32 v[2:3], v[2:3], s[28:29]
  v_cvt_pk_bf16_f32 v14, v2, v3
  v_lshlrev_b32 v2, 16, v15
  v_and_b32 v3, s30, v15
  v_pk_mul_f32 v[2:3], v[2:3], s[28:29]
  v_cvt_pk_bf16_f32 v15, v2, v3
  v_lshlrev_b32 v2, 16, v16
  v_and_b32 v3, s30, v16
  v_pk_mul_f32 v[2:3], v[2:3], s[28:29]
  v_cvt_pk_bf16_f32 v16, v2, v3
  v_lshlrev_b32 v2, 16, v17
  v_and_b32 v3, s30, v17
  v_pk_mul_f32 v[2:3], v[2:3], s[28:29]
  v_cvt_pk_bf16_f32 v17, v2, v3
  v_lshlrev_b32 v2, 16, v18
  v_and_b32 v3, s30, v18
  v_pk_mul_f32 v[2:3], v[2:3], s[28:29]
  v_cvt_pk_bf16_f32 v18, v2, v3
  v_lshlrev_b32 v2, 16, v19
  v_and_b32 v3, s30, v19
  v_pk_mul_f32 v[2:3], v[2:3], s[28:29]
  v_cvt_pk_bf16_f32 v19, v2, v3
  v_lshlrev_b32 v2, 16, v20
  v_and_b32 v3, s30, v20
  v_pk_mul_f32 v[2:3], v[2:3], s[28:29]
  v_cvt_pk_bf16_f32 v20, v2, v3
  v_lshlrev_b32 v2, 16, v21
  v_and_b32 v3, s30, v21
  v_pk_mul_f32 v[2:3], v[2:3], s[28:29]
  v_cvt_pk_bf16_f32 v21, v2, v3
  v_lshlrev_b32 v2, 16, v22
  v_and_b32 v3, s30, v22
  v_pk_mul_f32 v[2:3], v[2:3], s[28:29]
  v_cvt_pk_bf16_f32 v22, v2, v3
  v_lshlrev_b32 v2, 16, v23
  v_and_b32 v3, s30, v23
  v_pk_mul_f32 v[2:3], v[2:3], s[28:29]
  v_cvt_pk_bf16_f32 v23, v2, v3
  v_lshlrev_b32 v2, 16, v24
  v_and_b32 v3, s30, v24
  v_pk_mul_f32 v[2:3], v[2:3], s[28:29]
  v_cvt_pk_bf16_f32 v24, v2, v3
  v_lshlrev_b32 v2, 16, v25
  v_and_b32 v3, s30, v25
  v_pk_mul_f32 v[2:3], v[2:3], s[28:29]
  v_cvt_pk_bf16_f32 v25, v2, v3
  v_lshlrev_b32 v2, 16, v26
  v_and_b32 v3, s30, v26
  v_pk_mul_f32 v[2:3], v[2:3], s[28:29]
  v_cvt_pk_bf16_f32 v26, v2, v3
  v_lshlrev_b32 v2, 16, v27
  v_and_b32 v3, s30, v27
  v_pk_mul_f32 v[2:3], v[2:3], s[28:29]
  v_cvt_pk_bf16_f32 v27, v2, v3
WPST:
  buffer_store_dwordx4 v[12:15], v10, s[20:23], s3 offen offset:0
  buffer_store_dwordx4 v[16:19], v10, s[20:23], s3 offen offset:1024
  buffer_store_dwordx4 v[20:23], v10, s[20:23], s3 offen offset:2048
  buffer_store_dwordx4 v[24:27], v10, s[20:23], s3 offen offset:3072
  s_endpgm
WP4:
  ds_read_b64_tr_b16 v[12:13], v8 offset:16512
  ds_read_b64_tr_b16 v[14:15], v8 offset:17024
  ds_read_b64_tr_b16 v[16:17], v9 offset:16512
  ds_read_b64_tr_b16 v[18:19], v9 offset:17024
  v_and_b32 v2, 31, v1
  v_lshlrev_b32 v2, 1, v2
  ds_read_u16 v20, v2 offset:16384
  ds_read_u16 v21, v2 offset:16448
  v_subrev_u32 v5, 1, v5
  s_waitcnt lgkmcnt(0)
  v_lshlrev_b32 v2, 16, v12
  v_and_b32 v3, s30, v12
  v_pk_mul_f32 v[2:3], v[2:3], s[28:29]
  v_cvt_pk_bf16_f32 v12, v2, v3
  v_lshlrev_b32 v2, 16, v13
  v_and_b32 v3, s30, v13
  v_pk_mul_f32 v[2:3], v[2:3], s[28:29]
  v_cvt_pk_bf16_f32 v13, v2, v3
  v_lshlrev_b32 v2, 16, v14
  v_and_b32 v3, s30, v14
  v_pk_mul_f32 v[2:3], v[2:3], s[28:29]
  v_cvt_pk_bf16_f32 v14, v2, v3
  v_lshlrev_b32 v2, 16, v15
  v_and_b32 v3, s30, v15
  v_pk_mul_f32 v[2:3], v[2:3], s[28:29]
  v_cvt_pk_bf16_f32 v15, v2, v3
  v_lshlrev_b32 v2, 16, v16
  v_and_b32 v3, s30, v16
  v_pk_mul_f32 v[2:3], v[2:3], s[28:29]
  v_cvt_pk_bf16_f32 v16, v2, v3
  v_lshlrev_b32 v2, 16, v17
  v_and_b32 v3, s30, v17
  v_pk_mul_f32 v[2:3], v[2:3], s[28:29]
  v_cvt_pk_bf16_f32 v17, v2, v3
  v_lshlrev_b32 v2, 16, v18
  v_and_b32 v3, s30, v18
  v_pk_mul_f32 v[2:3], v[2:3], s[28:29]
  v_cvt_pk_bf16_f32 v18, v2, v3
  v_lshlrev_b32 v2, 16, v19
  v_and_b32 v3, s30, v19
  v_pk_mul_f32 v[2:3], v[2:3], s[28:29]
  v_cvt_pk_bf16_f32 v19, v2, v3
  v_lshlrev_b32 v20, 16, v20
  v_mul_f32 v20, s28, v20
  v_cvt_pk_f16_f32 v20, v20, 0
  v_and_b32 v20, v5, v20
  v_mov_b32 v22, 0
  v_lshlrev_b32 v21, 16, v21
  v_mul_f32 v21, s28, v21
  v_cvt_pk_f16_f32 v21, v21, 0
  v_and_b32 v21, v5, v21
  v_mov_b32 v23, 0
  buffer_store_dwordx4 v[12:15], v10, s[20:23], s3 offen offset:0
  buffer_store_dwordx4 v[16:19], v10, s[20:23], s3 offen offset:1024
  buffer_store_dwordx4 v[20:23], v10, s[20:23], s3 offen offset:2048
  buffer_store_dwordx4 v[20:23], v10, s[20:23], s3 offen offset:3072
  s_endpgm
WP5:
  v_lshrrev_b32 v4, 2, v1
  v_lshrrev_b32 v8, 4, v1
  v_xor_b32 v4, v4, v8
  v_and_b32 v4, 1, v4
  v_subrev_u32 v4, 1, v4
  v_lshlrev_b32 v2, 16, v28
  v_and_b32 v3, s30, v28
  v_cvt_pk_f16_f32 v2, v2, v3
  v_and_b32 v12, v4, v2
  v_lshlrev_b32 v2, 16, v29
  v_and_b32 v3, s30, v29
  v_cvt_pk_f16_f32 v2, v2, v3
  v_and_b32 v13, v4, v2
  v_lshlrev_b32 v2, 16, v30
  v_and_b32 v3, s30, v30
  v_cvt_pk_f16_f32 v2, v2, v3
  v_and_b32 v14, v4, v2
  v_lshlrev_b32 v2, 16, v31
  v_and_b32 v3, s30, v31
  v_cvt_pk_f16_f32 v2, v2, v3
  v_and_b32 v15, v4, v2
  v_lshlrev_b32 v2, 16, v32
  v_and_b32 v3, s30, v32
  v_cvt_pk_f16_f32 v2, v2, v3
  v_and_b32 v16, v4, v2
  v_lshlrev_b32 v2, 16, v33
  v_and_b32 v3, s30, v33
  v_cvt_pk_f16_f32 v2, v2, v3
  v_and_b32 v17, v4, v2
  v_lshlrev_b32 v2, 16, v34
  v_and_b32 v3, s30, v34
  v_cvt_pk_f16_f32 v2, v2, v3
  v_and_b32 v18, v4, v2
  v_lshlrev_b32 v2, 16, v35
  v_and_b32 v3, s30, v35
  v_cvt_pk_f16_f32 v2, v2, v3
  v_and_b32 v19, v4, v2
  v_lshlrev_b32 v2, 16, v36
  v_and_b32 v3, s30, v36
  v_cvt_pk_f16_f32 v2, v2, v3
  v_and_b32 v20, v4, v2
  v_lshlrev_b32 v2, 16, v37
  v_and_b32 v3, s30, v37
  v_cvt_pk_f16_f32 v2, v2, v3
  v_and_b32 v21, v4, v2
  v_lshlrev_b32 v2, 16, v38
  v_and_b32 v3, s30, v38
  v_cvt_pk_f16_f32 v2, v2, v3
  v_and_b32 v22, v4, v2
  v_lshlrev_b32 v2, 16, v39
  v_and_b32 v3, s30, v39
  v_cvt_pk_f16_f32 v2, v2, v3
  v_and_b32 v23, v4, v2
  v_lshlrev_b32 v2, 16, v40
  v_and_b32 v3, s30, v40
  v_cvt_pk_f16_f32 v2, v2, v3
  v_and_b32 v24, v4, v2
  v_lshlrev_b32 v2, 16, v41
  v_and_b32 v3, s30, v41
  v_cvt_pk_f16_f32 v2, v2, v3
  v_and_b32 v25, v4, v2
  v_lshlrev_b32 v2, 16, v42
  v_and_b32 v3, s30, v42
  v_cvt_pk_f16_f32 v2, v2, v3
  v_and_b32 v26, v4, v2
  v_lshlrev_b32 v2, 16, v43
  v_and_b32 v3, s30, v43
  v_cvt_pk_f16_f32 v2, v2, v3
  v_and_b32 v27, v4, v2
  s_branch WPST
WPEND:
  s_endpgm
.globl main_kernel
.p2align 8
.type main_kernel,@function
main_kernel:
  s_cmp_ge_u32 s2, 256
  s_cbranch_scc1 K2END
  s_load_dwordx2 s[52:53], s[0:1], 80
  s_load_dwordx8 s[32:39], s[0:1], 0
  s_load_dwordx4 s[48:51], s[0:1], 56
  s_and_b32 s3, s2, 7
  s_lshl_b32 s3, s3, 5
  s_lshr_b32 s56, s2, 3
  s_add_u32 s56, s56, s3
  v_lshrrev_b32 v2, 6, v0
  v_and_b32 v0, 63, v0
  v_readfirstlane_b32 s57, v2
  s_mov_b32 s60, 47
  s_mov_b32 s61, 0
  s_mov_b32 s63, 1
  s_mov_b32 s54, 1
  s_movk_i32 s64, 128
  s_mov_b32 s65, 0xffff0000
  s_mov_b32 s70, 0xbfb8aa3b
  s_mov_b32 s71, 0xbfb8aa3b
  s_mov_b32 s72, 1.0
  s_mov_b32 s73, 1.0
  s_mov_b32 s74, -1
  s_mov_b32 s75, 0
  s_lshl_b32 s3, s56, 3
  s_add_u32 s3, s3, s57
  s_mul_i32 s3, s3, 3125
  s_add_u32 s58, s3, 127
  s_lshr_b32 s58, s58, 7
  s_add_u32 s3, s3, 3252
  s_lshr_b32 s3, s3, 7
  s_sub_u32 s3, s3, s58
  s_bfm_b32 s78, s3, 0
  s_lshl_b32 s66, s57, 13
  s_add_u32 s66, s66, 81408
  s_lshl_b32 s67, s57, 10
  s_add_u32 s67, s67, 36352
  s_mul_i32 s3, s56, 32000
  s_mov_b32 s18, 32000
  s_mov_b32 s19, 0x20000
  s_waitcnt lgkmcnt(0)
  s_add_u32 s16, s52, s3
  s_addc_u32 s17, s53, 0
ROUND:
  s_lshl_b32 s3, s57, 12
  v_lshl_add_u32 v2, v0, 4, s3
  buffer_load_dwordx4 v[128:131], v2, s[16:19], 0 offen offset:0
  buffer_load_dwordx4 v[132:135], v2, s[16:19], 0 offen offset:1024
  buffer_load_dwordx4 v[136:139], v2, s[16:19], 0 offen offset:2048
  buffer_load_dwordx4 v[140:143], v2, s[16:19], 0 offen offset:3072
  s_and_b32 s3, s57, 3
  s_lshl_b32 s3, s3, 8
  v_lshl_add_u32 v4, v0, 2, s3
  v_mov_b32 v5, 0
  ds_write_b32 v4, v5 offset:34816
  s_cmp_eq_u32 s63, 0
  s_cbranch_scc1 NOTFIRST1
  s_mov_b32 s4, s32
  s_mov_b32 s5, s33
  s_mov_b32 s6, 6400000
  s_mov_b32 s7, 0x20000
  s_mov_b32 s12, s34
  s_mov_b32 s13, s35
  s_mov_b32 s14, 300000
  s_mov_b32 s15, 0x20000
  v_and_b32 v2, 7, v0
  v_bfe_u32 v3, v0, 4, 1
  v_lshrrev_b32 v5, 3, v0
  v_lshrrev_b32 v6, 5, v0
  v_lshl_add_u32 v237, v6, 2, 0
  v_xor_b32 v237, v237, v2
  v_lshlrev_b32 v237, 4, v237
  v_lshl_add_u32 v7, v5, 2, s58
  v_add_u32 v7, 0, v7
  v_mad_u32_u24 v7, v7, s64, v237
  s_add_u32 m0, s66, 0
  s_nop 0
  buffer_load_dwordx4 v7, s[4:7], 0 offen lds
  v_lshl_add_u32 v238, v6, 2, 1
  v_xor_b32 v238, v238, v2
  v_lshlrev_b32 v238, 4, v238
  v_lshl_add_u32 v7, v5, 2, s58
  v_add_u32 v7, 1, v7
  v_mad_u32_u24 v7, v7, s64, v238
  s_add_u32 m0, s66, 1024
  s_nop 0
  buffer_load_dwordx4 v7, s[4:7], 0 offen lds
  v_lshl_add_u32 v239, v6, 2, 2
  v_xor_b32 v239, v239, v2
  v_lshlrev_b32 v239, 4, v239
  v_lshl_add_u32 v7, v5, 2, s58
  v_add_u32 v7, 2, v7
  v_mad_u32_u24 v7, v7, s64, v239
  s_add_u32 m0, s66, 2048
  s_nop 0
  buffer_load_dwordx4 v7, s[4:7], 0 offen lds
  v_lshl_add_u32 v240, v6, 2, 3
  v_xor_b32 v240, v240, v2
  v_lshlrev_b32 v240, 4, v240
  v_lshl_add_u32 v7, v5, 2, s58
  v_add_u32 v7, 3, v7
  v_mad_u32_u24 v7, v7, s64, v240
  s_add_u32 m0, s66, 3072
  s_nop 0
  buffer_load_dwordx4 v7, s[4:7], 0 offen lds
  v_add_u32 v232, s58, v0
  v_mul_u32_u24 v7, 6, v232
  v_and_b32 v7, -4, v7
  buffer_load_dwordx2 v[228:229], v7, s[12:15], 0 offen
  s_mov_b32 s8, s36
  s_mov_b32 s9, s37
  s_mov_b32 s10, 25600000
  s_mov_b32 s11, 0x20000
  s_mov_b32 s28, s50
  s_mov_b32 s29, s51
  s_mov_b32 s30, 6700000
  s_mov_b32 s31, 0x20000
  s_mov_b32 s24, s48
  s_mov_b32 s25, s49
  s_mov_b32 s26, 16384
  s_mov_b32 s27, 0x20000
  s_add_u32 s20, s52, 8388608
  s_addc_u32 s21, s53, 0
  s_mov_b32 s22, 7364608
  s_mov_b32 s23, 0x20000
  v_lshlrev_b32 v1, 1, v3
  v_xor_b32 v1, v1, v2
  v_lshlrev_b32 v1, 4, v1
  v_lshl_or_b32 v1, v5, 7, v1
  v_lshlrev_b32 v254, 4, v6
  v_and_b32 v2, 3, v0
  v_bfe_u32 v4, v0, 2, 3
  v_lshl_add_u32 v4, v2, 3, v4
  v_xor_b32 v7, v3, v6
  v_lshlrev_b32 v7, 6, v7
  v_lshl_add_u32 v4, v4, 7, v7
  v_add_u32 v4, s66, v4
  v_xor_b32 v7, 0, v2
  v_lshl_add_u32 v241, v7, 4, v4
  v_xor_b32 v7, 1, v2
  v_lshl_add_u32 v242, v7, 4, v4
  v_xor_b32 v7, 2, v2
  v_lshl_add_u32 v243, v7, 4, v4
  v_xor_b32 v7, 3, v2
  v_lshl_add_u32 v244, v7, 4, v4
  s_add_u32 s3, s67, 32
  v_lshlrev_b32 v7, 5, v6
  v_sub_u32 v245, s3, v7
  s_add_u32 s3, s67, 224
  v_lshl_add_u32 v7, v3, 2, v2
  v_lshlrev_b32 v7, 5, v7
  v_sub_u32 v247, s3, v7
  s_mul_i32 s3, s57, 4608
  s_add_u32 s3, s3, 44544
  v_and_b32 v7, 31, v0
  s_movk_i32 s68, 144
  v_mul_u32_u24 v8, s68, v7
  v_add_u32 v8, s3, v8
  v_lshl_add_u32 v246, v6, 5, v8
  v_bfe_u32 v4, v0, 2, 2
  v_lshl_add_u32 v8, v6, 2, v4
  s_movk_i32 s68, 576
  v_mul_u32_u24 v9, s68, v8
  v_add_u32 v9, s3, v9
  v_xor_b32 v249, v3, v0
  v_and_b32 v249, 1, v249
  v_lshl_add_u32 v249, v249, 3, v9
  v_add_u32 v249, 128, v249
  v_lshl_add_u32 v248, v3, 5, v9
  v_lshl_add_u32 v248, v2, 3, v248
  v_mov_b32 v56, 0
  v_mov_b32 v57, 0
  v_mov_b32 v58, 0x3c00
  v_mov_b32 v59, 0x3c000000
  v_cmp_eq_u32 vcc, 28, v0
  s_nop 1
  v_cndmask_b32 v56, v56, v58, vcc
  v_cmp_eq_u32 vcc, 29, v0
  s_nop 1
  v_cndmask_b32 v56, v56, v59, vcc
  v_cmp_eq_u32 vcc, 30, v0
  s_nop 1
  v_cndmask_b32 v57, v57, v58, vcc
  v_cmp_eq_u32 vcc, 31, v0
  s_nop 1
  v_cndmask_b32 v57, v57, v59, vcc
  v_lshl_add_u32 v9, v0, 3, s67
  ds_write_b64 v9, v[56:57]
  v_mov_b32 v88, 0
  v_mov_b32 v89, 0
  v_mov_b32 v90, 0
  v_mov_b32 v91, 0
  v_mov_b32 v92, 0
  v_mov_b32 v93, 0
  v_mov_b32 v94, 0
  v_mov_b32 v95, 0
  v_mov_b32 v96, 0
  v_mov_b32 v97, 0
  v_mov_b32 v98, 0
  v_mov_b32 v99, 0
  v_mov_b32 v100, 0
  v_mov_b32 v101, 0
  v_mov_b32 v102, 0
  v_mov_b32 v103, 0
  v_mov_b32 v104, 0
  v_mov_b32 v105, 0
  v_mov_b32 v106, 0
  v_mov_b32 v107, 0
  v_mov_b32 v108, 0
  v_mov_b32 v109, 0
  v_mov_b32 v110, 0
  v_mov_b32 v111, 0
  v_mov_b32 v112, 0
  v_mov_b32 v113, 0
  v_mov_b32 v114, 0
  v_mov_b32 v115, 0
  v_mov_b32 v116, 0
  v_mov_b32 v117, 0
  v_mov_b32 v118, 0
  v_mov_b32 v119, 0
  v_mov_b32 v120, 0
  v_mov_b32 v121, 0
  v_mov_b32 v122, 0
  v_mov_b32 v123, 0
  s_branch FIRST1
NOTFIRST1:
  s_waitcnt vmcnt(0)
FIRST1:
  s_lshl_b32 s3, s57, 5
  v_lshrrev_b32 v2, 3, v0
  v_add_u32 v2, s3, v2
  s_movk_i32 s3, 25600
  v_mul_u32_u24 v2, s3, v2
  v_and_b32 v3, 7, v0
  v_lshl_add_u32 v2, v3, 4, v2
  v_lshlrev_b32 v3, 1, v3
  s_sub_i32 s68, s61, 15
  s_add_i32 s69, s68, s60
  s_max_i32 s68, s68, 0
  s_lshl_b32 s3, s68, 3
  v_add_u32 v2, s3, v2
  v_add_u32 v4, s68, v3
  v_mov_b32 v9, 1
  s_waitcnt lgkmcnt(0)
  s_barrier
  s_waitcnt vmcnt(8)
  v_ashrrev_i32 v5, 31, v131
  v_bfi_b32 v5, v5, 0, v130
  s_mov_b32 s3, 0
  v_mov_b32_dpp v6, v5 quad_perm:[3,3,3,3] row_mask:0xf bank_mask:0xf
  s_nop 1
  v_or_b32_dpp v6, v6, v6 row_half_mirror row_mask:0xf bank_mask:0xf
  v_lshrrev_b32 v220, 16, v6
  v_and_b32 v6, 0xffff, v6
  v_lshl_add_u32 v6, v6, 3, v2
  v_add_u32 v224, s3, v6
  v_min_i32 v216, s69, v220
  v_sub_u32 v216, v216, v4
  v_cmp_lt_i32 vcc, 0, v216
  s_nop 1
  v_cndmask_b32 v6, -16, v224, vcc
  buffer_load_dwordx4 v[144:147], v6, s[20:23], 0 offen
  s_waitcnt vmcnt(8)
  v_ashrrev_i32 v5, 31, v135
  v_bfi_b32 v5, v5, 0, v134
  s_mov_b32 s3, 204800
  v_mov_b32_dpp v6, v5 quad_perm:[3,3,3,3] row_mask:0xf bank_mask:0xf
  s_nop 1
  v_or_b32_dpp v6, v6, v6 row_half_mirror row_mask:0xf bank_mask:0xf
  v_lshrrev_b32 v221, 16, v6
  v_and_b32 v6, 0xffff, v6
  v_lshl_add_u32 v6, v6, 3, v2
  v_add_u32 v225, s3, v6
  v_min_i32 v217, s69, v221
  v_sub_u32 v217, v217, v4
  v_cmp_lt_i32 vcc, 0, v217
  s_nop 1
  v_cndmask_b32 v6, -16, v225, vcc
  buffer_load_dwordx4 v[148:151], v6, s[20:23], 0 offen
  s_waitcnt vmcnt(8)
  v_ashrrev_i32 v5, 31, v139
  v_bfi_b32 v5, v5, 0, v138
  s_mov_b32 s3, 409600
  v_mov_b32_dpp v6, v5 quad_perm:[3,3,3,3] row_mask:0xf bank_mask:0xf
  s_nop 1
  v_or_b32_dpp v6, v6, v6 row_half_mirror row_mask:0xf bank_mask:0xf
  v_lshrrev_b32 v222, 16, v6
  v_and_b32 v6, 0xffff, v6
  v_lshl_add_u32 v6, v6, 3, v2
  v_add_u32 v226, s3, v6
  v_min_i32 v218, s69, v222
  v_sub_u32 v218, v218, v4
  v_cmp_lt_i32 vcc, 0, v218
  s_nop 1
  v_cndmask_b32 v6, -16, v226, vcc
  buffer_load_dwordx4 v[152:155], v6, s[20:23], 0 offen
  s_waitcnt vmcnt(8)
  v_ashrrev_i32 v5, 31, v143
  v_bfi_b32 v5, v5, 0, v142
  s_mov_b32 s3, 614400
  v_mov_b32_dpp v6, v5 quad_perm:[3,3,3,3] row_mask:0xf bank_mask:0xf
  s_nop 1
  v_or_b32_dpp v6, v6, v6 row_half_mirror row_mask:0xf bank_mask:0xf
  v_lshrrev_b32 v223, 16, v6
  v_and_b32 v6, 0xffff, v6
  v_lshl_add_u32 v6, v6, 3, v2
  v_add_u32 v227, s3, v6
  v_min_i32 v219, s69, v223
  v_sub_u32 v219, v219, v4
  v_cmp_lt_i32 vcc, 0, v219
  s_nop 1
  v_cndmask_b32 v6, -16, v227, vcc
  buffer_load_dwordx4 v[156:159], v6, s[20:23], 0 offen
  v_max3_i32 v5, v216, v217, v218
  v_max_i32 v5, v5, v219
  v_cmp_lt_i32 s[76:77], 16, v5
  v_max3_i32 v5, v220, v221, v222
  v_max_i32 v5, v5, v223
  s_max_i32 s69, s69, 0
  v_cmp_lt_i32 s[68:69], s69, v5
  s_cmp_eq_u64 s[76:77], 0
  s_cbranch_scc1 NOL2A
  v_cmpx_lt_i32 vcc, 16, v216
  buffer_load_dwordx4 v[160:163], v224, s[20:23], 0 offen offset:128
  s_mov_b64 exec, -1
  v_cmpx_lt_i32 vcc, 16, v217
  buffer_load_dwordx4 v[164:167], v225, s[20:23], 0 offen offset:128
  s_mov_b64 exec, -1
  v_cmpx_lt_i32 vcc, 16, v218
  buffer_load_dwordx4 v[168:171], v226, s[20:23], 0 offen offset:128
  s_mov_b64 exec, -1
  v_cmpx_lt_i32 vcc, 16, v219
  buffer_load_dwordx4 v[172:175], v227, s[20:23], 0 offen offset:128
  s_mov_b64 exec, -1
NOL2A:
  s_cmp_eq_u32 s63, 0
  s_cbranch_scc1 NOTFIRST2
  s_lshl_b32 s3, s57, 10
  v_lshl_add_u32 v5, v0, 4, s3
  v_add_u32 v5, 7340032, v5
  s_add_u32 m0, s3, 44544
  s_nop 0
  buffer_load_dwordx4 v5, s[20:23], 0 offen lds
  v_add_u32 v5, 0x2000, v5
  s_add_u32 m0, s3, 52736
  s_nop 0
  buffer_load_dwordx4 v5, s[20:23], 0 offen lds
  v_add_u32 v5, 0x2000, v5
  s_add_u32 m0, s3, 60928
  s_nop 0
  buffer_load_dwordx4 v5, s[20:23], 0 offen lds
  v_add_u32 v1, s3, v1
  s_add_u32 m0, s3, 146944
  s_nop 0
  buffer_load_dwordx4 v1, s[24:27], 0 offen lds
  v_add_u32 v1, 0x2000, v1
  s_add_u32 m0, s3, 155136
  s_nop 0
  buffer_load_dwordx4 v1, s[24:27], 0 offen lds
  s_branch FIRST2
NOTFIRST2:
  s_add_u32 s3, s61, s60
  v_add_u32 v5, 0, v3
  v_cmp_le_u32 s[32:33], s3, v5
  v_cmp_gt_u32 s[34:35], s61, v5
  s_or_b64 s[34:35], s[34:35], s[32:33]
  v_cmp_gt_i32 vcc, 0, v129
  s_and_b64 vcc, vcc, s[32:33]
  s_or_b64 s[68:69], s[68:69], vcc
  v_cndmask_b32 v129, v129, 0, s[34:35]
  v_cmp_gt_i32 vcc, 0, v133
  s_and_b64 vcc, vcc, s[32:33]
  s_or_b64 s[68:69], s[68:69], vcc
  v_cndmask_b32 v133, v133, 0, s[34:35]
  v_cmp_gt_i32 vcc, 0, v137
  s_and_b64 vcc, vcc, s[32:33]
  s_or_b64 s[68:69], s[68:69], vcc
  v_cndmask_b32 v137, v137, 0, s[34:35]
  v_cmp_gt_i32 vcc, 0, v141
  s_and_b64 vcc, vcc, s[32:33]
  s_or_b64 s[68:69], s[68:69], vcc
  v_cndmask_b32 v141, v141, 0, s[34:35]
  v_add_u32 v5, 1, v3
  v_cmp_le_u32 s[32:33], s3, v5
  v_cmp_gt_u32 s[34:35], s61, v5
  s_or_b64 s[34:35], s[34:35], s[32:33]
  v_cmp_gt_i32 vcc, 0, v131
  s_and_b64 vcc, vcc, s[32:33]
  s_or_b64 s[68:69], s[68:69], vcc
  v_cndmask_b32 v131, v131, 0, s[34:35]
  v_cmp_gt_i32 vcc, 0, v135
  s_and_b64 vcc, vcc, s[32:33]
  s_or_b64 s[68:69], s[68:69], vcc
  v_cndmask_b32 v135, v135, 0, s[34:35]
  v_cmp_gt_i32 vcc, 0, v139
  s_and_b64 vcc, vcc, s[32:33]
  s_or_b64 s[68:69], s[68:69], vcc
  v_cndmask_b32 v139, v139, 0, s[34:35]
  v_cmp_gt_i32 vcc, 0, v143
  s_and_b64 vcc, vcc, s[32:33]
  s_or_b64 s[68:69], s[68:69], vcc
  v_cndmask_b32 v143, v143, 0, s[34:35]
  s_waitcnt vmcnt(0)
FIRST2:
  s_cmp_eq_u64 s[68:69], 0
  s_cbranch_scc1 NOFLAG
  v_mov_b32 v5, 35328
  ds_write_b32 v5, v5
NOFLAG:
  v_cmp_gt_i32 s[32:33], 0, v129
  v_lshlrev_b32_sdwa v200, 2, v129 dst_sel:DWORD dst_unused:UNUSED_PAD src0_sel:DWORD src1_sel:BYTE_3
  v_cmp_gt_i32 s[34:35], 0, v131
  v_lshlrev_b32_sdwa v201, 2, v131 dst_sel:DWORD dst_unused:UNUSED_PAD src0_sel:DWORD src1_sel:BYTE_3
  v_cmp_gt_i32 s[36:37], 0, v133
  v_lshlrev_b32_sdwa v202, 2, v133 dst_sel:DWORD dst_unused:UNUSED_PAD src0_sel:DWORD src1_sel:BYTE_3
  v_cmp_gt_i32 s[38:39], 0, v135
  v_lshlrev_b32_sdwa v203, 2, v135 dst_sel:DWORD dst_unused:UNUSED_PAD src0_sel:DWORD src1_sel:BYTE_3
  v_cmp_gt_i32 s[40:41], 0, v137
  v_lshlrev_b32_sdwa v204, 2, v137 dst_sel:DWORD dst_unused:UNUSED_PAD src0_sel:DWORD src1_sel:BYTE_3
  v_cmp_gt_i32 s[42:43], 0, v139
  v_lshlrev_b32_sdwa v205, 2, v139 dst_sel:DWORD dst_unused:UNUSED_PAD src0_sel:DWORD src1_sel:BYTE_3
  v_cmp_gt_i32 s[44:45], 0, v141
  v_lshlrev_b32_sdwa v206, 2, v141 dst_sel:DWORD dst_unused:UNUSED_PAD src0_sel:DWORD src1_sel:BYTE_3
  v_cmp_gt_i32 s[46:47], 0, v143
  v_lshlrev_b32_sdwa v207, 2, v143 dst_sel:DWORD dst_unused:UNUSED_PAD src0_sel:DWORD src1_sel:BYTE_3
  s_mov_b64 exec, s[32:33]
  ds_add_rtn_u32 v176, v200, v9 offset:34304
  s_mov_b64 exec, s[34:35]
  ds_add_rtn_u32 v177, v201, v9 offset:34304
  s_mov_b64 exec, s[36:37]
  ds_add_rtn_u32 v178, v202, v9 offset:34304
  s_mov_b64 exec, s[38:39]
  ds_add_rtn_u32 v179, v203, v9 offset:34304
  s_mov_b64 exec, s[40:41]
  ds_add_rtn_u32 v180, v204, v9 offset:34304
  s_mov_b64 exec, s[42:43]
  ds_add_rtn_u32 v181, v205, v9 offset:34304
  s_mov_b64 exec, s[44:45]
  ds_add_rtn_u32 v182, v206, v9 offset:34304
  s_mov_b64 exec, s[46:47]
  ds_add_rtn_u32 v183, v207, v9 offset:34304
  s_mov_b64 exec, -1
  s_cmp_eq_u64 s[76:77], 0
  s_cbranch_scc1 NOL2B
  s_waitcnt vmcnt(0)
  v_cmpx_lt_i32 vcc, 16, v216
  v_lshlrev_b32_sdwa v208, 2, v161 dst_sel:DWORD dst_unused:UNUSED_PAD src0_sel:DWORD src1_sel:BYTE_3
  ds_add_rtn_u32 v192, v208, v9 offset:34304
  v_cmpx_lt_i32 vcc, 17, v216
  v_lshlrev_b32_sdwa v209, 2, v163 dst_sel:DWORD dst_unused:UNUSED_PAD src0_sel:DWORD src1_sel:BYTE_3
  ds_add_rtn_u32 v193, v209, v9 offset:34304
  s_mov_b64 exec, -1
  v_cmpx_lt_i32 vcc, 16, v217
  v_lshlrev_b32_sdwa v210, 2, v165 dst_sel:DWORD dst_unused:UNUSED_PAD src0_sel:DWORD src1_sel:BYTE_3
  ds_add_rtn_u32 v194, v210, v9 offset:34304
  v_cmpx_lt_i32 vcc, 17, v217
  v_lshlrev_b32_sdwa v211, 2, v167 dst_sel:DWORD dst_unused:UNUSED_PAD src0_sel:DWORD src1_sel:BYTE_3
  ds_add_rtn_u32 v195, v211, v9 offset:34304
  s_mov_b64 exec, -1
  v_cmpx_lt_i32 vcc, 16, v218
  v_lshlrev_b32_sdwa v212, 2, v169 dst_sel:DWORD dst_unused:UNUSED_PAD src0_sel:DWORD src1_sel:BYTE_3
  ds_add_rtn_u32 v196, v212, v9 offset:34304
  v_cmpx_lt_i32 vcc, 17, v218
  v_lshlrev_b32_sdwa v213, 2, v171 dst_sel:DWORD dst_unused:UNUSED_PAD src0_sel:DWORD src1_sel:BYTE_3
  ds_add_rtn_u32 v197, v213, v9 offset:34304
  s_mov_b64 exec, -1
  v_cmpx_lt_i32 vcc, 16, v219
  v_lshlrev_b32_sdwa v214, 2, v173 dst_sel:DWORD dst_unused:UNUSED_PAD src0_sel:DWORD src1_sel:BYTE_3
  ds_add_rtn_u32 v198, v214, v9 offset:34304
  v_cmpx_lt_i32 vcc, 17, v219
  v_lshlrev_b32_sdwa v215, 2, v175 dst_sel:DWORD dst_unused:UNUSED_PAD src0_sel:DWORD src1_sel:BYTE_3
  ds_add_rtn_u32 v199, v215, v9 offset:34304
  s_mov_b64 exec, -1
NOL2B:
  s_waitcnt vmcnt(8)
  v_lshlrev_b32_sdwa v208, 2, v145 dst_sel:DWORD dst_unused:UNUSED_PAD src0_sel:DWORD src1_sel:BYTE_3
  v_lshlrev_b32_sdwa v209, 2, v147 dst_sel:DWORD dst_unused:UNUSED_PAD src0_sel:DWORD src1_sel:BYTE_3
  v_cmpx_lt_i32 vcc, 0, v216
  ds_add_rtn_u32 v184, v208, v9 offset:34304
  v_cmpx_lt_i32 vcc, 1, v216
  ds_add_rtn_u32 v185, v209, v9 offset:34304
  s_mov_b64 exec, -1
  s_waitcnt vmcnt(7)
  v_lshlrev_b32_sdwa v210, 2, v149 dst_sel:DWORD dst_unused:UNUSED_PAD src0_sel:DWORD src1_sel:BYTE_3
  v_lshlrev_b32_sdwa v211, 2, v151 dst_sel:DWORD dst_unused:UNUSED_PAD src0_sel:DWORD src1_sel:BYTE_3
  v_cmpx_lt_i32 vcc, 0, v217
  ds_add_rtn_u32 v186, v210, v9 offset:34304
  v_cmpx_lt_i32 vcc, 1, v217
  ds_add_rtn_u32 v187, v211, v9 offset:34304
  s_mov_b64 exec, -1
  s_waitcnt vmcnt(6)
  v_lshlrev_b32_sdwa v212, 2, v153 dst_sel:DWORD dst_unused:UNUSED_PAD src0_sel:DWORD src1_sel:BYTE_3
  v_lshlrev_b32_sdwa v213, 2, v155 dst_sel:DWORD dst_unused:UNUSED_PAD src0_sel:DWORD src1_sel:BYTE_3
  v_cmpx_lt_i32 vcc, 0, v218
  ds_add_rtn_u32 v188, v212, v9 offset:34304
  v_cmpx_lt_i32 vcc, 1, v218
  ds_add_rtn_u32 v189, v213, v9 offset:34304
  s_mov_b64 exec, -1
  s_waitcnt vmcnt(5)
  v_lshlrev_b32_sdwa v214, 2, v157 dst_sel:DWORD dst_unused:UNUSED_PAD src0_sel:DWORD src1_sel:BYTE_3
  v_lshlrev_b32_sdwa v215, 2, v159 dst_sel:DWORD dst_unused:UNUSED_PAD src0_sel:DWORD src1_sel:BYTE_3
  v_cmpx_lt_i32 vcc, 0, v219
  ds_add_rtn_u32 v190, v214, v9 offset:34304
  v_cmpx_lt_i32 vcc, 1, v219
  ds_add_rtn_u32 v191, v215, v9 offset:34304
  s_mov_b64 exec, -1
  v_lshlrev_b32 v2, 2, v0
  v_mov_b32 v3, 35328
  s_waitcnt lgkmcnt(0)
  s_barrier
  ds_read2st64_b32 v[4:5], v2 offset0:136 offset1:137
  ds_read_b32 v8, v3
  s_waitcnt lgkmcnt(0)
  v_readfirstlane_b32 s62, v8
  v_mov_b32 v6, v4
  v_mov_b32 v7, v5
  s_nop 0
  v_add_u32_dpp v6, v6, v6 row_shr:1 row_mask:0xf bank_mask:0xf
  v_add_u32_dpp v7, v7, v7 row_shr:1 row_mask:0xf bank_mask:0xf
  s_nop 0
  v_add_u32_dpp v6, v6, v6 row_shr:2 row_mask:0xf bank_mask:0xf
  v_add_u32_dpp v7, v7, v7 row_shr:2 row_mask:0xf bank_mask:0xf
  s_nop 0
  v_add_u32_dpp v6, v6, v6 row_shr:4 row_mask:0xf bank_mask:0xf
  v_add_u32_dpp v7, v7, v7 row_shr:4 row_mask:0xf bank_mask:0xf
  s_nop 0
  v_add_u32_dpp v6, v6, v6 row_shr:8 row_mask:0xf bank_mask:0xf
  v_add_u32_dpp v7, v7, v7 row_shr:8 row_mask:0xf bank_mask:0xf
  v_max_u32 v8, v6, v7
  v_cmp_lt_u32 vcc, 0x200, v8
  s_cbranch_vccz NOOVF
  s_lshr_b32 s60, s60, 1
  s_mov_b32 s63, 0
  s_waitcnt vmcnt(0)
  s_barrier
  s_branch ROUND
NOOVF:
  s_and_b32 s3, s57, 3
  s_lshl_b32 s3, s3, 4
  s_add_u32 s3, s3, 15
  v_readlane_b32 s68, v6, s3
  v_readlane_b32 s69, v7, s3
  v_lshrrev_b32 v8, 4, v0
  v_mul_u32_u24 v8, 544, v8
  v_sub_u32 v6, v6, v4
  v_sub_u32 v7, v7, v5
  v_add_u32 v6, v6, v8
  v_add_u32 v7, v7, v8
  v_add_u32 v7, 2176, v7
  ds_write2st64_b32 v2, v6, v7 offset0:140 offset1:141
  s_cmp_ge_u32 s57, 4
  s_cselect_b32 s68, s69, s68
  s_add_u32 s59, s68, 31
  s_lshr_b32 s59, s59, 5
  ds_read_b32 v200, v200 offset:35328
  ds_read_b32 v201, v201 offset:35328
  ds_read_b32 v202, v202 offset:35328
  ds_read_b32 v203, v203 offset:35328
  ds_read_b32 v204, v204 offset:35328
  ds_read_b32 v205, v205 offset:35328
  ds_read_b32 v206, v206 offset:35328
  ds_read_b32 v207, v207 offset:35328
  ds_read_b32 v208, v208 offset:35328
  ds_read_b32 v209, v209 offset:35328
  ds_read_b32 v210, v210 offset:35328
  ds_read_b32 v211, v211 offset:35328
  ds_read_b32 v212, v212 offset:35328
  ds_read_b32 v213, v213 offset:35328
  ds_read_b32 v214, v214 offset:35328
  ds_read_b32 v215, v215 offset:35328
  s_waitcnt lgkmcnt(12)
  v_add_lshl_u32 v200, v200, v176, 2
  v_add_lshl_u32 v201, v201, v177, 2
  v_add_lshl_u32 v202, v202, v178, 2
  v_add_lshl_u32 v203, v203, v179, 2
  s_waitcnt lgkmcnt(8)
  v_add_lshl_u32 v204, v204, v180, 2
  v_add_lshl_u32 v205, v205, v181, 2
  v_add_lshl_u32 v206, v206, v182, 2
  v_add_lshl_u32 v207, v207, v183, 2
  s_waitcnt lgkmcnt(4)
  v_add_lshl_u32 v208, v208, v184, 2
  v_add_lshl_u32 v209, v209, v185, 2
  v_add_lshl_u32 v210, v210, v186, 2
  v_add_lshl_u32 v211, v211, v187, 2
  s_waitcnt lgkmcnt(0)
  v_add_lshl_u32 v212, v212, v188, 2
  v_add_lshl_u32 v213, v213, v189, 2
  v_add_lshl_u32 v214, v214, v190, 2
  v_add_lshl_u32 v215, v215, v191, 2
  s_mov_b64 exec, s[32:33]
  ds_write2st64_b32 v200, v128, v129 offset0:0 offset1:68
  s_mov_b64 exec, s[34:35]
  ds_write2st64_b32 v201, v130, v131 offset0:0 offset1:68
  s_mov_b64 exec, s[36:37]
  ds_write2st64_b32 v202, v132, v133 offset0:0 offset1:68
  s_mov_b64 exec, s[38:39]
  ds_write2st64_b32 v203, v134, v135 offset0:0 offset1:68
  s_mov_b64 exec, s[40:41]
  ds_write2st64_b32 v204, v136, v137 offset0:0 offset1:68
  s_mov_b64 exec, s[42:43]
  ds_write2st64_b32 v205, v138, v139 offset0:0 offset1:68
  s_mov_b64 exec, s[44:45]
  ds_write2st64_b32 v206, v140, v141 offset0:0 offset1:68
  s_mov_b64 exec, s[46:47]
  ds_write2st64_b32 v207, v142, v143 offset0:0 offset1:68
  s_mov_b64 exec, -1
  v_cmpx_lt_i32 vcc, 0, v216
  ds_write2st64_b32 v208, v144, v145 offset0:0 offset1:68
  v_cmpx_lt_i32 vcc, 1, v216
  ds_write2st64_b32 v209, v146, v147 offset0:0 offset1:68
  s_mov_b64 exec, -1
  v_cmpx_lt_i32 vcc, 0, v217
  ds_write2st64_b32 v210, v148, v149 offset0:0 offset1:68
  v_cmpx_lt_i32 vcc, 1, v217
  ds_write2st64_b32 v211, v150, v151 offset0:0 offset1:68
  s_mov_b64 exec, -1
  v_cmpx_lt_i32 vcc, 0, v218
  ds_write2st64_b32 v212, v152, v153 offset0:0 offset1:68
  v_cmpx_lt_i32 vcc, 1, v218
  ds_write2st64_b32 v213, v154, v155 offset0:0 offset1:68
  s_mov_b64 exec, -1
  v_cmpx_lt_i32 vcc, 0, v219
  ds_write2st64_b32 v214, v156, v157 offset0:0 offset1:68
  v_cmpx_lt_i32 vcc, 1, v219
  ds_write2st64_b32 v215, v158, v159 offset0:0 offset1:68
  s_mov_b64 exec, -1
  s_cmp_eq_u64 s[76:77], 0
  s_cbranch_scc1 NOL2C
  v_cmpx_lt_i32 vcc, 16, v216
  v_lshlrev_b32_sdwa v208, 2, v161 dst_sel:DWORD dst_unused:UNUSED_PAD src0_sel:DWORD src1_sel:BYTE_3
  ds_read_b32 v208, v208 offset:35328
  v_cmpx_lt_i32 vcc, 17, v216
  v_lshlrev_b32_sdwa v209, 2, v163 dst_sel:DWORD dst_unused:UNUSED_PAD src0_sel:DWORD src1_sel:BYTE_3
  ds_read_b32 v209, v209 offset:35328
  s_mov_b64 exec, -1
  v_cmpx_lt_i32 vcc, 16, v217
  v_lshlrev_b32_sdwa v210, 2, v165 dst_sel:DWORD dst_unused:UNUSED_PAD src0_sel:DWORD src1_sel:BYTE_3
  ds_read_b32 v210, v210 offset:35328
  v_cmpx_lt_i32 vcc, 17, v217
  v_lshlrev_b32_sdwa v211, 2, v167 dst_sel:DWORD dst_unused:UNUSED_PAD src0_sel:DWORD src1_sel:BYTE_3
  ds_read_b32 v211, v211 offset:35328
  s_mov_b64 exec, -1
  v_cmpx_lt_i32 vcc, 16, v218
  v_lshlrev_b32_sdwa v212, 2, v169 dst_sel:DWORD dst_unused:UNUSED_PAD src0_sel:DWORD src1_sel:BYTE_3
  ds_read_b32 v212, v212 offset:35328
  v_cmpx_lt_i32 vcc, 17, v218
  v_lshlrev_b32_sdwa v213, 2, v171 dst_sel:DWORD dst_unused:UNUSED_PAD src0_sel:DWORD src1_sel:BYTE_3
  ds_read_b32 v213, v213 offset:35328
  s_mov_b64 exec, -1
  v_cmpx_lt_i32 vcc, 16, v219
  v_lshlrev_b32_sdwa v214, 2, v173 dst_sel:DWORD dst_unused:UNUSED_PAD src0_sel:DWORD src1_sel:BYTE_3
  ds_read_b32 v214, v214 offset:35328
  v_cmpx_lt_i32 vcc, 17, v219
  v_lshlrev_b32_sdwa v215, 2, v175 dst_sel:DWORD dst_unused:UNUSED_PAD src0_sel:DWORD src1_sel:BYTE_3
  ds_read_b32 v215, v215 offset:35328
  s_mov_b64 exec, -1
  s_waitcnt lgkmcnt(0)
  v_cmpx_lt_i32 vcc, 16, v216
  v_add_lshl_u32 v208, v208, v192, 2
  ds_write2st64_b32 v208, v160, v161 offset0:0 offset1:68
  v_cmpx_lt_i32 vcc, 17, v216
  v_add_lshl_u32 v209, v209, v193, 2
  ds_write2st64_b32 v209, v162, v163 offset0:0 offset1:68
  s_mov_b64 exec, -1
  v_cmpx_lt_i32 vcc, 16, v217
  v_add_lshl_u32 v210, v210, v194, 2
  ds_write2st64_b32 v210, v164, v165 offset0:0 offset1:68
  v_cmpx_lt_i32 vcc, 17, v217
  v_add_lshl_u32 v211, v211, v195, 2
  ds_write2st64_b32 v211, v166, v167 offset0:0 offset1:68
  s_mov_b64 exec, -1
  v_cmpx_lt_i32 vcc, 16, v218
  v_add_lshl_u32 v212, v212, v196, 2
  ds_write2st64_b32 v212, v168, v169 offset0:0 offset1:68
  v_cmpx_lt_i32 vcc, 17, v218
  v_add_lshl_u32 v213, v213, v197, 2
  ds_write2st64_b32 v213, v170, v171 offset0:0 offset1:68
  s_mov_b64 exec, -1
  v_cmpx_lt_i32 vcc, 16, v219
  v_add_lshl_u32 v214, v214, v198, 2
  ds_write2st64_b32 v214, v172, v173 offset0:0 offset1:68
  v_cmpx_lt_i32 vcc, 17, v219
  v_add_lshl_u32 v215, v215, v199, 2
  ds_write2st64_b32 v215, v174, v175 offset0:0 offset1:68
  s_mov_b64 exec, -1
NOL2C:
  ds_read_b128 v[200:203], v241
  ds_read_b128 v[204:207], v242
  ds_read_b128 v[208:211], v243
  ds_read_b128 v[212:215], v244
  s_mul_i32 s3, s57, 2176
  v_lshrrev_b32 v2, 3, v0
  v_lshl_add_u32 v250, v2, 4, s3
  v_and_b32 v2, 31, v0
  v_lshl_add_u32 v251, v2, 2, s3
  v_bfe_u32 v2, v0, 2, 2
  v_lshl_add_u32 v2, v2, 4, s3
  v_lshl_add_u32 v252, v254, 2, v2
  v_add_u32 v2, s68, v0
  s_lshl_b32 s69, s59, 5
  v_lshl_add_u32 v3, v2, 2, s3
  s_sub_u32 s3, s58, s69
  v_add_u32 v4, s3, v2
  v_mov_b32 v5, 0xffff
  v_cmp_gt_u32 vcc, s69, v2
  s_nop 1
  v_cndmask_b32 v4, v4, v5, vcc
  v_or_b32 v4, 0xf8000000, v4
  v_mov_b32 v5, 0x00ffffff
  s_add_u32 s69, s69, 32
  v_cmpx_gt_u32 vcc, s69, v2
  ds_write2st64_b32 v3, v4, v5 offset0:0 offset1:68
  s_mov_b64 exec, -1
  s_mov_b32 s63, 0
  s_cmp_eq_u32 s54, 0
  s_cbranch_scc1 NOINIT1
  v_lshlrev_b32 v5, 4, v232
  v_alignbit_b32 v6, v229, v228, v5
  v_lshrrev_b32 v7, v5, v229
  v_lshlrev_b32 v4, 16, v6
  v_and_b32 v5, s65, v6
  v_lshlrev_b32 v6, 16, v7
  v_lshl_add_u32 v9, v0, 3, s67
  s_mov_b64 exec, s[74:75]
  ds_write_b64 v9, v[4:5] offset:512
  ds_write_b32 v9, v6 offset:768
  s_mov_b64 exec, -1
  v_mov_b32 v228, 0
  v_mov_b32 v229, 0
  v_mov_b32 v230, 0
  v_mov_b32 v231, 0
NOINIT1:
  s_waitcnt vmcnt(0) lgkmcnt(0)
  s_barrier
  ds_read_b128 v[224:227], v250 offset:0
  ds_read_b32 v232, v251 offset:0
  ds_read_b32 v1, v251 offset:17408
  s_cmp_gt_i32 s59, -1
  s_cselect_b32 s6, 6400000, 0
  s_cselect_b32 s10, 25600000, 0
  s_cselect_b32 s14, 300000, 0
  s_waitcnt lgkmcnt(0)
  v_mad_u32_u24 v1, v1, 32, v254
  buffer_load_dwordx4 v[216:219], v1, s[8:11], 0 offen
  s_add_u32 m0, s66, 0
  v_mad_u32_u24 v224, v224, s64, v237
  buffer_load_dwordx4 v224, s[4:7], 0 offen  lds
  s_add_u32 m0, s66, 1024
  v_mad_u32_u24 v225, v225, s64, v238
  buffer_load_dwordx4 v225, s[4:7], 0 offen  lds
  s_add_u32 m0, s66, 2048
  v_mad_u32_u24 v226, v226, s64, v239
  buffer_load_dwordx4 v226, s[4:7], 0 offen  lds
  s_add_u32 m0, s66, 3072
  v_mad_u32_u24 v227, v227, s64, v240
  buffer_load_dwordx4 v227, s[4:7], 0 offen  lds
  v_mul_u32_u24 v1, 6, v232
  v_and_b32 v1, -4, v1
  s_mov_b64 exec, s[74:75]
  buffer_load_dwordx2 v[228:229], v1, s[12:15], 0 offen
  s_mov_b64 exec, -1
  ds_read_b128 v[224:227], v250 offset:128
  ds_read_b32 v233, v251 offset:128
  ds_read_b32 v1, v251 offset:17536
  s_cmp_gt_i32 s59, 0
  s_cselect_b32 s6, 6400000, 0
  s_cselect_b32 s10, 25600000, 0
  s_cselect_b32 s14, 300000, 0
  s_waitcnt lgkmcnt(0)
  v_mad_u32_u24 v1, v1, 32, v254
  buffer_load_dwordx4 v[220:223], v1, s[8:11], 0 offen
  s_add_u32 m0, s66, 4096
  v_mad_u32_u24 v224, v224, s64, v237
  buffer_load_dwordx4 v224, s[4:7], 0 offen  lds
  s_add_u32 m0, s66, 5120
  v_mad_u32_u24 v225, v225, s64, v238
  buffer_load_dwordx4 v225, s[4:7], 0 offen  lds
  s_add_u32 m0, s66, 6144
  v_mad_u32_u24 v226, v226, s64, v239
  buffer_load_dwordx4 v226, s[4:7], 0 offen  lds
  s_add_u32 m0, s66, 7168
  v_mad_u32_u24 v227, v227, s64, v240
  buffer_load_dwordx4 v227, s[4:7], 0 offen  lds
  v_mul_u32_u24 v1, 6, v233
  v_and_b32 v1, -4, v1
  s_mov_b64 exec, s[74:75]
  buffer_load_dwordx2 v[230:231], v1, s[12:15], 0 offen
  s_mov_b64 exec, -1
  s_waitcnt lgkmcnt(0)
  s_cmp_eq_u32 s54, 0
  s_cbranch_scc1 NOINIT2
  v_lshlrev_b32 v2, 4, v0
  v_add_u32 v2, 44544, v2
  ds_read_b128 v[128:131], v2 offset:0
  ds_read_b128 v[132:135], v2 offset:1024
  ds_read_b128 v[136:139], v2 offset:2048
  ds_read_b128 v[140:143], v2 offset:3072
  ds_read_b128 v[144:147], v2 offset:4096
  ds_read_b128 v[148:151], v2 offset:5120
  ds_read_b128 v[152:155], v2 offset:6144
  ds_read_b128 v[156:159], v2 offset:7168
  ds_read_b64 v[4:5], v2 offset:18432
  ds_read_b128 v[16:19], v2 offset:8192
  ds_read_b128 v[20:23], v2 offset:9216
  ds_read_b128 v[24:27], v2 offset:10240
  ds_read_b128 v[28:31], v2 offset:11264
  ds_read_b128 v[32:35], v2 offset:12288
  ds_read_b128 v[36:39], v2 offset:13312
  ds_read_b128 v[40:43], v2 offset:14336
  ds_read_b128 v[44:47], v2 offset:15360
  ds_read_b128 v[48:51], v2 offset:16384
  ds_read_b128 v[52:55], v2 offset:17408
  ds_read_b128 v[72:75], v2 offset:20480
  ds_read_b128 v[76:79], v2 offset:21504
  ds_read_b128 v[80:83], v2 offset:22528
  ds_read_b128 v[84:87], v2 offset:23552
  s_waitcnt lgkmcnt(15)
  v_mfma_f32_32x32x16_bf16 v[160:175], v[200:203], v[128:131], 0
  v_mfma_f32_32x32x16_bf16 v[176:191], v[200:203], v[144:147], 0
  v_mfma_f32_32x32x16_bf16 v[160:175], v[204:207], v[132:135], v[160:175]
  v_mfma_f32_32x32x16_bf16 v[176:191], v[204:207], v[148:151], v[176:191]
  v_mfma_f32_32x32x16_bf16 v[160:175], v[208:211], v[136:139], v[160:175]
  v_mfma_f32_32x32x16_bf16 v[176:191], v[208:211], v[152:155], v[176:191]
  v_mfma_f32_32x32x16_bf16 v[160:175], v[212:215], v[140:143], v[160:175]
  v_mfma_f32_32x32x16_bf16 v[176:191], v[212:215], v[156:159], v[176:191]
  s_waitcnt lgkmcnt(0)
  s_barrier
  s_mov_b32 s54, 0
  v_mov_b32 v63, v4
  v_mov_b32 v71, v5
  s_nop 5
  v_pk_mul_f32 v[160:161], v[160:161], s[70:71]
  v_cvt_pk_f16_f32 v56, v160, v161
  v_pk_mul_f32 v[162:163], v[162:163], s[70:71]
  v_cvt_pk_f16_f32 v57, v162, v163
  v_pk_mul_f32 v[164:165], v[164:165], s[70:71]
  v_cvt_pk_f16_f32 v58, v164, v165
  v_pk_mul_f32 v[166:167], v[166:167], s[70:71]
  v_cvt_pk_f16_f32 v59, v166, v167
  v_pk_mul_f32 v[168:169], v[168:169], s[70:71]
  v_cvt_pk_f16_f32 v60, v168, v169
  v_pk_mul_f32 v[170:171], v[170:171], s[70:71]
  v_cvt_pk_f16_f32 v61, v170, v171
  v_pk_mul_f32 v[172:173], v[172:173], s[70:71]
  v_cvt_pk_f16_f32 v62, v172, v173
  v_pk_mul_f32 v[176:177], v[176:177], s[70:71]
  v_cvt_pk_f16_f32 v64, v176, v177
  v_pk_mul_f32 v[178:179], v[178:179], s[70:71]
  v_cvt_pk_f16_f32 v65, v178, v179
  v_pk_mul_f32 v[180:181], v[180:181], s[70:71]
  v_cvt_pk_f16_f32 v66, v180, v181
  v_pk_mul_f32 v[182:183], v[182:183], s[70:71]
  v_cvt_pk_f16_f32 v67, v182, v183
  v_pk_mul_f32 v[184:185], v[184:185], s[70:71]
  v_cvt_pk_f16_f32 v68, v184, v185
  v_pk_mul_f32 v[186:187], v[186:187], s[70:71]
  v_cvt_pk_f16_f32 v69, v186, v187
  v_pk_mul_f32 v[188:189], v[188:189], s[70:71]
  v_cvt_pk_f16_f32 v70, v188, v189
NOINIT2:
  v_mov_b32 v184, 0
  v_mov_b32 v168, 0
  v_mov_b32 v185, 0
  v_mov_b32 v169, 0
  v_mov_b32 v186, 0
  v_mov_b32 v170, 0
  v_mov_b32 v187, 0
  v_mov_b32 v171, 0
  v_mov_b32 v188, 0
  v_mov_b32 v172, 0
  v_mov_b32 v189, 0
  v_mov_b32 v173, 0
  v_mov_b32 v190, 0
  v_mov_b32 v174, 0
  v_mov_b32 v191, 0
  v_mov_b32 v175, 0
  v_mov_b32 v124, 0
  v_mov_b32 v125, 0
  v_mov_b32 v126, 0
  v_mov_b32 v127, 0
  v_mov_b32 v13, 0
  v_mov_b32 v14, 0
  v_mov_b32 v15, 0
  s_mul_i32 s3, s57, 4608
  s_add_u32 s3, s3, 44544
  v_lshl_add_u32 v2, v0, 3, s3
  ds_write_b64 v2, v[184:185] offset:0
  ds_write_b64 v2, v[184:185] offset:512
  ds_write_b64 v2, v[184:185] offset:1024
  ds_write_b64 v2, v[184:185] offset:1536
  ds_write_b64 v2, v[184:185] offset:2048
  ds_write_b64 v2, v[184:185] offset:2560
  ds_write_b64 v2, v[184:185] offset:3072
  ds_write_b64 v2, v[184:185] offset:3584
  ds_write_b64 v2, v[184:185] offset:4096
  s_waitcnt vmcnt(6)
  ds_read_b128 v[200:203], v241 offset:0
  ds_read_b128 v[204:207], v242 offset:0
  ds_read_b128 v[208:211], v243 offset:0
  ds_read_b128 v[212:215], v244 offset:0
  v_add_u32_sdwa v253, v245, v232 dst_sel:DWORD dst_unused:UNUSED_PAD src0_sel:DWORD src1_sel:BYTE_3
  ds_read_b64 v[234:235], v253 offset:480
  ds_read_b32 v236, v253 offset:736
  v_lshlrev_b32 v125, 4, v232
  v_alignbit_b32 v126, v229, v228, v125
  v_lshrrev_b32 v127, v125, v229
  ds_read_b64 v[176:177], v253 offset:192
  ds_read_b64 v[178:179], v253 offset:128
  ds_read_b64 v[180:181], v253 offset:64
  ds_read_b32 v182, v253
  ds_read_b128 v[224:227], v250 offset:256
  ds_read_b32 v232, v251 offset:256
  ds_read_b32 v1, v251 offset:17664
  v_lshlrev_b32 v125, 16, v126
  v_and_b32 v126, s65, v126
  v_lshlrev_b32 v127, 16, v127
  s_waitcnt lgkmcnt(8)
  v_sub_f32 v234, v234, v125
  v_sub_f32 v235, v235, v126
  s_waitcnt lgkmcnt(7)
  v_sub_f32 v236, v236, v127
  v_cvt_pk_bf16_f32 v234, v234, v235
  v_cvt_pk_bf16_f32 v236, v236, v236
  v_lshlrev_b32 v10, 16, v234
  v_and_b32 v11, s65, v234
  v_lshlrev_b32 v12, 16, v236
  v_mul_f32 v234, v10, v10
  v_fmac_f32 v234, v11, v11
  v_fmac_f32 v234, v12, v12
  v_cvt_pk_f16_f32 v183, v234, v234
  v_mfma_f32_32x32x16_bf16 v[128:143], v[48:51], v[216:219], 0
  v_mfma_f32_32x32x16_bf16 v[144:159], v[52:55], v[216:219], 0
  v_mfma_f32_32x32x16_bf16 v[128:143], v[16:19], v[200:203], v[128:143]
  v_mfma_f32_32x32x16_bf16 v[128:143], v[20:23], v[204:207], v[128:143]
  v_mfma_f32_32x32x16_bf16 v[128:143], v[24:27], v[208:211], v[128:143]
  v_mfma_f32_32x32x16_bf16 v[128:143], v[28:31], v[212:215], v[128:143]
  s_waitcnt lgkmcnt(5)
  v_mfma_f32_32x32x16_f16 v[128:143], v[56:59], v[176:179], v[128:143]
  s_waitcnt lgkmcnt(3)
  v_mfma_f32_32x32x16_f16 v[128:143], v[60:63], v[180:183], v[128:143]
  s_cmp_gt_i32 s59, 1
  s_cselect_b32 s6, 6400000, 0
  s_cselect_b32 s10, 25600000, 0
  s_cselect_b32 s14, 300000, 0
  s_waitcnt lgkmcnt(0)
  v_mad_u32_u24 v1, v1, 32, v254
  buffer_load_dwordx4 v[216:219], v1, s[8:11], 0 offen
  s_add_u32 m0, s66, 0
  v_mad_u32_u24 v224, v224, s64, v237
  buffer_load_dwordx4 v224, s[4:7], 0 offen  lds
  s_add_u32 m0, s66, 1024
  v_mad_u32_u24 v225, v225, s64, v238
  buffer_load_dwordx4 v225, s[4:7], 0 offen  lds
  s_add_u32 m0, s66, 2048
  v_mad_u32_u24 v226, v226, s64, v239
  buffer_load_dwordx4 v226, s[4:7], 0 offen  lds
  s_add_u32 m0, s66, 3072
  v_mad_u32_u24 v227, v227, s64, v240
  buffer_load_dwordx4 v227, s[4:7], 0 offen  lds
  v_mul_u32_u24 v1, 6, v232
  v_and_b32 v1, -4, v1
  s_mov_b64 exec, s[74:75]
  buffer_load_dwordx2 v[228:229], v1, s[12:15], 0 offen
  s_mov_b64 exec, -1
  s_waitcnt lgkmcnt(0)
  s_cmp_eq_u32 s59, 0
  s_cbranch_scc1 LOOPEND
  s_movk_i32 s79, 0
LOOP:
  ds_read_b64_tr_b16 v[192:193], v248 offset:64
  ds_read_b64_tr_b16 v[194:195], v248 offset:208
  ds_read_b64_tr_b16 v[196:197], v248 offset:352
  ds_read_b64_tr_b16 v[198:199], v248 offset:496
  v_cvt_pk_f16_f32 v160, v128, v129
  v_cvt_pk_f16_f32 v161, v130, v131
  v_cvt_pk_f16_f32 v162, v132, v133
  v_cvt_pk_f16_f32 v163, v134, v135
  v_cvt_pk_f16_f32 v164, v136, v137
  v_cvt_pk_f16_f32 v165, v138, v139
  v_cvt_pk_f16_f32 v166, v140, v141
  v_cvt_pk_f16_f32 v167, v142, v143
  v_mfma_f32_16x16x32_f16 v[124:127], v[80:83], v[168:171], v[124:127]
  v_exp_f16_sdwa v2, v160 dst_sel:WORD_0 dst_unused:UNUSED_PAD src0_sel:WORD_0
  s_mov_b64 exec, 1
  ds_add_rtn_u32 v255, v0, v238 offset:35336
  s_mov_b64 exec, -1
  v_exp_f16_sdwa v3, v161 dst_sel:WORD_0 dst_unused:UNUSED_PAD src0_sel:WORD_0
  v_mfma_f32_16x16x32_f16 v[124:127], v[84:87], v[172:175], v[124:127]
  v_exp_f16_sdwa v4, v162 dst_sel:WORD_0 dst_unused:UNUSED_PAD src0_sel:WORD_0
  v_exp_f16_sdwa v5, v163 dst_sel:WORD_0 dst_unused:UNUSED_PAD src0_sel:WORD_0
  v_mfma_f32_32x32x16_bf16 v[144:159], v[32:35], v[200:203], v[144:159]
  s_waitcnt vmcnt(6)
  ds_read_b128 v[200:203], v241 offset:4096
  v_exp_f16_sdwa v2, v160 dst_sel:WORD_1 dst_unused:UNUSED_PRESERVE src0_sel:WORD_1
  v_exp_f16_sdwa v3, v161 dst_sel:WORD_1 dst_unused:UNUSED_PRESERVE src0_sel:WORD_1
  v_exp_f16_sdwa v4, v162 dst_sel:WORD_1 dst_unused:UNUSED_PRESERVE src0_sel:WORD_1
  s_waitcnt lgkmcnt(4)
  v_mfma_f32_32x32x16_f16 v[104:119], v[192:195], v[184:187], v[104:119]
  v_exp_f16_sdwa v5, v163 dst_sel:WORD_1 dst_unused:UNUSED_PRESERVE src0_sel:WORD_1
  v_pk_add_f16 v2, v2, 1.0 op_sel_hi:[1,0]
  v_pk_add_f16 v3, v3, 1.0 op_sel_hi:[1,0]
  v_pk_add_f16 v4, v4, 1.0 op_sel_hi:[1,0]
  v_pk_add_f16 v5, v5, 1.0 op_sel_hi:[1,0]
  v_mul_f32 v234, v13, v124
  v_mul_f32 v235, v14, v124
  v_mul_f32 v236, v15, v124
  v_cvt_pk_f16_f32 v234, v234, v235
  v_cvt_pk_f16_f32 v235, v236, v236
  s_mov_b64 exec, s[74:75]
  ds_write_b64 v246, v[234:235] offset:128
  s_mov_b64 exec, -1
  v_rcp_f16_sdwa v6, v2 dst_sel:WORD_0 dst_unused:UNUSED_PAD src0_sel:WORD_0
  v_rcp_f16_sdwa v7, v3 dst_sel:WORD_0 dst_unused:UNUSED_PAD src0_sel:WORD_0
  s_waitcnt lgkmcnt(3)
  v_mfma_f32_32x32x16_f16 v[104:119], v[196:199], v[188:191], v[104:119]
  ds_read_b64_tr_b16 v[192:193], v249 offset:0
  ds_read_b64_tr_b16 v[194:195], v249 offset:144
  ds_read_b64_tr_b16 v[196:197], v249 offset:288
  ds_read_b64_tr_b16 v[198:199], v249 offset:432
  v_rcp_f16_sdwa v8, v4 dst_sel:WORD_0 dst_unused:UNUSED_PAD src0_sel:WORD_0
  s_waitcnt lgkmcnt(6)
  v_readfirstlane_b32 s68, v255
  s_setprio 1
  s_cmp_lt_u32 s68, s79
  s_cbranch_scc0 PRI0
  s_setprio 0
PRI0:
  s_add_u32 s79, s79, 128
  v_rcp_f16_sdwa v9, v5 dst_sel:WORD_0 dst_unused:UNUSED_PAD src0_sel:WORD_0
  v_add_u32_sdwa v253, v245, v233 dst_sel:DWORD dst_unused:UNUSED_PAD src0_sel:DWORD src1_sel:BYTE_3
  ds_read_b64 v[234:235], v253 offset:480
  ds_read_b32 v236, v253 offset:736
  v_lshlrev_b32 v125, 4, v233
  v_alignbit_b32 v126, v231, v230, v125
  v_lshrrev_b32 v127, v125, v231
  v_rcp_f16_sdwa v6, v2 dst_sel:WORD_1 dst_unused:UNUSED_PRESERVE src0_sel:WORD_1
  v_mfma_f32_32x32x16_bf16 v[144:159], v[36:39], v[204:207], v[144:159]
  ds_read_b128 v[204:207], v242 offset:4096
  v_rcp_f16_sdwa v7, v3 dst_sel:WORD_1 dst_unused:UNUSED_PRESERVE src0_sel:WORD_1
  v_rcp_f16_sdwa v8, v4 dst_sel:WORD_1 dst_unused:UNUSED_PRESERVE src0_sel:WORD_1
  v_rcp_f16_sdwa v9, v5 dst_sel:WORD_1 dst_unused:UNUSED_PRESERVE src0_sel:WORD_1
  v_pk_mul_f16 v160, v160, v6
  v_pk_mul_f16 v161, v161, v7
  v_pk_mul_f16 v162, v162, v8
  v_pk_mul_f16 v163, v163, v9
  ds_write_b128 v246, v[160:163] offset:0
  v_mfma_f32_32x32x16_bf16 v[144:159], v[40:43], v[208:211], v[144:159]
  ds_read_b128 v[208:211], v243 offset:4096
  ds_read_b128 v[224:227], v250 offset:384
  ds_read_b32 v233, v251 offset:384
  ds_read_b32 v1, v251 offset:17792
  v_exp_f16_sdwa v2, v164 dst_sel:WORD_0 dst_unused:UNUSED_PAD src0_sel:WORD_0
  v_exp_f16_sdwa v3, v165 dst_sel:WORD_0 dst_unused:UNUSED_PAD src0_sel:WORD_0
  v_lshlrev_b32 v125, 16, v126
  v_and_b32 v126, s65, v126
  v_lshlrev_b32 v127, 16, v127
  v_exp_f16_sdwa v4, v166 dst_sel:WORD_0 dst_unused:UNUSED_PAD src0_sel:WORD_0
  v_mfma_f32_32x32x16_bf16 v[144:159], v[44:47], v[212:215], v[144:159]
  ds_read_b128 v[212:215], v244 offset:4096
  v_exp_f16_sdwa v5, v167 dst_sel:WORD_0 dst_unused:UNUSED_PAD src0_sel:WORD_0
  v_exp_f16_sdwa v2, v164 dst_sel:WORD_1 dst_unused:UNUSED_PRESERVE src0_sel:WORD_1
  v_exp_f16_sdwa v3, v165 dst_sel:WORD_1 dst_unused:UNUSED_PRESERVE src0_sel:WORD_1
  v_mfma_f32_32x32x16_f16 v[144:159], v[64:67], v[176:179], v[144:159]
  v_exp_f16_sdwa v4, v166 dst_sel:WORD_1 dst_unused:UNUSED_PRESERVE src0_sel:WORD_1
  s_waitcnt lgkmcnt(8)
  v_sub_f32 v234, v234, v125
  v_sub_f32 v235, v235, v126
  s_waitcnt lgkmcnt(7)
  v_sub_f32 v236, v236, v127
  v_cvt_pk_bf16_f32 v234, v234, v235
  v_cvt_pk_bf16_f32 v236, v236, v236
  v_lshlrev_b32 v13, 16, v234
  v_and_b32 v14, s65, v234
  v_lshlrev_b32 v15, 16, v236
  v_exp_f16_sdwa v5, v167 dst_sel:WORD_1 dst_unused:UNUSED_PRESERVE src0_sel:WORD_1
  v_pk_add_f16 v2, v2, 1.0 op_sel_hi:[1,0]
  v_pk_add_f16 v3, v3, 1.0 op_sel_hi:[1,0]
  v_pk_add_f16 v4, v4, 1.0 op_sel_hi:[1,0]
  v_pk_add_f16 v5, v5, 1.0 op_sel_hi:[1,0]
  v_rcp_f16_sdwa v6, v2 dst_sel:WORD_0 dst_unused:UNUSED_PAD src0_sel:WORD_0
  v_mfma_f32_32x32x16_f16 v[144:159], v[68:71], v[180:183], v[144:159]
  ds_read_b64 v[176:177], v253 offset:192
  ds_read_b64 v[178:179], v253 offset:128
  ds_read_b64 v[180:181], v253 offset:64
  ds_read_b32 v182, v253
  v_rcp_f16_sdwa v7, v3 dst_sel:WORD_0 dst_unused:UNUSED_PAD src0_sel:WORD_0
  v_rcp_f16_sdwa v8, v4 dst_sel:WORD_0 dst_unused:UNUSED_PAD src0_sel:WORD_0
  v_rcp_f16_sdwa v9, v5 dst_sel:WORD_0 dst_unused:UNUSED_PAD src0_sel:WORD_0
  v_mfma_f32_16x16x32_f16 v[120:123], v[192:195], v[184:187], v[120:123]
  v_rcp_f16_sdwa v6, v2 dst_sel:WORD_1 dst_unused:UNUSED_PRESERVE src0_sel:WORD_1
  v_rcp_f16_sdwa v7, v3 dst_sel:WORD_1 dst_unused:UNUSED_PRESERVE src0_sel:WORD_1
  v_mfma_f32_16x16x32_f16 v[120:123], v[196:199], v[188:191], v[120:123]
  ds_read_b128 v[184:187], v252 offset:0
  v_rcp_f16_sdwa v8, v4 dst_sel:WORD_1 dst_unused:UNUSED_PRESERVE src0_sel:WORD_1
  v_rcp_f16_sdwa v9, v5 dst_sel:WORD_1 dst_unused:UNUSED_PRESERVE src0_sel:WORD_1
  v_pk_mul_f16 v164, v164, v6
  v_pk_mul_f16 v165, v165, v7
  v_pk_mul_f16 v166, v166, v8
  v_pk_mul_f16 v167, v167, v9
  ds_write_b128 v246, v[164:167] offset:16
  ds_read_b64_tr_b16 v[192:193], v248 offset:0
  ds_read_b64_tr_b16 v[194:195], v248 offset:144
  ds_read_b64_tr_b16 v[196:197], v248 offset:288
  ds_read_b64_tr_b16 v[198:199], v248 offset:432
  v_cvt_pk_f16_f32 v168, v144, v145
  v_cvt_pk_f16_f32 v169, v146, v147
  v_cvt_pk_f16_f32 v170, v148, v149
  v_cvt_pk_f16_f32 v171, v150, v151
  v_cvt_pk_f16_f32 v172, v152, v153
  v_cvt_pk_f16_f32 v173, v154, v155
  v_cvt_pk_f16_f32 v174, v156, v157
  v_cvt_pk_f16_f32 v175, v158, v159
  v_mfma_f32_32x32x16_bf16 v[128:143], v[48:51], v[220:223], 0
  v_exp_f16_sdwa v2, v168 dst_sel:WORD_0 dst_unused:UNUSED_PAD src0_sel:WORD_0
  v_exp_f16_sdwa v3, v169 dst_sel:WORD_0 dst_unused:UNUSED_PAD src0_sel:WORD_0
  v_exp_f16_sdwa v4, v170 dst_sel:WORD_0 dst_unused:UNUSED_PAD src0_sel:WORD_0
  v_mfma_f32_32x32x16_bf16 v[144:159], v[52:55], v[220:223], 0
  s_cmp_gt_i32 s59, 2
  s_cselect_b32 s6, 6400000, 0
  s_cselect_b32 s10, 25600000, 0
  s_cselect_b32 s14, 300000, 0
  s_waitcnt lgkmcnt(11)
  v_mad_u32_u24 v1, v1, 32, v254
  buffer_load_dwordx4 v[220:223], v1, s[8:11], 0 offen
  v_exp_f16_sdwa v5, v171 dst_sel:WORD_0 dst_unused:UNUSED_PAD src0_sel:WORD_0
  v_exp_f16_sdwa v2, v168 dst_sel:WORD_1 dst_unused:UNUSED_PRESERVE src0_sel:WORD_1
  v_mfma_f32_32x32x16_bf16 v[128:143], v[16:19], v[200:203], v[128:143]
  s_add_u32 m0, s66, 4096
  v_mad_u32_u24 v224, v224, s64, v237
  s_waitcnt lgkmcnt(10)
  buffer_load_dwordx4 v224, s[4:7], 0 offen  lds
  v_exp_f16_sdwa v3, v169 dst_sel:WORD_1 dst_unused:UNUSED_PRESERVE src0_sel:WORD_1
  v_exp_f16_sdwa v4, v170 dst_sel:WORD_1 dst_unused:UNUSED_PRESERVE src0_sel:WORD_1
  s_waitcnt lgkmcnt(5)
  v_add_u32_sdwa v184, v247, v184 dst_sel:DWORD dst_unused:UNUSED_PAD src0_sel:DWORD src1_sel:BYTE_3
  v_add_u32_sdwa v185, v247, v185 dst_sel:DWORD dst_unused:UNUSED_PAD src0_sel:DWORD src1_sel:BYTE_3
  v_add_u32_sdwa v186, v247, v186 dst_sel:DWORD dst_unused:UNUSED_PAD src0_sel:DWORD src1_sel:BYTE_3
  v_add_u32_sdwa v187, v247, v187 dst_sel:DWORD dst_unused:UNUSED_PAD src0_sel:DWORD src1_sel:BYTE_3
  ds_read_b64_tr_b16 v[190:191], v187
  ds_read_b64_tr_b16 v[188:189], v186
  ds_read_b64_tr_b16 v[186:187], v185
  ds_read_b64_tr_b16 v[184:185], v184
  v_exp_f16_sdwa v5, v171 dst_sel:WORD_1 dst_unused:UNUSED_PRESERVE src0_sel:WORD_1
  v_pk_add_f16 v2, v2, 1.0 op_sel_hi:[1,0]
  v_pk_add_f16 v3, v3, 1.0 op_sel_hi:[1,0]
  v_pk_add_f16 v4, v4, 1.0 op_sel_hi:[1,0]
  v_pk_add_f16 v5, v5, 1.0 op_sel_hi:[1,0]
  v_mfma_f32_32x32x16_bf16 v[128:143], v[20:23], v[204:207], v[128:143]
  s_add_u32 m0, s66, 5120
  v_mad_u32_u24 v225, v225, s64, v238
  buffer_load_dwordx4 v225, s[4:7], 0 offen  lds
  v_rcp_f16_sdwa v6, v2 dst_sel:WORD_0 dst_unused:UNUSED_PAD src0_sel:WORD_0
  v_rcp_f16_sdwa v7, v3 dst_sel:WORD_0 dst_unused:UNUSED_PAD src0_sel:WORD_0
  v_rcp_f16_sdwa v8, v4 dst_sel:WORD_0 dst_unused:UNUSED_PAD src0_sel:WORD_0
  v_mfma_f32_32x32x16_bf16 v[128:143], v[24:27], v[208:211], v[128:143]
  s_add_u32 m0, s66, 6144
  v_mad_u32_u24 v226, v226, s64, v239
  buffer_load_dwordx4 v226, s[4:7], 0 offen  lds
  v_rcp_f16_sdwa v9, v5 dst_sel:WORD_0 dst_unused:UNUSED_PAD src0_sel:WORD_0
  v_rcp_f16_sdwa v6, v2 dst_sel:WORD_1 dst_unused:UNUSED_PRESERVE src0_sel:WORD_1
  v_mfma_f32_32x32x16_bf16 v[128:143], v[28:31], v[212:215], v[128:143]
  s_add_u32 m0, s66, 7168
  v_mad_u32_u24 v227, v227, s64, v240
  buffer_load_dwordx4 v227, s[4:7], 0 offen  lds
  v_rcp_f16_sdwa v7, v3 dst_sel:WORD_1 dst_unused:UNUSED_PRESERVE src0_sel:WORD_1
  v_rcp_f16_sdwa v8, v4 dst_sel:WORD_1 dst_unused:UNUSED_PRESERVE src0_sel:WORD_1
  v_mul_f32 v234, v13, v13
  v_fmac_f32 v234, v14, v14
  v_fmac_f32 v234, v15, v15
  v_cvt_pk_f16_f32 v183, v234, v234
  v_rcp_f16_sdwa v9, v5 dst_sel:WORD_1 dst_unused:UNUSED_PRESERVE src0_sel:WORD_1
  v_pk_mul_f16 v168, v168, v6
  v_pk_mul_f16 v169, v169, v7
  v_pk_mul_f16 v170, v170, v8
  v_pk_mul_f16 v171, v171, v9
  ds_write_b128 v246, v[168:171] offset:64
  v_mfma_f32_16x16x32_f16 v[124:127], v[72:75], v[160:163], 0
  v_exp_f16_sdwa v2, v172 dst_sel:WORD_0 dst_unused:UNUSED_PAD src0_sel:WORD_0
  v_mul_u32_u24 v1, 6, v233
  v_and_b32 v1, -4, v1
  s_mov_b64 exec, s[74:75]
  buffer_load_dwordx2 v[230:231], v1, s[12:15], 0 offen
  s_mov_b64 exec, -1
  v_exp_f16_sdwa v3, v173 dst_sel:WORD_0 dst_unused:UNUSED_PAD src0_sel:WORD_0
  v_mfma_f32_16x16x32_f16 v[124:127], v[76:79], v[164:167], v[124:127]
  v_exp_f16_sdwa v4, v174 dst_sel:WORD_0 dst_unused:UNUSED_PAD src0_sel:WORD_0
  v_exp_f16_sdwa v5, v175 dst_sel:WORD_0 dst_unused:UNUSED_PAD src0_sel:WORD_0
  v_mfma_f32_32x32x16_f16 v[128:143], v[56:59], v[176:179], v[128:143]
  v_exp_f16_sdwa v2, v172 dst_sel:WORD_1 dst_unused:UNUSED_PRESERVE src0_sel:WORD_1
  v_exp_f16_sdwa v3, v173 dst_sel:WORD_1 dst_unused:UNUSED_PRESERVE src0_sel:WORD_1
  v_exp_f16_sdwa v4, v174 dst_sel:WORD_1 dst_unused:UNUSED_PRESERVE src0_sel:WORD_1
  v_mfma_f32_32x32x16_f16 v[128:143], v[60:63], v[180:183], v[128:143]
  v_exp_f16_sdwa v5, v175 dst_sel:WORD_1 dst_unused:UNUSED_PRESERVE src0_sel:WORD_1
  v_pk_add_f16 v2, v2, 1.0 op_sel_hi:[1,0]
  v_pk_add_f16 v3, v3, 1.0 op_sel_hi:[1,0]
  v_pk_add_f16 v4, v4, 1.0 op_sel_hi:[1,0]
  v_pk_add_f16 v5, v5, 1.0 op_sel_hi:[1,0]
  v_rcp_f16_sdwa v6, v2 dst_sel:WORD_0 dst_unused:UNUSED_PAD src0_sel:WORD_0
  v_rcp_f16_sdwa v7, v3 dst_sel:WORD_0 dst_unused:UNUSED_PAD src0_sel:WORD_0
  s_waitcnt lgkmcnt(1)
  v_mfma_f32_32x32x16_f16 v[88:103], v[192:195], v[184:187], v[88:103]
  v_rcp_f16_sdwa v8, v4 dst_sel:WORD_0 dst_unused:UNUSED_PAD src0_sel:WORD_0
  v_rcp_f16_sdwa v9, v5 dst_sel:WORD_0 dst_unused:UNUSED_PAD src0_sel:WORD_0
  v_rcp_f16_sdwa v6, v2 dst_sel:WORD_1 dst_unused:UNUSED_PRESERVE src0_sel:WORD_1
  v_mfma_f32_32x32x16_f16 v[88:103], v[196:199], v[188:191], v[88:103]
  v_rcp_f16_sdwa v7, v3 dst_sel:WORD_1 dst_unused:UNUSED_PRESERVE src0_sel:WORD_1
  v_rcp_f16_sdwa v8, v4 dst_sel:WORD_1 dst_unused:UNUSED_PRESERVE src0_sel:WORD_1
  v_rcp_f16_sdwa v9, v5 dst_sel:WORD_1 dst_unused:UNUSED_PRESERVE src0_sel:WORD_1
  v_pk_mul_f16 v172, v172, v6
  v_pk_mul_f16 v173, v173, v7
  v_pk_mul_f16 v174, v174, v8
  v_pk_mul_f16 v175, v175, v9
  ds_write_b128 v246, v[172:175] offset:80
  s_sub_u32 s59, s59, 1
  s_cmp_eq_u32 s59, 0
  s_cbranch_scc1 TAIL0
  ds_read_b64_tr_b16 v[192:193], v248 offset:64
  ds_read_b64_tr_b16 v[194:195], v248 offset:208
  ds_read_b64_tr_b16 v[196:197], v248 offset:352
  ds_read_b64_tr_b16 v[198:199], v248 offset:496
  v_cvt_pk_f16_f32 v160, v128, v129
  v_cvt_pk_f16_f32 v161, v130, v131
  v_cvt_pk_f16_f32 v162, v132, v133
  v_cvt_pk_f16_f32 v163, v134, v135
  v_cvt_pk_f16_f32 v164, v136, v137
  v_cvt_pk_f16_f32 v165, v138, v139
  v_cvt_pk_f16_f32 v166, v140, v141
  v_cvt_pk_f16_f32 v167, v142, v143
  v_mfma_f32_16x16x32_f16 v[124:127], v[80:83], v[168:171], v[124:127]
  v_exp_f16_sdwa v2, v160 dst_sel:WORD_0 dst_unused:UNUSED_PAD src0_sel:WORD_0
  s_mov_b64 exec, 1
  ds_add_rtn_u32 v255, v0, v238 offset:35336
  s_mov_b64 exec, -1
  v_exp_f16_sdwa v3, v161 dst_sel:WORD_0 dst_unused:UNUSED_PAD src0_sel:WORD_0
  v_mfma_f32_16x16x32_f16 v[124:127], v[84:87], v[172:175], v[124:127]
  v_exp_f16_sdwa v4, v162 dst_sel:WORD_0 dst_unused:UNUSED_PAD src0_sel:WORD_0
  v_exp_f16_sdwa v5, v163 dst_sel:WORD_0 dst_unused:UNUSED_PAD src0_sel:WORD_0
  v_mfma_f32_32x32x16_bf16 v[144:159], v[32:35], v[200:203], v[144:159]
  s_waitcnt vmcnt(6)
  ds_read_b128 v[200:203], v241 offset:0
  v_exp_f16_sdwa v2, v160 dst_sel:WORD_1 dst_unused:UNUSED_PRESERVE src0_sel:WORD_1
  v_exp_f16_sdwa v3, v161 dst_sel:WORD_1 dst_unused:UNUSED_PRESERVE src0_sel:WORD_1
  v_exp_f16_sdwa v4, v162 dst_sel:WORD_1 dst_unused:UNUSED_PRESERVE src0_sel:WORD_1
  s_waitcnt lgkmcnt(4)
  v_mfma_f32_32x32x16_f16 v[104:119], v[192:195], v[184:187], v[104:119]
  v_exp_f16_sdwa v5, v163 dst_sel:WORD_1 dst_unused:UNUSED_PRESERVE src0_sel:WORD_1
  v_pk_add_f16 v2, v2, 1.0 op_sel_hi:[1,0]
  v_pk_add_f16 v3, v3, 1.0 op_sel_hi:[1,0]
  v_pk_add_f16 v4, v4, 1.0 op_sel_hi:[1,0]
  v_pk_add_f16 v5, v5, 1.0 op_sel_hi:[1,0]
  v_mul_f32 v234, v10, v124
  v_mul_f32 v235, v11, v124
  v_mul_f32 v236, v12, v124
  v_cvt_pk_f16_f32 v234, v234, v235
  v_cvt_pk_f16_f32 v235, v236, v236
  s_mov_b64 exec, s[74:75]
  ds_write_b64 v246, v[234:235] offset:128
  s_mov_b64 exec, -1
  v_rcp_f16_sdwa v6, v2 dst_sel:WORD_0 dst_unused:UNUSED_PAD src0_sel:WORD_0
  v_rcp_f16_sdwa v7, v3 dst_sel:WORD_0 dst_unused:UNUSED_PAD src0_sel:WORD_0
  s_waitcnt lgkmcnt(3)
  v_mfma_f32_32x32x16_f16 v[104:119], v[196:199], v[188:191], v[104:119]
  ds_read_b64_tr_b16 v[192:193], v249 offset:0
  ds_read_b64_tr_b16 v[194:195], v249 offset:144
  ds_read_b64_tr_b16 v[196:197], v249 offset:288
  ds_read_b64_tr_b16 v[198:199], v249 offset:432
  v_rcp_f16_sdwa v8, v4 dst_sel:WORD_0 dst_unused:UNUSED_PAD src0_sel:WORD_0
  s_waitcnt lgkmcnt(6)
  v_readfirstlane_b32 s68, v255
  s_setprio 1
  s_cmp_lt_u32 s68, s79
  s_cbranch_scc0 PRI1
  s_setprio 0
PRI1:
  s_add_u32 s79, s79, 128
  v_rcp_f16_sdwa v9, v5 dst_sel:WORD_0 dst_unused:UNUSED_PAD src0_sel:WORD_0
  v_add_u32_sdwa v253, v245, v232 dst_sel:DWORD dst_unused:UNUSED_PAD src0_sel:DWORD src1_sel:BYTE_3
  ds_read_b64 v[234:235], v253 offset:480
  ds_read_b32 v236, v253 offset:736
  v_lshlrev_b32 v125, 4, v232
  v_alignbit_b32 v126, v229, v228, v125
  v_lshrrev_b32 v127, v125, v229
  v_rcp_f16_sdwa v6, v2 dst_sel:WORD_1 dst_unused:UNUSED_PRESERVE src0_sel:WORD_1
  v_mfma_f32_32x32x16_bf16 v[144:159], v[36:39], v[204:207], v[144:159]
  ds_read_b128 v[204:207], v242 offset:0
  v_rcp_f16_sdwa v7, v3 dst_sel:WORD_1 dst_unused:UNUSED_PRESERVE src0_sel:WORD_1
  v_rcp_f16_sdwa v8, v4 dst_sel:WORD_1 dst_unused:UNUSED_PRESERVE src0_sel:WORD_1
  v_rcp_f16_sdwa v9, v5 dst_sel:WORD_1 dst_unused:UNUSED_PRESERVE src0_sel:WORD_1
  v_pk_mul_f16 v160, v160, v6
  v_pk_mul_f16 v161, v161, v7
  v_pk_mul_f16 v162, v162, v8
  v_pk_mul_f16 v163, v163, v9
  ds_write_b128 v246, v[160:163] offset:0
  v_mfma_f32_32x32x16_bf16 v[144:159], v[40:43], v[208:211], v[144:159]
  ds_read_b128 v[208:211], v243 offset:0
  ds_read_b128 v[224:227], v250 offset:512
  ds_read_b32 v232, v251 offset:512
  ds_read_b32 v1, v251 offset:17920
  v_exp_f16_sdwa v2, v164 dst_sel:WORD_0 dst_unused:UNUSED_PAD src0_sel:WORD_0
  v_exp_f16_sdwa v3, v165 dst_sel:WORD_0 dst_unused:UNUSED_PAD src0_sel:WORD_0
  v_lshlrev_b32 v125, 16, v126
  v_and_b32 v126, s65, v126
  v_lshlrev_b32 v127, 16, v127
  v_exp_f16_sdwa v4, v166 dst_sel:WORD_0 dst_unused:UNUSED_PAD src0_sel:WORD_0
  v_mfma_f32_32x32x16_bf16 v[144:159], v[44:47], v[212:215], v[144:159]
  ds_read_b128 v[212:215], v244 offset:0
  v_exp_f16_sdwa v5, v167 dst_sel:WORD_0 dst_unused:UNUSED_PAD src0_sel:WORD_0
  v_exp_f16_sdwa v2, v164 dst_sel:WORD_1 dst_unused:UNUSED_PRESERVE src0_sel:WORD_1
  v_exp_f16_sdwa v3, v165 dst_sel:WORD_1 dst_unused:UNUSED_PRESERVE src0_sel:WORD_1
  v_mfma_f32_32x32x16_f16 v[144:159], v[64:67], v[176:179], v[144:159]
  v_exp_f16_sdwa v4, v166 dst_sel:WORD_1 dst_unused:UNUSED_PRESERVE src0_sel:WORD_1
  s_waitcnt lgkmcnt(8)
  v_sub_f32 v234, v234, v125
  v_sub_f32 v235, v235, v126
  s_waitcnt lgkmcnt(7)
  v_sub_f32 v236, v236, v127
  v_cvt_pk_bf16_f32 v234, v234, v235
  v_cvt_pk_bf16_f32 v236, v236, v236
  v_lshlrev_b32 v10, 16, v234
  v_and_b32 v11, s65, v234
  v_lshlrev_b32 v12, 16, v236
  v_exp_f16_sdwa v5, v167 dst_sel:WORD_1 dst_unused:UNUSED_PRESERVE src0_sel:WORD_1
  v_pk_add_f16 v2, v2, 1.0 op_sel_hi:[1,0]
  v_pk_add_f16 v3, v3, 1.0 op_sel_hi:[1,0]
  v_pk_add_f16 v4, v4, 1.0 op_sel_hi:[1,0]
  v_pk_add_f16 v5, v5, 1.0 op_sel_hi:[1,0]
  v_rcp_f16_sdwa v6, v2 dst_sel:WORD_0 dst_unused:UNUSED_PAD src0_sel:WORD_0
  v_mfma_f32_32x32x16_f16 v[144:159], v[68:71], v[180:183], v[144:159]
  ds_read_b64 v[176:177], v253 offset:192
  ds_read_b64 v[178:179], v253 offset:128
  ds_read_b64 v[180:181], v253 offset:64
  ds_read_b32 v182, v253
  v_rcp_f16_sdwa v7, v3 dst_sel:WORD_0 dst_unused:UNUSED_PAD src0_sel:WORD_0
  v_rcp_f16_sdwa v8, v4 dst_sel:WORD_0 dst_unused:UNUSED_PAD src0_sel:WORD_0
  v_rcp_f16_sdwa v9, v5 dst_sel:WORD_0 dst_unused:UNUSED_PAD src0_sel:WORD_0
  v_mfma_f32_16x16x32_f16 v[120:123], v[192:195], v[184:187], v[120:123]
  v_rcp_f16_sdwa v6, v2 dst_sel:WORD_1 dst_unused:UNUSED_PRESERVE src0_sel:WORD_1
  v_rcp_f16_sdwa v7, v3 dst_sel:WORD_1 dst_unused:UNUSED_PRESERVE src0_sel:WORD_1
  v_mfma_f32_16x16x32_f16 v[120:123], v[196:199], v[188:191], v[120:123]
  ds_read_b128 v[184:187], v252 offset:128
  v_rcp_f16_sdwa v8, v4 dst_sel:WORD_1 dst_unused:UNUSED_PRESERVE src0_sel:WORD_1
  v_rcp_f16_sdwa v9, v5 dst_sel:WORD_1 dst_unused:UNUSED_PRESERVE src0_sel:WORD_1
  v_pk_mul_f16 v164, v164, v6
  v_pk_mul_f16 v165, v165, v7
  v_pk_mul_f16 v166, v166, v8
  v_pk_mul_f16 v167, v167, v9
  ds_write_b128 v246, v[164:167] offset:16
  ds_read_b64_tr_b16 v[192:193], v248 offset:0
  ds_read_b64_tr_b16 v[194:195], v248 offset:144
  ds_read_b64_tr_b16 v[196:197], v248 offset:288
  ds_read_b64_tr_b16 v[198:199], v248 offset:432
  v_cvt_pk_f16_f32 v168, v144, v145
  v_cvt_pk_f16_f32 v169, v146, v147
  v_cvt_pk_f16_f32 v170, v148, v149
  v_cvt_pk_f16_f32 v171, v150, v151
  v_cvt_pk_f16_f32 v172, v152, v153
  v_cvt_pk_f16_f32 v173, v154, v155
  v_cvt_pk_f16_f32 v174, v156, v157
  v_cvt_pk_f16_f32 v175, v158, v159
  v_mfma_f32_32x32x16_bf16 v[128:143], v[48:51], v[216:219], 0
  v_exp_f16_sdwa v2, v168 dst_sel:WORD_0 dst_unused:UNUSED_PAD src0_sel:WORD_0
  v_exp_f16_sdwa v3, v169 dst_sel:WORD_0 dst_unused:UNUSED_PAD src0_sel:WORD_0
  v_exp_f16_sdwa v4, v170 dst_sel:WORD_0 dst_unused:UNUSED_PAD src0_sel:WORD_0
  v_mfma_f32_32x32x16_bf16 v[144:159], v[52:55], v[216:219], 0
  s_cmp_gt_i32 s59, 2
  s_cselect_b32 s6, 6400000, 0
  s_cselect_b32 s10, 25600000, 0
  s_cselect_b32 s14, 300000, 0
  s_waitcnt lgkmcnt(11)
  v_mad_u32_u24 v1, v1, 32, v254
  buffer_load_dwordx4 v[216:219], v1, s[8:11], 0 offen
  v_exp_f16_sdwa v5, v171 dst_sel:WORD_0 dst_unused:UNUSED_PAD src0_sel:WORD_0
  v_exp_f16_sdwa v2, v168 dst_sel:WORD_1 dst_unused:UNUSED_PRESERVE src0_sel:WORD_1
  v_mfma_f32_32x32x16_bf16 v[128:143], v[16:19], v[200:203], v[128:143]
  s_add_u32 m0, s66, 0
  v_mad_u32_u24 v224, v224, s64, v237
  s_waitcnt lgkmcnt(10)
  buffer_load_dwordx4 v224, s[4:7], 0 offen  lds
  v_exp_f16_sdwa v3, v169 dst_sel:WORD_1 dst_unused:UNUSED_PRESERVE src0_sel:WORD_1
  v_exp_f16_sdwa v4, v170 dst_sel:WORD_1 dst_unused:UNUSED_PRESERVE src0_sel:WORD_1
  s_waitcnt lgkmcnt(5)
  v_add_u32_sdwa v184, v247, v184 dst_sel:DWORD dst_unused:UNUSED_PAD src0_sel:DWORD src1_sel:BYTE_3
  v_add_u32_sdwa v185, v247, v185 dst_sel:DWORD dst_unused:UNUSED_PAD src0_sel:DWORD src1_sel:BYTE_3
  v_add_u32_sdwa v186, v247, v186 dst_sel:DWORD dst_unused:UNUSED_PAD src0_sel:DWORD src1_sel:BYTE_3
  v_add_u32_sdwa v187, v247, v187 dst_sel:DWORD dst_unused:UNUSED_PAD src0_sel:DWORD src1_sel:BYTE_3
  ds_read_b64_tr_b16 v[190:191], v187
  ds_read_b64_tr_b16 v[188:189], v186
  ds_read_b64_tr_b16 v[186:187], v185
  ds_read_b64_tr_b16 v[184:185], v184
  v_exp_f16_sdwa v5, v171 dst_sel:WORD_1 dst_unused:UNUSED_PRESERVE src0_sel:WORD_1
  v_pk_add_f16 v2, v2, 1.0 op_sel_hi:[1,0]
  v_pk_add_f16 v3, v3, 1.0 op_sel_hi:[1,0]
  v_pk_add_f16 v4, v4, 1.0 op_sel_hi:[1,0]
  v_pk_add_f16 v5, v5, 1.0 op_sel_hi:[1,0]
  v_mfma_f32_32x32x16_bf16 v[128:143], v[20:23], v[204:207], v[128:143]
  s_add_u32 m0, s66, 1024
  v_mad_u32_u24 v225, v225, s64, v238
  buffer_load_dwordx4 v225, s[4:7], 0 offen  lds
  v_rcp_f16_sdwa v6, v2 dst_sel:WORD_0 dst_unused:UNUSED_PAD src0_sel:WORD_0
  v_rcp_f16_sdwa v7, v3 dst_sel:WORD_0 dst_unused:UNUSED_PAD src0_sel:WORD_0
  v_rcp_f16_sdwa v8, v4 dst_sel:WORD_0 dst_unused:UNUSED_PAD src0_sel:WORD_0
  v_mfma_f32_32x32x16_bf16 v[128:143], v[24:27], v[208:211], v[128:143]
  s_add_u32 m0, s66, 2048
  v_mad_u32_u24 v226, v226, s64, v239
  buffer_load_dwordx4 v226, s[4:7], 0 offen  lds
  v_rcp_f16_sdwa v9, v5 dst_sel:WORD_0 dst_unused:UNUSED_PAD src0_sel:WORD_0
  v_rcp_f16_sdwa v6, v2 dst_sel:WORD_1 dst_unused:UNUSED_PRESERVE src0_sel:WORD_1
  v_mfma_f32_32x32x16_bf16 v[128:143], v[28:31], v[212:215], v[128:143]
  s_add_u32 m0, s66, 3072
  v_mad_u32_u24 v227, v227, s64, v240
  buffer_load_dwordx4 v227, s[4:7], 0 offen  lds
  v_rcp_f16_sdwa v7, v3 dst_sel:WORD_1 dst_unused:UNUSED_PRESERVE src0_sel:WORD_1
  v_rcp_f16_sdwa v8, v4 dst_sel:WORD_1 dst_unused:UNUSED_PRESERVE src0_sel:WORD_1
  v_mul_f32 v234, v10, v10
  v_fmac_f32 v234, v11, v11
  v_fmac_f32 v234, v12, v12
  v_cvt_pk_f16_f32 v183, v234, v234
  v_rcp_f16_sdwa v9, v5 dst_sel:WORD_1 dst_unused:UNUSED_PRESERVE src0_sel:WORD_1
  v_pk_mul_f16 v168, v168, v6
  v_pk_mul_f16 v169, v169, v7
  v_pk_mul_f16 v170, v170, v8
  v_pk_mul_f16 v171, v171, v9
  ds_write_b128 v246, v[168:171] offset:64
  v_mfma_f32_16x16x32_f16 v[124:127], v[72:75], v[160:163], 0
  v_exp_f16_sdwa v2, v172 dst_sel:WORD_0 dst_unused:UNUSED_PAD src0_sel:WORD_0
  v_mul_u32_u24 v1, 6, v232
  v_and_b32 v1, -4, v1
  s_mov_b64 exec, s[74:75]
  buffer_load_dwordx2 v[228:229], v1, s[12:15], 0 offen
  s_mov_b64 exec, -1
  v_exp_f16_sdwa v3, v173 dst_sel:WORD_0 dst_unused:UNUSED_PAD src0_sel:WORD_0
  v_mfma_f32_16x16x32_f16 v[124:127], v[76:79], v[164:167], v[124:127]
  v_exp_f16_sdwa v4, v174 dst_sel:WORD_0 dst_unused:UNUSED_PAD src0_sel:WORD_0
  v_exp_f16_sdwa v5, v175 dst_sel:WORD_0 dst_unused:UNUSED_PAD src0_sel:WORD_0
  v_mfma_f32_32x32x16_f16 v[128:143], v[56:59], v[176:179], v[128:143]
  v_exp_f16_sdwa v2, v172 dst_sel:WORD_1 dst_unused:UNUSED_PRESERVE src0_sel:WORD_1
  v_exp_f16_sdwa v3, v173 dst_sel:WORD_1 dst_unused:UNUSED_PRESERVE src0_sel:WORD_1
  v_exp_f16_sdwa v4, v174 dst_sel:WORD_1 dst_unused:UNUSED_PRESERVE src0_sel:WORD_1
  v_mfma_f32_32x32x16_f16 v[128:143], v[60:63], v[180:183], v[128:143]
  v_exp_f16_sdwa v5, v175 dst_sel:WORD_1 dst_unused:UNUSED_PRESERVE src0_sel:WORD_1
  v_pk_add_f16 v2, v2, 1.0 op_sel_hi:[1,0]
  v_pk_add_f16 v3, v3, 1.0 op_sel_hi:[1,0]
  v_pk_add_f16 v4, v4, 1.0 op_sel_hi:[1,0]
  v_pk_add_f16 v5, v5, 1.0 op_sel_hi:[1,0]
  v_rcp_f16_sdwa v6, v2 dst_sel:WORD_0 dst_unused:UNUSED_PAD src0_sel:WORD_0
  v_rcp_f16_sdwa v7, v3 dst_sel:WORD_0 dst_unused:UNUSED_PAD src0_sel:WORD_0
  s_waitcnt lgkmcnt(1)
  v_mfma_f32_32x32x16_f16 v[88:103], v[192:195], v[184:187], v[88:103]
  v_rcp_f16_sdwa v8, v4 dst_sel:WORD_0 dst_unused:UNUSED_PAD src0_sel:WORD_0
  v_rcp_f16_sdwa v9, v5 dst_sel:WORD_0 dst_unused:UNUSED_PAD src0_sel:WORD_0
  v_rcp_f16_sdwa v6, v2 dst_sel:WORD_1 dst_unused:UNUSED_PRESERVE src0_sel:WORD_1
  v_mfma_f32_32x32x16_f16 v[88:103], v[196:199], v[188:191], v[88:103]
  v_rcp_f16_sdwa v7, v3 dst_sel:WORD_1 dst_unused:UNUSED_PRESERVE src0_sel:WORD_1
  v_rcp_f16_sdwa v8, v4 dst_sel:WORD_1 dst_unused:UNUSED_PRESERVE src0_sel:WORD_1
  v_rcp_f16_sdwa v9, v5 dst_sel:WORD_1 dst_unused:UNUSED_PRESERVE src0_sel:WORD_1
  v_pk_mul_f16 v172, v172, v6
  v_pk_mul_f16 v173, v173, v7
  v_pk_mul_f16 v174, v174, v8
  v_pk_mul_f16 v175, v175, v9
  ds_write_b128 v246, v[172:175] offset:80
  s_sub_u32 s59, s59, 1
  s_cmp_eq_u32 s59, 0
  v_add_u32 v250, 0x100, v250
  v_add_u32 v251, 0x100, v251
  v_add_u32 v252, 0x100, v252
  s_cbranch_scc0 LOOP
  v_mov_b32 v10, v13
  v_mov_b32 v11, v14
  v_mov_b32 v12, v15
TAIL0:
  s_waitcnt lgkmcnt(0)
  ds_read_b64_tr_b16 v[192:193], v248 offset:64
  ds_read_b64_tr_b16 v[194:195], v248 offset:208
  ds_read_b64_tr_b16 v[196:197], v248 offset:352
  ds_read_b64_tr_b16 v[198:199], v248 offset:496
  v_mfma_f32_16x16x32_f16 v[124:127], v[80:83], v[168:171], v[124:127]
  v_mfma_f32_16x16x32_f16 v[124:127], v[84:87], v[172:175], v[124:127]
  s_waitcnt lgkmcnt(2)
  v_mfma_f32_32x32x16_f16 v[104:119], v[192:195], v[184:187], v[104:119]
  s_waitcnt lgkmcnt(0)
  v_mfma_f32_32x32x16_f16 v[104:119], v[196:199], v[188:191], v[104:119]
  s_nop 3
  v_mul_f32 v234, v10, v124
  v_mul_f32 v235, v11, v124
  v_mul_f32 v236, v12, v124
  v_cvt_pk_f16_f32 v234, v234, v235
  v_cvt_pk_f16_f32 v235, v236, v236
  s_mov_b64 exec, s[74:75]
  ds_write_b64 v246, v[234:235] offset:128
  s_mov_b64 exec, -1
  ds_read_b64_tr_b16 v[192:193], v249 offset:0
  ds_read_b64_tr_b16 v[194:195], v249 offset:144
  ds_read_b64_tr_b16 v[196:197], v249 offset:288
  ds_read_b64_tr_b16 v[198:199], v249 offset:432
  s_waitcnt lgkmcnt(2)
  v_mfma_f32_16x16x32_f16 v[120:123], v[192:195], v[184:187], v[120:123]
  s_waitcnt lgkmcnt(0)
  v_mfma_f32_16x16x32_f16 v[120:123], v[196:199], v[188:191], v[120:123]
LOOPEND:
  s_cmp_eq_u32 s62, 0
  s_cbranch_scc1 EPI
  s_add_u32 s61, s61, s60
  s_min_u32 s60, s60, 32
  s_waitcnt vmcnt(0)
  s_barrier
  s_branch ROUND
EPI:
  v_and_b32 v2, 1, v0
  v_bfe_u32 v3, v0, 1, 1
  v_bfe_u32 v4, v0, 2, 2
  v_bfe_u32 v5, v0, 4, 1
  v_lshlrev_b32 v2, 6, v2
  v_lshl_add_u32 v2, v3, 3, v2
  v_lshl_add_u32 v2, v5, 4, v2
  v_lshrrev_b32 v3, 1, v4
  v_lshl_add_u32 v2, v3, 5, v2
  v_lshl_add_u32 v2, v4, 7, v2
  v_add_u32 v2, 146944, v2
  v_lshl_add_u32 v6, v254, 8, v2
  v_xor_b32 v7, 32, v6
  v_lshl_add_u32 v8, v254, 6, v2
  v_xor_b32 v9, 32, v8
  ds_read_b64_tr_b16 v[16:17], v6 offset:0
  ds_read_b64_tr_b16 v[18:19], v6 offset:512
  ds_read_b64_tr_b16 v[20:21], v6 offset:1024
  ds_read_b64_tr_b16 v[22:23], v6 offset:1536
  ds_read_b64_tr_b16 v[24:25], v6 offset:2048
  ds_read_b64_tr_b16 v[26:27], v6 offset:2560
  ds_read_b64_tr_b16 v[28:29], v6 offset:3072
  ds_read_b64_tr_b16 v[30:31], v6 offset:3584
  ds_read_b64_tr_b16 v[32:33], v8 offset:8192
  ds_read_b64_tr_b16 v[34:35], v8 offset:10240
  ds_read_b64_tr_b16 v[36:37], v8 offset:8704
  ds_read_b64_tr_b16 v[38:39], v8 offset:10752
  ds_read_b64_tr_b16 v[40:41], v8 offset:12288
  ds_read_b64_tr_b16 v[42:43], v8 offset:14336
  ds_read_b64_tr_b16 v[44:45], v8 offset:12800
  ds_read_b64_tr_b16 v[46:47], v8 offset:14848
  s_waitcnt lgkmcnt(0)
  ds_read_b64_tr_b16 v[48:49], v7 offset:0
  ds_read_b64_tr_b16 v[50:51], v7 offset:512
  ds_read_b64_tr_b16 v[52:53], v7 offset:1024
  ds_read_b64_tr_b16 v[54:55], v7 offset:1536
  ds_read_b64_tr_b16 v[56:57], v7 offset:2048
  ds_read_b64_tr_b16 v[58:59], v7 offset:2560
  ds_read_b64_tr_b16 v[60:61], v7 offset:3072
  ds_read_b64_tr_b16 v[62:63], v7 offset:3584
  ds_read_b64_tr_b16 v[64:65], v9 offset:8192
  ds_read_b64_tr_b16 v[66:67], v9 offset:10240
  ds_read_b64_tr_b16 v[68:69], v9 offset:8704
  ds_read_b64_tr_b16 v[70:71], v9 offset:10752
  ds_read_b64_tr_b16 v[72:73], v9 offset:12288
  ds_read_b64_tr_b16 v[74:75], v9 offset:14336
  ds_read_b64_tr_b16 v[76:77], v9 offset:12800
  ds_read_b64_tr_b16 v[78:79], v9 offset:14848
  v_lshl_add_u32 v253, v0, 3, s67
  ds_read_b64 v[224:225], v253 offset:512
  ds_read_b32 v226, v253 offset:768
  s_mov_b32 s68, 0xbf317218
  s_mov_b32 s69, 0xbf317218
  v_pk_mul_f32 v[88:89], v[88:89], s[68:69]
  v_pk_mul_f32 v[90:91], v[90:91], s[68:69]
  v_pk_mul_f32 v[92:93], v[92:93], s[68:69]
  v_pk_mul_f32 v[94:95], v[94:95], s[68:69]
  v_pk_mul_f32 v[96:97], v[96:97], s[68:69]
  v_pk_mul_f32 v[98:99], v[98:99], s[68:69]
  v_pk_mul_f32 v[100:101], v[100:101], s[68:69]
  v_pk_mul_f32 v[102:103], v[102:103], s[68:69]
  v_pk_mul_f32 v[104:105], v[104:105], s[68:69]
  v_pk_mul_f32 v[106:107], v[106:107], s[68:69]
  v_pk_mul_f32 v[108:109], v[108:109], s[68:69]
  v_pk_mul_f32 v[110:111], v[110:111], s[68:69]
  v_pk_mul_f32 v[112:113], v[112:113], s[68:69]
  v_pk_mul_f32 v[114:115], v[114:115], s[68:69]
  v_pk_mul_f32 v[116:117], v[116:117], s[68:69]
  v_pk_mul_f32 v[118:119], v[118:119], s[68:69]
  v_pk_mul_f32 v[120:121], v[120:121], s[68:69]
  v_pk_mul_f32 v[122:123], v[122:123], s[68:69]
  v_cvt_pk_bf16_f32 v160, v88, v89
  v_cvt_pk_bf16_f32 v161, v90, v91
  v_cvt_pk_bf16_f32 v162, v92, v93
  v_cvt_pk_bf16_f32 v163, v94, v95
  v_cvt_pk_bf16_f32 v164, v96, v97
  v_cvt_pk_bf16_f32 v165, v98, v99
  v_cvt_pk_bf16_f32 v166, v100, v101
  v_cvt_pk_bf16_f32 v167, v102, v103
  v_cvt_pk_bf16_f32 v168, v104, v105
  v_cvt_pk_bf16_f32 v169, v106, v107
  v_cvt_pk_bf16_f32 v170, v108, v109
  v_cvt_pk_bf16_f32 v171, v110, v111
  v_cvt_pk_bf16_f32 v172, v112, v113
  v_cvt_pk_bf16_f32 v173, v114, v115
  v_cvt_pk_bf16_f32 v174, v116, v117
  v_cvt_pk_bf16_f32 v175, v118, v119
  v_mfma_f32_32x32x16_bf16 v[128:143], v[16:19], v[200:203], 0
  v_mfma_f32_32x32x16_bf16 v[128:143], v[20:23], v[204:207], v[128:143]
  v_mfma_f32_32x32x16_bf16 v[128:143], v[24:27], v[208:211], v[128:143]
  v_mfma_f32_32x32x16_bf16 v[128:143], v[28:31], v[212:215], v[128:143]
  v_mfma_f32_32x32x16_bf16 v[128:143], v[32:35], v[160:163], v[128:143]
  v_mfma_f32_32x32x16_bf16 v[128:143], v[36:39], v[164:167], v[128:143]
  v_mfma_f32_32x32x16_bf16 v[128:143], v[40:43], v[168:171], v[128:143]
  v_mfma_f32_32x32x16_bf16 v[128:143], v[44:47], v[172:175], v[128:143]
  s_waitcnt lgkmcnt(0)
  v_mfma_f32_32x32x16_bf16 v[144:159], v[48:51], v[200:203], 0
  v_mfma_f32_32x32x16_bf16 v[144:159], v[52:55], v[204:207], v[144:159]
  v_mfma_f32_32x32x16_bf16 v[144:159], v[56:59], v[208:211], v[144:159]
  v_mfma_f32_32x32x16_bf16 v[144:159], v[60:63], v[212:215], v[144:159]
  v_mfma_f32_32x32x16_bf16 v[144:159], v[64:67], v[160:163], v[144:159]
  v_mfma_f32_32x32x16_bf16 v[144:159], v[68:71], v[164:167], v[144:159]
  v_mfma_f32_32x32x16_bf16 v[144:159], v[72:75], v[168:171], v[144:159]
  v_mfma_f32_32x32x16_bf16 v[144:159], v[76:79], v[172:175], v[144:159]
  v_add_f32 v224, v224, v120
  v_add_f32 v225, v225, v121
  v_add_f32 v226, v226, v122
  v_cvt_pk_bf16_f32 v224, v224, v225
  v_cvt_pk_bf16_f32 v226, v226, v226
  v_add_u32 v234, s58, v0
  v_mul_u32_u24 v234, 6, v234
  v_add_u32 v234, 6400000, v234
  s_mov_b32 exec_lo, s78
  s_mov_b32 exec_hi, 0
  buffer_store_short v224, v234, s[28:31], 0 offen
  buffer_store_short_d16_hi v224, v234, s[28:31], 0 offen offset:2
  buffer_store_short v226, v234, s[28:31], 0 offen offset:4
  s_mov_b64 exec, -1
  v_and_b32 v235, 31, v0
  v_add_u32 v235, s58, v235
  v_lshlrev_b32 v235, 7, v235
  v_lshl_add_u32 v235, v254, 2, v235
  s_mov_b32 s68, s78
  s_mov_b32 s69, s78
  v_pk_mul_f32 v[2:3], v[128:129], s[70:71]
  v_pk_mul_f32 v[4:5], v[130:131], s[70:71]
  v_pk_mul_f32 v[6:7], v[132:133], s[70:71]
  v_pk_mul_f32 v[8:9], v[134:135], s[70:71]
  v_exp_f32 v2, v2
  v_exp_f32 v3, v3
  v_exp_f32 v4, v4
  v_exp_f32 v5, v5
  v_exp_f32 v6, v6
  v_exp_f32 v7, v7
  v_exp_f32 v8, v8
  v_exp_f32 v9, v9
  v_pk_add_f32 v[2:3], v[2:3], s[72:73]
  v_pk_add_f32 v[4:5], v[4:5], s[72:73]
  v_pk_add_f32 v[6:7], v[6:7], s[72:73]
  v_pk_add_f32 v[8:9], v[8:9], s[72:73]
  v_rcp_f32 v2, v2
  v_rcp_f32 v3, v3
  v_rcp_f32 v4, v4
  v_rcp_f32 v5, v5
  v_rcp_f32 v6, v6
  v_rcp_f32 v7, v7
  v_rcp_f32 v8, v8
  v_rcp_f32 v9, v9
  v_pk_mul_f32 v[2:3], v[2:3], v[128:129]
  v_pk_mul_f32 v[4:5], v[4:5], v[130:131]
  v_pk_mul_f32 v[6:7], v[6:7], v[132:133]
  v_pk_mul_f32 v[8:9], v[8:9], v[134:135]
  v_cvt_pk_bf16_f32 v176, v2, v3
  v_cvt_pk_bf16_f32 v177, v4, v5
  v_cvt_pk_bf16_f32 v178, v6, v7
  v_cvt_pk_bf16_f32 v179, v8, v9
  v_lshlrev_b32 v2, 16, v176
  v_and_b32 v3, s65, v176
  v_lshlrev_b32 v4, 16, v200
  v_and_b32 v5, s65, v200
  v_pk_add_f32 v[2:3], v[2:3], v[4:5]
  v_cvt_pk_bf16_f32 v160, v2, v3
  v_lshlrev_b32 v2, 16, v177
  v_and_b32 v3, s65, v177
  v_lshlrev_b32 v4, 16, v201
  v_and_b32 v5, s65, v201
  v_pk_add_f32 v[2:3], v[2:3], v[4:5]
  v_cvt_pk_bf16_f32 v161, v2, v3
  v_lshlrev_b32 v2, 16, v178
  v_and_b32 v3, s65, v178
  v_lshlrev_b32 v4, 16, v202
  v_and_b32 v5, s65, v202
  v_pk_add_f32 v[2:3], v[2:3], v[4:5]
  v_cvt_pk_bf16_f32 v162, v2, v3
  v_lshlrev_b32 v2, 16, v179
  v_and_b32 v3, s65, v179
  v_lshlrev_b32 v4, 16, v203
  v_and_b32 v5, s65, v203
  v_pk_add_f32 v[2:3], v[2:3], v[4:5]
  v_cvt_pk_bf16_f32 v163, v2, v3
  s_mov_b64 exec, s[68:69]
  buffer_store_dwordx4 v[160:163], v235, s[28:31], 0 offen offset:0
  s_mov_b64 exec, -1
  v_pk_mul_f32 v[2:3], v[136:137], s[70:71]
  v_pk_mul_f32 v[4:5], v[138:139], s[70:71]
  v_pk_mul_f32 v[6:7], v[140:141], s[70:71]
  v_pk_mul_f32 v[8:9], v[142:143], s[70:71]
  v_exp_f32 v2, v2
  v_exp_f32 v3, v3
  v_exp_f32 v4, v4
  v_exp_f32 v5, v5
  v_exp_f32 v6, v6
  v_exp_f32 v7, v7
  v_exp_f32 v8, v8
  v_exp_f32 v9, v9
  v_pk_add_f32 v[2:3], v[2:3], s[72:73]
  v_pk_add_f32 v[4:5], v[4:5], s[72:73]
  v_pk_add_f32 v[6:7], v[6:7], s[72:73]
  v_pk_add_f32 v[8:9], v[8:9], s[72:73]
  v_rcp_f32 v2, v2
  v_rcp_f32 v3, v3
  v_rcp_f32 v4, v4
  v_rcp_f32 v5, v5
  v_rcp_f32 v6, v6
  v_rcp_f32 v7, v7
  v_rcp_f32 v8, v8
  v_rcp_f32 v9, v9
  v_pk_mul_f32 v[2:3], v[2:3], v[136:137]
  v_pk_mul_f32 v[4:5], v[4:5], v[138:139]
  v_pk_mul_f32 v[6:7], v[6:7], v[140:141]
  v_pk_mul_f32 v[8:9], v[8:9], v[142:143]
  v_cvt_pk_bf16_f32 v176, v2, v3
  v_cvt_pk_bf16_f32 v177, v4, v5
  v_cvt_pk_bf16_f32 v178, v6, v7
  v_cvt_pk_bf16_f32 v179, v8, v9
  v_lshlrev_b32 v2, 16, v176
  v_and_b32 v3, s65, v176
  v_lshlrev_b32 v4, 16, v204
  v_and_b32 v5, s65, v204
  v_pk_add_f32 v[2:3], v[2:3], v[4:5]
  v_cvt_pk_bf16_f32 v164, v2, v3
  v_lshlrev_b32 v2, 16, v177
  v_and_b32 v3, s65, v177
  v_lshlrev_b32 v4, 16, v205
  v_and_b32 v5, s65, v205
  v_pk_add_f32 v[2:3], v[2:3], v[4:5]
  v_cvt_pk_bf16_f32 v165, v2, v3
  v_lshlrev_b32 v2, 16, v178
  v_and_b32 v3, s65, v178
  v_lshlrev_b32 v4, 16, v206
  v_and_b32 v5, s65, v206
  v_pk_add_f32 v[2:3], v[2:3], v[4:5]
  v_cvt_pk_bf16_f32 v166, v2, v3
  v_lshlrev_b32 v2, 16, v179
  v_and_b32 v3, s65, v179
  v_lshlrev_b32 v4, 16, v207
  v_and_b32 v5, s65, v207
  v_pk_add_f32 v[2:3], v[2:3], v[4:5]
  v_cvt_pk_bf16_f32 v167, v2, v3
  s_mov_b64 exec, s[68:69]
  buffer_store_dwordx4 v[164:167], v235, s[28:31], 0 offen offset:16
  s_mov_b64 exec, -1
  v_pk_mul_f32 v[2:3], v[144:145], s[70:71]
  v_pk_mul_f32 v[4:5], v[146:147], s[70:71]
  v_pk_mul_f32 v[6:7], v[148:149], s[70:71]
  v_pk_mul_f32 v[8:9], v[150:151], s[70:71]
  v_exp_f32 v2, v2
  v_exp_f32 v3, v3
  v_exp_f32 v4, v4
  v_exp_f32 v5, v5
  v_exp_f32 v6, v6
  v_exp_f32 v7, v7
  v_exp_f32 v8, v8
  v_exp_f32 v9, v9
  v_pk_add_f32 v[2:3], v[2:3], s[72:73]
  v_pk_add_f32 v[4:5], v[4:5], s[72:73]
  v_pk_add_f32 v[6:7], v[6:7], s[72:73]
  v_pk_add_f32 v[8:9], v[8:9], s[72:73]
  v_rcp_f32 v2, v2
  v_rcp_f32 v3, v3
  v_rcp_f32 v4, v4
  v_rcp_f32 v5, v5
  v_rcp_f32 v6, v6
  v_rcp_f32 v7, v7
  v_rcp_f32 v8, v8
  v_rcp_f32 v9, v9
  v_pk_mul_f32 v[2:3], v[2:3], v[144:145]
  v_pk_mul_f32 v[4:5], v[4:5], v[146:147]
  v_pk_mul_f32 v[6:7], v[6:7], v[148:149]
  v_pk_mul_f32 v[8:9], v[8:9], v[150:151]
  v_cvt_pk_bf16_f32 v176, v2, v3
  v_cvt_pk_bf16_f32 v177, v4, v5
  v_cvt_pk_bf16_f32 v178, v6, v7
  v_cvt_pk_bf16_f32 v179, v8, v9
  v_lshlrev_b32 v2, 16, v176
  v_and_b32 v3, s65, v176
  v_lshlrev_b32 v4, 16, v208
  v_and_b32 v5, s65, v208
  v_pk_add_f32 v[2:3], v[2:3], v[4:5]
  v_cvt_pk_bf16_f32 v168, v2, v3
  v_lshlrev_b32 v2, 16, v177
  v_and_b32 v3, s65, v177
  v_lshlrev_b32 v4, 16, v209
  v_and_b32 v5, s65, v209
  v_pk_add_f32 v[2:3], v[2:3], v[4:5]
  v_cvt_pk_bf16_f32 v169, v2, v3
  v_lshlrev_b32 v2, 16, v178
  v_and_b32 v3, s65, v178
  v_lshlrev_b32 v4, 16, v210
  v_and_b32 v5, s65, v210
  v_pk_add_f32 v[2:3], v[2:3], v[4:5]
  v_cvt_pk_bf16_f32 v170, v2, v3
  v_lshlrev_b32 v2, 16, v179
  v_and_b32 v3, s65, v179
  v_lshlrev_b32 v4, 16, v211
  v_and_b32 v5, s65, v211
  v_pk_add_f32 v[2:3], v[2:3], v[4:5]
  v_cvt_pk_bf16_f32 v171, v2, v3
  s_mov_b64 exec, s[68:69]
  buffer_store_dwordx4 v[168:171], v235, s[28:31], 0 offen offset:32
  s_mov_b64 exec, -1
  v_pk_mul_f32 v[2:3], v[152:153], s[70:71]
  v_pk_mul_f32 v[4:5], v[154:155], s[70:71]
  v_pk_mul_f32 v[6:7], v[156:157], s[70:71]
  v_pk_mul_f32 v[8:9], v[158:159], s[70:71]
  v_exp_f32 v2, v2
  v_exp_f32 v3, v3
  v_exp_f32 v4, v4
  v_exp_f32 v5, v5
  v_exp_f32 v6, v6
  v_exp_f32 v7, v7
  v_exp_f32 v8, v8
  v_exp_f32 v9, v9
  v_pk_add_f32 v[2:3], v[2:3], s[72:73]
  v_pk_add_f32 v[4:5], v[4:5], s[72:73]
  v_pk_add_f32 v[6:7], v[6:7], s[72:73]
  v_pk_add_f32 v[8:9], v[8:9], s[72:73]
  v_rcp_f32 v2, v2
  v_rcp_f32 v3, v3
  v_rcp_f32 v4, v4
  v_rcp_f32 v5, v5
  v_rcp_f32 v6, v6
  v_rcp_f32 v7, v7
  v_rcp_f32 v8, v8
  v_rcp_f32 v9, v9
  v_pk_mul_f32 v[2:3], v[2:3], v[152:153]
  v_pk_mul_f32 v[4:5], v[4:5], v[154:155]
  v_pk_mul_f32 v[6:7], v[6:7], v[156:157]
  v_pk_mul_f32 v[8:9], v[8:9], v[158:159]
  v_cvt_pk_bf16_f32 v176, v2, v3
  v_cvt_pk_bf16_f32 v177, v4, v5
  v_cvt_pk_bf16_f32 v178, v6, v7
  v_cvt_pk_bf16_f32 v179, v8, v9
  v_lshlrev_b32 v2, 16, v176
  v_and_b32 v3, s65, v176
  v_lshlrev_b32 v4, 16, v212
  v_and_b32 v5, s65, v212
  v_pk_add_f32 v[2:3], v[2:3], v[4:5]
  v_cvt_pk_bf16_f32 v172, v2, v3
  v_lshlrev_b32 v2, 16, v177
  v_and_b32 v3, s65, v177
  v_lshlrev_b32 v4, 16, v213
  v_and_b32 v5, s65, v213
  v_pk_add_f32 v[2:3], v[2:3], v[4:5]
  v_cvt_pk_bf16_f32 v173, v2, v3
  v_lshlrev_b32 v2, 16, v178
  v_and_b32 v3, s65, v178
  v_lshlrev_b32 v4, 16, v214
  v_and_b32 v5, s65, v214
  v_pk_add_f32 v[2:3], v[2:3], v[4:5]
  v_cvt_pk_bf16_f32 v174, v2, v3
  v_lshlrev_b32 v2, 16, v179
  v_and_b32 v3, s65, v179
  v_lshlrev_b32 v4, 16, v215
  v_and_b32 v5, s65, v215
  v_pk_add_f32 v[2:3], v[2:3], v[4:5]
  v_cvt_pk_bf16_f32 v175, v2, v3
  s_mov_b64 exec, s[68:69]
  buffer_store_dwordx4 v[172:175], v235, s[28:31], 0 offen offset:48
  s_mov_b64 exec, -1
  s_waitcnt vmcnt(0)
K2END:
  s_endpgm
.section .rodata,"a"
.p2align 6
.amdhsa_kernel part_kernel
  .amdhsa_next_free_vgpr 56
  .amdhsa_next_free_sgpr 96
  .amdhsa_accum_offset 56
  .amdhsa_group_segment_fixed_size 0
  .amdhsa_kernarg_size 88
  .amdhsa_user_sgpr_count 2
  .amdhsa_user_sgpr_kernarg_segment_ptr 1
  .amdhsa_system_sgpr_workgroup_id_x 1
.end_amdhsa_kernel
.p2align 6
.amdhsa_kernel main_kernel
  .amdhsa_next_free_vgpr 256
  .amdhsa_next_free_sgpr 96
  .amdhsa_accum_offset 256
  .amdhsa_group_segment_fixed_size 0
  .amdhsa_kernarg_size 88
  .amdhsa_user_sgpr_count 2
  .amdhsa_user_sgpr_kernarg_segment_ptr 1
  .amdhsa_system_sgpr_workgroup_id_x 1
.end_amdhsa_kernel
```

```asm
; @launch kernel=part_kernel grid=(251,1,1) block=(640,1,1) lds=60416
; @launch kernel=main_kernel grid=(256,1,1) block=(512,1,1) lds=155136
.amdgcn_target "amdgcn-amd-amdhsa--gfx950"
.text
.globl part_kernel
.p2align 8
.type part_kernel,@function
part_kernel:
  s_cmp_gt_u32 s2, 250
  s_cbranch_scc1 K1END
  s_load_dwordx2 s[8:9], s[0:1], 80
  s_cmp_eq_u32 s2, 250
  s_cbranch_scc1 WPREP
  s_load_dwordx4 s[4:7], s[0:1], 24
  s_load_dwordx2 s[32:33], s[0:1], 0
  s_mul_i32 s3, s2, 12800
  v_lshlrev_b32 v2, 4, v0
  v_lshlrev_b32 v3, 2, v0
  v_add_u32 v3, 10240, v3
  v_and_b32 v1, 255, v0
  v_lshlrev_b32 v1, 2, v1
  v_mov_b32 v20, 0
  v_mov_b32 v21, 0
  v_mov_b32 v22, 0
  v_mov_b32 v23, 0
  s_waitcnt lgkmcnt(0)
  s_mov_b32 s12, s4
  s_mov_b32 s13, s5
  s_mov_b32 s14, 3200000
  s_mov_b32 s15, 0x20000
  s_mov_b32 s16, s6
  s_mov_b32 s17, s7
  s_mov_b32 s18, 3200000
  s_mov_b32 s19, 0x20000
  buffer_load_dwordx4 v[4:7], v2, s[16:19], s3 offen
  buffer_load_dword v8, v3, s[16:19], s3 offen
  buffer_load_dwordx4 v[12:15], v2, s[12:15], s3 offen
  buffer_load_dword v16, v3, s[12:15], s3 offen
  ds_write_b32 v1, v20 offset:58368
  ds_write_b128 v2, v[20:23] offset:0
  ds_write_b128 v2, v[20:23] offset:10240
  ds_write_b128 v2, v[20:23] offset:20480
  ds_write_b128 v2, v[20:23] offset:30720
  s_mov_b32 s20, s8
  s_mov_b32 s21, s9
  s_mov_b32 s22, 8388608
  s_mov_b32 s23, 0x20000
  s_add_u32 s24, s8, 8388608
  s_addc_u32 s25, s9, 0
  s_mov_b32 s26, 6400000
  s_mov_b32 s27, 0x20000
  s_mov_b32 s28, 175921861
  s_movk_i32 s29, 3125
  s_mul_i32 s30, s2, 3200
  s_or_b32 s30, s30, 0x80000000
  v_mov_b32 v50, 1
  v_mov_b32 v49, 127
  v_lshl_add_u32 v51, v0, 2, s30
  s_add_u32 s30, s30, 2560
  v_add_u32 v52, s30, v0
  v_readfirstlane_b32 s31, v0
  s_waitcnt lgkmcnt(0)
  s_barrier
  s_waitcnt vmcnt(2)
  v_mul_hi_u32 v37, s28, v4
  v_lshrrev_b32 v20, 1, v37
  v_and_b32 v20, 0x3fc, v20
  ds_add_rtn_u32 v28, v20, v50 offset:58368
  v_mul_hi_u32 v39, s28, v5
  v_lshrrev_b32 v21, 1, v39
  v_and_b32 v21, 0x3fc, v21
  ds_add_rtn_u32 v29, v21, v50 offset:58368
  v_mul_hi_u32 v41, s28, v6
  v_lshrrev_b32 v22, 1, v41
  v_and_b32 v22, 0x3fc, v22
  ds_add_rtn_u32 v30, v22, v50 offset:58368
  v_mul_hi_u32 v43, s28, v7
  v_lshrrev_b32 v23, 1, v43
  v_and_b32 v23, 0x3fc, v23
  ds_add_rtn_u32 v31, v23, v50 offset:58368
  v_mul_hi_u32 v45, s28, v8
  v_lshrrev_b32 v24, 1, v45
  v_and_b32 v24, 0x3fc, v24
  ds_add_rtn_u32 v32, v24, v50 offset:58368
  v_mad_u32_u24 v36, v37, s29, v49
  v_lshrrev_b32 v36, 7, v36
  v_sub_u32 v4, v4, v36
  v_and_b32 v37, 7, v37
  v_mad_u32_u24 v38, v39, s29, v49
  v_lshrrev_b32 v38, 7, v38
  v_sub_u32 v5, v5, v38
  v_and_b32 v39, 7, v39
  v_mad_u32_u24 v40, v41, s29, v49
  v_lshrrev_b32 v40, 7, v40
  v_sub_u32 v6, v6, v40
  v_and_b32 v41, 7, v41
  v_mad_u32_u24 v42, v43, s29, v49
  v_lshrrev_b32 v42, 7, v42
  v_sub_u32 v7, v7, v42
  v_and_b32 v43, 7, v43
  v_mad_u32_u24 v44, v45, s29, v49
  v_lshrrev_b32 v44, 7, v44
  v_sub_u32 v8, v8, v44
  v_and_b32 v45, 7, v45
  s_waitcnt vmcnt(0)
  v_lshl_or_b32 v36, v4, 27, v12
  v_lshrrev_b32 v12, 12, v12
  v_lshl_or_b32 v37, v37, 4, v12
  v_lshl_or_b32 v37, v37, 24, v51
  v_lshl_or_b32 v38, v5, 27, v13
  v_lshrrev_b32 v13, 12, v13
  v_lshl_or_b32 v39, v39, 4, v13
  v_add_u32 v51, 1, v51
  v_lshl_or_b32 v39, v39, 24, v51
  v_lshl_or_b32 v40, v6, 27, v14
  v_lshrrev_b32 v14, 12, v14
  v_lshl_or_b32 v41, v41, 4, v14
  v_add_u32 v51, 1, v51
  v_lshl_or_b32 v41, v41, 24, v51
  v_lshl_or_b32 v42, v7, 27, v15
  v_lshrrev_b32 v15, 12, v15
  v_lshl_or_b32 v43, v43, 4, v15
  v_add_u32 v51, 1, v51
  v_lshl_or_b32 v43, v43, 24, v51
  v_lshl_or_b32 v44, v8, 27, v16
  v_lshrrev_b32 v16, 12, v16
  v_lshl_or_b32 v45, v45, 4, v16
  v_lshl_or_b32 v45, v45, 24, v52
  v_and_b32 v1, 63, v0
  v_lshlrev_b32 v3, 9, v1
  v_lshlrev_b32 v1, 4, v1
  v_mov_b32 v48, 0x100ff1
  v_mov_b32 v49, 0xf0ff1
  s_waitcnt lgkmcnt(0)
  s_barrier
  ds_read_b128 v[4:7], v1 offset:58368
  s_waitcnt lgkmcnt(0)
  v_cmp_lt_u32 s[40:41], 16, v4
  v_subrev_u32 v4, 15, v4
  v_cmp_lt_u32 s[42:43], 16, v5
  v_subrev_u32 v5, 15, v5
  v_cmp_lt_u32 s[44:45], 16, v6
  v_subrev_u32 v6, 15, v6
  v_cmp_lt_u32 s[46:47], 16, v7
  v_subrev_u32 v7, 15, v7
  v_cndmask_b32 v4, 0, v4, s[40:41]
  v_cndmask_b32 v5, 0, v5, s[42:43]
  v_cndmask_b32 v6, 0, v6, s[44:45]
  v_cndmask_b32 v7, 0, v7, s[46:47]
  v_add_u32 v8, v4, v5
  v_add_u32 v9, v8, v6
  v_add_u32 v10, v9, v7
  v_mov_b32 v11, v10
  s_nop 1
  v_add_u32_dpp v11, v11, v11 row_shr:1 row_mask:0xf bank_mask:0xf
  s_nop 1
  v_add_u32_dpp v11, v11, v11 row_shr:2 row_mask:0xf bank_mask:0xf
  s_nop 1
  v_add_u32_dpp v11, v11, v11 row_shr:4 row_mask:0xf bank_mask:0xf
  s_nop 1
  v_add_u32_dpp v11, v11, v11 row_shr:8 row_mask:0xf bank_mask:0xf
  s_nop 1
  v_add_u32_dpp v11, v11, v11 row_bcast:15 row_mask:0xa bank_mask:0xf
  s_nop 1
  v_add_u32_dpp v11, v11, v11 row_bcast:31 row_mask:0xc bank_mask:0xf
  v_cndmask_b32 v16, v48, v49, s[40:41]
  v_cndmask_b32 v17, v48, v49, s[42:43]
  v_cndmask_b32 v18, v48, v49, s[44:45]
  v_cndmask_b32 v19, v48, v49, s[46:47]
  v_sub_u32 v12, v11, v10
  v_add_u32 v13, v12, v4
  v_add_u32 v14, v12, v8
  v_add_u32 v15, v12, v9
  v_readlane_b32 s33, v11, 63
  v_add_u32 v16, v16, v12
  v_add_u32 v17, v17, v13
  v_add_u32 v18, v18, v14
  v_add_u32 v19, v19, v15
  ds_write_b128 v1, v[16:19] offset:59392
  ds_read_b32 v17, v20 offset:59392
  ds_read_b32 v18, v21 offset:59392
  ds_read_b32 v19, v22 offset:59392
  ds_read_b32 v25, v23 offset:59392
  ds_read_b32 v26, v24 offset:59392
  s_cmp_ge_u32 s31, 64
  s_cbranch_scc1 K1NOPTR
  v_lshl_or_b32 v4, v4, 16, v12
  s_mov_b64 exec, s[40:41]
  ds_write_b32 v3, v4 offset:120
  s_mov_b64 exec, -1
  v_lshl_or_b32 v5, v5, 16, v13
  s_mov_b64 exec, s[42:43]
  ds_write_b32 v3, v5 offset:248
  s_mov_b64 exec, -1
  v_lshl_or_b32 v6, v6, 16, v14
  s_mov_b64 exec, s[44:45]
  ds_write_b32 v3, v6 offset:376
  s_mov_b64 exec, -1
  v_lshl_or_b32 v7, v7, 16, v15
  s_mov_b64 exec, s[46:47]
  ds_write_b32 v3, v7 offset:504
  s_mov_b64 exec, -1
K1NOPTR:
  v_lshlrev_b32 v20, 2, v20
  v_lshlrev_b32 v21, 2, v21
  v_lshlrev_b32 v22, 2, v22
  v_lshlrev_b32 v23, 2, v23
  v_lshlrev_b32 v24, 2, v24
  s_waitcnt lgkmcnt(0)
  v_cmp_lt_u32_sdwa vcc, v28, v17 src0_sel:DWORD src1_sel:WORD_1
  s_nop 1
  v_cndmask_b32_sdwa v20, v17, v20, vcc dst_sel:DWORD dst_unused:UNUSED_PAD src0_sel:WORD_0 src1_sel:DWORD
  v_add_lshl_u32 v20, v20, v28, 3
  ds_write_b64 v20, v[36:37]
  v_cmp_lt_u32_sdwa vcc, v29, v18 src0_sel:DWORD src1_sel:WORD_1
  s_nop 1
  v_cndmask_b32_sdwa v21, v18, v21, vcc dst_sel:DWORD dst_unused:UNUSED_PAD src0_sel:WORD_0 src1_sel:DWORD
  v_add_lshl_u32 v21, v21, v29, 3
  ds_write_b64 v21, v[38:39]
  v_cmp_lt_u32_sdwa vcc, v30, v19 src0_sel:DWORD src1_sel:WORD_1
  s_nop 1
  v_cndmask_b32_sdwa v22, v19, v22, vcc dst_sel:DWORD dst_unused:UNUSED_PAD src0_sel:WORD_0 src1_sel:DWORD
  v_add_lshl_u32 v22, v22, v30, 3
  ds_write_b64 v22, v[40:41]
  v_cmp_lt_u32_sdwa vcc, v31, v25 src0_sel:DWORD src1_sel:WORD_1
  s_nop 1
  v_cndmask_b32_sdwa v23, v25, v23, vcc dst_sel:DWORD dst_unused:UNUSED_PAD src0_sel:WORD_0 src1_sel:DWORD
  v_add_lshl_u32 v23, v23, v31, 3
  ds_write_b64 v23, v[42:43]
  v_cmp_lt_u32_sdwa vcc, v32, v26 src0_sel:DWORD src1_sel:WORD_1
  s_nop 1
  v_cndmask_b32_sdwa v24, v26, v24, vcc dst_sel:DWORD dst_unused:UNUSED_PAD src0_sel:WORD_0 src1_sel:DWORD
  v_add_lshl_u32 v24, v24, v32, 3
  ds_write_b64 v24, v[44:45]
  v_lshrrev_b32 v3, 3, v0
  s_movk_i32 s3, 32000
  v_mul_u32_u24 v3, s3, v3
  v_and_b32 v1, 7, v0
  v_lshl_add_u32 v3, v1, 4, v3
  s_mul_i32 s3, s2, 128
  s_add_u32 s4, s3, 2560000
  s_add_u32 s5, s3, 5120000
  s_add_u32 s6, s3, 7680000
  s_mul_i32 s7, s2, 25600
  s_lshl_b32 s33, s33, 3
  s_waitcnt lgkmcnt(0)
  s_barrier
  ds_read_b128 v[4:7], v2
  ds_read_b128 v[8:11], v2 offset:10240
  ds_read_b128 v[12:15], v2 offset:20480
  ds_read_b128 v[16:19], v2 offset:30720
  s_waitcnt lgkmcnt(3)
  buffer_store_dwordx4 v[4:7], v3, s[20:23], s3 offen
  s_waitcnt lgkmcnt(2)
  buffer_store_dwordx4 v[8:11], v3, s[20:23], s4 offen
  s_waitcnt lgkmcnt(1)
  buffer_store_dwordx4 v[12:15], v3, s[20:23], s5 offen
  s_cmp_ge_u32 s31, 128
  s_cbranch_scc1 K1OV
  s_waitcnt lgkmcnt(0)
  buffer_store_dwordx4 v[16:19], v3, s[20:23], s6 offen
K1OV:
  v_cmpx_gt_u32 vcc, s33, v2
  s_cbranch_execz K1END
  ds_read_b128 v[20:23], v2 offset:32768
  s_waitcnt lgkmcnt(0)
  buffer_store_dwordx4 v[20:23], v2, s[24:27], s7 offen
  v_add_u32 v2, 10240, v2
  s_waitcnt vmcnt(0)
  s_branch K1OV
K1END:
  s_endpgm
WPREP:
  s_load_dwordx4 s[4:7], s[0:1], 40
  v_lshrrev_b32 v2, 6, v0
  v_and_b32 v1, 63, v0
  v_readfirstlane_b32 s31, v2
  s_mov_b32 s28, 0xbfb8aa3b
  s_mov_b32 s29, 0xbfb8aa3b
  s_mov_b32 s30, 0xffff0000
  s_waitcnt lgkmcnt(0)
  s_mov_b32 s12, s4
  s_mov_b32 s13, s5
  s_mov_b32 s14, 18560
  s_mov_b32 s15, 0x20000
  s_mov_b32 s16, s6
  s_mov_b32 s17, s7
  s_mov_b32 s18, 128
  s_mov_b32 s19, 0x20000
  s_add_u32 s20, s8, 15728640
  s_addc_u32 s21, s9, 0
  s_mov_b32 s22, 24576
  s_mov_b32 s23, 0x20000
  v_and_b32 v2, 7, v1
  v_bfe_u32 v3, v1, 4, 1
  v_lshlrev_b32 v4, 2, v3
  v_xor_b32 v4, v4, v2
  v_lshlrev_b32 v4, 4, v4
  v_lshrrev_b32 v5, 3, v1
  v_lshl_or_b32 v4, v5, 7, v4
  s_lshl_b32 s3, s31, 10
  s_add_u32 s4, s3, 10240
  v_add_u32 v4, s3, v4
  s_mov_b32 m0, s3
  s_nop 0
  buffer_load_dwordx4 v4, s[12:15], 0 offen lds
  v_add_u32 v4, 10240, v4
  s_mov_b32 m0, s4
  s_nop 0
  buffer_load_dwordx4 v4, s[12:15], 0 offen lds
  v_lshrrev_b32 v5, 5, v1
  v_lshlrev_b32 v7, 3, v5
  buffer_load_dwordx2 v[28:29], v7, s[16:19], 0 offen offset:0
  buffer_load_dwordx2 v[30:31], v7, s[16:19], 0 offen offset:16
  buffer_load_dwordx2 v[32:33], v7, s[16:19], 0 offen offset:32
  buffer_load_dwordx2 v[34:35], v7, s[16:19], 0 offen offset:48
  buffer_load_dwordx2 v[36:37], v7, s[16:19], 0 offen offset:64
  buffer_load_dwordx2 v[38:39], v7, s[16:19], 0 offen offset:80
  buffer_load_dwordx2 v[40:41], v7, s[16:19], 0 offen offset:96
  buffer_load_dwordx2 v[42:43], v7, s[16:19], 0 offen offset:112
  v_and_b32 v2, 3, v1
  v_bfe_u32 v4, v1, 2, 2
  v_lshlrev_b32 v2, 3, v2
  v_lshl_add_u32 v2, v3, 5, v2
  v_lshl_add_u32 v2, v4, 7, v2
  v_lshl_add_u32 v6, v5, 12, v2
  v_lshrrev_b32 v3, 1, v4
  v_lshl_add_u32 v6, v3, 6, v6
  v_lshl_add_u32 v8, v5, 10, v2
  v_add_u32 v3, 1, v4
  v_bfe_u32 v3, v3, 1, 1
  v_lshl_add_u32 v8, v3, 6, v8
  v_xor_b32 v9, 64, v8
  s_and_b32 s3, s31, 1
  s_lshl_b32 s3, s3, 6
  v_xor_b32 v6, s3, v6
  s_lshr_b32 s3, s31, 1
  s_lshl_b32 s3, s3, 13
  v_add_u32 v6, s3, v6
  v_lshlrev_b32 v10, 4, v1
  s_lshl_b32 s3, s31, 12
  s_waitcnt vmcnt(0)
  s_barrier
  s_cmp_eq_u32 s31, 4
  s_cbranch_scc1 WP4
  s_cmp_eq_u32 s31, 5
  s_cbranch_scc1 WP5
  s_cmp_gt_u32 s31, 5
  s_cbranch_scc1 WPEND
  ds_read_b64_tr_b16 v[12:13], v6 offset:0
  ds_read_b64_tr_b16 v[14:15], v6 offset:512
  ds_read_b64_tr_b16 v[16:17], v6 offset:1024
  ds_read_b64_tr_b16 v[18:19], v6 offset:1536
  ds_read_b64_tr_b16 v[20:21], v6 offset:2048
  ds_read_b64_tr_b16 v[22:23], v6 offset:2560
  ds_read_b64_tr_b16 v[24:25], v6 offset:3072
  ds_read_b64_tr_b16 v[26:27], v6 offset:3584
  s_waitcnt lgkmcnt(0)
  s_cmp_lt_u32 s31, 2
  s_cbranch_scc1 WPST
  v_lshlrev_b32 v2, 16, v12
  v_and_b32 v3, s30, v12
  v_pk_mul_f32 v[2:3], v[2:3], s[28:29]
  v_cvt_pk_bf16_f32 v12, v2, v3
  v_lshlrev_b32 v2, 16, v13
  v_and_b32 v3, s30, v13
  v_pk_mul_f32 v[2:3], v[2:3], s[28:29]
  v_cvt_pk_bf16_f32 v13, v2, v3
  v_lshlrev_b32 v2, 16, v14
  v_and_b32 v3, s30, v14
  v_pk_mul_f32 v[2:3], v[2:3], s[28:29]
  v_cvt_pk_bf16_f32 v14, v2, v3
  v_lshlrev_b32 v2, 16, v15
  v_and_b32 v3, s30, v15
  v_pk_mul_f32 v[2:3], v[2:3], s[28:29]
  v_cvt_pk_bf16_f32 v15, v2, v3
  v_lshlrev_b32 v2, 16, v16
  v_and_b32 v3, s30, v16
  v_pk_mul_f32 v[2:3], v[2:3], s[28:29]
  v_cvt_pk_bf16_f32 v16, v2, v3
  v_lshlrev_b32 v2, 16, v17
  v_and_b32 v3, s30, v17
  v_pk_mul_f32 v[2:3], v[2:3], s[28:29]
  v_cvt_pk_bf16_f32 v17, v2, v3
  v_lshlrev_b32 v2, 16, v18
  v_and_b32 v3, s30, v18
  v_pk_mul_f32 v[2:3], v[2:3], s[28:29]
  v_cvt_pk_bf16_f32 v18, v2, v3
  v_lshlrev_b32 v2, 16, v19
  v_and_b32 v3, s30, v19
  v_pk_mul_f32 v[2:3], v[2:3], s[28:29]
  v_cvt_pk_bf16_f32 v19, v2, v3
  v_lshlrev_b32 v2, 16, v20
  v_and_b32 v3, s30, v20
  v_pk_mul_f32 v[2:3], v[2:3], s[28:29]
  v_cvt_pk_bf16_f32 v20, v2, v3
  v_lshlrev_b32 v2, 16, v21
  v_and_b32 v3, s30, v21
  v_pk_mul_f32 v[2:3], v[2:3], s[28:29]
  v_cvt_pk_bf16_f32 v21, v2, v3
  v_lshlrev_b32 v2, 16, v22
  v_and_b32 v3, s30, v22
  v_pk_mul_f32 v[2:3], v[2:3], s[28:29]
  v_cvt_pk_bf16_f32 v22, v2, v3
  v_lshlrev_b32 v2, 16, v23
  v_and_b32 v3, s30, v23
  v_pk_mul_f32 v[2:3], v[2:3], s[28:29]
  v_cvt_pk_bf16_f32 v23, v2, v3
  v_lshlrev_b32 v2, 16, v24
  v_and_b32 v3, s30, v24
  v_pk_mul_f32 v[2:3], v[2:3], s[28:29]
  v_cvt_pk_bf16_f32 v24, v2, v3
  v_lshlrev_b32 v2, 16, v25
  v_and_b32 v3, s30, v25
  v_pk_mul_f32 v[2:3], v[2:3], s[28:29]
  v_cvt_pk_bf16_f32 v25, v2, v3
  v_lshlrev_b32 v2, 16, v26
  v_and_b32 v3, s30, v26
  v_pk_mul_f32 v[2:3], v[2:3], s[28:29]
  v_cvt_pk_bf16_f32 v26, v2, v3
  v_lshlrev_b32 v2, 16, v27
  v_and_b32 v3, s30, v27
  v_pk_mul_f32 v[2:3], v[2:3], s[28:29]
  v_cvt_pk_bf16_f32 v27, v2, v3
WPST:
  buffer_store_dwordx4 v[12:15], v10, s[20:23], s3 offen offset:0
  buffer_store_dwordx4 v[16:19], v10, s[20:23], s3 offen offset:1024
  buffer_store_dwordx4 v[20:23], v10, s[20:23], s3 offen offset:2048
  buffer_store_dwordx4 v[24:27], v10, s[20:23], s3 offen offset:3072
  s_endpgm
WP4:
  ds_read_b64_tr_b16 v[12:13], v8 offset:16512
  ds_read_b64_tr_b16 v[14:15], v8 offset:17024
  ds_read_b64_tr_b16 v[16:17], v9 offset:16512
  ds_read_b64_tr_b16 v[18:19], v9 offset:17024
  v_and_b32 v2, 31, v1
  v_lshlrev_b32 v2, 1, v2
  ds_read_u16 v20, v2 offset:16384
  ds_read_u16 v21, v2 offset:16448
  v_subrev_u32 v5, 1, v5
  s_waitcnt lgkmcnt(0)
  v_lshlrev_b32 v2, 16, v12
  v_and_b32 v3, s30, v12
  v_pk_mul_f32 v[2:3], v[2:3], s[28:29]
  v_cvt_pk_bf16_f32 v12, v2, v3
  v_lshlrev_b32 v2, 16, v13
  v_and_b32 v3, s30, v13
  v_pk_mul_f32 v[2:3], v[2:3], s[28:29]
  v_cvt_pk_bf16_f32 v13, v2, v3
  v_lshlrev_b32 v2, 16, v14
  v_and_b32 v3, s30, v14
  v_pk_mul_f32 v[2:3], v[2:3], s[28:29]
  v_cvt_pk_bf16_f32 v14, v2, v3
  v_lshlrev_b32 v2, 16, v15
  v_and_b32 v3, s30, v15
  v_pk_mul_f32 v[2:3], v[2:3], s[28:29]
  v_cvt_pk_bf16_f32 v15, v2, v3
  v_lshlrev_b32 v2, 16, v16
  v_and_b32 v3, s30, v16
  v_pk_mul_f32 v[2:3], v[2:3], s[28:29]
  v_cvt_pk_bf16_f32 v16, v2, v3
  v_lshlrev_b32 v2, 16, v17
  v_and_b32 v3, s30, v17
  v_pk_mul_f32 v[2:3], v[2:3], s[28:29]
  v_cvt_pk_bf16_f32 v17, v2, v3
  v_lshlrev_b32 v2, 16, v18
  v_and_b32 v3, s30, v18
  v_pk_mul_f32 v[2:3], v[2:3], s[28:29]
  v_cvt_pk_bf16_f32 v18, v2, v3
  v_lshlrev_b32 v2, 16, v19
  v_and_b32 v3, s30, v19
  v_pk_mul_f32 v[2:3], v[2:3], s[28:29]
  v_cvt_pk_bf16_f32 v19, v2, v3
  v_lshlrev_b32 v20, 16, v20
  v_mul_f32 v20, s28, v20
  v_cvt_pk_f16_f32 v20, v20, 0
  v_and_b32 v20, v5, v20
  v_mov_b32 v22, 0
  v_lshlrev_b32 v21, 16, v21
  v_mul_f32 v21, s28, v21
  v_cvt_pk_f16_f32 v21, v21, 0
  v_and_b32 v21, v5, v21
  v_mov_b32 v23, 0
  buffer_store_dwordx4 v[12:15], v10, s[20:23], s3 offen offset:0
  buffer_store_dwordx4 v[16:19], v10, s[20:23], s3 offen offset:1024
  buffer_store_dwordx4 v[20:23], v10, s[20:23], s3 offen offset:2048
  buffer_store_dwordx4 v[20:23], v10, s[20:23], s3 offen offset:3072
  s_endpgm
WP5:
  v_lshrrev_b32 v4, 2, v1
  v_lshrrev_b32 v8, 4, v1
  v_xor_b32 v4, v4, v8
  v_and_b32 v4, 1, v4
  v_subrev_u32 v4, 1, v4
  v_lshlrev_b32 v2, 16, v28
  v_and_b32 v3, s30, v28
  v_cvt_pk_f16_f32 v2, v2, v3
  v_and_b32 v12, v4, v2
  v_lshlrev_b32 v2, 16, v29
  v_and_b32 v3, s30, v29
  v_cvt_pk_f16_f32 v2, v2, v3
  v_and_b32 v13, v4, v2
  v_lshlrev_b32 v2, 16, v30
  v_and_b32 v3, s30, v30
  v_cvt_pk_f16_f32 v2, v2, v3
  v_and_b32 v14, v4, v2
  v_lshlrev_b32 v2, 16, v31
  v_and_b32 v3, s30, v31
  v_cvt_pk_f16_f32 v2, v2, v3
  v_and_b32 v15, v4, v2
  v_lshlrev_b32 v2, 16, v32
  v_and_b32 v3, s30, v32
  v_cvt_pk_f16_f32 v2, v2, v3
  v_and_b32 v16, v4, v2
  v_lshlrev_b32 v2, 16, v33
  v_and_b32 v3, s30, v33
  v_cvt_pk_f16_f32 v2, v2, v3
  v_and_b32 v17, v4, v2
  v_lshlrev_b32 v2, 16, v34
  v_and_b32 v3, s30, v34
  v_cvt_pk_f16_f32 v2, v2, v3
  v_and_b32 v18, v4, v2
  v_lshlrev_b32 v2, 16, v35
  v_and_b32 v3, s30, v35
  v_cvt_pk_f16_f32 v2, v2, v3
  v_and_b32 v19, v4, v2
  v_lshlrev_b32 v2, 16, v36
  v_and_b32 v3, s30, v36
  v_cvt_pk_f16_f32 v2, v2, v3
  v_and_b32 v20, v4, v2
  v_lshlrev_b32 v2, 16, v37
  v_and_b32 v3, s30, v37
  v_cvt_pk_f16_f32 v2, v2, v3
  v_and_b32 v21, v4, v2
  v_lshlrev_b32 v2, 16, v38
  v_and_b32 v3, s30, v38
  v_cvt_pk_f16_f32 v2, v2, v3
  v_and_b32 v22, v4, v2
  v_lshlrev_b32 v2, 16, v39
  v_and_b32 v3, s30, v39
  v_cvt_pk_f16_f32 v2, v2, v3
  v_and_b32 v23, v4, v2
  v_lshlrev_b32 v2, 16, v40
  v_and_b32 v3, s30, v40
  v_cvt_pk_f16_f32 v2, v2, v3
  v_and_b32 v24, v4, v2
  v_lshlrev_b32 v2, 16, v41
  v_and_b32 v3, s30, v41
  v_cvt_pk_f16_f32 v2, v2, v3
  v_and_b32 v25, v4, v2
  v_lshlrev_b32 v2, 16, v42
  v_and_b32 v3, s30, v42
  v_cvt_pk_f16_f32 v2, v2, v3
  v_and_b32 v26, v4, v2
  v_lshlrev_b32 v2, 16, v43
  v_and_b32 v3, s30, v43
  v_cvt_pk_f16_f32 v2, v2, v3
  v_and_b32 v27, v4, v2
  s_branch WPST
WPEND:
  s_endpgm
.globl main_kernel
.p2align 8
.type main_kernel,@function
main_kernel:
  s_cmp_ge_u32 s2, 256
  s_cbranch_scc1 K2END
  s_load_dwordx2 s[52:53], s[0:1], 80
  s_load_dwordx8 s[32:39], s[0:1], 0
  s_load_dwordx4 s[48:51], s[0:1], 56
  s_and_b32 s3, s2, 7
  s_lshl_b32 s3, s3, 5
  s_lshr_b32 s56, s2, 3
  s_add_u32 s56, s56, s3
  v_lshrrev_b32 v2, 6, v0
  v_and_b32 v0, 63, v0
  v_readfirstlane_b32 s57, v2
  s_mov_b32 s60, 47
  s_mov_b32 s61, 0
  s_mov_b32 s63, 1
  s_mov_b32 s54, 1
  s_movk_i32 s64, 128
  s_mov_b32 s65, 0xffff0000
  s_mov_b32 s70, 0xbfb8aa3b
  s_mov_b32 s71, 0xbfb8aa3b
  s_mov_b32 s72, 1.0
  s_mov_b32 s73, 1.0
  s_mov_b32 s74, -1
  s_mov_b32 s75, 0
  s_lshl_b32 s3, s56, 3
  s_add_u32 s3, s3, s57
  s_mul_i32 s3, s3, 3125
  s_add_u32 s58, s3, 127
  s_lshr_b32 s58, s58, 7
  s_add_u32 s3, s3, 3252
  s_lshr_b32 s3, s3, 7
  s_sub_u32 s3, s3, s58
  s_bfm_b32 s78, s3, 0
  s_lshl_b32 s66, s57, 12
  s_add_u32 s66, s66, 81408
  s_lshl_b32 s67, s57, 10
  s_add_u32 s67, s67, 36352
  s_mul_i32 s3, s56, 32000
  s_mov_b32 s18, 32000
  s_mov_b32 s19, 0x20000
  s_waitcnt lgkmcnt(0)
  s_add_u32 s16, s52, s3
  s_addc_u32 s17, s53, 0
ROUND:
  s_lshl_b32 s3, s57, 12
  v_lshl_add_u32 v2, v0, 4, s3
  buffer_load_dwordx4 v[128:131], v2, s[16:19], 0 offen offset:0
  buffer_load_dwordx4 v[132:135], v2, s[16:19], 0 offen offset:1024
  buffer_load_dwordx4 v[136:139], v2, s[16:19], 0 offen offset:2048
  buffer_load_dwordx4 v[140:143], v2, s[16:19], 0 offen offset:3072
  s_and_b32 s3, s57, 3
  s_lshl_b32 s3, s3, 8
  v_lshl_add_u32 v4, v0, 2, s3
  v_mov_b32 v5, 0
  ds_write_b32 v4, v5 offset:34816
  s_cmp_eq_u32 s63, 0
  s_cbranch_scc1 NOTFIRST1
  s_mov_b32 s4, s32
  s_mov_b32 s5, s33
  s_mov_b32 s6, 6400000
  s_mov_b32 s7, 0x20000
  s_mov_b32 s12, s34
  s_mov_b32 s13, s35
  s_mov_b32 s14, 300000
  s_mov_b32 s15, 0x20000
  v_and_b32 v2, 7, v0
  v_bfe_u32 v3, v0, 4, 1
  v_lshrrev_b32 v5, 3, v0
  v_lshrrev_b32 v6, 5, v0
  v_lshl_add_u32 v237, v6, 2, 0
  v_xor_b32 v237, v237, v2
  v_lshlrev_b32 v237, 4, v237
  v_lshl_add_u32 v238, v6, 2, 1
  v_xor_b32 v238, v238, v2
  v_lshlrev_b32 v238, 4, v238
  v_lshl_add_u32 v239, v6, 2, 2
  v_xor_b32 v239, v239, v2
  v_lshlrev_b32 v239, 4, v239
  v_lshl_add_u32 v240, v6, 2, 3
  v_xor_b32 v240, v240, v2
  v_lshlrev_b32 v240, 4, v240
  v_lshl_add_u32 v7, v5, 2, s58
  v_add_u32 v7, 0, v7
  v_mad_u32_u24 v56, v7, s64, v237
  v_lshl_add_u32 v7, v5, 2, s58
  v_add_u32 v7, 1, v7
  v_mad_u32_u24 v57, v7, s64, v238
  v_lshl_add_u32 v7, v5, 2, s58
  v_add_u32 v7, 2, v7
  v_mad_u32_u24 v58, v7, s64, v239
  v_lshl_add_u32 v7, v5, 2, s58
  v_add_u32 v7, 3, v7
  v_mad_u32_u24 v59, v7, s64, v240
  v_add_u32 v12, s58, v0
  v_mul_u32_u24 v11, 6, v12
  v_and_b32 v11, -4, v11
  s_mov_b32 s8, s36
  s_mov_b32 s9, s37
  s_mov_b32 s10, 25600000
  s_mov_b32 s11, 0x20000
  s_mov_b32 s28, s50
  s_mov_b32 s29, s51
  s_mov_b32 s30, 6700000
  s_mov_b32 s31, 0x20000
  s_mov_b32 s24, s48
  s_mov_b32 s25, s49
  s_mov_b32 s26, 16384
  s_mov_b32 s27, 0x20000
  s_add_u32 s20, s52, 8388608
  s_addc_u32 s21, s53, 0
  s_mov_b32 s22, 7364608
  s_mov_b32 s23, 0x20000
  v_lshlrev_b32 v13, 1, v3
  v_xor_b32 v13, v13, v2
  v_lshlrev_b32 v13, 4, v13
  v_lshl_or_b32 v13, v5, 7, v13
  v_lshlrev_b32 v254, 4, v6
  v_and_b32 v2, 3, v0
  v_bfe_u32 v4, v0, 2, 3
  v_lshl_add_u32 v4, v2, 3, v4
  v_xor_b32 v7, v3, v6
  v_lshlrev_b32 v7, 6, v7
  v_lshl_add_u32 v4, v4, 7, v7
  v_add_u32 v4, s66, v4
  v_xor_b32 v7, 0, v2
  v_lshl_add_u32 v241, v7, 4, v4
  v_xor_b32 v7, 1, v2
  v_lshl_add_u32 v242, v7, 4, v4
  v_xor_b32 v7, 2, v2
  v_lshl_add_u32 v243, v7, 4, v4
  v_xor_b32 v7, 3, v2
  v_lshl_add_u32 v244, v7, 4, v4
  s_add_u32 s3, s67, 32
  v_lshlrev_b32 v7, 5, v6
  v_sub_u32 v245, s3, v7
  s_add_u32 s3, s67, 224
  v_lshl_add_u32 v7, v3, 2, v2
  v_lshlrev_b32 v7, 5, v7
  v_sub_u32 v247, s3, v7
  s_mul_i32 s3, s57, 4608
  s_add_u32 s3, s3, 44544
  v_and_b32 v7, 31, v0
  s_movk_i32 s68, 144
  v_mul_u32_u24 v8, s68, v7
  v_add_u32 v8, s3, v8
  v_lshl_add_u32 v246, v6, 5, v8
  v_bfe_u32 v4, v0, 2, 2
  v_lshl_add_u32 v8, v6, 2, v4
  s_movk_i32 s68, 576
  v_mul_u32_u24 v9, s68, v8
  v_add_u32 v9, s3, v9
  v_xor_b32 v249, v3, v0
  v_and_b32 v249, 1, v249
  v_lshl_add_u32 v249, v249, 3, v9
  v_add_u32 v249, 128, v249
  v_lshl_add_u32 v248, v3, 5, v9
  v_lshl_add_u32 v248, v2, 3, v248
  v_mov_b32 v72, 0
  v_mov_b32 v73, 0
  v_mov_b32 v74, 0x3c00
  v_mov_b32 v75, 0x3c000000
  v_cmp_eq_u32 vcc, 28, v0
  s_nop 1
  v_cndmask_b32 v72, v72, v74, vcc
  v_cmp_eq_u32 vcc, 29, v0
  s_nop 1
  v_cndmask_b32 v72, v72, v75, vcc
  v_cmp_eq_u32 vcc, 30, v0
  s_nop 1
  v_cndmask_b32 v73, v73, v74, vcc
  v_cmp_eq_u32 vcc, 31, v0
  s_nop 1
  v_cndmask_b32 v73, v73, v75, vcc
  v_lshl_add_u32 v9, v0, 3, s67
  ds_write_b64 v9, v[72:73]
  v_mov_b32 v88, 0
  v_mov_b32 v89, 0
  v_mov_b32 v90, 0
  v_mov_b32 v91, 0
  v_mov_b32 v92, 0
  v_mov_b32 v93, 0
  v_mov_b32 v94, 0
  v_mov_b32 v95, 0
  v_mov_b32 v96, 0
  v_mov_b32 v97, 0
  v_mov_b32 v98, 0
  v_mov_b32 v99, 0
  v_mov_b32 v100, 0
  v_mov_b32 v101, 0
  v_mov_b32 v102, 0
  v_mov_b32 v103, 0
  v_mov_b32 v104, 0
  v_mov_b32 v105, 0
  v_mov_b32 v106, 0
  v_mov_b32 v107, 0
  v_mov_b32 v108, 0
  v_mov_b32 v109, 0
  v_mov_b32 v110, 0
  v_mov_b32 v111, 0
  v_mov_b32 v112, 0
  v_mov_b32 v113, 0
  v_mov_b32 v114, 0
  v_mov_b32 v115, 0
  v_mov_b32 v116, 0
  v_mov_b32 v117, 0
  v_mov_b32 v118, 0
  v_mov_b32 v119, 0
  v_mov_b32 v120, 0
  v_mov_b32 v121, 0
  v_mov_b32 v122, 0
  v_mov_b32 v123, 0
  s_branch FIRST1
NOTFIRST1:
  s_waitcnt vmcnt(0)
FIRST1:
  s_lshl_b32 s3, s57, 5
  v_lshrrev_b32 v2, 3, v0
  v_add_u32 v2, s3, v2
  s_movk_i32 s3, 25600
  v_mul_u32_u24 v2, s3, v2
  v_and_b32 v3, 7, v0
  v_lshl_add_u32 v2, v3, 4, v2
  v_lshlrev_b32 v3, 1, v3
  s_sub_i32 s68, s61, 15
  s_add_i32 s69, s68, s60
  s_max_i32 s68, s68, 0
  s_lshl_b32 s3, s68, 3
  v_add_u32 v2, s3, v2
  v_add_u32 v4, s68, v3
  v_mov_b32 v9, 1
  s_waitcnt lgkmcnt(0)
  s_barrier
  s_waitcnt vmcnt(3)
  v_ashrrev_i32 v5, 31, v131
  v_bfi_b32 v5, v5, 0, v130
  s_mov_b32 s3, 0
  v_mov_b32_dpp v6, v5 quad_perm:[3,3,3,3] row_mask:0xf bank_mask:0xf
  s_nop 1
  v_or_b32_dpp v6, v6, v6 row_half_mirror row_mask:0xf bank_mask:0xf
  v_lshrrev_b32 v220, 16, v6
  v_and_b32 v6, 0xffff, v6
  v_lshl_add_u32 v6, v6, 3, v2
  v_add_u32 v224, s3, v6
  v_min_i32 v216, s69, v220
  v_sub_u32 v216, v216, v4
  v_cmp_lt_i32 vcc, 0, v216
  s_nop 1
  v_cndmask_b32 v6, -16, v224, vcc
  buffer_load_dwordx4 v[144:147], v6, s[20:23], 0 offen
  s_waitcnt vmcnt(3)
  v_ashrrev_i32 v5, 31, v135
  v_bfi_b32 v5, v5, 0, v134
  s_mov_b32 s3, 204800
  v_mov_b32_dpp v6, v5 quad_perm:[3,3,3,3] row_mask:0xf bank_mask:0xf
  s_nop 1
  v_or_b32_dpp v6, v6, v6 row_half_mirror row_mask:0xf bank_mask:0xf
  v_lshrrev_b32 v221, 16, v6
  v_and_b32 v6, 0xffff, v6
  v_lshl_add_u32 v6, v6, 3, v2
  v_add_u32 v225, s3, v6
  v_min_i32 v217, s69, v221
  v_sub_u32 v217, v217, v4
  v_cmp_lt_i32 vcc, 0, v217
  s_nop 1
  v_cndmask_b32 v6, -16, v225, vcc
  buffer_load_dwordx4 v[148:151], v6, s[20:23], 0 offen
  s_waitcnt vmcnt(3)
  v_ashrrev_i32 v5, 31, v139
  v_bfi_b32 v5, v5, 0, v138
  s_mov_b32 s3, 409600
  v_mov_b32_dpp v6, v5 quad_perm:[3,3,3,3] row_mask:0xf bank_mask:0xf
  s_nop 1
  v_or_b32_dpp v6, v6, v6 row_half_mirror row_mask:0xf bank_mask:0xf
  v_lshrrev_b32 v222, 16, v6
  v_and_b32 v6, 0xffff, v6
  v_lshl_add_u32 v6, v6, 3, v2
  v_add_u32 v226, s3, v6
  v_min_i32 v218, s69, v222
  v_sub_u32 v218, v218, v4
  v_cmp_lt_i32 vcc, 0, v218
  s_nop 1
  v_cndmask_b32 v6, -16, v226, vcc
  buffer_load_dwordx4 v[152:155], v6, s[20:23], 0 offen
  s_waitcnt vmcnt(3)
  v_ashrrev_i32 v5, 31, v143
  v_bfi_b32 v5, v5, 0, v142
  s_mov_b32 s3, 614400
  v_mov_b32_dpp v6, v5 quad_perm:[3,3,3,3] row_mask:0xf bank_mask:0xf
  s_nop 1
  v_or_b32_dpp v6, v6, v6 row_half_mirror row_mask:0xf bank_mask:0xf
  v_lshrrev_b32 v223, 16, v6
  v_and_b32 v6, 0xffff, v6
  v_lshl_add_u32 v6, v6, 3, v2
  v_add_u32 v227, s3, v6
  v_min_i32 v219, s69, v223
  v_sub_u32 v219, v219, v4
  v_cmp_lt_i32 vcc, 0, v219
  s_nop 1
  v_cndmask_b32 v6, -16, v227, vcc
  buffer_load_dwordx4 v[156:159], v6, s[20:23], 0 offen
  v_max3_i32 v5, v216, v217, v218
  v_max_i32 v5, v5, v219
  v_cmp_lt_i32 s[76:77], 16, v5
  v_max3_i32 v5, v220, v221, v222
  v_max_i32 v5, v5, v223
  s_max_i32 s69, s69, 0
  v_cmp_lt_i32 s[68:69], s69, v5
  s_cmp_eq_u64 s[76:77], 0
  s_cbranch_scc1 NOL2A
  v_cmpx_lt_i32 vcc, 16, v216
  buffer_load_dwordx4 v[160:163], v224, s[20:23], 0 offen offset:128
  s_mov_b64 exec, -1
  v_cmpx_lt_i32 vcc, 16, v217
  buffer_load_dwordx4 v[164:167], v225, s[20:23], 0 offen offset:128
  s_mov_b64 exec, -1
  v_cmpx_lt_i32 vcc, 16, v218
  buffer_load_dwordx4 v[168:171], v226, s[20:23], 0 offen offset:128
  s_mov_b64 exec, -1
  v_cmpx_lt_i32 vcc, 16, v219
  buffer_load_dwordx4 v[172:175], v227, s[20:23], 0 offen offset:128
  s_mov_b64 exec, -1
NOL2A:
  s_cmp_lg_u32 s63, 0
  s_cbranch_scc1 FIRST2
  s_add_u32 s3, s61, s60
  v_add_u32 v5, 0, v3
  v_cmp_le_u32 s[32:33], s3, v5
  v_cmp_gt_u32 s[34:35], s61, v5
  s_or_b64 s[34:35], s[34:35], s[32:33]
  v_cmp_gt_i32 vcc, 0, v129
  s_and_b64 vcc, vcc, s[32:33]
  s_or_b64 s[68:69], s[68:69], vcc
  v_cndmask_b32 v129, v129, 0, s[34:35]
  v_cmp_gt_i32 vcc, 0, v133
  s_and_b64 vcc, vcc, s[32:33]
  s_or_b64 s[68:69], s[68:69], vcc
  v_cndmask_b32 v133, v133, 0, s[34:35]
  v_cmp_gt_i32 vcc, 0, v137
  s_and_b64 vcc, vcc, s[32:33]
  s_or_b64 s[68:69], s[68:69], vcc
  v_cndmask_b32 v137, v137, 0, s[34:35]
  v_cmp_gt_i32 vcc, 0, v141
  s_and_b64 vcc, vcc, s[32:33]
  s_or_b64 s[68:69], s[68:69], vcc
  v_cndmask_b32 v141, v141, 0, s[34:35]
  v_add_u32 v5, 1, v3
  v_cmp_le_u32 s[32:33], s3, v5
  v_cmp_gt_u32 s[34:35], s61, v5
  s_or_b64 s[34:35], s[34:35], s[32:33]
  v_cmp_gt_i32 vcc, 0, v131
  s_and_b64 vcc, vcc, s[32:33]
  s_or_b64 s[68:69], s[68:69], vcc
  v_cndmask_b32 v131, v131, 0, s[34:35]
  v_cmp_gt_i32 vcc, 0, v135
  s_and_b64 vcc, vcc, s[32:33]
  s_or_b64 s[68:69], s[68:69], vcc
  v_cndmask_b32 v135, v135, 0, s[34:35]
  v_cmp_gt_i32 vcc, 0, v139
  s_and_b64 vcc, vcc, s[32:33]
  s_or_b64 s[68:69], s[68:69], vcc
  v_cndmask_b32 v139, v139, 0, s[34:35]
  v_cmp_gt_i32 vcc, 0, v143
  s_and_b64 vcc, vcc, s[32:33]
  s_or_b64 s[68:69], s[68:69], vcc
  v_cndmask_b32 v143, v143, 0, s[34:35]
  s_waitcnt vmcnt(0)
FIRST2:
  s_cmp_eq_u64 s[68:69], 0
  s_cbranch_scc1 NOFLAG
  v_mov_b32 v5, 35328
  ds_write_b32 v5, v5
NOFLAG:
  v_cmp_gt_i32 s[32:33], 0, v129
  v_lshlrev_b32_sdwa v200, 2, v129 dst_sel:DWORD dst_unused:UNUSED_PAD src0_sel:DWORD src1_sel:BYTE_3
  v_cmp_gt_i32 s[34:35], 0, v131
  v_lshlrev_b32_sdwa v201, 2, v131 dst_sel:DWORD dst_unused:UNUSED_PAD src0_sel:DWORD src1_sel:BYTE_3
  v_cmp_gt_i32 s[36:37], 0, v133
  v_lshlrev_b32_sdwa v202, 2, v133 dst_sel:DWORD dst_unused:UNUSED_PAD src0_sel:DWORD src1_sel:BYTE_3
  v_cmp_gt_i32 s[38:39], 0, v135
  v_lshlrev_b32_sdwa v203, 2, v135 dst_sel:DWORD dst_unused:UNUSED_PAD src0_sel:DWORD src1_sel:BYTE_3
  v_cmp_gt_i32 s[40:41], 0, v137
  v_lshlrev_b32_sdwa v204, 2, v137 dst_sel:DWORD dst_unused:UNUSED_PAD src0_sel:DWORD src1_sel:BYTE_3
  v_cmp_gt_i32 s[42:43], 0, v139
  v_lshlrev_b32_sdwa v205, 2, v139 dst_sel:DWORD dst_unused:UNUSED_PAD src0_sel:DWORD src1_sel:BYTE_3
  v_cmp_gt_i32 s[44:45], 0, v141
  v_lshlrev_b32_sdwa v206, 2, v141 dst_sel:DWORD dst_unused:UNUSED_PAD src0_sel:DWORD src1_sel:BYTE_3
  v_cmp_gt_i32 s[46:47], 0, v143
  v_lshlrev_b32_sdwa v207, 2, v143 dst_sel:DWORD dst_unused:UNUSED_PAD src0_sel:DWORD src1_sel:BYTE_3
  s_mov_b64 exec, s[32:33]
  ds_add_rtn_u32 v176, v200, v9 offset:34304
  s_mov_b64 exec, s[34:35]
  ds_add_rtn_u32 v177, v201, v9 offset:34304
  s_mov_b64 exec, s[36:37]
  ds_add_rtn_u32 v178, v202, v9 offset:34304
  s_mov_b64 exec, s[38:39]
  ds_add_rtn_u32 v179, v203, v9 offset:34304
  s_mov_b64 exec, s[40:41]
  ds_add_rtn_u32 v180, v204, v9 offset:34304
  s_mov_b64 exec, s[42:43]
  ds_add_rtn_u32 v181, v205, v9 offset:34304
  s_mov_b64 exec, s[44:45]
  ds_add_rtn_u32 v182, v206, v9 offset:34304
  s_mov_b64 exec, s[46:47]
  ds_add_rtn_u32 v183, v207, v9 offset:34304
  s_mov_b64 exec, -1
  s_cmp_eq_u32 s63, 0
  s_cbranch_scc1 NOLATE1
  s_lshl_b32 s3, s57, 10
  v_lshl_add_u32 v10, v0, 4, s3
  v_add_u32 v10, 7340032, v10
  s_add_u32 m0, s3, 130560
  s_nop 0
  buffer_load_dwordx4 v10, s[20:23], 0 offen lds
  v_add_u32 v10, 0x2000, v10
  s_add_u32 m0, s3, 138752
  s_nop 0
  buffer_load_dwordx4 v10, s[20:23], 0 offen lds
  v_add_u32 v10, 0x2000, v10
  s_add_u32 m0, s3, 146944
  s_nop 0
  buffer_load_dwordx4 v10, s[20:23], 0 offen lds
  v_add_u32 v13, s3, v13
  s_add_u32 m0, s3, 114176
  s_nop 0
  buffer_load_dwordx4 v13, s[24:27], 0 offen lds
  v_add_u32 v13, 0x2000, v13
  s_add_u32 m0, s3, 122368
  s_nop 0
  buffer_load_dwordx4 v13, s[24:27], 0 offen lds
NOLATE1:
  s_cmp_eq_u64 s[76:77], 0
  s_cbranch_scc1 NOL2B
  s_waitcnt vmcnt(0)
  v_cmpx_lt_i32 vcc, 16, v216
  v_lshlrev_b32_sdwa v208, 2, v161 dst_sel:DWORD dst_unused:UNUSED_PAD src0_sel:DWORD src1_sel:BYTE_3
  ds_add_rtn_u32 v192, v208, v9 offset:34304
  v_cmpx_lt_i32 vcc, 17, v216
  v_lshlrev_b32_sdwa v209, 2, v163 dst_sel:DWORD dst_unused:UNUSED_PAD src0_sel:DWORD src1_sel:BYTE_3
  ds_add_rtn_u32 v193, v209, v9 offset:34304
  s_mov_b64 exec, -1
  v_cmpx_lt_i32 vcc, 16, v217
  v_lshlrev_b32_sdwa v210, 2, v165 dst_sel:DWORD dst_unused:UNUSED_PAD src0_sel:DWORD src1_sel:BYTE_3
  ds_add_rtn_u32 v194, v210, v9 offset:34304
  v_cmpx_lt_i32 vcc, 17, v217
  v_lshlrev_b32_sdwa v211, 2, v167 dst_sel:DWORD dst_unused:UNUSED_PAD src0_sel:DWORD src1_sel:BYTE_3
  ds_add_rtn_u32 v195, v211, v9 offset:34304
  s_mov_b64 exec, -1
  v_cmpx_lt_i32 vcc, 16, v218
  v_lshlrev_b32_sdwa v212, 2, v169 dst_sel:DWORD dst_unused:UNUSED_PAD src0_sel:DWORD src1_sel:BYTE_3
  ds_add_rtn_u32 v196, v212, v9 offset:34304
  v_cmpx_lt_i32 vcc, 17, v218
  v_lshlrev_b32_sdwa v213, 2, v171 dst_sel:DWORD dst_unused:UNUSED_PAD src0_sel:DWORD src1_sel:BYTE_3
  ds_add_rtn_u32 v197, v213, v9 offset:34304
  s_mov_b64 exec, -1
  v_cmpx_lt_i32 vcc, 16, v219
  v_lshlrev_b32_sdwa v214, 2, v173 dst_sel:DWORD dst_unused:UNUSED_PAD src0_sel:DWORD src1_sel:BYTE_3
  ds_add_rtn_u32 v198, v214, v9 offset:34304
  v_cmpx_lt_i32 vcc, 17, v219
  v_lshlrev_b32_sdwa v215, 2, v175 dst_sel:DWORD dst_unused:UNUSED_PAD src0_sel:DWORD src1_sel:BYTE_3
  ds_add_rtn_u32 v199, v215, v9 offset:34304
  s_mov_b64 exec, -1
NOL2B:
  s_waitcnt vmcnt(8)
  v_lshlrev_b32_sdwa v208, 2, v145 dst_sel:DWORD dst_unused:UNUSED_PAD src0_sel:DWORD src1_sel:BYTE_3
  v_lshlrev_b32_sdwa v209, 2, v147 dst_sel:DWORD dst_unused:UNUSED_PAD src0_sel:DWORD src1_sel:BYTE_3
  v_cmpx_lt_i32 vcc, 0, v216
  ds_add_rtn_u32 v184, v208, v9 offset:34304
  v_cmpx_lt_i32 vcc, 1, v216
  ds_add_rtn_u32 v185, v209, v9 offset:34304
  s_mov_b64 exec, -1
  s_waitcnt vmcnt(7)
  v_lshlrev_b32_sdwa v210, 2, v149 dst_sel:DWORD dst_unused:UNUSED_PAD src0_sel:DWORD src1_sel:BYTE_3
  v_lshlrev_b32_sdwa v211, 2, v151 dst_sel:DWORD dst_unused:UNUSED_PAD src0_sel:DWORD src1_sel:BYTE_3
  v_cmpx_lt_i32 vcc, 0, v217
  ds_add_rtn_u32 v186, v210, v9 offset:34304
  v_cmpx_lt_i32 vcc, 1, v217
  ds_add_rtn_u32 v187, v211, v9 offset:34304
  s_mov_b64 exec, -1
  s_waitcnt vmcnt(6)
  v_lshlrev_b32_sdwa v212, 2, v153 dst_sel:DWORD dst_unused:UNUSED_PAD src0_sel:DWORD src1_sel:BYTE_3
  v_lshlrev_b32_sdwa v213, 2, v155 dst_sel:DWORD dst_unused:UNUSED_PAD src0_sel:DWORD src1_sel:BYTE_3
  v_cmpx_lt_i32 vcc, 0, v218
  ds_add_rtn_u32 v188, v212, v9 offset:34304
  v_cmpx_lt_i32 vcc, 1, v218
  ds_add_rtn_u32 v189, v213, v9 offset:34304
  s_mov_b64 exec, -1
  s_waitcnt vmcnt(5)
  v_lshlrev_b32_sdwa v214, 2, v157 dst_sel:DWORD dst_unused:UNUSED_PAD src0_sel:DWORD src1_sel:BYTE_3
  v_lshlrev_b32_sdwa v215, 2, v159 dst_sel:DWORD dst_unused:UNUSED_PAD src0_sel:DWORD src1_sel:BYTE_3
  v_cmpx_lt_i32 vcc, 0, v219
  ds_add_rtn_u32 v190, v214, v9 offset:34304
  v_cmpx_lt_i32 vcc, 1, v219
  ds_add_rtn_u32 v191, v215, v9 offset:34304
  s_mov_b64 exec, -1
  v_lshlrev_b32 v2, 2, v0
  v_mov_b32 v3, 35328
  s_waitcnt lgkmcnt(0)
  s_barrier
  ds_read2st64_b32 v[4:5], v2 offset0:136 offset1:137
  ds_read_b32 v8, v3
  s_cmp_eq_u32 s63, 0
  s_cbranch_scc1 NOLATE3
  s_mul_i32 s3, s57, 4608
  s_add_u32 m0, s3, 44544
  s_nop 0
  buffer_load_dwordx4 v56, s[4:7], 0 offen lds
  s_add_u32 m0, s3, 45568
  s_nop 0
  buffer_load_dwordx4 v57, s[4:7], 0 offen lds
  s_add_u32 m0, s3, 46592
  s_nop 0
  buffer_load_dwordx4 v58, s[4:7], 0 offen lds
  s_add_u32 m0, s3, 47616
  s_nop 0
  buffer_load_dwordx4 v59, s[4:7], 0 offen lds
  buffer_load_dwordx2 v[124:125], v11, s[12:15], 0 offen
NOLATE3:
  s_waitcnt lgkmcnt(0)
  v_readfirstlane_b32 s62, v8
  v_mov_b32 v6, v4
  v_mov_b32 v7, v5
  s_nop 0
  v_add_u32_dpp v6, v6, v6 row_shr:1 row_mask:0xf bank_mask:0xf
  v_add_u32_dpp v7, v7, v7 row_shr:1 row_mask:0xf bank_mask:0xf
  s_nop 0
  v_add_u32_dpp v6, v6, v6 row_shr:2 row_mask:0xf bank_mask:0xf
  v_add_u32_dpp v7, v7, v7 row_shr:2 row_mask:0xf bank_mask:0xf
  s_nop 0
  v_add_u32_dpp v6, v6, v6 row_shr:4 row_mask:0xf bank_mask:0xf
  v_add_u32_dpp v7, v7, v7 row_shr:4 row_mask:0xf bank_mask:0xf
  s_nop 0
  v_add_u32_dpp v6, v6, v6 row_shr:8 row_mask:0xf bank_mask:0xf
  v_add_u32_dpp v7, v7, v7 row_shr:8 row_mask:0xf bank_mask:0xf
  v_max_u32 v8, v6, v7
  v_cmp_lt_u32 vcc, 0x200, v8
  s_cbranch_vccz NOOVF
  s_lshr_b32 s60, s60, 1
  s_mov_b32 s63, 0
  s_waitcnt vmcnt(0)
  s_barrier
  s_branch ROUND
NOOVF:
  s_and_b32 s3, s57, 3
  s_lshl_b32 s3, s3, 4
  s_add_u32 s3, s3, 15
  v_readlane_b32 s68, v6, s3
  v_readlane_b32 s69, v7, s3
  v_lshrrev_b32 v8, 4, v0
  v_mul_u32_u24 v8, 544, v8
  v_sub_u32 v6, v6, v4
  v_sub_u32 v7, v7, v5
  v_add_u32 v6, v6, v8
  v_add_u32 v7, v7, v8
  v_add_u32 v7, 2176, v7
  ds_write2st64_b32 v2, v6, v7 offset0:140 offset1:141
  s_cmp_ge_u32 s57, 4
  s_cselect_b32 s68, s69, s68
  s_add_u32 s59, s68, 31
  s_lshr_b32 s59, s59, 5
  ds_read_b32 v200, v200 offset:35328
  ds_read_b32 v201, v201 offset:35328
  ds_read_b32 v202, v202 offset:35328
  ds_read_b32 v203, v203 offset:35328
  ds_read_b32 v204, v204 offset:35328
  ds_read_b32 v205, v205 offset:35328
  ds_read_b32 v206, v206 offset:35328
  ds_read_b32 v207, v207 offset:35328
  ds_read_b32 v208, v208 offset:35328
  ds_read_b32 v209, v209 offset:35328
  ds_read_b32 v210, v210 offset:35328
  ds_read_b32 v211, v211 offset:35328
  ds_read_b32 v212, v212 offset:35328
  ds_read_b32 v213, v213 offset:35328
  ds_read_b32 v214, v214 offset:35328
  ds_read_b32 v215, v215 offset:35328
  s_waitcnt lgkmcnt(12)
  v_add_lshl_u32 v200, v200, v176, 2
  v_add_lshl_u32 v201, v201, v177, 2
  v_add_lshl_u32 v202, v202, v178, 2
  v_add_lshl_u32 v203, v203, v179, 2
  s_waitcnt lgkmcnt(8)
  v_add_lshl_u32 v204, v204, v180, 2
  v_add_lshl_u32 v205, v205, v181, 2
  v_add_lshl_u32 v206, v206, v182, 2
  v_add_lshl_u32 v207, v207, v183, 2
  s_waitcnt lgkmcnt(4)
  v_add_lshl_u32 v208, v208, v184, 2
  v_add_lshl_u32 v209, v209, v185, 2
  v_add_lshl_u32 v210, v210, v186, 2
  v_add_lshl_u32 v211, v211, v187, 2
  s_waitcnt lgkmcnt(0)
  v_add_lshl_u32 v212, v212, v188, 2
  v_add_lshl_u32 v213, v213, v189, 2
  v_add_lshl_u32 v214, v214, v190, 2
  v_add_lshl_u32 v215, v215, v191, 2
  s_mov_b64 exec, s[32:33]
  ds_write2st64_b32 v200, v128, v129 offset0:0 offset1:68
  s_mov_b64 exec, s[34:35]
  ds_write2st64_b32 v201, v130, v131 offset0:0 offset1:68
  s_mov_b64 exec, s[36:37]
  ds_write2st64_b32 v202, v132, v133 offset0:0 offset1:68
  s_mov_b64 exec, s[38:39]
  ds_write2st64_b32 v203, v134, v135 offset0:0 offset1:68
  s_mov_b64 exec, s[40:41]
  ds_write2st64_b32 v204, v136, v137 offset0:0 offset1:68
  s_mov_b64 exec, s[42:43]
  ds_write2st64_b32 v205, v138, v139 offset0:0 offset1:68
  s_mov_b64 exec, s[44:45]
  ds_write2st64_b32 v206, v140, v141 offset0:0 offset1:68
  s_mov_b64 exec, s[46:47]
  ds_write2st64_b32 v207, v142, v143 offset0:0 offset1:68
  s_mov_b64 exec, -1
  v_cmpx_lt_i32 vcc, 0, v216
  ds_write2st64_b32 v208, v144, v145 offset0:0 offset1:68
  v_cmpx_lt_i32 vcc, 1, v216
  ds_write2st64_b32 v209, v146, v147 offset0:0 offset1:68
  s_mov_b64 exec, -1
  v_cmpx_lt_i32 vcc, 0, v217
  ds_write2st64_b32 v210, v148, v149 offset0:0 offset1:68
  v_cmpx_lt_i32 vcc, 1, v217
  ds_write2st64_b32 v211, v150, v151 offset0:0 offset1:68
  s_mov_b64 exec, -1
  v_cmpx_lt_i32 vcc, 0, v218
  ds_write2st64_b32 v212, v152, v153 offset0:0 offset1:68
  v_cmpx_lt_i32 vcc, 1, v218
  ds_write2st64_b32 v213, v154, v155 offset0:0 offset1:68
  s_mov_b64 exec, -1
  v_cmpx_lt_i32 vcc, 0, v219
  ds_write2st64_b32 v214, v156, v157 offset0:0 offset1:68
  v_cmpx_lt_i32 vcc, 1, v219
  ds_write2st64_b32 v215, v158, v159 offset0:0 offset1:68
  s_mov_b64 exec, -1
  s_cmp_eq_u64 s[76:77], 0
  s_cbranch_scc1 NOL2C
  v_cmpx_lt_i32 vcc, 16, v216
  v_lshlrev_b32_sdwa v208, 2, v161 dst_sel:DWORD dst_unused:UNUSED_PAD src0_sel:DWORD src1_sel:BYTE_3
  ds_read_b32 v208, v208 offset:35328
  v_cmpx_lt_i32 vcc, 17, v216
  v_lshlrev_b32_sdwa v209, 2, v163 dst_sel:DWORD dst_unused:UNUSED_PAD src0_sel:DWORD src1_sel:BYTE_3
  ds_read_b32 v209, v209 offset:35328
  s_mov_b64 exec, -1
  v_cmpx_lt_i32 vcc, 16, v217
  v_lshlrev_b32_sdwa v210, 2, v165 dst_sel:DWORD dst_unused:UNUSED_PAD src0_sel:DWORD src1_sel:BYTE_3
  ds_read_b32 v210, v210 offset:35328
  v_cmpx_lt_i32 vcc, 17, v217
  v_lshlrev_b32_sdwa v211, 2, v167 dst_sel:DWORD dst_unused:UNUSED_PAD src0_sel:DWORD src1_sel:BYTE_3
  ds_read_b32 v211, v211 offset:35328
  s_mov_b64 exec, -1
  v_cmpx_lt_i32 vcc, 16, v218
  v_lshlrev_b32_sdwa v212, 2, v169 dst_sel:DWORD dst_unused:UNUSED_PAD src0_sel:DWORD src1_sel:BYTE_3
  ds_read_b32 v212, v212 offset:35328
  v_cmpx_lt_i32 vcc, 17, v218
  v_lshlrev_b32_sdwa v213, 2, v171 dst_sel:DWORD dst_unused:UNUSED_PAD src0_sel:DWORD src1_sel:BYTE_3
  ds_read_b32 v213, v213 offset:35328
  s_mov_b64 exec, -1
  v_cmpx_lt_i32 vcc, 16, v219
  v_lshlrev_b32_sdwa v214, 2, v173 dst_sel:DWORD dst_unused:UNUSED_PAD src0_sel:DWORD src1_sel:BYTE_3
  ds_read_b32 v214, v214 offset:35328
  v_cmpx_lt_i32 vcc, 17, v219
  v_lshlrev_b32_sdwa v215, 2, v175 dst_sel:DWORD dst_unused:UNUSED_PAD src0_sel:DWORD src1_sel:BYTE_3
  ds_read_b32 v215, v215 offset:35328
  s_mov_b64 exec, -1
  s_waitcnt lgkmcnt(0)
  v_cmpx_lt_i32 vcc, 16, v216
  v_add_lshl_u32 v208, v208, v192, 2
  ds_write2st64_b32 v208, v160, v161 offset0:0 offset1:68
  v_cmpx_lt_i32 vcc, 17, v216
  v_add_lshl_u32 v209, v209, v193, 2
  ds_write2st64_b32 v209, v162, v163 offset0:0 offset1:68
  s_mov_b64 exec, -1
  v_cmpx_lt_i32 vcc, 16, v217
  v_add_lshl_u32 v210, v210, v194, 2
  ds_write2st64_b32 v210, v164, v165 offset0:0 offset1:68
  v_cmpx_lt_i32 vcc, 17, v217
  v_add_lshl_u32 v211, v211, v195, 2
  ds_write2st64_b32 v211, v166, v167 offset0:0 offset1:68
  s_mov_b64 exec, -1
  v_cmpx_lt_i32 vcc, 16, v218
  v_add_lshl_u32 v212, v212, v196, 2
  ds_write2st64_b32 v212, v168, v169 offset0:0 offset1:68
  v_cmpx_lt_i32 vcc, 17, v218
  v_add_lshl_u32 v213, v213, v197, 2
  ds_write2st64_b32 v213, v170, v171 offset0:0 offset1:68
  s_mov_b64 exec, -1
  v_cmpx_lt_i32 vcc, 16, v219
  v_add_lshl_u32 v214, v214, v198, 2
  ds_write2st64_b32 v214, v172, v173 offset0:0 offset1:68
  v_cmpx_lt_i32 vcc, 17, v219
  v_add_lshl_u32 v215, v215, v199, 2
  ds_write2st64_b32 v215, v174, v175 offset0:0 offset1:68
  s_mov_b64 exec, -1
NOL2C:
  s_mul_i32 s3, s57, 2176
  v_lshrrev_b32 v2, 3, v0
  v_lshl_add_u32 v250, v2, 4, s3
  v_and_b32 v2, 31, v0
  v_lshl_add_u32 v251, v2, 2, s3
  v_bfe_u32 v2, v0, 2, 2
  v_lshl_add_u32 v2, v2, 4, s3
  v_lshl_add_u32 v252, v254, 2, v2
  v_add_u32 v2, s68, v0
  s_lshl_b32 s69, s59, 5
  v_lshl_add_u32 v3, v2, 2, s3
  s_sub_u32 s3, s58, s69
  v_add_u32 v4, s3, v2
  v_mov_b32 v5, 0xffff
  v_cmp_gt_u32 vcc, s69, v2
  s_nop 1
  v_cndmask_b32 v4, v4, v5, vcc
  v_or_b32 v4, 0xf8000000, v4
  v_mov_b32 v5, 0x00ffffff
  s_add_u32 s69, s69, 32
  v_cmpx_gt_u32 vcc, s69, v2
  ds_write2st64_b32 v3, v4, v5 offset0:0 offset1:68
  s_mov_b64 exec, -1
  s_mov_b32 s63, 0
  v_mov_b32 v228, 0
  v_mov_b32 v229, 0
  v_mov_b32 v230, 0
  v_mov_b32 v231, 0
  s_waitcnt vmcnt(5) lgkmcnt(0)
  s_barrier
  ds_read_b128 v[224:227], v250 offset:0
  ds_read_b32 v232, v251 offset:0
  ds_read_b32 v1, v251 offset:17408
  s_cmp_gt_i32 s59, -1
  s_cselect_b32 s6, 6400000, 0
  s_cselect_b32 s10, 25600000, 0
  s_cselect_b32 s14, 300000, 0
  s_waitcnt lgkmcnt(0)
  v_mad_u32_u24 v1, v1, 32, v254
  buffer_load_dwordx4 v[216:219], v1, s[8:11], 0 offen
  s_add_u32 m0, s66, 0
  v_mad_u32_u24 v224, v224, s64, v237
  buffer_load_dwordx4 v224, s[4:7], 0 offen  lds
  s_add_u32 m0, s66, 1024
  v_mad_u32_u24 v225, v225, s64, v238
  buffer_load_dwordx4 v225, s[4:7], 0 offen  lds
  s_add_u32 m0, s66, 2048
  v_mad_u32_u24 v226, v226, s64, v239
  buffer_load_dwordx4 v226, s[4:7], 0 offen  lds
  s_add_u32 m0, s66, 3072
  v_mad_u32_u24 v227, v227, s64, v240
  buffer_load_dwordx4 v227, s[4:7], 0 offen  lds
  v_mul_u32_u24 v1, 6, v232
  v_and_b32 v1, -4, v1
  s_mov_b64 exec, s[74:75]
  buffer_load_dwordx2 v[228:229], v1, s[12:15], 0 offen
  s_mov_b64 exec, -1
  ds_read_b128 v[224:227], v250 offset:128
  ds_read_b32 v233, v251 offset:128
  ds_read_b32 v1, v251 offset:17536
  s_waitcnt lgkmcnt(0)
  s_cmp_eq_u32 s54, 0
  s_cbranch_scc1 NOINIT2
  v_lshlrev_b32 v2, 4, v0
  v_add_u32 v2, 130560, v2
  s_lshl_b32 s3, s57, 9
  s_sub_u32 s3, s3, 36864
  s_waitcnt vmcnt(6)
  v_add_u32 v6, s3, v241
  ds_read_b128 v[200:203], v6
  v_add_u32 v7, s3, v242
  ds_read_b128 v[204:207], v7
  v_add_u32 v8, s3, v243
  ds_read_b128 v[208:211], v8
  v_add_u32 v9, s3, v244
  ds_read_b128 v[212:215], v9
  ds_read_b128 v[128:131], v2 offset:0
  ds_read_b128 v[132:135], v2 offset:1024
  ds_read_b128 v[136:139], v2 offset:2048
  ds_read_b128 v[140:143], v2 offset:3072
  ds_read_b128 v[144:147], v2 offset:4096
  ds_read_b128 v[148:151], v2 offset:5120
  ds_read_b128 v[152:155], v2 offset:6144
  ds_read_b128 v[156:159], v2 offset:7168
  ds_read_b64 v[4:5], v2 offset:18432
  ds_read_b128 v[16:19], v2 offset:8192
  ds_read_b128 v[20:23], v2 offset:9216
  ds_read_b128 v[24:27], v2 offset:10240
  ds_read_b128 v[28:31], v2 offset:11264
  ds_read_b128 v[32:35], v2 offset:12288
  ds_read_b128 v[36:39], v2 offset:13312
  ds_read_b128 v[40:43], v2 offset:14336
  ds_read_b128 v[44:47], v2 offset:15360
  ds_read_b128 v[48:51], v2 offset:16384
  ds_read_b128 v[52:55], v2 offset:17408
  ds_read_b128 v[72:75], v2 offset:20480
  ds_read_b128 v[76:79], v2 offset:21504
  ds_read_b128 v[80:83], v2 offset:22528
  ds_read_b128 v[84:87], v2 offset:23552
  v_lshlrev_b32 v7, 4, v12
  v_alignbit_b32 v8, v125, v124, v7
  v_lshrrev_b32 v9, v7, v125
  v_lshlrev_b32 v6, 16, v8
  v_and_b32 v7, s65, v8
  v_lshlrev_b32 v8, 16, v9
  v_lshl_add_u32 v9, v0, 3, s67
  s_mov_b64 exec, s[74:75]
  ds_write_b64 v9, v[6:7] offset:512
  ds_write_b32 v9, v8 offset:768
  s_mov_b64 exec, -1
  s_waitcnt lgkmcnt(15)
  v_mfma_f32_32x32x16_bf16 v[160:175], v[200:203], v[128:131], 0
  v_mfma_f32_32x32x16_bf16 v[176:191], v[200:203], v[144:147], 0
  v_mfma_f32_32x32x16_bf16 v[160:175], v[204:207], v[132:135], v[160:175]
  v_mfma_f32_32x32x16_bf16 v[176:191], v[204:207], v[148:151], v[176:191]
  v_mfma_f32_32x32x16_bf16 v[160:175], v[208:211], v[136:139], v[160:175]
  v_mfma_f32_32x32x16_bf16 v[176:191], v[208:211], v[152:155], v[176:191]
  v_mfma_f32_32x32x16_bf16 v[160:175], v[212:215], v[140:143], v[160:175]
  v_mfma_f32_32x32x16_bf16 v[176:191], v[212:215], v[156:159], v[176:191]
  s_waitcnt lgkmcnt(0)
  s_mov_b32 s54, 0
  s_nop 7
  s_nop 0
  v_pk_mul_f32 v[160:161], v[160:161], s[70:71]
  v_cvt_pk_f16_f32 v56, v160, v161
  v_pk_mul_f32 v[162:163], v[162:163], s[70:71]
  v_cvt_pk_f16_f32 v57, v162, v163
  v_pk_mul_f32 v[164:165], v[164:165], s[70:71]
  v_cvt_pk_f16_f32 v58, v164, v165
  v_pk_mul_f32 v[166:167], v[166:167], s[70:71]
  v_cvt_pk_f16_f32 v59, v166, v167
  v_pk_mul_f32 v[168:169], v[168:169], s[70:71]
  v_cvt_pk_f16_f32 v60, v168, v169
  v_pk_mul_f32 v[170:171], v[170:171], s[70:71]
  v_cvt_pk_f16_f32 v61, v170, v171
  v_pk_mul_f32 v[172:173], v[172:173], s[70:71]
  v_cvt_pk_f16_f32 v62, v172, v173
  v_pk_mul_f32 v[176:177], v[176:177], s[70:71]
  v_cvt_pk_f16_f32 v64, v176, v177
  v_pk_mul_f32 v[178:179], v[178:179], s[70:71]
  v_cvt_pk_f16_f32 v65, v178, v179
  v_pk_mul_f32 v[180:181], v[180:181], s[70:71]
  v_cvt_pk_f16_f32 v66, v180, v181
  v_pk_mul_f32 v[182:183], v[182:183], s[70:71]
  v_cvt_pk_f16_f32 v67, v182, v183
  v_pk_mul_f32 v[184:185], v[184:185], s[70:71]
  v_cvt_pk_f16_f32 v68, v184, v185
  v_pk_mul_f32 v[186:187], v[186:187], s[70:71]
  v_cvt_pk_f16_f32 v69, v186, v187
  v_pk_mul_f32 v[188:189], v[188:189], s[70:71]
  v_cvt_pk_f16_f32 v70, v188, v189
  v_mov_b32 v63, v4
  v_mov_b32 v71, v5
NOINIT2:
  v_mov_b32 v184, 0
  v_mov_b32 v168, 0
  v_mov_b32 v185, 0
  v_mov_b32 v169, 0
  v_mov_b32 v186, 0
  v_mov_b32 v170, 0
  v_mov_b32 v187, 0
  v_mov_b32 v171, 0
  v_mov_b32 v188, 0
  v_mov_b32 v172, 0
  v_mov_b32 v189, 0
  v_mov_b32 v173, 0
  v_mov_b32 v190, 0
  v_mov_b32 v174, 0
  v_mov_b32 v191, 0
  v_mov_b32 v175, 0
  v_mov_b32 v124, 0
  v_mov_b32 v125, 0
  v_mov_b32 v126, 0
  v_mov_b32 v127, 0
  v_mov_b32 v13, 0
  v_mov_b32 v14, 0
  v_mov_b32 v15, 0
  s_mul_i32 s3, s57, 4608
  s_add_u32 s3, s3, 44544
  v_lshl_add_u32 v2, v0, 3, s3
  ds_write_b64 v2, v[184:185] offset:0
  ds_write_b64 v2, v[184:185] offset:512
  ds_write_b64 v2, v[184:185] offset:1024
  ds_write_b64 v2, v[184:185] offset:1536
  ds_write_b64 v2, v[184:185] offset:2048
  ds_write_b64 v2, v[184:185] offset:2560
  ds_write_b64 v2, v[184:185] offset:3072
  ds_write_b64 v2, v[184:185] offset:3584
  ds_write_b64 v2, v[184:185] offset:4096
  s_waitcnt vmcnt(0)
  ds_read_b128 v[200:203], v241
  ds_read_b128 v[204:207], v242
  ds_read_b128 v[208:211], v243
  ds_read_b128 v[212:215], v244
  v_add_u32_sdwa v253, v245, v232 dst_sel:DWORD dst_unused:UNUSED_PAD src0_sel:DWORD src1_sel:BYTE_3
  ds_read_b64 v[234:235], v253 offset:480
  ds_read_b32 v236, v253 offset:736
  v_lshlrev_b32 v125, 4, v232
  v_alignbit_b32 v126, v229, v228, v125
  v_lshrrev_b32 v127, v125, v229
  ds_read_b64 v[176:177], v253 offset:192
  ds_read_b64 v[178:179], v253 offset:128
  ds_read_b64 v[180:181], v253 offset:64
  ds_read_b32 v182, v253
  v_mfma_f32_32x32x16_bf16 v[128:143], v[48:51], v[216:219], 0
  v_mfma_f32_32x32x16_bf16 v[144:159], v[52:55], v[216:219], 0
  v_lshlrev_b32 v125, 16, v126
  v_and_b32 v126, s65, v126
  v_lshlrev_b32 v127, 16, v127
  s_waitcnt lgkmcnt(5)
  v_sub_f32 v234, v234, v125
  v_sub_f32 v235, v235, v126
  s_waitcnt lgkmcnt(4)
  v_sub_f32 v236, v236, v127
  v_cvt_pk_bf16_f32 v234, v234, v235
  v_cvt_pk_bf16_f32 v236, v236, v236
  v_lshlrev_b32 v10, 16, v234
  v_and_b32 v11, s65, v234
  v_lshlrev_b32 v12, 16, v236
  v_mul_f32 v234, v10, v10
  v_fmac_f32 v234, v11, v11
  v_fmac_f32 v234, v12, v12
  v_cvt_pk_f16_f32 v183, v234, v234
  v_mfma_f32_32x32x16_bf16 v[128:143], v[16:19], v[200:203], v[128:143]
  v_mfma_f32_32x32x16_bf16 v[128:143], v[20:23], v[204:207], v[128:143]
  v_mfma_f32_32x32x16_bf16 v[128:143], v[24:27], v[208:211], v[128:143]
  v_mfma_f32_32x32x16_bf16 v[128:143], v[28:31], v[212:215], v[128:143]
  s_waitcnt lgkmcnt(2)
  v_mfma_f32_32x32x16_f16 v[128:143], v[56:59], v[176:179], v[128:143]
  s_waitcnt lgkmcnt(0)
  v_mfma_f32_32x32x16_f16 v[128:143], v[60:63], v[180:183], v[128:143]
  s_cmp_gt_i32 s59, 0
  s_cselect_b32 s6, 6400000, 0
  s_cselect_b32 s10, 25600000, 0
  s_cselect_b32 s14, 300000, 0
  v_mad_u32_u24 v1, v1, 32, v254
  buffer_load_dwordx4 v[220:223], v1, s[8:11], 0 offen
  s_add_u32 m0, s66, 0
  v_mad_u32_u24 v224, v224, s64, v237
  buffer_load_dwordx4 v224, s[4:7], 0 offen  lds
  s_add_u32 m0, s66, 1024
  v_mad_u32_u24 v225, v225, s64, v238
  buffer_load_dwordx4 v225, s[4:7], 0 offen  lds
  s_add_u32 m0, s66, 2048
  v_mad_u32_u24 v226, v226, s64, v239
  buffer_load_dwordx4 v226, s[4:7], 0 offen  lds
  s_add_u32 m0, s66, 3072
  v_mad_u32_u24 v227, v227, s64, v240
  buffer_load_dwordx4 v227, s[4:7], 0 offen  lds
  v_mul_u32_u24 v1, 6, v233
  v_and_b32 v1, -4, v1
  s_mov_b64 exec, s[74:75]
  buffer_load_dwordx2 v[230:231], v1, s[12:15], 0 offen
  s_mov_b64 exec, -1
  s_waitcnt lgkmcnt(0)
  s_cmp_eq_u32 s59, 0
  s_cbranch_scc1 LOOPEND
  s_cmp_ge_u32 s57, 4
  s_movk_i32 s79, 0
  s_cmovk_i32 s79, 0
LOOP:
  ds_read_b64_tr_b16 v[192:193], v248 offset:64
  ds_read_b64_tr_b16 v[194:195], v248 offset:208
  ds_read_b64_tr_b16 v[196:197], v248 offset:352
  ds_read_b64_tr_b16 v[198:199], v248 offset:496
  v_cvt_pk_f16_f32 v160, v128, v129
  v_cvt_pk_f16_f32 v161, v130, v131
  v_cvt_pk_f16_f32 v162, v132, v133
  v_cvt_pk_f16_f32 v163, v134, v135
  v_cvt_pk_f16_f32 v164, v136, v137
  v_cvt_pk_f16_f32 v165, v138, v139
  v_cvt_pk_f16_f32 v166, v140, v141
  v_cvt_pk_f16_f32 v167, v142, v143
  v_mfma_f32_16x16x32_f16 v[124:127], v[80:83], v[168:171], v[124:127]
  v_exp_f16_sdwa v2, v160 dst_sel:WORD_0 dst_unused:UNUSED_PAD src0_sel:WORD_0
  s_mov_b64 exec, 1
  ds_add_rtn_u32 v255, v0, v238 offset:35336
  s_mov_b64 exec, -1
  v_exp_f16_sdwa v3, v161 dst_sel:WORD_0 dst_unused:UNUSED_PAD src0_sel:WORD_0
  v_mfma_f32_16x16x32_f16 v[124:127], v[84:87], v[172:175], v[124:127]
  v_exp_f16_sdwa v4, v162 dst_sel:WORD_0 dst_unused:UNUSED_PAD src0_sel:WORD_0
  v_exp_f16_sdwa v5, v163 dst_sel:WORD_0 dst_unused:UNUSED_PAD src0_sel:WORD_0
  v_mfma_f32_32x32x16_bf16 v[144:159], v[32:35], v[200:203], v[144:159]
  v_exp_f16_sdwa v2, v160 dst_sel:WORD_1 dst_unused:UNUSED_PRESERVE src0_sel:WORD_1
  v_exp_f16_sdwa v3, v161 dst_sel:WORD_1 dst_unused:UNUSED_PRESERVE src0_sel:WORD_1
  v_exp_f16_sdwa v4, v162 dst_sel:WORD_1 dst_unused:UNUSED_PRESERVE src0_sel:WORD_1
  s_waitcnt lgkmcnt(3)
  v_mfma_f32_32x32x16_f16 v[104:119], v[192:195], v[184:187], v[104:119]
  v_exp_f16_sdwa v5, v163 dst_sel:WORD_1 dst_unused:UNUSED_PRESERVE src0_sel:WORD_1
  v_pk_add_f16 v2, v2, 1.0 op_sel_hi:[1,0]
  v_pk_add_f16 v3, v3, 1.0 op_sel_hi:[1,0]
  v_pk_add_f16 v4, v4, 1.0 op_sel_hi:[1,0]
  v_pk_add_f16 v5, v5, 1.0 op_sel_hi:[1,0]
  v_mul_f32 v234, v13, v124
  v_mul_f32 v235, v14, v124
  v_mul_f32 v236, v15, v124
  v_cvt_pk_f16_f32 v234, v234, v235
  v_cvt_pk_f16_f32 v235, v236, v236
  s_mov_b64 exec, s[74:75]
  ds_write_b64 v246, v[234:235] offset:128
  s_mov_b64 exec, -1
  v_rcp_f16_sdwa v6, v2 dst_sel:WORD_0 dst_unused:UNUSED_PAD src0_sel:WORD_0
  v_rcp_f16_sdwa v7, v3 dst_sel:WORD_0 dst_unused:UNUSED_PAD src0_sel:WORD_0
  s_waitcnt lgkmcnt(2)
  v_mfma_f32_32x32x16_f16 v[104:119], v[196:199], v[188:191], v[104:119]
  ds_read_b64_tr_b16 v[192:193], v249 offset:0
  ds_read_b64_tr_b16 v[194:195], v249 offset:144
  ds_read_b64_tr_b16 v[196:197], v249 offset:288
  ds_read_b64_tr_b16 v[198:199], v249 offset:432
  v_rcp_f16_sdwa v8, v4 dst_sel:WORD_0 dst_unused:UNUSED_PAD src0_sel:WORD_0
  s_waitcnt lgkmcnt(5)
  v_readfirstlane_b32 s68, v255
  s_setprio 1
  s_cmp_lt_i32 s68, s79
  s_cbranch_scc0 PRI0
  s_setprio 0
PRI0:
  s_add_u32 s79, s79, 128
  v_rcp_f16_sdwa v9, v5 dst_sel:WORD_0 dst_unused:UNUSED_PAD src0_sel:WORD_0
  v_rcp_f16_sdwa v6, v2 dst_sel:WORD_1 dst_unused:UNUSED_PRESERVE src0_sel:WORD_1
  v_mfma_f32_32x32x16_bf16 v[144:159], v[36:39], v[204:207], v[144:159]
  v_rcp_f16_sdwa v7, v3 dst_sel:WORD_1 dst_unused:UNUSED_PRESERVE src0_sel:WORD_1
  v_rcp_f16_sdwa v8, v4 dst_sel:WORD_1 dst_unused:UNUSED_PRESERVE src0_sel:WORD_1
  v_rcp_f16_sdwa v9, v5 dst_sel:WORD_1 dst_unused:UNUSED_PRESERVE src0_sel:WORD_1
  v_pk_mul_f16 v160, v160, v6
  v_pk_mul_f16 v161, v161, v7
  v_pk_mul_f16 v162, v162, v8
  v_pk_mul_f16 v163, v163, v9
  ds_write_b128 v246, v[160:163] offset:0
  v_mfma_f32_32x32x16_bf16 v[144:159], v[40:43], v[208:211], v[144:159]
  v_exp_f16_sdwa v2, v164 dst_sel:WORD_0 dst_unused:UNUSED_PAD src0_sel:WORD_0
  v_exp_f16_sdwa v3, v165 dst_sel:WORD_0 dst_unused:UNUSED_PAD src0_sel:WORD_0
  v_exp_f16_sdwa v4, v166 dst_sel:WORD_0 dst_unused:UNUSED_PAD src0_sel:WORD_0
  v_mfma_f32_32x32x16_bf16 v[144:159], v[44:47], v[212:215], v[144:159]
  v_exp_f16_sdwa v5, v167 dst_sel:WORD_0 dst_unused:UNUSED_PAD src0_sel:WORD_0
  v_exp_f16_sdwa v2, v164 dst_sel:WORD_1 dst_unused:UNUSED_PRESERVE src0_sel:WORD_1
  v_exp_f16_sdwa v3, v165 dst_sel:WORD_1 dst_unused:UNUSED_PRESERVE src0_sel:WORD_1
  v_mfma_f32_32x32x16_f16 v[144:159], v[64:67], v[176:179], v[144:159]
  v_exp_f16_sdwa v4, v166 dst_sel:WORD_1 dst_unused:UNUSED_PRESERVE src0_sel:WORD_1
  v_exp_f16_sdwa v5, v167 dst_sel:WORD_1 dst_unused:UNUSED_PRESERVE src0_sel:WORD_1
  v_pk_add_f16 v2, v2, 1.0 op_sel_hi:[1,0]
  v_pk_add_f16 v3, v3, 1.0 op_sel_hi:[1,0]
  v_pk_add_f16 v4, v4, 1.0 op_sel_hi:[1,0]
  v_pk_add_f16 v5, v5, 1.0 op_sel_hi:[1,0]
  v_rcp_f16_sdwa v6, v2 dst_sel:WORD_0 dst_unused:UNUSED_PAD src0_sel:WORD_0
  v_mfma_f32_32x32x16_f16 v[144:159], v[68:71], v[180:183], v[144:159]
  v_rcp_f16_sdwa v7, v3 dst_sel:WORD_0 dst_unused:UNUSED_PAD src0_sel:WORD_0
  s_waitcnt vmcnt(0)
  ds_read_b128 v[200:203], v241
  ds_read_b128 v[204:207], v242
  v_rcp_f16_sdwa v8, v4 dst_sel:WORD_0 dst_unused:UNUSED_PAD src0_sel:WORD_0
  ds_read_b128 v[224:227], v250 offset:256
  ds_read_b32 v232, v251 offset:256
  ds_read_b32 v1, v251 offset:17664
  v_rcp_f16_sdwa v9, v5 dst_sel:WORD_0 dst_unused:UNUSED_PAD src0_sel:WORD_0
  s_waitcnt lgkmcnt(8)
  v_mfma_f32_16x16x32_f16 v[120:123], v[192:195], v[184:187], v[120:123]
  ds_read_b128 v[208:211], v243
  ds_read_b128 v[212:215], v244
  v_rcp_f16_sdwa v6, v2 dst_sel:WORD_1 dst_unused:UNUSED_PRESERVE src0_sel:WORD_1
  v_add_u32_sdwa v253, v245, v233 dst_sel:DWORD dst_unused:UNUSED_PAD src0_sel:DWORD src1_sel:BYTE_3
  ds_read_b64 v[234:235], v253 offset:480
  ds_read_b32 v236, v253 offset:736
  v_lshlrev_b32 v125, 4, v233
  v_alignbit_b32 v126, v231, v230, v125
  v_lshrrev_b32 v127, v125, v231
  v_rcp_f16_sdwa v7, v3 dst_sel:WORD_1 dst_unused:UNUSED_PRESERVE src0_sel:WORD_1
  s_waitcnt lgkmcnt(10)
  v_mfma_f32_16x16x32_f16 v[120:123], v[196:199], v[188:191], v[120:123]
  ds_read_b128 v[184:187], v252 offset:0
  ds_read_b64 v[176:177], v253 offset:192
  ds_read_b64 v[178:179], v253 offset:128
  ds_read_b64 v[180:181], v253 offset:64
  ds_read_b32 v182, v253
  v_rcp_f16_sdwa v8, v4 dst_sel:WORD_1 dst_unused:UNUSED_PRESERVE src0_sel:WORD_1
  v_rcp_f16_sdwa v9, v5 dst_sel:WORD_1 dst_unused:UNUSED_PRESERVE src0_sel:WORD_1
  v_pk_mul_f16 v164, v164, v6
  v_pk_mul_f16 v165, v165, v7
  v_pk_mul_f16 v166, v166, v8
  v_pk_mul_f16 v167, v167, v9
  ds_write_b128 v246, v[164:167] offset:16
  ds_read_b64_tr_b16 v[192:193], v248 offset:0
  ds_read_b64_tr_b16 v[194:195], v248 offset:144
  ds_read_b64_tr_b16 v[196:197], v248 offset:288
  ds_read_b64_tr_b16 v[198:199], v248 offset:432
  v_cvt_pk_f16_f32 v168, v144, v145
  v_cvt_pk_f16_f32 v169, v146, v147
  v_cvt_pk_f16_f32 v170, v148, v149
  v_cvt_pk_f16_f32 v171, v150, v151
  v_cvt_pk_f16_f32 v172, v152, v153
  v_cvt_pk_f16_f32 v173, v154, v155
  v_cvt_pk_f16_f32 v174, v156, v157
  v_cvt_pk_f16_f32 v175, v158, v159
  v_mfma_f32_32x32x16_bf16 v[128:143], v[48:51], v[220:223], 0
  v_exp_f16_sdwa v2, v168 dst_sel:WORD_0 dst_unused:UNUSED_PAD src0_sel:WORD_0
  v_exp_f16_sdwa v3, v169 dst_sel:WORD_0 dst_unused:UNUSED_PAD src0_sel:WORD_0
  v_exp_f16_sdwa v4, v170 dst_sel:WORD_0 dst_unused:UNUSED_PAD src0_sel:WORD_0
  v_mfma_f32_32x32x16_bf16 v[144:159], v[52:55], v[220:223], 0
  v_lshlrev_b32 v125, 16, v126
  v_and_b32 v126, s65, v126
  v_lshlrev_b32 v127, 16, v127
  s_cmp_gt_i32 s59, 1
  s_cselect_b32 s6, 6400000, 0
  s_cselect_b32 s10, 25600000, 0
  s_cselect_b32 s14, 300000, 0
  s_waitcnt lgkmcnt(14)
  v_mad_u32_u24 v1, v1, 32, v254
  buffer_load_dwordx4 v[216:219], v1, s[8:11], 0 offen
  v_exp_f16_sdwa v5, v171 dst_sel:WORD_0 dst_unused:UNUSED_PAD src0_sel:WORD_0
  v_exp_f16_sdwa v2, v168 dst_sel:WORD_1 dst_unused:UNUSED_PRESERVE src0_sel:WORD_1
  v_mfma_f32_32x32x16_bf16 v[128:143], v[16:19], v[200:203], v[128:143]
  s_add_u32 m0, s66, 0
  v_mad_u32_u24 v224, v224, s64, v237
  s_waitcnt lgkmcnt(12)
  buffer_load_dwordx4 v224, s[4:7], 0 offen  lds
  v_exp_f16_sdwa v3, v169 dst_sel:WORD_1 dst_unused:UNUSED_PRESERVE src0_sel:WORD_1
  v_exp_f16_sdwa v4, v170 dst_sel:WORD_1 dst_unused:UNUSED_PRESERVE src0_sel:WORD_1
  s_waitcnt lgkmcnt(9)
  v_add_u32_sdwa v184, v247, v184 dst_sel:DWORD dst_unused:UNUSED_PAD src0_sel:DWORD src1_sel:BYTE_3
  v_add_u32_sdwa v185, v247, v185 dst_sel:DWORD dst_unused:UNUSED_PAD src0_sel:DWORD src1_sel:BYTE_3
  v_add_u32_sdwa v186, v247, v186 dst_sel:DWORD dst_unused:UNUSED_PAD src0_sel:DWORD src1_sel:BYTE_3
  v_add_u32_sdwa v187, v247, v187 dst_sel:DWORD dst_unused:UNUSED_PAD src0_sel:DWORD src1_sel:BYTE_3
  ds_read_b64_tr_b16 v[190:191], v187
  ds_read_b64_tr_b16 v[188:189], v186
  ds_read_b64_tr_b16 v[186:187], v185
  ds_read_b64_tr_b16 v[184:185], v184
  v_exp_f16_sdwa v5, v171 dst_sel:WORD_1 dst_unused:UNUSED_PRESERVE src0_sel:WORD_1
  v_pk_add_f16 v2, v2, 1.0 op_sel_hi:[1,0]
  v_pk_add_f16 v3, v3, 1.0 op_sel_hi:[1,0]
  v_pk_add_f16 v4, v4, 1.0 op_sel_hi:[1,0]
  v_pk_add_f16 v5, v5, 1.0 op_sel_hi:[1,0]
  v_mfma_f32_32x32x16_bf16 v[128:143], v[20:23], v[204:207], v[128:143]
  v_sub_f32 v234, v234, v125
  v_sub_f32 v235, v235, v126
  v_sub_f32 v236, v236, v127
  v_cvt_pk_bf16_f32 v234, v234, v235
  v_cvt_pk_bf16_f32 v236, v236, v236
  v_lshlrev_b32 v13, 16, v234
  v_and_b32 v14, s65, v234
  v_lshlrev_b32 v15, 16, v236
  s_add_u32 m0, s66, 1024
  v_mad_u32_u24 v225, v225, s64, v238
  buffer_load_dwordx4 v225, s[4:7], 0 offen  lds
  v_rcp_f16_sdwa v6, v2 dst_sel:WORD_0 dst_unused:UNUSED_PAD src0_sel:WORD_0
  v_rcp_f16_sdwa v7, v3 dst_sel:WORD_0 dst_unused:UNUSED_PAD src0_sel:WORD_0
  v_rcp_f16_sdwa v8, v4 dst_sel:WORD_0 dst_unused:UNUSED_PAD src0_sel:WORD_0
  v_mfma_f32_32x32x16_bf16 v[128:143], v[24:27], v[208:211], v[128:143]
  s_add_u32 m0, s66, 2048
  v_mad_u32_u24 v226, v226, s64, v239
  buffer_load_dwordx4 v226, s[4:7], 0 offen  lds
  v_rcp_f16_sdwa v9, v5 dst_sel:WORD_0 dst_unused:UNUSED_PAD src0_sel:WORD_0
  v_rcp_f16_sdwa v6, v2 dst_sel:WORD_1 dst_unused:UNUSED_PRESERVE src0_sel:WORD_1
  v_mfma_f32_32x32x16_bf16 v[128:143], v[28:31], v[212:215], v[128:143]
  s_add_u32 m0, s66, 3072
  v_mad_u32_u24 v227, v227, s64, v240
  buffer_load_dwordx4 v227, s[4:7], 0 offen  lds
  v_rcp_f16_sdwa v7, v3 dst_sel:WORD_1 dst_unused:UNUSED_PRESERVE src0_sel:WORD_1
  v_rcp_f16_sdwa v8, v4 dst_sel:WORD_1 dst_unused:UNUSED_PRESERVE src0_sel:WORD_1
  v_mul_f32 v234, v13, v13
  v_fmac_f32 v234, v14, v14
  v_fmac_f32 v234, v15, v15
  v_cvt_pk_f16_f32 v183, v234, v234
  v_rcp_f16_sdwa v9, v5 dst_sel:WORD_1 dst_unused:UNUSED_PRESERVE src0_sel:WORD_1
  v_pk_mul_f16 v168, v168, v6
  v_pk_mul_f16 v169, v169, v7
  v_pk_mul_f16 v170, v170, v8
  v_pk_mul_f16 v171, v171, v9
  ds_write_b128 v246, v[168:171] offset:64
  v_mfma_f32_16x16x32_f16 v[124:127], v[72:75], v[160:163], 0
  v_exp_f16_sdwa v2, v172 dst_sel:WORD_0 dst_unused:UNUSED_PAD src0_sel:WORD_0
  v_mul_u32_u24 v1, 6, v232
  v_and_b32 v1, -4, v1
  s_mov_b64 exec, s[74:75]
  buffer_load_dwordx2 v[228:229], v1, s[12:15], 0 offen
  s_mov_b64 exec, -1
  v_exp_f16_sdwa v3, v173 dst_sel:WORD_0 dst_unused:UNUSED_PAD src0_sel:WORD_0
  v_mfma_f32_16x16x32_f16 v[124:127], v[76:79], v[164:167], v[124:127]
  v_exp_f16_sdwa v4, v174 dst_sel:WORD_0 dst_unused:UNUSED_PAD src0_sel:WORD_0
  v_exp_f16_sdwa v5, v175 dst_sel:WORD_0 dst_unused:UNUSED_PAD src0_sel:WORD_0
  s_waitcnt lgkmcnt(12)
  v_mfma_f32_32x32x16_f16 v[128:143], v[56:59], v[176:179], v[128:143]
  v_exp_f16_sdwa v2, v172 dst_sel:WORD_1 dst_unused:UNUSED_PRESERVE src0_sel:WORD_1
  v_exp_f16_sdwa v3, v173 dst_sel:WORD_1 dst_unused:UNUSED_PRESERVE src0_sel:WORD_1
  v_exp_f16_sdwa v4, v174 dst_sel:WORD_1 dst_unused:UNUSED_PRESERVE src0_sel:WORD_1
  s_waitcnt lgkmcnt(10)
  v_mfma_f32_32x32x16_f16 v[128:143], v[60:63], v[180:183], v[128:143]
  v_exp_f16_sdwa v5, v175 dst_sel:WORD_1 dst_unused:UNUSED_PRESERVE src0_sel:WORD_1
  v_pk_add_f16 v2, v2, 1.0 op_sel_hi:[1,0]
  v_pk_add_f16 v3, v3, 1.0 op_sel_hi:[1,0]
  v_pk_add_f16 v4, v4, 1.0 op_sel_hi:[1,0]
  v_pk_add_f16 v5, v5, 1.0 op_sel_hi:[1,0]
  v_rcp_f16_sdwa v6, v2 dst_sel:WORD_0 dst_unused:UNUSED_PAD src0_sel:WORD_0
  v_rcp_f16_sdwa v7, v3 dst_sel:WORD_0 dst_unused:UNUSED_PAD src0_sel:WORD_0
  s_waitcnt lgkmcnt(1)
  v_mfma_f32_32x32x16_f16 v[88:103], v[192:195], v[184:187], v[88:103]
  v_rcp_f16_sdwa v8, v4 dst_sel:WORD_0 dst_unused:UNUSED_PAD src0_sel:WORD_0
  v_rcp_f16_sdwa v9, v5 dst_sel:WORD_0 dst_unused:UNUSED_PAD src0_sel:WORD_0
  v_rcp_f16_sdwa v6, v2 dst_sel:WORD_1 dst_unused:UNUSED_PRESERVE src0_sel:WORD_1
  v_mfma_f32_32x32x16_f16 v[88:103], v[196:199], v[188:191], v[88:103]
  v_rcp_f16_sdwa v7, v3 dst_sel:WORD_1 dst_unused:UNUSED_PRESERVE src0_sel:WORD_1
  v_rcp_f16_sdwa v8, v4 dst_sel:WORD_1 dst_unused:UNUSED_PRESERVE src0_sel:WORD_1
  v_rcp_f16_sdwa v9, v5 dst_sel:WORD_1 dst_unused:UNUSED_PRESERVE src0_sel:WORD_1
  v_pk_mul_f16 v172, v172, v6
  v_pk_mul_f16 v173, v173, v7
  v_pk_mul_f16 v174, v174, v8
  v_pk_mul_f16 v175, v175, v9
  ds_write_b128 v246, v[172:175] offset:80
  s_sub_u32 s59, s59, 1
  s_cmp_eq_u32 s59, 0
  s_cbranch_scc1 TAIL0
  ds_read_b64_tr_b16 v[192:193], v248 offset:64
  ds_read_b64_tr_b16 v[194:195], v248 offset:208
  ds_read_b64_tr_b16 v[196:197], v248 offset:352
  ds_read_b64_tr_b16 v[198:199], v248 offset:496
  v_cvt_pk_f16_f32 v160, v128, v129
  v_cvt_pk_f16_f32 v161, v130, v131
  v_cvt_pk_f16_f32 v162, v132, v133
  v_cvt_pk_f16_f32 v163, v134, v135
  v_cvt_pk_f16_f32 v164, v136, v137
  v_cvt_pk_f16_f32 v165, v138, v139
  v_cvt_pk_f16_f32 v166, v140, v141
  v_cvt_pk_f16_f32 v167, v142, v143
  v_mfma_f32_16x16x32_f16 v[124:127], v[80:83], v[168:171], v[124:127]
  v_exp_f16_sdwa v2, v160 dst_sel:WORD_0 dst_unused:UNUSED_PAD src0_sel:WORD_0
  s_mov_b64 exec, 1
  ds_add_rtn_u32 v255, v0, v238 offset:35336
  s_mov_b64 exec, -1
  v_exp_f16_sdwa v3, v161 dst_sel:WORD_0 dst_unused:UNUSED_PAD src0_sel:WORD_0
  v_mfma_f32_16x16x32_f16 v[124:127], v[84:87], v[172:175], v[124:127]
  v_exp_f16_sdwa v4, v162 dst_sel:WORD_0 dst_unused:UNUSED_PAD src0_sel:WORD_0
  v_exp_f16_sdwa v5, v163 dst_sel:WORD_0 dst_unused:UNUSED_PAD src0_sel:WORD_0
  v_mfma_f32_32x32x16_bf16 v[144:159], v[32:35], v[200:203], v[144:159]
  v_exp_f16_sdwa v2, v160 dst_sel:WORD_1 dst_unused:UNUSED_PRESERVE src0_sel:WORD_1
  v_exp_f16_sdwa v3, v161 dst_sel:WORD_1 dst_unused:UNUSED_PRESERVE src0_sel:WORD_1
  v_exp_f16_sdwa v4, v162 dst_sel:WORD_1 dst_unused:UNUSED_PRESERVE src0_sel:WORD_1
  s_waitcnt lgkmcnt(3)
  v_mfma_f32_32x32x16_f16 v[104:119], v[192:195], v[184:187], v[104:119]
  v_exp_f16_sdwa v5, v163 dst_sel:WORD_1 dst_unused:UNUSED_PRESERVE src0_sel:WORD_1
  v_pk_add_f16 v2, v2, 1.0 op_sel_hi:[1,0]
  v_pk_add_f16 v3, v3, 1.0 op_sel_hi:[1,0]
  v_pk_add_f16 v4, v4, 1.0 op_sel_hi:[1,0]
  v_pk_add_f16 v5, v5, 1.0 op_sel_hi:[1,0]
  v_mul_f32 v234, v10, v124
  v_mul_f32 v235, v11, v124
  v_mul_f32 v236, v12, v124
  v_cvt_pk_f16_f32 v234, v234, v235
  v_cvt_pk_f16_f32 v235, v236, v236
  s_mov_b64 exec, s[74:75]
  ds_write_b64 v246, v[234:235] offset:128
  s_mov_b64 exec, -1
  v_rcp_f16_sdwa v6, v2 dst_sel:WORD_0 dst_unused:UNUSED_PAD src0_sel:WORD_0
  v_rcp_f16_sdwa v7, v3 dst_sel:WORD_0 dst_unused:UNUSED_PAD src0_sel:WORD_0
  s_waitcnt lgkmcnt(2)
  v_mfma_f32_32x32x16_f16 v[104:119], v[196:199], v[188:191], v[104:119]
  ds_read_b64_tr_b16 v[192:193], v249 offset:0
  ds_read_b64_tr_b16 v[194:195], v249 offset:144
  ds_read_b64_tr_b16 v[196:197], v249 offset:288
  ds_read_b64_tr_b16 v[198:199], v249 offset:432
  v_rcp_f16_sdwa v8, v4 dst_sel:WORD_0 dst_unused:UNUSED_PAD src0_sel:WORD_0
  s_waitcnt lgkmcnt(5)
  v_readfirstlane_b32 s68, v255
  s_setprio 1
  s_cmp_lt_i32 s68, s79
  s_cbranch_scc0 PRI1
  s_setprio 0
PRI1:
  s_add_u32 s79, s79, 128
  v_rcp_f16_sdwa v9, v5 dst_sel:WORD_0 dst_unused:UNUSED_PAD src0_sel:WORD_0
  v_rcp_f16_sdwa v6, v2 dst_sel:WORD_1 dst_unused:UNUSED_PRESERVE src0_sel:WORD_1
  v_mfma_f32_32x32x16_bf16 v[144:159], v[36:39], v[204:207], v[144:159]
  v_rcp_f16_sdwa v7, v3 dst_sel:WORD_1 dst_unused:UNUSED_PRESERVE src0_sel:WORD_1
  v_rcp_f16_sdwa v8, v4 dst_sel:WORD_1 dst_unused:UNUSED_PRESERVE src0_sel:WORD_1
  v_rcp_f16_sdwa v9, v5 dst_sel:WORD_1 dst_unused:UNUSED_PRESERVE src0_sel:WORD_1
  v_pk_mul_f16 v160, v160, v6
  v_pk_mul_f16 v161, v161, v7
  v_pk_mul_f16 v162, v162, v8
  v_pk_mul_f16 v163, v163, v9
  ds_write_b128 v246, v[160:163] offset:0
  v_mfma_f32_32x32x16_bf16 v[144:159], v[40:43], v[208:211], v[144:159]
  v_exp_f16_sdwa v2, v164 dst_sel:WORD_0 dst_unused:UNUSED_PAD src0_sel:WORD_0
  v_exp_f16_sdwa v3, v165 dst_sel:WORD_0 dst_unused:UNUSED_PAD src0_sel:WORD_0
  v_exp_f16_sdwa v4, v166 dst_sel:WORD_0 dst_unused:UNUSED_PAD src0_sel:WORD_0
  v_mfma_f32_32x32x16_bf16 v[144:159], v[44:47], v[212:215], v[144:159]
  v_exp_f16_sdwa v5, v167 dst_sel:WORD_0 dst_unused:UNUSED_PAD src0_sel:WORD_0
  v_exp_f16_sdwa v2, v164 dst_sel:WORD_1 dst_unused:UNUSED_PRESERVE src0_sel:WORD_1
  v_exp_f16_sdwa v3, v165 dst_sel:WORD_1 dst_unused:UNUSED_PRESERVE src0_sel:WORD_1
  v_mfma_f32_32x32x16_f16 v[144:159], v[64:67], v[176:179], v[144:159]
  v_exp_f16_sdwa v4, v166 dst_sel:WORD_1 dst_unused:UNUSED_PRESERVE src0_sel:WORD_1
  v_exp_f16_sdwa v5, v167 dst_sel:WORD_1 dst_unused:UNUSED_PRESERVE src0_sel:WORD_1
  v_pk_add_f16 v2, v2, 1.0 op_sel_hi:[1,0]
  v_pk_add_f16 v3, v3, 1.0 op_sel_hi:[1,0]
  v_pk_add_f16 v4, v4, 1.0 op_sel_hi:[1,0]
  v_pk_add_f16 v5, v5, 1.0 op_sel_hi:[1,0]
  v_rcp_f16_sdwa v6, v2 dst_sel:WORD_0 dst_unused:UNUSED_PAD src0_sel:WORD_0
  v_mfma_f32_32x32x16_f16 v[144:159], v[68:71], v[180:183], v[144:159]
  v_rcp_f16_sdwa v7, v3 dst_sel:WORD_0 dst_unused:UNUSED_PAD src0_sel:WORD_0
  s_waitcnt vmcnt(0)
  ds_read_b128 v[200:203], v241
  ds_read_b128 v[204:207], v242
  v_rcp_f16_sdwa v8, v4 dst_sel:WORD_0 dst_unused:UNUSED_PAD src0_sel:WORD_0
  ds_read_b128 v[224:227], v250 offset:384
  ds_read_b32 v233, v251 offset:384
  ds_read_b32 v1, v251 offset:17792
  v_rcp_f16_sdwa v9, v5 dst_sel:WORD_0 dst_unused:UNUSED_PAD src0_sel:WORD_0
  s_waitcnt lgkmcnt(8)
  v_mfma_f32_16x16x32_f16 v[120:123], v[192:195], v[184:187], v[120:123]
  ds_read_b128 v[208:211], v243
  ds_read_b128 v[212:215], v244
  v_rcp_f16_sdwa v6, v2 dst_sel:WORD_1 dst_unused:UNUSED_PRESERVE src0_sel:WORD_1
  v_add_u32_sdwa v253, v245, v232 dst_sel:DWORD dst_unused:UNUSED_PAD src0_sel:DWORD src1_sel:BYTE_3
  ds_read_b64 v[234:235], v253 offset:480
  ds_read_b32 v236, v253 offset:736
  v_lshlrev_b32 v125, 4, v232
  v_alignbit_b32 v126, v229, v228, v125
  v_lshrrev_b32 v127, v125, v229
  v_rcp_f16_sdwa v7, v3 dst_sel:WORD_1 dst_unused:UNUSED_PRESERVE src0_sel:WORD_1
  s_waitcnt lgkmcnt(10)
  v_mfma_f32_16x16x32_f16 v[120:123], v[196:199], v[188:191], v[120:123]
  ds_read_b128 v[184:187], v252 offset:128
  ds_read_b64 v[176:177], v253 offset:192
  ds_read_b64 v[178:179], v253 offset:128
  ds_read_b64 v[180:181], v253 offset:64
  ds_read_b32 v182, v253
  v_rcp_f16_sdwa v8, v4 dst_sel:WORD_1 dst_unused:UNUSED_PRESERVE src0_sel:WORD_1
  v_rcp_f16_sdwa v9, v5 dst_sel:WORD_1 dst_unused:UNUSED_PRESERVE src0_sel:WORD_1
  v_pk_mul_f16 v164, v164, v6
  v_pk_mul_f16 v165, v165, v7
  v_pk_mul_f16 v166, v166, v8
  v_pk_mul_f16 v167, v167, v9
  ds_write_b128 v246, v[164:167] offset:16
  ds_read_b64_tr_b16 v[192:193], v248 offset:0
  ds_read_b64_tr_b16 v[194:195], v248 offset:144
  ds_read_b64_tr_b16 v[196:197], v248 offset:288
  ds_read_b64_tr_b16 v[198:199], v248 offset:432
  v_cvt_pk_f16_f32 v168, v144, v145
  v_cvt_pk_f16_f32 v169, v146, v147
  v_cvt_pk_f16_f32 v170, v148, v149
  v_cvt_pk_f16_f32 v171, v150, v151
  v_cvt_pk_f16_f32 v172, v152, v153
  v_cvt_pk_f16_f32 v173, v154, v155
  v_cvt_pk_f16_f32 v174, v156, v157
  v_cvt_pk_f16_f32 v175, v158, v159
  v_mfma_f32_32x32x16_bf16 v[128:143], v[48:51], v[216:219], 0
  v_exp_f16_sdwa v2, v168 dst_sel:WORD_0 dst_unused:UNUSED_PAD src0_sel:WORD_0
  v_exp_f16_sdwa v3, v169 dst_sel:WORD_0 dst_unused:UNUSED_PAD src0_sel:WORD_0
  v_exp_f16_sdwa v4, v170 dst_sel:WORD_0 dst_unused:UNUSED_PAD src0_sel:WORD_0
  v_mfma_f32_32x32x16_bf16 v[144:159], v[52:55], v[216:219], 0
  v_lshlrev_b32 v125, 16, v126
  v_and_b32 v126, s65, v126
  v_lshlrev_b32 v127, 16, v127
  s_cmp_gt_i32 s59, 1
  s_cselect_b32 s6, 6400000, 0
  s_cselect_b32 s10, 25600000, 0
  s_cselect_b32 s14, 300000, 0
  s_waitcnt lgkmcnt(14)
  v_mad_u32_u24 v1, v1, 32, v254
  buffer_load_dwordx4 v[220:223], v1, s[8:11], 0 offen
  v_exp_f16_sdwa v5, v171 dst_sel:WORD_0 dst_unused:UNUSED_PAD src0_sel:WORD_0
  v_exp_f16_sdwa v2, v168 dst_sel:WORD_1 dst_unused:UNUSED_PRESERVE src0_sel:WORD_1
  v_mfma_f32_32x32x16_bf16 v[128:143], v[16:19], v[200:203], v[128:143]
  s_add_u32 m0, s66, 0
  v_mad_u32_u24 v224, v224, s64, v237
  s_waitcnt lgkmcnt(12)
  buffer_load_dwordx4 v224, s[4:7], 0 offen  lds
  v_exp_f16_sdwa v3, v169 dst_sel:WORD_1 dst_unused:UNUSED_PRESERVE src0_sel:WORD_1
  v_exp_f16_sdwa v4, v170 dst_sel:WORD_1 dst_unused:UNUSED_PRESERVE src0_sel:WORD_1
  s_waitcnt lgkmcnt(9)
  v_add_u32_sdwa v184, v247, v184 dst_sel:DWORD dst_unused:UNUSED_PAD src0_sel:DWORD src1_sel:BYTE_3
  v_add_u32_sdwa v185, v247, v185 dst_sel:DWORD dst_unused:UNUSED_PAD src0_sel:DWORD src1_sel:BYTE_3
  v_add_u32_sdwa v186, v247, v186 dst_sel:DWORD dst_unused:UNUSED_PAD src0_sel:DWORD src1_sel:BYTE_3
  v_add_u32_sdwa v187, v247, v187 dst_sel:DWORD dst_unused:UNUSED_PAD src0_sel:DWORD src1_sel:BYTE_3
  ds_read_b64_tr_b16 v[190:191], v187
  ds_read_b64_tr_b16 v[188:189], v186
  ds_read_b64_tr_b16 v[186:187], v185
  ds_read_b64_tr_b16 v[184:185], v184
  v_exp_f16_sdwa v5, v171 dst_sel:WORD_1 dst_unused:UNUSED_PRESERVE src0_sel:WORD_1
  v_pk_add_f16 v2, v2, 1.0 op_sel_hi:[1,0]
  v_pk_add_f16 v3, v3, 1.0 op_sel_hi:[1,0]
  v_pk_add_f16 v4, v4, 1.0 op_sel_hi:[1,0]
  v_pk_add_f16 v5, v5, 1.0 op_sel_hi:[1,0]
  v_mfma_f32_32x32x16_bf16 v[128:143], v[20:23], v[204:207], v[128:143]
  v_sub_f32 v234, v234, v125
  v_sub_f32 v235, v235, v126
  v_sub_f32 v236, v236, v127
  v_cvt_pk_bf16_f32 v234, v234, v235
  v_cvt_pk_bf16_f32 v236, v236, v236
  v_lshlrev_b32 v10, 16, v234
  v_and_b32 v11, s65, v234
  v_lshlrev_b32 v12, 16, v236
  s_add_u32 m0, s66, 1024
  v_mad_u32_u24 v225, v225, s64, v238
  buffer_load_dwordx4 v225, s[4:7], 0 offen  lds
  v_rcp_f16_sdwa v6, v2 dst_sel:WORD_0 dst_unused:UNUSED_PAD src0_sel:WORD_0
  v_rcp_f16_sdwa v7, v3 dst_sel:WORD_0 dst_unused:UNUSED_PAD src0_sel:WORD_0
  v_rcp_f16_sdwa v8, v4 dst_sel:WORD_0 dst_unused:UNUSED_PAD src0_sel:WORD_0
  v_mfma_f32_32x32x16_bf16 v[128:143], v[24:27], v[208:211], v[128:143]
  s_add_u32 m0, s66, 2048
  v_mad_u32_u24 v226, v226, s64, v239
  buffer_load_dwordx4 v226, s[4:7], 0 offen  lds
  v_rcp_f16_sdwa v9, v5 dst_sel:WORD_0 dst_unused:UNUSED_PAD src0_sel:WORD_0
  v_rcp_f16_sdwa v6, v2 dst_sel:WORD_1 dst_unused:UNUSED_PRESERVE src0_sel:WORD_1
  v_mfma_f32_32x32x16_bf16 v[128:143], v[28:31], v[212:215], v[128:143]
  s_add_u32 m0, s66, 3072
  v_mad_u32_u24 v227, v227, s64, v240
  buffer_load_dwordx4 v227, s[4:7], 0 offen  lds
  v_rcp_f16_sdwa v7, v3 dst_sel:WORD_1 dst_unused:UNUSED_PRESERVE src0_sel:WORD_1
  v_rcp_f16_sdwa v8, v4 dst_sel:WORD_1 dst_unused:UNUSED_PRESERVE src0_sel:WORD_1
  v_mul_f32 v234, v10, v10
  v_fmac_f32 v234, v11, v11
  v_fmac_f32 v234, v12, v12
  v_cvt_pk_f16_f32 v183, v234, v234
  v_rcp_f16_sdwa v9, v5 dst_sel:WORD_1 dst_unused:UNUSED_PRESERVE src0_sel:WORD_1
  v_pk_mul_f16 v168, v168, v6
  v_pk_mul_f16 v169, v169, v7
  v_pk_mul_f16 v170, v170, v8
  v_pk_mul_f16 v171, v171, v9
  ds_write_b128 v246, v[168:171] offset:64
  v_mfma_f32_16x16x32_f16 v[124:127], v[72:75], v[160:163], 0
  v_exp_f16_sdwa v2, v172 dst_sel:WORD_0 dst_unused:UNUSED_PAD src0_sel:WORD_0
  v_mul_u32_u24 v1, 6, v233
  v_and_b32 v1, -4, v1
  s_mov_b64 exec, s[74:75]
  buffer_load_dwordx2 v[230:231], v1, s[12:15], 0 offen
  s_mov_b64 exec, -1
  v_exp_f16_sdwa v3, v173 dst_sel:WORD_0 dst_unused:UNUSED_PAD src0_sel:WORD_0
  v_mfma_f32_16x16x32_f16 v[124:127], v[76:79], v[164:167], v[124:127]
  v_exp_f16_sdwa v4, v174 dst_sel:WORD_0 dst_unused:UNUSED_PAD src0_sel:WORD_0
  v_exp_f16_sdwa v5, v175 dst_sel:WORD_0 dst_unused:UNUSED_PAD src0_sel:WORD_0
  s_waitcnt lgkmcnt(12)
  v_mfma_f32_32x32x16_f16 v[128:143], v[56:59], v[176:179], v[128:143]
  v_exp_f16_sdwa v2, v172 dst_sel:WORD_1 dst_unused:UNUSED_PRESERVE src0_sel:WORD_1
  v_exp_f16_sdwa v3, v173 dst_sel:WORD_1 dst_unused:UNUSED_PRESERVE src0_sel:WORD_1
  v_exp_f16_sdwa v4, v174 dst_sel:WORD_1 dst_unused:UNUSED_PRESERVE src0_sel:WORD_1
  s_waitcnt lgkmcnt(10)
  v_mfma_f32_32x32x16_f16 v[128:143], v[60:63], v[180:183], v[128:143]
  v_exp_f16_sdwa v5, v175 dst_sel:WORD_1 dst_unused:UNUSED_PRESERVE src0_sel:WORD_1
  v_pk_add_f16 v2, v2, 1.0 op_sel_hi:[1,0]
  v_pk_add_f16 v3, v3, 1.0 op_sel_hi:[1,0]
  v_pk_add_f16 v4, v4, 1.0 op_sel_hi:[1,0]
  v_pk_add_f16 v5, v5, 1.0 op_sel_hi:[1,0]
  v_rcp_f16_sdwa v6, v2 dst_sel:WORD_0 dst_unused:UNUSED_PAD src0_sel:WORD_0
  v_rcp_f16_sdwa v7, v3 dst_sel:WORD_0 dst_unused:UNUSED_PAD src0_sel:WORD_0
  s_waitcnt lgkmcnt(1)
  v_mfma_f32_32x32x16_f16 v[88:103], v[192:195], v[184:187], v[88:103]
  v_rcp_f16_sdwa v8, v4 dst_sel:WORD_0 dst_unused:UNUSED_PAD src0_sel:WORD_0
  v_rcp_f16_sdwa v9, v5 dst_sel:WORD_0 dst_unused:UNUSED_PAD src0_sel:WORD_0
  v_rcp_f16_sdwa v6, v2 dst_sel:WORD_1 dst_unused:UNUSED_PRESERVE src0_sel:WORD_1
  v_mfma_f32_32x32x16_f16 v[88:103], v[196:199], v[188:191], v[88:103]
  v_rcp_f16_sdwa v7, v3 dst_sel:WORD_1 dst_unused:UNUSED_PRESERVE src0_sel:WORD_1
  v_rcp_f16_sdwa v8, v4 dst_sel:WORD_1 dst_unused:UNUSED_PRESERVE src0_sel:WORD_1
  v_rcp_f16_sdwa v9, v5 dst_sel:WORD_1 dst_unused:UNUSED_PRESERVE src0_sel:WORD_1
  v_pk_mul_f16 v172, v172, v6
  v_pk_mul_f16 v173, v173, v7
  v_pk_mul_f16 v174, v174, v8
  v_pk_mul_f16 v175, v175, v9
  ds_write_b128 v246, v[172:175] offset:80
  s_sub_u32 s59, s59, 1
  s_cmp_eq_u32 s59, 0
  v_add_u32 v250, 0x100, v250
  v_add_u32 v251, 0x100, v251
  v_add_u32 v252, 0x100, v252
  s_cbranch_scc0 LOOP
  v_mov_b32 v10, v13
  v_mov_b32 v11, v14
  v_mov_b32 v12, v15
TAIL0:
  s_waitcnt lgkmcnt(0)
  ds_read_b64_tr_b16 v[192:193], v248 offset:64
  ds_read_b64_tr_b16 v[194:195], v248 offset:208
  ds_read_b64_tr_b16 v[196:197], v248 offset:352
  ds_read_b64_tr_b16 v[198:199], v248 offset:496
  v_mfma_f32_16x16x32_f16 v[124:127], v[80:83], v[168:171], v[124:127]
  v_mfma_f32_16x16x32_f16 v[124:127], v[84:87], v[172:175], v[124:127]
  s_waitcnt lgkmcnt(2)
  v_mfma_f32_32x32x16_f16 v[104:119], v[192:195], v[184:187], v[104:119]
  s_waitcnt lgkmcnt(0)
  v_mfma_f32_32x32x16_f16 v[104:119], v[196:199], v[188:191], v[104:119]
  s_nop 3
  v_mul_f32 v234, v10, v124
  v_mul_f32 v235, v11, v124
  v_mul_f32 v236, v12, v124
  v_cvt_pk_f16_f32 v234, v234, v235
  v_cvt_pk_f16_f32 v235, v236, v236
  s_mov_b64 exec, s[74:75]
  ds_write_b64 v246, v[234:235] offset:128
  s_mov_b64 exec, -1
  ds_read_b64_tr_b16 v[192:193], v249 offset:0
  ds_read_b64_tr_b16 v[194:195], v249 offset:144
  ds_read_b64_tr_b16 v[196:197], v249 offset:288
  ds_read_b64_tr_b16 v[198:199], v249 offset:432
  s_waitcnt lgkmcnt(2)
  v_mfma_f32_16x16x32_f16 v[120:123], v[192:195], v[184:187], v[120:123]
  s_waitcnt lgkmcnt(0)
  v_mfma_f32_16x16x32_f16 v[120:123], v[196:199], v[188:191], v[120:123]
LOOPEND:
  s_cmp_eq_u32 s62, 0
  s_cbranch_scc1 EPI
  s_add_u32 s61, s61, s60
  s_min_u32 s60, s60, 32
  s_waitcnt vmcnt(0)
  s_barrier
  s_branch ROUND
EPI:
  v_and_b32 v2, 1, v0
  v_bfe_u32 v3, v0, 1, 1
  v_bfe_u32 v4, v0, 2, 2
  v_bfe_u32 v5, v0, 4, 1
  v_lshlrev_b32 v2, 6, v2
  v_lshl_add_u32 v2, v3, 3, v2
  v_lshl_add_u32 v2, v5, 4, v2
  v_lshrrev_b32 v3, 1, v4
  v_lshl_add_u32 v2, v3, 5, v2
  v_lshl_add_u32 v2, v4, 7, v2
  v_add_u32 v2, 114176, v2
  v_lshl_add_u32 v6, v254, 8, v2
  v_xor_b32 v7, 32, v6
  v_lshl_add_u32 v8, v254, 6, v2
  v_xor_b32 v9, 32, v8
  ds_read_b64_tr_b16 v[16:17], v6 offset:0
  ds_read_b64_tr_b16 v[18:19], v6 offset:512
  ds_read_b64_tr_b16 v[20:21], v6 offset:1024
  ds_read_b64_tr_b16 v[22:23], v6 offset:1536
  ds_read_b64_tr_b16 v[24:25], v6 offset:2048
  ds_read_b64_tr_b16 v[26:27], v6 offset:2560
  ds_read_b64_tr_b16 v[28:29], v6 offset:3072
  ds_read_b64_tr_b16 v[30:31], v6 offset:3584
  ds_read_b64_tr_b16 v[32:33], v8 offset:8192
  ds_read_b64_tr_b16 v[34:35], v8 offset:10240
  ds_read_b64_tr_b16 v[36:37], v8 offset:8704
  ds_read_b64_tr_b16 v[38:39], v8 offset:10752
  ds_read_b64_tr_b16 v[40:41], v8 offset:12288
  ds_read_b64_tr_b16 v[42:43], v8 offset:14336
  ds_read_b64_tr_b16 v[44:45], v8 offset:12800
  ds_read_b64_tr_b16 v[46:47], v8 offset:14848
  s_waitcnt lgkmcnt(0)
  ds_read_b64_tr_b16 v[48:49], v7 offset:0
  ds_read_b64_tr_b16 v[50:51], v7 offset:512
  ds_read_b64_tr_b16 v[52:53], v7 offset:1024
  ds_read_b64_tr_b16 v[54:55], v7 offset:1536
  ds_read_b64_tr_b16 v[56:57], v7 offset:2048
  ds_read_b64_tr_b16 v[58:59], v7 offset:2560
  ds_read_b64_tr_b16 v[60:61], v7 offset:3072
  ds_read_b64_tr_b16 v[62:63], v7 offset:3584
  ds_read_b64_tr_b16 v[64:65], v9 offset:8192
  ds_read_b64_tr_b16 v[66:67], v9 offset:10240
  ds_read_b64_tr_b16 v[68:69], v9 offset:8704
  ds_read_b64_tr_b16 v[70:71], v9 offset:10752
  ds_read_b64_tr_b16 v[72:73], v9 offset:12288
  ds_read_b64_tr_b16 v[74:75], v9 offset:14336
  ds_read_b64_tr_b16 v[76:77], v9 offset:12800
  ds_read_b64_tr_b16 v[78:79], v9 offset:14848
  v_lshl_add_u32 v253, v0, 3, s67
  ds_read_b64 v[224:225], v253 offset:512
  ds_read_b32 v226, v253 offset:768
  s_mov_b32 s68, 0xbf317218
  s_mov_b32 s69, 0xbf317218
  v_pk_mul_f32 v[88:89], v[88:89], s[68:69]
  v_pk_mul_f32 v[90:91], v[90:91], s[68:69]
  v_pk_mul_f32 v[92:93], v[92:93], s[68:69]
  v_pk_mul_f32 v[94:95], v[94:95], s[68:69]
  v_pk_mul_f32 v[96:97], v[96:97], s[68:69]
  v_pk_mul_f32 v[98:99], v[98:99], s[68:69]
  v_pk_mul_f32 v[100:101], v[100:101], s[68:69]
  v_pk_mul_f32 v[102:103], v[102:103], s[68:69]
  v_pk_mul_f32 v[104:105], v[104:105], s[68:69]
  v_pk_mul_f32 v[106:107], v[106:107], s[68:69]
  v_pk_mul_f32 v[108:109], v[108:109], s[68:69]
  v_pk_mul_f32 v[110:111], v[110:111], s[68:69]
  v_pk_mul_f32 v[112:113], v[112:113], s[68:69]
  v_pk_mul_f32 v[114:115], v[114:115], s[68:69]
  v_pk_mul_f32 v[116:117], v[116:117], s[68:69]
  v_pk_mul_f32 v[118:119], v[118:119], s[68:69]
  v_pk_mul_f32 v[120:121], v[120:121], s[68:69]
  v_pk_mul_f32 v[122:123], v[122:123], s[68:69]
  v_cvt_pk_bf16_f32 v160, v88, v89
  v_cvt_pk_bf16_f32 v161, v90, v91
  v_cvt_pk_bf16_f32 v162, v92, v93
  v_cvt_pk_bf16_f32 v163, v94, v95
  v_cvt_pk_bf16_f32 v164, v96, v97
  v_cvt_pk_bf16_f32 v165, v98, v99
  v_cvt_pk_bf16_f32 v166, v100, v101
  v_cvt_pk_bf16_f32 v167, v102, v103
  v_cvt_pk_bf16_f32 v168, v104, v105
  v_cvt_pk_bf16_f32 v169, v106, v107
  v_cvt_pk_bf16_f32 v170, v108, v109
  v_cvt_pk_bf16_f32 v171, v110, v111
  v_cvt_pk_bf16_f32 v172, v112, v113
  v_cvt_pk_bf16_f32 v173, v114, v115
  v_cvt_pk_bf16_f32 v174, v116, v117
  v_cvt_pk_bf16_f32 v175, v118, v119
  v_mfma_f32_32x32x16_bf16 v[128:143], v[16:19], v[200:203], 0
  v_mfma_f32_32x32x16_bf16 v[128:143], v[20:23], v[204:207], v[128:143]
  v_mfma_f32_32x32x16_bf16 v[128:143], v[24:27], v[208:211], v[128:143]
  v_mfma_f32_32x32x16_bf16 v[128:143], v[28:31], v[212:215], v[128:143]
  v_mfma_f32_32x32x16_bf16 v[128:143], v[32:35], v[160:163], v[128:143]
  v_mfma_f32_32x32x16_bf16 v[128:143], v[36:39], v[164:167], v[128:143]
  v_mfma_f32_32x32x16_bf16 v[128:143], v[40:43], v[168:171], v[128:143]
  v_mfma_f32_32x32x16_bf16 v[128:143], v[44:47], v[172:175], v[128:143]
  s_waitcnt lgkmcnt(0)
  v_mfma_f32_32x32x16_bf16 v[144:159], v[48:51], v[200:203], 0
  v_mfma_f32_32x32x16_bf16 v[144:159], v[52:55], v[204:207], v[144:159]
  v_mfma_f32_32x32x16_bf16 v[144:159], v[56:59], v[208:211], v[144:159]
  v_mfma_f32_32x32x16_bf16 v[144:159], v[60:63], v[212:215], v[144:159]
  v_mfma_f32_32x32x16_bf16 v[144:159], v[64:67], v[160:163], v[144:159]
  v_mfma_f32_32x32x16_bf16 v[144:159], v[68:71], v[164:167], v[144:159]
  v_mfma_f32_32x32x16_bf16 v[144:159], v[72:75], v[168:171], v[144:159]
  v_mfma_f32_32x32x16_bf16 v[144:159], v[76:79], v[172:175], v[144:159]
  v_add_f32 v224, v224, v120
  v_add_f32 v225, v225, v121
  v_add_f32 v226, v226, v122
  v_cvt_pk_bf16_f32 v224, v224, v225
  v_cvt_pk_bf16_f32 v226, v226, v226
  v_add_u32 v234, s58, v0
  v_mul_u32_u24 v234, 6, v234
  v_add_u32 v234, 6400000, v234
  s_mov_b32 exec_lo, s78
  s_mov_b32 exec_hi, 0
  buffer_store_short v224, v234, s[28:31], 0 offen
  buffer_store_short_d16_hi v224, v234, s[28:31], 0 offen offset:2
  buffer_store_short v226, v234, s[28:31], 0 offen offset:4
  s_mov_b64 exec, -1
  v_and_b32 v235, 31, v0
  v_add_u32 v235, s58, v235
  v_lshlrev_b32 v235, 7, v235
  v_lshl_add_u32 v235, v254, 2, v235
  s_mov_b32 s68, s78
  s_mov_b32 s69, s78
  v_pk_mul_f32 v[2:3], v[128:129], s[70:71]
  v_pk_mul_f32 v[4:5], v[130:131], s[70:71]
  v_pk_mul_f32 v[6:7], v[132:133], s[70:71]
  v_pk_mul_f32 v[8:9], v[134:135], s[70:71]
  v_exp_f32 v2, v2
  v_exp_f32 v3, v3
  v_exp_f32 v4, v4
  v_exp_f32 v5, v5
  v_exp_f32 v6, v6
  v_exp_f32 v7, v7
  v_exp_f32 v8, v8
  v_exp_f32 v9, v9
  v_pk_add_f32 v[2:3], v[2:3], s[72:73]
  v_pk_add_f32 v[4:5], v[4:5], s[72:73]
  v_pk_add_f32 v[6:7], v[6:7], s[72:73]
  v_pk_add_f32 v[8:9], v[8:9], s[72:73]
  v_rcp_f32 v2, v2
  v_rcp_f32 v3, v3
  v_rcp_f32 v4, v4
  v_rcp_f32 v5, v5
  v_rcp_f32 v6, v6
  v_rcp_f32 v7, v7
  v_rcp_f32 v8, v8
  v_rcp_f32 v9, v9
  v_pk_mul_f32 v[2:3], v[2:3], v[128:129]
  v_pk_mul_f32 v[4:5], v[4:5], v[130:131]
  v_pk_mul_f32 v[6:7], v[6:7], v[132:133]
  v_pk_mul_f32 v[8:9], v[8:9], v[134:135]
  v_cvt_pk_bf16_f32 v176, v2, v3
  v_cvt_pk_bf16_f32 v177, v4, v5
  v_cvt_pk_bf16_f32 v178, v6, v7
  v_cvt_pk_bf16_f32 v179, v8, v9
  v_lshlrev_b32 v2, 16, v176
  v_and_b32 v3, s65, v176
  v_lshlrev_b32 v4, 16, v200
  v_and_b32 v5, s65, v200
  v_pk_add_f32 v[2:3], v[2:3], v[4:5]
  v_cvt_pk_bf16_f32 v160, v2, v3
  v_lshlrev_b32 v2, 16, v177
  v_and_b32 v3, s65, v177
  v_lshlrev_b32 v4, 16, v201
  v_and_b32 v5, s65, v201
  v_pk_add_f32 v[2:3], v[2:3], v[4:5]
  v_cvt_pk_bf16_f32 v161, v2, v3
  v_lshlrev_b32 v2, 16, v178
  v_and_b32 v3, s65, v178
  v_lshlrev_b32 v4, 16, v202
  v_and_b32 v5, s65, v202
  v_pk_add_f32 v[2:3], v[2:3], v[4:5]
  v_cvt_pk_bf16_f32 v162, v2, v3
  v_lshlrev_b32 v2, 16, v179
  v_and_b32 v3, s65, v179
  v_lshlrev_b32 v4, 16, v203
  v_and_b32 v5, s65, v203
  v_pk_add_f32 v[2:3], v[2:3], v[4:5]
  v_cvt_pk_bf16_f32 v163, v2, v3
  s_mov_b64 exec, s[68:69]
  buffer_store_dwordx4 v[160:163], v235, s[28:31], 0 offen offset:0
  s_mov_b64 exec, -1
  v_pk_mul_f32 v[2:3], v[136:137], s[70:71]
  v_pk_mul_f32 v[4:5], v[138:139], s[70:71]
  v_pk_mul_f32 v[6:7], v[140:141], s[70:71]
  v_pk_mul_f32 v[8:9], v[142:143], s[70:71]
  v_exp_f32 v2, v2
  v_exp_f32 v3, v3
  v_exp_f32 v4, v4
  v_exp_f32 v5, v5
  v_exp_f32 v6, v6
  v_exp_f32 v7, v7
  v_exp_f32 v8, v8
  v_exp_f32 v9, v9
  v_pk_add_f32 v[2:3], v[2:3], s[72:73]
  v_pk_add_f32 v[4:5], v[4:5], s[72:73]
  v_pk_add_f32 v[6:7], v[6:7], s[72:73]
  v_pk_add_f32 v[8:9], v[8:9], s[72:73]
  v_rcp_f32 v2, v2
  v_rcp_f32 v3, v3
  v_rcp_f32 v4, v4
  v_rcp_f32 v5, v5
  v_rcp_f32 v6, v6
  v_rcp_f32 v7, v7
  v_rcp_f32 v8, v8
  v_rcp_f32 v9, v9
  v_pk_mul_f32 v[2:3], v[2:3], v[136:137]
  v_pk_mul_f32 v[4:5], v[4:5], v[138:139]
  v_pk_mul_f32 v[6:7], v[6:7], v[140:141]
  v_pk_mul_f32 v[8:9], v[8:9], v[142:143]
  v_cvt_pk_bf16_f32 v176, v2, v3
  v_cvt_pk_bf16_f32 v177, v4, v5
  v_cvt_pk_bf16_f32 v178, v6, v7
  v_cvt_pk_bf16_f32 v179, v8, v9
  v_lshlrev_b32 v2, 16, v176
  v_and_b32 v3, s65, v176
  v_lshlrev_b32 v4, 16, v204
  v_and_b32 v5, s65, v204
  v_pk_add_f32 v[2:3], v[2:3], v[4:5]
  v_cvt_pk_bf16_f32 v164, v2, v3
  v_lshlrev_b32 v2, 16, v177
  v_and_b32 v3, s65, v177
  v_lshlrev_b32 v4, 16, v205
  v_and_b32 v5, s65, v205
  v_pk_add_f32 v[2:3], v[2:3], v[4:5]
  v_cvt_pk_bf16_f32 v165, v2, v3
  v_lshlrev_b32 v2, 16, v178
  v_and_b32 v3, s65, v178
  v_lshlrev_b32 v4, 16, v206
  v_and_b32 v5, s65, v206
  v_pk_add_f32 v[2:3], v[2:3], v[4:5]
  v_cvt_pk_bf16_f32 v166, v2, v3
  v_lshlrev_b32 v2, 16, v179
  v_and_b32 v3, s65, v179
  v_lshlrev_b32 v4, 16, v207
  v_and_b32 v5, s65, v207
  v_pk_add_f32 v[2:3], v[2:3], v[4:5]
  v_cvt_pk_bf16_f32 v167, v2, v3
  s_mov_b64 exec, s[68:69]
  buffer_store_dwordx4 v[164:167], v235, s[28:31], 0 offen offset:16
  s_mov_b64 exec, -1
  v_pk_mul_f32 v[2:3], v[144:145], s[70:71]
  v_pk_mul_f32 v[4:5], v[146:147], s[70:71]
  v_pk_mul_f32 v[6:7], v[148:149], s[70:71]
  v_pk_mul_f32 v[8:9], v[150:151], s[70:71]
  v_exp_f32 v2, v2
  v_exp_f32 v3, v3
  v_exp_f32 v4, v4
  v_exp_f32 v5, v5
  v_exp_f32 v6, v6
  v_exp_f32 v7, v7
  v_exp_f32 v8, v8
  v_exp_f32 v9, v9
  v_pk_add_f32 v[2:3], v[2:3], s[72:73]
  v_pk_add_f32 v[4:5], v[4:5], s[72:73]
  v_pk_add_f32 v[6:7], v[6:7], s[72:73]
  v_pk_add_f32 v[8:9], v[8:9], s[72:73]
  v_rcp_f32 v2, v2
  v_rcp_f32 v3, v3
  v_rcp_f32 v4, v4
  v_rcp_f32 v5, v5
  v_rcp_f32 v6, v6
  v_rcp_f32 v7, v7
  v_rcp_f32 v8, v8
  v_rcp_f32 v9, v9
  v_pk_mul_f32 v[2:3], v[2:3], v[144:145]
  v_pk_mul_f32 v[4:5], v[4:5], v[146:147]
  v_pk_mul_f32 v[6:7], v[6:7], v[148:149]
  v_pk_mul_f32 v[8:9], v[8:9], v[150:151]
  v_cvt_pk_bf16_f32 v176, v2, v3
  v_cvt_pk_bf16_f32 v177, v4, v5
  v_cvt_pk_bf16_f32 v178, v6, v7
  v_cvt_pk_bf16_f32 v179, v8, v9
  v_lshlrev_b32 v2, 16, v176
  v_and_b32 v3, s65, v176
  v_lshlrev_b32 v4, 16, v208
  v_and_b32 v5, s65, v208
  v_pk_add_f32 v[2:3], v[2:3], v[4:5]
  v_cvt_pk_bf16_f32 v168, v2, v3
  v_lshlrev_b32 v2, 16, v177
  v_and_b32 v3, s65, v177
  v_lshlrev_b32 v4, 16, v209
  v_and_b32 v5, s65, v209
  v_pk_add_f32 v[2:3], v[2:3], v[4:5]
  v_cvt_pk_bf16_f32 v169, v2, v3
  v_lshlrev_b32 v2, 16, v178
  v_and_b32 v3, s65, v178
  v_lshlrev_b32 v4, 16, v210
  v_and_b32 v5, s65, v210
  v_pk_add_f32 v[2:3], v[2:3], v[4:5]
  v_cvt_pk_bf16_f32 v170, v2, v3
  v_lshlrev_b32 v2, 16, v179
  v_and_b32 v3, s65, v179
  v_lshlrev_b32 v4, 16, v211
  v_and_b32 v5, s65, v211
  v_pk_add_f32 v[2:3], v[2:3], v[4:5]
  v_cvt_pk_bf16_f32 v171, v2, v3
  s_mov_b64 exec, s[68:69]
  buffer_store_dwordx4 v[168:171], v235, s[28:31], 0 offen offset:32
  s_mov_b64 exec, -1
  v_pk_mul_f32 v[2:3], v[152:153], s[70:71]
  v_pk_mul_f32 v[4:5], v[154:155], s[70:71]
  v_pk_mul_f32 v[6:7], v[156:157], s[70:71]
  v_pk_mul_f32 v[8:9], v[158:159], s[70:71]
  v_exp_f32 v2, v2
  v_exp_f32 v3, v3
  v_exp_f32 v4, v4
  v_exp_f32 v5, v5
  v_exp_f32 v6, v6
  v_exp_f32 v7, v7
  v_exp_f32 v8, v8
  v_exp_f32 v9, v9
  v_pk_add_f32 v[2:3], v[2:3], s[72:73]
  v_pk_add_f32 v[4:5], v[4:5], s[72:73]
  v_pk_add_f32 v[6:7], v[6:7], s[72:73]
  v_pk_add_f32 v[8:9], v[8:9], s[72:73]
  v_rcp_f32 v2, v2
  v_rcp_f32 v3, v3
  v_rcp_f32 v4, v4
  v_rcp_f32 v5, v5
  v_rcp_f32 v6, v6
  v_rcp_f32 v7, v7
  v_rcp_f32 v8, v8
  v_rcp_f32 v9, v9
  v_pk_mul_f32 v[2:3], v[2:3], v[152:153]
  v_pk_mul_f32 v[4:5], v[4:5], v[154:155]
  v_pk_mul_f32 v[6:7], v[6:7], v[156:157]
  v_pk_mul_f32 v[8:9], v[8:9], v[158:159]
  v_cvt_pk_bf16_f32 v176, v2, v3
  v_cvt_pk_bf16_f32 v177, v4, v5
  v_cvt_pk_bf16_f32 v178, v6, v7
  v_cvt_pk_bf16_f32 v179, v8, v9
  v_lshlrev_b32 v2, 16, v176
  v_and_b32 v3, s65, v176
  v_lshlrev_b32 v4, 16, v212
  v_and_b32 v5, s65, v212
  v_pk_add_f32 v[2:3], v[2:3], v[4:5]
  v_cvt_pk_bf16_f32 v172, v2, v3
  v_lshlrev_b32 v2, 16, v177
  v_and_b32 v3, s65, v177
  v_lshlrev_b32 v4, 16, v213
  v_and_b32 v5, s65, v213
  v_pk_add_f32 v[2:3], v[2:3], v[4:5]
  v_cvt_pk_bf16_f32 v173, v2, v3
  v_lshlrev_b32 v2, 16, v178
  v_and_b32 v3, s65, v178
  v_lshlrev_b32 v4, 16, v214
  v_and_b32 v5, s65, v214
  v_pk_add_f32 v[2:3], v[2:3], v[4:5]
  v_cvt_pk_bf16_f32 v174, v2, v3
  v_lshlrev_b32 v2, 16, v179
  v_and_b32 v3, s65, v179
  v_lshlrev_b32 v4, 16, v215
  v_and_b32 v5, s65, v215
  v_pk_add_f32 v[2:3], v[2:3], v[4:5]
  v_cvt_pk_bf16_f32 v175, v2, v3
  s_mov_b64 exec, s[68:69]
  buffer_store_dwordx4 v[172:175], v235, s[28:31], 0 offen offset:48
  s_mov_b64 exec, -1
  s_waitcnt vmcnt(0)
K2END:
  s_endpgm
.section .rodata,"a"
.p2align 6
.amdhsa_kernel part_kernel
  .amdhsa_next_free_vgpr 56
  .amdhsa_next_free_sgpr 96
  .amdhsa_accum_offset 56
  .amdhsa_group_segment_fixed_size 0
  .amdhsa_kernarg_size 88
  .amdhsa_user_sgpr_count 2
  .amdhsa_user_sgpr_kernarg_segment_ptr 1
  .amdhsa_system_sgpr_workgroup_id_x 1
.end_amdhsa_kernel
.p2align 6
.amdhsa_kernel main_kernel
  .amdhsa_next_free_vgpr 256
  .amdhsa_next_free_sgpr 96
  .amdhsa_accum_offset 256
  .amdhsa_group_segment_fixed_size 0
  .amdhsa_kernarg_size 88
  .amdhsa_user_sgpr_count 2
  .amdhsa_user_sgpr_kernarg_segment_ptr 1
  .amdhsa_system_sgpr_workgroup_id_x 1
.end_amdhsa_kernel
```

```asm
; @launch kernel=part_kernel grid=(251,1,1) block=(640,1,1) lds=60432
; @launch kernel=main_kernel grid=(256,1,1) block=(512,1,1) lds=155136
.amdgcn_target "amdgcn-amd-amdhsa--gfx950"
.text
.globl part_kernel
.p2align 8
.type part_kernel,@function
part_kernel:
  s_cmp_gt_u32 s2, 250
  s_cbranch_scc1 K1END
  s_load_dwordx2 s[8:9], s[0:1], 80
  s_cmp_eq_u32 s2, 250
  s_cbranch_scc1 WPREP
  s_load_dwordx4 s[4:7], s[0:1], 24
  s_load_dwordx2 s[32:33], s[0:1], 0
  s_mul_i32 s3, s2, 12800
  v_lshlrev_b32 v2, 4, v0
  v_lshlrev_b32 v3, 2, v0
  v_add_u32 v3, 10240, v3
  v_and_b32 v1, 255, v0
  v_lshlrev_b32 v1, 2, v1
  v_mov_b32 v20, 0
  v_mov_b32 v21, 0
  v_mov_b32 v22, 0
  v_mov_b32 v23, 0
  s_waitcnt lgkmcnt(0)
  s_mov_b32 s12, s4
  s_mov_b32 s13, s5
  s_mov_b32 s14, 3200000
  s_mov_b32 s15, 0x20000
  s_mov_b32 s16, s6
  s_mov_b32 s17, s7
  s_mov_b32 s18, 3200000
  s_mov_b32 s19, 0x20000
  buffer_load_dwordx4 v[4:7], v2, s[16:19], s3 offen
  buffer_load_dword v8, v3, s[16:19], s3 offen
  buffer_load_dwordx4 v[12:15], v2, s[12:15], s3 offen
  buffer_load_dword v16, v3, s[12:15], s3 offen
  ds_write_b32 v1, v20 offset:58368
  ds_write_b32 v20, v20 offset:60416
  ds_write_b128 v2, v[20:23] offset:0
  ds_write_b128 v2, v[20:23] offset:10240
  ds_write_b128 v2, v[20:23] offset:20480
  ds_write_b128 v2, v[20:23] offset:30720
  s_mov_b32 s20, s8
  s_mov_b32 s21, s9
  s_mov_b32 s22, 8388608
  s_mov_b32 s23, 0x20000
  s_add_u32 s24, s8, 8388488
  s_addc_u32 s25, s9, 0
  s_mov_b32 s26, 14592120
  s_mov_b32 s27, 0x20000
  s_mov_b32 s28, 175921861
  s_movk_i32 s29, 3125
  s_mul_i32 s30, s2, 3200
  s_or_b32 s30, s30, 0x80000000
  v_mov_b32 v50, 1
  v_mov_b32 v49, 127
  v_lshl_add_u32 v51, v0, 2, s30
  s_add_u32 s30, s30, 2560
  v_add_u32 v52, s30, v0
  v_readfirstlane_b32 s31, v0
  s_waitcnt lgkmcnt(0)
  s_barrier
  s_waitcnt vmcnt(2)
  v_mul_hi_u32 v37, s28, v4
  v_lshrrev_b32 v20, 1, v37
  v_and_b32 v20, 0x3fc, v20
  ds_add_rtn_u32 v28, v20, v50 offset:58368
  v_mul_hi_u32 v39, s28, v5
  v_lshrrev_b32 v21, 1, v39
  v_and_b32 v21, 0x3fc, v21
  ds_add_rtn_u32 v29, v21, v50 offset:58368
  v_mul_hi_u32 v41, s28, v6
  v_lshrrev_b32 v22, 1, v41
  v_and_b32 v22, 0x3fc, v22
  ds_add_rtn_u32 v30, v22, v50 offset:58368
  v_mul_hi_u32 v43, s28, v7
  v_lshrrev_b32 v23, 1, v43
  v_and_b32 v23, 0x3fc, v23
  ds_add_rtn_u32 v31, v23, v50 offset:58368
  v_mul_hi_u32 v45, s28, v8
  v_lshrrev_b32 v24, 1, v45
  v_and_b32 v24, 0x3fc, v24
  ds_add_rtn_u32 v32, v24, v50 offset:58368
  v_mad_u32_u24 v36, v37, s29, v49
  v_lshrrev_b32 v36, 7, v36
  v_sub_u32 v4, v4, v36
  v_and_b32 v37, 7, v37
  v_mad_u32_u24 v38, v39, s29, v49
  v_lshrrev_b32 v38, 7, v38
  v_sub_u32 v5, v5, v38
  v_and_b32 v39, 7, v39
  v_mad_u32_u24 v40, v41, s29, v49
  v_lshrrev_b32 v40, 7, v40
  v_sub_u32 v6, v6, v40
  v_and_b32 v41, 7, v41
  v_mad_u32_u24 v42, v43, s29, v49
  v_lshrrev_b32 v42, 7, v42
  v_sub_u32 v7, v7, v42
  v_and_b32 v43, 7, v43
  v_mad_u32_u24 v44, v45, s29, v49
  v_lshrrev_b32 v44, 7, v44
  v_sub_u32 v8, v8, v44
  v_and_b32 v45, 7, v45
  s_waitcnt vmcnt(0)
  v_lshl_or_b32 v36, v4, 27, v12
  v_lshrrev_b32 v12, 12, v12
  v_lshl_or_b32 v37, v37, 4, v12
  v_lshl_or_b32 v37, v37, 24, v51
  v_lshl_or_b32 v38, v5, 27, v13
  v_lshrrev_b32 v13, 12, v13
  v_lshl_or_b32 v39, v39, 4, v13
  v_add_u32 v51, 1, v51
  v_lshl_or_b32 v39, v39, 24, v51
  v_lshl_or_b32 v40, v6, 27, v14
  v_lshrrev_b32 v14, 12, v14
  v_lshl_or_b32 v41, v41, 4, v14
  v_add_u32 v51, 1, v51
  v_lshl_or_b32 v41, v41, 24, v51
  v_lshl_or_b32 v42, v7, 27, v15
  v_lshrrev_b32 v15, 12, v15
  v_lshl_or_b32 v43, v43, 4, v15
  v_add_u32 v51, 1, v51
  v_lshl_or_b32 v43, v43, 24, v51
  v_lshl_or_b32 v44, v8, 27, v16
  v_lshrrev_b32 v16, 12, v16
  v_lshl_or_b32 v45, v45, 4, v16
  v_lshl_or_b32 v45, v45, 24, v52
  v_lshrrev_b32 v3, 3, v0
  s_movk_i32 s3, 128
  v_mul_u32_u24 v3, s3, v3
  v_and_b32 v1, 7, v0
  v_lshl_add_u32 v3, v1, 4, v3
  s_mul_i32 s3, s2, 32896
  s_add_u32 s4, s3, 10240
  s_add_u32 s5, s3, 20480
  s_add_u32 s6, s3, 30720
  s_mul_i32 s7, s2, 58368
  s_mov_b32 s33, 0
  s_mov_b32 s34, 0xfff20000
  v_mov_b32 v1, 60416
  v_lshlrev_b32 v4, 5, v20
  v_lshlrev_b32 v5, 5, v21
  v_lshlrev_b32 v6, 5, v22
  v_lshlrev_b32 v7, 5, v23
  v_lshlrev_b32 v8, 5, v24
  s_waitcnt lgkmcnt(4)
  v_cmp_gt_u32 s[40:41], 15, v28
  v_lshl_add_u32 v12, v28, 3, v4
  s_waitcnt lgkmcnt(3)
  v_cmp_gt_u32 s[42:43], 15, v29
  v_lshl_add_u32 v13, v29, 3, v5
  s_waitcnt lgkmcnt(2)
  v_cmp_gt_u32 s[44:45], 15, v30
  v_lshl_add_u32 v14, v30, 3, v6
  s_waitcnt lgkmcnt(1)
  v_cmp_gt_u32 s[46:47], 15, v31
  v_lshl_add_u32 v15, v31, 3, v7
  s_waitcnt lgkmcnt(0)
  v_cmp_gt_u32 s[48:49], 15, v32
  v_lshl_add_u32 v16, v32, 3, v8
  v_max3_u32 v48, v28, v29, v30
  v_max3_u32 v48, v48, v31, v32
  v_cmp_le_u32 s[50:51], 31, v48
  s_mov_b64 exec, s[40:41]
  ds_write_b64 v12, v[36:37]
  s_mov_b64 exec, s[42:43]
  ds_write_b64 v13, v[38:39]
  s_mov_b64 exec, s[44:45]
  ds_write_b64 v14, v[40:41]
  s_mov_b64 exec, s[46:47]
  ds_write_b64 v15, v[42:43]
  s_mov_b64 exec, s[48:49]
  ds_write_b64 v16, v[44:45]
  s_not_b64 exec, s[40:41]
  s_cbranch_scc0 K1N0
  v_lshl_add_u32 v48, v20, 2, s34
  v_lshl_add_u32 v48, v28, 16, v48
  ds_max_u32 v4, v48 offset:120
  v_cmpx_gt_u32 vcc, 31, v28
  s_cbranch_execz K1N0
  buffer_store_dwordx2 v[36:37], v12, s[24:27], s7 offen
K1N0:
  s_not_b64 exec, s[42:43]
  s_cbranch_scc0 K1N1
  v_lshl_add_u32 v48, v21, 2, s34
  v_lshl_add_u32 v48, v29, 16, v48
  ds_max_u32 v5, v48 offset:120
  v_cmpx_gt_u32 vcc, 31, v29
  s_cbranch_execz K1N1
  buffer_store_dwordx2 v[38:39], v13, s[24:27], s7 offen
K1N1:
  s_not_b64 exec, s[44:45]
  s_cbranch_scc0 K1N2
  v_lshl_add_u32 v48, v22, 2, s34
  v_lshl_add_u32 v48, v30, 16, v48
  ds_max_u32 v6, v48 offset:120
  v_cmpx_gt_u32 vcc, 31, v30
  s_cbranch_execz K1N2
  buffer_store_dwordx2 v[40:41], v14, s[24:27], s7 offen
K1N2:
  s_not_b64 exec, s[46:47]
  s_cbranch_scc0 K1N3
  v_lshl_add_u32 v48, v23, 2, s34
  v_lshl_add_u32 v48, v31, 16, v48
  ds_max_u32 v7, v48 offset:120
  v_cmpx_gt_u32 vcc, 31, v31
  s_cbranch_execz K1N3
  buffer_store_dwordx2 v[42:43], v15, s[24:27], s7 offen
K1N3:
  s_not_b64 exec, s[48:49]
  s_cbranch_scc0 K1N4
  v_lshl_add_u32 v48, v24, 2, s34
  v_lshl_add_u32 v48, v32, 16, v48
  ds_max_u32 v8, v48 offset:120
  v_cmpx_gt_u32 vcc, 31, v32
  s_cbranch_execz K1N4
  buffer_store_dwordx2 v[44:45], v16, s[24:27], s7 offen
K1N4:
  s_mov_b64 exec, s[50:51]
  ds_write_b32 v1, v50
  s_mov_b64 exec, -1
  s_waitcnt lgkmcnt(0)
  s_barrier
  ds_read_b32 v48, v1
K1RD:
  ds_read_b128 v[4:7], v2
  ds_read_b128 v[8:11], v2 offset:10240
  ds_read_b128 v[12:15], v2 offset:20480
  ds_read_b128 v[16:19], v2 offset:30720
  s_waitcnt lgkmcnt(3)
  v_cmp_ne_u32 vcc, 0, v48
  s_cbranch_vccnz K1SLOW
  buffer_store_dwordx4 v[4:7], v3, s[20:23], s3 offen nt
  s_waitcnt lgkmcnt(2)
  buffer_store_dwordx4 v[8:11], v3, s[20:23], s4 offen nt
  s_waitcnt lgkmcnt(1)
  buffer_store_dwordx4 v[12:15], v3, s[20:23], s5 offen nt
  s_add_u32 s7, s7, 32888
  s_cmp_ge_u32 s31, 128
  s_cbranch_scc1 K1OV
  s_waitcnt lgkmcnt(0)
  buffer_store_dwordx4 v[16:19], v3, s[20:23], s6 offen nt
K1OV:
  v_cmpx_gt_u32 vcc, s33, v2
  s_cbranch_execz K1FIN
  ds_read_b128 v[20:23], v2 offset:32768
  s_waitcnt lgkmcnt(0)
  buffer_store_dwordx4 v[20:23], v2, s[24:27], s7 offen nt
  v_add_u32 v2, 10240, v2
  s_waitcnt vmcnt(0)
  s_branch K1OV
K1FIN:
K1END:
  s_endpgm
K1SLOW:
  v_and_b32 v1, 63, v0
  v_lshlrev_b32 v53, 9, v1
  v_lshlrev_b32 v1, 4, v1
  v_mov_b32 v48, 0xffff0000
  v_mov_b32 v49, 0xf0ff1
  s_waitcnt lgkmcnt(0)
  ds_read_b128 v[4:7], v1 offset:58368
  s_waitcnt lgkmcnt(0)
  v_cmp_lt_u32 s[40:41], 31, v4
  v_subrev_u32 v4, 15, v4
  v_cmp_lt_u32 s[42:43], 31, v5
  v_subrev_u32 v5, 15, v5
  v_cmp_lt_u32 s[44:45], 31, v6
  v_subrev_u32 v6, 15, v6
  v_cmp_lt_u32 s[46:47], 31, v7
  v_subrev_u32 v7, 15, v7
  v_cndmask_b32 v4, 0, v4, s[40:41]
  v_cndmask_b32 v5, 0, v5, s[42:43]
  v_cndmask_b32 v6, 0, v6, s[44:45]
  v_cndmask_b32 v7, 0, v7, s[46:47]
  v_add_u32 v8, v4, v5
  v_add_u32 v9, v8, v6
  v_add_u32 v10, v9, v7
  v_mov_b32 v11, v10
  s_nop 1
  v_add_u32_dpp v11, v11, v11 row_shr:1 row_mask:0xf bank_mask:0xf
  s_nop 1
  v_add_u32_dpp v11, v11, v11 row_shr:2 row_mask:0xf bank_mask:0xf
  s_nop 1
  v_add_u32_dpp v11, v11, v11 row_shr:4 row_mask:0xf bank_mask:0xf
  s_nop 1
  v_add_u32_dpp v11, v11, v11 row_shr:8 row_mask:0xf bank_mask:0xf
  s_nop 1
  v_add_u32_dpp v11, v11, v11 row_bcast:15 row_mask:0xa bank_mask:0xf
  s_nop 1
  v_add_u32_dpp v11, v11, v11 row_bcast:31 row_mask:0xc bank_mask:0xf
  v_cndmask_b32 v16, v48, v49, s[40:41]
  v_cndmask_b32 v17, v48, v49, s[42:43]
  v_cndmask_b32 v18, v48, v49, s[44:45]
  v_cndmask_b32 v19, v48, v49, s[46:47]
  v_sub_u32 v12, v11, v10
  v_add_u32 v13, v12, v4
  v_add_u32 v14, v12, v8
  v_add_u32 v15, v12, v9
  v_readlane_b32 s33, v11, 63
  v_add_u32 v16, v16, v12
  v_add_u32 v17, v17, v13
  v_add_u32 v18, v18, v14
  v_add_u32 v19, v19, v15
  ds_write_b128 v1, v[16:19] offset:59392
  ds_read_b32 v20, v20 offset:59392
  ds_read_b32 v21, v21 offset:59392
  ds_read_b32 v22, v22 offset:59392
  ds_read_b32 v23, v23 offset:59392
  ds_read_b32 v24, v24 offset:59392
  v_lshl_or_b32 v4, v4, 16, v12
  v_add_u32 v4, 4096, v4
  s_mov_b64 exec, s[40:41]
  ds_write_b32 v53, v4 offset:120
  s_mov_b64 exec, -1
  v_lshl_or_b32 v5, v5, 16, v13
  v_add_u32 v5, 4096, v5
  s_mov_b64 exec, s[42:43]
  ds_write_b32 v53, v5 offset:248
  s_mov_b64 exec, -1
  v_lshl_or_b32 v6, v6, 16, v14
  v_add_u32 v6, 4096, v6
  s_mov_b64 exec, s[44:45]
  ds_write_b32 v53, v6 offset:376
  s_mov_b64 exec, -1
  v_lshl_or_b32 v7, v7, 16, v15
  v_add_u32 v7, 4096, v7
  s_mov_b64 exec, s[46:47]
  ds_write_b32 v53, v7 offset:504
  s_mov_b64 exec, -1
  s_waitcnt lgkmcnt(0)
  v_cmp_ge_u32_sdwa vcc, v28, v20 src0_sel:DWORD src1_sel:WORD_1
  v_and_b32 v20, 0xffff, v20
  v_add_lshl_u32 v20, v20, v28, 3
  s_mov_b64 exec, vcc
  ds_write_b64 v20, v[36:37]
  s_mov_b64 exec, -1
  v_cmp_ge_u32_sdwa vcc, v29, v21 src0_sel:DWORD src1_sel:WORD_1
  v_and_b32 v21, 0xffff, v21
  v_add_lshl_u32 v21, v21, v29, 3
  s_mov_b64 exec, vcc
  ds_write_b64 v21, v[38:39]
  s_mov_b64 exec, -1
  v_cmp_ge_u32_sdwa vcc, v30, v22 src0_sel:DWORD src1_sel:WORD_1
  v_and_b32 v22, 0xffff, v22
  v_add_lshl_u32 v22, v22, v30, 3
  s_mov_b64 exec, vcc
  ds_write_b64 v22, v[40:41]
  s_mov_b64 exec, -1
  v_cmp_ge_u32_sdwa vcc, v31, v23 src0_sel:DWORD src1_sel:WORD_1
  v_and_b32 v23, 0xffff, v23
  v_add_lshl_u32 v23, v23, v31, 3
  s_mov_b64 exec, vcc
  ds_write_b64 v23, v[42:43]
  s_mov_b64 exec, -1
  v_cmp_ge_u32_sdwa vcc, v32, v24 src0_sel:DWORD src1_sel:WORD_1
  v_and_b32 v24, 0xffff, v24
  v_add_lshl_u32 v24, v24, v32, 3
  s_mov_b64 exec, vcc
  ds_write_b64 v24, v[44:45]
  s_mov_b64 exec, -1
  s_lshl_b32 s33, s33, 3
  v_mov_b32 v48, 0
  s_waitcnt lgkmcnt(0)
  s_barrier
  s_branch K1RD
WPREP:
  s_load_dwordx4 s[4:7], s[0:1], 40
  v_lshrrev_b32 v2, 6, v0
  v_and_b32 v1, 63, v0
  v_readfirstlane_b32 s31, v2
  s_mov_b32 s28, 0xbfb8aa3b
  s_mov_b32 s29, 0xbfb8aa3b
  s_mov_b32 s30, 0xffff0000
  s_waitcnt lgkmcnt(0)
  s_mov_b32 s12, s4
  s_mov_b32 s13, s5
  s_mov_b32 s14, 18560
  s_mov_b32 s15, 0x20000
  s_mov_b32 s16, s6
  s_mov_b32 s17, s7
  s_mov_b32 s18, 128
  s_mov_b32 s19, 0x20000
  s_add_u32 s20, s8, 23068672
  s_addc_u32 s21, s9, 0
  s_mov_b32 s22, 24576
  s_mov_b32 s23, 0x20000
  v_and_b32 v2, 7, v1
  v_bfe_u32 v3, v1, 4, 1
  v_lshlrev_b32 v4, 2, v3
  v_xor_b32 v4, v4, v2
  v_lshlrev_b32 v4, 4, v4
  v_lshrrev_b32 v5, 3, v1
  v_lshl_or_b32 v4, v5, 7, v4
  s_lshl_b32 s3, s31, 10
  s_add_u32 s4, s3, 10240
  v_add_u32 v4, s3, v4
  s_mov_b32 m0, s3
  s_nop 0
  buffer_load_dwordx4 v4, s[12:15], 0 offen lds
  v_add_u32 v4, 10240, v4
  s_mov_b32 m0, s4
  s_nop 0
  buffer_load_dwordx4 v4, s[12:15], 0 offen lds
  v_lshrrev_b32 v5, 5, v1
  v_lshlrev_b32 v7, 3, v5
  buffer_load_dwordx2 v[28:29], v7, s[16:19], 0 offen offset:0
  buffer_load_dwordx2 v[30:31], v7, s[16:19], 0 offen offset:16
  buffer_load_dwordx2 v[32:33], v7, s[16:19], 0 offen offset:32
  buffer_load_dwordx2 v[34:35], v7, s[16:19], 0 offen offset:48
  buffer_load_dwordx2 v[36:37], v7, s[16:19], 0 offen offset:64
  buffer_load_dwordx2 v[38:39], v7, s[16:19], 0 offen offset:80
  buffer_load_dwordx2 v[40:41], v7, s[16:19], 0 offen offset:96
  buffer_load_dwordx2 v[42:43], v7, s[16:19], 0 offen offset:112
  v_and_b32 v2, 3, v1
  v_bfe_u32 v4, v1, 2, 2
  v_lshlrev_b32 v2, 3, v2
  v_lshl_add_u32 v2, v3, 5, v2
  v_lshl_add_u32 v2, v4, 7, v2
  v_lshl_add_u32 v6, v5, 12, v2
  v_lshrrev_b32 v3, 1, v4
  v_lshl_add_u32 v6, v3, 6, v6
  v_lshl_add_u32 v8, v5, 10, v2
  v_add_u32 v3, 1, v4
  v_bfe_u32 v3, v3, 1, 1
  v_lshl_add_u32 v8, v3, 6, v8
  v_xor_b32 v9, 64, v8
  s_and_b32 s3, s31, 1
  s_lshl_b32 s3, s3, 6
  v_xor_b32 v6, s3, v6
  s_lshr_b32 s3, s31, 1
  s_lshl_b32 s3, s3, 13
  v_add_u32 v6, s3, v6
  v_lshlrev_b32 v10, 4, v1
  s_lshl_b32 s3, s31, 12
  s_waitcnt vmcnt(0)
  s_barrier
  s_cmp_eq_u32 s31, 4
  s_cbranch_scc1 WP4
  s_cmp_eq_u32 s31, 5
  s_cbranch_scc1 WP5
  s_cmp_gt_u32 s31, 5
  s_cbranch_scc1 WPEND
  ds_read_b64_tr_b16 v[12:13], v6 offset:0
  ds_read_b64_tr_b16 v[14:15], v6 offset:512
  ds_read_b64_tr_b16 v[16:17], v6 offset:1024
  ds_read_b64_tr_b16 v[18:19], v6 offset:1536
  ds_read_b64_tr_b16 v[20:21], v6 offset:2048
  ds_read_b64_tr_b16 v[22:23], v6 offset:2560
  ds_read_b64_tr_b16 v[24:25], v6 offset:3072
  ds_read_b64_tr_b16 v[26:27], v6 offset:3584
  s_waitcnt lgkmcnt(0)
  s_cmp_lt_u32 s31, 2
  s_cbranch_scc1 WPST
  v_lshlrev_b32 v2, 16, v12
  v_and_b32 v3, s30, v12
  v_pk_mul_f32 v[2:3], v[2:3], s[28:29]
  v_cvt_pk_bf16_f32 v12, v2, v3
  v_lshlrev_b32 v2, 16, v13
  v_and_b32 v3, s30, v13
  v_pk_mul_f32 v[2:3], v[2:3], s[28:29]
  v_cvt_pk_bf16_f32 v13, v2, v3
  v_lshlrev_b32 v2, 16, v14
  v_and_b32 v3, s30, v14
  v_pk_mul_f32 v[2:3], v[2:3], s[28:29]
  v_cvt_pk_bf16_f32 v14, v2, v3
  v_lshlrev_b32 v2, 16, v15
  v_and_b32 v3, s30, v15
  v_pk_mul_f32 v[2:3], v[2:3], s[28:29]
  v_cvt_pk_bf16_f32 v15, v2, v3
  v_lshlrev_b32 v2, 16, v16
  v_and_b32 v3, s30, v16
  v_pk_mul_f32 v[2:3], v[2:3], s[28:29]
  v_cvt_pk_bf16_f32 v16, v2, v3
  v_lshlrev_b32 v2, 16, v17
  v_and_b32 v3, s30, v17
  v_pk_mul_f32 v[2:3], v[2:3], s[28:29]
  v_cvt_pk_bf16_f32 v17, v2, v3
  v_lshlrev_b32 v2, 16, v18
  v_and_b32 v3, s30, v18
  v_pk_mul_f32 v[2:3], v[2:3], s[28:29]
  v_cvt_pk_bf16_f32 v18, v2, v3
  v_lshlrev_b32 v2, 16, v19
  v_and_b32 v3, s30, v19
  v_pk_mul_f32 v[2:3], v[2:3], s[28:29]
  v_cvt_pk_bf16_f32 v19, v2, v3
  v_lshlrev_b32 v2, 16, v20
  v_and_b32 v3, s30, v20
  v_pk_mul_f32 v[2:3], v[2:3], s[28:29]
  v_cvt_pk_bf16_f32 v20, v2, v3
  v_lshlrev_b32 v2, 16, v21
  v_and_b32 v3, s30, v21
  v_pk_mul_f32 v[2:3], v[2:3], s[28:29]
  v_cvt_pk_bf16_f32 v21, v2, v3
  v_lshlrev_b32 v2, 16, v22
  v_and_b32 v3, s30, v22
  v_pk_mul_f32 v[2:3], v[2:3], s[28:29]
  v_cvt_pk_bf16_f32 v22, v2, v3
  v_lshlrev_b32 v2, 16, v23
  v_and_b32 v3, s30, v23
  v_pk_mul_f32 v[2:3], v[2:3], s[28:29]
  v_cvt_pk_bf16_f32 v23, v2, v3
  v_lshlrev_b32 v2, 16, v24
  v_and_b32 v3, s30, v24
  v_pk_mul_f32 v[2:3], v[2:3], s[28:29]
  v_cvt_pk_bf16_f32 v24, v2, v3
  v_lshlrev_b32 v2, 16, v25
  v_and_b32 v3, s30, v25
  v_pk_mul_f32 v[2:3], v[2:3], s[28:29]
  v_cvt_pk_bf16_f32 v25, v2, v3
  v_lshlrev_b32 v2, 16, v26
  v_and_b32 v3, s30, v26
  v_pk_mul_f32 v[2:3], v[2:3], s[28:29]
  v_cvt_pk_bf16_f32 v26, v2, v3
  v_lshlrev_b32 v2, 16, v27
  v_and_b32 v3, s30, v27
  v_pk_mul_f32 v[2:3], v[2:3], s[28:29]
  v_cvt_pk_bf16_f32 v27, v2, v3
WPST:
  buffer_store_dwordx4 v[12:15], v10, s[20:23], s3 offen offset:0
  buffer_store_dwordx4 v[16:19], v10, s[20:23], s3 offen offset:1024
  buffer_store_dwordx4 v[20:23], v10, s[20:23], s3 offen offset:2048
  buffer_store_dwordx4 v[24:27], v10, s[20:23], s3 offen offset:3072
  s_endpgm
WP4:
  ds_read_b64_tr_b16 v[12:13], v8 offset:16512
  ds_read_b64_tr_b16 v[14:15], v8 offset:17024
  ds_read_b64_tr_b16 v[16:17], v9 offset:16512
  ds_read_b64_tr_b16 v[18:19], v9 offset:17024
  v_and_b32 v2, 31, v1
  v_lshlrev_b32 v2, 1, v2
  ds_read_u16 v20, v2 offset:16384
  ds_read_u16 v21, v2 offset:16448
  v_subrev_u32 v5, 1, v5
  s_waitcnt lgkmcnt(0)
  v_lshlrev_b32 v2, 16, v12
  v_and_b32 v3, s30, v12
  v_pk_mul_f32 v[2:3], v[2:3], s[28:29]
  v_cvt_pk_bf16_f32 v12, v2, v3
  v_lshlrev_b32 v2, 16, v13
  v_and_b32 v3, s30, v13
  v_pk_mul_f32 v[2:3], v[2:3], s[28:29]
  v_cvt_pk_bf16_f32 v13, v2, v3
  v_lshlrev_b32 v2, 16, v14
  v_and_b32 v3, s30, v14
  v_pk_mul_f32 v[2:3], v[2:3], s[28:29]
  v_cvt_pk_bf16_f32 v14, v2, v3
  v_lshlrev_b32 v2, 16, v15
  v_and_b32 v3, s30, v15
  v_pk_mul_f32 v[2:3], v[2:3], s[28:29]
  v_cvt_pk_bf16_f32 v15, v2, v3
  v_lshlrev_b32 v2, 16, v16
  v_and_b32 v3, s30, v16
  v_pk_mul_f32 v[2:3], v[2:3], s[28:29]
  v_cvt_pk_bf16_f32 v16, v2, v3
  v_lshlrev_b32 v2, 16, v17
  v_and_b32 v3, s30, v17
  v_pk_mul_f32 v[2:3], v[2:3], s[28:29]
  v_cvt_pk_bf16_f32 v17, v2, v3
  v_lshlrev_b32 v2, 16, v18
  v_and_b32 v3, s30, v18
  v_pk_mul_f32 v[2:3], v[2:3], s[28:29]
  v_cvt_pk_bf16_f32 v18, v2, v3
  v_lshlrev_b32 v2, 16, v19
  v_and_b32 v3, s30, v19
  v_pk_mul_f32 v[2:3], v[2:3], s[28:29]
  v_cvt_pk_bf16_f32 v19, v2, v3
  v_lshlrev_b32 v20, 16, v20
  v_mul_f32 v20, s28, v20
  v_cvt_pk_f16_f32 v20, v20, 0
  v_and_b32 v20, v5, v20
  v_mov_b32 v22, 0
  v_lshlrev_b32 v21, 16, v21
  v_mul_f32 v21, s28, v21
  v_cvt_pk_f16_f32 v21, v21, 0
  v_and_b32 v21, v5, v21
  v_mov_b32 v23, 0
  buffer_store_dwordx4 v[12:15], v10, s[20:23], s3 offen offset:0
  buffer_store_dwordx4 v[16:19], v10, s[20:23], s3 offen offset:1024
  buffer_store_dwordx4 v[20:23], v10, s[20:23], s3 offen offset:2048
  buffer_store_dwordx4 v[20:23], v10, s[20:23], s3 offen offset:3072
  s_endpgm
WP5:
  v_lshrrev_b32 v4, 2, v1
  v_lshrrev_b32 v8, 4, v1
  v_xor_b32 v4, v4, v8
  v_and_b32 v4, 1, v4
  v_subrev_u32 v4, 1, v4
  v_lshlrev_b32 v2, 16, v28
  v_and_b32 v3, s30, v28
  v_cvt_pk_f16_f32 v2, v2, v3
  v_and_b32 v12, v4, v2
  v_lshlrev_b32 v2, 16, v29
  v_and_b32 v3, s30, v29
  v_cvt_pk_f16_f32 v2, v2, v3
  v_and_b32 v13, v4, v2
  v_lshlrev_b32 v2, 16, v30
  v_and_b32 v3, s30, v30
  v_cvt_pk_f16_f32 v2, v2, v3
  v_and_b32 v14, v4, v2
  v_lshlrev_b32 v2, 16, v31
  v_and_b32 v3, s30, v31
  v_cvt_pk_f16_f32 v2, v2, v3
  v_and_b32 v15, v4, v2
  v_lshlrev_b32 v2, 16, v32
  v_and_b32 v3, s30, v32
  v_cvt_pk_f16_f32 v2, v2, v3
  v_and_b32 v16, v4, v2
  v_lshlrev_b32 v2, 16, v33
  v_and_b32 v3, s30, v33
  v_cvt_pk_f16_f32 v2, v2, v3
  v_and_b32 v17, v4, v2
  v_lshlrev_b32 v2, 16, v34
  v_and_b32 v3, s30, v34
  v_cvt_pk_f16_f32 v2, v2, v3
  v_and_b32 v18, v4, v2
  v_lshlrev_b32 v2, 16, v35
  v_and_b32 v3, s30, v35
  v_cvt_pk_f16_f32 v2, v2, v3
  v_and_b32 v19, v4, v2
  v_lshlrev_b32 v2, 16, v36
  v_and_b32 v3, s30, v36
  v_cvt_pk_f16_f32 v2, v2, v3
  v_and_b32 v20, v4, v2
  v_lshlrev_b32 v2, 16, v37
  v_and_b32 v3, s30, v37
  v_cvt_pk_f16_f32 v2, v2, v3
  v_and_b32 v21, v4, v2
  v_lshlrev_b32 v2, 16, v38
  v_and_b32 v3, s30, v38
  v_cvt_pk_f16_f32 v2, v2, v3
  v_and_b32 v22, v4, v2
  v_lshlrev_b32 v2, 16, v39
  v_and_b32 v3, s30, v39
  v_cvt_pk_f16_f32 v2, v2, v3
  v_and_b32 v23, v4, v2
  v_lshlrev_b32 v2, 16, v40
  v_and_b32 v3, s30, v40
  v_cvt_pk_f16_f32 v2, v2, v3
  v_and_b32 v24, v4, v2
  v_lshlrev_b32 v2, 16, v41
  v_and_b32 v3, s30, v41
  v_cvt_pk_f16_f32 v2, v2, v3
  v_and_b32 v25, v4, v2
  v_lshlrev_b32 v2, 16, v42
  v_and_b32 v3, s30, v42
  v_cvt_pk_f16_f32 v2, v2, v3
  v_and_b32 v26, v4, v2
  v_lshlrev_b32 v2, 16, v43
  v_and_b32 v3, s30, v43
  v_cvt_pk_f16_f32 v2, v2, v3
  v_and_b32 v27, v4, v2
  s_branch WPST
WPEND:
  s_endpgm
.globl main_kernel
.p2align 8
.type main_kernel,@function
main_kernel:
  s_cmp_ge_u32 s2, 256
  s_cbranch_scc1 K2END
  s_load_dwordx2 s[52:53], s[0:1], 80
  s_load_dwordx8 s[32:39], s[0:1], 0
  s_load_dwordx4 s[48:51], s[0:1], 56
  s_and_b32 s3, s2, 7
  s_lshl_b32 s3, s3, 5
  s_lshr_b32 s56, s2, 3
  s_add_u32 s56, s56, s3
  v_lshrrev_b32 v2, 6, v0
  v_and_b32 v0, 63, v0
  v_readfirstlane_b32 s57, v2
  s_mov_b32 s60, 47
  s_mov_b32 s61, 0
  s_mov_b32 s63, 1
  s_mov_b32 s54, 1
  s_movk_i32 s55, 2176
  s_movk_i32 s94, 17404
  s_movk_i32 s95, 0xf0
  s_movk_i32 s64, 128
  s_mov_b32 s65, 0xffff0000
  s_mov_b32 s70, 0xbfb8aa3b
  s_mov_b32 s71, 0xbfb8aa3b
  s_mov_b32 s72, 1.0
  s_mov_b32 s73, 1.0
  s_mov_b32 s74, -1
  s_mov_b32 s75, 0
  s_lshl_b32 s3, s56, 3
  s_add_u32 s3, s3, s57
  s_mul_i32 s3, s3, 3125
  s_add_u32 s58, s3, 127
  s_lshr_b32 s58, s58, 7
  s_add_u32 s3, s3, 3252
  s_lshr_b32 s3, s3, 7
  s_sub_u32 s3, s3, s58
  s_bfm_b32 s78, s3, 0
  s_lshl_b32 s66, s57, 12
  s_add_u32 s66, s66, 81408
  s_lshl_b32 s67, s57, 10
  s_add_u32 s67, s67, 36352
  s_mul_i32 s3, s56, 128
  s_mov_b32 s18, 8191232
  s_mov_b32 s19, 0x20000
  s_waitcnt lgkmcnt(0)
  s_add_u32 s16, s52, s3
  s_addc_u32 s17, s53, 0
ROUND:
  s_lshl_b32 s3, s57, 12
  v_lshl_add_u32 v2, v0, 4, s3
  v_lshrrev_b32 v3, 7, v2
  v_lshl_add_u32 v2, v3, 15, v2
  buffer_load_dwordx4 v[128:131], v2, s[16:19], 0 offen offset:0
  v_add_u32 v2, 262144, v2
  buffer_load_dwordx4 v[132:135], v2, s[16:19], 0 offen offset:1024
  v_add_u32 v2, 262144, v2
  buffer_load_dwordx4 v[136:139], v2, s[16:19], 0 offen offset:2048
  v_add_u32 v2, 262144, v2
  buffer_load_dwordx4 v[140:143], v2, s[16:19], 0 offen offset:3072
  s_and_b32 s3, s57, 3
  s_lshl_b32 s3, s3, 8
  v_lshl_add_u32 v4, v0, 2, s3
  v_mov_b32 v5, 0
  ds_write_b32 v4, v5 offset:34816
  s_cmp_eq_u32 s63, 0
  s_cbranch_scc1 NOTFIRST1
  s_mov_b32 s4, s32
  s_mov_b32 s5, s33
  s_mov_b32 s6, 6400000
  s_mov_b32 s7, 0x20000
  s_mov_b32 s12, s34
  s_mov_b32 s13, s35
  s_mov_b32 s14, 300000
  s_mov_b32 s15, 0x20000
  v_and_b32 v2, 7, v0
  v_bfe_u32 v3, v0, 4, 1
  v_lshrrev_b32 v5, 3, v0
  v_lshrrev_b32 v6, 5, v0
  v_lshl_add_u32 v237, v6, 2, 0
  v_xor_b32 v237, v237, v2
  v_lshlrev_b32 v237, 4, v237
  v_lshl_add_u32 v238, v6, 2, 1
  v_xor_b32 v238, v238, v2
  v_lshlrev_b32 v238, 4, v238
  v_lshl_add_u32 v239, v6, 2, 2
  v_xor_b32 v239, v239, v2
  v_lshlrev_b32 v239, 4, v239
  v_lshl_add_u32 v240, v6, 2, 3
  v_xor_b32 v240, v240, v2
  v_lshlrev_b32 v240, 4, v240
  v_lshl_add_u32 v7, v5, 2, s58
  v_add_u32 v7, 0, v7
  v_mad_u32_u24 v56, v7, s64, v237
  v_lshl_add_u32 v7, v5, 2, s58
  v_add_u32 v7, 1, v7
  v_mad_u32_u24 v57, v7, s64, v238
  v_lshl_add_u32 v7, v5, 2, s58
  v_add_u32 v7, 2, v7
  v_mad_u32_u24 v58, v7, s64, v239
  v_lshl_add_u32 v7, v5, 2, s58
  v_add_u32 v7, 3, v7
  v_mad_u32_u24 v59, v7, s64, v240
  v_add_u32 v12, s58, v0
  v_mul_u32_u24 v11, 6, v12
  v_and_b32 v11, -4, v11
  s_mov_b32 s8, s36
  s_mov_b32 s9, s37
  s_mov_b32 s10, 25600000
  s_mov_b32 s11, 0x20000
  s_mov_b32 s28, s50
  s_mov_b32 s29, s51
  s_mov_b32 s30, 6700000
  s_mov_b32 s31, 0x20000
  s_mov_b32 s24, s48
  s_mov_b32 s25, s49
  s_mov_b32 s26, 16384
  s_mov_b32 s27, 0x20000
  s_add_u32 s20, s52, 8388608
  s_addc_u32 s21, s53, 0
  s_mov_b32 s22, 14704640
  s_mov_b32 s23, 0x20000
  v_lshlrev_b32 v13, 1, v3
  v_xor_b32 v13, v13, v2
  v_lshlrev_b32 v13, 4, v13
  v_lshl_or_b32 v13, v5, 7, v13
  s_lshl_b32 s3, s57, 10
  v_lshl_add_u32 v10, v0, 4, s3
  v_add_u32 v10, 14680064, v10
  v_add_u32 v13, s3, v13
  v_lshlrev_b32 v254, 4, v6
  v_and_b32 v2, 3, v0
  v_bfe_u32 v4, v0, 2, 3
  v_lshl_add_u32 v4, v2, 3, v4
  v_xor_b32 v7, v3, v6
  v_lshlrev_b32 v7, 6, v7
  v_lshl_add_u32 v4, v4, 7, v7
  v_add_u32 v4, s66, v4
  v_xor_b32 v7, 0, v2
  v_lshl_add_u32 v241, v7, 4, v4
  v_xor_b32 v7, 1, v2
  v_lshl_add_u32 v242, v7, 4, v4
  v_xor_b32 v7, 2, v2
  v_lshl_add_u32 v243, v7, 4, v4
  v_xor_b32 v7, 3, v2
  v_lshl_add_u32 v244, v7, 4, v4
  s_add_u32 s3, s67, 32
  v_lshlrev_b32 v7, 5, v6
  v_sub_u32 v245, s3, v7
  s_add_u32 s3, s67, 224
  v_lshl_add_u32 v7, v3, 2, v2
  v_lshlrev_b32 v7, 5, v7
  v_sub_u32 v247, s3, v7
  s_mul_i32 s3, s57, 4608
  s_add_u32 s3, s3, 44544
  v_and_b32 v7, 31, v0
  s_movk_i32 s68, 144
  v_mul_u32_u24 v8, s68, v7
  v_add_u32 v8, s3, v8
  v_lshl_add_u32 v246, v6, 5, v8
  v_bfe_u32 v4, v0, 2, 2
  v_lshl_add_u32 v8, v6, 2, v4
  s_movk_i32 s68, 576
  v_mul_u32_u24 v9, s68, v8
  v_add_u32 v9, s3, v9
  v_xor_b32 v249, v3, v0
  v_and_b32 v249, 1, v249
  v_lshl_add_u32 v249, v249, 3, v9
  v_add_u32 v249, 128, v249
  v_lshl_add_u32 v248, v3, 5, v9
  v_lshl_add_u32 v248, v2, 3, v248
  v_mov_b32 v72, 0
  v_mov_b32 v73, 0
  v_mov_b32 v74, 0x3c00
  v_mov_b32 v75, 0x3c000000
  v_cmp_eq_u32 vcc, 28, v0
  s_nop 1
  v_cndmask_b32 v72, v72, v74, vcc
  v_cmp_eq_u32 vcc, 29, v0
  s_nop 1
  v_cndmask_b32 v72, v72, v75, vcc
  v_cmp_eq_u32 vcc, 30, v0
  s_nop 1
  v_cndmask_b32 v73, v73, v74, vcc
  v_cmp_eq_u32 vcc, 31, v0
  s_nop 1
  v_cndmask_b32 v73, v73, v75, vcc
  v_lshl_add_u32 v9, v0, 3, s67
  ds_write_b64 v9, v[72:73]
  v_mov_b32 v88, 0
  v_mov_b32 v89, 0
  v_mov_b32 v90, 0
  v_mov_b32 v91, 0
  v_mov_b32 v92, 0
  v_mov_b32 v93, 0
  v_mov_b32 v94, 0
  v_mov_b32 v95, 0
  v_mov_b32 v96, 0
  v_mov_b32 v97, 0
  v_mov_b32 v98, 0
  v_mov_b32 v99, 0
  v_mov_b32 v100, 0
  v_mov_b32 v101, 0
  v_mov_b32 v102, 0
  v_mov_b32 v103, 0
  v_mov_b32 v104, 0
  v_mov_b32 v105, 0
  v_mov_b32 v106, 0
  v_mov_b32 v107, 0
  v_mov_b32 v108, 0
  v_mov_b32 v109, 0
  v_mov_b32 v110, 0
  v_mov_b32 v111, 0
  v_mov_b32 v112, 0
  v_mov_b32 v113, 0
  v_mov_b32 v114, 0
  v_mov_b32 v115, 0
  v_mov_b32 v116, 0
  v_mov_b32 v117, 0
  v_mov_b32 v118, 0
  v_mov_b32 v119, 0
  v_mov_b32 v120, 0
  v_mov_b32 v121, 0
  v_mov_b32 v122, 0
  v_mov_b32 v123, 0
  s_branch FIRST1
NOTFIRST1:
  s_waitcnt vmcnt(0)
FIRST1:
  s_lshl_b32 s3, s57, 5
  v_lshrrev_b32 v2, 3, v0
  v_add_u32 v2, s3, v2
  s_mov_b32 s3, 58368
  v_mul_u32_u24 v2, s3, v2
  v_and_b32 v3, 7, v0
  v_lshl_add_u32 v2, v3, 4, v2
  v_lshlrev_b32 v3, 1, v3
  s_sub_i32 s68, s61, 15
  s_add_i32 s69, s68, s60
  s_max_i32 s68, s68, 0
  s_lshl_b32 s3, s68, 3
  v_add_u32 v2, s3, v2
  v_add_u32 v4, s68, v3
  v_mov_b32 v9, 1
  s_waitcnt lgkmcnt(0)
  s_barrier
  s_waitcnt vmcnt(3)
  v_ashrrev_i32 v5, 31, v131
  v_bfi_b32 v5, v5, 0, v130
  s_mov_b32 s3, 0
  v_mov_b32_dpp v6, v5 quad_perm:[3,3,3,3] row_mask:0xf bank_mask:0xf
  s_nop 1
  v_or_b32_dpp v6, v6, v6 row_half_mirror row_mask:0xf bank_mask:0xf
  v_lshrrev_b32 v220, 16, v6
  v_and_b32 v6, 0xffff, v6
  v_lshl_add_u32 v6, v6, 3, v2
  v_add_u32 v224, s3, v6
  v_min_i32 v216, s69, v220
  v_sub_u32 v216, v216, v4
  v_cmp_lt_i32 vcc, 0, v216
  s_nop 1
  v_cndmask_b32 v6, -16, v224, vcc
  buffer_load_dwordx4 v[144:147], v6, s[20:23], 0 offen
  s_waitcnt vmcnt(3)
  v_ashrrev_i32 v5, 31, v135
  v_bfi_b32 v5, v5, 0, v134
  s_mov_b32 s3, 466944
  v_mov_b32_dpp v6, v5 quad_perm:[3,3,3,3] row_mask:0xf bank_mask:0xf
  s_nop 1
  v_or_b32_dpp v6, v6, v6 row_half_mirror row_mask:0xf bank_mask:0xf
  v_lshrrev_b32 v221, 16, v6
  v_and_b32 v6, 0xffff, v6
  v_lshl_add_u32 v6, v6, 3, v2
  v_add_u32 v225, s3, v6
  v_min_i32 v217, s69, v221
  v_sub_u32 v217, v217, v4
  v_cmp_lt_i32 vcc, 0, v217
  s_nop 1
  v_cndmask_b32 v6, -16, v225, vcc
  buffer_load_dwordx4 v[148:151], v6, s[20:23], 0 offen
  s_waitcnt vmcnt(3)
  v_ashrrev_i32 v5, 31, v139
  v_bfi_b32 v5, v5, 0, v138
  s_mov_b32 s3, 933888
  v_mov_b32_dpp v6, v5 quad_perm:[3,3,3,3] row_mask:0xf bank_mask:0xf
  s_nop 1
  v_or_b32_dpp v6, v6, v6 row_half_mirror row_mask:0xf bank_mask:0xf
  v_lshrrev_b32 v222, 16, v6
  v_and_b32 v6, 0xffff, v6
  v_lshl_add_u32 v6, v6, 3, v2
  v_add_u32 v226, s3, v6
  v_min_i32 v218, s69, v222
  v_sub_u32 v218, v218, v4
  v_cmp_lt_i32 vcc, 0, v218
  s_nop 1
  v_cndmask_b32 v6, -16, v226, vcc
  buffer_load_dwordx4 v[152:155], v6, s[20:23], 0 offen
  s_waitcnt vmcnt(3)
  v_ashrrev_i32 v5, 31, v143
  v_bfi_b32 v5, v5, 0, v142
  s_mov_b32 s3, 1400832
  v_mov_b32_dpp v6, v5 quad_perm:[3,3,3,3] row_mask:0xf bank_mask:0xf
  s_nop 1
  v_or_b32_dpp v6, v6, v6 row_half_mirror row_mask:0xf bank_mask:0xf
  v_lshrrev_b32 v223, 16, v6
  v_and_b32 v6, 0xffff, v6
  v_lshl_add_u32 v6, v6, 3, v2
  v_add_u32 v227, s3, v6
  v_min_i32 v219, s69, v223
  v_sub_u32 v219, v219, v4
  v_cmp_lt_i32 vcc, 0, v219
  s_nop 1
  v_cndmask_b32 v6, -16, v227, vcc
  buffer_load_dwordx4 v[156:159], v6, s[20:23], 0 offen
  s_cmp_eq_u32 s63, 0
  s_cbranch_scc1 NOLATE1
  s_lshl_b32 m0, s57, 10
  s_add_u32 m0, m0, 130560
  s_nop 0
  buffer_load_dwordx4 v10, s[20:23], 0 offen lds
  v_add_u32 v10, 0x2000, v10
  s_lshl_b32 m0, s57, 10
  s_add_u32 m0, m0, 138752
  s_nop 0
  buffer_load_dwordx4 v10, s[20:23], 0 offen lds
  v_add_u32 v10, 0x2000, v10
  s_lshl_b32 m0, s57, 10
  s_add_u32 m0, m0, 146944
  s_nop 0
  buffer_load_dwordx4 v10, s[20:23], 0 offen lds
NOLATE1:
  v_max3_i32 v5, v216, v217, v218
  v_max_i32 v5, v5, v219
  v_cmp_lt_i32 s[76:77], 16, v5
  v_max3_i32 v5, v220, v221, v222
  v_max_i32 v5, v5, v223
  s_max_i32 s69, s69, 0
  v_cmp_lt_i32 s[68:69], s69, v5
  s_cmp_eq_u64 s[76:77], 0
  s_cbranch_scc1 NOL2A
  v_cmpx_lt_i32 vcc, 16, v216
  buffer_load_dwordx4 v[160:163], v224, s[20:23], 0 offen offset:128
  s_mov_b64 exec, -1
  v_cmpx_lt_i32 vcc, 16, v217
  buffer_load_dwordx4 v[164:167], v225, s[20:23], 0 offen offset:128
  s_mov_b64 exec, -1
  v_cmpx_lt_i32 vcc, 16, v218
  buffer_load_dwordx4 v[168:171], v226, s[20:23], 0 offen offset:128
  s_mov_b64 exec, -1
  v_cmpx_lt_i32 vcc, 16, v219
  buffer_load_dwordx4 v[172:175], v227, s[20:23], 0 offen offset:128
  s_mov_b64 exec, -1
NOL2A:
  s_cmp_lg_u32 s63, 0
  s_cbranch_scc1 FIRST2
  s_add_u32 s3, s61, s60
  v_add_u32 v5, 0, v3
  v_cmp_le_u32 s[32:33], s3, v5
  v_cmp_gt_u32 s[34:35], s61, v5
  s_or_b64 s[34:35], s[34:35], s[32:33]
  v_cmp_gt_i32 vcc, 0, v129
  s_and_b64 vcc, vcc, s[32:33]
  s_or_b64 s[68:69], s[68:69], vcc
  v_cndmask_b32 v129, v129, 0, s[34:35]
  v_cmp_gt_i32 vcc, 0, v133
  s_and_b64 vcc, vcc, s[32:33]
  s_or_b64 s[68:69], s[68:69], vcc
  v_cndmask_b32 v133, v133, 0, s[34:35]
  v_cmp_gt_i32 vcc, 0, v137
  s_and_b64 vcc, vcc, s[32:33]
  s_or_b64 s[68:69], s[68:69], vcc
  v_cndmask_b32 v137, v137, 0, s[34:35]
  v_cmp_gt_i32 vcc, 0, v141
  s_and_b64 vcc, vcc, s[32:33]
  s_or_b64 s[68:69], s[68:69], vcc
  v_cndmask_b32 v141, v141, 0, s[34:35]
  v_add_u32 v5, 1, v3
  v_cmp_le_u32 s[32:33], s3, v5
  v_cmp_gt_u32 s[34:35], s61, v5
  s_or_b64 s[34:35], s[34:35], s[32:33]
  v_cmp_gt_i32 vcc, 0, v131
  s_and_b64 vcc, vcc, s[32:33]
  s_or_b64 s[68:69], s[68:69], vcc
  v_cndmask_b32 v131, v131, 0, s[34:35]
  v_cmp_gt_i32 vcc, 0, v135
  s_and_b64 vcc, vcc, s[32:33]
  s_or_b64 s[68:69], s[68:69], vcc
  v_cndmask_b32 v135, v135, 0, s[34:35]
  v_cmp_gt_i32 vcc, 0, v139
  s_and_b64 vcc, vcc, s[32:33]
  s_or_b64 s[68:69], s[68:69], vcc
  v_cndmask_b32 v139, v139, 0, s[34:35]
  v_cmp_gt_i32 vcc, 0, v143
  s_and_b64 vcc, vcc, s[32:33]
  s_or_b64 s[68:69], s[68:69], vcc
  v_cndmask_b32 v143, v143, 0, s[34:35]
  s_waitcnt vmcnt(0)
FIRST2:
  s_cmp_eq_u64 s[68:69], 0
  s_cbranch_scc1 NOFLAG
  v_mov_b32 v5, 35328
  ds_write_b32 v5, v5
NOFLAG:
  v_cmp_gt_i32 s[32:33], 0, v129
  v_lshlrev_b32_sdwa v200, 2, v129 dst_sel:DWORD dst_unused:UNUSED_PAD src0_sel:DWORD src1_sel:BYTE_3
  v_cmp_gt_i32 s[34:35], 0, v131
  v_lshlrev_b32_sdwa v201, 2, v131 dst_sel:DWORD dst_unused:UNUSED_PAD src0_sel:DWORD src1_sel:BYTE_3
  v_cmp_gt_i32 s[36:37], 0, v133
  v_lshlrev_b32_sdwa v202, 2, v133 dst_sel:DWORD dst_unused:UNUSED_PAD src0_sel:DWORD src1_sel:BYTE_3
  v_cmp_gt_i32 s[38:39], 0, v135
  v_lshlrev_b32_sdwa v203, 2, v135 dst_sel:DWORD dst_unused:UNUSED_PAD src0_sel:DWORD src1_sel:BYTE_3
  v_cmp_gt_i32 s[40:41], 0, v137
  v_lshlrev_b32_sdwa v204, 2, v137 dst_sel:DWORD dst_unused:UNUSED_PAD src0_sel:DWORD src1_sel:BYTE_3
  v_cmp_gt_i32 s[42:43], 0, v139
  v_lshlrev_b32_sdwa v205, 2, v139 dst_sel:DWORD dst_unused:UNUSED_PAD src0_sel:DWORD src1_sel:BYTE_3
  v_cmp_gt_i32 s[44:45], 0, v141
  v_lshlrev_b32_sdwa v206, 2, v141 dst_sel:DWORD dst_unused:UNUSED_PAD src0_sel:DWORD src1_sel:BYTE_3
  v_cmp_gt_i32 s[46:47], 0, v143
  v_lshlrev_b32_sdwa v207, 2, v143 dst_sel:DWORD dst_unused:UNUSED_PAD src0_sel:DWORD src1_sel:BYTE_3
  s_mov_b64 exec, s[32:33]
  ds_add_rtn_u32 v176, v200, v9 offset:34304
  s_mov_b64 exec, s[34:35]
  ds_add_rtn_u32 v177, v201, v9 offset:34304
  s_mov_b64 exec, s[36:37]
  ds_add_rtn_u32 v178, v202, v9 offset:34304
  s_mov_b64 exec, s[38:39]
  ds_add_rtn_u32 v179, v203, v9 offset:34304
  s_mov_b64 exec, s[40:41]
  ds_add_rtn_u32 v180, v204, v9 offset:34304
  s_mov_b64 exec, s[42:43]
  ds_add_rtn_u32 v181, v205, v9 offset:34304
  s_mov_b64 exec, s[44:45]
  ds_add_rtn_u32 v182, v206, v9 offset:34304
  s_mov_b64 exec, s[46:47]
  ds_add_rtn_u32 v183, v207, v9 offset:34304
  s_mov_b64 exec, -1
  s_cmp_eq_u32 s63, 0
  s_cbranch_scc1 NOLATE2
  s_lshl_b32 m0, s57, 10
  s_add_u32 m0, m0, 114176
  s_nop 0
  buffer_load_dwordx4 v13, s[24:27], 0 offen lds
  v_add_u32 v13, 0x2000, v13
  s_lshl_b32 m0, s57, 10
  s_add_u32 m0, m0, 122368
  s_nop 0
  buffer_load_dwordx4 v13, s[24:27], 0 offen lds
NOLATE2:
  v_lshlrev_b32 v2, 2, v0
  v_lshrrev_b32 v8, 4, v0
  v_mul_u32_u24 v8, 544, v8
  v_and_b32 v3, 0x30, v0
  v_add_u32 v3, 35456, v3
  v_cmp_lt_i32 s[48:49], 0, v216
  v_cmp_lt_i32 s[50:51], 1, v216
  v_cmp_lt_i32 s[52:53], 0, v217
  v_cmp_lt_i32 s[96:97], 1, v217
  v_cmp_lt_i32 s[98:99], 0, v218
  v_cmp_lt_i32 s[100:101], 1, v218
  v_cmp_lt_i32 s[68:69], 0, v219
  s_waitcnt lgkmcnt(0)
  s_barrier
  ds_read2st64_b32 v[4:5], v2 offset0:136 offset1:137
  s_waitcnt lgkmcnt(0)
  v_mov_b32 v6, v4
  v_mov_b32 v7, v5
  s_nop 0
  v_add_u32_dpp v6, v6, v6 row_shr:1 row_mask:0xf bank_mask:0xf
  v_add_u32_dpp v7, v7, v7 row_shr:1 row_mask:0xf bank_mask:0xf
  s_nop 0
  v_add_u32_dpp v6, v6, v6 row_shr:2 row_mask:0xf bank_mask:0xf
  v_add_u32_dpp v7, v7, v7 row_shr:2 row_mask:0xf bank_mask:0xf
  s_nop 0
  v_add_u32_dpp v6, v6, v6 row_shr:4 row_mask:0xf bank_mask:0xf
  v_add_u32_dpp v7, v7, v7 row_shr:4 row_mask:0xf bank_mask:0xf
  s_nop 0
  v_add_u32_dpp v6, v6, v6 row_shr:8 row_mask:0xf bank_mask:0xf
  v_add_u32_dpp v7, v7, v7 row_shr:8 row_mask:0xf bank_mask:0xf
  v_sub_u32 v6, v6, v4
  v_sub_u32 v7, v7, v5
  v_add_u32 v4, v6, v8
  v_add3_u32 v5, v7, v8, s55
  ds_write2st64_b32 v2, v4, v5 offset0:140 offset1:141
  v_max_u32 v8, v6, v7
  v_cmp_lt_u32 vcc, 0x200, v8
  s_mov_b32 exec_lo, 0x80008000
  s_mov_b32 exec_hi, 0x80008000
  ds_write2_b32 v3, v4, v5 offset0:1 offset1:17
  s_mov_b64 exec, -1
  v_mov_b32 v8, 1
  v_mov_b32 v9, 0
  s_cbranch_vccz NOOVF1
  s_mov_b64 s[32:33], 0
  s_mov_b64 s[34:35], 0
  s_mov_b64 s[36:37], 0
  s_mov_b64 s[38:39], 0
  s_mov_b64 s[40:41], 0
  s_mov_b64 s[42:43], 0
  s_mov_b64 s[44:45], 0
  s_mov_b64 s[46:47], 0
NOOVF1:
  v_cmp_lt_i32 vcc, 1, v219
  s_waitcnt vmcnt(5)
  v_and_b32_sdwa v208, s95, v145 dst_sel:DWORD dst_unused:UNUSED_PAD src0_sel:DWORD src1_sel:BYTE_3
  v_and_b32_sdwa v209, s95, v147 dst_sel:DWORD dst_unused:UNUSED_PAD src0_sel:DWORD src1_sel:BYTE_3
  v_and_b32_sdwa v210, s95, v149 dst_sel:DWORD dst_unused:UNUSED_PAD src0_sel:DWORD src1_sel:BYTE_3
  v_and_b32_sdwa v211, s95, v151 dst_sel:DWORD dst_unused:UNUSED_PAD src0_sel:DWORD src1_sel:BYTE_3
  v_and_b32_sdwa v212, s95, v153 dst_sel:DWORD dst_unused:UNUSED_PAD src0_sel:DWORD src1_sel:BYTE_3
  v_and_b32_sdwa v213, s95, v155 dst_sel:DWORD dst_unused:UNUSED_PAD src0_sel:DWORD src1_sel:BYTE_3
  v_and_b32_sdwa v214, s95, v157 dst_sel:DWORD dst_unused:UNUSED_PAD src0_sel:DWORD src1_sel:BYTE_3
  v_and_b32_sdwa v215, s95, v159 dst_sel:DWORD dst_unused:UNUSED_PAD src0_sel:DWORD src1_sel:BYTE_3
  s_mov_b64 exec, s[48:49]
  ds_add_rtn_u64 v[184:185], v208, v[8:9] offset:35328
  s_mov_b64 exec, s[50:51]
  ds_add_rtn_u64 v[186:187], v209, v[8:9] offset:35328
  s_mov_b64 exec, s[52:53]
  ds_add_rtn_u64 v[188:189], v210, v[8:9] offset:35328
  s_mov_b64 exec, s[96:97]
  ds_add_rtn_u64 v[190:191], v211, v[8:9] offset:35328
  s_mov_b64 exec, s[98:99]
  ds_add_rtn_u64 v[192:193], v212, v[8:9] offset:35328
  s_mov_b64 exec, s[100:101]
  ds_add_rtn_u64 v[194:195], v213, v[8:9] offset:35328
  s_mov_b64 exec, s[68:69]
  ds_add_rtn_u64 v[196:197], v214, v[8:9] offset:35328
  s_mov_b64 exec, vcc
  ds_add_rtn_u64 v[198:199], v215, v[8:9] offset:35328
  s_mov_b64 exec, -1
  ds_read_b32 v200, v200 offset:35328
  ds_read_b32 v201, v201 offset:35328
  ds_read_b32 v202, v202 offset:35328
  ds_read_b32 v203, v203 offset:35328
  ds_read_b32 v204, v204 offset:35328
  ds_read_b32 v205, v205 offset:35328
  ds_read_b32 v206, v206 offset:35328
  ds_read_b32 v207, v207 offset:35328
  s_cmp_eq_u32 s63, 0
  s_cbranch_scc1 NOLATE4
  s_mul_i32 m0, s57, 4608
  s_add_u32 m0, m0, 44544
  s_nop 0
  buffer_load_dwordx4 v56, s[4:7], 0 offen lds
  s_mul_i32 m0, s57, 4608
  s_add_u32 m0, m0, 45568
  s_nop 0
  buffer_load_dwordx4 v57, s[4:7], 0 offen lds
NOLATE4:
  s_mul_i32 s3, s57, 2176
  v_lshrrev_b32 v2, 3, v0
  v_lshl_add_u32 v250, v2, 4, s3
  v_and_b32 v2, 31, v0
  v_lshl_add_u32 v251, v2, 2, s3
  v_bfe_u32 v2, v0, 2, 2
  v_lshl_add_u32 v2, v2, 4, s3
  v_lshl_add_u32 v252, v254, 2, v2
  v_mov_b32 v2, 35328
  s_waitcnt lgkmcnt(8)
  v_add_lshl_u32 v208, v184, v185, 2
  v_min_u32 v208, s94, v208
  v_add_lshl_u32 v209, v186, v187, 2
  v_min_u32 v209, s94, v209
  v_add_lshl_u32 v210, v188, v189, 2
  v_min_u32 v210, s94, v210
  v_add_lshl_u32 v211, v190, v191, 2
  v_min_u32 v211, s94, v211
  v_add_lshl_u32 v212, v192, v193, 2
  v_min_u32 v212, s94, v212
  v_add_lshl_u32 v213, v194, v195, 2
  v_min_u32 v213, s94, v213
  v_add_lshl_u32 v214, v196, v197, 2
  v_min_u32 v214, s94, v214
  v_add_lshl_u32 v215, v198, v199, 2
  v_min_u32 v215, s94, v215
  s_waitcnt lgkmcnt(6)
  v_add_lshl_u32 v200, v200, v176, 2
  v_add_lshl_u32 v201, v201, v177, 2
  s_waitcnt lgkmcnt(4)
  v_add_lshl_u32 v202, v202, v178, 2
  v_add_lshl_u32 v203, v203, v179, 2
  s_waitcnt lgkmcnt(2)
  v_add_lshl_u32 v204, v204, v180, 2
  v_add_lshl_u32 v205, v205, v181, 2
  s_waitcnt lgkmcnt(0)
  v_add_lshl_u32 v206, v206, v182, 2
  v_add_lshl_u32 v207, v207, v183, 2
  s_mov_b64 exec, s[32:33]
  ds_write2st64_b32 v200, v128, v129 offset0:0 offset1:68
  s_mov_b64 exec, s[34:35]
  ds_write2st64_b32 v201, v130, v131 offset0:0 offset1:68
  s_mov_b64 exec, s[36:37]
  ds_write2st64_b32 v202, v132, v133 offset0:0 offset1:68
  s_mov_b64 exec, s[38:39]
  ds_write2st64_b32 v203, v134, v135 offset0:0 offset1:68
  s_mov_b64 exec, -1
  s_cmp_eq_u32 s63, 0
  s_cbranch_scc1 NOLATE5
  s_mul_i32 m0, s57, 4608
  s_add_u32 m0, m0, 46592
  s_nop 0
  buffer_load_dwordx4 v58, s[4:7], 0 offen lds
NOLATE5:
  s_mov_b64 exec, s[40:41]
  ds_write2st64_b32 v204, v136, v137 offset0:0 offset1:68
  s_mov_b64 exec, s[42:43]
  ds_write2st64_b32 v205, v138, v139 offset0:0 offset1:68
  s_mov_b64 exec, s[44:45]
  ds_write2st64_b32 v206, v140, v141 offset0:0 offset1:68
  s_mov_b64 exec, s[46:47]
  ds_write2st64_b32 v207, v142, v143 offset0:0 offset1:68
  s_mov_b64 exec, -1
  s_cmp_eq_u32 s63, 0
  s_cbranch_scc1 NOLATE6
  s_mul_i32 m0, s57, 4608
  s_add_u32 m0, m0, 47616
  s_nop 0
  buffer_load_dwordx4 v59, s[4:7], 0 offen lds
NOLATE6:
  s_mov_b64 exec, s[48:49]
  ds_write2st64_b32 v208, v144, v145 offset0:0 offset1:68
  s_mov_b64 exec, s[50:51]
  ds_write2st64_b32 v209, v146, v147 offset0:0 offset1:68
  s_mov_b64 exec, s[52:53]
  ds_write2st64_b32 v210, v148, v149 offset0:0 offset1:68
  s_mov_b64 exec, s[96:97]
  ds_write2st64_b32 v211, v150, v151 offset0:0 offset1:68
  s_mov_b64 exec, s[98:99]
  ds_write2st64_b32 v212, v152, v153 offset0:0 offset1:68
  s_mov_b64 exec, s[100:101]
  ds_write2st64_b32 v213, v154, v155 offset0:0 offset1:68
  s_mov_b64 exec, s[68:69]
  ds_write2st64_b32 v214, v156, v157 offset0:0 offset1:68
  s_mov_b64 exec, vcc
  ds_write2st64_b32 v215, v158, v159 offset0:0 offset1:68
  s_mov_b64 exec, -1
  s_cmp_eq_u64 s[76:77], 0
  s_cbranch_scc1 NOL2B
  s_waitcnt vmcnt(0) lgkmcnt(0)
  v_cmpx_lt_i32 vcc, 16, v216
  v_and_b32_sdwa v208, s95, v161 dst_sel:DWORD dst_unused:UNUSED_PAD src0_sel:DWORD src1_sel:BYTE_3
  ds_add_rtn_u64 v[184:185], v208, v[8:9] offset:35328
  v_cmpx_lt_i32 vcc, 17, v216
  v_and_b32_sdwa v209, s95, v163 dst_sel:DWORD dst_unused:UNUSED_PAD src0_sel:DWORD src1_sel:BYTE_3
  ds_add_rtn_u64 v[186:187], v209, v[8:9] offset:35328
  s_mov_b64 exec, -1
  v_cmpx_lt_i32 vcc, 16, v217
  v_and_b32_sdwa v210, s95, v165 dst_sel:DWORD dst_unused:UNUSED_PAD src0_sel:DWORD src1_sel:BYTE_3
  ds_add_rtn_u64 v[188:189], v210, v[8:9] offset:35328
  v_cmpx_lt_i32 vcc, 17, v217
  v_and_b32_sdwa v211, s95, v167 dst_sel:DWORD dst_unused:UNUSED_PAD src0_sel:DWORD src1_sel:BYTE_3
  ds_add_rtn_u64 v[190:191], v211, v[8:9] offset:35328
  s_mov_b64 exec, -1
  v_cmpx_lt_i32 vcc, 16, v218
  v_and_b32_sdwa v212, s95, v169 dst_sel:DWORD dst_unused:UNUSED_PAD src0_sel:DWORD src1_sel:BYTE_3
  ds_add_rtn_u64 v[192:193], v212, v[8:9] offset:35328
  v_cmpx_lt_i32 vcc, 17, v218
  v_and_b32_sdwa v213, s95, v171 dst_sel:DWORD dst_unused:UNUSED_PAD src0_sel:DWORD src1_sel:BYTE_3
  ds_add_rtn_u64 v[194:195], v213, v[8:9] offset:35328
  s_mov_b64 exec, -1
  v_cmpx_lt_i32 vcc, 16, v219
  v_and_b32_sdwa v214, s95, v173 dst_sel:DWORD dst_unused:UNUSED_PAD src0_sel:DWORD src1_sel:BYTE_3
  ds_add_rtn_u64 v[196:197], v214, v[8:9] offset:35328
  v_cmpx_lt_i32 vcc, 17, v219
  v_and_b32_sdwa v215, s95, v175 dst_sel:DWORD dst_unused:UNUSED_PAD src0_sel:DWORD src1_sel:BYTE_3
  ds_add_rtn_u64 v[198:199], v215, v[8:9] offset:35328
  s_mov_b64 exec, -1
  s_waitcnt lgkmcnt(0)
  v_cmpx_lt_i32 vcc, 16, v216
  v_add_lshl_u32 v208, v184, v185, 2
  v_min_u32 v208, s94, v208
  ds_write2st64_b32 v208, v160, v161 offset0:0 offset1:68
  v_cmpx_lt_i32 vcc, 17, v216
  v_add_lshl_u32 v209, v186, v187, 2
  v_min_u32 v209, s94, v209
  ds_write2st64_b32 v209, v162, v163 offset0:0 offset1:68
  s_mov_b64 exec, -1
  v_cmpx_lt_i32 vcc, 16, v217
  v_add_lshl_u32 v210, v188, v189, 2
  v_min_u32 v210, s94, v210
  ds_write2st64_b32 v210, v164, v165 offset0:0 offset1:68
  v_cmpx_lt_i32 vcc, 17, v217
  v_add_lshl_u32 v211, v190, v191, 2
  v_min_u32 v211, s94, v211
  ds_write2st64_b32 v211, v166, v167 offset0:0 offset1:68
  s_mov_b64 exec, -1
  v_cmpx_lt_i32 vcc, 16, v218
  v_add_lshl_u32 v212, v192, v193, 2
  v_min_u32 v212, s94, v212
  ds_write2st64_b32 v212, v168, v169 offset0:0 offset1:68
  v_cmpx_lt_i32 vcc, 17, v218
  v_add_lshl_u32 v213, v194, v195, 2
  v_min_u32 v213, s94, v213
  ds_write2st64_b32 v213, v170, v171 offset0:0 offset1:68
  s_mov_b64 exec, -1
  v_cmpx_lt_i32 vcc, 16, v219
  v_add_lshl_u32 v214, v196, v197, 2
  v_min_u32 v214, s94, v214
  ds_write2st64_b32 v214, v172, v173 offset0:0 offset1:68
  v_cmpx_lt_i32 vcc, 17, v219
  v_add_lshl_u32 v215, v198, v199, 2
  v_min_u32 v215, s94, v215
  ds_write2st64_b32 v215, v174, v175 offset0:0 offset1:68
  s_mov_b64 exec, -1
NOL2B:
  s_cmp_eq_u32 s63, 0
  s_cbranch_scc1 NOLATE7
  buffer_load_dwordx2 v[124:125], v11, s[12:15], 0 offen
NOLATE7:
  s_mov_b32 s63, 0
  v_mov_b32 v228, 0
  v_mov_b32 v229, 0
  v_mov_b32 v230, 0
  v_mov_b32 v231, 0
  s_and_b32 s62, s57, 3
  s_lshl_b32 s62, s62, 4
  s_add_u32 s62, s62, 15
  s_waitcnt vmcnt(5) lgkmcnt(0)
  s_barrier
  ds_read2_b32 v[4:5], v3 offset0:0 offset1:16
  ds_read_b32 v8, v2
  ds_read_b128 v[224:227], v250 offset:0
  ds_read_b32 v232, v251 offset:0
  ds_read_b32 v1, v251 offset:17408
  s_waitcnt lgkmcnt(3)
  v_add_u32 v6, v6, v4
  v_add_u32 v7, v7, v5
  v_max_u32 v4, v6, v7
  v_cmp_lt_u32 vcc, 0x200, v4
  v_readlane_b32 s68, v6, s62
  v_readlane_b32 s69, v7, s62
  v_readfirstlane_b32 s62, v8
  s_cbranch_vccz NOOVF
  s_lshr_b32 s60, s60, 1
  s_waitcnt vmcnt(0) lgkmcnt(0)
  s_barrier
  s_branch ROUND
NOOVF:
  s_cmp_ge_u32 s57, 4
  s_cselect_b32 s68, s69, s68
  s_add_u32 s59, s68, 31
  s_lshr_b32 s59, s59, 5
  v_add_u32 v2, s68, v0
  s_lshl_b32 s69, s59, 5
  v_lshl_add_u32 v3, v2, 2, s3
  s_sub_u32 s3, s58, s69
  v_add_u32 v4, s3, v2
  v_mov_b32 v5, 0xffff
  v_cmp_gt_u32 vcc, s69, v2
  s_nop 1
  v_cndmask_b32 v4, v4, v5, vcc
  v_or_b32 v4, 0xf8000000, v4
  v_mov_b32 v5, 0x00ffffff
  s_add_u32 s69, s69, 32
  v_cmpx_gt_u32 vcc, s69, v2
  ds_write2st64_b32 v3, v4, v5 offset0:0 offset1:68
  s_mov_b64 exec, -1
  s_cmp_ge_u32 s68, 32
  s_cbranch_scc1 FULL0
  ds_read_b128 v[224:227], v250 offset:0
  ds_read_b32 v232, v251 offset:0
  ds_read_b32 v1, v251 offset:17408
  s_waitcnt lgkmcnt(0)
FULL0:
  s_waitcnt lgkmcnt(1)
  s_cmp_gt_i32 s59, -1
  s_cselect_b32 s6, 6400000, 0
  s_cselect_b32 s10, 25600000, 0
  s_cselect_b32 s14, 300000, 0
  v_mad_u32_u24 v1, v1, 32, v254
  buffer_load_dwordx4 v[216:219], v1, s[8:11], 0 offen
  s_add_u32 m0, s66, 0
  v_mad_u32_u24 v224, v224, s64, v237
  buffer_load_dwordx4 v224, s[4:7], 0 offen  lds
  s_add_u32 m0, s66, 1024
  v_mad_u32_u24 v225, v225, s64, v238
  buffer_load_dwordx4 v225, s[4:7], 0 offen  lds
  s_add_u32 m0, s66, 2048
  v_mad_u32_u24 v226, v226, s64, v239
  buffer_load_dwordx4 v226, s[4:7], 0 offen  lds
  s_add_u32 m0, s66, 3072
  v_mad_u32_u24 v227, v227, s64, v240
  buffer_load_dwordx4 v227, s[4:7], 0 offen  lds
  v_mul_u32_u24 v1, 6, v232
  v_and_b32 v1, -4, v1
  s_mov_b64 exec, s[74:75]
  buffer_load_dwordx2 v[228:229], v1, s[12:15], 0 offen
  s_mov_b64 exec, -1
  ds_read_b128 v[224:227], v250 offset:128
  ds_read_b32 v233, v251 offset:128
  ds_read_b32 v1, v251 offset:17536
  s_waitcnt lgkmcnt(0)
  s_cmp_eq_u32 s54, 0
  s_cbranch_scc1 NOINIT2
  v_lshlrev_b32 v2, 4, v0
  v_add_u32 v2, 130560, v2
  s_lshl_b32 s3, s57, 9
  s_sub_u32 s3, s3, 36864
  s_waitcnt vmcnt(6)
  v_add_u32 v6, s3, v241
  ds_read_b128 v[200:203], v6
  v_add_u32 v7, s3, v242
  ds_read_b128 v[204:207], v7
  v_add_u32 v8, s3, v243
  ds_read_b128 v[208:211], v8
  v_add_u32 v9, s3, v244
  ds_read_b128 v[212:215], v9
  ds_read_b128 v[128:131], v2 offset:0
  ds_read_b128 v[132:135], v2 offset:1024
  ds_read_b128 v[136:139], v2 offset:2048
  ds_read_b128 v[140:143], v2 offset:3072
  ds_read_b128 v[144:147], v2 offset:4096
  ds_read_b128 v[148:151], v2 offset:5120
  ds_read_b128 v[152:155], v2 offset:6144
  ds_read_b128 v[156:159], v2 offset:7168
  ds_read_b64 v[4:5], v2 offset:18432
  ds_read_b128 v[16:19], v2 offset:8192
  ds_read_b128 v[20:23], v2 offset:9216
  ds_read_b128 v[24:27], v2 offset:10240
  ds_read_b128 v[28:31], v2 offset:11264
  ds_read_b128 v[32:35], v2 offset:12288
  ds_read_b128 v[36:39], v2 offset:13312
  ds_read_b128 v[40:43], v2 offset:14336
  ds_read_b128 v[44:47], v2 offset:15360
  ds_read_b128 v[48:51], v2 offset:16384
  ds_read_b128 v[52:55], v2 offset:17408
  ds_read_b128 v[72:75], v2 offset:20480
  ds_read_b128 v[76:79], v2 offset:21504
  ds_read_b128 v[80:83], v2 offset:22528
  ds_read_b128 v[84:87], v2 offset:23552
  v_lshlrev_b32 v7, 4, v12
  v_alignbit_b32 v8, v125, v124, v7
  v_lshrrev_b32 v9, v7, v125
  v_lshlrev_b32 v6, 16, v8
  v_and_b32 v7, s65, v8
  v_lshlrev_b32 v8, 16, v9
  v_lshl_add_u32 v9, v0, 3, s67
  s_mov_b64 exec, s[74:75]
  ds_write_b64 v9, v[6:7] offset:512
  ds_write_b32 v9, v8 offset:768
  s_mov_b64 exec, -1
  s_waitcnt lgkmcnt(15)
  v_mfma_f32_32x32x16_bf16 v[160:175], v[200:203], v[128:131], 0
  v_mfma_f32_32x32x16_bf16 v[176:191], v[200:203], v[144:147], 0
  v_mfma_f32_32x32x16_bf16 v[160:175], v[204:207], v[132:135], v[160:175]
  v_mfma_f32_32x32x16_bf16 v[176:191], v[204:207], v[148:151], v[176:191]
  v_mfma_f32_32x32x16_bf16 v[160:175], v[208:211], v[136:139], v[160:175]
  v_mfma_f32_32x32x16_bf16 v[176:191], v[208:211], v[152:155], v[176:191]
  v_mfma_f32_32x32x16_bf16 v[160:175], v[212:215], v[140:143], v[160:175]
  v_mfma_f32_32x32x16_bf16 v[176:191], v[212:215], v[156:159], v[176:191]
  s_waitcnt lgkmcnt(0)
  s_mov_b32 s54, 0
  s_nop 7
  s_nop 0
  v_pk_mul_f32 v[160:161], v[160:161], s[70:71]
  v_cvt_pk_f16_f32 v56, v160, v161
  v_pk_mul_f32 v[162:163], v[162:163], s[70:71]
  v_cvt_pk_f16_f32 v57, v162, v163
  v_pk_mul_f32 v[164:165], v[164:165], s[70:71]
  v_cvt_pk_f16_f32 v58, v164, v165
  v_pk_mul_f32 v[166:167], v[166:167], s[70:71]
  v_cvt_pk_f16_f32 v59, v166, v167
  v_pk_mul_f32 v[168:169], v[168:169], s[70:71]
  v_cvt_pk_f16_f32 v60, v168, v169
  v_pk_mul_f32 v[170:171], v[170:171], s[70:71]
  v_cvt_pk_f16_f32 v61, v170, v171
  v_pk_mul_f32 v[172:173], v[172:173], s[70:71]
  v_cvt_pk_f16_f32 v62, v172, v173
  v_pk_mul_f32 v[176:177], v[176:177], s[70:71]
  v_cvt_pk_f16_f32 v64, v176, v177
  v_pk_mul_f32 v[178:179], v[178:179], s[70:71]
  v_cvt_pk_f16_f32 v65, v178, v179
  v_pk_mul_f32 v[180:181], v[180:181], s[70:71]
  v_cvt_pk_f16_f32 v66, v180, v181
  v_pk_mul_f32 v[182:183], v[182:183], s[70:71]
  v_cvt_pk_f16_f32 v67, v182, v183
  v_pk_mul_f32 v[184:185], v[184:185], s[70:71]
  v_cvt_pk_f16_f32 v68, v184, v185
  v_pk_mul_f32 v[186:187], v[186:187], s[70:71]
  v_cvt_pk_f16_f32 v69, v186, v187
  v_pk_mul_f32 v[188:189], v[188:189], s[70:71]
  v_cvt_pk_f16_f32 v70, v188, v189
  v_mov_b32 v63, v4
  v_mov_b32 v71, v5
NOINIT2:
  v_mov_b32 v184, 0
  v_mov_b32 v168, 0
  v_mov_b32 v185, 0
  v_mov_b32 v169, 0
  v_mov_b32 v186, 0
  v_mov_b32 v170, 0
  v_mov_b32 v187, 0
  v_mov_b32 v171, 0
  v_mov_b32 v188, 0
  v_mov_b32 v172, 0
  v_mov_b32 v189, 0
  v_mov_b32 v173, 0
  v_mov_b32 v190, 0
  v_mov_b32 v174, 0
  v_mov_b32 v191, 0
  v_mov_b32 v175, 0
  v_mov_b32 v124, 0
  v_mov_b32 v125, 0
  v_mov_b32 v126, 0
  v_mov_b32 v127, 0
  v_mov_b32 v13, 0
  v_mov_b32 v14, 0
  v_mov_b32 v15, 0
  s_mul_i32 s3, s57, 4608
  s_add_u32 s3, s3, 44544
  v_lshl_add_u32 v2, v0, 3, s3
  ds_write_b64 v2, v[184:185] offset:0
  ds_write_b64 v2, v[184:185] offset:512
  ds_write_b64 v2, v[184:185] offset:1024
  ds_write_b64 v2, v[184:185] offset:1536
  ds_write_b64 v2, v[184:185] offset:2048
  ds_write_b64 v2, v[184:185] offset:2560
  ds_write_b64 v2, v[184:185] offset:3072
  ds_write_b64 v2, v[184:185] offset:3584
  ds_write_b64 v2, v[184:185] offset:4096
  s_waitcnt vmcnt(0)
  ds_read_b128 v[200:203], v241
  ds_read_b128 v[204:207], v242
  ds_read_b128 v[208:211], v243
  ds_read_b128 v[212:215], v244
  v_add_u32_sdwa v253, v245, v232 dst_sel:DWORD dst_unused:UNUSED_PAD src0_sel:DWORD src1_sel:BYTE_3
  ds_read_b64 v[234:235], v253 offset:480
  ds_read_b32 v236, v253 offset:736
  v_lshlrev_b32 v125, 4, v232
  v_alignbit_b32 v126, v229, v228, v125
  v_lshrrev_b32 v127, v125, v229
  ds_read_b64 v[176:177], v253 offset:192
  ds_read_b64 v[178:179], v253 offset:128
  ds_read_b64 v[180:181], v253 offset:64
  ds_read_b32 v182, v253
  v_mfma_f32_32x32x16_bf16 v[128:143], v[48:51], v[216:219], 0
  v_mfma_f32_32x32x16_bf16 v[144:159], v[52:55], v[216:219], 0
  v_lshlrev_b32 v125, 16, v126
  v_and_b32 v126, s65, v126
  v_lshlrev_b32 v127, 16, v127
  s_waitcnt lgkmcnt(5)
  v_sub_f32 v234, v234, v125
  v_sub_f32 v235, v235, v126
  s_waitcnt lgkmcnt(4)
  v_sub_f32 v236, v236, v127
  v_cvt_pk_bf16_f32 v234, v234, v235
  v_cvt_pk_bf16_f32 v236, v236, v236
  v_lshlrev_b32 v10, 16, v234
  v_and_b32 v11, s65, v234
  v_lshlrev_b32 v12, 16, v236
  v_mul_f32 v234, v10, v10
  v_fmac_f32 v234, v11, v11
  v_fmac_f32 v234, v12, v12
  v_cvt_pk_f16_f32 v183, v234, v234
  v_mfma_f32_32x32x16_bf16 v[128:143], v[16:19], v[200:203], v[128:143]
  v_mfma_f32_32x32x16_bf16 v[128:143], v[20:23], v[204:207], v[128:143]
  v_mfma_f32_32x32x16_bf16 v[128:143], v[24:27], v[208:211], v[128:143]
  v_mfma_f32_32x32x16_bf16 v[128:143], v[28:31], v[212:215], v[128:143]
  s_waitcnt lgkmcnt(2)
  v_mfma_f32_32x32x16_f16 v[128:143], v[56:59], v[176:179], v[128:143]
  s_waitcnt lgkmcnt(0)
  v_mfma_f32_32x32x16_f16 v[128:143], v[60:63], v[180:183], v[128:143]
  s_cmp_gt_i32 s59, 0
  s_cselect_b32 s6, 6400000, 0
  s_cselect_b32 s10, 25600000, 0
  s_cselect_b32 s14, 300000, 0
  v_mad_u32_u24 v1, v1, 32, v254
  buffer_load_dwordx4 v[220:223], v1, s[8:11], 0 offen
  s_add_u32 m0, s66, 0
  v_mad_u32_u24 v224, v224, s64, v237
  buffer_load_dwordx4 v224, s[4:7], 0 offen  lds
  s_add_u32 m0, s66, 1024
  v_mad_u32_u24 v225, v225, s64, v238
  buffer_load_dwordx4 v225, s[4:7], 0 offen  lds
  s_add_u32 m0, s66, 2048
  v_mad_u32_u24 v226, v226, s64, v239
  buffer_load_dwordx4 v226, s[4:7], 0 offen  lds
  s_add_u32 m0, s66, 3072
  v_mad_u32_u24 v227, v227, s64, v240
  buffer_load_dwordx4 v227, s[4:7], 0 offen  lds
  v_mul_u32_u24 v1, 6, v233
  v_and_b32 v1, -4, v1
  s_mov_b64 exec, s[74:75]
  buffer_load_dwordx2 v[230:231], v1, s[12:15], 0 offen
  s_mov_b64 exec, -1
  s_waitcnt lgkmcnt(0)
  s_cmp_eq_u32 s59, 0
  s_cbranch_scc1 LOOPEND
  s_cmp_ge_u32 s57, 4
  s_movk_i32 s79, 0
  s_cmovk_i32 s79, 0
LOOP:
  ds_read_b64_tr_b16 v[192:193], v248 offset:64
  ds_read_b64_tr_b16 v[194:195], v248 offset:208
  ds_read_b64_tr_b16 v[196:197], v248 offset:352
  ds_read_b64_tr_b16 v[198:199], v248 offset:496
  v_cvt_pk_f16_f32 v160, v128, v129
  v_cvt_pk_f16_f32 v161, v130, v131
  v_cvt_pk_f16_f32 v162, v132, v133
  v_cvt_pk_f16_f32 v163, v134, v135
  v_cvt_pk_f16_f32 v164, v136, v137
  v_cvt_pk_f16_f32 v165, v138, v139
  v_cvt_pk_f16_f32 v166, v140, v141
  v_cvt_pk_f16_f32 v167, v142, v143
  v_mfma_f32_16x16x32_f16 v[124:127], v[80:83], v[168:171], v[124:127]
  v_exp_f16_sdwa v2, v160 dst_sel:WORD_0 dst_unused:UNUSED_PAD src0_sel:WORD_0
  s_mov_b64 exec, 1
  ds_add_rtn_u32 v255, v0, v238 offset:35336
  s_mov_b64 exec, -1
  v_exp_f16_sdwa v3, v161 dst_sel:WORD_0 dst_unused:UNUSED_PAD src0_sel:WORD_0
  v_mfma_f32_16x16x32_f16 v[124:127], v[84:87], v[172:175], v[124:127]
  v_exp_f16_sdwa v4, v162 dst_sel:WORD_0 dst_unused:UNUSED_PAD src0_sel:WORD_0
  v_exp_f16_sdwa v5, v163 dst_sel:WORD_0 dst_unused:UNUSED_PAD src0_sel:WORD_0
  v_mfma_f32_32x32x16_bf16 v[144:159], v[32:35], v[200:203], v[144:159]
  v_exp_f16_sdwa v2, v160 dst_sel:WORD_1 dst_unused:UNUSED_PRESERVE src0_sel:WORD_1
  v_exp_f16_sdwa v3, v161 dst_sel:WORD_1 dst_unused:UNUSED_PRESERVE src0_sel:WORD_1
  v_exp_f16_sdwa v4, v162 dst_sel:WORD_1 dst_unused:UNUSED_PRESERVE src0_sel:WORD_1
  s_waitcnt lgkmcnt(3)
  v_mfma_f32_32x32x16_f16 v[104:119], v[192:195], v[184:187], v[104:119]
  v_exp_f16_sdwa v5, v163 dst_sel:WORD_1 dst_unused:UNUSED_PRESERVE src0_sel:WORD_1
  v_pk_add_f16 v2, v2, 1.0 op_sel_hi:[1,0]
  v_pk_add_f16 v3, v3, 1.0 op_sel_hi:[1,0]
  v_pk_add_f16 v4, v4, 1.0 op_sel_hi:[1,0]
  v_pk_add_f16 v5, v5, 1.0 op_sel_hi:[1,0]
  v_mul_f32 v234, v13, v124
  v_mul_f32 v235, v14, v124
  v_mul_f32 v236, v15, v124
  v_cvt_pk_f16_f32 v234, v234, v235
  v_cvt_pk_f16_f32 v235, v236, v236
  s_mov_b64 exec, s[74:75]
  ds_write_b64 v246, v[234:235] offset:128
  s_mov_b64 exec, -1
  v_rcp_f16_sdwa v6, v2 dst_sel:WORD_0 dst_unused:UNUSED_PAD src0_sel:WORD_0
  v_rcp_f16_sdwa v7, v3 dst_sel:WORD_0 dst_unused:UNUSED_PAD src0_sel:WORD_0
  s_waitcnt lgkmcnt(2)
  v_mfma_f32_32x32x16_f16 v[104:119], v[196:199], v[188:191], v[104:119]
  ds_read_b64_tr_b16 v[192:193], v249 offset:0
  ds_read_b64_tr_b16 v[194:195], v249 offset:144
  ds_read_b64_tr_b16 v[196:197], v249 offset:288
  ds_read_b64_tr_b16 v[198:199], v249 offset:432
  v_rcp_f16_sdwa v8, v4 dst_sel:WORD_0 dst_unused:UNUSED_PAD src0_sel:WORD_0
  s_waitcnt lgkmcnt(5)
  v_readfirstlane_b32 s68, v255
  s_setprio 1
  s_cmp_lt_i32 s68, s79
  s_cbranch_scc0 PRI0
  s_setprio 0
PRI0:
  s_add_u32 s79, s79, 128
  v_rcp_f16_sdwa v9, v5 dst_sel:WORD_0 dst_unused:UNUSED_PAD src0_sel:WORD_0
  v_rcp_f16_sdwa v6, v2 dst_sel:WORD_1 dst_unused:UNUSED_PRESERVE src0_sel:WORD_1
  v_mfma_f32_32x32x16_bf16 v[144:159], v[36:39], v[204:207], v[144:159]
  v_rcp_f16_sdwa v7, v3 dst_sel:WORD_1 dst_unused:UNUSED_PRESERVE src0_sel:WORD_1
  v_rcp_f16_sdwa v8, v4 dst_sel:WORD_1 dst_unused:UNUSED_PRESERVE src0_sel:WORD_1
  v_rcp_f16_sdwa v9, v5 dst_sel:WORD_1 dst_unused:UNUSED_PRESERVE src0_sel:WORD_1
  v_pk_mul_f16 v160, v160, v6
  v_pk_mul_f16 v161, v161, v7
  v_pk_mul_f16 v162, v162, v8
  v_pk_mul_f16 v163, v163, v9
  ds_write_b128 v246, v[160:163] offset:0
  v_mfma_f32_32x32x16_bf16 v[144:159], v[40:43], v[208:211], v[144:159]
  v_exp_f16_sdwa v2, v164 dst_sel:WORD_0 dst_unused:UNUSED_PAD src0_sel:WORD_0
  v_exp_f16_sdwa v3, v165 dst_sel:WORD_0 dst_unused:UNUSED_PAD src0_sel:WORD_0
  v_exp_f16_sdwa v4, v166 dst_sel:WORD_0 dst_unused:UNUSED_PAD src0_sel:WORD_0
  v_mfma_f32_32x32x16_bf16 v[144:159], v[44:47], v[212:215], v[144:159]
  v_exp_f16_sdwa v5, v167 dst_sel:WORD_0 dst_unused:UNUSED_PAD src0_sel:WORD_0
  v_exp_f16_sdwa v2, v164 dst_sel:WORD_1 dst_unused:UNUSED_PRESERVE src0_sel:WORD_1
  v_exp_f16_sdwa v3, v165 dst_sel:WORD_1 dst_unused:UNUSED_PRESERVE src0_sel:WORD_1
  v_mfma_f32_32x32x16_f16 v[144:159], v[64:67], v[176:179], v[144:159]
  v_exp_f16_sdwa v4, v166 dst_sel:WORD_1 dst_unused:UNUSED_PRESERVE src0_sel:WORD_1
  v_exp_f16_sdwa v5, v167 dst_sel:WORD_1 dst_unused:UNUSED_PRESERVE src0_sel:WORD_1
  v_pk_add_f16 v2, v2, 1.0 op_sel_hi:[1,0]
  v_pk_add_f16 v3, v3, 1.0 op_sel_hi:[1,0]
  v_pk_add_f16 v4, v4, 1.0 op_sel_hi:[1,0]
  v_pk_add_f16 v5, v5, 1.0 op_sel_hi:[1,0]
  v_rcp_f16_sdwa v6, v2 dst_sel:WORD_0 dst_unused:UNUSED_PAD src0_sel:WORD_0
  v_mfma_f32_32x32x16_f16 v[144:159], v[68:71], v[180:183], v[144:159]
  v_rcp_f16_sdwa v7, v3 dst_sel:WORD_0 dst_unused:UNUSED_PAD src0_sel:WORD_0
  s_waitcnt vmcnt(0)
  ds_read_b128 v[200:203], v241
  ds_read_b128 v[204:207], v242
  v_rcp_f16_sdwa v8, v4 dst_sel:WORD_0 dst_unused:UNUSED_PAD src0_sel:WORD_0
  ds_read_b128 v[224:227], v250 offset:256
  ds_read_b32 v232, v251 offset:256
  ds_read_b32 v1, v251 offset:17664
  v_rcp_f16_sdwa v9, v5 dst_sel:WORD_0 dst_unused:UNUSED_PAD src0_sel:WORD_0
  s_waitcnt lgkmcnt(8)
  v_mfma_f32_16x16x32_f16 v[120:123], v[192:195], v[184:187], v[120:123]
  ds_read_b128 v[208:211], v243
  ds_read_b128 v[212:215], v244
  v_rcp_f16_sdwa v6, v2 dst_sel:WORD_1 dst_unused:UNUSED_PRESERVE src0_sel:WORD_1
  v_add_u32_sdwa v253, v245, v233 dst_sel:DWORD dst_unused:UNUSED_PAD src0_sel:DWORD src1_sel:BYTE_3
  ds_read_b64 v[234:235], v253 offset:480
  ds_read_b32 v236, v253 offset:736
  v_lshlrev_b32 v125, 4, v233
  v_alignbit_b32 v126, v231, v230, v125
  v_lshrrev_b32 v127, v125, v231
  v_rcp_f16_sdwa v7, v3 dst_sel:WORD_1 dst_unused:UNUSED_PRESERVE src0_sel:WORD_1
  s_waitcnt lgkmcnt(10)
  v_mfma_f32_16x16x32_f16 v[120:123], v[196:199], v[188:191], v[120:123]
  ds_read_b128 v[184:187], v252 offset:0
  ds_read_b64 v[176:177], v253 offset:192
  ds_read_b64 v[178:179], v253 offset:128
  ds_read_b64 v[180:181], v253 offset:64
  ds_read_b32 v182, v253
  v_rcp_f16_sdwa v8, v4 dst_sel:WORD_1 dst_unused:UNUSED_PRESERVE src0_sel:WORD_1
  v_rcp_f16_sdwa v9, v5 dst_sel:WORD_1 dst_unused:UNUSED_PRESERVE src0_sel:WORD_1
  v_pk_mul_f16 v164, v164, v6
  v_pk_mul_f16 v165, v165, v7
  v_pk_mul_f16 v166, v166, v8
  v_pk_mul_f16 v167, v167, v9
  ds_write_b128 v246, v[164:167] offset:16
  ds_read_b64_tr_b16 v[192:193], v248 offset:0
  ds_read_b64_tr_b16 v[194:195], v248 offset:144
  ds_read_b64_tr_b16 v[196:197], v248 offset:288
  ds_read_b64_tr_b16 v[198:199], v248 offset:432
  v_cvt_pk_f16_f32 v168, v144, v145
  v_cvt_pk_f16_f32 v169, v146, v147
  v_cvt_pk_f16_f32 v170, v148, v149
  v_cvt_pk_f16_f32 v171, v150, v151
  v_cvt_pk_f16_f32 v172, v152, v153
  v_cvt_pk_f16_f32 v173, v154, v155
  v_cvt_pk_f16_f32 v174, v156, v157
  v_cvt_pk_f16_f32 v175, v158, v159
  v_mfma_f32_32x32x16_bf16 v[128:143], v[48:51], v[220:223], 0
  v_exp_f16_sdwa v2, v168 dst_sel:WORD_0 dst_unused:UNUSED_PAD src0_sel:WORD_0
  v_exp_f16_sdwa v3, v169 dst_sel:WORD_0 dst_unused:UNUSED_PAD src0_sel:WORD_0
  v_exp_f16_sdwa v4, v170 dst_sel:WORD_0 dst_unused:UNUSED_PAD src0_sel:WORD_0
  v_mfma_f32_32x32x16_bf16 v[144:159], v[52:55], v[220:223], 0
  v_lshlrev_b32 v125, 16, v126
  v_and_b32 v126, s65, v126
  v_lshlrev_b32 v127, 16, v127
  s_cmp_gt_i32 s59, 1
  s_cselect_b32 s6, 6400000, 0
  s_cselect_b32 s10, 25600000, 0
  s_cselect_b32 s14, 300000, 0
  s_waitcnt lgkmcnt(14)
  v_mad_u32_u24 v1, v1, 32, v254
  buffer_load_dwordx4 v[216:219], v1, s[8:11], 0 offen
  v_exp_f16_sdwa v5, v171 dst_sel:WORD_0 dst_unused:UNUSED_PAD src0_sel:WORD_0
  v_exp_f16_sdwa v2, v168 dst_sel:WORD_1 dst_unused:UNUSED_PRESERVE src0_sel:WORD_1
  v_mfma_f32_32x32x16_bf16 v[128:143], v[16:19], v[200:203], v[128:143]
  s_add_u32 m0, s66, 0
  v_mad_u32_u24 v224, v224, s64, v237
  s_waitcnt lgkmcnt(12)
  buffer_load_dwordx4 v224, s[4:7], 0 offen  lds
  v_exp_f16_sdwa v3, v169 dst_sel:WORD_1 dst_unused:UNUSED_PRESERVE src0_sel:WORD_1
  v_exp_f16_sdwa v4, v170 dst_sel:WORD_1 dst_unused:UNUSED_PRESERVE src0_sel:WORD_1
  s_waitcnt lgkmcnt(9)
  v_add_u32_sdwa v184, v247, v184 dst_sel:DWORD dst_unused:UNUSED_PAD src0_sel:DWORD src1_sel:BYTE_3
  v_add_u32_sdwa v185, v247, v185 dst_sel:DWORD dst_unused:UNUSED_PAD src0_sel:DWORD src1_sel:BYTE_3
  v_add_u32_sdwa v186, v247, v186 dst_sel:DWORD dst_unused:UNUSED_PAD src0_sel:DWORD src1_sel:BYTE_3
  v_add_u32_sdwa v187, v247, v187 dst_sel:DWORD dst_unused:UNUSED_PAD src0_sel:DWORD src1_sel:BYTE_3
  ds_read_b64_tr_b16 v[190:191], v187
  ds_read_b64_tr_b16 v[188:189], v186
  ds_read_b64_tr_b16 v[186:187], v185
  ds_read_b64_tr_b16 v[184:185], v184
  v_exp_f16_sdwa v5, v171 dst_sel:WORD_1 dst_unused:UNUSED_PRESERVE src0_sel:WORD_1
  v_pk_add_f16 v2, v2, 1.0 op_sel_hi:[1,0]
  v_pk_add_f16 v3, v3, 1.0 op_sel_hi:[1,0]
  v_pk_add_f16 v4, v4, 1.0 op_sel_hi:[1,0]
  v_pk_add_f16 v5, v5, 1.0 op_sel_hi:[1,0]
  v_mfma_f32_32x32x16_bf16 v[128:143], v[20:23], v[204:207], v[128:143]
  v_sub_f32 v234, v234, v125
  v_sub_f32 v235, v235, v126
  v_sub_f32 v236, v236, v127
  v_cvt_pk_bf16_f32 v234, v234, v235
  v_cvt_pk_bf16_f32 v236, v236, v236
  v_lshlrev_b32 v13, 16, v234
  v_and_b32 v14, s65, v234
  v_lshlrev_b32 v15, 16, v236
  s_add_u32 m0, s66, 1024
  v_mad_u32_u24 v225, v225, s64, v238
  buffer_load_dwordx4 v225, s[4:7], 0 offen  lds
  v_rcp_f16_sdwa v6, v2 dst_sel:WORD_0 dst_unused:UNUSED_PAD src0_sel:WORD_0
  v_rcp_f16_sdwa v7, v3 dst_sel:WORD_0 dst_unused:UNUSED_PAD src0_sel:WORD_0
  v_rcp_f16_sdwa v8, v4 dst_sel:WORD_0 dst_unused:UNUSED_PAD src0_sel:WORD_0
  v_mfma_f32_32x32x16_bf16 v[128:143], v[24:27], v[208:211], v[128:143]
  s_add_u32 m0, s66, 2048
  v_mad_u32_u24 v226, v226, s64, v239
  buffer_load_dwordx4 v226, s[4:7], 0 offen  lds
  v_rcp_f16_sdwa v9, v5 dst_sel:WORD_0 dst_unused:UNUSED_PAD src0_sel:WORD_0
  v_rcp_f16_sdwa v6, v2 dst_sel:WORD_1 dst_unused:UNUSED_PRESERVE src0_sel:WORD_1
  v_mfma_f32_32x32x16_bf16 v[128:143], v[28:31], v[212:215], v[128:143]
  s_add_u32 m0, s66, 3072
  v_mad_u32_u24 v227, v227, s64, v240
  buffer_load_dwordx4 v227, s[4:7], 0 offen  lds
  v_rcp_f16_sdwa v7, v3 dst_sel:WORD_1 dst_unused:UNUSED_PRESERVE src0_sel:WORD_1
  v_rcp_f16_sdwa v8, v4 dst_sel:WORD_1 dst_unused:UNUSED_PRESERVE src0_sel:WORD_1
  v_mul_f32 v234, v13, v13
  v_fmac_f32 v234, v14, v14
  v_fmac_f32 v234, v15, v15
  v_cvt_pk_f16_f32 v183, v234, v234
  v_rcp_f16_sdwa v9, v5 dst_sel:WORD_1 dst_unused:UNUSED_PRESERVE src0_sel:WORD_1
  v_pk_mul_f16 v168, v168, v6
  v_pk_mul_f16 v169, v169, v7
  v_pk_mul_f16 v170, v170, v8
  v_pk_mul_f16 v171, v171, v9
  ds_write_b128 v246, v[168:171] offset:64
  v_mfma_f32_16x16x32_f16 v[124:127], v[72:75], v[160:163], 0
  v_exp_f16_sdwa v2, v172 dst_sel:WORD_0 dst_unused:UNUSED_PAD src0_sel:WORD_0
  v_mul_u32_u24 v1, 6, v232
  v_and_b32 v1, -4, v1
  s_mov_b64 exec, s[74:75]
  buffer_load_dwordx2 v[228:229], v1, s[12:15], 0 offen
  s_mov_b64 exec, -1
  v_exp_f16_sdwa v3, v173 dst_sel:WORD_0 dst_unused:UNUSED_PAD src0_sel:WORD_0
  v_mfma_f32_16x16x32_f16 v[124:127], v[76:79], v[164:167], v[124:127]
  v_exp_f16_sdwa v4, v174 dst_sel:WORD_0 dst_unused:UNUSED_PAD src0_sel:WORD_0
  v_exp_f16_sdwa v5, v175 dst_sel:WORD_0 dst_unused:UNUSED_PAD src0_sel:WORD_0
  s_waitcnt lgkmcnt(12)
  v_mfma_f32_32x32x16_f16 v[128:143], v[56:59], v[176:179], v[128:143]
  v_exp_f16_sdwa v2, v172 dst_sel:WORD_1 dst_unused:UNUSED_PRESERVE src0_sel:WORD_1
  v_exp_f16_sdwa v3, v173 dst_sel:WORD_1 dst_unused:UNUSED_PRESERVE src0_sel:WORD_1
  v_exp_f16_sdwa v4, v174 dst_sel:WORD_1 dst_unused:UNUSED_PRESERVE src0_sel:WORD_1
  s_waitcnt lgkmcnt(10)
  v_mfma_f32_32x32x16_f16 v[128:143], v[60:63], v[180:183], v[128:143]
  v_exp_f16_sdwa v5, v175 dst_sel:WORD_1 dst_unused:UNUSED_PRESERVE src0_sel:WORD_1
  v_pk_add_f16 v2, v2, 1.0 op_sel_hi:[1,0]
  v_pk_add_f16 v3, v3, 1.0 op_sel_hi:[1,0]
  v_pk_add_f16 v4, v4, 1.0 op_sel_hi:[1,0]
  v_pk_add_f16 v5, v5, 1.0 op_sel_hi:[1,0]
  v_rcp_f16_sdwa v6, v2 dst_sel:WORD_0 dst_unused:UNUSED_PAD src0_sel:WORD_0
  v_rcp_f16_sdwa v7, v3 dst_sel:WORD_0 dst_unused:UNUSED_PAD src0_sel:WORD_0
  s_waitcnt lgkmcnt(1)
  v_mfma_f32_32x32x16_f16 v[88:103], v[192:195], v[184:187], v[88:103]
  v_rcp_f16_sdwa v8, v4 dst_sel:WORD_0 dst_unused:UNUSED_PAD src0_sel:WORD_0
  v_rcp_f16_sdwa v9, v5 dst_sel:WORD_0 dst_unused:UNUSED_PAD src0_sel:WORD_0
  v_rcp_f16_sdwa v6, v2 dst_sel:WORD_1 dst_unused:UNUSED_PRESERVE src0_sel:WORD_1
  v_mfma_f32_32x32x16_f16 v[88:103], v[196:199], v[188:191], v[88:103]
  v_rcp_f16_sdwa v7, v3 dst_sel:WORD_1 dst_unused:UNUSED_PRESERVE src0_sel:WORD_1
  v_rcp_f16_sdwa v8, v4 dst_sel:WORD_1 dst_unused:UNUSED_PRESERVE src0_sel:WORD_1
  v_rcp_f16_sdwa v9, v5 dst_sel:WORD_1 dst_unused:UNUSED_PRESERVE src0_sel:WORD_1
  v_pk_mul_f16 v172, v172, v6
  v_pk_mul_f16 v173, v173, v7
  v_pk_mul_f16 v174, v174, v8
  v_pk_mul_f16 v175, v175, v9
  ds_write_b128 v246, v[172:175] offset:80
  s_sub_u32 s59, s59, 1
  s_cmp_eq_u32 s59, 0
  s_cbranch_scc1 TAIL0
  ds_read_b64_tr_b16 v[192:193], v248 offset:64
  ds_read_b64_tr_b16 v[194:195], v248 offset:208
  ds_read_b64_tr_b16 v[196:197], v248 offset:352
  ds_read_b64_tr_b16 v[198:199], v248 offset:496
  v_cvt_pk_f16_f32 v160, v128, v129
  v_cvt_pk_f16_f32 v161, v130, v131
  v_cvt_pk_f16_f32 v162, v132, v133
  v_cvt_pk_f16_f32 v163, v134, v135
  v_cvt_pk_f16_f32 v164, v136, v137
  v_cvt_pk_f16_f32 v165, v138, v139
  v_cvt_pk_f16_f32 v166, v140, v141
  v_cvt_pk_f16_f32 v167, v142, v143
  v_mfma_f32_16x16x32_f16 v[124:127], v[80:83], v[168:171], v[124:127]
  v_exp_f16_sdwa v2, v160 dst_sel:WORD_0 dst_unused:UNUSED_PAD src0_sel:WORD_0
  s_mov_b64 exec, 1
  ds_add_rtn_u32 v255, v0, v238 offset:35336
  s_mov_b64 exec, -1
  v_exp_f16_sdwa v3, v161 dst_sel:WORD_0 dst_unused:UNUSED_PAD src0_sel:WORD_0
  v_mfma_f32_16x16x32_f16 v[124:127], v[84:87], v[172:175], v[124:127]
  v_exp_f16_sdwa v4, v162 dst_sel:WORD_0 dst_unused:UNUSED_PAD src0_sel:WORD_0
  v_exp_f16_sdwa v5, v163 dst_sel:WORD_0 dst_unused:UNUSED_PAD src0_sel:WORD_0
  v_mfma_f32_32x32x16_bf16 v[144:159], v[32:35], v[200:203], v[144:159]
  v_exp_f16_sdwa v2, v160 dst_sel:WORD_1 dst_unused:UNUSED_PRESERVE src0_sel:WORD_1
  v_exp_f16_sdwa v3, v161 dst_sel:WORD_1 dst_unused:UNUSED_PRESERVE src0_sel:WORD_1
  v_exp_f16_sdwa v4, v162 dst_sel:WORD_1 dst_unused:UNUSED_PRESERVE src0_sel:WORD_1
  s_waitcnt lgkmcnt(3)
  v_mfma_f32_32x32x16_f16 v[104:119], v[192:195], v[184:187], v[104:119]
  v_exp_f16_sdwa v5, v163 dst_sel:WORD_1 dst_unused:UNUSED_PRESERVE src0_sel:WORD_1
  v_pk_add_f16 v2, v2, 1.0 op_sel_hi:[1,0]
  v_pk_add_f16 v3, v3, 1.0 op_sel_hi:[1,0]
  v_pk_add_f16 v4, v4, 1.0 op_sel_hi:[1,0]
  v_pk_add_f16 v5, v5, 1.0 op_sel_hi:[1,0]
  v_mul_f32 v234, v10, v124
  v_mul_f32 v235, v11, v124
  v_mul_f32 v236, v12, v124
  v_cvt_pk_f16_f32 v234, v234, v235
  v_cvt_pk_f16_f32 v235, v236, v236
  s_mov_b64 exec, s[74:75]
  ds_write_b64 v246, v[234:235] offset:128
  s_mov_b64 exec, -1
  v_rcp_f16_sdwa v6, v2 dst_sel:WORD_0 dst_unused:UNUSED_PAD src0_sel:WORD_0
  v_rcp_f16_sdwa v7, v3 dst_sel:WORD_0 dst_unused:UNUSED_PAD src0_sel:WORD_0
  s_waitcnt lgkmcnt(2)
  v_mfma_f32_32x32x16_f16 v[104:119], v[196:199], v[188:191], v[104:119]
  ds_read_b64_tr_b16 v[192:193], v249 offset:0
  ds_read_b64_tr_b16 v[194:195], v249 offset:144
  ds_read_b64_tr_b16 v[196:197], v249 offset:288
  ds_read_b64_tr_b16 v[198:199], v249 offset:432
  v_rcp_f16_sdwa v8, v4 dst_sel:WORD_0 dst_unused:UNUSED_PAD src0_sel:WORD_0
  s_waitcnt lgkmcnt(5)
  v_readfirstlane_b32 s68, v255
  s_setprio 1
  s_cmp_lt_i32 s68, s79
  s_cbranch_scc0 PRI1
  s_setprio 0
PRI1:
  s_add_u32 s79, s79, 128
  v_rcp_f16_sdwa v9, v5 dst_sel:WORD_0 dst_unused:UNUSED_PAD src0_sel:WORD_0
  v_rcp_f16_sdwa v6, v2 dst_sel:WORD_1 dst_unused:UNUSED_PRESERVE src0_sel:WORD_1
  v_mfma_f32_32x32x16_bf16 v[144:159], v[36:39], v[204:207], v[144:159]
  v_rcp_f16_sdwa v7, v3 dst_sel:WORD_1 dst_unused:UNUSED_PRESERVE src0_sel:WORD_1
  v_rcp_f16_sdwa v8, v4 dst_sel:WORD_1 dst_unused:UNUSED_PRESERVE src0_sel:WORD_1
  v_rcp_f16_sdwa v9, v5 dst_sel:WORD_1 dst_unused:UNUSED_PRESERVE src0_sel:WORD_1
  v_pk_mul_f16 v160, v160, v6
  v_pk_mul_f16 v161, v161, v7
  v_pk_mul_f16 v162, v162, v8
  v_pk_mul_f16 v163, v163, v9
  ds_write_b128 v246, v[160:163] offset:0
  v_mfma_f32_32x32x16_bf16 v[144:159], v[40:43], v[208:211], v[144:159]
  v_exp_f16_sdwa v2, v164 dst_sel:WORD_0 dst_unused:UNUSED_PAD src0_sel:WORD_0
  v_exp_f16_sdwa v3, v165 dst_sel:WORD_0 dst_unused:UNUSED_PAD src0_sel:WORD_0
  v_exp_f16_sdwa v4, v166 dst_sel:WORD_0 dst_unused:UNUSED_PAD src0_sel:WORD_0
  v_mfma_f32_32x32x16_bf16 v[144:159], v[44:47], v[212:215], v[144:159]
  v_exp_f16_sdwa v5, v167 dst_sel:WORD_0 dst_unused:UNUSED_PAD src0_sel:WORD_0
  v_exp_f16_sdwa v2, v164 dst_sel:WORD_1 dst_unused:UNUSED_PRESERVE src0_sel:WORD_1
  v_exp_f16_sdwa v3, v165 dst_sel:WORD_1 dst_unused:UNUSED_PRESERVE src0_sel:WORD_1
  v_mfma_f32_32x32x16_f16 v[144:159], v[64:67], v[176:179], v[144:159]
  v_exp_f16_sdwa v4, v166 dst_sel:WORD_1 dst_unused:UNUSED_PRESERVE src0_sel:WORD_1
  v_exp_f16_sdwa v5, v167 dst_sel:WORD_1 dst_unused:UNUSED_PRESERVE src0_sel:WORD_1
  v_pk_add_f16 v2, v2, 1.0 op_sel_hi:[1,0]
  v_pk_add_f16 v3, v3, 1.0 op_sel_hi:[1,0]
  v_pk_add_f16 v4, v4, 1.0 op_sel_hi:[1,0]
  v_pk_add_f16 v5, v5, 1.0 op_sel_hi:[1,0]
  v_rcp_f16_sdwa v6, v2 dst_sel:WORD_0 dst_unused:UNUSED_PAD src0_sel:WORD_0
  v_mfma_f32_32x32x16_f16 v[144:159], v[68:71], v[180:183], v[144:159]
  v_rcp_f16_sdwa v7, v3 dst_sel:WORD_0 dst_unused:UNUSED_PAD src0_sel:WORD_0
  s_waitcnt vmcnt(0)
  ds_read_b128 v[200:203], v241
  ds_read_b128 v[204:207], v242
  v_rcp_f16_sdwa v8, v4 dst_sel:WORD_0 dst_unused:UNUSED_PAD src0_sel:WORD_0
  ds_read_b128 v[224:227], v250 offset:384
  ds_read_b32 v233, v251 offset:384
  ds_read_b32 v1, v251 offset:17792
  v_rcp_f16_sdwa v9, v5 dst_sel:WORD_0 dst_unused:UNUSED_PAD src0_sel:WORD_0
  s_waitcnt lgkmcnt(8)
  v_mfma_f32_16x16x32_f16 v[120:123], v[192:195], v[184:187], v[120:123]
  ds_read_b128 v[208:211], v243
  ds_read_b128 v[212:215], v244
  v_rcp_f16_sdwa v6, v2 dst_sel:WORD_1 dst_unused:UNUSED_PRESERVE src0_sel:WORD_1
  v_add_u32_sdwa v253, v245, v232 dst_sel:DWORD dst_unused:UNUSED_PAD src0_sel:DWORD src1_sel:BYTE_3
  ds_read_b64 v[234:235], v253 offset:480
  ds_read_b32 v236, v253 offset:736
  v_lshlrev_b32 v125, 4, v232
  v_alignbit_b32 v126, v229, v228, v125
  v_lshrrev_b32 v127, v125, v229
  v_rcp_f16_sdwa v7, v3 dst_sel:WORD_1 dst_unused:UNUSED_PRESERVE src0_sel:WORD_1
  s_waitcnt lgkmcnt(10)
  v_mfma_f32_16x16x32_f16 v[120:123], v[196:199], v[188:191], v[120:123]
  ds_read_b128 v[184:187], v252 offset:128
  ds_read_b64 v[176:177], v253 offset:192
  ds_read_b64 v[178:179], v253 offset:128
  ds_read_b64 v[180:181], v253 offset:64
  ds_read_b32 v182, v253
  v_rcp_f16_sdwa v8, v4 dst_sel:WORD_1 dst_unused:UNUSED_PRESERVE src0_sel:WORD_1
  v_rcp_f16_sdwa v9, v5 dst_sel:WORD_1 dst_unused:UNUSED_PRESERVE src0_sel:WORD_1
  v_pk_mul_f16 v164, v164, v6
  v_pk_mul_f16 v165, v165, v7
  v_pk_mul_f16 v166, v166, v8
  v_pk_mul_f16 v167, v167, v9
  ds_write_b128 v246, v[164:167] offset:16
  ds_read_b64_tr_b16 v[192:193], v248 offset:0
  ds_read_b64_tr_b16 v[194:195], v248 offset:144
  ds_read_b64_tr_b16 v[196:197], v248 offset:288
  ds_read_b64_tr_b16 v[198:199], v248 offset:432
  v_cvt_pk_f16_f32 v168, v144, v145
  v_cvt_pk_f16_f32 v169, v146, v147
  v_cvt_pk_f16_f32 v170, v148, v149
  v_cvt_pk_f16_f32 v171, v150, v151
  v_cvt_pk_f16_f32 v172, v152, v153
  v_cvt_pk_f16_f32 v173, v154, v155
  v_cvt_pk_f16_f32 v174, v156, v157
  v_cvt_pk_f16_f32 v175, v158, v159
  v_mfma_f32_32x32x16_bf16 v[128:143], v[48:51], v[216:219], 0
  v_exp_f16_sdwa v2, v168 dst_sel:WORD_0 dst_unused:UNUSED_PAD src0_sel:WORD_0
  v_exp_f16_sdwa v3, v169 dst_sel:WORD_0 dst_unused:UNUSED_PAD src0_sel:WORD_0
  v_exp_f16_sdwa v4, v170 dst_sel:WORD_0 dst_unused:UNUSED_PAD src0_sel:WORD_0
  v_mfma_f32_32x32x16_bf16 v[144:159], v[52:55], v[216:219], 0
  v_lshlrev_b32 v125, 16, v126
  v_and_b32 v126, s65, v126
  v_lshlrev_b32 v127, 16, v127
  s_cmp_gt_i32 s59, 1
  s_cselect_b32 s6, 6400000, 0
  s_cselect_b32 s10, 25600000, 0
  s_cselect_b32 s14, 300000, 0
  s_waitcnt lgkmcnt(14)
  v_mad_u32_u24 v1, v1, 32, v254
  buffer_load_dwordx4 v[220:223], v1, s[8:11], 0 offen
  v_exp_f16_sdwa v5, v171 dst_sel:WORD_0 dst_unused:UNUSED_PAD src0_sel:WORD_0
  v_exp_f16_sdwa v2, v168 dst_sel:WORD_1 dst_unused:UNUSED_PRESERVE src0_sel:WORD_1
  v_mfma_f32_32x32x16_bf16 v[128:143], v[16:19], v[200:203], v[128:143]
  s_add_u32 m0, s66, 0
  v_mad_u32_u24 v224, v224, s64, v237
  s_waitcnt lgkmcnt(12)
  buffer_load_dwordx4 v224, s[4:7], 0 offen  lds
  v_exp_f16_sdwa v3, v169 dst_sel:WORD_1 dst_unused:UNUSED_PRESERVE src0_sel:WORD_1
  v_exp_f16_sdwa v4, v170 dst_sel:WORD_1 dst_unused:UNUSED_PRESERVE src0_sel:WORD_1
  s_waitcnt lgkmcnt(9)
  v_add_u32_sdwa v184, v247, v184 dst_sel:DWORD dst_unused:UNUSED_PAD src0_sel:DWORD src1_sel:BYTE_3
  v_add_u32_sdwa v185, v247, v185 dst_sel:DWORD dst_unused:UNUSED_PAD src0_sel:DWORD src1_sel:BYTE_3
  v_add_u32_sdwa v186, v247, v186 dst_sel:DWORD dst_unused:UNUSED_PAD src0_sel:DWORD src1_sel:BYTE_3
  v_add_u32_sdwa v187, v247, v187 dst_sel:DWORD dst_unused:UNUSED_PAD src0_sel:DWORD src1_sel:BYTE_3
  ds_read_b64_tr_b16 v[190:191], v187
  ds_read_b64_tr_b16 v[188:189], v186
  ds_read_b64_tr_b16 v[186:187], v185
  ds_read_b64_tr_b16 v[184:185], v184
  v_exp_f16_sdwa v5, v171 dst_sel:WORD_1 dst_unused:UNUSED_PRESERVE src0_sel:WORD_1
  v_pk_add_f16 v2, v2, 1.0 op_sel_hi:[1,0]
  v_pk_add_f16 v3, v3, 1.0 op_sel_hi:[1,0]
  v_pk_add_f16 v4, v4, 1.0 op_sel_hi:[1,0]
  v_pk_add_f16 v5, v5, 1.0 op_sel_hi:[1,0]
  v_mfma_f32_32x32x16_bf16 v[128:143], v[20:23], v[204:207], v[128:143]
  v_sub_f32 v234, v234, v125
  v_sub_f32 v235, v235, v126
  v_sub_f32 v236, v236, v127
  v_cvt_pk_bf16_f32 v234, v234, v235
  v_cvt_pk_bf16_f32 v236, v236, v236
  v_lshlrev_b32 v10, 16, v234
  v_and_b32 v11, s65, v234
  v_lshlrev_b32 v12, 16, v236
  s_add_u32 m0, s66, 1024
  v_mad_u32_u24 v225, v225, s64, v238
  buffer_load_dwordx4 v225, s[4:7], 0 offen  lds
  v_rcp_f16_sdwa v6, v2 dst_sel:WORD_0 dst_unused:UNUSED_PAD src0_sel:WORD_0
  v_rcp_f16_sdwa v7, v3 dst_sel:WORD_0 dst_unused:UNUSED_PAD src0_sel:WORD_0
  v_rcp_f16_sdwa v8, v4 dst_sel:WORD_0 dst_unused:UNUSED_PAD src0_sel:WORD_0
  v_mfma_f32_32x32x16_bf16 v[128:143], v[24:27], v[208:211], v[128:143]
  s_add_u32 m0, s66, 2048
  v_mad_u32_u24 v226, v226, s64, v239
  buffer_load_dwordx4 v226, s[4:7], 0 offen  lds
  v_rcp_f16_sdwa v9, v5 dst_sel:WORD_0 dst_unused:UNUSED_PAD src0_sel:WORD_0
  v_rcp_f16_sdwa v6, v2 dst_sel:WORD_1 dst_unused:UNUSED_PRESERVE src0_sel:WORD_1
  v_mfma_f32_32x32x16_bf16 v[128:143], v[28:31], v[212:215], v[128:143]
  s_add_u32 m0, s66, 3072
  v_mad_u32_u24 v227, v227, s64, v240
  buffer_load_dwordx4 v227, s[4:7], 0 offen  lds
  v_rcp_f16_sdwa v7, v3 dst_sel:WORD_1 dst_unused:UNUSED_PRESERVE src0_sel:WORD_1
  v_rcp_f16_sdwa v8, v4 dst_sel:WORD_1 dst_unused:UNUSED_PRESERVE src0_sel:WORD_1
  v_mul_f32 v234, v10, v10
  v_fmac_f32 v234, v11, v11
  v_fmac_f32 v234, v12, v12
  v_cvt_pk_f16_f32 v183, v234, v234
  v_rcp_f16_sdwa v9, v5 dst_sel:WORD_1 dst_unused:UNUSED_PRESERVE src0_sel:WORD_1
  v_pk_mul_f16 v168, v168, v6
  v_pk_mul_f16 v169, v169, v7
  v_pk_mul_f16 v170, v170, v8
  v_pk_mul_f16 v171, v171, v9
  ds_write_b128 v246, v[168:171] offset:64
  v_mfma_f32_16x16x32_f16 v[124:127], v[72:75], v[160:163], 0
  v_exp_f16_sdwa v2, v172 dst_sel:WORD_0 dst_unused:UNUSED_PAD src0_sel:WORD_0
  v_mul_u32_u24 v1, 6, v233
  v_and_b32 v1, -4, v1
  s_mov_b64 exec, s[74:75]
  buffer_load_dwordx2 v[230:231], v1, s[12:15], 0 offen
  s_mov_b64 exec, -1
  v_exp_f16_sdwa v3, v173 dst_sel:WORD_0 dst_unused:UNUSED_PAD src0_sel:WORD_0
  v_mfma_f32_16x16x32_f16 v[124:127], v[76:79], v[164:167], v[124:127]
  v_exp_f16_sdwa v4, v174 dst_sel:WORD_0 dst_unused:UNUSED_PAD src0_sel:WORD_0
  v_exp_f16_sdwa v5, v175 dst_sel:WORD_0 dst_unused:UNUSED_PAD src0_sel:WORD_0
  s_waitcnt lgkmcnt(12)
  v_mfma_f32_32x32x16_f16 v[128:143], v[56:59], v[176:179], v[128:143]
  v_exp_f16_sdwa v2, v172 dst_sel:WORD_1 dst_unused:UNUSED_PRESERVE src0_sel:WORD_1
  v_exp_f16_sdwa v3, v173 dst_sel:WORD_1 dst_unused:UNUSED_PRESERVE src0_sel:WORD_1
  v_exp_f16_sdwa v4, v174 dst_sel:WORD_1 dst_unused:UNUSED_PRESERVE src0_sel:WORD_1
  s_waitcnt lgkmcnt(10)
  v_mfma_f32_32x32x16_f16 v[128:143], v[60:63], v[180:183], v[128:143]
  v_exp_f16_sdwa v5, v175 dst_sel:WORD_1 dst_unused:UNUSED_PRESERVE src0_sel:WORD_1
  v_pk_add_f16 v2, v2, 1.0 op_sel_hi:[1,0]
  v_pk_add_f16 v3, v3, 1.0 op_sel_hi:[1,0]
  v_pk_add_f16 v4, v4, 1.0 op_sel_hi:[1,0]
  v_pk_add_f16 v5, v5, 1.0 op_sel_hi:[1,0]
  v_rcp_f16_sdwa v6, v2 dst_sel:WORD_0 dst_unused:UNUSED_PAD src0_sel:WORD_0
  v_rcp_f16_sdwa v7, v3 dst_sel:WORD_0 dst_unused:UNUSED_PAD src0_sel:WORD_0
  s_waitcnt lgkmcnt(1)
  v_mfma_f32_32x32x16_f16 v[88:103], v[192:195], v[184:187], v[88:103]
  v_rcp_f16_sdwa v8, v4 dst_sel:WORD_0 dst_unused:UNUSED_PAD src0_sel:WORD_0
  v_rcp_f16_sdwa v9, v5 dst_sel:WORD_0 dst_unused:UNUSED_PAD src0_sel:WORD_0
  v_rcp_f16_sdwa v6, v2 dst_sel:WORD_1 dst_unused:UNUSED_PRESERVE src0_sel:WORD_1
  v_mfma_f32_32x32x16_f16 v[88:103], v[196:199], v[188:191], v[88:103]
  v_rcp_f16_sdwa v7, v3 dst_sel:WORD_1 dst_unused:UNUSED_PRESERVE src0_sel:WORD_1
  v_rcp_f16_sdwa v8, v4 dst_sel:WORD_1 dst_unused:UNUSED_PRESERVE src0_sel:WORD_1
  v_rcp_f16_sdwa v9, v5 dst_sel:WORD_1 dst_unused:UNUSED_PRESERVE src0_sel:WORD_1
  v_pk_mul_f16 v172, v172, v6
  v_pk_mul_f16 v173, v173, v7
  v_pk_mul_f16 v174, v174, v8
  v_pk_mul_f16 v175, v175, v9
  ds_write_b128 v246, v[172:175] offset:80
  s_sub_u32 s59, s59, 1
  s_cmp_eq_u32 s59, 0
  v_add_u32 v250, 0x100, v250
  v_add_u32 v251, 0x100, v251
  v_add_u32 v252, 0x100, v252
  s_cbranch_scc0 LOOP
  v_mov_b32 v10, v13
  v_mov_b32 v11, v14
  v_mov_b32 v12, v15
TAIL0:
  s_waitcnt lgkmcnt(0)
  ds_read_b64_tr_b16 v[192:193], v248 offset:64
  ds_read_b64_tr_b16 v[194:195], v248 offset:208
  ds_read_b64_tr_b16 v[196:197], v248 offset:352
  ds_read_b64_tr_b16 v[198:199], v248 offset:496
  v_mfma_f32_16x16x32_f16 v[124:127], v[80:83], v[168:171], v[124:127]
  v_mfma_f32_16x16x32_f16 v[124:127], v[84:87], v[172:175], v[124:127]
  s_waitcnt lgkmcnt(2)
  v_mfma_f32_32x32x16_f16 v[104:119], v[192:195], v[184:187], v[104:119]
  s_waitcnt lgkmcnt(0)
  v_mfma_f32_32x32x16_f16 v[104:119], v[196:199], v[188:191], v[104:119]
  s_nop 3
  v_mul_f32 v234, v10, v124
  v_mul_f32 v235, v11, v124
  v_mul_f32 v236, v12, v124
  v_cvt_pk_f16_f32 v234, v234, v235
  v_cvt_pk_f16_f32 v235, v236, v236
  s_mov_b64 exec, s[74:75]
  ds_write_b64 v246, v[234:235] offset:128
  s_mov_b64 exec, -1
  ds_read_b64_tr_b16 v[192:193], v249 offset:0
  ds_read_b64_tr_b16 v[194:195], v249 offset:144
  ds_read_b64_tr_b16 v[196:197], v249 offset:288
  ds_read_b64_tr_b16 v[198:199], v249 offset:432
  s_waitcnt lgkmcnt(2)
  v_mfma_f32_16x16x32_f16 v[120:123], v[192:195], v[184:187], v[120:123]
  s_waitcnt lgkmcnt(0)
  v_mfma_f32_16x16x32_f16 v[120:123], v[196:199], v[188:191], v[120:123]
LOOPEND:
  s_cmp_eq_u32 s62, 0
  s_cbranch_scc1 EPI
  s_add_u32 s61, s61, s60
  s_min_u32 s60, s60, 32
  s_waitcnt vmcnt(0)
  s_barrier
  s_branch ROUND
EPI:
  v_and_b32 v2, 1, v0
  v_bfe_u32 v3, v0, 1, 1
  v_bfe_u32 v4, v0, 2, 2
  v_bfe_u32 v5, v0, 4, 1
  v_lshlrev_b32 v2, 6, v2
  v_lshl_add_u32 v2, v3, 3, v2
  v_lshl_add_u32 v2, v5, 4, v2
  v_lshrrev_b32 v3, 1, v4
  v_lshl_add_u32 v2, v3, 5, v2
  v_lshl_add_u32 v2, v4, 7, v2
  v_add_u32 v2, 114176, v2
  v_lshl_add_u32 v6, v254, 8, v2
  v_xor_b32 v7, 32, v6
  v_lshl_add_u32 v8, v254, 6, v2
  v_xor_b32 v9, 32, v8
  ds_read_b64_tr_b16 v[16:17], v6 offset:0
  ds_read_b64_tr_b16 v[18:19], v6 offset:512
  ds_read_b64_tr_b16 v[20:21], v6 offset:1024
  ds_read_b64_tr_b16 v[22:23], v6 offset:1536
  ds_read_b64_tr_b16 v[24:25], v6 offset:2048
  ds_read_b64_tr_b16 v[26:27], v6 offset:2560
  ds_read_b64_tr_b16 v[28:29], v6 offset:3072
  ds_read_b64_tr_b16 v[30:31], v6 offset:3584
  ds_read_b64_tr_b16 v[32:33], v8 offset:8192
  ds_read_b64_tr_b16 v[34:35], v8 offset:10240
  ds_read_b64_tr_b16 v[36:37], v8 offset:8704
  ds_read_b64_tr_b16 v[38:39], v8 offset:10752
  ds_read_b64_tr_b16 v[40:41], v8 offset:12288
  ds_read_b64_tr_b16 v[42:43], v8 offset:14336
  ds_read_b64_tr_b16 v[44:45], v8 offset:12800
  ds_read_b64_tr_b16 v[46:47], v8 offset:14848
  s_waitcnt lgkmcnt(0)
  ds_read_b64_tr_b16 v[48:49], v7 offset:0
  ds_read_b64_tr_b16 v[50:51], v7 offset:512
  ds_read_b64_tr_b16 v[52:53], v7 offset:1024
  ds_read_b64_tr_b16 v[54:55], v7 offset:1536
  ds_read_b64_tr_b16 v[56:57], v7 offset:2048
  ds_read_b64_tr_b16 v[58:59], v7 offset:2560
  ds_read_b64_tr_b16 v[60:61], v7 offset:3072
  ds_read_b64_tr_b16 v[62:63], v7 offset:3584
  ds_read_b64_tr_b16 v[64:65], v9 offset:8192
  ds_read_b64_tr_b16 v[66:67], v9 offset:10240
  ds_read_b64_tr_b16 v[68:69], v9 offset:8704
  ds_read_b64_tr_b16 v[70:71], v9 offset:10752
  ds_read_b64_tr_b16 v[72:73], v9 offset:12288
  ds_read_b64_tr_b16 v[74:75], v9 offset:14336
  ds_read_b64_tr_b16 v[76:77], v9 offset:12800
  ds_read_b64_tr_b16 v[78:79], v9 offset:14848
  v_lshl_add_u32 v253, v0, 3, s67
  ds_read_b64 v[224:225], v253 offset:512
  ds_read_b32 v226, v253 offset:768
  s_mov_b32 s68, 0xbf317218
  s_mov_b32 s69, 0xbf317218
  v_pk_mul_f32 v[88:89], v[88:89], s[68:69]
  v_pk_mul_f32 v[90:91], v[90:91], s[68:69]
  v_pk_mul_f32 v[92:93], v[92:93], s[68:69]
  v_pk_mul_f32 v[94:95], v[94:95], s[68:69]
  v_pk_mul_f32 v[96:97], v[96:97], s[68:69]
  v_pk_mul_f32 v[98:99], v[98:99], s[68:69]
  v_pk_mul_f32 v[100:101], v[100:101], s[68:69]
  v_pk_mul_f32 v[102:103], v[102:103], s[68:69]
  v_pk_mul_f32 v[104:105], v[104:105], s[68:69]
  v_pk_mul_f32 v[106:107], v[106:107], s[68:69]
  v_pk_mul_f32 v[108:109], v[108:109], s[68:69]
  v_pk_mul_f32 v[110:111], v[110:111], s[68:69]
  v_pk_mul_f32 v[112:113], v[112:113], s[68:69]
  v_pk_mul_f32 v[114:115], v[114:115], s[68:69]
  v_pk_mul_f32 v[116:117], v[116:117], s[68:69]
  v_pk_mul_f32 v[118:119], v[118:119], s[68:69]
  v_pk_mul_f32 v[120:121], v[120:121], s[68:69]
  v_pk_mul_f32 v[122:123], v[122:123], s[68:69]
  v_cvt_pk_bf16_f32 v160, v88, v89
  v_cvt_pk_bf16_f32 v161, v90, v91
  v_cvt_pk_bf16_f32 v162, v92, v93
  v_cvt_pk_bf16_f32 v163, v94, v95
  v_cvt_pk_bf16_f32 v164, v96, v97
  v_cvt_pk_bf16_f32 v165, v98, v99
  v_cvt_pk_bf16_f32 v166, v100, v101
  v_cvt_pk_bf16_f32 v167, v102, v103
  v_cvt_pk_bf16_f32 v168, v104, v105
  v_cvt_pk_bf16_f32 v169, v106, v107
  v_cvt_pk_bf16_f32 v170, v108, v109
  v_cvt_pk_bf16_f32 v171, v110, v111
  v_cvt_pk_bf16_f32 v172, v112, v113
  v_cvt_pk_bf16_f32 v173, v114, v115
  v_cvt_pk_bf16_f32 v174, v116, v117
  v_cvt_pk_bf16_f32 v175, v118, v119
  v_mfma_f32_32x32x16_bf16 v[128:143], v[16:19], v[200:203], 0
  v_mfma_f32_32x32x16_bf16 v[128:143], v[20:23], v[204:207], v[128:143]
  v_mfma_f32_32x32x16_bf16 v[128:143], v[24:27], v[208:211], v[128:143]
  v_mfma_f32_32x32x16_bf16 v[128:143], v[28:31], v[212:215], v[128:143]
  v_mfma_f32_32x32x16_bf16 v[128:143], v[32:35], v[160:163], v[128:143]
  v_mfma_f32_32x32x16_bf16 v[128:143], v[36:39], v[164:167], v[128:143]
  v_mfma_f32_32x32x16_bf16 v[128:143], v[40:43], v[168:171], v[128:143]
  v_mfma_f32_32x32x16_bf16 v[128:143], v[44:47], v[172:175], v[128:143]
  s_waitcnt lgkmcnt(0)
  v_mfma_f32_32x32x16_bf16 v[144:159], v[48:51], v[200:203], 0
  v_mfma_f32_32x32x16_bf16 v[144:159], v[52:55], v[204:207], v[144:159]
  v_mfma_f32_32x32x16_bf16 v[144:159], v[56:59], v[208:211], v[144:159]
  v_mfma_f32_32x32x16_bf16 v[144:159], v[60:63], v[212:215], v[144:159]
  v_mfma_f32_32x32x16_bf16 v[144:159], v[64:67], v[160:163], v[144:159]
  v_mfma_f32_32x32x16_bf16 v[144:159], v[68:71], v[164:167], v[144:159]
  v_mfma_f32_32x32x16_bf16 v[144:159], v[72:75], v[168:171], v[144:159]
  v_mfma_f32_32x32x16_bf16 v[144:159], v[76:79], v[172:175], v[144:159]
  v_add_f32 v224, v224, v120
  v_add_f32 v225, v225, v121
  v_add_f32 v226, v226, v122
  v_cvt_pk_bf16_f32 v224, v224, v225
  v_cvt_pk_bf16_f32 v226, v226, v226
  v_add_u32 v234, s58, v0
  v_mul_u32_u24 v234, 6, v234
  v_add_u32 v234, 6400000, v234
  s_mov_b32 exec_lo, s78
  s_mov_b32 exec_hi, 0
  buffer_store_short v224, v234, s[28:31], 0 offen
  buffer_store_short_d16_hi v224, v234, s[28:31], 0 offen offset:2
  buffer_store_short v226, v234, s[28:31], 0 offen offset:4
  s_mov_b64 exec, -1
  v_and_b32 v235, 31, v0
  v_add_u32 v235, s58, v235
  v_lshlrev_b32 v235, 7, v235
  v_lshl_add_u32 v235, v254, 2, v235
  s_mov_b32 s68, s78
  s_mov_b32 s69, s78
  v_pk_mul_f32 v[2:3], v[128:129], s[70:71]
  v_pk_mul_f32 v[4:5], v[130:131], s[70:71]
  v_pk_mul_f32 v[6:7], v[132:133], s[70:71]
  v_pk_mul_f32 v[8:9], v[134:135], s[70:71]
  v_exp_f32 v2, v2
  v_exp_f32 v3, v3
  v_exp_f32 v4, v4
  v_exp_f32 v5, v5
  v_exp_f32 v6, v6
  v_exp_f32 v7, v7
  v_exp_f32 v8, v8
  v_exp_f32 v9, v9
  v_pk_add_f32 v[2:3], v[2:3], s[72:73]
  v_pk_add_f32 v[4:5], v[4:5], s[72:73]
  v_pk_add_f32 v[6:7], v[6:7], s[72:73]
  v_pk_add_f32 v[8:9], v[8:9], s[72:73]
  v_rcp_f32 v2, v2
  v_rcp_f32 v3, v3
  v_rcp_f32 v4, v4
  v_rcp_f32 v5, v5
  v_rcp_f32 v6, v6
  v_rcp_f32 v7, v7
  v_rcp_f32 v8, v8
  v_rcp_f32 v9, v9
  v_pk_mul_f32 v[2:3], v[2:3], v[128:129]
  v_pk_mul_f32 v[4:5], v[4:5], v[130:131]
  v_pk_mul_f32 v[6:7], v[6:7], v[132:133]
  v_pk_mul_f32 v[8:9], v[8:9], v[134:135]
  v_cvt_pk_bf16_f32 v176, v2, v3
  v_cvt_pk_bf16_f32 v177, v4, v5
  v_cvt_pk_bf16_f32 v178, v6, v7
  v_cvt_pk_bf16_f32 v179, v8, v9
  v_lshlrev_b32 v2, 16, v176
  v_and_b32 v3, s65, v176
  v_lshlrev_b32 v4, 16, v200
  v_and_b32 v5, s65, v200
  v_pk_add_f32 v[2:3], v[2:3], v[4:5]
  v_cvt_pk_bf16_f32 v160, v2, v3
  v_lshlrev_b32 v2, 16, v177
  v_and_b32 v3, s65, v177
  v_lshlrev_b32 v4, 16, v201
  v_and_b32 v5, s65, v201
  v_pk_add_f32 v[2:3], v[2:3], v[4:5]
  v_cvt_pk_bf16_f32 v161, v2, v3
  v_lshlrev_b32 v2, 16, v178
  v_and_b32 v3, s65, v178
  v_lshlrev_b32 v4, 16, v202
  v_and_b32 v5, s65, v202
  v_pk_add_f32 v[2:3], v[2:3], v[4:5]
  v_cvt_pk_bf16_f32 v162, v2, v3
  v_lshlrev_b32 v2, 16, v179
  v_and_b32 v3, s65, v179
  v_lshlrev_b32 v4, 16, v203
  v_and_b32 v5, s65, v203
  v_pk_add_f32 v[2:3], v[2:3], v[4:5]
  v_cvt_pk_bf16_f32 v163, v2, v3
  s_mov_b64 exec, s[68:69]
  buffer_store_dwordx4 v[160:163], v235, s[28:31], 0 offen offset:0
  s_mov_b64 exec, -1
  v_pk_mul_f32 v[2:3], v[136:137], s[70:71]
  v_pk_mul_f32 v[4:5], v[138:139], s[70:71]
  v_pk_mul_f32 v[6:7], v[140:141], s[70:71]
  v_pk_mul_f32 v[8:9], v[142:143], s[70:71]
  v_exp_f32 v2, v2
  v_exp_f32 v3, v3
  v_exp_f32 v4, v4
  v_exp_f32 v5, v5
  v_exp_f32 v6, v6
  v_exp_f32 v7, v7
  v_exp_f32 v8, v8
  v_exp_f32 v9, v9
  v_pk_add_f32 v[2:3], v[2:3], s[72:73]
  v_pk_add_f32 v[4:5], v[4:5], s[72:73]
  v_pk_add_f32 v[6:7], v[6:7], s[72:73]
  v_pk_add_f32 v[8:9], v[8:9], s[72:73]
  v_rcp_f32 v2, v2
  v_rcp_f32 v3, v3
  v_rcp_f32 v4, v4
  v_rcp_f32 v5, v5
  v_rcp_f32 v6, v6
  v_rcp_f32 v7, v7
  v_rcp_f32 v8, v8
  v_rcp_f32 v9, v9
  v_pk_mul_f32 v[2:3], v[2:3], v[136:137]
  v_pk_mul_f32 v[4:5], v[4:5], v[138:139]
  v_pk_mul_f32 v[6:7], v[6:7], v[140:141]
  v_pk_mul_f32 v[8:9], v[8:9], v[142:143]
  v_cvt_pk_bf16_f32 v176, v2, v3
  v_cvt_pk_bf16_f32 v177, v4, v5
  v_cvt_pk_bf16_f32 v178, v6, v7
  v_cvt_pk_bf16_f32 v179, v8, v9
  v_lshlrev_b32 v2, 16, v176
  v_and_b32 v3, s65, v176
  v_lshlrev_b32 v4, 16, v204
  v_and_b32 v5, s65, v204
  v_pk_add_f32 v[2:3], v[2:3], v[4:5]
  v_cvt_pk_bf16_f32 v164, v2, v3
  v_lshlrev_b32 v2, 16, v177
  v_and_b32 v3, s65, v177
  v_lshlrev_b32 v4, 16, v205
  v_and_b32 v5, s65, v205
  v_pk_add_f32 v[2:3], v[2:3], v[4:5]
  v_cvt_pk_bf16_f32 v165, v2, v3
  v_lshlrev_b32 v2, 16, v178
  v_and_b32 v3, s65, v178
  v_lshlrev_b32 v4, 16, v206
  v_and_b32 v5, s65, v206
  v_pk_add_f32 v[2:3], v[2:3], v[4:5]
  v_cvt_pk_bf16_f32 v166, v2, v3
  v_lshlrev_b32 v2, 16, v179
  v_and_b32 v3, s65, v179
  v_lshlrev_b32 v4, 16, v207
  v_and_b32 v5, s65, v207
  v_pk_add_f32 v[2:3], v[2:3], v[4:5]
  v_cvt_pk_bf16_f32 v167, v2, v3
  s_mov_b64 exec, s[68:69]
  buffer_store_dwordx4 v[164:167], v235, s[28:31], 0 offen offset:16
  s_mov_b64 exec, -1
  v_pk_mul_f32 v[2:3], v[144:145], s[70:71]
  v_pk_mul_f32 v[4:5], v[146:147], s[70:71]
  v_pk_mul_f32 v[6:7], v[148:149], s[70:71]
  v_pk_mul_f32 v[8:9], v[150:151], s[70:71]
  v_exp_f32 v2, v2
  v_exp_f32 v3, v3
  v_exp_f32 v4, v4
  v_exp_f32 v5, v5
  v_exp_f32 v6, v6
  v_exp_f32 v7, v7
  v_exp_f32 v8, v8
  v_exp_f32 v9, v9
  v_pk_add_f32 v[2:3], v[2:3], s[72:73]
  v_pk_add_f32 v[4:5], v[4:5], s[72:73]
  v_pk_add_f32 v[6:7], v[6:7], s[72:73]
  v_pk_add_f32 v[8:9], v[8:9], s[72:73]
  v_rcp_f32 v2, v2
  v_rcp_f32 v3, v3
  v_rcp_f32 v4, v4
  v_rcp_f32 v5, v5
  v_rcp_f32 v6, v6
  v_rcp_f32 v7, v7
  v_rcp_f32 v8, v8
  v_rcp_f32 v9, v9
  v_pk_mul_f32 v[2:3], v[2:3], v[144:145]
  v_pk_mul_f32 v[4:5], v[4:5], v[146:147]
  v_pk_mul_f32 v[6:7], v[6:7], v[148:149]
  v_pk_mul_f32 v[8:9], v[8:9], v[150:151]
  v_cvt_pk_bf16_f32 v176, v2, v3
  v_cvt_pk_bf16_f32 v177, v4, v5
  v_cvt_pk_bf16_f32 v178, v6, v7
  v_cvt_pk_bf16_f32 v179, v8, v9
  v_lshlrev_b32 v2, 16, v176
  v_and_b32 v3, s65, v176
  v_lshlrev_b32 v4, 16, v208
  v_and_b32 v5, s65, v208
  v_pk_add_f32 v[2:3], v[2:3], v[4:5]
  v_cvt_pk_bf16_f32 v168, v2, v3
  v_lshlrev_b32 v2, 16, v177
  v_and_b32 v3, s65, v177
  v_lshlrev_b32 v4, 16, v209
  v_and_b32 v5, s65, v209
  v_pk_add_f32 v[2:3], v[2:3], v[4:5]
  v_cvt_pk_bf16_f32 v169, v2, v3
  v_lshlrev_b32 v2, 16, v178
  v_and_b32 v3, s65, v178
  v_lshlrev_b32 v4, 16, v210
  v_and_b32 v5, s65, v210
  v_pk_add_f32 v[2:3], v[2:3], v[4:5]
  v_cvt_pk_bf16_f32 v170, v2, v3
  v_lshlrev_b32 v2, 16, v179
  v_and_b32 v3, s65, v179
  v_lshlrev_b32 v4, 16, v211
  v_and_b32 v5, s65, v211
  v_pk_add_f32 v[2:3], v[2:3], v[4:5]
  v_cvt_pk_bf16_f32 v171, v2, v3
  s_mov_b64 exec, s[68:69]
  buffer_store_dwordx4 v[168:171], v235, s[28:31], 0 offen offset:32
  s_mov_b64 exec, -1
  v_pk_mul_f32 v[2:3], v[152:153], s[70:71]
  v_pk_mul_f32 v[4:5], v[154:155], s[70:71]
  v_pk_mul_f32 v[6:7], v[156:157], s[70:71]
  v_pk_mul_f32 v[8:9], v[158:159], s[70:71]
  v_exp_f32 v2, v2
  v_exp_f32 v3, v3
  v_exp_f32 v4, v4
  v_exp_f32 v5, v5
  v_exp_f32 v6, v6
  v_exp_f32 v7, v7
  v_exp_f32 v8, v8
  v_exp_f32 v9, v9
  v_pk_add_f32 v[2:3], v[2:3], s[72:73]
  v_pk_add_f32 v[4:5], v[4:5], s[72:73]
  v_pk_add_f32 v[6:7], v[6:7], s[72:73]
  v_pk_add_f32 v[8:9], v[8:9], s[72:73]
  v_rcp_f32 v2, v2
  v_rcp_f32 v3, v3
  v_rcp_f32 v4, v4
  v_rcp_f32 v5, v5
  v_rcp_f32 v6, v6
  v_rcp_f32 v7, v7
  v_rcp_f32 v8, v8
  v_rcp_f32 v9, v9
  v_pk_mul_f32 v[2:3], v[2:3], v[152:153]
  v_pk_mul_f32 v[4:5], v[4:5], v[154:155]
  v_pk_mul_f32 v[6:7], v[6:7], v[156:157]
  v_pk_mul_f32 v[8:9], v[8:9], v[158:159]
  v_cvt_pk_bf16_f32 v176, v2, v3
  v_cvt_pk_bf16_f32 v177, v4, v5
  v_cvt_pk_bf16_f32 v178, v6, v7
  v_cvt_pk_bf16_f32 v179, v8, v9
  v_lshlrev_b32 v2, 16, v176
  v_and_b32 v3, s65, v176
  v_lshlrev_b32 v4, 16, v212
  v_and_b32 v5, s65, v212
  v_pk_add_f32 v[2:3], v[2:3], v[4:5]
  v_cvt_pk_bf16_f32 v172, v2, v3
  v_lshlrev_b32 v2, 16, v177
  v_and_b32 v3, s65, v177
  v_lshlrev_b32 v4, 16, v213
  v_and_b32 v5, s65, v213
  v_pk_add_f32 v[2:3], v[2:3], v[4:5]
  v_cvt_pk_bf16_f32 v173, v2, v3
  v_lshlrev_b32 v2, 16, v178
  v_and_b32 v3, s65, v178
  v_lshlrev_b32 v4, 16, v214
  v_and_b32 v5, s65, v214
  v_pk_add_f32 v[2:3], v[2:3], v[4:5]
  v_cvt_pk_bf16_f32 v174, v2, v3
  v_lshlrev_b32 v2, 16, v179
  v_and_b32 v3, s65, v179
  v_lshlrev_b32 v4, 16, v215
  v_and_b32 v5, s65, v215
  v_pk_add_f32 v[2:3], v[2:3], v[4:5]
  v_cvt_pk_bf16_f32 v175, v2, v3
  s_mov_b64 exec, s[68:69]
  buffer_store_dwordx4 v[172:175], v235, s[28:31], 0 offen offset:48
  s_mov_b64 exec, -1
  s_waitcnt vmcnt(0)
K2END:
  s_endpgm
.section .rodata,"a"
.p2align 6
.amdhsa_kernel part_kernel
  .amdhsa_next_free_vgpr 56
  .amdhsa_next_free_sgpr 102
  .amdhsa_accum_offset 56
  .amdhsa_group_segment_fixed_size 0
  .amdhsa_kernarg_size 88
  .amdhsa_user_sgpr_count 2
  .amdhsa_user_sgpr_kernarg_segment_ptr 1
  .amdhsa_system_sgpr_workgroup_id_x 1
.end_amdhsa_kernel
.p2align 6
.amdhsa_kernel main_kernel
  .amdhsa_next_free_vgpr 256
  .amdhsa_next_free_sgpr 102
  .amdhsa_accum_offset 256
  .amdhsa_group_segment_fixed_size 0
  .amdhsa_kernarg_size 88
  .amdhsa_user_sgpr_count 2
  .amdhsa_user_sgpr_kernarg_segment_ptr 1
  .amdhsa_system_sgpr_workgroup_id_x 1
.end_amdhsa_kernel
```

```asm
; @launch kernel=part_kernel grid=(251,1,1) block=(640,1,1) lds=60432
; @launch kernel=main_kernel grid=(256,1,1) block=(512,1,1) lds=155136
.amdgcn_target "amdgcn-amd-amdhsa--gfx950"
.text
.globl part_kernel
.p2align 8
.type part_kernel,@function
part_kernel:
  s_cmp_gt_u32 s2, 250
  s_cbranch_scc1 K1END
  s_load_dwordx2 s[8:9], s[0:1], 80
  s_cmp_eq_u32 s2, 250
  s_cbranch_scc1 WPREP
  s_load_dwordx4 s[4:7], s[0:1], 24
  s_load_dwordx2 s[32:33], s[0:1], 0
  s_mul_i32 s3, s2, 12800
  v_lshlrev_b32 v2, 4, v0
  v_lshlrev_b32 v3, 2, v0
  v_add_u32 v3, 10240, v3
  v_and_b32 v1, 255, v0
  v_lshlrev_b32 v1, 2, v1
  v_mov_b32 v20, 0
  v_mov_b32 v21, 0
  v_mov_b32 v22, 0
  v_mov_b32 v23, 0
  s_waitcnt lgkmcnt(0)
  s_mov_b32 s12, s4
  s_mov_b32 s13, s5
  s_mov_b32 s14, 3200000
  s_mov_b32 s15, 0x20000
  s_mov_b32 s16, s6
  s_mov_b32 s17, s7
  s_mov_b32 s18, 3200000
  s_mov_b32 s19, 0x20000
  buffer_load_dwordx4 v[4:7], v2, s[16:19], s3 offen
  buffer_load_dword v8, v3, s[16:19], s3 offen
  buffer_load_dwordx4 v[12:15], v2, s[12:15], s3 offen
  buffer_load_dword v16, v3, s[12:15], s3 offen
  ds_write_b32 v1, v20 offset:58368
  ds_write_b32 v20, v20 offset:60416
  ds_write_b128 v2, v[20:23] offset:0
  ds_write_b128 v2, v[20:23] offset:10240
  ds_write_b128 v2, v[20:23] offset:20480
  ds_write_b128 v2, v[20:23] offset:30720
  s_mov_b32 s20, s8
  s_mov_b32 s21, s9
  s_mov_b32 s22, 8388608
  s_mov_b32 s23, 0x20000
  s_add_u32 s24, s8, 8388488
  s_addc_u32 s25, s9, 0
  s_mov_b32 s26, 14592120
  s_mov_b32 s27, 0x20000
  s_mov_b32 s28, 175921861
  s_movk_i32 s29, 3125
  s_mul_i32 s30, s2, 3200
  s_or_b32 s30, s30, 0x80000000
  v_mov_b32 v50, 1
  v_mov_b32 v49, 127
  v_lshl_add_u32 v51, v0, 2, s30
  s_add_u32 s30, s30, 2560
  v_add_u32 v52, s30, v0
  v_readfirstlane_b32 s31, v0
  s_waitcnt lgkmcnt(0)
  s_barrier
  s_waitcnt vmcnt(2)
  v_mul_hi_u32 v37, s28, v4
  v_lshrrev_b32 v20, 1, v37
  v_and_b32 v20, 0x3fc, v20
  ds_add_rtn_u32 v28, v20, v50 offset:58368
  v_mul_hi_u32 v39, s28, v5
  v_lshrrev_b32 v21, 1, v39
  v_and_b32 v21, 0x3fc, v21
  ds_add_rtn_u32 v29, v21, v50 offset:58368
  v_mul_hi_u32 v41, s28, v6
  v_lshrrev_b32 v22, 1, v41
  v_and_b32 v22, 0x3fc, v22
  ds_add_rtn_u32 v30, v22, v50 offset:58368
  v_mul_hi_u32 v43, s28, v7
  v_lshrrev_b32 v23, 1, v43
  v_and_b32 v23, 0x3fc, v23
  ds_add_rtn_u32 v31, v23, v50 offset:58368
  v_mul_hi_u32 v45, s28, v8
  v_lshrrev_b32 v24, 1, v45
  v_and_b32 v24, 0x3fc, v24
  ds_add_rtn_u32 v32, v24, v50 offset:58368
  v_mad_u32_u24 v36, v37, s29, v49
  v_lshrrev_b32 v36, 7, v36
  v_sub_u32 v4, v4, v36
  v_and_b32 v37, 7, v37
  v_mad_u32_u24 v38, v39, s29, v49
  v_lshrrev_b32 v38, 7, v38
  v_sub_u32 v5, v5, v38
  v_and_b32 v39, 7, v39
  v_mad_u32_u24 v40, v41, s29, v49
  v_lshrrev_b32 v40, 7, v40
  v_sub_u32 v6, v6, v40
  v_and_b32 v41, 7, v41
  v_mad_u32_u24 v42, v43, s29, v49
  v_lshrrev_b32 v42, 7, v42
  v_sub_u32 v7, v7, v42
  v_and_b32 v43, 7, v43
  v_mad_u32_u24 v44, v45, s29, v49
  v_lshrrev_b32 v44, 7, v44
  v_sub_u32 v8, v8, v44
  v_and_b32 v45, 7, v45
  s_waitcnt vmcnt(0)
  v_lshl_or_b32 v36, v4, 27, v12
  v_lshrrev_b32 v12, 12, v12
  v_lshl_or_b32 v37, v37, 4, v12
  v_lshl_or_b32 v37, v37, 24, v51
  v_lshl_or_b32 v38, v5, 27, v13
  v_lshrrev_b32 v13, 12, v13
  v_lshl_or_b32 v39, v39, 4, v13
  v_add_u32 v51, 1, v51
  v_lshl_or_b32 v39, v39, 24, v51
  v_lshl_or_b32 v40, v6, 27, v14
  v_lshrrev_b32 v14, 12, v14
  v_lshl_or_b32 v41, v41, 4, v14
  v_add_u32 v51, 1, v51
  v_lshl_or_b32 v41, v41, 24, v51
  v_lshl_or_b32 v42, v7, 27, v15
  v_lshrrev_b32 v15, 12, v15
  v_lshl_or_b32 v43, v43, 4, v15
  v_add_u32 v51, 1, v51
  v_lshl_or_b32 v43, v43, 24, v51
  v_lshl_or_b32 v44, v8, 27, v16
  v_lshrrev_b32 v16, 12, v16
  v_lshl_or_b32 v45, v45, 4, v16
  v_lshl_or_b32 v45, v45, 24, v52
  v_lshrrev_b32 v3, 3, v0
  s_movk_i32 s3, 128
  v_mul_u32_u24 v3, s3, v3
  v_and_b32 v1, 7, v0
  v_lshl_add_u32 v3, v1, 4, v3
  s_mul_i32 s3, s2, 32896
  s_add_u32 s4, s3, 10240
  s_add_u32 s5, s3, 20480
  s_add_u32 s6, s3, 30720
  s_mul_i32 s7, s2, 58368
  s_mov_b32 s33, 0
  s_mov_b32 s34, 0xfff20000
  v_mov_b32 v1, 60416
  v_lshlrev_b32 v4, 5, v20
  v_lshlrev_b32 v5, 5, v21
  v_lshlrev_b32 v6, 5, v22
  v_lshlrev_b32 v7, 5, v23
  v_lshlrev_b32 v8, 5, v24
  s_waitcnt lgkmcnt(4)
  v_cmp_gt_u32 s[40:41], 15, v28
  v_lshl_add_u32 v12, v28, 3, v4
  s_waitcnt lgkmcnt(3)
  v_cmp_gt_u32 s[42:43], 15, v29
  v_lshl_add_u32 v13, v29, 3, v5
  s_waitcnt lgkmcnt(2)
  v_cmp_gt_u32 s[44:45], 15, v30
  v_lshl_add_u32 v14, v30, 3, v6
  s_waitcnt lgkmcnt(1)
  v_cmp_gt_u32 s[46:47], 15, v31
  v_lshl_add_u32 v15, v31, 3, v7
  s_waitcnt lgkmcnt(0)
  v_cmp_gt_u32 s[48:49], 15, v32
  v_lshl_add_u32 v16, v32, 3, v8
  v_max3_u32 v48, v28, v29, v30
  v_max3_u32 v48, v48, v31, v32
  v_cmp_le_u32 s[50:51], 31, v48
  s_mov_b64 exec, s[40:41]
  ds_write_b64 v12, v[36:37]
  s_mov_b64 exec, s[42:43]
  ds_write_b64 v13, v[38:39]
  s_mov_b64 exec, s[44:45]
  ds_write_b64 v14, v[40:41]
  s_mov_b64 exec, s[46:47]
  ds_write_b64 v15, v[42:43]
  s_mov_b64 exec, s[48:49]
  ds_write_b64 v16, v[44:45]
  s_not_b64 exec, s[40:41]
  s_cbranch_scc0 K1N0
  v_lshl_add_u32 v48, v20, 2, s34
  v_lshl_add_u32 v48, v28, 16, v48
  ds_max_u32 v4, v48 offset:120
  v_cmpx_gt_u32 vcc, 31, v28
  s_cbranch_execz K1N0
  buffer_store_dwordx2 v[36:37], v12, s[24:27], s7 offen
K1N0:
  s_not_b64 exec, s[42:43]
  s_cbranch_scc0 K1N1
  v_lshl_add_u32 v48, v21, 2, s34
  v_lshl_add_u32 v48, v29, 16, v48
  ds_max_u32 v5, v48 offset:120
  v_cmpx_gt_u32 vcc, 31, v29
  s_cbranch_execz K1N1
  buffer_store_dwordx2 v[38:39], v13, s[24:27], s7 offen
K1N1:
  s_not_b64 exec, s[44:45]
  s_cbranch_scc0 K1N2
  v_lshl_add_u32 v48, v22, 2, s34
  v_lshl_add_u32 v48, v30, 16, v48
  ds_max_u32 v6, v48 offset:120
  v_cmpx_gt_u32 vcc, 31, v30
  s_cbranch_execz K1N2
  buffer_store_dwordx2 v[40:41], v14, s[24:27], s7 offen
K1N2:
  s_not_b64 exec, s[46:47]
  s_cbranch_scc0 K1N3
  v_lshl_add_u32 v48, v23, 2, s34
  v_lshl_add_u32 v48, v31, 16, v48
  ds_max_u32 v7, v48 offset:120
  v_cmpx_gt_u32 vcc, 31, v31
  s_cbranch_execz K1N3
  buffer_store_dwordx2 v[42:43], v15, s[24:27], s7 offen
K1N3:
  s_not_b64 exec, s[48:49]
  s_cbranch_scc0 K1N4
  v_lshl_add_u32 v48, v24, 2, s34
  v_lshl_add_u32 v48, v32, 16, v48
  ds_max_u32 v8, v48 offset:120
  v_cmpx_gt_u32 vcc, 31, v32
  s_cbranch_execz K1N4
  buffer_store_dwordx2 v[44:45], v16, s[24:27], s7 offen
K1N4:
  s_mov_b64 exec, s[50:51]
  ds_write_b32 v1, v50
  s_mov_b64 exec, -1
  s_waitcnt lgkmcnt(0)
  s_barrier
  ds_read_b32 v48, v1
K1RD:
  ds_read_b128 v[4:7], v2
  ds_read_b128 v[8:11], v2 offset:10240
  ds_read_b128 v[12:15], v2 offset:20480
  ds_read_b128 v[16:19], v2 offset:30720
  s_waitcnt lgkmcnt(3)
  v_cmp_ne_u32 vcc, 0, v48
  s_cbranch_vccnz K1SLOW
  buffer_store_dwordx4 v[4:7], v3, s[20:23], s3 offen sc1
  s_waitcnt lgkmcnt(2)
  buffer_store_dwordx4 v[8:11], v3, s[20:23], s4 offen sc1
  s_waitcnt lgkmcnt(1)
  buffer_store_dwordx4 v[12:15], v3, s[20:23], s5 offen sc1
  s_add_u32 s7, s7, 32888
  s_cmp_ge_u32 s31, 128
  s_cbranch_scc1 K1OV
  s_waitcnt lgkmcnt(0)
  buffer_store_dwordx4 v[16:19], v3, s[20:23], s6 offen sc1
K1OV:
  v_cmpx_gt_u32 vcc, s33, v2
  s_cbranch_execz K1FIN
  ds_read_b128 v[20:23], v2 offset:32768
  s_waitcnt lgkmcnt(0)
  buffer_store_dwordx4 v[20:23], v2, s[24:27], s7 offen sc1
  v_add_u32 v2, 10240, v2
  s_waitcnt vmcnt(0)
  s_branch K1OV
K1FIN:
K1END:
  s_endpgm
K1SLOW:
  v_and_b32 v1, 63, v0
  v_lshlrev_b32 v53, 9, v1
  v_lshlrev_b32 v1, 4, v1
  v_mov_b32 v48, 0xffff0000
  v_mov_b32 v49, 0xf0ff1
  s_waitcnt lgkmcnt(0)
  ds_read_b128 v[4:7], v1 offset:58368
  s_waitcnt lgkmcnt(0)
  v_cmp_lt_u32 s[40:41], 31, v4
  v_subrev_u32 v4, 15, v4
  v_cmp_lt_u32 s[42:43], 31, v5
  v_subrev_u32 v5, 15, v5
  v_cmp_lt_u32 s[44:45], 31, v6
  v_subrev_u32 v6, 15, v6
  v_cmp_lt_u32 s[46:47], 31, v7
  v_subrev_u32 v7, 15, v7
  v_cndmask_b32 v4, 0, v4, s[40:41]
  v_cndmask_b32 v5, 0, v5, s[42:43]
  v_cndmask_b32 v6, 0, v6, s[44:45]
  v_cndmask_b32 v7, 0, v7, s[46:47]
  v_add_u32 v8, v4, v5
  v_add_u32 v9, v8, v6
  v_add_u32 v10, v9, v7
  v_mov_b32 v11, v10
  s_nop 1
  v_add_u32_dpp v11, v11, v11 row_shr:1 row_mask:0xf bank_mask:0xf
  s_nop 1
  v_add_u32_dpp v11, v11, v11 row_shr:2 row_mask:0xf bank_mask:0xf
  s_nop 1
  v_add_u32_dpp v11, v11, v11 row_shr:4 row_mask:0xf bank_mask:0xf
  s_nop 1
  v_add_u32_dpp v11, v11, v11 row_shr:8 row_mask:0xf bank_mask:0xf
  s_nop 1
  v_add_u32_dpp v11, v11, v11 row_bcast:15 row_mask:0xa bank_mask:0xf
  s_nop 1
  v_add_u32_dpp v11, v11, v11 row_bcast:31 row_mask:0xc bank_mask:0xf
  v_cndmask_b32 v16, v48, v49, s[40:41]
  v_cndmask_b32 v17, v48, v49, s[42:43]
  v_cndmask_b32 v18, v48, v49, s[44:45]
  v_cndmask_b32 v19, v48, v49, s[46:47]
  v_sub_u32 v12, v11, v10
  v_add_u32 v13, v12, v4
  v_add_u32 v14, v12, v8
  v_add_u32 v15, v12, v9
  v_readlane_b32 s33, v11, 63
  v_add_u32 v16, v16, v12
  v_add_u32 v17, v17, v13
  v_add_u32 v18, v18, v14
  v_add_u32 v19, v19, v15
  ds_write_b128 v1, v[16:19] offset:59392
  ds_read_b32 v20, v20 offset:59392
  ds_read_b32 v21, v21 offset:59392
  ds_read_b32 v22, v22 offset:59392
  ds_read_b32 v23, v23 offset:59392
  ds_read_b32 v24, v24 offset:59392
  v_lshl_or_b32 v4, v4, 16, v12
  v_add_u32 v4, 4096, v4
  s_mov_b64 exec, s[40:41]
  ds_write_b32 v53, v4 offset:120
  s_mov_b64 exec, -1
  v_lshl_or_b32 v5, v5, 16, v13
  v_add_u32 v5, 4096, v5
  s_mov_b64 exec, s[42:43]
  ds_write_b32 v53, v5 offset:248
  s_mov_b64 exec, -1
  v_lshl_or_b32 v6, v6, 16, v14
  v_add_u32 v6, 4096, v6
  s_mov_b64 exec, s[44:45]
  ds_write_b32 v53, v6 offset:376
  s_mov_b64 exec, -1
  v_lshl_or_b32 v7, v7, 16, v15
  v_add_u32 v7, 4096, v7
  s_mov_b64 exec, s[46:47]
  ds_write_b32 v53, v7 offset:504
  s_mov_b64 exec, -1
  s_waitcnt lgkmcnt(0)
  v_cmp_ge_u32_sdwa vcc, v28, v20 src0_sel:DWORD src1_sel:WORD_1
  v_and_b32 v20, 0xffff, v20
  v_add_lshl_u32 v20, v20, v28, 3
  s_mov_b64 exec, vcc
  ds_write_b64 v20, v[36:37]
  s_mov_b64 exec, -1
  v_cmp_ge_u32_sdwa vcc, v29, v21 src0_sel:DWORD src1_sel:WORD_1
  v_and_b32 v21, 0xffff, v21
  v_add_lshl_u32 v21, v21, v29, 3
  s_mov_b64 exec, vcc
  ds_write_b64 v21, v[38:39]
  s_mov_b64 exec, -1
  v_cmp_ge_u32_sdwa vcc, v30, v22 src0_sel:DWORD src1_sel:WORD_1
  v_and_b32 v22, 0xffff, v22
  v_add_lshl_u32 v22, v22, v30, 3
  s_mov_b64 exec, vcc
  ds_write_b64 v22, v[40:41]
  s_mov_b64 exec, -1
  v_cmp_ge_u32_sdwa vcc, v31, v23 src0_sel:DWORD src1_sel:WORD_1
  v_and_b32 v23, 0xffff, v23
  v_add_lshl_u32 v23, v23, v31, 3
  s_mov_b64 exec, vcc
  ds_write_b64 v23, v[42:43]
  s_mov_b64 exec, -1
  v_cmp_ge_u32_sdwa vcc, v32, v24 src0_sel:DWORD src1_sel:WORD_1
  v_and_b32 v24, 0xffff, v24
  v_add_lshl_u32 v24, v24, v32, 3
  s_mov_b64 exec, vcc
  ds_write_b64 v24, v[44:45]
  s_mov_b64 exec, -1
  s_lshl_b32 s33, s33, 3
  v_mov_b32 v48, 0
  s_waitcnt lgkmcnt(0)
  s_barrier
  s_branch K1RD
WPREP:
  s_load_dwordx4 s[4:7], s[0:1], 40
  v_lshrrev_b32 v2, 6, v0
  v_and_b32 v1, 63, v0
  v_readfirstlane_b32 s31, v2
  s_mov_b32 s28, 0xbfb8aa3b
  s_mov_b32 s29, 0xbfb8aa3b
  s_mov_b32 s30, 0xffff0000
  s_waitcnt lgkmcnt(0)
  s_mov_b32 s12, s4
  s_mov_b32 s13, s5
  s_mov_b32 s14, 18560
  s_mov_b32 s15, 0x20000
  s_mov_b32 s16, s6
  s_mov_b32 s17, s7
  s_mov_b32 s18, 128
  s_mov_b32 s19, 0x20000
  s_add_u32 s20, s8, 23068672
  s_addc_u32 s21, s9, 0
  s_mov_b32 s22, 24576
  s_mov_b32 s23, 0x20000
  v_and_b32 v2, 7, v1
  v_bfe_u32 v3, v1, 4, 1
  v_lshlrev_b32 v4, 2, v3
  v_xor_b32 v4, v4, v2
  v_lshlrev_b32 v4, 4, v4
  v_lshrrev_b32 v5, 3, v1
  v_lshl_or_b32 v4, v5, 7, v4
  s_lshl_b32 s3, s31, 10
  s_add_u32 s4, s3, 10240
  v_add_u32 v4, s3, v4
  s_mov_b32 m0, s3
  s_nop 0
  buffer_load_dwordx4 v4, s[12:15], 0 offen lds
  v_add_u32 v4, 10240, v4
  s_mov_b32 m0, s4
  s_nop 0
  buffer_load_dwordx4 v4, s[12:15], 0 offen lds
  v_lshrrev_b32 v5, 5, v1
  v_lshlrev_b32 v7, 3, v5
  buffer_load_dwordx2 v[28:29], v7, s[16:19], 0 offen offset:0
  buffer_load_dwordx2 v[30:31], v7, s[16:19], 0 offen offset:16
  buffer_load_dwordx2 v[32:33], v7, s[16:19], 0 offen offset:32
  buffer_load_dwordx2 v[34:35], v7, s[16:19], 0 offen offset:48
  buffer_load_dwordx2 v[36:37], v7, s[16:19], 0 offen offset:64
  buffer_load_dwordx2 v[38:39], v7, s[16:19], 0 offen offset:80
  buffer_load_dwordx2 v[40:41], v7, s[16:19], 0 offen offset:96
  buffer_load_dwordx2 v[42:43], v7, s[16:19], 0 offen offset:112
  v_and_b32 v2, 3, v1
  v_bfe_u32 v4, v1, 2, 2
  v_lshlrev_b32 v2, 3, v2
  v_lshl_add_u32 v2, v3, 5, v2
  v_lshl_add_u32 v2, v4, 7, v2
  v_lshl_add_u32 v6, v5, 12, v2
  v_lshrrev_b32 v3, 1, v4
  v_lshl_add_u32 v6, v3, 6, v6
  v_lshl_add_u32 v8, v5, 10, v2
  v_add_u32 v3, 1, v4
  v_bfe_u32 v3, v3, 1, 1
  v_lshl_add_u32 v8, v3, 6, v8
  v_xor_b32 v9, 64, v8
  s_and_b32 s3, s31, 1
  s_lshl_b32 s3, s3, 6
  v_xor_b32 v6, s3, v6
  s_lshr_b32 s3, s31, 1
  s_lshl_b32 s3, s3, 13
  v_add_u32 v6, s3, v6
  v_lshlrev_b32 v10, 4, v1
  s_lshl_b32 s3, s31, 12
  s_waitcnt vmcnt(0)
  s_barrier
  s_cmp_eq_u32 s31, 4
  s_cbranch_scc1 WP4
  s_cmp_eq_u32 s31, 5
  s_cbranch_scc1 WP5
  s_cmp_gt_u32 s31, 5
  s_cbranch_scc1 WPEND
  ds_read_b64_tr_b16 v[12:13], v6 offset:0
  ds_read_b64_tr_b16 v[14:15], v6 offset:512
  ds_read_b64_tr_b16 v[16:17], v6 offset:1024
  ds_read_b64_tr_b16 v[18:19], v6 offset:1536
  ds_read_b64_tr_b16 v[20:21], v6 offset:2048
  ds_read_b64_tr_b16 v[22:23], v6 offset:2560
  ds_read_b64_tr_b16 v[24:25], v6 offset:3072
  ds_read_b64_tr_b16 v[26:27], v6 offset:3584
  s_waitcnt lgkmcnt(0)
  s_cmp_lt_u32 s31, 2
  s_cbranch_scc1 WPST
  v_lshlrev_b32 v2, 16, v12
  v_and_b32 v3, s30, v12
  v_pk_mul_f32 v[2:3], v[2:3], s[28:29]
  v_cvt_pk_bf16_f32 v12, v2, v3
  v_lshlrev_b32 v2, 16, v13
  v_and_b32 v3, s30, v13
  v_pk_mul_f32 v[2:3], v[2:3], s[28:29]
  v_cvt_pk_bf16_f32 v13, v2, v3
  v_lshlrev_b32 v2, 16, v14
  v_and_b32 v3, s30, v14
  v_pk_mul_f32 v[2:3], v[2:3], s[28:29]
  v_cvt_pk_bf16_f32 v14, v2, v3
  v_lshlrev_b32 v2, 16, v15
  v_and_b32 v3, s30, v15
  v_pk_mul_f32 v[2:3], v[2:3], s[28:29]
  v_cvt_pk_bf16_f32 v15, v2, v3
  v_lshlrev_b32 v2, 16, v16
  v_and_b32 v3, s30, v16
  v_pk_mul_f32 v[2:3], v[2:3], s[28:29]
  v_cvt_pk_bf16_f32 v16, v2, v3
  v_lshlrev_b32 v2, 16, v17
  v_and_b32 v3, s30, v17
  v_pk_mul_f32 v[2:3], v[2:3], s[28:29]
  v_cvt_pk_bf16_f32 v17, v2, v3
  v_lshlrev_b32 v2, 16, v18
  v_and_b32 v3, s30, v18
  v_pk_mul_f32 v[2:3], v[2:3], s[28:29]
  v_cvt_pk_bf16_f32 v18, v2, v3
  v_lshlrev_b32 v2, 16, v19
  v_and_b32 v3, s30, v19
  v_pk_mul_f32 v[2:3], v[2:3], s[28:29]
  v_cvt_pk_bf16_f32 v19, v2, v3
  v_lshlrev_b32 v2, 16, v20
  v_and_b32 v3, s30, v20
  v_pk_mul_f32 v[2:3], v[2:3], s[28:29]
  v_cvt_pk_bf16_f32 v20, v2, v3
  v_lshlrev_b32 v2, 16, v21
  v_and_b32 v3, s30, v21
  v_pk_mul_f32 v[2:3], v[2:3], s[28:29]
  v_cvt_pk_bf16_f32 v21, v2, v3
  v_lshlrev_b32 v2, 16, v22
  v_and_b32 v3, s30, v22
  v_pk_mul_f32 v[2:3], v[2:3], s[28:29]
  v_cvt_pk_bf16_f32 v22, v2, v3
  v_lshlrev_b32 v2, 16, v23
  v_and_b32 v3, s30, v23
  v_pk_mul_f32 v[2:3], v[2:3], s[28:29]
  v_cvt_pk_bf16_f32 v23, v2, v3
  v_lshlrev_b32 v2, 16, v24
  v_and_b32 v3, s30, v24
  v_pk_mul_f32 v[2:3], v[2:3], s[28:29]
  v_cvt_pk_bf16_f32 v24, v2, v3
  v_lshlrev_b32 v2, 16, v25
  v_and_b32 v3, s30, v25
  v_pk_mul_f32 v[2:3], v[2:3], s[28:29]
  v_cvt_pk_bf16_f32 v25, v2, v3
  v_lshlrev_b32 v2, 16, v26
  v_and_b32 v3, s30, v26
  v_pk_mul_f32 v[2:3], v[2:3], s[28:29]
  v_cvt_pk_bf16_f32 v26, v2, v3
  v_lshlrev_b32 v2, 16, v27
  v_and_b32 v3, s30, v27
  v_pk_mul_f32 v[2:3], v[2:3], s[28:29]
  v_cvt_pk_bf16_f32 v27, v2, v3
WPST:
  buffer_store_dwordx4 v[12:15], v10, s[20:23], s3 offen offset:0
  buffer_store_dwordx4 v[16:19], v10, s[20:23], s3 offen offset:1024
  buffer_store_dwordx4 v[20:23], v10, s[20:23], s3 offen offset:2048
  buffer_store_dwordx4 v[24:27], v10, s[20:23], s3 offen offset:3072
  s_endpgm
WP4:
  ds_read_b64_tr_b16 v[12:13], v8 offset:16512
  ds_read_b64_tr_b16 v[14:15], v8 offset:17024
  ds_read_b64_tr_b16 v[16:17], v9 offset:16512
  ds_read_b64_tr_b16 v[18:19], v9 offset:17024
  v_and_b32 v2, 31, v1
  v_lshlrev_b32 v2, 1, v2
  ds_read_u16 v20, v2 offset:16384
  ds_read_u16 v21, v2 offset:16448
  v_subrev_u32 v5, 1, v5
  s_waitcnt lgkmcnt(0)
  v_lshlrev_b32 v2, 16, v12
  v_and_b32 v3, s30, v12
  v_pk_mul_f32 v[2:3], v[2:3], s[28:29]
  v_cvt_pk_bf16_f32 v12, v2, v3
  v_lshlrev_b32 v2, 16, v13
  v_and_b32 v3, s30, v13
  v_pk_mul_f32 v[2:3], v[2:3], s[28:29]
  v_cvt_pk_bf16_f32 v13, v2, v3
  v_lshlrev_b32 v2, 16, v14
  v_and_b32 v3, s30, v14
  v_pk_mul_f32 v[2:3], v[2:3], s[28:29]
  v_cvt_pk_bf16_f32 v14, v2, v3
  v_lshlrev_b32 v2, 16, v15
  v_and_b32 v3, s30, v15
  v_pk_mul_f32 v[2:3], v[2:3], s[28:29]
  v_cvt_pk_bf16_f32 v15, v2, v3
  v_lshlrev_b32 v2, 16, v16
  v_and_b32 v3, s30, v16
  v_pk_mul_f32 v[2:3], v[2:3], s[28:29]
  v_cvt_pk_bf16_f32 v16, v2, v3
  v_lshlrev_b32 v2, 16, v17
  v_and_b32 v3, s30, v17
  v_pk_mul_f32 v[2:3], v[2:3], s[28:29]
  v_cvt_pk_bf16_f32 v17, v2, v3
  v_lshlrev_b32 v2, 16, v18
  v_and_b32 v3, s30, v18
  v_pk_mul_f32 v[2:3], v[2:3], s[28:29]
  v_cvt_pk_bf16_f32 v18, v2, v3
  v_lshlrev_b32 v2, 16, v19
  v_and_b32 v3, s30, v19
  v_pk_mul_f32 v[2:3], v[2:3], s[28:29]
  v_cvt_pk_bf16_f32 v19, v2, v3
  v_lshlrev_b32 v20, 16, v20
  v_mul_f32 v20, s28, v20
  v_cvt_pk_f16_f32 v20, v20, 0
  v_and_b32 v20, v5, v20
  v_mov_b32 v22, 0
  v_lshlrev_b32 v21, 16, v21
  v_mul_f32 v21, s28, v21
  v_cvt_pk_f16_f32 v21, v21, 0
  v_and_b32 v21, v5, v21
  v_mov_b32 v23, 0
  buffer_store_dwordx4 v[12:15], v10, s[20:23], s3 offen offset:0
  buffer_store_dwordx4 v[16:19], v10, s[20:23], s3 offen offset:1024
  buffer_store_dwordx4 v[20:23], v10, s[20:23], s3 offen offset:2048
  buffer_store_dwordx4 v[20:23], v10, s[20:23], s3 offen offset:3072
  s_endpgm
WP5:
  v_lshrrev_b32 v4, 2, v1
  v_lshrrev_b32 v8, 4, v1
  v_xor_b32 v4, v4, v8
  v_and_b32 v4, 1, v4
  v_subrev_u32 v4, 1, v4
  v_lshlrev_b32 v2, 16, v28
  v_and_b32 v3, s30, v28
  v_cvt_pk_f16_f32 v2, v2, v3
  v_and_b32 v12, v4, v2
  v_lshlrev_b32 v2, 16, v29
  v_and_b32 v3, s30, v29
  v_cvt_pk_f16_f32 v2, v2, v3
  v_and_b32 v13, v4, v2
  v_lshlrev_b32 v2, 16, v30
  v_and_b32 v3, s30, v30
  v_cvt_pk_f16_f32 v2, v2, v3
  v_and_b32 v14, v4, v2
  v_lshlrev_b32 v2, 16, v31
  v_and_b32 v3, s30, v31
  v_cvt_pk_f16_f32 v2, v2, v3
  v_and_b32 v15, v4, v2
  v_lshlrev_b32 v2, 16, v32
  v_and_b32 v3, s30, v32
  v_cvt_pk_f16_f32 v2, v2, v3
  v_and_b32 v16, v4, v2
  v_lshlrev_b32 v2, 16, v33
  v_and_b32 v3, s30, v33
  v_cvt_pk_f16_f32 v2, v2, v3
  v_and_b32 v17, v4, v2
  v_lshlrev_b32 v2, 16, v34
  v_and_b32 v3, s30, v34
  v_cvt_pk_f16_f32 v2, v2, v3
  v_and_b32 v18, v4, v2
  v_lshlrev_b32 v2, 16, v35
  v_and_b32 v3, s30, v35
  v_cvt_pk_f16_f32 v2, v2, v3
  v_and_b32 v19, v4, v2
  v_lshlrev_b32 v2, 16, v36
  v_and_b32 v3, s30, v36
  v_cvt_pk_f16_f32 v2, v2, v3
  v_and_b32 v20, v4, v2
  v_lshlrev_b32 v2, 16, v37
  v_and_b32 v3, s30, v37
  v_cvt_pk_f16_f32 v2, v2, v3
  v_and_b32 v21, v4, v2
  v_lshlrev_b32 v2, 16, v38
  v_and_b32 v3, s30, v38
  v_cvt_pk_f16_f32 v2, v2, v3
  v_and_b32 v22, v4, v2
  v_lshlrev_b32 v2, 16, v39
  v_and_b32 v3, s30, v39
  v_cvt_pk_f16_f32 v2, v2, v3
  v_and_b32 v23, v4, v2
  v_lshlrev_b32 v2, 16, v40
  v_and_b32 v3, s30, v40
  v_cvt_pk_f16_f32 v2, v2, v3
  v_and_b32 v24, v4, v2
  v_lshlrev_b32 v2, 16, v41
  v_and_b32 v3, s30, v41
  v_cvt_pk_f16_f32 v2, v2, v3
  v_and_b32 v25, v4, v2
  v_lshlrev_b32 v2, 16, v42
  v_and_b32 v3, s30, v42
  v_cvt_pk_f16_f32 v2, v2, v3
  v_and_b32 v26, v4, v2
  v_lshlrev_b32 v2, 16, v43
  v_and_b32 v3, s30, v43
  v_cvt_pk_f16_f32 v2, v2, v3
  v_and_b32 v27, v4, v2
  s_branch WPST
WPEND:
  s_endpgm
.globl main_kernel
.p2align 8
.type main_kernel,@function
main_kernel:
  s_cmp_ge_u32 s2, 256
  s_cbranch_scc1 K2END
  s_load_dwordx2 s[52:53], s[0:1], 80
  s_load_dwordx8 s[32:39], s[0:1], 0
  s_load_dwordx4 s[48:51], s[0:1], 56
  s_and_b32 s3, s2, 7
  s_lshl_b32 s3, s3, 5
  s_lshr_b32 s56, s2, 3
  s_add_u32 s56, s56, s3
  v_lshrrev_b32 v2, 6, v0
  v_and_b32 v0, 63, v0
  v_readfirstlane_b32 s57, v2
  s_mov_b32 s60, 47
  s_mov_b32 s61, 0
  s_mov_b32 s63, 1
  s_mov_b32 s54, 1
  s_movk_i32 s55, 2176
  s_movk_i32 s94, 17404
  s_movk_i32 s95, 0xf0
  s_movk_i32 s64, 128
  s_mov_b32 s65, 0xffff0000
  s_mov_b32 s70, 0xbfb8aa3b
  s_mov_b32 s71, 0xbfb8aa3b
  s_mov_b32 s72, 1.0
  s_mov_b32 s73, 1.0
  s_mov_b32 s74, -1
  s_mov_b32 s75, 0
  s_lshl_b32 s3, s56, 3
  s_add_u32 s3, s3, s57
  s_mul_i32 s3, s3, 3125
  s_add_u32 s58, s3, 127
  s_lshr_b32 s58, s58, 7
  s_add_u32 s3, s3, 3252
  s_lshr_b32 s3, s3, 7
  s_sub_u32 s3, s3, s58
  s_bfm_b32 s78, s3, 0
  s_lshl_b32 s66, s57, 12
  s_add_u32 s66, s66, 81408
  s_lshl_b32 s67, s57, 10
  s_add_u32 s67, s67, 36352
  s_mul_i32 s3, s56, 128
  s_mov_b32 s18, 8191232
  s_mov_b32 s19, 0x20000
  s_waitcnt lgkmcnt(0)
  s_add_u32 s16, s52, s3
  s_addc_u32 s17, s53, 0
ROUND:
  s_lshl_b32 s3, s57, 12
  v_lshl_add_u32 v2, v0, 4, s3
  v_lshrrev_b32 v3, 7, v2
  v_lshl_add_u32 v2, v3, 15, v2
  buffer_load_dwordx4 v[128:131], v2, s[16:19], 0 offen offset:0
  v_add_u32 v2, 262144, v2
  buffer_load_dwordx4 v[132:135], v2, s[16:19], 0 offen offset:1024
  v_add_u32 v2, 262144, v2
  buffer_load_dwordx4 v[136:139], v2, s[16:19], 0 offen offset:2048
  v_add_u32 v2, 262144, v2
  buffer_load_dwordx4 v[140:143], v2, s[16:19], 0 offen offset:3072
  s_and_b32 s3, s57, 3
  s_lshl_b32 s3, s3, 8
  v_lshl_add_u32 v4, v0, 2, s3
  v_mov_b32 v5, 0
  ds_write_b32 v4, v5 offset:34816
  s_cmp_eq_u32 s63, 0
  s_cbranch_scc1 NOTFIRST1
  s_mov_b32 s4, s32
  s_mov_b32 s5, s33
  s_mov_b32 s6, 6400000
  s_mov_b32 s7, 0x20000
  s_mov_b32 s12, s34
  s_mov_b32 s13, s35
  s_mov_b32 s14, 300000
  s_mov_b32 s15, 0x20000
  v_and_b32 v2, 7, v0
  v_bfe_u32 v3, v0, 4, 1
  v_lshrrev_b32 v5, 3, v0
  v_lshrrev_b32 v6, 5, v0
  v_lshl_add_u32 v237, v6, 2, 0
  v_xor_b32 v237, v237, v2
  v_lshlrev_b32 v237, 4, v237
  v_lshl_add_u32 v238, v6, 2, 1
  v_xor_b32 v238, v238, v2
  v_lshlrev_b32 v238, 4, v238
  v_lshl_add_u32 v239, v6, 2, 2
  v_xor_b32 v239, v239, v2
  v_lshlrev_b32 v239, 4, v239
  v_lshl_add_u32 v240, v6, 2, 3
  v_xor_b32 v240, v240, v2
  v_lshlrev_b32 v240, 4, v240
  v_lshl_add_u32 v7, v5, 2, s58
  v_add_u32 v7, 0, v7
  v_mad_u32_u24 v56, v7, s64, v237
  v_lshl_add_u32 v7, v5, 2, s58
  v_add_u32 v7, 1, v7
  v_mad_u32_u24 v57, v7, s64, v238
  v_lshl_add_u32 v7, v5, 2, s58
  v_add_u32 v7, 2, v7
  v_mad_u32_u24 v58, v7, s64, v239
  v_lshl_add_u32 v7, v5, 2, s58
  v_add_u32 v7, 3, v7
  v_mad_u32_u24 v59, v7, s64, v240
  v_add_u32 v12, s58, v0
  v_mul_u32_u24 v11, 6, v12
  v_and_b32 v11, -4, v11
  s_mov_b32 s8, s36
  s_mov_b32 s9, s37
  s_mov_b32 s10, 25600000
  s_mov_b32 s11, 0x20000
  s_mov_b32 s28, s50
  s_mov_b32 s29, s51
  s_mov_b32 s30, 6700000
  s_mov_b32 s31, 0x20000
  s_mov_b32 s24, s48
  s_mov_b32 s25, s49
  s_mov_b32 s26, 16384
  s_mov_b32 s27, 0x20000
  s_add_u32 s20, s52, 8388608
  s_addc_u32 s21, s53, 0
  s_mov_b32 s22, 14704640
  s_mov_b32 s23, 0x20000
  v_lshlrev_b32 v13, 1, v3
  v_xor_b32 v13, v13, v2
  v_lshlrev_b32 v13, 4, v13
  v_lshl_or_b32 v13, v5, 7, v13
  s_lshl_b32 s3, s57, 10
  v_lshl_add_u32 v10, v0, 4, s3
  v_add_u32 v10, 14680064, v10
  v_add_u32 v13, s3, v13
  v_lshlrev_b32 v254, 4, v6
  v_and_b32 v2, 3, v0
  v_bfe_u32 v4, v0, 2, 3
  v_lshl_add_u32 v4, v2, 3, v4
  v_xor_b32 v7, v3, v6
  v_lshlrev_b32 v7, 6, v7
  v_lshl_add_u32 v4, v4, 7, v7
  v_add_u32 v4, s66, v4
  v_xor_b32 v7, 0, v2
  v_lshl_add_u32 v241, v7, 4, v4
  v_xor_b32 v7, 1, v2
  v_lshl_add_u32 v242, v7, 4, v4
  v_xor_b32 v7, 2, v2
  v_lshl_add_u32 v243, v7, 4, v4
  v_xor_b32 v7, 3, v2
  v_lshl_add_u32 v244, v7, 4, v4
  s_add_u32 s3, s67, 32
  v_lshlrev_b32 v7, 5, v6
  v_sub_u32 v245, s3, v7
  s_add_u32 s3, s67, 224
  v_lshl_add_u32 v7, v3, 2, v2
  v_lshlrev_b32 v7, 5, v7
  v_sub_u32 v247, s3, v7
  s_mul_i32 s3, s57, 4608
  s_add_u32 s3, s3, 44544
  v_and_b32 v7, 31, v0
  s_movk_i32 s68, 144
  v_mul_u32_u24 v8, s68, v7
  v_add_u32 v8, s3, v8
  v_lshl_add_u32 v246, v6, 5, v8
  v_bfe_u32 v4, v0, 2, 2
  v_lshl_add_u32 v8, v6, 2, v4
  s_movk_i32 s68, 576
  v_mul_u32_u24 v9, s68, v8
  v_add_u32 v9, s3, v9
  v_xor_b32 v249, v3, v0
  v_and_b32 v249, 1, v249
  v_lshl_add_u32 v249, v249, 3, v9
  v_add_u32 v249, 128, v249
  v_lshl_add_u32 v248, v3, 5, v9
  v_lshl_add_u32 v248, v2, 3, v248
  v_mov_b32 v72, 0
  v_mov_b32 v73, 0
  v_mov_b32 v74, 0x3c00
  v_mov_b32 v75, 0x3c000000
  v_cmp_eq_u32 vcc, 28, v0
  s_nop 1
  v_cndmask_b32 v72, v72, v74, vcc
  v_cmp_eq_u32 vcc, 29, v0
  s_nop 1
  v_cndmask_b32 v72, v72, v75, vcc
  v_cmp_eq_u32 vcc, 30, v0
  s_nop 1
  v_cndmask_b32 v73, v73, v74, vcc
  v_cmp_eq_u32 vcc, 31, v0
  s_nop 1
  v_cndmask_b32 v73, v73, v75, vcc
  v_lshl_add_u32 v9, v0, 3, s67
  ds_write_b64 v9, v[72:73]
  v_mov_b32 v88, 0
  v_mov_b32 v89, 0
  v_mov_b32 v90, 0
  v_mov_b32 v91, 0
  v_mov_b32 v92, 0
  v_mov_b32 v93, 0
  v_mov_b32 v94, 0
  v_mov_b32 v95, 0
  v_mov_b32 v96, 0
  v_mov_b32 v97, 0
  v_mov_b32 v98, 0
  v_mov_b32 v99, 0
  v_mov_b32 v100, 0
  v_mov_b32 v101, 0
  v_mov_b32 v102, 0
  v_mov_b32 v103, 0
  v_mov_b32 v104, 0
  v_mov_b32 v105, 0
  v_mov_b32 v106, 0
  v_mov_b32 v107, 0
  v_mov_b32 v108, 0
  v_mov_b32 v109, 0
  v_mov_b32 v110, 0
  v_mov_b32 v111, 0
  v_mov_b32 v112, 0
  v_mov_b32 v113, 0
  v_mov_b32 v114, 0
  v_mov_b32 v115, 0
  v_mov_b32 v116, 0
  v_mov_b32 v117, 0
  v_mov_b32 v118, 0
  v_mov_b32 v119, 0
  v_mov_b32 v120, 0
  v_mov_b32 v121, 0
  v_mov_b32 v122, 0
  v_mov_b32 v123, 0
  s_branch FIRST1
NOTFIRST1:
  s_waitcnt vmcnt(0)
FIRST1:
  s_lshl_b32 s3, s57, 5
  v_lshrrev_b32 v2, 3, v0
  v_add_u32 v2, s3, v2
  s_mov_b32 s3, 58368
  v_mul_u32_u24 v2, s3, v2
  v_and_b32 v3, 7, v0
  v_lshl_add_u32 v2, v3, 4, v2
  v_lshlrev_b32 v3, 1, v3
  s_sub_i32 s68, s61, 15
  s_add_i32 s69, s68, s60
  s_max_i32 s68, s68, 0
  s_lshl_b32 s3, s68, 3
  v_add_u32 v2, s3, v2
  v_add_u32 v4, s68, v3
  v_mov_b32 v9, 1
  s_waitcnt lgkmcnt(0)
  s_barrier
  s_waitcnt vmcnt(3)
  v_ashrrev_i32 v5, 31, v131
  v_bfi_b32 v5, v5, 0, v130
  s_mov_b32 s3, 0
  v_mov_b32_dpp v6, v5 quad_perm:[3,3,3,3] row_mask:0xf bank_mask:0xf
  s_nop 1
  v_or_b32_dpp v6, v6, v6 row_half_mirror row_mask:0xf bank_mask:0xf
  v_lshrrev_b32 v220, 16, v6
  v_and_b32 v6, 0xffff, v6
  v_lshl_add_u32 v6, v6, 3, v2
  v_add_u32 v224, s3, v6
  v_min_i32 v216, s69, v220
  v_sub_u32 v216, v216, v4
  v_cmp_lt_i32 vcc, 0, v216
  s_nop 1
  v_cndmask_b32 v6, -16, v224, vcc
  buffer_load_dwordx4 v[144:147], v6, s[20:23], 0 offen
  s_waitcnt vmcnt(3)
  v_ashrrev_i32 v5, 31, v135
  v_bfi_b32 v5, v5, 0, v134
  s_mov_b32 s3, 466944
  v_mov_b32_dpp v6, v5 quad_perm:[3,3,3,3] row_mask:0xf bank_mask:0xf
  s_nop 1
  v_or_b32_dpp v6, v6, v6 row_half_mirror row_mask:0xf bank_mask:0xf
  v_lshrrev_b32 v221, 16, v6
  v_and_b32 v6, 0xffff, v6
  v_lshl_add_u32 v6, v6, 3, v2
  v_add_u32 v225, s3, v6
  v_min_i32 v217, s69, v221
  v_sub_u32 v217, v217, v4
  v_cmp_lt_i32 vcc, 0, v217
  s_nop 1
  v_cndmask_b32 v6, -16, v225, vcc
  buffer_load_dwordx4 v[148:151], v6, s[20:23], 0 offen
  s_waitcnt vmcnt(3)
  v_ashrrev_i32 v5, 31, v139
  v_bfi_b32 v5, v5, 0, v138
  s_mov_b32 s3, 933888
  v_mov_b32_dpp v6, v5 quad_perm:[3,3,3,3] row_mask:0xf bank_mask:0xf
  s_nop 1
  v_or_b32_dpp v6, v6, v6 row_half_mirror row_mask:0xf bank_mask:0xf
  v_lshrrev_b32 v222, 16, v6
  v_and_b32 v6, 0xffff, v6
  v_lshl_add_u32 v6, v6, 3, v2
  v_add_u32 v226, s3, v6
  v_min_i32 v218, s69, v222
  v_sub_u32 v218, v218, v4
  v_cmp_lt_i32 vcc, 0, v218
  s_nop 1
  v_cndmask_b32 v6, -16, v226, vcc
  buffer_load_dwordx4 v[152:155], v6, s[20:23], 0 offen
  s_waitcnt vmcnt(3)
  v_ashrrev_i32 v5, 31, v143
  v_bfi_b32 v5, v5, 0, v142
  s_mov_b32 s3, 1400832
  v_mov_b32_dpp v6, v5 quad_perm:[3,3,3,3] row_mask:0xf bank_mask:0xf
  s_nop 1
  v_or_b32_dpp v6, v6, v6 row_half_mirror row_mask:0xf bank_mask:0xf
  v_lshrrev_b32 v223, 16, v6
  v_and_b32 v6, 0xffff, v6
  v_lshl_add_u32 v6, v6, 3, v2
  v_add_u32 v227, s3, v6
  v_min_i32 v219, s69, v223
  v_sub_u32 v219, v219, v4
  v_cmp_lt_i32 vcc, 0, v219
  s_nop 1
  v_cndmask_b32 v6, -16, v227, vcc
  buffer_load_dwordx4 v[156:159], v6, s[20:23], 0 offen
  s_cmp_eq_u32 s63, 0
  s_cbranch_scc1 NOLATE1
  s_lshl_b32 m0, s57, 10
  s_add_u32 m0, m0, 130560
  s_nop 0
  buffer_load_dwordx4 v10, s[20:23], 0 offen lds
  v_add_u32 v10, 0x2000, v10
  s_lshl_b32 m0, s57, 10
  s_add_u32 m0, m0, 138752
  s_nop 0
  buffer_load_dwordx4 v10, s[20:23], 0 offen lds
  v_add_u32 v10, 0x2000, v10
  s_lshl_b32 m0, s57, 10
  s_add_u32 m0, m0, 146944
  s_nop 0
  buffer_load_dwordx4 v10, s[20:23], 0 offen lds
NOLATE1:
  v_max3_i32 v5, v216, v217, v218
  v_max_i32 v5, v5, v219
  v_cmp_lt_i32 s[76:77], 16, v5
  v_max3_i32 v5, v220, v221, v222
  v_max_i32 v5, v5, v223
  s_max_i32 s69, s69, 0
  v_cmp_lt_i32 s[68:69], s69, v5
  s_cmp_eq_u64 s[76:77], 0
  s_cbranch_scc1 NOL2A
  v_cmpx_lt_i32 vcc, 16, v216
  buffer_load_dwordx4 v[160:163], v224, s[20:23], 0 offen offset:128
  s_mov_b64 exec, -1
  v_cmpx_lt_i32 vcc, 16, v217
  buffer_load_dwordx4 v[164:167], v225, s[20:23], 0 offen offset:128
  s_mov_b64 exec, -1
  v_cmpx_lt_i32 vcc, 16, v218
  buffer_load_dwordx4 v[168:171], v226, s[20:23], 0 offen offset:128
  s_mov_b64 exec, -1
  v_cmpx_lt_i32 vcc, 16, v219
  buffer_load_dwordx4 v[172:175], v227, s[20:23], 0 offen offset:128
  s_mov_b64 exec, -1
NOL2A:
  s_cmp_lg_u32 s63, 0
  s_cbranch_scc1 FIRST2
  s_add_u32 s3, s61, s60
  v_add_u32 v5, 0, v3
  v_cmp_le_u32 s[32:33], s3, v5
  v_cmp_gt_u32 s[34:35], s61, v5
  s_or_b64 s[34:35], s[34:35], s[32:33]
  v_cmp_gt_i32 vcc, 0, v129
  s_and_b64 vcc, vcc, s[32:33]
  s_or_b64 s[68:69], s[68:69], vcc
  v_cndmask_b32 v129, v129, 0, s[34:35]
  v_cmp_gt_i32 vcc, 0, v133
  s_and_b64 vcc, vcc, s[32:33]
  s_or_b64 s[68:69], s[68:69], vcc
  v_cndmask_b32 v133, v133, 0, s[34:35]
  v_cmp_gt_i32 vcc, 0, v137
  s_and_b64 vcc, vcc, s[32:33]
  s_or_b64 s[68:69], s[68:69], vcc
  v_cndmask_b32 v137, v137, 0, s[34:35]
  v_cmp_gt_i32 vcc, 0, v141
  s_and_b64 vcc, vcc, s[32:33]
  s_or_b64 s[68:69], s[68:69], vcc
  v_cndmask_b32 v141, v141, 0, s[34:35]
  v_add_u32 v5, 1, v3
  v_cmp_le_u32 s[32:33], s3, v5
  v_cmp_gt_u32 s[34:35], s61, v5
  s_or_b64 s[34:35], s[34:35], s[32:33]
  v_cmp_gt_i32 vcc, 0, v131
  s_and_b64 vcc, vcc, s[32:33]
  s_or_b64 s[68:69], s[68:69], vcc
  v_cndmask_b32 v131, v131, 0, s[34:35]
  v_cmp_gt_i32 vcc, 0, v135
  s_and_b64 vcc, vcc, s[32:33]
  s_or_b64 s[68:69], s[68:69], vcc
  v_cndmask_b32 v135, v135, 0, s[34:35]
  v_cmp_gt_i32 vcc, 0, v139
  s_and_b64 vcc, vcc, s[32:33]
  s_or_b64 s[68:69], s[68:69], vcc
  v_cndmask_b32 v139, v139, 0, s[34:35]
  v_cmp_gt_i32 vcc, 0, v143
  s_and_b64 vcc, vcc, s[32:33]
  s_or_b64 s[68:69], s[68:69], vcc
  v_cndmask_b32 v143, v143, 0, s[34:35]
  s_waitcnt vmcnt(0)
FIRST2:
  s_cmp_eq_u64 s[68:69], 0
  s_cbranch_scc1 NOFLAG
  v_mov_b32 v5, 35328
  ds_write_b32 v5, v5
NOFLAG:
  v_cmp_gt_i32 s[32:33], 0, v129
  v_lshlrev_b32_sdwa v200, 2, v129 dst_sel:DWORD dst_unused:UNUSED_PAD src0_sel:DWORD src1_sel:BYTE_3
  v_cmp_gt_i32 s[34:35], 0, v131
  v_lshlrev_b32_sdwa v201, 2, v131 dst_sel:DWORD dst_unused:UNUSED_PAD src0_sel:DWORD src1_sel:BYTE_3
  v_cmp_gt_i32 s[36:37], 0, v133
  v_lshlrev_b32_sdwa v202, 2, v133 dst_sel:DWORD dst_unused:UNUSED_PAD src0_sel:DWORD src1_sel:BYTE_3
  v_cmp_gt_i32 s[38:39], 0, v135
  v_lshlrev_b32_sdwa v203, 2, v135 dst_sel:DWORD dst_unused:UNUSED_PAD src0_sel:DWORD src1_sel:BYTE_3
  v_cmp_gt_i32 s[40:41], 0, v137
  v_lshlrev_b32_sdwa v204, 2, v137 dst_sel:DWORD dst_unused:UNUSED_PAD src0_sel:DWORD src1_sel:BYTE_3
  v_cmp_gt_i32 s[42:43], 0, v139
  v_lshlrev_b32_sdwa v205, 2, v139 dst_sel:DWORD dst_unused:UNUSED_PAD src0_sel:DWORD src1_sel:BYTE_3
  v_cmp_gt_i32 s[44:45], 0, v141
  v_lshlrev_b32_sdwa v206, 2, v141 dst_sel:DWORD dst_unused:UNUSED_PAD src0_sel:DWORD src1_sel:BYTE_3
  v_cmp_gt_i32 s[46:47], 0, v143
  v_lshlrev_b32_sdwa v207, 2, v143 dst_sel:DWORD dst_unused:UNUSED_PAD src0_sel:DWORD src1_sel:BYTE_3
  s_mov_b64 exec, s[32:33]
  ds_add_rtn_u32 v176, v200, v9 offset:34304
  s_mov_b64 exec, s[34:35]
  ds_add_rtn_u32 v177, v201, v9 offset:34304
  s_mov_b64 exec, s[36:37]
  ds_add_rtn_u32 v178, v202, v9 offset:34304
  s_mov_b64 exec, s[38:39]
  ds_add_rtn_u32 v179, v203, v9 offset:34304
  s_mov_b64 exec, s[40:41]
  ds_add_rtn_u32 v180, v204, v9 offset:34304
  s_mov_b64 exec, s[42:43]
  ds_add_rtn_u32 v181, v205, v9 offset:34304
  s_mov_b64 exec, s[44:45]
  ds_add_rtn_u32 v182, v206, v9 offset:34304
  s_mov_b64 exec, s[46:47]
  ds_add_rtn_u32 v183, v207, v9 offset:34304
  s_mov_b64 exec, -1
  s_cmp_eq_u32 s63, 0
  s_cbranch_scc1 NOLATE2
  s_lshl_b32 m0, s57, 10
  s_add_u32 m0, m0, 114176
  s_nop 0
  buffer_load_dwordx4 v13, s[24:27], 0 offen lds
  v_add_u32 v13, 0x2000, v13
  s_lshl_b32 m0, s57, 10
  s_add_u32 m0, m0, 122368
  s_nop 0
  buffer_load_dwordx4 v13, s[24:27], 0 offen lds
NOLATE2:
  v_lshlrev_b32 v2, 2, v0
  v_lshrrev_b32 v8, 4, v0
  v_mul_u32_u24 v8, 544, v8
  v_and_b32 v3, 0x30, v0
  v_add_u32 v3, 35456, v3
  v_cmp_lt_i32 s[48:49], 0, v216
  v_cmp_lt_i32 s[50:51], 1, v216
  v_cmp_lt_i32 s[52:53], 0, v217
  v_cmp_lt_i32 s[96:97], 1, v217
  v_cmp_lt_i32 s[98:99], 0, v218
  v_cmp_lt_i32 s[100:101], 1, v218
  v_cmp_lt_i32 s[68:69], 0, v219
  s_waitcnt lgkmcnt(0)
  s_barrier
  ds_read2st64_b32 v[4:5], v2 offset0:136 offset1:137
  s_waitcnt lgkmcnt(0)
  v_mov_b32 v6, v4
  v_mov_b32 v7, v5
  s_nop 0
  v_add_u32_dpp v6, v6, v6 row_shr:1 row_mask:0xf bank_mask:0xf
  v_add_u32_dpp v7, v7, v7 row_shr:1 row_mask:0xf bank_mask:0xf
  s_nop 0
  v_add_u32_dpp v6, v6, v6 row_shr:2 row_mask:0xf bank_mask:0xf
  v_add_u32_dpp v7, v7, v7 row_shr:2 row_mask:0xf bank_mask:0xf
  s_nop 0
  v_add_u32_dpp v6, v6, v6 row_shr:4 row_mask:0xf bank_mask:0xf
  v_add_u32_dpp v7, v7, v7 row_shr:4 row_mask:0xf bank_mask:0xf
  s_nop 0
  v_add_u32_dpp v6, v6, v6 row_shr:8 row_mask:0xf bank_mask:0xf
  v_add_u32_dpp v7, v7, v7 row_shr:8 row_mask:0xf bank_mask:0xf
  v_sub_u32 v6, v6, v4
  v_sub_u32 v7, v7, v5
  v_add_u32 v4, v6, v8
  v_add3_u32 v5, v7, v8, s55
  ds_write2st64_b32 v2, v4, v5 offset0:140 offset1:141
  v_max_u32 v8, v6, v7
  v_cmp_lt_u32 vcc, 0x200, v8
  s_mov_b32 exec_lo, 0x80008000
  s_mov_b32 exec_hi, 0x80008000
  ds_write2_b32 v3, v4, v5 offset0:1 offset1:17
  s_mov_b64 exec, -1
  v_mov_b32 v8, 1
  v_mov_b32 v9, 0
  s_cbranch_vccz NOOVF1
  s_mov_b64 s[32:33], 0
  s_mov_b64 s[34:35], 0
  s_mov_b64 s[36:37], 0
  s_mov_b64 s[38:39], 0
  s_mov_b64 s[40:41], 0
  s_mov_b64 s[42:43], 0
  s_mov_b64 s[44:45], 0
  s_mov_b64 s[46:47], 0
NOOVF1:
  v_cmp_lt_i32 vcc, 1, v219
  s_waitcnt vmcnt(5)
  v_and_b32_sdwa v208, s95, v145 dst_sel:DWORD dst_unused:UNUSED_PAD src0_sel:DWORD src1_sel:BYTE_3
  v_and_b32_sdwa v209, s95, v147 dst_sel:DWORD dst_unused:UNUSED_PAD src0_sel:DWORD src1_sel:BYTE_3
  v_and_b32_sdwa v210, s95, v149 dst_sel:DWORD dst_unused:UNUSED_PAD src0_sel:DWORD src1_sel:BYTE_3
  v_and_b32_sdwa v211, s95, v151 dst_sel:DWORD dst_unused:UNUSED_PAD src0_sel:DWORD src1_sel:BYTE_3
  v_and_b32_sdwa v212, s95, v153 dst_sel:DWORD dst_unused:UNUSED_PAD src0_sel:DWORD src1_sel:BYTE_3
  v_and_b32_sdwa v213, s95, v155 dst_sel:DWORD dst_unused:UNUSED_PAD src0_sel:DWORD src1_sel:BYTE_3
  v_and_b32_sdwa v214, s95, v157 dst_sel:DWORD dst_unused:UNUSED_PAD src0_sel:DWORD src1_sel:BYTE_3
  v_and_b32_sdwa v215, s95, v159 dst_sel:DWORD dst_unused:UNUSED_PAD src0_sel:DWORD src1_sel:BYTE_3
  s_mov_b64 exec, s[48:49]
  ds_add_rtn_u64 v[184:185], v208, v[8:9] offset:35328
  s_mov_b64 exec, s[50:51]
  ds_add_rtn_u64 v[186:187], v209, v[8:9] offset:35328
  s_mov_b64 exec, s[52:53]
  ds_add_rtn_u64 v[188:189], v210, v[8:9] offset:35328
  s_mov_b64 exec, s[96:97]
  ds_add_rtn_u64 v[190:191], v211, v[8:9] offset:35328
  s_mov_b64 exec, s[98:99]
  ds_add_rtn_u64 v[192:193], v212, v[8:9] offset:35328
  s_mov_b64 exec, s[100:101]
  ds_add_rtn_u64 v[194:195], v213, v[8:9] offset:35328
  s_mov_b64 exec, s[68:69]
  ds_add_rtn_u64 v[196:197], v214, v[8:9] offset:35328
  s_mov_b64 exec, vcc
  ds_add_rtn_u64 v[198:199], v215, v[8:9] offset:35328
  s_mov_b64 exec, -1
  ds_read_b32 v200, v200 offset:35328
  ds_read_b32 v201, v201 offset:35328
  ds_read_b32 v202, v202 offset:35328
  ds_read_b32 v203, v203 offset:35328
  ds_read_b32 v204, v204 offset:35328
  ds_read_b32 v205, v205 offset:35328
  ds_read_b32 v206, v206 offset:35328
  ds_read_b32 v207, v207 offset:35328
  s_cmp_eq_u32 s63, 0
  s_cbranch_scc1 NOLATE4
  s_mul_i32 m0, s57, 4608
  s_add_u32 m0, m0, 44544
  s_nop 0
  buffer_load_dwordx4 v56, s[4:7], 0 offen lds
  s_mul_i32 m0, s57, 4608
  s_add_u32 m0, m0, 45568
  s_nop 0
  buffer_load_dwordx4 v57, s[4:7], 0 offen lds
NOLATE4:
  s_mul_i32 s3, s57, 2176
  v_lshrrev_b32 v2, 3, v0
  v_lshl_add_u32 v250, v2, 4, s3
  v_and_b32 v2, 31, v0
  v_lshl_add_u32 v251, v2, 2, s3
  v_bfe_u32 v2, v0, 2, 2
  v_lshl_add_u32 v2, v2, 4, s3
  v_lshl_add_u32 v252, v254, 2, v2
  v_mov_b32 v2, 35328
  s_waitcnt lgkmcnt(8)
  v_add_lshl_u32 v208, v184, v185, 2
  v_min_u32 v208, s94, v208
  v_add_lshl_u32 v209, v186, v187, 2
  v_min_u32 v209, s94, v209
  v_add_lshl_u32 v210, v188, v189, 2
  v_min_u32 v210, s94, v210
  v_add_lshl_u32 v211, v190, v191, 2
  v_min_u32 v211, s94, v211
  v_add_lshl_u32 v212, v192, v193, 2
  v_min_u32 v212, s94, v212
  v_add_lshl_u32 v213, v194, v195, 2
  v_min_u32 v213, s94, v213
  v_add_lshl_u32 v214, v196, v197, 2
  v_min_u32 v214, s94, v214
  v_add_lshl_u32 v215, v198, v199, 2
  v_min_u32 v215, s94, v215
  s_waitcnt lgkmcnt(6)
  v_add_lshl_u32 v200, v200, v176, 2
  v_add_lshl_u32 v201, v201, v177, 2
  s_waitcnt lgkmcnt(4)
  v_add_lshl_u32 v202, v202, v178, 2
  v_add_lshl_u32 v203, v203, v179, 2
  s_waitcnt lgkmcnt(2)
  v_add_lshl_u32 v204, v204, v180, 2
  v_add_lshl_u32 v205, v205, v181, 2
  s_waitcnt lgkmcnt(0)
  v_add_lshl_u32 v206, v206, v182, 2
  v_add_lshl_u32 v207, v207, v183, 2
  s_mov_b64 exec, s[32:33]
  ds_write2st64_b32 v200, v128, v129 offset0:0 offset1:68
  s_mov_b64 exec, s[34:35]
  ds_write2st64_b32 v201, v130, v131 offset0:0 offset1:68
  s_mov_b64 exec, s[36:37]
  ds_write2st64_b32 v202, v132, v133 offset0:0 offset1:68
  s_mov_b64 exec, s[38:39]
  ds_write2st64_b32 v203, v134, v135 offset0:0 offset1:68
  s_mov_b64 exec, -1
  s_cmp_eq_u32 s63, 0
  s_cbranch_scc1 NOLATE5
  s_mul_i32 m0, s57, 4608
  s_add_u32 m0, m0, 46592
  s_nop 0
  buffer_load_dwordx4 v58, s[4:7], 0 offen lds
NOLATE5:
  s_mov_b64 exec, s[40:41]
  ds_write2st64_b32 v204, v136, v137 offset0:0 offset1:68
  s_mov_b64 exec, s[42:43]
  ds_write2st64_b32 v205, v138, v139 offset0:0 offset1:68
  s_mov_b64 exec, s[44:45]
  ds_write2st64_b32 v206, v140, v141 offset0:0 offset1:68
  s_mov_b64 exec, s[46:47]
  ds_write2st64_b32 v207, v142, v143 offset0:0 offset1:68
  s_mov_b64 exec, -1
  s_cmp_eq_u32 s63, 0
  s_cbranch_scc1 NOLATE6
  s_mul_i32 m0, s57, 4608
  s_add_u32 m0, m0, 47616
  s_nop 0
  buffer_load_dwordx4 v59, s[4:7], 0 offen lds
NOLATE6:
  s_mov_b64 exec, s[48:49]
  ds_write2st64_b32 v208, v144, v145 offset0:0 offset1:68
  s_mov_b64 exec, s[50:51]
  ds_write2st64_b32 v209, v146, v147 offset0:0 offset1:68
  s_mov_b64 exec, s[52:53]
  ds_write2st64_b32 v210, v148, v149 offset0:0 offset1:68
  s_mov_b64 exec, s[96:97]
  ds_write2st64_b32 v211, v150, v151 offset0:0 offset1:68
  s_mov_b64 exec, s[98:99]
  ds_write2st64_b32 v212, v152, v153 offset0:0 offset1:68
  s_mov_b64 exec, s[100:101]
  ds_write2st64_b32 v213, v154, v155 offset0:0 offset1:68
  s_mov_b64 exec, s[68:69]
  ds_write2st64_b32 v214, v156, v157 offset0:0 offset1:68
  s_mov_b64 exec, vcc
  ds_write2st64_b32 v215, v158, v159 offset0:0 offset1:68
  s_mov_b64 exec, -1
  s_cmp_eq_u64 s[76:77], 0
  s_cbranch_scc1 NOL2B
  s_waitcnt vmcnt(0) lgkmcnt(0)
  v_cmpx_lt_i32 vcc, 16, v216
  v_and_b32_sdwa v208, s95, v161 dst_sel:DWORD dst_unused:UNUSED_PAD src0_sel:DWORD src1_sel:BYTE_3
  ds_add_rtn_u64 v[184:185], v208, v[8:9] offset:35328
  v_cmpx_lt_i32 vcc, 17, v216
  v_and_b32_sdwa v209, s95, v163 dst_sel:DWORD dst_unused:UNUSED_PAD src0_sel:DWORD src1_sel:BYTE_3
  ds_add_rtn_u64 v[186:187], v209, v[8:9] offset:35328
  s_mov_b64 exec, -1
  v_cmpx_lt_i32 vcc, 16, v217
  v_and_b32_sdwa v210, s95, v165 dst_sel:DWORD dst_unused:UNUSED_PAD src0_sel:DWORD src1_sel:BYTE_3
  ds_add_rtn_u64 v[188:189], v210, v[8:9] offset:35328
  v_cmpx_lt_i32 vcc, 17, v217
  v_and_b32_sdwa v211, s95, v167 dst_sel:DWORD dst_unused:UNUSED_PAD src0_sel:DWORD src1_sel:BYTE_3
  ds_add_rtn_u64 v[190:191], v211, v[8:9] offset:35328
  s_mov_b64 exec, -1
  v_cmpx_lt_i32 vcc, 16, v218
  v_and_b32_sdwa v212, s95, v169 dst_sel:DWORD dst_unused:UNUSED_PAD src0_sel:DWORD src1_sel:BYTE_3
  ds_add_rtn_u64 v[192:193], v212, v[8:9] offset:35328
  v_cmpx_lt_i32 vcc, 17, v218
  v_and_b32_sdwa v213, s95, v171 dst_sel:DWORD dst_unused:UNUSED_PAD src0_sel:DWORD src1_sel:BYTE_3
  ds_add_rtn_u64 v[194:195], v213, v[8:9] offset:35328
  s_mov_b64 exec, -1
  v_cmpx_lt_i32 vcc, 16, v219
  v_and_b32_sdwa v214, s95, v173 dst_sel:DWORD dst_unused:UNUSED_PAD src0_sel:DWORD src1_sel:BYTE_3
  ds_add_rtn_u64 v[196:197], v214, v[8:9] offset:35328
  v_cmpx_lt_i32 vcc, 17, v219
  v_and_b32_sdwa v215, s95, v175 dst_sel:DWORD dst_unused:UNUSED_PAD src0_sel:DWORD src1_sel:BYTE_3
  ds_add_rtn_u64 v[198:199], v215, v[8:9] offset:35328
  s_mov_b64 exec, -1
  s_waitcnt lgkmcnt(0)
  v_cmpx_lt_i32 vcc, 16, v216
  v_add_lshl_u32 v208, v184, v185, 2
  v_min_u32 v208, s94, v208
  ds_write2st64_b32 v208, v160, v161 offset0:0 offset1:68
  v_cmpx_lt_i32 vcc, 17, v216
  v_add_lshl_u32 v209, v186, v187, 2
  v_min_u32 v209, s94, v209
  ds_write2st64_b32 v209, v162, v163 offset0:0 offset1:68
  s_mov_b64 exec, -1
  v_cmpx_lt_i32 vcc, 16, v217
  v_add_lshl_u32 v210, v188, v189, 2
  v_min_u32 v210, s94, v210
  ds_write2st64_b32 v210, v164, v165 offset0:0 offset1:68
  v_cmpx_lt_i32 vcc, 17, v217
  v_add_lshl_u32 v211, v190, v191, 2
  v_min_u32 v211, s94, v211
  ds_write2st64_b32 v211, v166, v167 offset0:0 offset1:68
  s_mov_b64 exec, -1
  v_cmpx_lt_i32 vcc, 16, v218
  v_add_lshl_u32 v212, v192, v193, 2
  v_min_u32 v212, s94, v212
  ds_write2st64_b32 v212, v168, v169 offset0:0 offset1:68
  v_cmpx_lt_i32 vcc, 17, v218
  v_add_lshl_u32 v213, v194, v195, 2
  v_min_u32 v213, s94, v213
  ds_write2st64_b32 v213, v170, v171 offset0:0 offset1:68
  s_mov_b64 exec, -1
  v_cmpx_lt_i32 vcc, 16, v219
  v_add_lshl_u32 v214, v196, v197, 2
  v_min_u32 v214, s94, v214
  ds_write2st64_b32 v214, v172, v173 offset0:0 offset1:68
  v_cmpx_lt_i32 vcc, 17, v219
  v_add_lshl_u32 v215, v198, v199, 2
  v_min_u32 v215, s94, v215
  ds_write2st64_b32 v215, v174, v175 offset0:0 offset1:68
  s_mov_b64 exec, -1
NOL2B:
  s_cmp_eq_u32 s63, 0
  s_cbranch_scc1 NOLATE7
  buffer_load_dwordx2 v[124:125], v11, s[12:15], 0 offen
NOLATE7:
  s_mov_b32 s63, 0
  v_mov_b32 v228, 0
  v_mov_b32 v229, 0
  v_mov_b32 v230, 0
  v_mov_b32 v231, 0
  s_and_b32 s62, s57, 3
  s_lshl_b32 s62, s62, 4
  s_add_u32 s62, s62, 15
  s_waitcnt vmcnt(5) lgkmcnt(0)
  s_barrier
  ds_read2_b32 v[4:5], v3 offset0:0 offset1:16
  ds_read_b32 v8, v2
  ds_read_b128 v[224:227], v250 offset:0
  ds_read_b32 v232, v251 offset:0
  ds_read_b32 v1, v251 offset:17408
  s_waitcnt lgkmcnt(3)
  v_add_u32 v6, v6, v4
  v_add_u32 v7, v7, v5
  v_max_u32 v4, v6, v7
  v_cmp_lt_u32 vcc, 0x200, v4
  v_readlane_b32 s68, v6, s62
  v_readlane_b32 s69, v7, s62
  v_readfirstlane_b32 s62, v8
  s_cbranch_vccz NOOVF
  s_lshr_b32 s60, s60, 1
  s_waitcnt vmcnt(0) lgkmcnt(0)
  s_barrier
  s_branch ROUND
NOOVF:
  s_cmp_ge_u32 s57, 4
  s_cselect_b32 s68, s69, s68
  s_add_u32 s59, s68, 31
  s_lshr_b32 s59, s59, 5
  v_add_u32 v2, s68, v0
  s_lshl_b32 s69, s59, 5
  v_lshl_add_u32 v3, v2, 2, s3
  s_sub_u32 s3, s58, s69
  v_add_u32 v4, s3, v2
  v_mov_b32 v5, 0xffff
  v_cmp_gt_u32 vcc, s69, v2
  s_nop 1
  v_cndmask_b32 v4, v4, v5, vcc
  v_or_b32 v4, 0xf8000000, v4
  v_mov_b32 v5, 0x00ffffff
  s_add_u32 s69, s69, 32
  v_cmpx_gt_u32 vcc, s69, v2
  ds_write2st64_b32 v3, v4, v5 offset0:0 offset1:68
  s_mov_b64 exec, -1
  s_cmp_ge_u32 s68, 32
  s_cbranch_scc1 FULL0
  ds_read_b128 v[224:227], v250 offset:0
  ds_read_b32 v232, v251 offset:0
  ds_read_b32 v1, v251 offset:17408
  s_waitcnt lgkmcnt(0)
FULL0:
  s_waitcnt lgkmcnt(1)
  s_cmp_gt_i32 s59, -1
  s_cselect_b32 s6, 6400000, 0
  s_cselect_b32 s10, 25600000, 0
  s_cselect_b32 s14, 300000, 0
  v_mad_u32_u24 v1, v1, 32, v254
  buffer_load_dwordx4 v[216:219], v1, s[8:11], 0 offen
  s_add_u32 m0, s66, 0
  v_mad_u32_u24 v224, v224, s64, v237
  buffer_load_dwordx4 v224, s[4:7], 0 offen  lds
  s_add_u32 m0, s66, 1024
  v_mad_u32_u24 v225, v225, s64, v238
  buffer_load_dwordx4 v225, s[4:7], 0 offen  lds
  s_add_u32 m0, s66, 2048
  v_mad_u32_u24 v226, v226, s64, v239
  buffer_load_dwordx4 v226, s[4:7], 0 offen  lds
  s_add_u32 m0, s66, 3072
  v_mad_u32_u24 v227, v227, s64, v240
  buffer_load_dwordx4 v227, s[4:7], 0 offen  lds
  v_mul_u32_u24 v1, 6, v232
  v_and_b32 v1, -4, v1
  s_mov_b64 exec, s[74:75]
  buffer_load_dwordx2 v[228:229], v1, s[12:15], 0 offen
  s_mov_b64 exec, -1
  ds_read_b128 v[224:227], v250 offset:128
  ds_read_b32 v233, v251 offset:128
  ds_read_b32 v1, v251 offset:17536
  s_waitcnt lgkmcnt(0)
  s_cmp_eq_u32 s54, 0
  s_cbranch_scc1 NOINIT2
  v_lshlrev_b32 v2, 4, v0
  v_add_u32 v2, 130560, v2
  s_lshl_b32 s3, s57, 9
  s_sub_u32 s3, s3, 36864
  s_waitcnt vmcnt(6)
  v_add_u32 v6, s3, v241
  ds_read_b128 v[200:203], v6
  v_add_u32 v7, s3, v242
  ds_read_b128 v[204:207], v7
  v_add_u32 v8, s3, v243
  ds_read_b128 v[208:211], v8
  v_add_u32 v9, s3, v244
  ds_read_b128 v[212:215], v9
  ds_read_b128 v[128:131], v2 offset:0
  ds_read_b128 v[132:135], v2 offset:1024
  ds_read_b128 v[136:139], v2 offset:2048
  ds_read_b128 v[140:143], v2 offset:3072
  ds_read_b128 v[144:147], v2 offset:4096
  ds_read_b128 v[148:151], v2 offset:5120
  ds_read_b128 v[152:155], v2 offset:6144
  ds_read_b128 v[156:159], v2 offset:7168
  ds_read_b64 v[4:5], v2 offset:18432
  ds_read_b128 v[16:19], v2 offset:8192
  ds_read_b128 v[20:23], v2 offset:9216
  ds_read_b128 v[24:27], v2 offset:10240
  ds_read_b128 v[28:31], v2 offset:11264
  ds_read_b128 v[32:35], v2 offset:12288
  ds_read_b128 v[36:39], v2 offset:13312
  ds_read_b128 v[40:43], v2 offset:14336
  ds_read_b128 v[44:47], v2 offset:15360
  ds_read_b128 v[48:51], v2 offset:16384
  ds_read_b128 v[52:55], v2 offset:17408
  ds_read_b128 v[72:75], v2 offset:20480
  ds_read_b128 v[76:79], v2 offset:21504
  ds_read_b128 v[80:83], v2 offset:22528
  ds_read_b128 v[84:87], v2 offset:23552
  v_lshlrev_b32 v7, 4, v12
  v_alignbit_b32 v8, v125, v124, v7
  v_lshrrev_b32 v9, v7, v125
  v_lshlrev_b32 v6, 16, v8
  v_and_b32 v7, s65, v8
  v_lshlrev_b32 v8, 16, v9
  v_lshl_add_u32 v9, v0, 3, s67
  s_mov_b64 exec, s[74:75]
  ds_write_b64 v9, v[6:7] offset:512
  ds_write_b32 v9, v8 offset:768
  s_mov_b64 exec, -1
  s_waitcnt lgkmcnt(15)
  v_mfma_f32_32x32x16_bf16 v[160:175], v[200:203], v[128:131], 0
  v_mfma_f32_32x32x16_bf16 v[176:191], v[200:203], v[144:147], 0
  v_mfma_f32_32x32x16_bf16 v[160:175], v[204:207], v[132:135], v[160:175]
  v_mfma_f32_32x32x16_bf16 v[176:191], v[204:207], v[148:151], v[176:191]
  v_mfma_f32_32x32x16_bf16 v[160:175], v[208:211], v[136:139], v[160:175]
  v_mfma_f32_32x32x16_bf16 v[176:191], v[208:211], v[152:155], v[176:191]
  v_mfma_f32_32x32x16_bf16 v[160:175], v[212:215], v[140:143], v[160:175]
  v_mfma_f32_32x32x16_bf16 v[176:191], v[212:215], v[156:159], v[176:191]
  s_waitcnt lgkmcnt(0)
  s_mov_b32 s54, 0
  s_nop 7
  s_nop 0
  v_pk_mul_f32 v[160:161], v[160:161], s[70:71]
  v_cvt_pk_f16_f32 v56, v160, v161
  v_pk_mul_f32 v[162:163], v[162:163], s[70:71]
  v_cvt_pk_f16_f32 v57, v162, v163
  v_pk_mul_f32 v[164:165], v[164:165], s[70:71]
  v_cvt_pk_f16_f32 v58, v164, v165
  v_pk_mul_f32 v[166:167], v[166:167], s[70:71]
  v_cvt_pk_f16_f32 v59, v166, v167
  v_pk_mul_f32 v[168:169], v[168:169], s[70:71]
  v_cvt_pk_f16_f32 v60, v168, v169
  v_pk_mul_f32 v[170:171], v[170:171], s[70:71]
  v_cvt_pk_f16_f32 v61, v170, v171
  v_pk_mul_f32 v[172:173], v[172:173], s[70:71]
  v_cvt_pk_f16_f32 v62, v172, v173
  v_pk_mul_f32 v[176:177], v[176:177], s[70:71]
  v_cvt_pk_f16_f32 v64, v176, v177
  v_pk_mul_f32 v[178:179], v[178:179], s[70:71]
  v_cvt_pk_f16_f32 v65, v178, v179
  v_pk_mul_f32 v[180:181], v[180:181], s[70:71]
  v_cvt_pk_f16_f32 v66, v180, v181
  v_pk_mul_f32 v[182:183], v[182:183], s[70:71]
  v_cvt_pk_f16_f32 v67, v182, v183
  v_pk_mul_f32 v[184:185], v[184:185], s[70:71]
  v_cvt_pk_f16_f32 v68, v184, v185
  v_pk_mul_f32 v[186:187], v[186:187], s[70:71]
  v_cvt_pk_f16_f32 v69, v186, v187
  v_pk_mul_f32 v[188:189], v[188:189], s[70:71]
  v_cvt_pk_f16_f32 v70, v188, v189
  v_mov_b32 v63, v4
  v_mov_b32 v71, v5
NOINIT2:
  v_mov_b32 v184, 0
  v_mov_b32 v168, 0
  v_mov_b32 v185, 0
  v_mov_b32 v169, 0
  v_mov_b32 v186, 0
  v_mov_b32 v170, 0
  v_mov_b32 v187, 0
  v_mov_b32 v171, 0
  v_mov_b32 v188, 0
  v_mov_b32 v172, 0
  v_mov_b32 v189, 0
  v_mov_b32 v173, 0
  v_mov_b32 v190, 0
  v_mov_b32 v174, 0
  v_mov_b32 v191, 0
  v_mov_b32 v175, 0
  v_mov_b32 v124, 0
  v_mov_b32 v125, 0
  v_mov_b32 v126, 0
  v_mov_b32 v127, 0
  v_mov_b32 v13, 0
  v_mov_b32 v14, 0
  v_mov_b32 v15, 0
  s_mul_i32 s3, s57, 4608
  s_add_u32 s3, s3, 44544
  v_lshl_add_u32 v2, v0, 3, s3
  ds_write_b64 v2, v[184:185] offset:0
  ds_write_b64 v2, v[184:185] offset:512
  ds_write_b64 v2, v[184:185] offset:1024
  ds_write_b64 v2, v[184:185] offset:1536
  ds_write_b64 v2, v[184:185] offset:2048
  ds_write_b64 v2, v[184:185] offset:2560
  ds_write_b64 v2, v[184:185] offset:3072
  ds_write_b64 v2, v[184:185] offset:3584
  ds_write_b64 v2, v[184:185] offset:4096
  s_waitcnt vmcnt(0)
  ds_read_b128 v[200:203], v241
  ds_read_b128 v[204:207], v242
  ds_read_b128 v[208:211], v243
  ds_read_b128 v[212:215], v244
  v_add_u32_sdwa v253, v245, v232 dst_sel:DWORD dst_unused:UNUSED_PAD src0_sel:DWORD src1_sel:BYTE_3
  ds_read_b64 v[234:235], v253 offset:480
  ds_read_b32 v236, v253 offset:736
  v_lshlrev_b32 v125, 4, v232
  v_alignbit_b32 v126, v229, v228, v125
  v_lshrrev_b32 v127, v125, v229
  ds_read_b64 v[176:177], v253 offset:192
  ds_read_b64 v[178:179], v253 offset:128
  ds_read_b64 v[180:181], v253 offset:64
  ds_read_b32 v182, v253
  v_mfma_f32_32x32x16_bf16 v[128:143], v[48:51], v[216:219], 0
  v_mfma_f32_32x32x16_bf16 v[144:159], v[52:55], v[216:219], 0
  v_lshlrev_b32 v125, 16, v126
  v_and_b32 v126, s65, v126
  v_lshlrev_b32 v127, 16, v127
  s_waitcnt lgkmcnt(5)
  v_sub_f32 v234, v234, v125
  v_sub_f32 v235, v235, v126
  s_waitcnt lgkmcnt(4)
  v_sub_f32 v236, v236, v127
  v_cvt_pk_bf16_f32 v234, v234, v235
  v_cvt_pk_bf16_f32 v236, v236, v236
  v_lshlrev_b32 v10, 16, v234
  v_and_b32 v11, s65, v234
  v_lshlrev_b32 v12, 16, v236
  v_mul_f32 v234, v10, v10
  v_fmac_f32 v234, v11, v11
  v_fmac_f32 v234, v12, v12
  v_cvt_pk_f16_f32 v183, v234, v234
  v_mfma_f32_32x32x16_bf16 v[128:143], v[16:19], v[200:203], v[128:143]
  v_mfma_f32_32x32x16_bf16 v[128:143], v[20:23], v[204:207], v[128:143]
  v_mfma_f32_32x32x16_bf16 v[128:143], v[24:27], v[208:211], v[128:143]
  v_mfma_f32_32x32x16_bf16 v[128:143], v[28:31], v[212:215], v[128:143]
  s_waitcnt lgkmcnt(2)
  v_mfma_f32_32x32x16_f16 v[128:143], v[56:59], v[176:179], v[128:143]
  s_waitcnt lgkmcnt(0)
  v_mfma_f32_32x32x16_f16 v[128:143], v[60:63], v[180:183], v[128:143]
  s_cmp_gt_i32 s59, 0
  s_cselect_b32 s6, 6400000, 0
  s_cselect_b32 s10, 25600000, 0
  s_cselect_b32 s14, 300000, 0
  v_mad_u32_u24 v1, v1, 32, v254
  buffer_load_dwordx4 v[220:223], v1, s[8:11], 0 offen
  s_add_u32 m0, s66, 0
  v_mad_u32_u24 v224, v224, s64, v237
  buffer_load_dwordx4 v224, s[4:7], 0 offen  lds
  s_add_u32 m0, s66, 1024
  v_mad_u32_u24 v225, v225, s64, v238
  buffer_load_dwordx4 v225, s[4:7], 0 offen  lds
  s_add_u32 m0, s66, 2048
  v_mad_u32_u24 v226, v226, s64, v239
  buffer_load_dwordx4 v226, s[4:7], 0 offen  lds
  s_add_u32 m0, s66, 3072
  v_mad_u32_u24 v227, v227, s64, v240
  buffer_load_dwordx4 v227, s[4:7], 0 offen  lds
  v_mul_u32_u24 v1, 6, v233
  v_and_b32 v1, -4, v1
  s_mov_b64 exec, s[74:75]
  buffer_load_dwordx2 v[230:231], v1, s[12:15], 0 offen
  s_mov_b64 exec, -1
  s_waitcnt lgkmcnt(0)
  s_cmp_eq_u32 s59, 0
  s_cbranch_scc1 LOOPEND
  s_cmp_ge_u32 s57, 4
  s_movk_i32 s79, 0
  s_cmovk_i32 s79, 0
LOOP:
  ds_read_b64_tr_b16 v[192:193], v248 offset:64
  ds_read_b64_tr_b16 v[194:195], v248 offset:208
  ds_read_b64_tr_b16 v[196:197], v248 offset:352
  ds_read_b64_tr_b16 v[198:199], v248 offset:496
  v_cvt_pk_f16_f32 v160, v128, v129
  v_cvt_pk_f16_f32 v161, v130, v131
  v_cvt_pk_f16_f32 v162, v132, v133
  v_cvt_pk_f16_f32 v163, v134, v135
  v_cvt_pk_f16_f32 v164, v136, v137
  v_cvt_pk_f16_f32 v165, v138, v139
  v_cvt_pk_f16_f32 v166, v140, v141
  v_cvt_pk_f16_f32 v167, v142, v143
  v_mfma_f32_16x16x32_f16 v[124:127], v[80:83], v[168:171], v[124:127]
  v_exp_f16_sdwa v2, v160 dst_sel:WORD_0 dst_unused:UNUSED_PAD src0_sel:WORD_0
  s_mov_b64 exec, 1
  ds_add_rtn_u32 v255, v0, v238 offset:35336
  s_mov_b64 exec, -1
  v_exp_f16_sdwa v3, v161 dst_sel:WORD_0 dst_unused:UNUSED_PAD src0_sel:WORD_0
  v_mfma_f32_16x16x32_f16 v[124:127], v[84:87], v[172:175], v[124:127]
  v_exp_f16_sdwa v4, v162 dst_sel:WORD_0 dst_unused:UNUSED_PAD src0_sel:WORD_0
  v_exp_f16_sdwa v5, v163 dst_sel:WORD_0 dst_unused:UNUSED_PAD src0_sel:WORD_0
  v_mfma_f32_32x32x16_bf16 v[144:159], v[32:35], v[200:203], v[144:159]
  v_exp_f16_sdwa v2, v160 dst_sel:WORD_1 dst_unused:UNUSED_PRESERVE src0_sel:WORD_1
  v_exp_f16_sdwa v3, v161 dst_sel:WORD_1 dst_unused:UNUSED_PRESERVE src0_sel:WORD_1
  v_exp_f16_sdwa v4, v162 dst_sel:WORD_1 dst_unused:UNUSED_PRESERVE src0_sel:WORD_1
  s_waitcnt lgkmcnt(3)
  v_mfma_f32_32x32x16_f16 v[104:119], v[192:195], v[184:187], v[104:119]
  v_exp_f16_sdwa v5, v163 dst_sel:WORD_1 dst_unused:UNUSED_PRESERVE src0_sel:WORD_1
  v_pk_add_f16 v2, v2, 1.0 op_sel_hi:[1,0]
  v_pk_add_f16 v3, v3, 1.0 op_sel_hi:[1,0]
  v_pk_add_f16 v4, v4, 1.0 op_sel_hi:[1,0]
  v_pk_add_f16 v5, v5, 1.0 op_sel_hi:[1,0]
  v_mul_f32 v234, v13, v124
  v_mul_f32 v235, v14, v124
  v_mul_f32 v236, v15, v124
  v_cvt_pk_f16_f32 v234, v234, v235
  v_cvt_pk_f16_f32 v235, v236, v236
  s_mov_b64 exec, s[74:75]
  ds_write_b64 v246, v[234:235] offset:128
  s_mov_b64 exec, -1
  v_rcp_f16_sdwa v6, v2 dst_sel:WORD_0 dst_unused:UNUSED_PAD src0_sel:WORD_0
  v_rcp_f16_sdwa v7, v3 dst_sel:WORD_0 dst_unused:UNUSED_PAD src0_sel:WORD_0
  s_waitcnt lgkmcnt(2)
  v_mfma_f32_32x32x16_f16 v[104:119], v[196:199], v[188:191], v[104:119]
  ds_read_b64_tr_b16 v[192:193], v249 offset:0
  ds_read_b64_tr_b16 v[194:195], v249 offset:144
  ds_read_b64_tr_b16 v[196:197], v249 offset:288
  ds_read_b64_tr_b16 v[198:199], v249 offset:432
  v_rcp_f16_sdwa v8, v4 dst_sel:WORD_0 dst_unused:UNUSED_PAD src0_sel:WORD_0
  s_waitcnt lgkmcnt(5)
  v_readfirstlane_b32 s68, v255
  s_setprio 1
  s_cmp_lt_i32 s68, s79
  s_cbranch_scc0 PRI0
  s_setprio 0
PRI0:
  s_add_u32 s79, s79, 128
  v_rcp_f16_sdwa v9, v5 dst_sel:WORD_0 dst_unused:UNUSED_PAD src0_sel:WORD_0
  v_rcp_f16_sdwa v6, v2 dst_sel:WORD_1 dst_unused:UNUSED_PRESERVE src0_sel:WORD_1
  v_mfma_f32_32x32x16_bf16 v[144:159], v[36:39], v[204:207], v[144:159]
  v_rcp_f16_sdwa v7, v3 dst_sel:WORD_1 dst_unused:UNUSED_PRESERVE src0_sel:WORD_1
  v_rcp_f16_sdwa v8, v4 dst_sel:WORD_1 dst_unused:UNUSED_PRESERVE src0_sel:WORD_1
  v_rcp_f16_sdwa v9, v5 dst_sel:WORD_1 dst_unused:UNUSED_PRESERVE src0_sel:WORD_1
  v_pk_mul_f16 v160, v160, v6
  v_pk_mul_f16 v161, v161, v7
  v_pk_mul_f16 v162, v162, v8
  v_pk_mul_f16 v163, v163, v9
  ds_write_b128 v246, v[160:163] offset:0
  v_mfma_f32_32x32x16_bf16 v[144:159], v[40:43], v[208:211], v[144:159]
  v_exp_f16_sdwa v2, v164 dst_sel:WORD_0 dst_unused:UNUSED_PAD src0_sel:WORD_0
  v_exp_f16_sdwa v3, v165 dst_sel:WORD_0 dst_unused:UNUSED_PAD src0_sel:WORD_0
  v_exp_f16_sdwa v4, v166 dst_sel:WORD_0 dst_unused:UNUSED_PAD src0_sel:WORD_0
  v_mfma_f32_32x32x16_bf16 v[144:159], v[44:47], v[212:215], v[144:159]
  v_exp_f16_sdwa v5, v167 dst_sel:WORD_0 dst_unused:UNUSED_PAD src0_sel:WORD_0
  v_exp_f16_sdwa v2, v164 dst_sel:WORD_1 dst_unused:UNUSED_PRESERVE src0_sel:WORD_1
  v_exp_f16_sdwa v3, v165 dst_sel:WORD_1 dst_unused:UNUSED_PRESERVE src0_sel:WORD_1
  v_mfma_f32_32x32x16_f16 v[144:159], v[64:67], v[176:179], v[144:159]
  v_exp_f16_sdwa v4, v166 dst_sel:WORD_1 dst_unused:UNUSED_PRESERVE src0_sel:WORD_1
  v_exp_f16_sdwa v5, v167 dst_sel:WORD_1 dst_unused:UNUSED_PRESERVE src0_sel:WORD_1
  v_pk_add_f16 v2, v2, 1.0 op_sel_hi:[1,0]
  v_pk_add_f16 v3, v3, 1.0 op_sel_hi:[1,0]
  v_pk_add_f16 v4, v4, 1.0 op_sel_hi:[1,0]
  v_pk_add_f16 v5, v5, 1.0 op_sel_hi:[1,0]
  v_rcp_f16_sdwa v6, v2 dst_sel:WORD_0 dst_unused:UNUSED_PAD src0_sel:WORD_0
  v_mfma_f32_32x32x16_f16 v[144:159], v[68:71], v[180:183], v[144:159]
  v_rcp_f16_sdwa v7, v3 dst_sel:WORD_0 dst_unused:UNUSED_PAD src0_sel:WORD_0
  s_waitcnt vmcnt(0)
  ds_read_b128 v[200:203], v241
  ds_read_b128 v[204:207], v242
  v_rcp_f16_sdwa v8, v4 dst_sel:WORD_0 dst_unused:UNUSED_PAD src0_sel:WORD_0
  ds_read_b128 v[224:227], v250 offset:256
  ds_read_b32 v232, v251 offset:256
  ds_read_b32 v1, v251 offset:17664
  v_rcp_f16_sdwa v9, v5 dst_sel:WORD_0 dst_unused:UNUSED_PAD src0_sel:WORD_0
  s_waitcnt lgkmcnt(8)
  v_mfma_f32_16x16x32_f16 v[120:123], v[192:195], v[184:187], v[120:123]
  ds_read_b128 v[208:211], v243
  ds_read_b128 v[212:215], v244
  v_rcp_f16_sdwa v6, v2 dst_sel:WORD_1 dst_unused:UNUSED_PRESERVE src0_sel:WORD_1
  v_add_u32_sdwa v253, v245, v233 dst_sel:DWORD dst_unused:UNUSED_PAD src0_sel:DWORD src1_sel:BYTE_3
  ds_read_b64 v[234:235], v253 offset:480
  ds_read_b32 v236, v253 offset:736
  v_lshlrev_b32 v125, 4, v233
  v_alignbit_b32 v126, v231, v230, v125
  v_lshrrev_b32 v127, v125, v231
  v_rcp_f16_sdwa v7, v3 dst_sel:WORD_1 dst_unused:UNUSED_PRESERVE src0_sel:WORD_1
  s_waitcnt lgkmcnt(10)
  v_mfma_f32_16x16x32_f16 v[120:123], v[196:199], v[188:191], v[120:123]
  ds_read_b128 v[184:187], v252 offset:0
  ds_read_b64 v[176:177], v253 offset:192
  ds_read_b64 v[178:179], v253 offset:128
  ds_read_b64 v[180:181], v253 offset:64
  ds_read_b32 v182, v253
  v_rcp_f16_sdwa v8, v4 dst_sel:WORD_1 dst_unused:UNUSED_PRESERVE src0_sel:WORD_1
  v_rcp_f16_sdwa v9, v5 dst_sel:WORD_1 dst_unused:UNUSED_PRESERVE src0_sel:WORD_1
  v_pk_mul_f16 v164, v164, v6
  v_pk_mul_f16 v165, v165, v7
  v_pk_mul_f16 v166, v166, v8
  v_pk_mul_f16 v167, v167, v9
  ds_write_b128 v246, v[164:167] offset:16
  ds_read_b64_tr_b16 v[192:193], v248 offset:0
  ds_read_b64_tr_b16 v[194:195], v248 offset:144
  ds_read_b64_tr_b16 v[196:197], v248 offset:288
  ds_read_b64_tr_b16 v[198:199], v248 offset:432
  v_cvt_pk_f16_f32 v168, v144, v145
  v_cvt_pk_f16_f32 v169, v146, v147
  v_cvt_pk_f16_f32 v170, v148, v149
  v_cvt_pk_f16_f32 v171, v150, v151
  v_cvt_pk_f16_f32 v172, v152, v153
  v_cvt_pk_f16_f32 v173, v154, v155
  v_cvt_pk_f16_f32 v174, v156, v157
  v_cvt_pk_f16_f32 v175, v158, v159
  v_mfma_f32_32x32x16_bf16 v[128:143], v[48:51], v[220:223], 0
  v_exp_f16_sdwa v2, v168 dst_sel:WORD_0 dst_unused:UNUSED_PAD src0_sel:WORD_0
  v_exp_f16_sdwa v3, v169 dst_sel:WORD_0 dst_unused:UNUSED_PAD src0_sel:WORD_0
  v_exp_f16_sdwa v4, v170 dst_sel:WORD_0 dst_unused:UNUSED_PAD src0_sel:WORD_0
  v_mfma_f32_32x32x16_bf16 v[144:159], v[52:55], v[220:223], 0
  v_lshlrev_b32 v125, 16, v126
  v_and_b32 v126, s65, v126
  v_lshlrev_b32 v127, 16, v127
  s_cmp_gt_i32 s59, 1
  s_cselect_b32 s6, 6400000, 0
  s_cselect_b32 s10, 25600000, 0
  s_cselect_b32 s14, 300000, 0
  s_waitcnt lgkmcnt(14)
  v_mad_u32_u24 v1, v1, 32, v254
  buffer_load_dwordx4 v[216:219], v1, s[8:11], 0 offen
  v_exp_f16_sdwa v5, v171 dst_sel:WORD_0 dst_unused:UNUSED_PAD src0_sel:WORD_0
  v_exp_f16_sdwa v2, v168 dst_sel:WORD_1 dst_unused:UNUSED_PRESERVE src0_sel:WORD_1
  v_mfma_f32_32x32x16_bf16 v[128:143], v[16:19], v[200:203], v[128:143]
  s_add_u32 m0, s66, 0
  v_mad_u32_u24 v224, v224, s64, v237
  s_waitcnt lgkmcnt(12)
  buffer_load_dwordx4 v224, s[4:7], 0 offen  lds
  v_exp_f16_sdwa v3, v169 dst_sel:WORD_1 dst_unused:UNUSED_PRESERVE src0_sel:WORD_1
  v_exp_f16_sdwa v4, v170 dst_sel:WORD_1 dst_unused:UNUSED_PRESERVE src0_sel:WORD_1
  s_waitcnt lgkmcnt(9)
  v_add_u32_sdwa v184, v247, v184 dst_sel:DWORD dst_unused:UNUSED_PAD src0_sel:DWORD src1_sel:BYTE_3
  v_add_u32_sdwa v185, v247, v185 dst_sel:DWORD dst_unused:UNUSED_PAD src0_sel:DWORD src1_sel:BYTE_3
  v_add_u32_sdwa v186, v247, v186 dst_sel:DWORD dst_unused:UNUSED_PAD src0_sel:DWORD src1_sel:BYTE_3
  v_add_u32_sdwa v187, v247, v187 dst_sel:DWORD dst_unused:UNUSED_PAD src0_sel:DWORD src1_sel:BYTE_3
  ds_read_b64_tr_b16 v[190:191], v187
  ds_read_b64_tr_b16 v[188:189], v186
  ds_read_b64_tr_b16 v[186:187], v185
  ds_read_b64_tr_b16 v[184:185], v184
  v_exp_f16_sdwa v5, v171 dst_sel:WORD_1 dst_unused:UNUSED_PRESERVE src0_sel:WORD_1
  v_pk_add_f16 v2, v2, 1.0 op_sel_hi:[1,0]
  v_pk_add_f16 v3, v3, 1.0 op_sel_hi:[1,0]
  v_pk_add_f16 v4, v4, 1.0 op_sel_hi:[1,0]
  v_pk_add_f16 v5, v5, 1.0 op_sel_hi:[1,0]
  v_mfma_f32_32x32x16_bf16 v[128:143], v[20:23], v[204:207], v[128:143]
  v_sub_f32 v234, v234, v125
  v_sub_f32 v235, v235, v126
  v_sub_f32 v236, v236, v127
  v_cvt_pk_bf16_f32 v234, v234, v235
  v_cvt_pk_bf16_f32 v236, v236, v236
  v_lshlrev_b32 v13, 16, v234
  v_and_b32 v14, s65, v234
  v_lshlrev_b32 v15, 16, v236
  s_add_u32 m0, s66, 1024
  v_mad_u32_u24 v225, v225, s64, v238
  buffer_load_dwordx4 v225, s[4:7], 0 offen  lds
  v_rcp_f16_sdwa v6, v2 dst_sel:WORD_0 dst_unused:UNUSED_PAD src0_sel:WORD_0
  v_rcp_f16_sdwa v7, v3 dst_sel:WORD_0 dst_unused:UNUSED_PAD src0_sel:WORD_0
  v_rcp_f16_sdwa v8, v4 dst_sel:WORD_0 dst_unused:UNUSED_PAD src0_sel:WORD_0
  v_mfma_f32_32x32x16_bf16 v[128:143], v[24:27], v[208:211], v[128:143]
  s_add_u32 m0, s66, 2048
  v_mad_u32_u24 v226, v226, s64, v239
  buffer_load_dwordx4 v226, s[4:7], 0 offen  lds
  v_rcp_f16_sdwa v9, v5 dst_sel:WORD_0 dst_unused:UNUSED_PAD src0_sel:WORD_0
  v_rcp_f16_sdwa v6, v2 dst_sel:WORD_1 dst_unused:UNUSED_PRESERVE src0_sel:WORD_1
  v_mfma_f32_32x32x16_bf16 v[128:143], v[28:31], v[212:215], v[128:143]
  s_add_u32 m0, s66, 3072
  v_mad_u32_u24 v227, v227, s64, v240
  buffer_load_dwordx4 v227, s[4:7], 0 offen  lds
  v_rcp_f16_sdwa v7, v3 dst_sel:WORD_1 dst_unused:UNUSED_PRESERVE src0_sel:WORD_1
  v_rcp_f16_sdwa v8, v4 dst_sel:WORD_1 dst_unused:UNUSED_PRESERVE src0_sel:WORD_1
  v_mul_f32 v234, v13, v13
  v_fmac_f32 v234, v14, v14
  v_fmac_f32 v234, v15, v15
  v_cvt_pk_f16_f32 v183, v234, v234
  v_rcp_f16_sdwa v9, v5 dst_sel:WORD_1 dst_unused:UNUSED_PRESERVE src0_sel:WORD_1
  v_pk_mul_f16 v168, v168, v6
  v_pk_mul_f16 v169, v169, v7
  v_pk_mul_f16 v170, v170, v8
  v_pk_mul_f16 v171, v171, v9
  ds_write_b128 v246, v[168:171] offset:64
  v_mfma_f32_16x16x32_f16 v[124:127], v[72:75], v[160:163], 0
  v_exp_f16_sdwa v2, v172 dst_sel:WORD_0 dst_unused:UNUSED_PAD src0_sel:WORD_0
  v_mul_u32_u24 v1, 6, v232
  v_and_b32 v1, -4, v1
  s_mov_b64 exec, s[74:75]
  buffer_load_dwordx2 v[228:229], v1, s[12:15], 0 offen
  s_mov_b64 exec, -1
  v_exp_f16_sdwa v3, v173 dst_sel:WORD_0 dst_unused:UNUSED_PAD src0_sel:WORD_0
  v_mfma_f32_16x16x32_f16 v[124:127], v[76:79], v[164:167], v[124:127]
  v_exp_f16_sdwa v4, v174 dst_sel:WORD_0 dst_unused:UNUSED_PAD src0_sel:WORD_0
  v_exp_f16_sdwa v5, v175 dst_sel:WORD_0 dst_unused:UNUSED_PAD src0_sel:WORD_0
  s_waitcnt lgkmcnt(12)
  v_mfma_f32_32x32x16_f16 v[128:143], v[56:59], v[176:179], v[128:143]
  v_exp_f16_sdwa v2, v172 dst_sel:WORD_1 dst_unused:UNUSED_PRESERVE src0_sel:WORD_1
  v_exp_f16_sdwa v3, v173 dst_sel:WORD_1 dst_unused:UNUSED_PRESERVE src0_sel:WORD_1
  v_exp_f16_sdwa v4, v174 dst_sel:WORD_1 dst_unused:UNUSED_PRESERVE src0_sel:WORD_1
  s_waitcnt lgkmcnt(10)
  v_mfma_f32_32x32x16_f16 v[128:143], v[60:63], v[180:183], v[128:143]
  v_exp_f16_sdwa v5, v175 dst_sel:WORD_1 dst_unused:UNUSED_PRESERVE src0_sel:WORD_1
  v_pk_add_f16 v2, v2, 1.0 op_sel_hi:[1,0]
  v_pk_add_f16 v3, v3, 1.0 op_sel_hi:[1,0]
  v_pk_add_f16 v4, v4, 1.0 op_sel_hi:[1,0]
  v_pk_add_f16 v5, v5, 1.0 op_sel_hi:[1,0]
  v_rcp_f16_sdwa v6, v2 dst_sel:WORD_0 dst_unused:UNUSED_PAD src0_sel:WORD_0
  v_rcp_f16_sdwa v7, v3 dst_sel:WORD_0 dst_unused:UNUSED_PAD src0_sel:WORD_0
  s_waitcnt lgkmcnt(1)
  v_mfma_f32_32x32x16_f16 v[88:103], v[192:195], v[184:187], v[88:103]
  v_rcp_f16_sdwa v8, v4 dst_sel:WORD_0 dst_unused:UNUSED_PAD src0_sel:WORD_0
  v_rcp_f16_sdwa v9, v5 dst_sel:WORD_0 dst_unused:UNUSED_PAD src0_sel:WORD_0
  v_rcp_f16_sdwa v6, v2 dst_sel:WORD_1 dst_unused:UNUSED_PRESERVE src0_sel:WORD_1
  v_mfma_f32_32x32x16_f16 v[88:103], v[196:199], v[188:191], v[88:103]
  v_rcp_f16_sdwa v7, v3 dst_sel:WORD_1 dst_unused:UNUSED_PRESERVE src0_sel:WORD_1
  v_rcp_f16_sdwa v8, v4 dst_sel:WORD_1 dst_unused:UNUSED_PRESERVE src0_sel:WORD_1
  v_rcp_f16_sdwa v9, v5 dst_sel:WORD_1 dst_unused:UNUSED_PRESERVE src0_sel:WORD_1
  v_pk_mul_f16 v172, v172, v6
  v_pk_mul_f16 v173, v173, v7
  v_pk_mul_f16 v174, v174, v8
  v_pk_mul_f16 v175, v175, v9
  ds_write_b128 v246, v[172:175] offset:80
  s_sub_u32 s59, s59, 1
  s_cmp_eq_u32 s59, 0
  s_cbranch_scc1 TAIL0
  ds_read_b64_tr_b16 v[192:193], v248 offset:64
  ds_read_b64_tr_b16 v[194:195], v248 offset:208
  ds_read_b64_tr_b16 v[196:197], v248 offset:352
  ds_read_b64_tr_b16 v[198:199], v248 offset:496
  v_cvt_pk_f16_f32 v160, v128, v129
  v_cvt_pk_f16_f32 v161, v130, v131
  v_cvt_pk_f16_f32 v162, v132, v133
  v_cvt_pk_f16_f32 v163, v134, v135
  v_cvt_pk_f16_f32 v164, v136, v137
  v_cvt_pk_f16_f32 v165, v138, v139
  v_cvt_pk_f16_f32 v166, v140, v141
  v_cvt_pk_f16_f32 v167, v142, v143
  v_mfma_f32_16x16x32_f16 v[124:127], v[80:83], v[168:171], v[124:127]
  v_exp_f16_sdwa v2, v160 dst_sel:WORD_0 dst_unused:UNUSED_PAD src0_sel:WORD_0
  s_mov_b64 exec, 1
  ds_add_rtn_u32 v255, v0, v238 offset:35336
  s_mov_b64 exec, -1
  v_exp_f16_sdwa v3, v161 dst_sel:WORD_0 dst_unused:UNUSED_PAD src0_sel:WORD_0
  v_mfma_f32_16x16x32_f16 v[124:127], v[84:87], v[172:175], v[124:127]
  v_exp_f16_sdwa v4, v162 dst_sel:WORD_0 dst_unused:UNUSED_PAD src0_sel:WORD_0
  v_exp_f16_sdwa v5, v163 dst_sel:WORD_0 dst_unused:UNUSED_PAD src0_sel:WORD_0
  v_mfma_f32_32x32x16_bf16 v[144:159], v[32:35], v[200:203], v[144:159]
  v_exp_f16_sdwa v2, v160 dst_sel:WORD_1 dst_unused:UNUSED_PRESERVE src0_sel:WORD_1
  v_exp_f16_sdwa v3, v161 dst_sel:WORD_1 dst_unused:UNUSED_PRESERVE src0_sel:WORD_1
  v_exp_f16_sdwa v4, v162 dst_sel:WORD_1 dst_unused:UNUSED_PRESERVE src0_sel:WORD_1
  s_waitcnt lgkmcnt(3)
  v_mfma_f32_32x32x16_f16 v[104:119], v[192:195], v[184:187], v[104:119]
  v_exp_f16_sdwa v5, v163 dst_sel:WORD_1 dst_unused:UNUSED_PRESERVE src0_sel:WORD_1
  v_pk_add_f16 v2, v2, 1.0 op_sel_hi:[1,0]
  v_pk_add_f16 v3, v3, 1.0 op_sel_hi:[1,0]
  v_pk_add_f16 v4, v4, 1.0 op_sel_hi:[1,0]
  v_pk_add_f16 v5, v5, 1.0 op_sel_hi:[1,0]
  v_mul_f32 v234, v10, v124
  v_mul_f32 v235, v11, v124
  v_mul_f32 v236, v12, v124
  v_cvt_pk_f16_f32 v234, v234, v235
  v_cvt_pk_f16_f32 v235, v236, v236
  s_mov_b64 exec, s[74:75]
  ds_write_b64 v246, v[234:235] offset:128
  s_mov_b64 exec, -1
  v_rcp_f16_sdwa v6, v2 dst_sel:WORD_0 dst_unused:UNUSED_PAD src0_sel:WORD_0
  v_rcp_f16_sdwa v7, v3 dst_sel:WORD_0 dst_unused:UNUSED_PAD src0_sel:WORD_0
  s_waitcnt lgkmcnt(2)
  v_mfma_f32_32x32x16_f16 v[104:119], v[196:199], v[188:191], v[104:119]
  ds_read_b64_tr_b16 v[192:193], v249 offset:0
  ds_read_b64_tr_b16 v[194:195], v249 offset:144
  ds_read_b64_tr_b16 v[196:197], v249 offset:288
  ds_read_b64_tr_b16 v[198:199], v249 offset:432
  v_rcp_f16_sdwa v8, v4 dst_sel:WORD_0 dst_unused:UNUSED_PAD src0_sel:WORD_0
  s_waitcnt lgkmcnt(5)
  v_readfirstlane_b32 s68, v255
  s_setprio 1
  s_cmp_lt_i32 s68, s79
  s_cbranch_scc0 PRI1
  s_setprio 0
PRI1:
  s_add_u32 s79, s79, 128
  v_rcp_f16_sdwa v9, v5 dst_sel:WORD_0 dst_unused:UNUSED_PAD src0_sel:WORD_0
  v_rcp_f16_sdwa v6, v2 dst_sel:WORD_1 dst_unused:UNUSED_PRESERVE src0_sel:WORD_1
  v_mfma_f32_32x32x16_bf16 v[144:159], v[36:39], v[204:207], v[144:159]
  v_rcp_f16_sdwa v7, v3 dst_sel:WORD_1 dst_unused:UNUSED_PRESERVE src0_sel:WORD_1
  v_rcp_f16_sdwa v8, v4 dst_sel:WORD_1 dst_unused:UNUSED_PRESERVE src0_sel:WORD_1
  v_rcp_f16_sdwa v9, v5 dst_sel:WORD_1 dst_unused:UNUSED_PRESERVE src0_sel:WORD_1
  v_pk_mul_f16 v160, v160, v6
  v_pk_mul_f16 v161, v161, v7
  v_pk_mul_f16 v162, v162, v8
  v_pk_mul_f16 v163, v163, v9
  ds_write_b128 v246, v[160:163] offset:0
  v_mfma_f32_32x32x16_bf16 v[144:159], v[40:43], v[208:211], v[144:159]
  v_exp_f16_sdwa v2, v164 dst_sel:WORD_0 dst_unused:UNUSED_PAD src0_sel:WORD_0
  v_exp_f16_sdwa v3, v165 dst_sel:WORD_0 dst_unused:UNUSED_PAD src0_sel:WORD_0
  v_exp_f16_sdwa v4, v166 dst_sel:WORD_0 dst_unused:UNUSED_PAD src0_sel:WORD_0
  v_mfma_f32_32x32x16_bf16 v[144:159], v[44:47], v[212:215], v[144:159]
  v_exp_f16_sdwa v5, v167 dst_sel:WORD_0 dst_unused:UNUSED_PAD src0_sel:WORD_0
  v_exp_f16_sdwa v2, v164 dst_sel:WORD_1 dst_unused:UNUSED_PRESERVE src0_sel:WORD_1
  v_exp_f16_sdwa v3, v165 dst_sel:WORD_1 dst_unused:UNUSED_PRESERVE src0_sel:WORD_1
  v_mfma_f32_32x32x16_f16 v[144:159], v[64:67], v[176:179], v[144:159]
  v_exp_f16_sdwa v4, v166 dst_sel:WORD_1 dst_unused:UNUSED_PRESERVE src0_sel:WORD_1
  v_exp_f16_sdwa v5, v167 dst_sel:WORD_1 dst_unused:UNUSED_PRESERVE src0_sel:WORD_1
  v_pk_add_f16 v2, v2, 1.0 op_sel_hi:[1,0]
  v_pk_add_f16 v3, v3, 1.0 op_sel_hi:[1,0]
  v_pk_add_f16 v4, v4, 1.0 op_sel_hi:[1,0]
  v_pk_add_f16 v5, v5, 1.0 op_sel_hi:[1,0]
  v_rcp_f16_sdwa v6, v2 dst_sel:WORD_0 dst_unused:UNUSED_PAD src0_sel:WORD_0
  v_mfma_f32_32x32x16_f16 v[144:159], v[68:71], v[180:183], v[144:159]
  v_rcp_f16_sdwa v7, v3 dst_sel:WORD_0 dst_unused:UNUSED_PAD src0_sel:WORD_0
  s_waitcnt vmcnt(0)
  ds_read_b128 v[200:203], v241
  ds_read_b128 v[204:207], v242
  v_rcp_f16_sdwa v8, v4 dst_sel:WORD_0 dst_unused:UNUSED_PAD src0_sel:WORD_0
  ds_read_b128 v[224:227], v250 offset:384
  ds_read_b32 v233, v251 offset:384
  ds_read_b32 v1, v251 offset:17792
  v_rcp_f16_sdwa v9, v5 dst_sel:WORD_0 dst_unused:UNUSED_PAD src0_sel:WORD_0
  s_waitcnt lgkmcnt(8)
  v_mfma_f32_16x16x32_f16 v[120:123], v[192:195], v[184:187], v[120:123]
  ds_read_b128 v[208:211], v243
  ds_read_b128 v[212:215], v244
  v_rcp_f16_sdwa v6, v2 dst_sel:WORD_1 dst_unused:UNUSED_PRESERVE src0_sel:WORD_1
  v_add_u32_sdwa v253, v245, v232 dst_sel:DWORD dst_unused:UNUSED_PAD src0_sel:DWORD src1_sel:BYTE_3
  ds_read_b64 v[234:235], v253 offset:480
  ds_read_b32 v236, v253 offset:736
  v_lshlrev_b32 v125, 4, v232
  v_alignbit_b32 v126, v229, v228, v125
  v_lshrrev_b32 v127, v125, v229
  v_rcp_f16_sdwa v7, v3 dst_sel:WORD_1 dst_unused:UNUSED_PRESERVE src0_sel:WORD_1
  s_waitcnt lgkmcnt(10)
  v_mfma_f32_16x16x32_f16 v[120:123], v[196:199], v[188:191], v[120:123]
  ds_read_b128 v[184:187], v252 offset:128
  ds_read_b64 v[176:177], v253 offset:192
  ds_read_b64 v[178:179], v253 offset:128
  ds_read_b64 v[180:181], v253 offset:64
  ds_read_b32 v182, v253
  v_rcp_f16_sdwa v8, v4 dst_sel:WORD_1 dst_unused:UNUSED_PRESERVE src0_sel:WORD_1
  v_rcp_f16_sdwa v9, v5 dst_sel:WORD_1 dst_unused:UNUSED_PRESERVE src0_sel:WORD_1
  v_pk_mul_f16 v164, v164, v6
  v_pk_mul_f16 v165, v165, v7
  v_pk_mul_f16 v166, v166, v8
  v_pk_mul_f16 v167, v167, v9
  ds_write_b128 v246, v[164:167] offset:16
  ds_read_b64_tr_b16 v[192:193], v248 offset:0
  ds_read_b64_tr_b16 v[194:195], v248 offset:144
  ds_read_b64_tr_b16 v[196:197], v248 offset:288
  ds_read_b64_tr_b16 v[198:199], v248 offset:432
  v_cvt_pk_f16_f32 v168, v144, v145
  v_cvt_pk_f16_f32 v169, v146, v147
  v_cvt_pk_f16_f32 v170, v148, v149
  v_cvt_pk_f16_f32 v171, v150, v151
  v_cvt_pk_f16_f32 v172, v152, v153
  v_cvt_pk_f16_f32 v173, v154, v155
  v_cvt_pk_f16_f32 v174, v156, v157
  v_cvt_pk_f16_f32 v175, v158, v159
  v_mfma_f32_32x32x16_bf16 v[128:143], v[48:51], v[216:219], 0
  v_exp_f16_sdwa v2, v168 dst_sel:WORD_0 dst_unused:UNUSED_PAD src0_sel:WORD_0
  v_exp_f16_sdwa v3, v169 dst_sel:WORD_0 dst_unused:UNUSED_PAD src0_sel:WORD_0
  v_exp_f16_sdwa v4, v170 dst_sel:WORD_0 dst_unused:UNUSED_PAD src0_sel:WORD_0
  v_mfma_f32_32x32x16_bf16 v[144:159], v[52:55], v[216:219], 0
  v_lshlrev_b32 v125, 16, v126
  v_and_b32 v126, s65, v126
  v_lshlrev_b32 v127, 16, v127
  s_cmp_gt_i32 s59, 1
  s_cselect_b32 s6, 6400000, 0
  s_cselect_b32 s10, 25600000, 0
  s_cselect_b32 s14, 300000, 0
  s_waitcnt lgkmcnt(14)
  v_mad_u32_u24 v1, v1, 32, v254
  buffer_load_dwordx4 v[220:223], v1, s[8:11], 0 offen
  v_exp_f16_sdwa v5, v171 dst_sel:WORD_0 dst_unused:UNUSED_PAD src0_sel:WORD_0
  v_exp_f16_sdwa v2, v168 dst_sel:WORD_1 dst_unused:UNUSED_PRESERVE src0_sel:WORD_1
  v_mfma_f32_32x32x16_bf16 v[128:143], v[16:19], v[200:203], v[128:143]
  s_add_u32 m0, s66, 0
  v_mad_u32_u24 v224, v224, s64, v237
  s_waitcnt lgkmcnt(12)
  buffer_load_dwordx4 v224, s[4:7], 0 offen  lds
  v_exp_f16_sdwa v3, v169 dst_sel:WORD_1 dst_unused:UNUSED_PRESERVE src0_sel:WORD_1
  v_exp_f16_sdwa v4, v170 dst_sel:WORD_1 dst_unused:UNUSED_PRESERVE src0_sel:WORD_1
  s_waitcnt lgkmcnt(9)
  v_add_u32_sdwa v184, v247, v184 dst_sel:DWORD dst_unused:UNUSED_PAD src0_sel:DWORD src1_sel:BYTE_3
  v_add_u32_sdwa v185, v247, v185 dst_sel:DWORD dst_unused:UNUSED_PAD src0_sel:DWORD src1_sel:BYTE_3
  v_add_u32_sdwa v186, v247, v186 dst_sel:DWORD dst_unused:UNUSED_PAD src0_sel:DWORD src1_sel:BYTE_3
  v_add_u32_sdwa v187, v247, v187 dst_sel:DWORD dst_unused:UNUSED_PAD src0_sel:DWORD src1_sel:BYTE_3
  ds_read_b64_tr_b16 v[190:191], v187
  ds_read_b64_tr_b16 v[188:189], v186
  ds_read_b64_tr_b16 v[186:187], v185
  ds_read_b64_tr_b16 v[184:185], v184
  v_exp_f16_sdwa v5, v171 dst_sel:WORD_1 dst_unused:UNUSED_PRESERVE src0_sel:WORD_1
  v_pk_add_f16 v2, v2, 1.0 op_sel_hi:[1,0]
  v_pk_add_f16 v3, v3, 1.0 op_sel_hi:[1,0]
  v_pk_add_f16 v4, v4, 1.0 op_sel_hi:[1,0]
  v_pk_add_f16 v5, v5, 1.0 op_sel_hi:[1,0]
  v_mfma_f32_32x32x16_bf16 v[128:143], v[20:23], v[204:207], v[128:143]
  v_sub_f32 v234, v234, v125
  v_sub_f32 v235, v235, v126
  v_sub_f32 v236, v236, v127
  v_cvt_pk_bf16_f32 v234, v234, v235
  v_cvt_pk_bf16_f32 v236, v236, v236
  v_lshlrev_b32 v10, 16, v234
  v_and_b32 v11, s65, v234
  v_lshlrev_b32 v12, 16, v236
  s_add_u32 m0, s66, 1024
  v_mad_u32_u24 v225, v225, s64, v238
  buffer_load_dwordx4 v225, s[4:7], 0 offen  lds
  v_rcp_f16_sdwa v6, v2 dst_sel:WORD_0 dst_unused:UNUSED_PAD src0_sel:WORD_0
  v_rcp_f16_sdwa v7, v3 dst_sel:WORD_0 dst_unused:UNUSED_PAD src0_sel:WORD_0
  v_rcp_f16_sdwa v8, v4 dst_sel:WORD_0 dst_unused:UNUSED_PAD src0_sel:WORD_0
  v_mfma_f32_32x32x16_bf16 v[128:143], v[24:27], v[208:211], v[128:143]
  s_add_u32 m0, s66, 2048
  v_mad_u32_u24 v226, v226, s64, v239
  buffer_load_dwordx4 v226, s[4:7], 0 offen  lds
  v_rcp_f16_sdwa v9, v5 dst_sel:WORD_0 dst_unused:UNUSED_PAD src0_sel:WORD_0
  v_rcp_f16_sdwa v6, v2 dst_sel:WORD_1 dst_unused:UNUSED_PRESERVE src0_sel:WORD_1
  v_mfma_f32_32x32x16_bf16 v[128:143], v[28:31], v[212:215], v[128:143]
  s_add_u32 m0, s66, 3072
  v_mad_u32_u24 v227, v227, s64, v240
  buffer_load_dwordx4 v227, s[4:7], 0 offen  lds
  v_rcp_f16_sdwa v7, v3 dst_sel:WORD_1 dst_unused:UNUSED_PRESERVE src0_sel:WORD_1
  v_rcp_f16_sdwa v8, v4 dst_sel:WORD_1 dst_unused:UNUSED_PRESERVE src0_sel:WORD_1
  v_mul_f32 v234, v10, v10
  v_fmac_f32 v234, v11, v11
  v_fmac_f32 v234, v12, v12
  v_cvt_pk_f16_f32 v183, v234, v234
  v_rcp_f16_sdwa v9, v5 dst_sel:WORD_1 dst_unused:UNUSED_PRESERVE src0_sel:WORD_1
  v_pk_mul_f16 v168, v168, v6
  v_pk_mul_f16 v169, v169, v7
  v_pk_mul_f16 v170, v170, v8
  v_pk_mul_f16 v171, v171, v9
  ds_write_b128 v246, v[168:171] offset:64
  v_mfma_f32_16x16x32_f16 v[124:127], v[72:75], v[160:163], 0
  v_exp_f16_sdwa v2, v172 dst_sel:WORD_0 dst_unused:UNUSED_PAD src0_sel:WORD_0
  v_mul_u32_u24 v1, 6, v233
  v_and_b32 v1, -4, v1
  s_mov_b64 exec, s[74:75]
  buffer_load_dwordx2 v[230:231], v1, s[12:15], 0 offen
  s_mov_b64 exec, -1
  v_exp_f16_sdwa v3, v173 dst_sel:WORD_0 dst_unused:UNUSED_PAD src0_sel:WORD_0
  v_mfma_f32_16x16x32_f16 v[124:127], v[76:79], v[164:167], v[124:127]
  v_exp_f16_sdwa v4, v174 dst_sel:WORD_0 dst_unused:UNUSED_PAD src0_sel:WORD_0
  v_exp_f16_sdwa v5, v175 dst_sel:WORD_0 dst_unused:UNUSED_PAD src0_sel:WORD_0
  s_waitcnt lgkmcnt(12)
  v_mfma_f32_32x32x16_f16 v[128:143], v[56:59], v[176:179], v[128:143]
  v_exp_f16_sdwa v2, v172 dst_sel:WORD_1 dst_unused:UNUSED_PRESERVE src0_sel:WORD_1
  v_exp_f16_sdwa v3, v173 dst_sel:WORD_1 dst_unused:UNUSED_PRESERVE src0_sel:WORD_1
  v_exp_f16_sdwa v4, v174 dst_sel:WORD_1 dst_unused:UNUSED_PRESERVE src0_sel:WORD_1
  s_waitcnt lgkmcnt(10)
  v_mfma_f32_32x32x16_f16 v[128:143], v[60:63], v[180:183], v[128:143]
  v_exp_f16_sdwa v5, v175 dst_sel:WORD_1 dst_unused:UNUSED_PRESERVE src0_sel:WORD_1
  v_pk_add_f16 v2, v2, 1.0 op_sel_hi:[1,0]
  v_pk_add_f16 v3, v3, 1.0 op_sel_hi:[1,0]
  v_pk_add_f16 v4, v4, 1.0 op_sel_hi:[1,0]
  v_pk_add_f16 v5, v5, 1.0 op_sel_hi:[1,0]
  v_rcp_f16_sdwa v6, v2 dst_sel:WORD_0 dst_unused:UNUSED_PAD src0_sel:WORD_0
  v_rcp_f16_sdwa v7, v3 dst_sel:WORD_0 dst_unused:UNUSED_PAD src0_sel:WORD_0
  s_waitcnt lgkmcnt(1)
  v_mfma_f32_32x32x16_f16 v[88:103], v[192:195], v[184:187], v[88:103]
  v_rcp_f16_sdwa v8, v4 dst_sel:WORD_0 dst_unused:UNUSED_PAD src0_sel:WORD_0
  v_rcp_f16_sdwa v9, v5 dst_sel:WORD_0 dst_unused:UNUSED_PAD src0_sel:WORD_0
  v_rcp_f16_sdwa v6, v2 dst_sel:WORD_1 dst_unused:UNUSED_PRESERVE src0_sel:WORD_1
  v_mfma_f32_32x32x16_f16 v[88:103], v[196:199], v[188:191], v[88:103]
  v_rcp_f16_sdwa v7, v3 dst_sel:WORD_1 dst_unused:UNUSED_PRESERVE src0_sel:WORD_1
  v_rcp_f16_sdwa v8, v4 dst_sel:WORD_1 dst_unused:UNUSED_PRESERVE src0_sel:WORD_1
  v_rcp_f16_sdwa v9, v5 dst_sel:WORD_1 dst_unused:UNUSED_PRESERVE src0_sel:WORD_1
  v_pk_mul_f16 v172, v172, v6
  v_pk_mul_f16 v173, v173, v7
  v_pk_mul_f16 v174, v174, v8
  v_pk_mul_f16 v175, v175, v9
  ds_write_b128 v246, v[172:175] offset:80
  s_sub_u32 s59, s59, 1
  s_cmp_eq_u32 s59, 0
  v_add_u32 v250, 0x100, v250
  v_add_u32 v251, 0x100, v251
  v_add_u32 v252, 0x100, v252
  s_cbranch_scc0 LOOP
  v_mov_b32 v10, v13
  v_mov_b32 v11, v14
  v_mov_b32 v12, v15
TAIL0:
  s_waitcnt lgkmcnt(0)
  ds_read_b64_tr_b16 v[192:193], v248 offset:64
  ds_read_b64_tr_b16 v[194:195], v248 offset:208
  ds_read_b64_tr_b16 v[196:197], v248 offset:352
  ds_read_b64_tr_b16 v[198:199], v248 offset:496
  v_mfma_f32_16x16x32_f16 v[124:127], v[80:83], v[168:171], v[124:127]
  v_mfma_f32_16x16x32_f16 v[124:127], v[84:87], v[172:175], v[124:127]
  s_waitcnt lgkmcnt(2)
  v_mfma_f32_32x32x16_f16 v[104:119], v[192:195], v[184:187], v[104:119]
  s_waitcnt lgkmcnt(0)
  v_mfma_f32_32x32x16_f16 v[104:119], v[196:199], v[188:191], v[104:119]
  s_nop 3
  v_mul_f32 v234, v10, v124
  v_mul_f32 v235, v11, v124
  v_mul_f32 v236, v12, v124
  v_cvt_pk_f16_f32 v234, v234, v235
  v_cvt_pk_f16_f32 v235, v236, v236
  s_mov_b64 exec, s[74:75]
  ds_write_b64 v246, v[234:235] offset:128
  s_mov_b64 exec, -1
  ds_read_b64_tr_b16 v[192:193], v249 offset:0
  ds_read_b64_tr_b16 v[194:195], v249 offset:144
  ds_read_b64_tr_b16 v[196:197], v249 offset:288
  ds_read_b64_tr_b16 v[198:199], v249 offset:432
  s_waitcnt lgkmcnt(2)
  v_mfma_f32_16x16x32_f16 v[120:123], v[192:195], v[184:187], v[120:123]
  s_waitcnt lgkmcnt(0)
  v_mfma_f32_16x16x32_f16 v[120:123], v[196:199], v[188:191], v[120:123]
LOOPEND:
  s_cmp_eq_u32 s62, 0
  s_cbranch_scc1 EPI
  s_add_u32 s61, s61, s60
  s_min_u32 s60, s60, 32
  s_waitcnt vmcnt(0)
  s_barrier
  s_branch ROUND
EPI:
  v_and_b32 v2, 1, v0
  v_bfe_u32 v3, v0, 1, 1
  v_bfe_u32 v4, v0, 2, 2
  v_bfe_u32 v5, v0, 4, 1
  v_lshlrev_b32 v2, 6, v2
  v_lshl_add_u32 v2, v3, 3, v2
  v_lshl_add_u32 v2, v5, 4, v2
  v_lshrrev_b32 v3, 1, v4
  v_lshl_add_u32 v2, v3, 5, v2
  v_lshl_add_u32 v2, v4, 7, v2
  v_add_u32 v2, 114176, v2
  v_lshl_add_u32 v6, v254, 8, v2
  v_xor_b32 v7, 32, v6
  v_lshl_add_u32 v8, v254, 6, v2
  v_xor_b32 v9, 32, v8
  v_lshl_add_u32 v253, v0, 3, s67
  ds_read_b64 v[224:225], v253 offset:512
  ds_read_b32 v226, v253 offset:768
  ds_read_b64_tr_b16 v[16:17], v6 offset:0
  ds_read_b64_tr_b16 v[18:19], v6 offset:512
  ds_read_b64_tr_b16 v[20:21], v6 offset:1024
  ds_read_b64_tr_b16 v[22:23], v6 offset:1536
  ds_read_b64_tr_b16 v[24:25], v6 offset:2048
  ds_read_b64_tr_b16 v[26:27], v6 offset:2560
  ds_read_b64_tr_b16 v[28:29], v6 offset:3072
  ds_read_b64_tr_b16 v[30:31], v6 offset:3584
  ds_read_b64_tr_b16 v[32:33], v8 offset:8192
  ds_read_b64_tr_b16 v[34:35], v8 offset:10240
  ds_read_b64_tr_b16 v[36:37], v8 offset:8704
  ds_read_b64_tr_b16 v[38:39], v8 offset:10752
  ds_read_b64_tr_b16 v[40:41], v8 offset:12288
  ds_read_b64_tr_b16 v[42:43], v8 offset:14336
  ds_read_b64_tr_b16 v[44:45], v8 offset:12800
  ds_read_b64_tr_b16 v[46:47], v8 offset:14848
  s_mov_b32 s68, 0xbf317218
  s_mov_b32 s69, 0xbf317218
  v_pk_mul_f32 v[88:89], v[88:89], s[68:69]
  v_pk_mul_f32 v[90:91], v[90:91], s[68:69]
  v_pk_mul_f32 v[92:93], v[92:93], s[68:69]
  v_pk_mul_f32 v[94:95], v[94:95], s[68:69]
  v_pk_mul_f32 v[96:97], v[96:97], s[68:69]
  v_pk_mul_f32 v[98:99], v[98:99], s[68:69]
  v_pk_mul_f32 v[100:101], v[100:101], s[68:69]
  v_pk_mul_f32 v[102:103], v[102:103], s[68:69]
  v_pk_mul_f32 v[104:105], v[104:105], s[68:69]
  v_pk_mul_f32 v[106:107], v[106:107], s[68:69]
  v_pk_mul_f32 v[108:109], v[108:109], s[68:69]
  v_pk_mul_f32 v[110:111], v[110:111], s[68:69]
  v_pk_mul_f32 v[112:113], v[112:113], s[68:69]
  v_pk_mul_f32 v[114:115], v[114:115], s[68:69]
  v_pk_mul_f32 v[116:117], v[116:117], s[68:69]
  v_pk_mul_f32 v[118:119], v[118:119], s[68:69]
  v_pk_mul_f32 v[120:121], v[120:121], s[68:69]
  v_pk_mul_f32 v[122:123], v[122:123], s[68:69]
  s_waitcnt lgkmcnt(8)
  v_mfma_f32_32x32x16_bf16 v[128:143], v[16:19], v[200:203], 0
  v_cvt_pk_bf16_f32 v160, v88, v89
  v_cvt_pk_bf16_f32 v161, v90, v91
  v_cvt_pk_bf16_f32 v162, v92, v93
  v_cvt_pk_bf16_f32 v163, v94, v95
  v_cvt_pk_bf16_f32 v164, v96, v97
  v_mfma_f32_32x32x16_bf16 v[128:143], v[20:23], v[204:207], v[128:143]
  v_cvt_pk_bf16_f32 v165, v98, v99
  v_cvt_pk_bf16_f32 v166, v100, v101
  v_cvt_pk_bf16_f32 v167, v102, v103
  v_cvt_pk_bf16_f32 v168, v104, v105
  v_cvt_pk_bf16_f32 v169, v106, v107
  v_mfma_f32_32x32x16_bf16 v[128:143], v[24:27], v[208:211], v[128:143]
  v_cvt_pk_bf16_f32 v170, v108, v109
  v_cvt_pk_bf16_f32 v171, v110, v111
  v_cvt_pk_bf16_f32 v172, v112, v113
  v_cvt_pk_bf16_f32 v173, v114, v115
  v_cvt_pk_bf16_f32 v174, v116, v117
  v_mfma_f32_32x32x16_bf16 v[128:143], v[28:31], v[212:215], v[128:143]
  v_cvt_pk_bf16_f32 v175, v118, v119
  s_waitcnt lgkmcnt(0)
  ds_read_b64_tr_b16 v[48:49], v7 offset:0
  ds_read_b64_tr_b16 v[50:51], v7 offset:512
  ds_read_b64_tr_b16 v[52:53], v7 offset:1024
  ds_read_b64_tr_b16 v[54:55], v7 offset:1536
  ds_read_b64_tr_b16 v[56:57], v7 offset:2048
  ds_read_b64_tr_b16 v[58:59], v7 offset:2560
  ds_read_b64_tr_b16 v[60:61], v7 offset:3072
  ds_read_b64_tr_b16 v[62:63], v7 offset:3584
  ds_read_b64_tr_b16 v[64:65], v9 offset:8192
  ds_read_b64_tr_b16 v[66:67], v9 offset:10240
  ds_read_b64_tr_b16 v[68:69], v9 offset:8704
  ds_read_b64_tr_b16 v[70:71], v9 offset:10752
  ds_read_b64_tr_b16 v[72:73], v9 offset:12288
  ds_read_b64_tr_b16 v[74:75], v9 offset:14336
  ds_read_b64_tr_b16 v[76:77], v9 offset:12800
  ds_read_b64_tr_b16 v[78:79], v9 offset:14848
  v_mfma_f32_32x32x16_bf16 v[128:143], v[32:35], v[160:163], v[128:143]
  v_add_f32 v224, v224, v120
  v_add_f32 v225, v225, v121
  v_add_f32 v226, v226, v122
  v_cvt_pk_bf16_f32 v224, v224, v225
  v_cvt_pk_bf16_f32 v226, v226, v226
  v_add_u32 v234, s58, v0
  v_mfma_f32_32x32x16_bf16 v[128:143], v[36:39], v[164:167], v[128:143]
  v_mul_u32_u24 v234, 6, v234
  v_add_u32 v234, 6400000, v234
  v_lshl_add_u32 v246, v254, 1, v246
  v_lshrrev_b32 v250, 3, v0
  v_and_b32 v251, 7, v0
  s_mul_i32 s3, s57, 4608
  v_mfma_f32_32x32x16_bf16 v[128:143], v[40:43], v[168:171], v[128:143]
  s_add_u32 s3, s3, 44544
  v_mul_u32_u24 v252, 144, v250
  v_lshl_add_u32 v252, v251, 4, v252
  v_add_u32 v252, s3, v252
  s_lshl_b32 s3, s58, 7
  v_lshl_add_u32 v235, v0, 4, s3
  v_mfma_f32_32x32x16_bf16 v[128:143], v[44:47], v[172:175], v[128:143]
  s_bfe_u32 s68, s78, 0x10018
  s_mul_i32 s68, s68, 255
  s_mov_b32 s69, 0
  s_mov_b32 exec_lo, s78
  s_mov_b32 exec_hi, 0
  buffer_store_short v224, v234, s[28:31], 0 offen
  buffer_store_short_d16_hi v224, v234, s[28:31], 0 offen offset:2
  buffer_store_short v226, v234, s[28:31], 0 offen offset:4
  s_mov_b64 exec, -1
  s_waitcnt lgkmcnt(0)
  v_mfma_f32_32x32x16_bf16 v[144:159], v[48:51], v[200:203], 0
  s_nop 0
  v_pk_mul_f32 v[2:3], v[128:129], s[70:71]
  v_pk_mul_f32 v[4:5], v[130:131], s[70:71]
  v_pk_mul_f32 v[6:7], v[132:133], s[70:71]
  v_pk_mul_f32 v[8:9], v[134:135], s[70:71]
  v_exp_f32 v2, v2
  v_mfma_f32_32x32x16_bf16 v[144:159], v[52:55], v[204:207], v[144:159]
  v_exp_f32 v3, v3
  v_exp_f32 v4, v4
  v_exp_f32 v5, v5
  v_exp_f32 v6, v6
  v_exp_f32 v7, v7
  v_exp_f32 v8, v8
  v_exp_f32 v9, v9
  v_mfma_f32_32x32x16_bf16 v[144:159], v[56:59], v[208:211], v[144:159]
  v_pk_add_f32 v[2:3], v[2:3], s[72:73]
  v_pk_add_f32 v[4:5], v[4:5], s[72:73]
  v_pk_add_f32 v[6:7], v[6:7], s[72:73]
  v_pk_add_f32 v[8:9], v[8:9], s[72:73]
  v_rcp_f32 v2, v2
  v_rcp_f32 v3, v3
  v_rcp_f32 v4, v4
  v_mfma_f32_32x32x16_bf16 v[144:159], v[60:63], v[212:215], v[144:159]
  v_rcp_f32 v5, v5
  v_rcp_f32 v6, v6
  v_rcp_f32 v7, v7
  v_rcp_f32 v8, v8
  v_rcp_f32 v9, v9
  v_pk_mul_f32 v[2:3], v[2:3], v[128:129]
  v_pk_mul_f32 v[4:5], v[4:5], v[130:131]
  v_mfma_f32_32x32x16_bf16 v[144:159], v[64:67], v[160:163], v[144:159]
  v_pk_mul_f32 v[6:7], v[6:7], v[132:133]
  v_pk_mul_f32 v[8:9], v[8:9], v[134:135]
  v_cvt_pk_bf16_f32 v176, v2, v3
  v_cvt_pk_bf16_f32 v177, v4, v5
  v_cvt_pk_bf16_f32 v178, v6, v7
  v_cvt_pk_bf16_f32 v179, v8, v9
  v_lshlrev_b32 v2, 16, v176
  v_mfma_f32_32x32x16_bf16 v[144:159], v[68:71], v[164:167], v[144:159]
  v_and_b32 v3, s65, v176
  v_lshlrev_b32 v4, 16, v200
  v_and_b32 v5, s65, v200
  v_pk_add_f32 v[2:3], v[2:3], v[4:5]
  v_cvt_pk_bf16_f32 v88, v2, v3
  v_lshlrev_b32 v6, 16, v177
  v_and_b32 v7, s65, v177
  v_mfma_f32_32x32x16_bf16 v[144:159], v[72:75], v[168:171], v[144:159]
  v_lshlrev_b32 v8, 16, v201
  v_and_b32 v9, s65, v201
  v_pk_add_f32 v[6:7], v[6:7], v[8:9]
  v_cvt_pk_bf16_f32 v89, v6, v7
  v_lshlrev_b32 v2, 16, v178
  v_and_b32 v3, s65, v178
  v_lshlrev_b32 v4, 16, v202
  v_mfma_f32_32x32x16_bf16 v[144:159], v[76:79], v[172:175], v[144:159]
  v_and_b32 v5, s65, v202
  v_pk_add_f32 v[2:3], v[2:3], v[4:5]
  v_cvt_pk_bf16_f32 v90, v2, v3
  v_lshlrev_b32 v6, 16, v179
  v_and_b32 v7, s65, v179
  v_lshlrev_b32 v8, 16, v203
  v_and_b32 v9, s65, v203
  v_pk_add_f32 v[6:7], v[6:7], v[8:9]
  v_cvt_pk_bf16_f32 v91, v6, v7
  ds_write_b128 v246, v[88:91] offset:0
  v_pk_mul_f32 v[2:3], v[136:137], s[70:71]
  v_pk_mul_f32 v[4:5], v[138:139], s[70:71]
  v_pk_mul_f32 v[6:7], v[140:141], s[70:71]
  v_pk_mul_f32 v[8:9], v[142:143], s[70:71]
  v_exp_f32 v2, v2
  v_exp_f32 v3, v3
  v_exp_f32 v4, v4
  v_exp_f32 v5, v5
  v_exp_f32 v6, v6
  v_exp_f32 v7, v7
  v_exp_f32 v8, v8
  v_exp_f32 v9, v9
  v_pk_add_f32 v[2:3], v[2:3], s[72:73]
  v_pk_add_f32 v[4:5], v[4:5], s[72:73]
  v_pk_add_f32 v[6:7], v[6:7], s[72:73]
  v_pk_add_f32 v[8:9], v[8:9], s[72:73]
  v_rcp_f32 v2, v2
  v_rcp_f32 v3, v3
  v_rcp_f32 v4, v4
  v_rcp_f32 v5, v5
  v_rcp_f32 v6, v6
  v_rcp_f32 v7, v7
  v_rcp_f32 v8, v8
  v_rcp_f32 v9, v9
  v_pk_mul_f32 v[2:3], v[2:3], v[136:137]
  v_pk_mul_f32 v[4:5], v[4:5], v[138:139]
  v_pk_mul_f32 v[6:7], v[6:7], v[140:141]
  v_pk_mul_f32 v[8:9], v[8:9], v[142:143]
  v_cvt_pk_bf16_f32 v176, v2, v3
  v_cvt_pk_bf16_f32 v177, v4, v5
  v_cvt_pk_bf16_f32 v178, v6, v7
  v_cvt_pk_bf16_f32 v179, v8, v9
  v_lshlrev_b32 v2, 16, v176
  v_and_b32 v3, s65, v176
  v_lshlrev_b32 v4, 16, v204
  v_and_b32 v5, s65, v204
  v_pk_add_f32 v[2:3], v[2:3], v[4:5]
  v_cvt_pk_bf16_f32 v92, v2, v3
  v_lshlrev_b32 v6, 16, v177
  v_and_b32 v7, s65, v177
  v_lshlrev_b32 v8, 16, v205
  v_and_b32 v9, s65, v205
  v_pk_add_f32 v[6:7], v[6:7], v[8:9]
  v_cvt_pk_bf16_f32 v93, v6, v7
  v_lshlrev_b32 v2, 16, v178
  v_and_b32 v3, s65, v178
  v_lshlrev_b32 v4, 16, v206
  v_and_b32 v5, s65, v206
  v_pk_add_f32 v[2:3], v[2:3], v[4:5]
  v_cvt_pk_bf16_f32 v94, v2, v3
  v_lshlrev_b32 v6, 16, v179
  v_and_b32 v7, s65, v179
  v_lshlrev_b32 v8, 16, v207
  v_and_b32 v9, s65, v207
  v_pk_add_f32 v[6:7], v[6:7], v[8:9]
  v_cvt_pk_bf16_f32 v95, v6, v7
  ds_write_b128 v246, v[92:95] offset:16
  v_pk_mul_f32 v[2:3], v[144:145], s[70:71]
  v_pk_mul_f32 v[4:5], v[146:147], s[70:71]
  v_pk_mul_f32 v[6:7], v[148:149], s[70:71]
  v_pk_mul_f32 v[8:9], v[150:151], s[70:71]
  v_exp_f32 v2, v2
  v_exp_f32 v3, v3
  v_exp_f32 v4, v4
  v_exp_f32 v5, v5
  v_exp_f32 v6, v6
  v_exp_f32 v7, v7
  v_exp_f32 v8, v8
  v_exp_f32 v9, v9
  v_pk_add_f32 v[2:3], v[2:3], s[72:73]
  v_pk_add_f32 v[4:5], v[4:5], s[72:73]
  v_pk_add_f32 v[6:7], v[6:7], s[72:73]
  v_pk_add_f32 v[8:9], v[8:9], s[72:73]
  v_rcp_f32 v2, v2
  v_rcp_f32 v3, v3
  v_rcp_f32 v4, v4
  v_rcp_f32 v5, v5
  v_rcp_f32 v6, v6
  v_rcp_f32 v7, v7
  v_rcp_f32 v8, v8
  v_rcp_f32 v9, v9
  v_pk_mul_f32 v[2:3], v[2:3], v[144:145]
  v_pk_mul_f32 v[4:5], v[4:5], v[146:147]
  v_pk_mul_f32 v[6:7], v[6:7], v[148:149]
  v_pk_mul_f32 v[8:9], v[8:9], v[150:151]
  v_cvt_pk_bf16_f32 v176, v2, v3
  v_cvt_pk_bf16_f32 v177, v4, v5
  v_cvt_pk_bf16_f32 v178, v6, v7
  v_cvt_pk_bf16_f32 v179, v8, v9
  v_lshlrev_b32 v2, 16, v176
  v_and_b32 v3, s65, v176
  v_lshlrev_b32 v4, 16, v208
  v_and_b32 v5, s65, v208
  v_pk_add_f32 v[2:3], v[2:3], v[4:5]
  v_cvt_pk_bf16_f32 v96, v2, v3
  v_lshlrev_b32 v6, 16, v177
  v_and_b32 v7, s65, v177
  v_lshlrev_b32 v8, 16, v209
  v_and_b32 v9, s65, v209
  v_pk_add_f32 v[6:7], v[6:7], v[8:9]
  v_cvt_pk_bf16_f32 v97, v6, v7
  v_lshlrev_b32 v2, 16, v178
  v_and_b32 v3, s65, v178
  v_lshlrev_b32 v4, 16, v210
  v_and_b32 v5, s65, v210
  v_pk_add_f32 v[2:3], v[2:3], v[4:5]
  v_cvt_pk_bf16_f32 v98, v2, v3
  v_lshlrev_b32 v6, 16, v179
  v_and_b32 v7, s65, v179
  v_lshlrev_b32 v8, 16, v211
  v_and_b32 v9, s65, v211
  v_pk_add_f32 v[6:7], v[6:7], v[8:9]
  v_cvt_pk_bf16_f32 v99, v6, v7
  ds_write_b128 v246, v[96:99] offset:32
  v_pk_mul_f32 v[2:3], v[152:153], s[70:71]
  v_pk_mul_f32 v[4:5], v[154:155], s[70:71]
  v_pk_mul_f32 v[6:7], v[156:157], s[70:71]
  v_pk_mul_f32 v[8:9], v[158:159], s[70:71]
  v_exp_f32 v2, v2
  v_exp_f32 v3, v3
  v_exp_f32 v4, v4
  v_exp_f32 v5, v5
  v_exp_f32 v6, v6
  v_exp_f32 v7, v7
  v_exp_f32 v8, v8
  v_exp_f32 v9, v9
  v_pk_add_f32 v[2:3], v[2:3], s[72:73]
  v_pk_add_f32 v[4:5], v[4:5], s[72:73]
  v_pk_add_f32 v[6:7], v[6:7], s[72:73]
  v_pk_add_f32 v[8:9], v[8:9], s[72:73]
  v_rcp_f32 v2, v2
  v_rcp_f32 v3, v3
  v_rcp_f32 v4, v4
  v_rcp_f32 v5, v5
  v_rcp_f32 v6, v6
  v_rcp_f32 v7, v7
  v_rcp_f32 v8, v8
  v_rcp_f32 v9, v9
  v_pk_mul_f32 v[2:3], v[2:3], v[152:153]
  v_pk_mul_f32 v[4:5], v[4:5], v[154:155]
  v_pk_mul_f32 v[6:7], v[6:7], v[156:157]
  v_pk_mul_f32 v[8:9], v[8:9], v[158:159]
  v_cvt_pk_bf16_f32 v176, v2, v3
  v_cvt_pk_bf16_f32 v177, v4, v5
  v_cvt_pk_bf16_f32 v178, v6, v7
  v_cvt_pk_bf16_f32 v179, v8, v9
  v_lshlrev_b32 v2, 16, v176
  v_and_b32 v3, s65, v176
  v_lshlrev_b32 v4, 16, v212
  v_and_b32 v5, s65, v212
  v_pk_add_f32 v[2:3], v[2:3], v[4:5]
  v_cvt_pk_bf16_f32 v100, v2, v3
  v_lshlrev_b32 v6, 16, v177
  v_and_b32 v7, s65, v177
  v_lshlrev_b32 v8, 16, v213
  v_and_b32 v9, s65, v213
  v_pk_add_f32 v[6:7], v[6:7], v[8:9]
  v_cvt_pk_bf16_f32 v101, v6, v7
  v_lshlrev_b32 v2, 16, v178
  v_and_b32 v3, s65, v178
  v_lshlrev_b32 v4, 16, v214
  v_and_b32 v5, s65, v214
  v_pk_add_f32 v[2:3], v[2:3], v[4:5]
  v_cvt_pk_bf16_f32 v102, v2, v3
  v_lshlrev_b32 v6, 16, v179
  v_and_b32 v7, s65, v179
  v_lshlrev_b32 v8, 16, v215
  v_and_b32 v9, s65, v215
  v_pk_add_f32 v[6:7], v[6:7], v[8:9]
  v_cvt_pk_bf16_f32 v103, v6, v7
  ds_write_b128 v246, v[100:103] offset:48
  ds_read_b128 v[128:131], v252 offset:0
  ds_read_b128 v[132:135], v252 offset:1152
  ds_read_b128 v[136:139], v252 offset:2304
  ds_read_b128 v[140:143], v252 offset:3456
  s_waitcnt lgkmcnt(3)
  buffer_store_dwordx4 v[128:131], v235, s[28:31], 0 offen offset:0
  s_waitcnt lgkmcnt(2)
  buffer_store_dwordx4 v[132:135], v235, s[28:31], 0 offen offset:1024
  s_waitcnt lgkmcnt(1)
  buffer_store_dwordx4 v[136:139], v235, s[28:31], 0 offen offset:2048
  s_waitcnt lgkmcnt(0)
  s_cmp_eq_u32 s68, 0
  s_cbranch_scc1 NO25
  s_mov_b64 exec, s[68:69]
  buffer_store_dwordx4 v[140:143], v235, s[28:31], 0 offen offset:3072
  s_mov_b64 exec, -1
NO25:
K2END:
  s_endpgm
.section .rodata,"a"
.p2align 6
.amdhsa_kernel part_kernel
  .amdhsa_next_free_vgpr 56
  .amdhsa_next_free_sgpr 102
  .amdhsa_accum_offset 56
  .amdhsa_group_segment_fixed_size 0
  .amdhsa_kernarg_size 88
  .amdhsa_user_sgpr_count 2
  .amdhsa_user_sgpr_kernarg_segment_ptr 1
  .amdhsa_system_sgpr_workgroup_id_x 1
.end_amdhsa_kernel
.p2align 6
.amdhsa_kernel main_kernel
  .amdhsa_next_free_vgpr 256
  .amdhsa_next_free_sgpr 102
  .amdhsa_accum_offset 256
  .amdhsa_group_segment_fixed_size 0
  .amdhsa_kernarg_size 88
  .amdhsa_user_sgpr_count 2
  .amdhsa_user_sgpr_kernarg_segment_ptr 1
  .amdhsa_system_sgpr_workgroup_id_x 1
.end_amdhsa_kernel
```

```asm
; @launch kernel=part_kernel grid=(251,1,1) block=(640,1,1) lds=60432
; @launch kernel=main_kernel grid=(256,1,1) block=(512,1,1) lds=163328
.amdgcn_target "amdgcn-amd-amdhsa--gfx950"
.text
.globl part_kernel
.p2align 8
.type part_kernel,@function
part_kernel:
  s_cmp_gt_u32 s2, 250
  s_cbranch_scc1 K1END
  s_load_dwordx2 s[8:9], s[0:1], 80
  s_cmp_eq_u32 s2, 250
  s_cbranch_scc1 WPREP
  s_load_dwordx4 s[4:7], s[0:1], 24
  s_load_dwordx2 s[32:33], s[0:1], 0
  s_mul_i32 s3, s2, 12800
  v_lshlrev_b32 v2, 4, v0
  v_lshlrev_b32 v3, 2, v0
  v_add_u32 v3, 10240, v3
  v_and_b32 v1, 255, v0
  v_lshlrev_b32 v1, 2, v1
  v_mov_b32 v20, 0
  v_mov_b32 v21, 0
  v_mov_b32 v22, 0
  v_mov_b32 v23, 0
  s_waitcnt lgkmcnt(0)
  s_mov_b32 s12, s4
  s_mov_b32 s13, s5
  s_mov_b32 s14, 3200000
  s_mov_b32 s15, 0x20000
  s_mov_b32 s16, s6
  s_mov_b32 s17, s7
  s_mov_b32 s18, 3200000
  s_mov_b32 s19, 0x20000
  buffer_load_dwordx4 v[4:7], v2, s[16:19], s3 offen
  buffer_load_dword v8, v3, s[16:19], s3 offen
  buffer_load_dwordx4 v[12:15], v2, s[12:15], s3 offen
  buffer_load_dword v16, v3, s[12:15], s3 offen
  ds_write_b32 v1, v20 offset:58368
  ds_write_b32 v20, v20 offset:60416
  ds_write_b128 v2, v[20:23] offset:0
  ds_write_b128 v2, v[20:23] offset:10240
  ds_write_b128 v2, v[20:23] offset:20480
  ds_write_b128 v2, v[20:23] offset:30720
  s_mov_b32 s20, s8
  s_mov_b32 s21, s9
  s_mov_b32 s22, 8388608
  s_mov_b32 s23, 0x20000
  s_add_u32 s24, s8, 8388488
  s_addc_u32 s25, s9, 0
  s_mov_b32 s26, 14592120
  s_mov_b32 s27, 0x20000
  s_mov_b32 s28, 175921861
  s_movk_i32 s29, 3125
  s_mul_i32 s30, s2, 3200
  s_or_b32 s30, s30, 0x80000000
  v_mov_b32 v50, 1
  v_mov_b32 v49, 127
  v_lshl_add_u32 v51, v0, 2, s30
  s_add_u32 s30, s30, 2560
  v_add_u32 v52, s30, v0
  v_readfirstlane_b32 s31, v0
  s_waitcnt lgkmcnt(0)
  s_barrier
  s_waitcnt vmcnt(2)
  v_mul_hi_u32 v37, s28, v4
  v_lshrrev_b32 v20, 1, v37
  v_and_b32 v20, 0x3fc, v20
  ds_add_rtn_u32 v28, v20, v50 offset:58368
  v_mul_hi_u32 v39, s28, v5
  v_lshrrev_b32 v21, 1, v39
  v_and_b32 v21, 0x3fc, v21
  ds_add_rtn_u32 v29, v21, v50 offset:58368
  v_mul_hi_u32 v41, s28, v6
  v_lshrrev_b32 v22, 1, v41
  v_and_b32 v22, 0x3fc, v22
  ds_add_rtn_u32 v30, v22, v50 offset:58368
  v_mul_hi_u32 v43, s28, v7
  v_lshrrev_b32 v23, 1, v43
  v_and_b32 v23, 0x3fc, v23
  ds_add_rtn_u32 v31, v23, v50 offset:58368
  v_mul_hi_u32 v45, s28, v8
  v_lshrrev_b32 v24, 1, v45
  v_and_b32 v24, 0x3fc, v24
  ds_add_rtn_u32 v32, v24, v50 offset:58368
  v_mad_u32_u24 v36, v37, s29, v49
  v_lshrrev_b32 v36, 7, v36
  v_sub_u32 v4, v4, v36
  v_and_b32 v37, 7, v37
  v_mad_u32_u24 v38, v39, s29, v49
  v_lshrrev_b32 v38, 7, v38
  v_sub_u32 v5, v5, v38
  v_and_b32 v39, 7, v39
  v_mad_u32_u24 v40, v41, s29, v49
  v_lshrrev_b32 v40, 7, v40
  v_sub_u32 v6, v6, v40
  v_and_b32 v41, 7, v41
  v_mad_u32_u24 v42, v43, s29, v49
  v_lshrrev_b32 v42, 7, v42
  v_sub_u32 v7, v7, v42
  v_and_b32 v43, 7, v43
  v_mad_u32_u24 v44, v45, s29, v49
  v_lshrrev_b32 v44, 7, v44
  v_sub_u32 v8, v8, v44
  v_and_b32 v45, 7, v45
  s_waitcnt vmcnt(0)
  v_lshl_or_b32 v36, v4, 27, v12
  v_lshrrev_b32 v12, 12, v12
  v_lshl_or_b32 v37, v37, 4, v12
  v_lshl_or_b32 v37, v37, 24, v51
  v_lshl_or_b32 v38, v5, 27, v13
  v_lshrrev_b32 v13, 12, v13
  v_lshl_or_b32 v39, v39, 4, v13
  v_add_u32 v51, 1, v51
  v_lshl_or_b32 v39, v39, 24, v51
  v_lshl_or_b32 v40, v6, 27, v14
  v_lshrrev_b32 v14, 12, v14
  v_lshl_or_b32 v41, v41, 4, v14
  v_add_u32 v51, 1, v51
  v_lshl_or_b32 v41, v41, 24, v51
  v_lshl_or_b32 v42, v7, 27, v15
  v_lshrrev_b32 v15, 12, v15
  v_lshl_or_b32 v43, v43, 4, v15
  v_add_u32 v51, 1, v51
  v_lshl_or_b32 v43, v43, 24, v51
  v_lshl_or_b32 v44, v8, 27, v16
  v_lshrrev_b32 v16, 12, v16
  v_lshl_or_b32 v45, v45, 4, v16
  v_lshl_or_b32 v45, v45, 24, v52
  v_lshrrev_b32 v3, 3, v0
  s_movk_i32 s3, 128
  v_mul_u32_u24 v3, s3, v3
  v_and_b32 v1, 7, v0
  v_lshl_add_u32 v3, v1, 4, v3
  s_mul_i32 s3, s2, 32896
  s_add_u32 s4, s3, 10240
  s_add_u32 s5, s3, 20480
  s_add_u32 s6, s3, 30720
  s_mul_i32 s7, s2, 58368
  s_mov_b32 s33, 0
  s_mov_b32 s34, 0xfff20000
  v_mov_b32 v1, 60416
  v_lshlrev_b32 v4, 5, v20
  v_lshlrev_b32 v5, 5, v21
  v_lshlrev_b32 v6, 5, v22
  v_lshlrev_b32 v7, 5, v23
  v_lshlrev_b32 v8, 5, v24
  s_waitcnt lgkmcnt(4)
  v_cmp_gt_u32 s[40:41], 15, v28
  v_lshl_add_u32 v12, v28, 3, v4
  s_waitcnt lgkmcnt(3)
  v_cmp_gt_u32 s[42:43], 15, v29
  v_lshl_add_u32 v13, v29, 3, v5
  s_waitcnt lgkmcnt(2)
  v_cmp_gt_u32 s[44:45], 15, v30
  v_lshl_add_u32 v14, v30, 3, v6
  s_waitcnt lgkmcnt(1)
  v_cmp_gt_u32 s[46:47], 15, v31
  v_lshl_add_u32 v15, v31, 3, v7
  s_waitcnt lgkmcnt(0)
  v_cmp_gt_u32 s[48:49], 15, v32
  v_lshl_add_u32 v16, v32, 3, v8
  v_max3_u32 v48, v28, v29, v30
  v_max3_u32 v48, v48, v31, v32
  v_cmp_le_u32 s[50:51], 31, v48
  s_mov_b64 exec, s[40:41]
  ds_write_b64 v12, v[36:37]
  s_mov_b64 exec, s[42:43]
  ds_write_b64 v13, v[38:39]
  s_mov_b64 exec, s[44:45]
  ds_write_b64 v14, v[40:41]
  s_mov_b64 exec, s[46:47]
  ds_write_b64 v15, v[42:43]
  s_mov_b64 exec, s[48:49]
  ds_write_b64 v16, v[44:45]
  s_not_b64 exec, s[40:41]
  s_cbranch_scc0 K1N0
  v_lshl_add_u32 v48, v20, 2, s34
  v_lshl_add_u32 v48, v28, 16, v48
  ds_max_u32 v4, v48 offset:120
  v_cmpx_gt_u32 vcc, 31, v28
  s_cbranch_execz K1N0
  buffer_store_dwordx2 v[36:37], v12, s[24:27], s7 offen
K1N0:
  s_not_b64 exec, s[42:43]
  s_cbranch_scc0 K1N1
  v_lshl_add_u32 v48, v21, 2, s34
  v_lshl_add_u32 v48, v29, 16, v48
  ds_max_u32 v5, v48 offset:120
  v_cmpx_gt_u32 vcc, 31, v29
  s_cbranch_execz K1N1
  buffer_store_dwordx2 v[38:39], v13, s[24:27], s7 offen
K1N1:
  s_not_b64 exec, s[44:45]
  s_cbranch_scc0 K1N2
  v_lshl_add_u32 v48, v22, 2, s34
  v_lshl_add_u32 v48, v30, 16, v48
  ds_max_u32 v6, v48 offset:120
  v_cmpx_gt_u32 vcc, 31, v30
  s_cbranch_execz K1N2
  buffer_store_dwordx2 v[40:41], v14, s[24:27], s7 offen
K1N2:
  s_not_b64 exec, s[46:47]
  s_cbranch_scc0 K1N3
  v_lshl_add_u32 v48, v23, 2, s34
  v_lshl_add_u32 v48, v31, 16, v48
  ds_max_u32 v7, v48 offset:120
  v_cmpx_gt_u32 vcc, 31, v31
  s_cbranch_execz K1N3
  buffer_store_dwordx2 v[42:43], v15, s[24:27], s7 offen
K1N3:
  s_not_b64 exec, s[48:49]
  s_cbranch_scc0 K1N4
  v_lshl_add_u32 v48, v24, 2, s34
  v_lshl_add_u32 v48, v32, 16, v48
  ds_max_u32 v8, v48 offset:120
  v_cmpx_gt_u32 vcc, 31, v32
  s_cbranch_execz K1N4
  buffer_store_dwordx2 v[44:45], v16, s[24:27], s7 offen
K1N4:
  s_mov_b64 exec, s[50:51]
  ds_write_b32 v1, v50
  s_mov_b64 exec, -1
  s_waitcnt lgkmcnt(0)
  s_barrier
  ds_read_b32 v48, v1
K1RD:
  ds_read_b128 v[4:7], v2
  ds_read_b128 v[8:11], v2 offset:10240
  ds_read_b128 v[12:15], v2 offset:20480
  ds_read_b128 v[16:19], v2 offset:30720
  s_waitcnt lgkmcnt(3)
  v_cmp_ne_u32 vcc, 0, v48
  s_cbranch_vccnz K1SLOW
  buffer_store_dwordx4 v[4:7], v3, s[20:23], s3 offen sc1
  s_waitcnt lgkmcnt(2)
  buffer_store_dwordx4 v[8:11], v3, s[20:23], s4 offen sc1
  s_waitcnt lgkmcnt(1)
  buffer_store_dwordx4 v[12:15], v3, s[20:23], s5 offen sc1
  s_add_u32 s7, s7, 32888
  s_cmp_ge_u32 s31, 128
  s_cbranch_scc1 K1OV
  s_waitcnt lgkmcnt(0)
  buffer_store_dwordx4 v[16:19], v3, s[20:23], s6 offen sc1
K1OV:
  v_cmpx_gt_u32 vcc, s33, v2
  s_cbranch_execz K1FIN
  ds_read_b128 v[20:23], v2 offset:32768
  s_waitcnt lgkmcnt(0)
  buffer_store_dwordx4 v[20:23], v2, s[24:27], s7 offen sc1
  v_add_u32 v2, 10240, v2
  s_waitcnt vmcnt(0)
  s_branch K1OV
K1FIN:
K1END:
  s_endpgm
K1SLOW:
  v_and_b32 v1, 63, v0
  v_lshlrev_b32 v53, 9, v1
  v_lshlrev_b32 v1, 4, v1
  v_mov_b32 v48, 0xffff0000
  v_mov_b32 v49, 0xf0ff1
  s_waitcnt lgkmcnt(0)
  ds_read_b128 v[4:7], v1 offset:58368
  s_waitcnt lgkmcnt(0)
  v_cmp_lt_u32 s[40:41], 31, v4
  v_subrev_u32 v4, 15, v4
  v_cmp_lt_u32 s[42:43], 31, v5
  v_subrev_u32 v5, 15, v5
  v_cmp_lt_u32 s[44:45], 31, v6
  v_subrev_u32 v6, 15, v6
  v_cmp_lt_u32 s[46:47], 31, v7
  v_subrev_u32 v7, 15, v7
  v_cndmask_b32 v4, 0, v4, s[40:41]
  v_cndmask_b32 v5, 0, v5, s[42:43]
  v_cndmask_b32 v6, 0, v6, s[44:45]
  v_cndmask_b32 v7, 0, v7, s[46:47]
  v_add_u32 v8, v4, v5
  v_add_u32 v9, v8, v6
  v_add_u32 v10, v9, v7
  v_mov_b32 v11, v10
  s_nop 1
  v_add_u32_dpp v11, v11, v11 row_shr:1 row_mask:0xf bank_mask:0xf
  s_nop 1
  v_add_u32_dpp v11, v11, v11 row_shr:2 row_mask:0xf bank_mask:0xf
  s_nop 1
  v_add_u32_dpp v11, v11, v11 row_shr:4 row_mask:0xf bank_mask:0xf
  s_nop 1
  v_add_u32_dpp v11, v11, v11 row_shr:8 row_mask:0xf bank_mask:0xf
  s_nop 1
  v_add_u32_dpp v11, v11, v11 row_bcast:15 row_mask:0xa bank_mask:0xf
  s_nop 1
  v_add_u32_dpp v11, v11, v11 row_bcast:31 row_mask:0xc bank_mask:0xf
  v_cndmask_b32 v16, v48, v49, s[40:41]
  v_cndmask_b32 v17, v48, v49, s[42:43]
  v_cndmask_b32 v18, v48, v49, s[44:45]
  v_cndmask_b32 v19, v48, v49, s[46:47]
  v_sub_u32 v12, v11, v10
  v_add_u32 v13, v12, v4
  v_add_u32 v14, v12, v8
  v_add_u32 v15, v12, v9
  v_readlane_b32 s33, v11, 63
  v_add_u32 v16, v16, v12
  v_add_u32 v17, v17, v13
  v_add_u32 v18, v18, v14
  v_add_u32 v19, v19, v15
  ds_write_b128 v1, v[16:19] offset:59392
  ds_read_b32 v20, v20 offset:59392
  ds_read_b32 v21, v21 offset:59392
  ds_read_b32 v22, v22 offset:59392
  ds_read_b32 v23, v23 offset:59392
  ds_read_b32 v24, v24 offset:59392
  v_lshl_or_b32 v4, v4, 16, v12
  v_add_u32 v4, 4096, v4
  s_mov_b64 exec, s[40:41]
  ds_write_b32 v53, v4 offset:120
  s_mov_b64 exec, -1
  v_lshl_or_b32 v5, v5, 16, v13
  v_add_u32 v5, 4096, v5
  s_mov_b64 exec, s[42:43]
  ds_write_b32 v53, v5 offset:248
  s_mov_b64 exec, -1
  v_lshl_or_b32 v6, v6, 16, v14
  v_add_u32 v6, 4096, v6
  s_mov_b64 exec, s[44:45]
  ds_write_b32 v53, v6 offset:376
  s_mov_b64 exec, -1
  v_lshl_or_b32 v7, v7, 16, v15
  v_add_u32 v7, 4096, v7
  s_mov_b64 exec, s[46:47]
  ds_write_b32 v53, v7 offset:504
  s_mov_b64 exec, -1
  s_waitcnt lgkmcnt(0)
  v_cmp_ge_u32_sdwa vcc, v28, v20 src0_sel:DWORD src1_sel:WORD_1
  v_and_b32 v20, 0xffff, v20
  v_add_lshl_u32 v20, v20, v28, 3
  s_mov_b64 exec, vcc
  ds_write_b64 v20, v[36:37]
  s_mov_b64 exec, -1
  v_cmp_ge_u32_sdwa vcc, v29, v21 src0_sel:DWORD src1_sel:WORD_1
  v_and_b32 v21, 0xffff, v21
  v_add_lshl_u32 v21, v21, v29, 3
  s_mov_b64 exec, vcc
  ds_write_b64 v21, v[38:39]
  s_mov_b64 exec, -1
  v_cmp_ge_u32_sdwa vcc, v30, v22 src0_sel:DWORD src1_sel:WORD_1
  v_and_b32 v22, 0xffff, v22
  v_add_lshl_u32 v22, v22, v30, 3
  s_mov_b64 exec, vcc
  ds_write_b64 v22, v[40:41]
  s_mov_b64 exec, -1
  v_cmp_ge_u32_sdwa vcc, v31, v23 src0_sel:DWORD src1_sel:WORD_1
  v_and_b32 v23, 0xffff, v23
  v_add_lshl_u32 v23, v23, v31, 3
  s_mov_b64 exec, vcc
  ds_write_b64 v23, v[42:43]
  s_mov_b64 exec, -1
  v_cmp_ge_u32_sdwa vcc, v32, v24 src0_sel:DWORD src1_sel:WORD_1
  v_and_b32 v24, 0xffff, v24
  v_add_lshl_u32 v24, v24, v32, 3
  s_mov_b64 exec, vcc
  ds_write_b64 v24, v[44:45]
  s_mov_b64 exec, -1
  s_lshl_b32 s33, s33, 3
  v_mov_b32 v48, 0
  s_waitcnt lgkmcnt(0)
  s_barrier
  s_branch K1RD
WPREP:
  s_load_dwordx4 s[4:7], s[0:1], 40
  v_lshrrev_b32 v2, 6, v0
  v_and_b32 v1, 63, v0
  v_readfirstlane_b32 s31, v2
  s_mov_b32 s28, 0xbfb8aa3b
  s_mov_b32 s29, 0xbfb8aa3b
  s_mov_b32 s30, 0xffff0000
  s_waitcnt lgkmcnt(0)
  s_mov_b32 s12, s4
  s_mov_b32 s13, s5
  s_mov_b32 s14, 18560
  s_mov_b32 s15, 0x20000
  s_mov_b32 s16, s6
  s_mov_b32 s17, s7
  s_mov_b32 s18, 128
  s_mov_b32 s19, 0x20000
  s_add_u32 s20, s8, 23068672
  s_addc_u32 s21, s9, 0
  s_mov_b32 s22, 24576
  s_mov_b32 s23, 0x20000
  v_and_b32 v2, 7, v1
  v_bfe_u32 v3, v1, 4, 1
  v_lshlrev_b32 v4, 2, v3
  v_xor_b32 v4, v4, v2
  v_lshlrev_b32 v4, 4, v4
  v_lshrrev_b32 v5, 3, v1
  v_lshl_or_b32 v4, v5, 7, v4
  s_lshl_b32 s3, s31, 10
  s_add_u32 s4, s3, 10240
  v_add_u32 v4, s3, v4
  s_mov_b32 m0, s3
  s_nop 0
  buffer_load_dwordx4 v4, s[12:15], 0 offen lds
  v_add_u32 v4, 10240, v4
  s_mov_b32 m0, s4
  s_nop 0
  buffer_load_dwordx4 v4, s[12:15], 0 offen lds
  v_lshrrev_b32 v5, 5, v1
  v_lshlrev_b32 v7, 3, v5
  buffer_load_dwordx2 v[28:29], v7, s[16:19], 0 offen offset:0
  buffer_load_dwordx2 v[30:31], v7, s[16:19], 0 offen offset:16
  buffer_load_dwordx2 v[32:33], v7, s[16:19], 0 offen offset:32
  buffer_load_dwordx2 v[34:35], v7, s[16:19], 0 offen offset:48
  buffer_load_dwordx2 v[36:37], v7, s[16:19], 0 offen offset:64
  buffer_load_dwordx2 v[38:39], v7, s[16:19], 0 offen offset:80
  buffer_load_dwordx2 v[40:41], v7, s[16:19], 0 offen offset:96
  buffer_load_dwordx2 v[42:43], v7, s[16:19], 0 offen offset:112
  v_and_b32 v2, 3, v1
  v_bfe_u32 v4, v1, 2, 2
  v_lshlrev_b32 v2, 3, v2
  v_lshl_add_u32 v2, v3, 5, v2
  v_lshl_add_u32 v2, v4, 7, v2
  v_lshl_add_u32 v6, v5, 12, v2
  v_lshrrev_b32 v3, 1, v4
  v_lshl_add_u32 v6, v3, 6, v6
  v_lshl_add_u32 v8, v5, 10, v2
  v_add_u32 v3, 1, v4
  v_bfe_u32 v3, v3, 1, 1
  v_lshl_add_u32 v8, v3, 6, v8
  v_xor_b32 v9, 64, v8
  s_and_b32 s3, s31, 1
  s_lshl_b32 s3, s3, 6
  v_xor_b32 v6, s3, v6
  s_lshr_b32 s3, s31, 1
  s_lshl_b32 s3, s3, 13
  v_add_u32 v6, s3, v6
  v_lshlrev_b32 v10, 4, v1
  s_lshl_b32 s3, s31, 12
  s_waitcnt vmcnt(0)
  s_barrier
  s_cmp_eq_u32 s31, 4
  s_cbranch_scc1 WP4
  s_cmp_eq_u32 s31, 5
  s_cbranch_scc1 WP5
  s_cmp_gt_u32 s31, 5
  s_cbranch_scc1 WPEND
  ds_read_b64_tr_b16 v[12:13], v6 offset:0
  ds_read_b64_tr_b16 v[14:15], v6 offset:512
  ds_read_b64_tr_b16 v[16:17], v6 offset:1024
  ds_read_b64_tr_b16 v[18:19], v6 offset:1536
  ds_read_b64_tr_b16 v[20:21], v6 offset:2048
  ds_read_b64_tr_b16 v[22:23], v6 offset:2560
  ds_read_b64_tr_b16 v[24:25], v6 offset:3072
  ds_read_b64_tr_b16 v[26:27], v6 offset:3584
  s_waitcnt lgkmcnt(0)
  s_cmp_lt_u32 s31, 2
  s_cbranch_scc1 WPST
  v_lshlrev_b32 v2, 16, v12
  v_and_b32 v3, s30, v12
  v_pk_mul_f32 v[2:3], v[2:3], s[28:29]
  v_cvt_pk_bf16_f32 v12, v2, v3
  v_lshlrev_b32 v2, 16, v13
  v_and_b32 v3, s30, v13
  v_pk_mul_f32 v[2:3], v[2:3], s[28:29]
  v_cvt_pk_bf16_f32 v13, v2, v3
  v_lshlrev_b32 v2, 16, v14
  v_and_b32 v3, s30, v14
  v_pk_mul_f32 v[2:3], v[2:3], s[28:29]
  v_cvt_pk_bf16_f32 v14, v2, v3
  v_lshlrev_b32 v2, 16, v15
  v_and_b32 v3, s30, v15
  v_pk_mul_f32 v[2:3], v[2:3], s[28:29]
  v_cvt_pk_bf16_f32 v15, v2, v3
  v_lshlrev_b32 v2, 16, v16
  v_and_b32 v3, s30, v16
  v_pk_mul_f32 v[2:3], v[2:3], s[28:29]
  v_cvt_pk_bf16_f32 v16, v2, v3
  v_lshlrev_b32 v2, 16, v17
  v_and_b32 v3, s30, v17
  v_pk_mul_f32 v[2:3], v[2:3], s[28:29]
  v_cvt_pk_bf16_f32 v17, v2, v3
  v_lshlrev_b32 v2, 16, v18
  v_and_b32 v3, s30, v18
  v_pk_mul_f32 v[2:3], v[2:3], s[28:29]
  v_cvt_pk_bf16_f32 v18, v2, v3
  v_lshlrev_b32 v2, 16, v19
  v_and_b32 v3, s30, v19
  v_pk_mul_f32 v[2:3], v[2:3], s[28:29]
  v_cvt_pk_bf16_f32 v19, v2, v3
  v_lshlrev_b32 v2, 16, v20
  v_and_b32 v3, s30, v20
  v_pk_mul_f32 v[2:3], v[2:3], s[28:29]
  v_cvt_pk_bf16_f32 v20, v2, v3
  v_lshlrev_b32 v2, 16, v21
  v_and_b32 v3, s30, v21
  v_pk_mul_f32 v[2:3], v[2:3], s[28:29]
  v_cvt_pk_bf16_f32 v21, v2, v3
  v_lshlrev_b32 v2, 16, v22
  v_and_b32 v3, s30, v22
  v_pk_mul_f32 v[2:3], v[2:3], s[28:29]
  v_cvt_pk_bf16_f32 v22, v2, v3
  v_lshlrev_b32 v2, 16, v23
  v_and_b32 v3, s30, v23
  v_pk_mul_f32 v[2:3], v[2:3], s[28:29]
  v_cvt_pk_bf16_f32 v23, v2, v3
  v_lshlrev_b32 v2, 16, v24
  v_and_b32 v3, s30, v24
  v_pk_mul_f32 v[2:3], v[2:3], s[28:29]
  v_cvt_pk_bf16_f32 v24, v2, v3
  v_lshlrev_b32 v2, 16, v25
  v_and_b32 v3, s30, v25
  v_pk_mul_f32 v[2:3], v[2:3], s[28:29]
  v_cvt_pk_bf16_f32 v25, v2, v3
  v_lshlrev_b32 v2, 16, v26
  v_and_b32 v3, s30, v26
  v_pk_mul_f32 v[2:3], v[2:3], s[28:29]
  v_cvt_pk_bf16_f32 v26, v2, v3
  v_lshlrev_b32 v2, 16, v27
  v_and_b32 v3, s30, v27
  v_pk_mul_f32 v[2:3], v[2:3], s[28:29]
  v_cvt_pk_bf16_f32 v27, v2, v3
WPST:
  buffer_store_dwordx4 v[12:15], v10, s[20:23], s3 offen offset:0
  buffer_store_dwordx4 v[16:19], v10, s[20:23], s3 offen offset:1024
  buffer_store_dwordx4 v[20:23], v10, s[20:23], s3 offen offset:2048
  buffer_store_dwordx4 v[24:27], v10, s[20:23], s3 offen offset:3072
  s_endpgm
WP4:
  ds_read_b64_tr_b16 v[12:13], v8 offset:16512
  ds_read_b64_tr_b16 v[14:15], v8 offset:17024
  ds_read_b64_tr_b16 v[16:17], v9 offset:16512
  ds_read_b64_tr_b16 v[18:19], v9 offset:17024
  v_and_b32 v2, 31, v1
  v_lshlrev_b32 v2, 1, v2
  ds_read_u16 v20, v2 offset:16384
  ds_read_u16 v21, v2 offset:16448
  v_subrev_u32 v5, 1, v5
  s_waitcnt lgkmcnt(0)
  v_lshlrev_b32 v2, 16, v12
  v_and_b32 v3, s30, v12
  v_pk_mul_f32 v[2:3], v[2:3], s[28:29]
  v_cvt_pk_bf16_f32 v12, v2, v3
  v_lshlrev_b32 v2, 16, v13
  v_and_b32 v3, s30, v13
  v_pk_mul_f32 v[2:3], v[2:3], s[28:29]
  v_cvt_pk_bf16_f32 v13, v2, v3
  v_lshlrev_b32 v2, 16, v14
  v_and_b32 v3, s30, v14
  v_pk_mul_f32 v[2:3], v[2:3], s[28:29]
  v_cvt_pk_bf16_f32 v14, v2, v3
  v_lshlrev_b32 v2, 16, v15
  v_and_b32 v3, s30, v15
  v_pk_mul_f32 v[2:3], v[2:3], s[28:29]
  v_cvt_pk_bf16_f32 v15, v2, v3
  v_lshlrev_b32 v2, 16, v16
  v_and_b32 v3, s30, v16
  v_pk_mul_f32 v[2:3], v[2:3], s[28:29]
  v_cvt_pk_bf16_f32 v16, v2, v3
  v_lshlrev_b32 v2, 16, v17
  v_and_b32 v3, s30, v17
  v_pk_mul_f32 v[2:3], v[2:3], s[28:29]
  v_cvt_pk_bf16_f32 v17, v2, v3
  v_lshlrev_b32 v2, 16, v18
  v_and_b32 v3, s30, v18
  v_pk_mul_f32 v[2:3], v[2:3], s[28:29]
  v_cvt_pk_bf16_f32 v18, v2, v3
  v_lshlrev_b32 v2, 16, v19
  v_and_b32 v3, s30, v19
  v_pk_mul_f32 v[2:3], v[2:3], s[28:29]
  v_cvt_pk_bf16_f32 v19, v2, v3
  v_lshlrev_b32 v20, 16, v20
  v_mul_f32 v20, s28, v20
  v_cvt_pk_f16_f32 v20, v20, 0
  v_and_b32 v20, v5, v20
  v_mov_b32 v22, 0
  v_lshlrev_b32 v21, 16, v21
  v_mul_f32 v21, s28, v21
  v_cvt_pk_f16_f32 v21, v21, 0
  v_and_b32 v21, v5, v21
  v_mov_b32 v23, 0
  buffer_store_dwordx4 v[12:15], v10, s[20:23], s3 offen offset:0
  buffer_store_dwordx4 v[16:19], v10, s[20:23], s3 offen offset:1024
  buffer_store_dwordx4 v[20:23], v10, s[20:23], s3 offen offset:2048
  buffer_store_dwordx4 v[20:23], v10, s[20:23], s3 offen offset:3072
  s_endpgm
WP5:
  v_lshrrev_b32 v4, 2, v1
  v_lshrrev_b32 v8, 4, v1
  v_xor_b32 v4, v4, v8
  v_and_b32 v4, 1, v4
  v_subrev_u32 v4, 1, v4
  v_lshlrev_b32 v2, 16, v28
  v_and_b32 v3, s30, v28
  v_cvt_pk_f16_f32 v2, v2, v3
  v_and_b32 v12, v4, v2
  v_lshlrev_b32 v2, 16, v29
  v_and_b32 v3, s30, v29
  v_cvt_pk_f16_f32 v2, v2, v3
  v_and_b32 v13, v4, v2
  v_lshlrev_b32 v2, 16, v30
  v_and_b32 v3, s30, v30
  v_cvt_pk_f16_f32 v2, v2, v3
  v_and_b32 v14, v4, v2
  v_lshlrev_b32 v2, 16, v31
  v_and_b32 v3, s30, v31
  v_cvt_pk_f16_f32 v2, v2, v3
  v_and_b32 v15, v4, v2
  v_lshlrev_b32 v2, 16, v32
  v_and_b32 v3, s30, v32
  v_cvt_pk_f16_f32 v2, v2, v3
  v_and_b32 v16, v4, v2
  v_lshlrev_b32 v2, 16, v33
  v_and_b32 v3, s30, v33
  v_cvt_pk_f16_f32 v2, v2, v3
  v_and_b32 v17, v4, v2
  v_lshlrev_b32 v2, 16, v34
  v_and_b32 v3, s30, v34
  v_cvt_pk_f16_f32 v2, v2, v3
  v_and_b32 v18, v4, v2
  v_lshlrev_b32 v2, 16, v35
  v_and_b32 v3, s30, v35
  v_cvt_pk_f16_f32 v2, v2, v3
  v_and_b32 v19, v4, v2
  v_lshlrev_b32 v2, 16, v36
  v_and_b32 v3, s30, v36
  v_cvt_pk_f16_f32 v2, v2, v3
  v_and_b32 v20, v4, v2
  v_lshlrev_b32 v2, 16, v37
  v_and_b32 v3, s30, v37
  v_cvt_pk_f16_f32 v2, v2, v3
  v_and_b32 v21, v4, v2
  v_lshlrev_b32 v2, 16, v38
  v_and_b32 v3, s30, v38
  v_cvt_pk_f16_f32 v2, v2, v3
  v_and_b32 v22, v4, v2
  v_lshlrev_b32 v2, 16, v39
  v_and_b32 v3, s30, v39
  v_cvt_pk_f16_f32 v2, v2, v3
  v_and_b32 v23, v4, v2
  v_lshlrev_b32 v2, 16, v40
  v_and_b32 v3, s30, v40
  v_cvt_pk_f16_f32 v2, v2, v3
  v_and_b32 v24, v4, v2
  v_lshlrev_b32 v2, 16, v41
  v_and_b32 v3, s30, v41
  v_cvt_pk_f16_f32 v2, v2, v3
  v_and_b32 v25, v4, v2
  v_lshlrev_b32 v2, 16, v42
  v_and_b32 v3, s30, v42
  v_cvt_pk_f16_f32 v2, v2, v3
  v_and_b32 v26, v4, v2
  v_lshlrev_b32 v2, 16, v43
  v_and_b32 v3, s30, v43
  v_cvt_pk_f16_f32 v2, v2, v3
  v_and_b32 v27, v4, v2
  s_branch WPST
WPEND:
  s_endpgm
.globl main_kernel
.p2align 8
.type main_kernel,@function
main_kernel:
  s_cmp_ge_u32 s2, 256
  s_cbranch_scc1 K2END
  s_load_dwordx2 s[52:53], s[0:1], 80
  s_load_dwordx8 s[32:39], s[0:1], 0
  s_load_dwordx4 s[48:51], s[0:1], 56
  s_and_b32 s3, s2, 7
  s_lshl_b32 s3, s3, 5
  s_lshr_b32 s56, s2, 3
  s_add_u32 s56, s56, s3
  v_lshrrev_b32 v2, 6, v0
  v_and_b32 v0, 63, v0
  v_readfirstlane_b32 s57, v2
  s_mov_b32 s60, 47
  s_mov_b32 s61, 0
  s_mov_b32 s63, 1
  s_mov_b32 s54, 1
  s_movk_i32 s55, 2176
  s_movk_i32 s94, 17404
  s_movk_i32 s95, 0xf0
  s_movk_i32 s64, 128
  s_mov_b32 s65, 0xffff0000
  s_mov_b32 s70, 0xbfb8aa3b
  s_mov_b32 s71, 0xbfb8aa3b
  s_mov_b32 s72, 1.0
  s_mov_b32 s73, 1.0
  s_mov_b32 s74, -1
  s_mov_b32 s75, 0
  s_lshl_b32 s66, s57, 12
  s_add_u32 s66, s66, 81408
  s_lshl_b32 s67, s57, 10
  s_add_u32 s67, s67, 36352
  s_mul_i32 s3, s56, 128
  s_mov_b32 s18, 8191232
  s_mov_b32 s19, 0x20000
  s_waitcnt lgkmcnt(0)
  s_add_u32 s16, s52, s3
  s_addc_u32 s17, s53, 0
ROUND:
  s_lshl_b32 s3, s57, 12
  v_lshl_add_u32 v2, v0, 4, s3
  v_lshrrev_b32 v3, 7, v2
  v_lshl_add_u32 v2, v3, 15, v2
  buffer_load_dwordx4 v[128:131], v2, s[16:19], 0 offen offset:0
  v_add_u32 v2, 262144, v2
  buffer_load_dwordx4 v[132:135], v2, s[16:19], 0 offen offset:1024
  v_add_u32 v2, 262144, v2
  buffer_load_dwordx4 v[136:139], v2, s[16:19], 0 offen offset:2048
  v_add_u32 v2, 262144, v2
  buffer_load_dwordx4 v[140:143], v2, s[16:19], 0 offen offset:3072
  s_and_b32 s3, s57, 3
  s_lshl_b32 s3, s3, 8
  v_lshl_add_u32 v4, v0, 2, s3
  v_mov_b32 v5, 0
  ds_write_b32 v4, v5 offset:34816
  s_cmp_eq_u32 s63, 0
  s_cbranch_scc1 NOTFIRST1
  s_mov_b32 s4, s32
  s_mov_b32 s5, s33
  s_mov_b32 s6, 6400000
  s_mov_b32 s7, 0x20000
  s_mov_b32 s12, s34
  s_mov_b32 s13, s35
  s_mov_b32 s14, 300000
  s_mov_b32 s15, 0x20000
  v_and_b32 v2, 7, v0
  v_bfe_u32 v3, v0, 4, 1
  v_lshrrev_b32 v5, 3, v0
  v_lshrrev_b32 v6, 5, v0
  v_lshl_add_u32 v233, v6, 2, 0
  v_xor_b32 v233, v233, v2
  v_lshlrev_b32 v233, 4, v233
  v_lshl_add_u32 v234, v6, 2, 1
  v_xor_b32 v234, v234, v2
  v_lshlrev_b32 v234, 4, v234
  v_lshl_add_u32 v235, v6, 2, 2
  v_xor_b32 v235, v235, v2
  v_lshlrev_b32 v235, 4, v235
  v_lshl_add_u32 v236, v6, 2, 3
  v_xor_b32 v236, v236, v2
  v_lshlrev_b32 v236, 4, v236
  v_lshl_add_u32 v7, v5, 2, 0
  v_mad_u32_u24 v56, v7, s64, v233
  v_lshl_add_u32 v7, v5, 2, 1
  v_mad_u32_u24 v57, v7, s64, v234
  v_lshl_add_u32 v7, v5, 2, 2
  v_mad_u32_u24 v58, v7, s64, v235
  v_lshl_add_u32 v7, v5, 2, 3
  v_mad_u32_u24 v59, v7, s64, v236
  s_mov_b32 s8, s36
  s_mov_b32 s9, s37
  s_mov_b32 s10, 25600000
  s_mov_b32 s11, 0x20000
  s_mov_b32 s28, s50
  s_mov_b32 s29, s51
  s_mov_b32 s30, 6700000
  s_mov_b32 s31, 0x20000
  s_mov_b32 s24, s48
  s_mov_b32 s25, s49
  s_mov_b32 s26, 16384
  s_mov_b32 s27, 0x20000
  s_add_u32 s20, s52, 8388608
  s_addc_u32 s21, s53, 0
  s_mov_b32 s22, 14704640
  s_mov_b32 s23, 0x20000
  v_lshlrev_b32 v13, 1, v3
  v_xor_b32 v13, v13, v2
  v_lshlrev_b32 v13, 4, v13
  v_lshl_or_b32 v13, v5, 7, v13
  s_lshl_b32 s3, s57, 10
  v_lshl_add_u32 v10, v0, 4, s3
  v_add_u32 v10, 14680064, v10
  v_add_u32 v13, s3, v13
  v_lshlrev_b32 v250, 4, v6
  v_and_b32 v2, 3, v0
  v_bfe_u32 v4, v0, 2, 3
  v_lshl_add_u32 v4, v2, 3, v4
  v_xor_b32 v7, v3, v6
  v_lshlrev_b32 v7, 6, v7
  v_lshl_add_u32 v4, v4, 7, v7
  v_add_u32 v4, s66, v4
  v_xor_b32 v7, 0, v2
  v_lshl_add_u32 v237, v7, 4, v4
  v_xor_b32 v7, 1, v2
  v_lshl_add_u32 v238, v7, 4, v4
  v_xor_b32 v7, 2, v2
  v_lshl_add_u32 v239, v7, 4, v4
  v_xor_b32 v7, 3, v2
  v_lshl_add_u32 v240, v7, 4, v4
  s_add_u32 s3, s67, 32
  v_lshlrev_b32 v7, 5, v6
  v_sub_u32 v241, s3, v7
  s_add_u32 s3, s67, 224
  v_lshl_add_u32 v7, v3, 2, v2
  v_lshlrev_b32 v7, 5, v7
  v_sub_u32 v243, s3, v7
  s_mul_i32 s3, s57, 4608
  s_add_u32 s3, s3, 44544
  v_and_b32 v7, 31, v0
  s_movk_i32 s68, 144
  v_mul_u32_u24 v8, s68, v7
  v_add_u32 v8, s3, v8
  v_lshl_add_u32 v242, v6, 5, v8
  v_bfe_u32 v4, v0, 2, 2
  v_lshl_add_u32 v8, v6, 2, v4
  s_movk_i32 s68, 576
  v_mul_u32_u24 v9, s68, v8
  v_add_u32 v9, s3, v9
  v_xor_b32 v245, v3, v0
  v_and_b32 v245, 1, v245
  v_lshl_add_u32 v245, v245, 3, v9
  v_add_u32 v245, 128, v245
  v_lshl_add_u32 v244, v3, 5, v9
  v_lshl_add_u32 v244, v2, 3, v244
  v_xor_b32 v253, v3, v0
  v_and_b32 v253, 1, v253
  v_lshlrev_b32 v253, 4, v253
  v_xor_b32 v254, v5, v6
  v_and_b32 v254, 1, v254
  v_lshlrev_b32 v254, 4, v254
  v_lshl_add_u32 v254, v7, 5, v254
  s_add_u32 s3, s67, 118784
  v_add_u32 v254, s3, v254
  v_mov_b32 v72, 0
  v_mov_b32 v73, 0
  v_mov_b32 v74, 0x3c00
  v_mov_b32 v75, 0x3c000000
  v_cmp_eq_u32 vcc, 28, v0
  s_nop 1
  v_cndmask_b32 v72, v72, v74, vcc
  v_cmp_eq_u32 vcc, 29, v0
  s_nop 1
  v_cndmask_b32 v72, v72, v75, vcc
  v_cmp_eq_u32 vcc, 30, v0
  s_nop 1
  v_cndmask_b32 v73, v73, v74, vcc
  v_cmp_eq_u32 vcc, 31, v0
  s_nop 1
  v_cndmask_b32 v73, v73, v75, vcc
  v_lshl_add_u32 v9, v0, 3, s67
  ds_write_b64 v9, v[72:73]
  v_mov_b32 v88, 0
  v_mov_b32 v89, 0
  v_mov_b32 v90, 0
  v_mov_b32 v91, 0
  v_mov_b32 v92, 0
  v_mov_b32 v93, 0
  v_mov_b32 v94, 0
  v_mov_b32 v95, 0
  v_mov_b32 v96, 0
  v_mov_b32 v97, 0
  v_mov_b32 v98, 0
  v_mov_b32 v99, 0
  v_mov_b32 v100, 0
  v_mov_b32 v101, 0
  v_mov_b32 v102, 0
  v_mov_b32 v103, 0
  v_mov_b32 v104, 0
  v_mov_b32 v105, 0
  v_mov_b32 v106, 0
  v_mov_b32 v107, 0
  v_mov_b32 v108, 0
  v_mov_b32 v109, 0
  v_mov_b32 v110, 0
  v_mov_b32 v111, 0
  v_mov_b32 v112, 0
  v_mov_b32 v113, 0
  v_mov_b32 v114, 0
  v_mov_b32 v115, 0
  v_mov_b32 v116, 0
  v_mov_b32 v117, 0
  v_mov_b32 v118, 0
  v_mov_b32 v119, 0
  v_mov_b32 v120, 0
  v_mov_b32 v121, 0
  v_mov_b32 v122, 0
  v_mov_b32 v123, 0
  s_branch FIRST1
NOTFIRST1:
  s_waitcnt vmcnt(0)
FIRST1:
  s_lshl_b32 s3, s57, 5
  v_lshrrev_b32 v2, 3, v0
  v_add_u32 v2, s3, v2
  s_mov_b32 s3, 58368
  v_mul_u32_u24 v2, s3, v2
  v_and_b32 v3, 7, v0
  v_lshl_add_u32 v2, v3, 4, v2
  v_lshlrev_b32 v3, 1, v3
  s_sub_i32 s68, s61, 15
  s_add_i32 s69, s68, s60
  s_max_i32 s68, s68, 0
  s_lshl_b32 s3, s68, 3
  v_add_u32 v2, s3, v2
  v_add_u32 v4, s68, v3
  v_mov_b32 v9, 1
  s_waitcnt lgkmcnt(0)
  s_barrier
  s_waitcnt vmcnt(3)
  v_ashrrev_i32 v5, 31, v131
  v_bfi_b32 v5, v5, 0, v130
  s_mov_b32 s3, 0
  v_mov_b32_dpp v6, v5 quad_perm:[3,3,3,3] row_mask:0xf bank_mask:0xf
  s_nop 1
  v_or_b32_dpp v6, v6, v6 row_half_mirror row_mask:0xf bank_mask:0xf
  v_lshrrev_b32 v224, 16, v6
  v_and_b32 v6, 0xffff, v6
  v_lshl_add_u32 v6, v6, 3, v2
  v_add_u32 v220, s3, v6
  v_min_i32 v216, s69, v224
  v_sub_u32 v216, v216, v4
  v_cmp_lt_i32 vcc, 0, v216
  s_nop 1
  v_cndmask_b32 v6, -16, v220, vcc
  buffer_load_dwordx4 v[144:147], v6, s[20:23], 0 offen
  s_waitcnt vmcnt(3)
  v_ashrrev_i32 v5, 31, v135
  v_bfi_b32 v5, v5, 0, v134
  s_mov_b32 s3, 466944
  v_mov_b32_dpp v6, v5 quad_perm:[3,3,3,3] row_mask:0xf bank_mask:0xf
  s_nop 1
  v_or_b32_dpp v6, v6, v6 row_half_mirror row_mask:0xf bank_mask:0xf
  v_lshrrev_b32 v225, 16, v6
  v_and_b32 v6, 0xffff, v6
  v_lshl_add_u32 v6, v6, 3, v2
  v_add_u32 v221, s3, v6
  v_min_i32 v217, s69, v225
  v_sub_u32 v217, v217, v4
  v_cmp_lt_i32 vcc, 0, v217
  s_nop 1
  v_cndmask_b32 v6, -16, v221, vcc
  buffer_load_dwordx4 v[148:151], v6, s[20:23], 0 offen
  s_waitcnt vmcnt(3)
  v_ashrrev_i32 v5, 31, v139
  v_bfi_b32 v5, v5, 0, v138
  s_mov_b32 s3, 933888
  v_mov_b32_dpp v6, v5 quad_perm:[3,3,3,3] row_mask:0xf bank_mask:0xf
  s_nop 1
  v_or_b32_dpp v6, v6, v6 row_half_mirror row_mask:0xf bank_mask:0xf
  v_lshrrev_b32 v226, 16, v6
  v_and_b32 v6, 0xffff, v6
  v_lshl_add_u32 v6, v6, 3, v2
  v_add_u32 v222, s3, v6
  v_min_i32 v218, s69, v226
  v_sub_u32 v218, v218, v4
  v_cmp_lt_i32 vcc, 0, v218
  s_nop 1
  v_cndmask_b32 v6, -16, v222, vcc
  buffer_load_dwordx4 v[152:155], v6, s[20:23], 0 offen
  s_waitcnt vmcnt(3)
  v_ashrrev_i32 v5, 31, v143
  v_bfi_b32 v5, v5, 0, v142
  s_mov_b32 s3, 1400832
  v_mov_b32_dpp v6, v5 quad_perm:[3,3,3,3] row_mask:0xf bank_mask:0xf
  s_nop 1
  v_or_b32_dpp v6, v6, v6 row_half_mirror row_mask:0xf bank_mask:0xf
  v_lshrrev_b32 v227, 16, v6
  v_and_b32 v6, 0xffff, v6
  v_lshl_add_u32 v6, v6, 3, v2
  v_add_u32 v223, s3, v6
  v_min_i32 v219, s69, v227
  v_sub_u32 v219, v219, v4
  v_cmp_lt_i32 vcc, 0, v219
  s_nop 1
  v_cndmask_b32 v6, -16, v223, vcc
  buffer_load_dwordx4 v[156:159], v6, s[20:23], 0 offen
  s_cmp_eq_u32 s63, 0
  s_cbranch_scc1 NOLATE1
  s_lshl_b32 m0, s57, 10
  s_add_u32 m0, m0, 130560
  s_nop 0
  buffer_load_dwordx4 v10, s[20:23], 0 offen lds
  v_add_u32 v10, 0x2000, v10
  s_lshl_b32 m0, s57, 10
  s_add_u32 m0, m0, 138752
  s_nop 0
  buffer_load_dwordx4 v10, s[20:23], 0 offen lds
  v_add_u32 v10, 0x2000, v10
  s_lshl_b32 m0, s57, 10
  s_add_u32 m0, m0, 146944
  s_nop 0
  buffer_load_dwordx4 v10, s[20:23], 0 offen lds
NOLATE1:
  v_max3_i32 v5, v216, v217, v218
  v_max_i32 v5, v5, v219
  v_cmp_lt_i32 s[76:77], 16, v5
  v_max3_i32 v5, v224, v225, v226
  v_max_i32 v5, v5, v227
  s_max_i32 s69, s69, 0
  v_cmp_lt_i32 s[68:69], s69, v5
  s_cmp_eq_u64 s[76:77], 0
  s_cbranch_scc1 NOL2A
  v_cmpx_lt_i32 vcc, 16, v216
  buffer_load_dwordx4 v[160:163], v220, s[20:23], 0 offen offset:128
  s_mov_b64 exec, -1
  v_cmpx_lt_i32 vcc, 16, v217
  buffer_load_dwordx4 v[164:167], v221, s[20:23], 0 offen offset:128
  s_mov_b64 exec, -1
  v_cmpx_lt_i32 vcc, 16, v218
  buffer_load_dwordx4 v[168:171], v222, s[20:23], 0 offen offset:128
  s_mov_b64 exec, -1
  v_cmpx_lt_i32 vcc, 16, v219
  buffer_load_dwordx4 v[172:175], v223, s[20:23], 0 offen offset:128
  s_mov_b64 exec, -1
NOL2A:
  s_cmp_lg_u32 s63, 0
  s_cbranch_scc1 FIRST2
  s_add_u32 s3, s61, s60
  v_add_u32 v5, 0, v3
  v_cmp_le_u32 s[32:33], s3, v5
  v_cmp_gt_u32 s[34:35], s61, v5
  s_or_b64 s[34:35], s[34:35], s[32:33]
  v_cmp_gt_i32 vcc, 0, v129
  s_and_b64 vcc, vcc, s[32:33]
  s_or_b64 s[68:69], s[68:69], vcc
  v_cndmask_b32 v129, v129, 0, s[34:35]
  v_cmp_gt_i32 vcc, 0, v133
  s_and_b64 vcc, vcc, s[32:33]
  s_or_b64 s[68:69], s[68:69], vcc
  v_cndmask_b32 v133, v133, 0, s[34:35]
  v_cmp_gt_i32 vcc, 0, v137
  s_and_b64 vcc, vcc, s[32:33]
  s_or_b64 s[68:69], s[68:69], vcc
  v_cndmask_b32 v137, v137, 0, s[34:35]
  v_cmp_gt_i32 vcc, 0, v141
  s_and_b64 vcc, vcc, s[32:33]
  s_or_b64 s[68:69], s[68:69], vcc
  v_cndmask_b32 v141, v141, 0, s[34:35]
  v_add_u32 v5, 1, v3
  v_cmp_le_u32 s[32:33], s3, v5
  v_cmp_gt_u32 s[34:35], s61, v5
  s_or_b64 s[34:35], s[34:35], s[32:33]
  v_cmp_gt_i32 vcc, 0, v131
  s_and_b64 vcc, vcc, s[32:33]
  s_or_b64 s[68:69], s[68:69], vcc
  v_cndmask_b32 v131, v131, 0, s[34:35]
  v_cmp_gt_i32 vcc, 0, v135
  s_and_b64 vcc, vcc, s[32:33]
  s_or_b64 s[68:69], s[68:69], vcc
  v_cndmask_b32 v135, v135, 0, s[34:35]
  v_cmp_gt_i32 vcc, 0, v139
  s_and_b64 vcc, vcc, s[32:33]
  s_or_b64 s[68:69], s[68:69], vcc
  v_cndmask_b32 v139, v139, 0, s[34:35]
  v_cmp_gt_i32 vcc, 0, v143
  s_and_b64 vcc, vcc, s[32:33]
  s_or_b64 s[68:69], s[68:69], vcc
  v_cndmask_b32 v143, v143, 0, s[34:35]
  s_waitcnt vmcnt(0)
FIRST2:
  s_cmp_eq_u64 s[68:69], 0
  s_cbranch_scc1 NOFLAG
  v_mov_b32 v5, 35328
  ds_write_b32 v5, v5
NOFLAG:
  v_cmp_gt_i32 s[32:33], 0, v129
  v_lshlrev_b32_sdwa v200, 2, v129 dst_sel:DWORD dst_unused:UNUSED_PAD src0_sel:DWORD src1_sel:BYTE_3
  v_cmp_gt_i32 s[34:35], 0, v131
  v_lshlrev_b32_sdwa v201, 2, v131 dst_sel:DWORD dst_unused:UNUSED_PAD src0_sel:DWORD src1_sel:BYTE_3
  v_cmp_gt_i32 s[36:37], 0, v133
  v_lshlrev_b32_sdwa v202, 2, v133 dst_sel:DWORD dst_unused:UNUSED_PAD src0_sel:DWORD src1_sel:BYTE_3
  v_cmp_gt_i32 s[38:39], 0, v135
  v_lshlrev_b32_sdwa v203, 2, v135 dst_sel:DWORD dst_unused:UNUSED_PAD src0_sel:DWORD src1_sel:BYTE_3
  v_cmp_gt_i32 s[40:41], 0, v137
  v_lshlrev_b32_sdwa v204, 2, v137 dst_sel:DWORD dst_unused:UNUSED_PAD src0_sel:DWORD src1_sel:BYTE_3
  v_cmp_gt_i32 s[42:43], 0, v139
  v_lshlrev_b32_sdwa v205, 2, v139 dst_sel:DWORD dst_unused:UNUSED_PAD src0_sel:DWORD src1_sel:BYTE_3
  v_cmp_gt_i32 s[44:45], 0, v141
  v_lshlrev_b32_sdwa v206, 2, v141 dst_sel:DWORD dst_unused:UNUSED_PAD src0_sel:DWORD src1_sel:BYTE_3
  v_cmp_gt_i32 s[46:47], 0, v143
  v_lshlrev_b32_sdwa v207, 2, v143 dst_sel:DWORD dst_unused:UNUSED_PAD src0_sel:DWORD src1_sel:BYTE_3
  s_mov_b64 exec, s[32:33]
  ds_add_rtn_u32 v176, v200, v9 offset:34304
  s_mov_b64 exec, s[34:35]
  ds_add_rtn_u32 v177, v201, v9 offset:34304
  s_mov_b64 exec, s[36:37]
  ds_add_rtn_u32 v178, v202, v9 offset:34304
  s_mov_b64 exec, s[38:39]
  ds_add_rtn_u32 v179, v203, v9 offset:34304
  s_mov_b64 exec, s[40:41]
  ds_add_rtn_u32 v180, v204, v9 offset:34304
  s_mov_b64 exec, s[42:43]
  ds_add_rtn_u32 v181, v205, v9 offset:34304
  s_mov_b64 exec, s[44:45]
  ds_add_rtn_u32 v182, v206, v9 offset:34304
  s_mov_b64 exec, s[46:47]
  ds_add_rtn_u32 v183, v207, v9 offset:34304
  s_mov_b64 exec, -1
  s_cmp_eq_u32 s63, 0
  s_cbranch_scc1 NOLATE2
  s_lshl_b32 m0, s57, 10
  s_add_u32 m0, m0, 114176
  s_nop 0
  buffer_load_dwordx4 v13, s[24:27], 0 offen lds
  v_add_u32 v13, 0x2000, v13
  s_lshl_b32 m0, s57, 10
  s_add_u32 m0, m0, 122368
  s_nop 0
  buffer_load_dwordx4 v13, s[24:27], 0 offen lds
NOLATE2:
  v_lshlrev_b32 v2, 2, v0
  v_lshrrev_b32 v8, 4, v0
  v_mul_u32_u24 v8, 544, v8
  v_and_b32 v3, 0x30, v0
  v_add_u32 v3, 35456, v3
  v_cmp_lt_i32 s[48:49], 0, v216
  v_cmp_lt_i32 s[50:51], 1, v216
  v_cmp_lt_i32 s[52:53], 0, v217
  v_cmp_lt_i32 s[96:97], 1, v217
  v_cmp_lt_i32 s[98:99], 0, v218
  v_cmp_lt_i32 s[100:101], 1, v218
  v_cmp_lt_i32 s[68:69], 0, v219
  s_waitcnt lgkmcnt(0)
  s_barrier
  ds_read2st64_b32 v[4:5], v2 offset0:136 offset1:137
  s_waitcnt lgkmcnt(0)
  v_mov_b32 v6, v4
  v_mov_b32 v7, v5
  s_nop 0
  v_add_u32_dpp v6, v6, v6 row_shr:1 row_mask:0xf bank_mask:0xf
  v_add_u32_dpp v7, v7, v7 row_shr:1 row_mask:0xf bank_mask:0xf
  s_nop 0
  v_add_u32_dpp v6, v6, v6 row_shr:2 row_mask:0xf bank_mask:0xf
  v_add_u32_dpp v7, v7, v7 row_shr:2 row_mask:0xf bank_mask:0xf
  s_nop 0
  v_add_u32_dpp v6, v6, v6 row_shr:4 row_mask:0xf bank_mask:0xf
  v_add_u32_dpp v7, v7, v7 row_shr:4 row_mask:0xf bank_mask:0xf
  s_nop 0
  v_add_u32_dpp v6, v6, v6 row_shr:8 row_mask:0xf bank_mask:0xf
  v_add_u32_dpp v7, v7, v7 row_shr:8 row_mask:0xf bank_mask:0xf
  v_sub_u32 v6, v6, v4
  v_sub_u32 v7, v7, v5
  v_add_u32 v4, v6, v8
  v_add3_u32 v5, v7, v8, s55
  ds_write2st64_b32 v2, v4, v5 offset0:140 offset1:141
  v_max_u32 v8, v6, v7
  v_cmp_lt_u32 vcc, 0x200, v8
  s_mov_b32 exec_lo, 0x80008000
  s_mov_b32 exec_hi, 0x80008000
  ds_write2_b32 v3, v4, v5 offset0:1 offset1:17
  s_mov_b64 exec, -1
  v_mov_b32 v8, 1
  v_mov_b32 v9, 0
  s_cbranch_vccz NOOVF1
  s_mov_b64 s[32:33], 0
  s_mov_b64 s[34:35], 0
  s_mov_b64 s[36:37], 0
  s_mov_b64 s[38:39], 0
  s_mov_b64 s[40:41], 0
  s_mov_b64 s[42:43], 0
  s_mov_b64 s[44:45], 0
  s_mov_b64 s[46:47], 0
NOOVF1:
  v_cmp_lt_i32 vcc, 1, v219
  s_waitcnt vmcnt(5)
  v_and_b32_sdwa v208, s95, v145 dst_sel:DWORD dst_unused:UNUSED_PAD src0_sel:DWORD src1_sel:BYTE_3
  v_and_b32_sdwa v209, s95, v147 dst_sel:DWORD dst_unused:UNUSED_PAD src0_sel:DWORD src1_sel:BYTE_3
  v_and_b32_sdwa v210, s95, v149 dst_sel:DWORD dst_unused:UNUSED_PAD src0_sel:DWORD src1_sel:BYTE_3
  v_and_b32_sdwa v211, s95, v151 dst_sel:DWORD dst_unused:UNUSED_PAD src0_sel:DWORD src1_sel:BYTE_3
  v_and_b32_sdwa v212, s95, v153 dst_sel:DWORD dst_unused:UNUSED_PAD src0_sel:DWORD src1_sel:BYTE_3
  v_and_b32_sdwa v213, s95, v155 dst_sel:DWORD dst_unused:UNUSED_PAD src0_sel:DWORD src1_sel:BYTE_3
  v_and_b32_sdwa v214, s95, v157 dst_sel:DWORD dst_unused:UNUSED_PAD src0_sel:DWORD src1_sel:BYTE_3
  v_and_b32_sdwa v215, s95, v159 dst_sel:DWORD dst_unused:UNUSED_PAD src0_sel:DWORD src1_sel:BYTE_3
  s_mov_b64 exec, s[48:49]
  ds_add_rtn_u64 v[184:185], v208, v[8:9] offset:35328
  s_mov_b64 exec, s[50:51]
  ds_add_rtn_u64 v[186:187], v209, v[8:9] offset:35328
  s_mov_b64 exec, s[52:53]
  ds_add_rtn_u64 v[188:189], v210, v[8:9] offset:35328
  s_mov_b64 exec, s[96:97]
  ds_add_rtn_u64 v[190:191], v211, v[8:9] offset:35328
  s_mov_b64 exec, s[98:99]
  ds_add_rtn_u64 v[192:193], v212, v[8:9] offset:35328
  s_mov_b64 exec, s[100:101]
  ds_add_rtn_u64 v[194:195], v213, v[8:9] offset:35328
  s_mov_b64 exec, s[68:69]
  ds_add_rtn_u64 v[196:197], v214, v[8:9] offset:35328
  s_mov_b64 exec, vcc
  ds_add_rtn_u64 v[198:199], v215, v[8:9] offset:35328
  s_mov_b64 exec, -1
  ds_read_b32 v200, v200 offset:35328
  ds_read_b32 v201, v201 offset:35328
  ds_read_b32 v202, v202 offset:35328
  ds_read_b32 v203, v203 offset:35328
  ds_read_b32 v204, v204 offset:35328
  ds_read_b32 v205, v205 offset:35328
  ds_read_b32 v206, v206 offset:35328
  ds_read_b32 v207, v207 offset:35328
  s_cmp_eq_u32 s63, 0
  s_cbranch_scc1 NOPERM
  v_mov_b32 v2, v6
  s_sub_u32 s3, 11, s57
  s_nop 0
  v_mov_b32_dpp v2, v7 row_shl:1 row_mask:0xf bank_mask:0xf
  s_cmp_lt_u32 s57, 4
  v_lshl_or_b32 v2, v2, 6, v0
  s_cselect_b32 s3, s57, s3
  s_mov_b32 s2, 7
  v_readlane_b32 s80, v2, 15
  v_readlane_b32 s82, v2, 31
  v_readlane_b32 s84, v2, 47
  v_readlane_b32 s86, v2, 63
  v_readlane_b32 s88, v2, 14
  v_readlane_b32 s90, v2, 30
  v_readlane_b32 s92, v2, 46
  s_mov_b32 exec_lo, 0xc000c000
  s_mov_b32 exec_hi, 0xc000c000
  v_cmp_lt_u32 s[80:81], s80, v2
  v_cmp_lt_u32 s[82:83], s82, v2
  v_cmp_lt_u32 s[84:85], s84, v2
  v_cmp_lt_u32 s[86:87], s86, v2
  v_cmp_lt_u32 s[88:89], s88, v2
  v_cmp_lt_u32 s[90:91], s90, v2
  v_cmp_lt_u32 s[92:93], s92, v2
  s_mov_b64 exec, -1
  s_bcnt1_i32_b64 s80, s[80:81]
  s_cmp_eq_u32 s80, s3
  s_cselect_b32 s2, 0, s2
  s_bcnt1_i32_b64 s82, s[82:83]
  s_cmp_eq_u32 s82, s3
  s_cselect_b32 s2, 1, s2
  s_bcnt1_i32_b64 s84, s[84:85]
  s_cmp_eq_u32 s84, s3
  s_cselect_b32 s2, 2, s2
  s_bcnt1_i32_b64 s86, s[86:87]
  s_cmp_eq_u32 s86, s3
  s_cselect_b32 s2, 3, s2
  s_bcnt1_i32_b64 s88, s[88:89]
  s_cmp_eq_u32 s88, s3
  s_cselect_b32 s2, 4, s2
  s_bcnt1_i32_b64 s90, s[90:91]
  s_cmp_eq_u32 s90, s3
  s_cselect_b32 s2, 5, s2
  s_bcnt1_i32_b64 s92, s[92:93]
  s_cmp_eq_u32 s92, s3
  s_cselect_b32 s2, 6, s2
  s_lshl_b32 s3, s56, 3
  s_add_u32 s3, s3, s2
  s_mul_i32 s3, s3, 3125
  s_add_u32 s58, s3, 127
  s_lshr_b32 s58, s58, 7
  s_add_u32 s3, s3, 3252
  s_lshr_b32 s3, s3, 7
  s_sub_u32 s3, s3, s58
  s_bfm_b32 s78, s3, 0
  s_lshl_b32 s3, s58, 7
  v_add_u32 v12, s58, v0
  v_add_u32 v56, s3, v56
  v_add_u32 v57, s3, v57
  v_add_u32 v58, s3, v58
  v_add_u32 v59, s3, v59
  v_mul_u32_u24 v11, 6, v12
  v_and_b32 v11, -4, v11
NOPERM:
  s_cmp_eq_u32 s63, 0
  s_cbranch_scc1 NOLATE4
  s_mul_i32 m0, s57, 4608
  s_add_u32 m0, m0, 44544
  s_nop 0
  buffer_load_dwordx4 v56, s[4:7], 0 offen lds
  s_mul_i32 m0, s57, 4608
  s_add_u32 m0, m0, 45568
  s_nop 0
  buffer_load_dwordx4 v57, s[4:7], 0 offen lds
NOLATE4:
  s_mul_i32 s3, s2, 2176
  v_lshrrev_b32 v2, 3, v0
  v_lshl_add_u32 v246, v2, 4, s3
  v_and_b32 v2, 31, v0
  v_lshl_add_u32 v247, v2, 2, s3
  v_bfe_u32 v2, v0, 2, 2
  v_lshl_add_u32 v2, v2, 4, s3
  v_lshl_add_u32 v248, v250, 2, v2
  v_lshrrev_b32 v2, 1, v0
  v_lshl_add_u32 v252, v2, 2, s3
  v_mov_b32 v2, 35328
  s_waitcnt lgkmcnt(8)
  v_add_lshl_u32 v208, v184, v185, 2
  v_min_u32 v208, s94, v208
  v_add_lshl_u32 v209, v186, v187, 2
  v_min_u32 v209, s94, v209
  v_add_lshl_u32 v210, v188, v189, 2
  v_min_u32 v210, s94, v210
  v_add_lshl_u32 v211, v190, v191, 2
  v_min_u32 v211, s94, v211
  v_add_lshl_u32 v212, v192, v193, 2
  v_min_u32 v212, s94, v212
  v_add_lshl_u32 v213, v194, v195, 2
  v_min_u32 v213, s94, v213
  v_add_lshl_u32 v214, v196, v197, 2
  v_min_u32 v214, s94, v214
  v_add_lshl_u32 v215, v198, v199, 2
  v_min_u32 v215, s94, v215
  s_waitcnt lgkmcnt(6)
  v_add_lshl_u32 v200, v200, v176, 2
  v_add_lshl_u32 v201, v201, v177, 2
  s_waitcnt lgkmcnt(4)
  v_add_lshl_u32 v202, v202, v178, 2
  v_add_lshl_u32 v203, v203, v179, 2
  s_waitcnt lgkmcnt(2)
  v_add_lshl_u32 v204, v204, v180, 2
  v_add_lshl_u32 v205, v205, v181, 2
  s_waitcnt lgkmcnt(0)
  v_add_lshl_u32 v206, v206, v182, 2
  v_add_lshl_u32 v207, v207, v183, 2
  s_mov_b64 exec, s[32:33]
  ds_write2st64_b32 v200, v128, v129 offset0:0 offset1:68
  s_mov_b64 exec, s[34:35]
  ds_write2st64_b32 v201, v130, v131 offset0:0 offset1:68
  s_mov_b64 exec, s[36:37]
  ds_write2st64_b32 v202, v132, v133 offset0:0 offset1:68
  s_mov_b64 exec, s[38:39]
  ds_write2st64_b32 v203, v134, v135 offset0:0 offset1:68
  s_mov_b64 exec, -1
  s_cmp_eq_u32 s63, 0
  s_cbranch_scc1 NOLATE5
  s_mul_i32 m0, s57, 4608
  s_add_u32 m0, m0, 46592
  s_nop 0
  buffer_load_dwordx4 v58, s[4:7], 0 offen lds
NOLATE5:
  s_mov_b64 exec, s[40:41]
  ds_write2st64_b32 v204, v136, v137 offset0:0 offset1:68
  s_mov_b64 exec, s[42:43]
  ds_write2st64_b32 v205, v138, v139 offset0:0 offset1:68
  s_mov_b64 exec, s[44:45]
  ds_write2st64_b32 v206, v140, v141 offset0:0 offset1:68
  s_mov_b64 exec, s[46:47]
  ds_write2st64_b32 v207, v142, v143 offset0:0 offset1:68
  s_mov_b64 exec, -1
  s_cmp_eq_u32 s63, 0
  s_cbranch_scc1 NOLATE6
  s_mul_i32 m0, s57, 4608
  s_add_u32 m0, m0, 47616
  s_nop 0
  buffer_load_dwordx4 v59, s[4:7], 0 offen lds
NOLATE6:
  s_mov_b64 exec, s[48:49]
  ds_write2st64_b32 v208, v144, v145 offset0:0 offset1:68
  s_mov_b64 exec, s[50:51]
  ds_write2st64_b32 v209, v146, v147 offset0:0 offset1:68
  s_mov_b64 exec, s[52:53]
  ds_write2st64_b32 v210, v148, v149 offset0:0 offset1:68
  s_mov_b64 exec, s[96:97]
  ds_write2st64_b32 v211, v150, v151 offset0:0 offset1:68
  s_mov_b64 exec, s[98:99]
  ds_write2st64_b32 v212, v152, v153 offset0:0 offset1:68
  s_mov_b64 exec, s[100:101]
  ds_write2st64_b32 v213, v154, v155 offset0:0 offset1:68
  s_mov_b64 exec, s[68:69]
  ds_write2st64_b32 v214, v156, v157 offset0:0 offset1:68
  s_mov_b64 exec, vcc
  ds_write2st64_b32 v215, v158, v159 offset0:0 offset1:68
  s_mov_b64 exec, -1
  s_cmp_eq_u64 s[76:77], 0
  s_cbranch_scc1 NOL2B
  s_waitcnt vmcnt(0) lgkmcnt(0)
  v_cmpx_lt_i32 vcc, 16, v216
  v_and_b32_sdwa v208, s95, v161 dst_sel:DWORD dst_unused:UNUSED_PAD src0_sel:DWORD src1_sel:BYTE_3
  ds_add_rtn_u64 v[184:185], v208, v[8:9] offset:35328
  v_cmpx_lt_i32 vcc, 17, v216
  v_and_b32_sdwa v209, s95, v163 dst_sel:DWORD dst_unused:UNUSED_PAD src0_sel:DWORD src1_sel:BYTE_3
  ds_add_rtn_u64 v[186:187], v209, v[8:9] offset:35328
  s_mov_b64 exec, -1
  v_cmpx_lt_i32 vcc, 16, v217
  v_and_b32_sdwa v210, s95, v165 dst_sel:DWORD dst_unused:UNUSED_PAD src0_sel:DWORD src1_sel:BYTE_3
  ds_add_rtn_u64 v[188:189], v210, v[8:9] offset:35328
  v_cmpx_lt_i32 vcc, 17, v217
  v_and_b32_sdwa v211, s95, v167 dst_sel:DWORD dst_unused:UNUSED_PAD src0_sel:DWORD src1_sel:BYTE_3
  ds_add_rtn_u64 v[190:191], v211, v[8:9] offset:35328
  s_mov_b64 exec, -1
  v_cmpx_lt_i32 vcc, 16, v218
  v_and_b32_sdwa v212, s95, v169 dst_sel:DWORD dst_unused:UNUSED_PAD src0_sel:DWORD src1_sel:BYTE_3
  ds_add_rtn_u64 v[192:193], v212, v[8:9] offset:35328
  v_cmpx_lt_i32 vcc, 17, v218
  v_and_b32_sdwa v213, s95, v171 dst_sel:DWORD dst_unused:UNUSED_PAD src0_sel:DWORD src1_sel:BYTE_3
  ds_add_rtn_u64 v[194:195], v213, v[8:9] offset:35328
  s_mov_b64 exec, -1
  v_cmpx_lt_i32 vcc, 16, v219
  v_and_b32_sdwa v214, s95, v173 dst_sel:DWORD dst_unused:UNUSED_PAD src0_sel:DWORD src1_sel:BYTE_3
  ds_add_rtn_u64 v[196:197], v214, v[8:9] offset:35328
  v_cmpx_lt_i32 vcc, 17, v219
  v_and_b32_sdwa v215, s95, v175 dst_sel:DWORD dst_unused:UNUSED_PAD src0_sel:DWORD src1_sel:BYTE_3
  ds_add_rtn_u64 v[198:199], v215, v[8:9] offset:35328
  s_mov_b64 exec, -1
  s_waitcnt lgkmcnt(0)
  v_cmpx_lt_i32 vcc, 16, v216
  v_add_lshl_u32 v208, v184, v185, 2
  v_min_u32 v208, s94, v208
  ds_write2st64_b32 v208, v160, v161 offset0:0 offset1:68
  v_cmpx_lt_i32 vcc, 17, v216
  v_add_lshl_u32 v209, v186, v187, 2
  v_min_u32 v209, s94, v209
  ds_write2st64_b32 v209, v162, v163 offset0:0 offset1:68
  s_mov_b64 exec, -1
  v_cmpx_lt_i32 vcc, 16, v217
  v_add_lshl_u32 v210, v188, v189, 2
  v_min_u32 v210, s94, v210
  ds_write2st64_b32 v210, v164, v165 offset0:0 offset1:68
  v_cmpx_lt_i32 vcc, 17, v217
  v_add_lshl_u32 v211, v190, v191, 2
  v_min_u32 v211, s94, v211
  ds_write2st64_b32 v211, v166, v167 offset0:0 offset1:68
  s_mov_b64 exec, -1
  v_cmpx_lt_i32 vcc, 16, v218
  v_add_lshl_u32 v212, v192, v193, 2
  v_min_u32 v212, s94, v212
  ds_write2st64_b32 v212, v168, v169 offset0:0 offset1:68
  v_cmpx_lt_i32 vcc, 17, v218
  v_add_lshl_u32 v213, v194, v195, 2
  v_min_u32 v213, s94, v213
  ds_write2st64_b32 v213, v170, v171 offset0:0 offset1:68
  s_mov_b64 exec, -1
  v_cmpx_lt_i32 vcc, 16, v219
  v_add_lshl_u32 v214, v196, v197, 2
  v_min_u32 v214, s94, v214
  ds_write2st64_b32 v214, v172, v173 offset0:0 offset1:68
  v_cmpx_lt_i32 vcc, 17, v219
  v_add_lshl_u32 v215, v198, v199, 2
  v_min_u32 v215, s94, v215
  ds_write2st64_b32 v215, v174, v175 offset0:0 offset1:68
  s_mov_b64 exec, -1
NOL2B:
  s_cmp_eq_u32 s63, 0
  s_cbranch_scc1 NOLATE7
  buffer_load_dwordx2 v[124:125], v11, s[12:15], 0 offen
NOLATE7:
  s_mov_b32 s63, 0
  v_mov_b32 v224, 0
  v_mov_b32 v225, 0
  v_mov_b32 v226, 0
  v_mov_b32 v227, 0
  s_and_b32 s62, s2, 3
  s_lshl_b32 s62, s62, 4
  s_add_u32 s62, s62, 15
  s_waitcnt vmcnt(5) lgkmcnt(0)
  s_barrier
  ds_read2_b32 v[4:5], v3 offset0:0 offset1:16
  ds_read_b32 v8, v2
  ds_read_b128 v[220:223], v246 offset:0
  ds_read_b32 v228, v247 offset:0
  ds_read_b32 v1, v252 offset:17408
  s_waitcnt lgkmcnt(3)
  v_add_u32 v6, v6, v4
  v_add_u32 v7, v7, v5
  v_max_u32 v4, v6, v7
  v_cmp_lt_u32 vcc, 0x200, v4
  v_readlane_b32 s68, v6, s62
  v_readlane_b32 s69, v7, s62
  v_readfirstlane_b32 s62, v8
  s_cbranch_vccz NOOVF
  s_lshr_b32 s60, s60, 1
  s_waitcnt vmcnt(0) lgkmcnt(0)
  s_barrier
  s_branch ROUND
NOOVF:
  s_cmp_ge_u32 s2, 4
  s_cselect_b32 s68, s69, s68
  s_add_u32 s59, s68, 31
  s_lshr_b32 s59, s59, 5
  v_add_u32 v2, s68, v0
  s_lshl_b32 s69, s59, 5
  v_lshl_add_u32 v3, v2, 2, s3
  s_sub_u32 s3, s58, s69
  v_add_u32 v4, s3, v2
  v_mov_b32 v5, 0xffff
  v_cmp_gt_u32 vcc, s69, v2
  s_nop 1
  v_cndmask_b32 v4, v4, v5, vcc
  v_or_b32 v4, 0xf8000000, v4
  v_mov_b32 v5, 0x00ffffff
  s_add_u32 s69, s69, 32
  v_cmpx_gt_u32 vcc, s69, v2
  ds_write2st64_b32 v3, v4, v5 offset0:0 offset1:68
  s_mov_b64 exec, -1
  s_cmp_ge_u32 s68, 32
  s_cbranch_scc1 FULL0
  ds_read_b128 v[220:223], v246 offset:0
  ds_read_b32 v228, v247 offset:0
  ds_read_b32 v1, v252 offset:17408
  s_waitcnt lgkmcnt(0)
FULL0:
  s_waitcnt lgkmcnt(1)
  s_cmp_gt_i32 s59, -1
  s_cselect_b32 s6, 6400000, 0
  s_cselect_b32 s10, 25600000, 0
  s_cselect_b32 s14, 300000, 0
  s_add_u32 m0, s67, 118784
  v_mad_u32_u24 v1, v1, 32, v253
  buffer_load_dwordx4 v1, s[8:11], 0 offen  lds
  s_add_u32 m0, s66, 0
  v_mad_u32_u24 v220, v220, s64, v233
  buffer_load_dwordx4 v220, s[4:7], 0 offen  lds
  s_add_u32 m0, s66, 1024
  v_mad_u32_u24 v221, v221, s64, v234
  buffer_load_dwordx4 v221, s[4:7], 0 offen  lds
  s_add_u32 m0, s66, 2048
  v_mad_u32_u24 v222, v222, s64, v235
  buffer_load_dwordx4 v222, s[4:7], 0 offen  lds
  s_add_u32 m0, s66, 3072
  v_mad_u32_u24 v223, v223, s64, v236
  buffer_load_dwordx4 v223, s[4:7], 0 offen  lds
  v_mul_u32_u24 v1, 6, v228
  v_and_b32 v1, -4, v1
  s_mov_b64 exec, s[74:75]
  buffer_load_dwordx2 v[224:225], v1, s[12:15], 0 offen
  s_mov_b64 exec, -1
  ds_read_b128 v[220:223], v246 offset:128
  ds_read_b32 v229, v247 offset:128
  ds_read_b32 v1, v252 offset:17536
  s_waitcnt lgkmcnt(0)
  s_cmp_eq_u32 s54, 0
  s_cbranch_scc1 NOINIT2
  v_lshlrev_b32 v2, 4, v0
  v_add_u32 v2, 130560, v2
  s_lshl_b32 s3, s57, 9
  s_sub_u32 s3, s3, 36864
  s_waitcnt vmcnt(6)
  v_add_u32 v6, s3, v237
  ds_read_b128 v[200:203], v6
  v_add_u32 v7, s3, v238
  ds_read_b128 v[204:207], v7
  v_add_u32 v8, s3, v239
  ds_read_b128 v[208:211], v8
  v_add_u32 v9, s3, v240
  ds_read_b128 v[212:215], v9
  ds_read_b128 v[128:131], v2 offset:0
  ds_read_b128 v[132:135], v2 offset:1024
  ds_read_b128 v[136:139], v2 offset:2048
  ds_read_b128 v[140:143], v2 offset:3072
  ds_read_b128 v[144:147], v2 offset:4096
  ds_read_b128 v[148:151], v2 offset:5120
  ds_read_b128 v[152:155], v2 offset:6144
  ds_read_b128 v[156:159], v2 offset:7168
  ds_read_b64 v[4:5], v2 offset:18432
  ds_read_b128 v[16:19], v2 offset:8192
  ds_read_b128 v[20:23], v2 offset:9216
  ds_read_b128 v[24:27], v2 offset:10240
  ds_read_b128 v[28:31], v2 offset:11264
  ds_read_b128 v[32:35], v2 offset:12288
  ds_read_b128 v[36:39], v2 offset:13312
  ds_read_b128 v[40:43], v2 offset:14336
  ds_read_b128 v[44:47], v2 offset:15360
  ds_read_b128 v[48:51], v2 offset:16384
  ds_read_b128 v[52:55], v2 offset:17408
  ds_read_b128 v[72:75], v2 offset:20480
  ds_read_b128 v[76:79], v2 offset:21504
  ds_read_b128 v[80:83], v2 offset:22528
  ds_read_b128 v[84:87], v2 offset:23552
  v_lshlrev_b32 v7, 4, v12
  v_alignbit_b32 v8, v125, v124, v7
  v_lshrrev_b32 v9, v7, v125
  v_lshlrev_b32 v6, 16, v8
  v_and_b32 v7, s65, v8
  v_lshlrev_b32 v8, 16, v9
  v_lshl_add_u32 v9, v0, 3, s67
  s_mov_b64 exec, s[74:75]
  ds_write_b64 v9, v[6:7] offset:512
  ds_write_b32 v9, v8 offset:768
  s_mov_b64 exec, -1
  s_waitcnt lgkmcnt(15)
  v_mfma_f32_32x32x16_bf16 v[160:175], v[200:203], v[128:131], 0
  v_mfma_f32_32x32x16_bf16 v[176:191], v[200:203], v[144:147], 0
  v_mfma_f32_32x32x16_bf16 v[160:175], v[204:207], v[132:135], v[160:175]
  v_mfma_f32_32x32x16_bf16 v[176:191], v[204:207], v[148:151], v[176:191]
  v_mfma_f32_32x32x16_bf16 v[160:175], v[208:211], v[136:139], v[160:175]
  v_mfma_f32_32x32x16_bf16 v[176:191], v[208:211], v[152:155], v[176:191]
  v_mfma_f32_32x32x16_bf16 v[160:175], v[212:215], v[140:143], v[160:175]
  v_mfma_f32_32x32x16_bf16 v[176:191], v[212:215], v[156:159], v[176:191]
  s_waitcnt lgkmcnt(0)
  s_mov_b32 s54, 0
  s_nop 7
  s_nop 0
  v_pk_mul_f32 v[160:161], v[160:161], s[70:71]
  v_cvt_pk_f16_f32 v56, v160, v161
  v_pk_mul_f32 v[162:163], v[162:163], s[70:71]
  v_cvt_pk_f16_f32 v57, v162, v163
  v_pk_mul_f32 v[164:165], v[164:165], s[70:71]
  v_cvt_pk_f16_f32 v58, v164, v165
  v_pk_mul_f32 v[166:167], v[166:167], s[70:71]
  v_cvt_pk_f16_f32 v59, v166, v167
  v_pk_mul_f32 v[168:169], v[168:169], s[70:71]
  v_cvt_pk_f16_f32 v60, v168, v169
  v_pk_mul_f32 v[170:171], v[170:171], s[70:71]
  v_cvt_pk_f16_f32 v61, v170, v171
  v_pk_mul_f32 v[172:173], v[172:173], s[70:71]
  v_cvt_pk_f16_f32 v62, v172, v173
  v_pk_mul_f32 v[176:177], v[176:177], s[70:71]
  v_cvt_pk_f16_f32 v64, v176, v177
  v_pk_mul_f32 v[178:179], v[178:179], s[70:71]
  v_cvt_pk_f16_f32 v65, v178, v179
  v_pk_mul_f32 v[180:181], v[180:181], s[70:71]
  v_cvt_pk_f16_f32 v66, v180, v181
  v_pk_mul_f32 v[182:183], v[182:183], s[70:71]
  v_cvt_pk_f16_f32 v67, v182, v183
  v_pk_mul_f32 v[184:185], v[184:185], s[70:71]
  v_cvt_pk_f16_f32 v68, v184, v185
  v_pk_mul_f32 v[186:187], v[186:187], s[70:71]
  v_cvt_pk_f16_f32 v69, v186, v187
  v_pk_mul_f32 v[188:189], v[188:189], s[70:71]
  v_cvt_pk_f16_f32 v70, v188, v189
  v_mov_b32 v63, v4
  v_mov_b32 v71, v5
NOINIT2:
  v_mov_b32 v184, 0
  v_mov_b32 v168, 0
  v_mov_b32 v185, 0
  v_mov_b32 v169, 0
  v_mov_b32 v186, 0
  v_mov_b32 v170, 0
  v_mov_b32 v187, 0
  v_mov_b32 v171, 0
  v_mov_b32 v188, 0
  v_mov_b32 v172, 0
  v_mov_b32 v189, 0
  v_mov_b32 v173, 0
  v_mov_b32 v190, 0
  v_mov_b32 v174, 0
  v_mov_b32 v191, 0
  v_mov_b32 v175, 0
  v_mov_b32 v124, 0
  v_mov_b32 v125, 0
  v_mov_b32 v126, 0
  v_mov_b32 v127, 0
  v_mov_b32 v13, 0
  v_mov_b32 v14, 0
  v_mov_b32 v15, 0
  s_mul_i32 s3, s57, 4608
  s_add_u32 s3, s3, 44544
  v_lshl_add_u32 v2, v0, 3, s3
  ds_write_b64 v2, v[184:185] offset:0
  ds_write_b64 v2, v[184:185] offset:512
  ds_write_b64 v2, v[184:185] offset:1024
  ds_write_b64 v2, v[184:185] offset:1536
  ds_write_b64 v2, v[184:185] offset:2048
  ds_write_b64 v2, v[184:185] offset:2560
  ds_write_b64 v2, v[184:185] offset:3072
  ds_write_b64 v2, v[184:185] offset:3584
  ds_write_b64 v2, v[184:185] offset:4096
  s_waitcnt vmcnt(0)
  ds_read_b128 v[216:219], v254
  ds_read_b128 v[200:203], v237
  ds_read_b128 v[204:207], v238
  ds_read_b128 v[208:211], v239
  ds_read_b128 v[212:215], v240
  v_add_u32_sdwa v249, v241, v228 dst_sel:DWORD dst_unused:UNUSED_PAD src0_sel:DWORD src1_sel:BYTE_3
  ds_read_b64 v[230:231], v249 offset:480
  ds_read_b32 v232, v249 offset:736
  v_lshlrev_b32 v125, 4, v228
  v_alignbit_b32 v126, v225, v224, v125
  v_lshrrev_b32 v127, v125, v225
  ds_read_b64 v[176:177], v249 offset:192
  ds_read_b64 v[178:179], v249 offset:128
  ds_read_b64 v[180:181], v249 offset:64
  ds_read_b32 v182, v249
  s_waitcnt lgkmcnt(10)
  v_mfma_f32_32x32x16_bf16 v[128:143], v[48:51], v[216:219], 0
  v_mfma_f32_32x32x16_bf16 v[144:159], v[52:55], v[216:219], 0
  v_lshlrev_b32 v125, 16, v126
  v_and_b32 v126, s65, v126
  v_lshlrev_b32 v127, 16, v127
  s_waitcnt lgkmcnt(5)
  v_sub_f32 v230, v230, v125
  v_sub_f32 v231, v231, v126
  s_waitcnt lgkmcnt(4)
  v_sub_f32 v232, v232, v127
  v_cvt_pk_bf16_f32 v230, v230, v231
  v_cvt_pk_bf16_f32 v232, v232, v232
  v_lshlrev_b32 v10, 16, v230
  v_and_b32 v11, s65, v230
  v_lshlrev_b32 v12, 16, v232
  v_mul_f32 v230, v10, v10
  v_fmac_f32 v230, v11, v11
  v_fmac_f32 v230, v12, v12
  v_cvt_pk_f16_f32 v183, v230, v230
  v_mfma_f32_32x32x16_bf16 v[128:143], v[16:19], v[200:203], v[128:143]
  v_mfma_f32_32x32x16_bf16 v[128:143], v[20:23], v[204:207], v[128:143]
  v_mfma_f32_32x32x16_bf16 v[128:143], v[24:27], v[208:211], v[128:143]
  v_mfma_f32_32x32x16_bf16 v[128:143], v[28:31], v[212:215], v[128:143]
  s_waitcnt lgkmcnt(2)
  v_mfma_f32_32x32x16_f16 v[128:143], v[56:59], v[176:179], v[128:143]
  s_waitcnt lgkmcnt(0)
  v_mfma_f32_32x32x16_f16 v[128:143], v[60:63], v[180:183], v[128:143]
  s_cmp_gt_i32 s59, 0
  s_cselect_b32 s6, 6400000, 0
  s_cselect_b32 s10, 25600000, 0
  s_cselect_b32 s14, 300000, 0
  s_add_u32 m0, s67, 118784
  v_mad_u32_u24 v1, v1, 32, v253
  buffer_load_dwordx4 v1, s[8:11], 0 offen  lds
  s_add_u32 m0, s66, 0
  v_mad_u32_u24 v220, v220, s64, v233
  buffer_load_dwordx4 v220, s[4:7], 0 offen  lds
  s_add_u32 m0, s66, 1024
  v_mad_u32_u24 v221, v221, s64, v234
  buffer_load_dwordx4 v221, s[4:7], 0 offen  lds
  s_add_u32 m0, s66, 2048
  v_mad_u32_u24 v222, v222, s64, v235
  buffer_load_dwordx4 v222, s[4:7], 0 offen  lds
  s_add_u32 m0, s66, 3072
  v_mad_u32_u24 v223, v223, s64, v236
  buffer_load_dwordx4 v223, s[4:7], 0 offen  lds
  v_mul_u32_u24 v1, 6, v229
  v_and_b32 v1, -4, v1
  s_mov_b64 exec, s[74:75]
  buffer_load_dwordx2 v[226:227], v1, s[12:15], 0 offen
  s_mov_b64 exec, -1
  s_waitcnt lgkmcnt(0)
  s_cmp_eq_u32 s59, 0
  s_cbranch_scc1 LOOPEND
  s_cmp_ge_u32 s57, 4
  s_movk_i32 s79, 0
  s_cmovk_i32 s79, 0
LOOP:
  ds_read_b64_tr_b16 v[192:193], v244 offset:64
  ds_read_b64_tr_b16 v[194:195], v244 offset:208
  ds_read_b64_tr_b16 v[196:197], v244 offset:352
  ds_read_b64_tr_b16 v[198:199], v244 offset:496
  v_cvt_pk_f16_f32 v160, v128, v129
  v_cvt_pk_f16_f32 v161, v130, v131
  v_cvt_pk_f16_f32 v162, v132, v133
  v_cvt_pk_f16_f32 v163, v134, v135
  v_cvt_pk_f16_f32 v164, v136, v137
  v_cvt_pk_f16_f32 v165, v138, v139
  v_cvt_pk_f16_f32 v166, v140, v141
  v_cvt_pk_f16_f32 v167, v142, v143
  v_mfma_f32_16x16x32_f16 v[124:127], v[80:83], v[168:171], v[124:127]
  v_exp_f16_sdwa v2, v160 dst_sel:WORD_0 dst_unused:UNUSED_PAD src0_sel:WORD_0
  s_mov_b64 exec, 1
  ds_add_rtn_u32 v251, v0, v234 offset:35336
  s_mov_b64 exec, -1
  v_exp_f16_sdwa v3, v161 dst_sel:WORD_0 dst_unused:UNUSED_PAD src0_sel:WORD_0
  v_mfma_f32_16x16x32_f16 v[124:127], v[84:87], v[172:175], v[124:127]
  v_exp_f16_sdwa v4, v162 dst_sel:WORD_0 dst_unused:UNUSED_PAD src0_sel:WORD_0
  v_exp_f16_sdwa v5, v163 dst_sel:WORD_0 dst_unused:UNUSED_PAD src0_sel:WORD_0
  v_mfma_f32_32x32x16_bf16 v[144:159], v[32:35], v[200:203], v[144:159]
  v_exp_f16_sdwa v2, v160 dst_sel:WORD_1 dst_unused:UNUSED_PRESERVE src0_sel:WORD_1
  v_exp_f16_sdwa v3, v161 dst_sel:WORD_1 dst_unused:UNUSED_PRESERVE src0_sel:WORD_1
  v_exp_f16_sdwa v4, v162 dst_sel:WORD_1 dst_unused:UNUSED_PRESERVE src0_sel:WORD_1
  s_waitcnt lgkmcnt(3)
  v_mfma_f32_32x32x16_f16 v[104:119], v[192:195], v[184:187], v[104:119]
  v_exp_f16_sdwa v5, v163 dst_sel:WORD_1 dst_unused:UNUSED_PRESERVE src0_sel:WORD_1
  v_pk_add_f16 v2, v2, 1.0 op_sel_hi:[1,0]
  v_pk_add_f16 v3, v3, 1.0 op_sel_hi:[1,0]
  v_pk_add_f16 v4, v4, 1.0 op_sel_hi:[1,0]
  v_pk_add_f16 v5, v5, 1.0 op_sel_hi:[1,0]
  v_mul_f32 v230, v13, v124
  v_mul_f32 v231, v14, v124
  v_mul_f32 v232, v15, v124
  v_cvt_pk_f16_f32 v230, v230, v231
  v_cvt_pk_f16_f32 v231, v232, v232
  s_mov_b64 exec, s[74:75]
  ds_write_b64 v242, v[230:231] offset:128
  s_mov_b64 exec, -1
  v_rcp_f16_sdwa v6, v2 dst_sel:WORD_0 dst_unused:UNUSED_PAD src0_sel:WORD_0
  v_rcp_f16_sdwa v7, v3 dst_sel:WORD_0 dst_unused:UNUSED_PAD src0_sel:WORD_0
  s_waitcnt lgkmcnt(2)
  v_mfma_f32_32x32x16_f16 v[104:119], v[196:199], v[188:191], v[104:119]
  ds_read_b64_tr_b16 v[192:193], v245 offset:0
  ds_read_b64_tr_b16 v[194:195], v245 offset:144
  ds_read_b64_tr_b16 v[196:197], v245 offset:288
  ds_read_b64_tr_b16 v[198:199], v245 offset:432
  v_rcp_f16_sdwa v8, v4 dst_sel:WORD_0 dst_unused:UNUSED_PAD src0_sel:WORD_0
  s_waitcnt lgkmcnt(5)
  v_readfirstlane_b32 s68, v251
  s_setprio 1
  s_cmp_lt_i32 s68, s79
  s_cbranch_scc0 PRI0
  s_setprio 0
PRI0:
  s_add_u32 s79, s79, 128
  v_rcp_f16_sdwa v9, v5 dst_sel:WORD_0 dst_unused:UNUSED_PAD src0_sel:WORD_0
  v_rcp_f16_sdwa v6, v2 dst_sel:WORD_1 dst_unused:UNUSED_PRESERVE src0_sel:WORD_1
  v_mfma_f32_32x32x16_bf16 v[144:159], v[36:39], v[204:207], v[144:159]
  v_rcp_f16_sdwa v7, v3 dst_sel:WORD_1 dst_unused:UNUSED_PRESERVE src0_sel:WORD_1
  v_rcp_f16_sdwa v8, v4 dst_sel:WORD_1 dst_unused:UNUSED_PRESERVE src0_sel:WORD_1
  v_rcp_f16_sdwa v9, v5 dst_sel:WORD_1 dst_unused:UNUSED_PRESERVE src0_sel:WORD_1
  v_pk_mul_f16 v160, v160, v6
  v_pk_mul_f16 v161, v161, v7
  v_pk_mul_f16 v162, v162, v8
  v_pk_mul_f16 v163, v163, v9
  ds_write_b128 v242, v[160:163] offset:0
  v_mfma_f32_32x32x16_bf16 v[144:159], v[40:43], v[208:211], v[144:159]
  v_exp_f16_sdwa v2, v164 dst_sel:WORD_0 dst_unused:UNUSED_PAD src0_sel:WORD_0
  v_exp_f16_sdwa v3, v165 dst_sel:WORD_0 dst_unused:UNUSED_PAD src0_sel:WORD_0
  v_exp_f16_sdwa v4, v166 dst_sel:WORD_0 dst_unused:UNUSED_PAD src0_sel:WORD_0
  v_mfma_f32_32x32x16_bf16 v[144:159], v[44:47], v[212:215], v[144:159]
  v_exp_f16_sdwa v5, v167 dst_sel:WORD_0 dst_unused:UNUSED_PAD src0_sel:WORD_0
  v_exp_f16_sdwa v2, v164 dst_sel:WORD_1 dst_unused:UNUSED_PRESERVE src0_sel:WORD_1
  v_exp_f16_sdwa v3, v165 dst_sel:WORD_1 dst_unused:UNUSED_PRESERVE src0_sel:WORD_1
  v_mfma_f32_32x32x16_f16 v[144:159], v[64:67], v[176:179], v[144:159]
  v_exp_f16_sdwa v4, v166 dst_sel:WORD_1 dst_unused:UNUSED_PRESERVE src0_sel:WORD_1
  v_exp_f16_sdwa v5, v167 dst_sel:WORD_1 dst_unused:UNUSED_PRESERVE src0_sel:WORD_1
  v_pk_add_f16 v2, v2, 1.0 op_sel_hi:[1,0]
  v_pk_add_f16 v3, v3, 1.0 op_sel_hi:[1,0]
  v_pk_add_f16 v4, v4, 1.0 op_sel_hi:[1,0]
  v_pk_add_f16 v5, v5, 1.0 op_sel_hi:[1,0]
  v_rcp_f16_sdwa v6, v2 dst_sel:WORD_0 dst_unused:UNUSED_PAD src0_sel:WORD_0
  v_mfma_f32_32x32x16_f16 v[144:159], v[68:71], v[180:183], v[144:159]
  v_rcp_f16_sdwa v7, v3 dst_sel:WORD_0 dst_unused:UNUSED_PAD src0_sel:WORD_0
  s_waitcnt vmcnt(0)
  ds_read_b128 v[216:219], v254
  ds_read_b128 v[200:203], v237
  ds_read_b128 v[204:207], v238
  v_rcp_f16_sdwa v8, v4 dst_sel:WORD_0 dst_unused:UNUSED_PAD src0_sel:WORD_0
  v_rcp_f16_sdwa v9, v5 dst_sel:WORD_0 dst_unused:UNUSED_PAD src0_sel:WORD_0
  s_waitcnt lgkmcnt(6)
  v_mfma_f32_16x16x32_f16 v[120:123], v[192:195], v[184:187], v[120:123]
  ds_read_b128 v[208:211], v239
  ds_read_b128 v[212:215], v240
  v_rcp_f16_sdwa v6, v2 dst_sel:WORD_1 dst_unused:UNUSED_PRESERVE src0_sel:WORD_1
  v_add_u32_sdwa v249, v241, v229 dst_sel:DWORD dst_unused:UNUSED_PAD src0_sel:DWORD src1_sel:BYTE_3
  ds_read_b64 v[230:231], v249 offset:480
  ds_read_b32 v232, v249 offset:736
  v_lshlrev_b32 v125, 4, v229
  v_alignbit_b32 v126, v227, v226, v125
  v_lshrrev_b32 v127, v125, v227
  v_rcp_f16_sdwa v7, v3 dst_sel:WORD_1 dst_unused:UNUSED_PRESERVE src0_sel:WORD_1
  s_waitcnt lgkmcnt(8)
  v_mfma_f32_16x16x32_f16 v[120:123], v[196:199], v[188:191], v[120:123]
  ds_read_b64 v[176:177], v249 offset:192
  ds_read_b64 v[178:179], v249 offset:128
  ds_read_b64 v[180:181], v249 offset:64
  ds_read_b32 v182, v249
  ds_read_b128 v[184:187], v248 offset:0
  v_rcp_f16_sdwa v8, v4 dst_sel:WORD_1 dst_unused:UNUSED_PRESERVE src0_sel:WORD_1
  ds_read_b128 v[220:223], v246 offset:256
  ds_read_b32 v228, v247 offset:256
  ds_read_b32 v1, v252 offset:17664
  v_rcp_f16_sdwa v9, v5 dst_sel:WORD_1 dst_unused:UNUSED_PRESERVE src0_sel:WORD_1
  v_pk_mul_f16 v164, v164, v6
  v_pk_mul_f16 v165, v165, v7
  v_pk_mul_f16 v166, v166, v8
  v_pk_mul_f16 v167, v167, v9
  ds_write_b128 v242, v[164:167] offset:16
  v_cvt_pk_f16_f32 v168, v144, v145
  v_cvt_pk_f16_f32 v169, v146, v147
  v_cvt_pk_f16_f32 v170, v148, v149
  v_cvt_pk_f16_f32 v171, v150, v151
  v_cvt_pk_f16_f32 v172, v152, v153
  v_cvt_pk_f16_f32 v173, v154, v155
  v_cvt_pk_f16_f32 v174, v156, v157
  v_cvt_pk_f16_f32 v175, v158, v159
  s_waitcnt lgkmcnt(15)
  v_mfma_f32_32x32x16_bf16 v[128:143], v[48:51], v[216:219], 0
  ds_read_b64_tr_b16 v[192:193], v244 offset:0
  ds_read_b64_tr_b16 v[194:195], v244 offset:144
  ds_read_b64_tr_b16 v[196:197], v244 offset:288
  ds_read_b64_tr_b16 v[198:199], v244 offset:432
  v_exp_f16_sdwa v2, v168 dst_sel:WORD_0 dst_unused:UNUSED_PAD src0_sel:WORD_0
  v_exp_f16_sdwa v3, v169 dst_sel:WORD_0 dst_unused:UNUSED_PAD src0_sel:WORD_0
  v_exp_f16_sdwa v4, v170 dst_sel:WORD_0 dst_unused:UNUSED_PAD src0_sel:WORD_0
  v_mfma_f32_32x32x16_bf16 v[144:159], v[52:55], v[216:219], 0
  v_lshlrev_b32 v125, 16, v126
  v_and_b32 v126, s65, v126
  v_lshlrev_b32 v127, 16, v127
  v_exp_f16_sdwa v5, v171 dst_sel:WORD_0 dst_unused:UNUSED_PAD src0_sel:WORD_0
  v_exp_f16_sdwa v2, v168 dst_sel:WORD_1 dst_unused:UNUSED_PRESERVE src0_sel:WORD_1
  s_waitcnt lgkmcnt(15)
  v_mfma_f32_32x32x16_bf16 v[128:143], v[16:19], v[200:203], v[128:143]
  v_exp_f16_sdwa v3, v169 dst_sel:WORD_1 dst_unused:UNUSED_PRESERVE src0_sel:WORD_1
  v_exp_f16_sdwa v4, v170 dst_sel:WORD_1 dst_unused:UNUSED_PRESERVE src0_sel:WORD_1
  s_waitcnt lgkmcnt(8)
  v_add_u32_sdwa v184, v243, v184 dst_sel:DWORD dst_unused:UNUSED_PAD src0_sel:DWORD src1_sel:BYTE_3
  v_add_u32_sdwa v185, v243, v185 dst_sel:DWORD dst_unused:UNUSED_PAD src0_sel:DWORD src1_sel:BYTE_3
  v_add_u32_sdwa v186, v243, v186 dst_sel:DWORD dst_unused:UNUSED_PAD src0_sel:DWORD src1_sel:BYTE_3
  v_add_u32_sdwa v187, v243, v187 dst_sel:DWORD dst_unused:UNUSED_PAD src0_sel:DWORD src1_sel:BYTE_3
  ds_read_b64_tr_b16 v[190:191], v187
  ds_read_b64_tr_b16 v[188:189], v186
  ds_read_b64_tr_b16 v[186:187], v185
  ds_read_b64_tr_b16 v[184:185], v184
  s_cmp_gt_i32 s59, 1
  s_cselect_b32 s6, 6400000, 0
  s_cselect_b32 s10, 25600000, 0
  s_cselect_b32 s14, 300000, 0
  s_add_u32 m0, s67, 118784
  s_waitcnt lgkmcnt(9)
  v_mad_u32_u24 v1, v1, 32, v253
  buffer_load_dwordx4 v1, s[8:11], 0 offen  lds
  v_exp_f16_sdwa v5, v171 dst_sel:WORD_1 dst_unused:UNUSED_PRESERVE src0_sel:WORD_1
  v_pk_add_f16 v2, v2, 1.0 op_sel_hi:[1,0]
  v_pk_add_f16 v3, v3, 1.0 op_sel_hi:[1,0]
  v_pk_add_f16 v4, v4, 1.0 op_sel_hi:[1,0]
  v_pk_add_f16 v5, v5, 1.0 op_sel_hi:[1,0]
  v_mfma_f32_32x32x16_bf16 v[128:143], v[20:23], v[204:207], v[128:143]
  v_sub_f32 v230, v230, v125
  v_sub_f32 v231, v231, v126
  v_sub_f32 v232, v232, v127
  v_cvt_pk_bf16_f32 v230, v230, v231
  v_cvt_pk_bf16_f32 v232, v232, v232
  v_lshlrev_b32 v13, 16, v230
  v_and_b32 v14, s65, v230
  v_lshlrev_b32 v15, 16, v232
  v_rcp_f16_sdwa v6, v2 dst_sel:WORD_0 dst_unused:UNUSED_PAD src0_sel:WORD_0
  v_rcp_f16_sdwa v7, v3 dst_sel:WORD_0 dst_unused:UNUSED_PAD src0_sel:WORD_0
  v_rcp_f16_sdwa v8, v4 dst_sel:WORD_0 dst_unused:UNUSED_PAD src0_sel:WORD_0
  v_mfma_f32_32x32x16_bf16 v[128:143], v[24:27], v[208:211], v[128:143]
  s_add_u32 m0, s66, 0
  v_mad_u32_u24 v220, v220, s64, v233
  buffer_load_dwordx4 v220, s[4:7], 0 offen  lds
  v_rcp_f16_sdwa v9, v5 dst_sel:WORD_0 dst_unused:UNUSED_PAD src0_sel:WORD_0
  v_rcp_f16_sdwa v6, v2 dst_sel:WORD_1 dst_unused:UNUSED_PRESERVE src0_sel:WORD_1
  v_mfma_f32_32x32x16_bf16 v[128:143], v[28:31], v[212:215], v[128:143]
  s_add_u32 m0, s66, 1024
  v_mad_u32_u24 v221, v221, s64, v234
  buffer_load_dwordx4 v221, s[4:7], 0 offen  lds
  v_rcp_f16_sdwa v7, v3 dst_sel:WORD_1 dst_unused:UNUSED_PRESERVE src0_sel:WORD_1
  v_rcp_f16_sdwa v8, v4 dst_sel:WORD_1 dst_unused:UNUSED_PRESERVE src0_sel:WORD_1
  v_mul_f32 v230, v13, v13
  v_fmac_f32 v230, v14, v14
  v_fmac_f32 v230, v15, v15
  v_cvt_pk_f16_f32 v183, v230, v230
  v_rcp_f16_sdwa v9, v5 dst_sel:WORD_1 dst_unused:UNUSED_PRESERVE src0_sel:WORD_1
  v_pk_mul_f16 v168, v168, v6
  v_pk_mul_f16 v169, v169, v7
  v_pk_mul_f16 v170, v170, v8
  v_pk_mul_f16 v171, v171, v9
  ds_write_b128 v242, v[168:171] offset:64
  v_mfma_f32_16x16x32_f16 v[124:127], v[72:75], v[160:163], 0
  s_add_u32 m0, s66, 2048
  v_mad_u32_u24 v222, v222, s64, v235
  buffer_load_dwordx4 v222, s[4:7], 0 offen  lds
  v_exp_f16_sdwa v2, v172 dst_sel:WORD_0 dst_unused:UNUSED_PAD src0_sel:WORD_0
  v_exp_f16_sdwa v3, v173 dst_sel:WORD_0 dst_unused:UNUSED_PAD src0_sel:WORD_0
  v_mfma_f32_16x16x32_f16 v[124:127], v[76:79], v[164:167], v[124:127]
  s_add_u32 m0, s66, 3072
  v_mad_u32_u24 v223, v223, s64, v236
  buffer_load_dwordx4 v223, s[4:7], 0 offen  lds
  v_exp_f16_sdwa v4, v174 dst_sel:WORD_0 dst_unused:UNUSED_PAD src0_sel:WORD_0
  v_exp_f16_sdwa v5, v175 dst_sel:WORD_0 dst_unused:UNUSED_PAD src0_sel:WORD_0
  v_mfma_f32_32x32x16_f16 v[128:143], v[56:59], v[176:179], v[128:143]
  v_exp_f16_sdwa v2, v172 dst_sel:WORD_1 dst_unused:UNUSED_PRESERVE src0_sel:WORD_1
  v_exp_f16_sdwa v3, v173 dst_sel:WORD_1 dst_unused:UNUSED_PRESERVE src0_sel:WORD_1
  v_exp_f16_sdwa v4, v174 dst_sel:WORD_1 dst_unused:UNUSED_PRESERVE src0_sel:WORD_1
  v_mfma_f32_32x32x16_f16 v[128:143], v[60:63], v[180:183], v[128:143]
  v_mul_u32_u24 v1, 6, v228
  v_and_b32 v1, -4, v1
  s_mov_b64 exec, s[74:75]
  buffer_load_dwordx2 v[224:225], v1, s[12:15], 0 offen
  s_mov_b64 exec, -1
  v_exp_f16_sdwa v5, v175 dst_sel:WORD_1 dst_unused:UNUSED_PRESERVE src0_sel:WORD_1
  v_pk_add_f16 v2, v2, 1.0 op_sel_hi:[1,0]
  v_pk_add_f16 v3, v3, 1.0 op_sel_hi:[1,0]
  v_pk_add_f16 v4, v4, 1.0 op_sel_hi:[1,0]
  v_pk_add_f16 v5, v5, 1.0 op_sel_hi:[1,0]
  v_rcp_f16_sdwa v6, v2 dst_sel:WORD_0 dst_unused:UNUSED_PAD src0_sel:WORD_0
  v_rcp_f16_sdwa v7, v3 dst_sel:WORD_0 dst_unused:UNUSED_PAD src0_sel:WORD_0
  s_waitcnt lgkmcnt(1)
  v_mfma_f32_32x32x16_f16 v[88:103], v[192:195], v[184:187], v[88:103]
  v_rcp_f16_sdwa v8, v4 dst_sel:WORD_0 dst_unused:UNUSED_PAD src0_sel:WORD_0
  v_rcp_f16_sdwa v9, v5 dst_sel:WORD_0 dst_unused:UNUSED_PAD src0_sel:WORD_0
  v_rcp_f16_sdwa v6, v2 dst_sel:WORD_1 dst_unused:UNUSED_PRESERVE src0_sel:WORD_1
  v_mfma_f32_32x32x16_f16 v[88:103], v[196:199], v[188:191], v[88:103]
  v_rcp_f16_sdwa v7, v3 dst_sel:WORD_1 dst_unused:UNUSED_PRESERVE src0_sel:WORD_1
  v_rcp_f16_sdwa v8, v4 dst_sel:WORD_1 dst_unused:UNUSED_PRESERVE src0_sel:WORD_1
  v_rcp_f16_sdwa v9, v5 dst_sel:WORD_1 dst_unused:UNUSED_PRESERVE src0_sel:WORD_1
  v_pk_mul_f16 v172, v172, v6
  v_pk_mul_f16 v173, v173, v7
  v_pk_mul_f16 v174, v174, v8
  v_pk_mul_f16 v175, v175, v9
  ds_write_b128 v242, v[172:175] offset:80
  s_sub_u32 s59, s59, 1
  s_cmp_eq_u32 s59, 0
  s_cbranch_scc1 TAIL0
  ds_read_b64_tr_b16 v[192:193], v244 offset:64
  ds_read_b64_tr_b16 v[194:195], v244 offset:208
  ds_read_b64_tr_b16 v[196:197], v244 offset:352
  ds_read_b64_tr_b16 v[198:199], v244 offset:496
  v_cvt_pk_f16_f32 v160, v128, v129
  v_cvt_pk_f16_f32 v161, v130, v131
  v_cvt_pk_f16_f32 v162, v132, v133
  v_cvt_pk_f16_f32 v163, v134, v135
  v_cvt_pk_f16_f32 v164, v136, v137
  v_cvt_pk_f16_f32 v165, v138, v139
  v_cvt_pk_f16_f32 v166, v140, v141
  v_cvt_pk_f16_f32 v167, v142, v143
  v_mfma_f32_16x16x32_f16 v[124:127], v[80:83], v[168:171], v[124:127]
  v_exp_f16_sdwa v2, v160 dst_sel:WORD_0 dst_unused:UNUSED_PAD src0_sel:WORD_0
  s_mov_b64 exec, 1
  ds_add_rtn_u32 v251, v0, v234 offset:35336
  s_mov_b64 exec, -1
  v_exp_f16_sdwa v3, v161 dst_sel:WORD_0 dst_unused:UNUSED_PAD src0_sel:WORD_0
  v_mfma_f32_16x16x32_f16 v[124:127], v[84:87], v[172:175], v[124:127]
  v_exp_f16_sdwa v4, v162 dst_sel:WORD_0 dst_unused:UNUSED_PAD src0_sel:WORD_0
  v_exp_f16_sdwa v5, v163 dst_sel:WORD_0 dst_unused:UNUSED_PAD src0_sel:WORD_0
  v_mfma_f32_32x32x16_bf16 v[144:159], v[32:35], v[200:203], v[144:159]
  v_exp_f16_sdwa v2, v160 dst_sel:WORD_1 dst_unused:UNUSED_PRESERVE src0_sel:WORD_1
  v_exp_f16_sdwa v3, v161 dst_sel:WORD_1 dst_unused:UNUSED_PRESERVE src0_sel:WORD_1
  v_exp_f16_sdwa v4, v162 dst_sel:WORD_1 dst_unused:UNUSED_PRESERVE src0_sel:WORD_1
  s_waitcnt lgkmcnt(3)
  v_mfma_f32_32x32x16_f16 v[104:119], v[192:195], v[184:187], v[104:119]
  v_exp_f16_sdwa v5, v163 dst_sel:WORD_1 dst_unused:UNUSED_PRESERVE src0_sel:WORD_1
  v_pk_add_f16 v2, v2, 1.0 op_sel_hi:[1,0]
  v_pk_add_f16 v3, v3, 1.0 op_sel_hi:[1,0]
  v_pk_add_f16 v4, v4, 1.0 op_sel_hi:[1,0]
  v_pk_add_f16 v5, v5, 1.0 op_sel_hi:[1,0]
  v_mul_f32 v230, v10, v124
  v_mul_f32 v231, v11, v124
  v_mul_f32 v232, v12, v124
  v_cvt_pk_f16_f32 v230, v230, v231
  v_cvt_pk_f16_f32 v231, v232, v232
  s_mov_b64 exec, s[74:75]
  ds_write_b64 v242, v[230:231] offset:128
  s_mov_b64 exec, -1
  v_rcp_f16_sdwa v6, v2 dst_sel:WORD_0 dst_unused:UNUSED_PAD src0_sel:WORD_0
  v_rcp_f16_sdwa v7, v3 dst_sel:WORD_0 dst_unused:UNUSED_PAD src0_sel:WORD_0
  s_waitcnt lgkmcnt(2)
  v_mfma_f32_32x32x16_f16 v[104:119], v[196:199], v[188:191], v[104:119]
  ds_read_b64_tr_b16 v[192:193], v245 offset:0
  ds_read_b64_tr_b16 v[194:195], v245 offset:144
  ds_read_b64_tr_b16 v[196:197], v245 offset:288
  ds_read_b64_tr_b16 v[198:199], v245 offset:432
  v_rcp_f16_sdwa v8, v4 dst_sel:WORD_0 dst_unused:UNUSED_PAD src0_sel:WORD_0
  s_waitcnt lgkmcnt(5)
  v_readfirstlane_b32 s68, v251
  s_setprio 1
  s_cmp_lt_i32 s68, s79
  s_cbranch_scc0 PRI1
  s_setprio 0
PRI1:
  s_add_u32 s79, s79, 128
  v_rcp_f16_sdwa v9, v5 dst_sel:WORD_0 dst_unused:UNUSED_PAD src0_sel:WORD_0
  v_rcp_f16_sdwa v6, v2 dst_sel:WORD_1 dst_unused:UNUSED_PRESERVE src0_sel:WORD_1
  v_mfma_f32_32x32x16_bf16 v[144:159], v[36:39], v[204:207], v[144:159]
  v_rcp_f16_sdwa v7, v3 dst_sel:WORD_1 dst_unused:UNUSED_PRESERVE src0_sel:WORD_1
  v_rcp_f16_sdwa v8, v4 dst_sel:WORD_1 dst_unused:UNUSED_PRESERVE src0_sel:WORD_1
  v_rcp_f16_sdwa v9, v5 dst_sel:WORD_1 dst_unused:UNUSED_PRESERVE src0_sel:WORD_1
  v_pk_mul_f16 v160, v160, v6
  v_pk_mul_f16 v161, v161, v7
  v_pk_mul_f16 v162, v162, v8
  v_pk_mul_f16 v163, v163, v9
  ds_write_b128 v242, v[160:163] offset:0
  v_mfma_f32_32x32x16_bf16 v[144:159], v[40:43], v[208:211], v[144:159]
  v_exp_f16_sdwa v2, v164 dst_sel:WORD_0 dst_unused:UNUSED_PAD src0_sel:WORD_0
  v_exp_f16_sdwa v3, v165 dst_sel:WORD_0 dst_unused:UNUSED_PAD src0_sel:WORD_0
  v_exp_f16_sdwa v4, v166 dst_sel:WORD_0 dst_unused:UNUSED_PAD src0_sel:WORD_0
  v_mfma_f32_32x32x16_bf16 v[144:159], v[44:47], v[212:215], v[144:159]
  v_exp_f16_sdwa v5, v167 dst_sel:WORD_0 dst_unused:UNUSED_PAD src0_sel:WORD_0
  v_exp_f16_sdwa v2, v164 dst_sel:WORD_1 dst_unused:UNUSED_PRESERVE src0_sel:WORD_1
  v_exp_f16_sdwa v3, v165 dst_sel:WORD_1 dst_unused:UNUSED_PRESERVE src0_sel:WORD_1
  v_mfma_f32_32x32x16_f16 v[144:159], v[64:67], v[176:179], v[144:159]
  v_exp_f16_sdwa v4, v166 dst_sel:WORD_1 dst_unused:UNUSED_PRESERVE src0_sel:WORD_1
  v_exp_f16_sdwa v5, v167 dst_sel:WORD_1 dst_unused:UNUSED_PRESERVE src0_sel:WORD_1
  v_pk_add_f16 v2, v2, 1.0 op_sel_hi:[1,0]
  v_pk_add_f16 v3, v3, 1.0 op_sel_hi:[1,0]
  v_pk_add_f16 v4, v4, 1.0 op_sel_hi:[1,0]
  v_pk_add_f16 v5, v5, 1.0 op_sel_hi:[1,0]
  v_rcp_f16_sdwa v6, v2 dst_sel:WORD_0 dst_unused:UNUSED_PAD src0_sel:WORD_0
  v_mfma_f32_32x32x16_f16 v[144:159], v[68:71], v[180:183], v[144:159]
  v_rcp_f16_sdwa v7, v3 dst_sel:WORD_0 dst_unused:UNUSED_PAD src0_sel:WORD_0
  s_waitcnt vmcnt(0)
  ds_read_b128 v[216:219], v254
  ds_read_b128 v[200:203], v237
  ds_read_b128 v[204:207], v238
  v_rcp_f16_sdwa v8, v4 dst_sel:WORD_0 dst_unused:UNUSED_PAD src0_sel:WORD_0
  v_rcp_f16_sdwa v9, v5 dst_sel:WORD_0 dst_unused:UNUSED_PAD src0_sel:WORD_0
  s_waitcnt lgkmcnt(6)
  v_mfma_f32_16x16x32_f16 v[120:123], v[192:195], v[184:187], v[120:123]
  ds_read_b128 v[208:211], v239
  ds_read_b128 v[212:215], v240
  v_rcp_f16_sdwa v6, v2 dst_sel:WORD_1 dst_unused:UNUSED_PRESERVE src0_sel:WORD_1
  v_add_u32_sdwa v249, v241, v228 dst_sel:DWORD dst_unused:UNUSED_PAD src0_sel:DWORD src1_sel:BYTE_3
  ds_read_b64 v[230:231], v249 offset:480
  ds_read_b32 v232, v249 offset:736
  v_lshlrev_b32 v125, 4, v228
  v_alignbit_b32 v126, v225, v224, v125
  v_lshrrev_b32 v127, v125, v225
  v_rcp_f16_sdwa v7, v3 dst_sel:WORD_1 dst_unused:UNUSED_PRESERVE src0_sel:WORD_1
  s_waitcnt lgkmcnt(8)
  v_mfma_f32_16x16x32_f16 v[120:123], v[196:199], v[188:191], v[120:123]
  ds_read_b64 v[176:177], v249 offset:192
  ds_read_b64 v[178:179], v249 offset:128
  ds_read_b64 v[180:181], v249 offset:64
  ds_read_b32 v182, v249
  ds_read_b128 v[184:187], v248 offset:128
  v_rcp_f16_sdwa v8, v4 dst_sel:WORD_1 dst_unused:UNUSED_PRESERVE src0_sel:WORD_1
  ds_read_b128 v[220:223], v246 offset:384
  ds_read_b32 v229, v247 offset:384
  ds_read_b32 v1, v252 offset:17792
  v_rcp_f16_sdwa v9, v5 dst_sel:WORD_1 dst_unused:UNUSED_PRESERVE src0_sel:WORD_1
  v_pk_mul_f16 v164, v164, v6
  v_pk_mul_f16 v165, v165, v7
  v_pk_mul_f16 v166, v166, v8
  v_pk_mul_f16 v167, v167, v9
  ds_write_b128 v242, v[164:167] offset:16
  v_cvt_pk_f16_f32 v168, v144, v145
  v_cvt_pk_f16_f32 v169, v146, v147
  v_cvt_pk_f16_f32 v170, v148, v149
  v_cvt_pk_f16_f32 v171, v150, v151
  v_cvt_pk_f16_f32 v172, v152, v153
  v_cvt_pk_f16_f32 v173, v154, v155
  v_cvt_pk_f16_f32 v174, v156, v157
  v_cvt_pk_f16_f32 v175, v158, v159
  s_waitcnt lgkmcnt(15)
  v_mfma_f32_32x32x16_bf16 v[128:143], v[48:51], v[216:219], 0
  ds_read_b64_tr_b16 v[192:193], v244 offset:0
  ds_read_b64_tr_b16 v[194:195], v244 offset:144
  ds_read_b64_tr_b16 v[196:197], v244 offset:288
  ds_read_b64_tr_b16 v[198:199], v244 offset:432
  v_exp_f16_sdwa v2, v168 dst_sel:WORD_0 dst_unused:UNUSED_PAD src0_sel:WORD_0
  v_exp_f16_sdwa v3, v169 dst_sel:WORD_0 dst_unused:UNUSED_PAD src0_sel:WORD_0
  v_exp_f16_sdwa v4, v170 dst_sel:WORD_0 dst_unused:UNUSED_PAD src0_sel:WORD_0
  v_mfma_f32_32x32x16_bf16 v[144:159], v[52:55], v[216:219], 0
  v_lshlrev_b32 v125, 16, v126
  v_and_b32 v126, s65, v126
  v_lshlrev_b32 v127, 16, v127
  v_exp_f16_sdwa v5, v171 dst_sel:WORD_0 dst_unused:UNUSED_PAD src0_sel:WORD_0
  v_exp_f16_sdwa v2, v168 dst_sel:WORD_1 dst_unused:UNUSED_PRESERVE src0_sel:WORD_1
  s_waitcnt lgkmcnt(15)
  v_mfma_f32_32x32x16_bf16 v[128:143], v[16:19], v[200:203], v[128:143]
  v_exp_f16_sdwa v3, v169 dst_sel:WORD_1 dst_unused:UNUSED_PRESERVE src0_sel:WORD_1
  v_exp_f16_sdwa v4, v170 dst_sel:WORD_1 dst_unused:UNUSED_PRESERVE src0_sel:WORD_1
  s_waitcnt lgkmcnt(8)
  v_add_u32_sdwa v184, v243, v184 dst_sel:DWORD dst_unused:UNUSED_PAD src0_sel:DWORD src1_sel:BYTE_3
  v_add_u32_sdwa v185, v243, v185 dst_sel:DWORD dst_unused:UNUSED_PAD src0_sel:DWORD src1_sel:BYTE_3
  v_add_u32_sdwa v186, v243, v186 dst_sel:DWORD dst_unused:UNUSED_PAD src0_sel:DWORD src1_sel:BYTE_3
  v_add_u32_sdwa v187, v243, v187 dst_sel:DWORD dst_unused:UNUSED_PAD src0_sel:DWORD src1_sel:BYTE_3
  ds_read_b64_tr_b16 v[190:191], v187
  ds_read_b64_tr_b16 v[188:189], v186
  ds_read_b64_tr_b16 v[186:187], v185
  ds_read_b64_tr_b16 v[184:185], v184
  s_cmp_gt_i32 s59, 1
  s_cselect_b32 s6, 6400000, 0
  s_cselect_b32 s10, 25600000, 0
  s_cselect_b32 s14, 300000, 0
  s_add_u32 m0, s67, 118784
  s_waitcnt lgkmcnt(9)
  v_mad_u32_u24 v1, v1, 32, v253
  buffer_load_dwordx4 v1, s[8:11], 0 offen  lds
  v_exp_f16_sdwa v5, v171 dst_sel:WORD_1 dst_unused:UNUSED_PRESERVE src0_sel:WORD_1
  v_pk_add_f16 v2, v2, 1.0 op_sel_hi:[1,0]
  v_pk_add_f16 v3, v3, 1.0 op_sel_hi:[1,0]
  v_pk_add_f16 v4, v4, 1.0 op_sel_hi:[1,0]
  v_pk_add_f16 v5, v5, 1.0 op_sel_hi:[1,0]
  v_mfma_f32_32x32x16_bf16 v[128:143], v[20:23], v[204:207], v[128:143]
  v_sub_f32 v230, v230, v125
  v_sub_f32 v231, v231, v126
  v_sub_f32 v232, v232, v127
  v_cvt_pk_bf16_f32 v230, v230, v231
  v_cvt_pk_bf16_f32 v232, v232, v232
  v_lshlrev_b32 v10, 16, v230
  v_and_b32 v11, s65, v230
  v_lshlrev_b32 v12, 16, v232
  v_rcp_f16_sdwa v6, v2 dst_sel:WORD_0 dst_unused:UNUSED_PAD src0_sel:WORD_0
  v_rcp_f16_sdwa v7, v3 dst_sel:WORD_0 dst_unused:UNUSED_PAD src0_sel:WORD_0
  v_rcp_f16_sdwa v8, v4 dst_sel:WORD_0 dst_unused:UNUSED_PAD src0_sel:WORD_0
  v_mfma_f32_32x32x16_bf16 v[128:143], v[24:27], v[208:211], v[128:143]
  s_add_u32 m0, s66, 0
  v_mad_u32_u24 v220, v220, s64, v233
  buffer_load_dwordx4 v220, s[4:7], 0 offen  lds
  v_rcp_f16_sdwa v9, v5 dst_sel:WORD_0 dst_unused:UNUSED_PAD src0_sel:WORD_0
  v_rcp_f16_sdwa v6, v2 dst_sel:WORD_1 dst_unused:UNUSED_PRESERVE src0_sel:WORD_1
  v_mfma_f32_32x32x16_bf16 v[128:143], v[28:31], v[212:215], v[128:143]
  s_add_u32 m0, s66, 1024
  v_mad_u32_u24 v221, v221, s64, v234
  buffer_load_dwordx4 v221, s[4:7], 0 offen  lds
  v_rcp_f16_sdwa v7, v3 dst_sel:WORD_1 dst_unused:UNUSED_PRESERVE src0_sel:WORD_1
  v_rcp_f16_sdwa v8, v4 dst_sel:WORD_1 dst_unused:UNUSED_PRESERVE src0_sel:WORD_1
  v_mul_f32 v230, v10, v10
  v_fmac_f32 v230, v11, v11
  v_fmac_f32 v230, v12, v12
  v_cvt_pk_f16_f32 v183, v230, v230
  v_rcp_f16_sdwa v9, v5 dst_sel:WORD_1 dst_unused:UNUSED_PRESERVE src0_sel:WORD_1
  v_pk_mul_f16 v168, v168, v6
  v_pk_mul_f16 v169, v169, v7
  v_pk_mul_f16 v170, v170, v8
  v_pk_mul_f16 v171, v171, v9
  ds_write_b128 v242, v[168:171] offset:64
  v_mfma_f32_16x16x32_f16 v[124:127], v[72:75], v[160:163], 0
  s_add_u32 m0, s66, 2048
  v_mad_u32_u24 v222, v222, s64, v235
  buffer_load_dwordx4 v222, s[4:7], 0 offen  lds
  v_exp_f16_sdwa v2, v172 dst_sel:WORD_0 dst_unused:UNUSED_PAD src0_sel:WORD_0
  v_exp_f16_sdwa v3, v173 dst_sel:WORD_0 dst_unused:UNUSED_PAD src0_sel:WORD_0
  v_mfma_f32_16x16x32_f16 v[124:127], v[76:79], v[164:167], v[124:127]
  s_add_u32 m0, s66, 3072
  v_mad_u32_u24 v223, v223, s64, v236
  buffer_load_dwordx4 v223, s[4:7], 0 offen  lds
  v_exp_f16_sdwa v4, v174 dst_sel:WORD_0 dst_unused:UNUSED_PAD src0_sel:WORD_0
  v_exp_f16_sdwa v5, v175 dst_sel:WORD_0 dst_unused:UNUSED_PAD src0_sel:WORD_0
  v_mfma_f32_32x32x16_f16 v[128:143], v[56:59], v[176:179], v[128:143]
  v_exp_f16_sdwa v2, v172 dst_sel:WORD_1 dst_unused:UNUSED_PRESERVE src0_sel:WORD_1
  v_exp_f16_sdwa v3, v173 dst_sel:WORD_1 dst_unused:UNUSED_PRESERVE src0_sel:WORD_1
  v_exp_f16_sdwa v4, v174 dst_sel:WORD_1 dst_unused:UNUSED_PRESERVE src0_sel:WORD_1
  v_mfma_f32_32x32x16_f16 v[128:143], v[60:63], v[180:183], v[128:143]
  v_mul_u32_u24 v1, 6, v229
  v_and_b32 v1, -4, v1
  s_mov_b64 exec, s[74:75]
  buffer_load_dwordx2 v[226:227], v1, s[12:15], 0 offen
  s_mov_b64 exec, -1
  v_exp_f16_sdwa v5, v175 dst_sel:WORD_1 dst_unused:UNUSED_PRESERVE src0_sel:WORD_1
  v_pk_add_f16 v2, v2, 1.0 op_sel_hi:[1,0]
  v_pk_add_f16 v3, v3, 1.0 op_sel_hi:[1,0]
  v_pk_add_f16 v4, v4, 1.0 op_sel_hi:[1,0]
  v_pk_add_f16 v5, v5, 1.0 op_sel_hi:[1,0]
  v_rcp_f16_sdwa v6, v2 dst_sel:WORD_0 dst_unused:UNUSED_PAD src0_sel:WORD_0
  v_rcp_f16_sdwa v7, v3 dst_sel:WORD_0 dst_unused:UNUSED_PAD src0_sel:WORD_0
  s_waitcnt lgkmcnt(1)
  v_mfma_f32_32x32x16_f16 v[88:103], v[192:195], v[184:187], v[88:103]
  v_rcp_f16_sdwa v8, v4 dst_sel:WORD_0 dst_unused:UNUSED_PAD src0_sel:WORD_0
  v_rcp_f16_sdwa v9, v5 dst_sel:WORD_0 dst_unused:UNUSED_PAD src0_sel:WORD_0
  v_rcp_f16_sdwa v6, v2 dst_sel:WORD_1 dst_unused:UNUSED_PRESERVE src0_sel:WORD_1
  v_mfma_f32_32x32x16_f16 v[88:103], v[196:199], v[188:191], v[88:103]
  v_rcp_f16_sdwa v7, v3 dst_sel:WORD_1 dst_unused:UNUSED_PRESERVE src0_sel:WORD_1
  v_rcp_f16_sdwa v8, v4 dst_sel:WORD_1 dst_unused:UNUSED_PRESERVE src0_sel:WORD_1
  v_rcp_f16_sdwa v9, v5 dst_sel:WORD_1 dst_unused:UNUSED_PRESERVE src0_sel:WORD_1
  v_pk_mul_f16 v172, v172, v6
  v_pk_mul_f16 v173, v173, v7
  v_pk_mul_f16 v174, v174, v8
  v_pk_mul_f16 v175, v175, v9
  ds_write_b128 v242, v[172:175] offset:80
  s_sub_u32 s59, s59, 1
  s_cmp_eq_u32 s59, 0
  v_add_u32 v246, 0x100, v246
  v_add_u32 v247, 0x100, v247
  v_add_u32 v248, 0x100, v248
  v_add_u32 v252, 0x100, v252
  s_cbranch_scc0 LOOP
  v_mov_b32 v10, v13
  v_mov_b32 v11, v14
  v_mov_b32 v12, v15
TAIL0:
  s_waitcnt lgkmcnt(0)
  ds_read_b64_tr_b16 v[192:193], v244 offset:64
  ds_read_b64_tr_b16 v[194:195], v244 offset:208
  ds_read_b64_tr_b16 v[196:197], v244 offset:352
  ds_read_b64_tr_b16 v[198:199], v244 offset:496
  v_mfma_f32_16x16x32_f16 v[124:127], v[80:83], v[168:171], v[124:127]
  v_mfma_f32_16x16x32_f16 v[124:127], v[84:87], v[172:175], v[124:127]
  s_waitcnt lgkmcnt(2)
  v_mfma_f32_32x32x16_f16 v[104:119], v[192:195], v[184:187], v[104:119]
  s_waitcnt lgkmcnt(0)
  v_mfma_f32_32x32x16_f16 v[104:119], v[196:199], v[188:191], v[104:119]
  s_nop 3
  v_mul_f32 v230, v10, v124
  v_mul_f32 v231, v11, v124
  v_mul_f32 v232, v12, v124
  v_cvt_pk_f16_f32 v230, v230, v231
  v_cvt_pk_f16_f32 v231, v232, v232
  s_mov_b64 exec, s[74:75]
  ds_write_b64 v242, v[230:231] offset:128
  s_mov_b64 exec, -1
  ds_read_b64_tr_b16 v[192:193], v245 offset:0
  ds_read_b64_tr_b16 v[194:195], v245 offset:144
  ds_read_b64_tr_b16 v[196:197], v245 offset:288
  ds_read_b64_tr_b16 v[198:199], v245 offset:432
  s_waitcnt lgkmcnt(2)
  v_mfma_f32_16x16x32_f16 v[120:123], v[192:195], v[184:187], v[120:123]
  s_waitcnt lgkmcnt(0)
  v_mfma_f32_16x16x32_f16 v[120:123], v[196:199], v[188:191], v[120:123]
LOOPEND:
  s_cmp_eq_u32 s62, 0
  s_cbranch_scc1 EPI
  s_add_u32 s61, s61, s60
  s_min_u32 s60, s60, 32
  s_waitcnt vmcnt(0)
  s_barrier
  s_branch ROUND
EPI:
  v_and_b32 v2, 1, v0
  v_bfe_u32 v3, v0, 1, 1
  v_bfe_u32 v4, v0, 2, 2
  v_bfe_u32 v5, v0, 4, 1
  v_lshlrev_b32 v2, 6, v2
  v_lshl_add_u32 v2, v3, 3, v2
  v_lshl_add_u32 v2, v5, 4, v2
  v_lshrrev_b32 v3, 1, v4
  v_lshl_add_u32 v2, v3, 5, v2
  v_lshl_add_u32 v2, v4, 7, v2
  v_add_u32 v2, 114176, v2
  v_lshl_add_u32 v6, v250, 8, v2
  v_xor_b32 v7, 32, v6
  v_lshl_add_u32 v8, v250, 6, v2
  v_xor_b32 v9, 32, v8
  v_lshl_add_u32 v249, v0, 3, s67
  ds_read_b64 v[220:221], v249 offset:512
  ds_read_b32 v222, v249 offset:768
  ds_read_b64_tr_b16 v[16:17], v6 offset:0
  ds_read_b64_tr_b16 v[18:19], v6 offset:512
  ds_read_b64_tr_b16 v[20:21], v6 offset:1024
  ds_read_b64_tr_b16 v[22:23], v6 offset:1536
  ds_read_b64_tr_b16 v[24:25], v6 offset:2048
  ds_read_b64_tr_b16 v[26:27], v6 offset:2560
  ds_read_b64_tr_b16 v[28:29], v6 offset:3072
  ds_read_b64_tr_b16 v[30:31], v6 offset:3584
  ds_read_b64_tr_b16 v[32:33], v8 offset:8192
  ds_read_b64_tr_b16 v[34:35], v8 offset:10240
  ds_read_b64_tr_b16 v[36:37], v8 offset:8704
  ds_read_b64_tr_b16 v[38:39], v8 offset:10752
  ds_read_b64_tr_b16 v[40:41], v8 offset:12288
  ds_read_b64_tr_b16 v[42:43], v8 offset:14336
  ds_read_b64_tr_b16 v[44:45], v8 offset:12800
  ds_read_b64_tr_b16 v[46:47], v8 offset:14848
  s_mov_b32 s68, 0xbf317218
  s_mov_b32 s69, 0xbf317218
  v_pk_mul_f32 v[88:89], v[88:89], s[68:69]
  v_pk_mul_f32 v[90:91], v[90:91], s[68:69]
  v_pk_mul_f32 v[92:93], v[92:93], s[68:69]
  v_pk_mul_f32 v[94:95], v[94:95], s[68:69]
  v_pk_mul_f32 v[96:97], v[96:97], s[68:69]
  v_pk_mul_f32 v[98:99], v[98:99], s[68:69]
  v_pk_mul_f32 v[100:101], v[100:101], s[68:69]
  v_pk_mul_f32 v[102:103], v[102:103], s[68:69]
  v_pk_mul_f32 v[104:105], v[104:105], s[68:69]
  v_pk_mul_f32 v[106:107], v[106:107], s[68:69]
  v_pk_mul_f32 v[108:109], v[108:109], s[68:69]
  v_pk_mul_f32 v[110:111], v[110:111], s[68:69]
  v_pk_mul_f32 v[112:113], v[112:113], s[68:69]
  v_pk_mul_f32 v[114:115], v[114:115], s[68:69]
  v_pk_mul_f32 v[116:117], v[116:117], s[68:69]
  v_pk_mul_f32 v[118:119], v[118:119], s[68:69]
  v_pk_mul_f32 v[120:121], v[120:121], s[68:69]
  v_pk_mul_f32 v[122:123], v[122:123], s[68:69]
  s_waitcnt lgkmcnt(8)
  v_mfma_f32_32x32x16_bf16 v[128:143], v[16:19], v[200:203], 0
  v_cvt_pk_bf16_f32 v160, v88, v89
  v_cvt_pk_bf16_f32 v161, v90, v91
  v_cvt_pk_bf16_f32 v162, v92, v93
  v_cvt_pk_bf16_f32 v163, v94, v95
  v_cvt_pk_bf16_f32 v164, v96, v97
  v_mfma_f32_32x32x16_bf16 v[128:143], v[20:23], v[204:207], v[128:143]
  v_cvt_pk_bf16_f32 v165, v98, v99
  v_cvt_pk_bf16_f32 v166, v100, v101
  v_cvt_pk_bf16_f32 v167, v102, v103
  v_cvt_pk_bf16_f32 v168, v104, v105
  v_cvt_pk_bf16_f32 v169, v106, v107
  v_mfma_f32_32x32x16_bf16 v[128:143], v[24:27], v[208:211], v[128:143]
  v_cvt_pk_bf16_f32 v170, v108, v109
  v_cvt_pk_bf16_f32 v171, v110, v111
  v_cvt_pk_bf16_f32 v172, v112, v113
  v_cvt_pk_bf16_f32 v173, v114, v115
  v_cvt_pk_bf16_f32 v174, v116, v117
  v_mfma_f32_32x32x16_bf16 v[128:143], v[28:31], v[212:215], v[128:143]
  v_cvt_pk_bf16_f32 v175, v118, v119
  s_waitcnt lgkmcnt(0)
  ds_read_b64_tr_b16 v[48:49], v7 offset:0
  ds_read_b64_tr_b16 v[50:51], v7 offset:512
  ds_read_b64_tr_b16 v[52:53], v7 offset:1024
  ds_read_b64_tr_b16 v[54:55], v7 offset:1536
  ds_read_b64_tr_b16 v[56:57], v7 offset:2048
  ds_read_b64_tr_b16 v[58:59], v7 offset:2560
  ds_read_b64_tr_b16 v[60:61], v7 offset:3072
  ds_read_b64_tr_b16 v[62:63], v7 offset:3584
  ds_read_b64_tr_b16 v[64:65], v9 offset:8192
  ds_read_b64_tr_b16 v[66:67], v9 offset:10240
  ds_read_b64_tr_b16 v[68:69], v9 offset:8704
  ds_read_b64_tr_b16 v[70:71], v9 offset:10752
  ds_read_b64_tr_b16 v[72:73], v9 offset:12288
  ds_read_b64_tr_b16 v[74:75], v9 offset:14336
  ds_read_b64_tr_b16 v[76:77], v9 offset:12800
  ds_read_b64_tr_b16 v[78:79], v9 offset:14848
  v_mfma_f32_32x32x16_bf16 v[128:143], v[32:35], v[160:163], v[128:143]
  v_add_f32 v220, v220, v120
  v_add_f32 v221, v221, v121
  v_add_f32 v222, v222, v122
  v_cvt_pk_bf16_f32 v220, v220, v221
  v_cvt_pk_bf16_f32 v222, v222, v222
  v_add_u32 v230, s58, v0
  v_mfma_f32_32x32x16_bf16 v[128:143], v[36:39], v[164:167], v[128:143]
  v_mul_u32_u24 v230, 6, v230
  v_add_u32 v230, 6400000, v230
  v_lshl_add_u32 v242, v250, 1, v242
  v_lshrrev_b32 v246, 3, v0
  v_and_b32 v247, 7, v0
  s_mul_i32 s3, s57, 4608
  v_mfma_f32_32x32x16_bf16 v[128:143], v[40:43], v[168:171], v[128:143]
  s_add_u32 s3, s3, 44544
  v_mul_u32_u24 v248, 144, v246
  v_lshl_add_u32 v248, v247, 4, v248
  v_add_u32 v248, s3, v248
  s_lshl_b32 s3, s58, 7
  v_lshl_add_u32 v231, v0, 4, s3
  v_mfma_f32_32x32x16_bf16 v[128:143], v[44:47], v[172:175], v[128:143]
  s_bfe_u32 s68, s78, 0x10018
  s_mul_i32 s68, s68, 255
  s_mov_b32 s69, 0
  s_mov_b32 exec_lo, s78
  s_mov_b32 exec_hi, 0
  buffer_store_short v220, v230, s[28:31], 0 offen
  buffer_store_short_d16_hi v220, v230, s[28:31], 0 offen offset:2
  buffer_store_short v222, v230, s[28:31], 0 offen offset:4
  s_mov_b64 exec, -1
  s_waitcnt lgkmcnt(0)
  v_mfma_f32_32x32x16_bf16 v[144:159], v[48:51], v[200:203], 0
  s_nop 0
  v_pk_mul_f32 v[2:3], v[128:129], s[70:71]
  v_pk_mul_f32 v[4:5], v[130:131], s[70:71]
  v_pk_mul_f32 v[6:7], v[132:133], s[70:71]
  v_pk_mul_f32 v[8:9], v[134:135], s[70:71]
  v_exp_f32 v2, v2
  v_mfma_f32_32x32x16_bf16 v[144:159], v[52:55], v[204:207], v[144:159]
  v_exp_f32 v3, v3
  v_exp_f32 v4, v4
  v_exp_f32 v5, v5
  v_exp_f32 v6, v6
  v_exp_f32 v7, v7
  v_exp_f32 v8, v8
  v_exp_f32 v9, v9
  v_mfma_f32_32x32x16_bf16 v[144:159], v[56:59], v[208:211], v[144:159]
  v_pk_add_f32 v[2:3], v[2:3], s[72:73]
  v_pk_add_f32 v[4:5], v[4:5], s[72:73]
  v_pk_add_f32 v[6:7], v[6:7], s[72:73]
  v_pk_add_f32 v[8:9], v[8:9], s[72:73]
  v_rcp_f32 v2, v2
  v_rcp_f32 v3, v3
  v_rcp_f32 v4, v4
  v_mfma_f32_32x32x16_bf16 v[144:159], v[60:63], v[212:215], v[144:159]
  v_rcp_f32 v5, v5
  v_rcp_f32 v6, v6
  v_rcp_f32 v7, v7
  v_rcp_f32 v8, v8
  v_rcp_f32 v9, v9
  v_pk_mul_f32 v[2:3], v[2:3], v[128:129]
  v_pk_mul_f32 v[4:5], v[4:5], v[130:131]
  v_mfma_f32_32x32x16_bf16 v[144:159], v[64:67], v[160:163], v[144:159]
  v_pk_mul_f32 v[6:7], v[6:7], v[132:133]
  v_pk_mul_f32 v[8:9], v[8:9], v[134:135]
  v_cvt_pk_bf16_f32 v176, v2, v3
  v_cvt_pk_bf16_f32 v177, v4, v5
  v_cvt_pk_bf16_f32 v178, v6, v7
  v_cvt_pk_bf16_f32 v179, v8, v9
  v_lshlrev_b32 v2, 16, v176
  v_mfma_f32_32x32x16_bf16 v[144:159], v[68:71], v[164:167], v[144:159]
  v_and_b32 v3, s65, v176
  v_lshlrev_b32 v4, 16, v200
  v_and_b32 v5, s65, v200
  v_pk_add_f32 v[2:3], v[2:3], v[4:5]
  v_cvt_pk_bf16_f32 v88, v2, v3
  v_lshlrev_b32 v6, 16, v177
  v_and_b32 v7, s65, v177
  v_mfma_f32_32x32x16_bf16 v[144:159], v[72:75], v[168:171], v[144:159]
  v_lshlrev_b32 v8, 16, v201
  v_and_b32 v9, s65, v201
  v_pk_add_f32 v[6:7], v[6:7], v[8:9]
  v_cvt_pk_bf16_f32 v89, v6, v7
  v_lshlrev_b32 v2, 16, v178
  v_and_b32 v3, s65, v178
  v_lshlrev_b32 v4, 16, v202
  v_mfma_f32_32x32x16_bf16 v[144:159], v[76:79], v[172:175], v[144:159]
  v_and_b32 v5, s65, v202
  v_pk_add_f32 v[2:3], v[2:3], v[4:5]
  v_cvt_pk_bf16_f32 v90, v2, v3
  v_lshlrev_b32 v6, 16, v179
  v_and_b32 v7, s65, v179
  v_lshlrev_b32 v8, 16, v203
  v_and_b32 v9, s65, v203
  v_pk_add_f32 v[6:7], v[6:7], v[8:9]
  v_cvt_pk_bf16_f32 v91, v6, v7
  ds_write_b128 v242, v[88:91] offset:0
  v_pk_mul_f32 v[2:3], v[136:137], s[70:71]
  v_pk_mul_f32 v[4:5], v[138:139], s[70:71]
  v_pk_mul_f32 v[6:7], v[140:141], s[70:71]
  v_pk_mul_f32 v[8:9], v[142:143], s[70:71]
  v_exp_f32 v2, v2
  v_exp_f32 v3, v3
  v_exp_f32 v4, v4
  v_exp_f32 v5, v5
  v_exp_f32 v6, v6
  v_exp_f32 v7, v7
  v_exp_f32 v8, v8
  v_exp_f32 v9, v9
  v_pk_add_f32 v[2:3], v[2:3], s[72:73]
  v_pk_add_f32 v[4:5], v[4:5], s[72:73]
  v_pk_add_f32 v[6:7], v[6:7], s[72:73]
  v_pk_add_f32 v[8:9], v[8:9], s[72:73]
  v_rcp_f32 v2, v2
  v_rcp_f32 v3, v3
  v_rcp_f32 v4, v4
  v_rcp_f32 v5, v5
  v_rcp_f32 v6, v6
  v_rcp_f32 v7, v7
  v_rcp_f32 v8, v8
  v_rcp_f32 v9, v9
  v_pk_mul_f32 v[2:3], v[2:3], v[136:137]
  v_pk_mul_f32 v[4:5], v[4:5], v[138:139]
  v_pk_mul_f32 v[6:7], v[6:7], v[140:141]
  v_pk_mul_f32 v[8:9], v[8:9], v[142:143]
  v_cvt_pk_bf16_f32 v176, v2, v3
  v_cvt_pk_bf16_f32 v177, v4, v5
  v_cvt_pk_bf16_f32 v178, v6, v7
  v_cvt_pk_bf16_f32 v179, v8, v9
  v_lshlrev_b32 v2, 16, v176
  v_and_b32 v3, s65, v176
  v_lshlrev_b32 v4, 16, v204
  v_and_b32 v5, s65, v204
  v_pk_add_f32 v[2:3], v[2:3], v[4:5]
  v_cvt_pk_bf16_f32 v92, v2, v3
  v_lshlrev_b32 v6, 16, v177
  v_and_b32 v7, s65, v177
  v_lshlrev_b32 v8, 16, v205
  v_and_b32 v9, s65, v205
  v_pk_add_f32 v[6:7], v[6:7], v[8:9]
  v_cvt_pk_bf16_f32 v93, v6, v7
  v_lshlrev_b32 v2, 16, v178
  v_and_b32 v3, s65, v178
  v_lshlrev_b32 v4, 16, v206
  v_and_b32 v5, s65, v206
  v_pk_add_f32 v[2:3], v[2:3], v[4:5]
  v_cvt_pk_bf16_f32 v94, v2, v3
  v_lshlrev_b32 v6, 16, v179
  v_and_b32 v7, s65, v179
  v_lshlrev_b32 v8, 16, v207
  v_and_b32 v9, s65, v207
  v_pk_add_f32 v[6:7], v[6:7], v[8:9]
  v_cvt_pk_bf16_f32 v95, v6, v7
  ds_write_b128 v242, v[92:95] offset:16
  v_pk_mul_f32 v[2:3], v[144:145], s[70:71]
  v_pk_mul_f32 v[4:5], v[146:147], s[70:71]
  v_pk_mul_f32 v[6:7], v[148:149], s[70:71]
  v_pk_mul_f32 v[8:9], v[150:151], s[70:71]
  v_exp_f32 v2, v2
  v_exp_f32 v3, v3
  v_exp_f32 v4, v4
  v_exp_f32 v5, v5
  v_exp_f32 v6, v6
  v_exp_f32 v7, v7
  v_exp_f32 v8, v8
  v_exp_f32 v9, v9
  v_pk_add_f32 v[2:3], v[2:3], s[72:73]
  v_pk_add_f32 v[4:5], v[4:5], s[72:73]
  v_pk_add_f32 v[6:7], v[6:7], s[72:73]
  v_pk_add_f32 v[8:9], v[8:9], s[72:73]
  v_rcp_f32 v2, v2
  v_rcp_f32 v3, v3
  v_rcp_f32 v4, v4
  v_rcp_f32 v5, v5
  v_rcp_f32 v6, v6
  v_rcp_f32 v7, v7
  v_rcp_f32 v8, v8
  v_rcp_f32 v9, v9
  v_pk_mul_f32 v[2:3], v[2:3], v[144:145]
  v_pk_mul_f32 v[4:5], v[4:5], v[146:147]
  v_pk_mul_f32 v[6:7], v[6:7], v[148:149]
  v_pk_mul_f32 v[8:9], v[8:9], v[150:151]
  v_cvt_pk_bf16_f32 v176, v2, v3
  v_cvt_pk_bf16_f32 v177, v4, v5
  v_cvt_pk_bf16_f32 v178, v6, v7
  v_cvt_pk_bf16_f32 v179, v8, v9
  v_lshlrev_b32 v2, 16, v176
  v_and_b32 v3, s65, v176
  v_lshlrev_b32 v4, 16, v208
  v_and_b32 v5, s65, v208
  v_pk_add_f32 v[2:3], v[2:3], v[4:5]
  v_cvt_pk_bf16_f32 v96, v2, v3
  v_lshlrev_b32 v6, 16, v177
  v_and_b32 v7, s65, v177
  v_lshlrev_b32 v8, 16, v209
  v_and_b32 v9, s65, v209
  v_pk_add_f32 v[6:7], v[6:7], v[8:9]
  v_cvt_pk_bf16_f32 v97, v6, v7
  v_lshlrev_b32 v2, 16, v178
  v_and_b32 v3, s65, v178
  v_lshlrev_b32 v4, 16, v210
  v_and_b32 v5, s65, v210
  v_pk_add_f32 v[2:3], v[2:3], v[4:5]
  v_cvt_pk_bf16_f32 v98, v2, v3
  v_lshlrev_b32 v6, 16, v179
  v_and_b32 v7, s65, v179
  v_lshlrev_b32 v8, 16, v211
  v_and_b32 v9, s65, v211
  v_pk_add_f32 v[6:7], v[6:7], v[8:9]
  v_cvt_pk_bf16_f32 v99, v6, v7
  ds_write_b128 v242, v[96:99] offset:32
  v_pk_mul_f32 v[2:3], v[152:153], s[70:71]
  v_pk_mul_f32 v[4:5], v[154:155], s[70:71]
  v_pk_mul_f32 v[6:7], v[156:157], s[70:71]
  v_pk_mul_f32 v[8:9], v[158:159], s[70:71]
  v_exp_f32 v2, v2
  v_exp_f32 v3, v3
  v_exp_f32 v4, v4
  v_exp_f32 v5, v5
  v_exp_f32 v6, v6
  v_exp_f32 v7, v7
  v_exp_f32 v8, v8
  v_exp_f32 v9, v9
  v_pk_add_f32 v[2:3], v[2:3], s[72:73]
  v_pk_add_f32 v[4:5], v[4:5], s[72:73]
  v_pk_add_f32 v[6:7], v[6:7], s[72:73]
  v_pk_add_f32 v[8:9], v[8:9], s[72:73]
  v_rcp_f32 v2, v2
  v_rcp_f32 v3, v3
  v_rcp_f32 v4, v4
  v_rcp_f32 v5, v5
  v_rcp_f32 v6, v6
  v_rcp_f32 v7, v7
  v_rcp_f32 v8, v8
  v_rcp_f32 v9, v9
  v_pk_mul_f32 v[2:3], v[2:3], v[152:153]
  v_pk_mul_f32 v[4:5], v[4:5], v[154:155]
  v_pk_mul_f32 v[6:7], v[6:7], v[156:157]
  v_pk_mul_f32 v[8:9], v[8:9], v[158:159]
  v_cvt_pk_bf16_f32 v176, v2, v3
  v_cvt_pk_bf16_f32 v177, v4, v5
  v_cvt_pk_bf16_f32 v178, v6, v7
  v_cvt_pk_bf16_f32 v179, v8, v9
  v_lshlrev_b32 v2, 16, v176
  v_and_b32 v3, s65, v176
  v_lshlrev_b32 v4, 16, v212
  v_and_b32 v5, s65, v212
  v_pk_add_f32 v[2:3], v[2:3], v[4:5]
  v_cvt_pk_bf16_f32 v100, v2, v3
  v_lshlrev_b32 v6, 16, v177
  v_and_b32 v7, s65, v177
  v_lshlrev_b32 v8, 16, v213
  v_and_b32 v9, s65, v213
  v_pk_add_f32 v[6:7], v[6:7], v[8:9]
  v_cvt_pk_bf16_f32 v101, v6, v7
  v_lshlrev_b32 v2, 16, v178
  v_and_b32 v3, s65, v178
  v_lshlrev_b32 v4, 16, v214
  v_and_b32 v5, s65, v214
  v_pk_add_f32 v[2:3], v[2:3], v[4:5]
  v_cvt_pk_bf16_f32 v102, v2, v3
  v_lshlrev_b32 v6, 16, v179
  v_and_b32 v7, s65, v179
  v_lshlrev_b32 v8, 16, v215
  v_and_b32 v9, s65, v215
  v_pk_add_f32 v[6:7], v[6:7], v[8:9]
  v_cvt_pk_bf16_f32 v103, v6, v7
  ds_write_b128 v242, v[100:103] offset:48
  ds_read_b128 v[128:131], v248 offset:0
  ds_read_b128 v[132:135], v248 offset:1152
  ds_read_b128 v[136:139], v248 offset:2304
  ds_read_b128 v[140:143], v248 offset:3456
  s_waitcnt lgkmcnt(3)
  buffer_store_dwordx4 v[128:131], v231, s[28:31], 0 offen offset:0
  s_waitcnt lgkmcnt(2)
  buffer_store_dwordx4 v[132:135], v231, s[28:31], 0 offen offset:1024
  s_waitcnt lgkmcnt(1)
  buffer_store_dwordx4 v[136:139], v231, s[28:31], 0 offen offset:2048
  s_waitcnt lgkmcnt(0)
  s_cmp_eq_u32 s68, 0
  s_cbranch_scc1 NO25
  s_mov_b64 exec, s[68:69]
  buffer_store_dwordx4 v[140:143], v231, s[28:31], 0 offen offset:3072
  s_mov_b64 exec, -1
NO25:
K2END:
  s_endpgm
.section .rodata,"a"
.p2align 6
.amdhsa_kernel part_kernel
  .amdhsa_next_free_vgpr 56
  .amdhsa_next_free_sgpr 102
  .amdhsa_accum_offset 56
  .amdhsa_group_segment_fixed_size 0
  .amdhsa_kernarg_size 88
  .amdhsa_user_sgpr_count 2
  .amdhsa_user_sgpr_kernarg_segment_ptr 1
  .amdhsa_system_sgpr_workgroup_id_x 1
.end_amdhsa_kernel
.p2align 6
.amdhsa_kernel main_kernel
  .amdhsa_next_free_vgpr 256
  .amdhsa_next_free_sgpr 102
  .amdhsa_accum_offset 256
  .amdhsa_group_segment_fixed_size 0
  .amdhsa_kernarg_size 88
  .amdhsa_user_sgpr_count 2
  .amdhsa_user_sgpr_kernarg_segment_ptr 1
  .amdhsa_system_sgpr_workgroup_id_x 1
.end_amdhsa_kernel
```

```asm
; @launch kernel=part_kernel grid=(251,1,1) block=(640,1,1) lds=93312
; @launch kernel=main_kernel grid=(256,1,1) block=(512,1,1) lds=163328
.amdgcn_target "amdgcn-amd-amdhsa--gfx950"
.text
.globl part_kernel
.p2align 8
.type part_kernel,@function
part_kernel:
  s_cmp_gt_u32 s2, 250
  s_cbranch_scc1 K1END
  s_load_dwordx2 s[8:9], s[0:1], 80
  s_cmp_eq_u32 s2, 250
  s_cbranch_scc1 WPREP
  s_load_dwordx4 s[4:7], s[0:1], 24
  s_load_dwordx2 s[32:33], s[0:1], 16
  s_mul_i32 s3, s2, 12800
  v_lshlrev_b32 v2, 4, v0
  v_lshlrev_b32 v3, 2, v0
  v_add_u32 v3, 10240, v3
  v_and_b32 v1, 255, v0
  v_lshlrev_b32 v1, 2, v1
  v_mov_b32 v20, 0
  v_mov_b32 v21, 0
  v_mov_b32 v22, 0
  v_mov_b32 v23, 0
  s_waitcnt lgkmcnt(0)
  s_mov_b32 s12, s4
  s_mov_b32 s13, s5
  s_mov_b32 s14, 3200000
  s_mov_b32 s15, 0x20000
  s_mov_b32 s16, s6
  s_mov_b32 s17, s7
  s_mov_b32 s18, 3200000
  s_mov_b32 s19, 0x20000
  buffer_load_dwordx4 v[4:7], v2, s[16:19], s3 offen
  buffer_load_dword v8, v3, s[16:19], s3 offen
  buffer_load_dwordx4 v[12:15], v2, s[12:15], s3 offen
  buffer_load_dword v16, v3, s[12:15], s3 offen
  ds_write_b32 v1, v20 offset:58368
  ds_write_b32 v20, v20 offset:60416
  ds_write_b128 v2, v[20:23] offset:0
  ds_write_b128 v2, v[20:23] offset:10240
  ds_write_b128 v2, v[20:23] offset:20480
  ds_write_b128 v2, v[20:23] offset:30720
  s_mov_b32 s20, s8
  s_mov_b32 s21, s9
  s_mov_b32 s22, 8388608
  s_mov_b32 s23, 0x20000
  s_add_u32 s24, s8, 8388488
  s_addc_u32 s25, s9, 0
  s_mov_b32 s26, 14592120
  s_mov_b32 s27, 0x20000
  s_mov_b32 s28, 175921861
  s_movk_i32 s29, 3125
  s_mul_i32 s30, s2, 3200
  s_or_b32 s30, s30, 0x80000000
  v_mov_b32 v50, 1
  v_mov_b32 v49, 127
  v_lshl_add_u32 v51, v0, 2, s30
  s_add_u32 s30, s30, 2560
  v_add_u32 v52, s30, v0
  v_readfirstlane_b32 s31, v0
  v_lshrrev_b32 v55, 3, v0
  v_lshlrev_b32 v55, 2, v55
  v_add_u32 v55, 58368, v55
  v_add_u32 v60, 60544, v2
  v_and_b32 v61, 0, v0
  v_lshl_add_u32 v61, v61, 1, 15
  s_waitcnt lgkmcnt(0)
  s_barrier
  s_waitcnt vmcnt(2)
  v_mul_hi_u32 v37, s28, v4
  v_lshrrev_b32 v20, 1, v37
  v_and_b32 v20, 0x3fc, v20
  ds_add_rtn_u32 v28, v20, v50 offset:58368
  v_mul_hi_u32 v39, s28, v5
  v_lshrrev_b32 v21, 1, v39
  v_and_b32 v21, 0x3fc, v21
  ds_add_rtn_u32 v29, v21, v50 offset:58368
  v_mul_hi_u32 v41, s28, v6
  v_lshrrev_b32 v22, 1, v41
  v_and_b32 v22, 0x3fc, v22
  ds_add_rtn_u32 v30, v22, v50 offset:58368
  v_mul_hi_u32 v43, s28, v7
  v_lshrrev_b32 v23, 1, v43
  v_and_b32 v23, 0x3fc, v23
  ds_add_rtn_u32 v31, v23, v50 offset:58368
  v_mul_hi_u32 v45, s28, v8
  v_lshrrev_b32 v24, 1, v45
  v_and_b32 v24, 0x3fc, v24
  ds_add_rtn_u32 v32, v24, v50 offset:58368
  v_mad_u32_u24 v36, v37, s29, v49
  v_lshrrev_b32 v36, 7, v36
  v_sub_u32 v4, v4, v36
  v_and_b32 v37, 7, v37
  v_mad_u32_u24 v38, v39, s29, v49
  v_lshrrev_b32 v38, 7, v38
  v_sub_u32 v5, v5, v38
  v_and_b32 v39, 7, v39
  v_mad_u32_u24 v40, v41, s29, v49
  v_lshrrev_b32 v40, 7, v40
  v_sub_u32 v6, v6, v40
  v_and_b32 v41, 7, v41
  v_mad_u32_u24 v42, v43, s29, v49
  v_lshrrev_b32 v42, 7, v42
  v_sub_u32 v7, v7, v42
  v_and_b32 v43, 7, v43
  v_mad_u32_u24 v44, v45, s29, v49
  v_lshrrev_b32 v44, 7, v44
  v_sub_u32 v8, v8, v44
  v_and_b32 v45, 7, v45
  s_waitcnt vmcnt(0)
  v_lshl_or_b32 v36, v4, 27, v12
  v_lshrrev_b32 v12, 12, v12
  v_lshl_or_b32 v37, v37, 4, v12
  v_lshl_or_b32 v37, v37, 24, v51
  v_lshl_or_b32 v38, v5, 27, v13
  v_lshrrev_b32 v13, 12, v13
  v_lshl_or_b32 v39, v39, 4, v13
  v_add_u32 v51, 1, v51
  v_lshl_or_b32 v39, v39, 24, v51
  v_lshl_or_b32 v40, v6, 27, v14
  v_lshrrev_b32 v14, 12, v14
  v_lshl_or_b32 v41, v41, 4, v14
  v_add_u32 v51, 1, v51
  v_lshl_or_b32 v41, v41, 24, v51
  v_lshl_or_b32 v42, v7, 27, v15
  v_lshrrev_b32 v15, 12, v15
  v_lshl_or_b32 v43, v43, 4, v15
  v_add_u32 v51, 1, v51
  v_lshl_or_b32 v43, v43, 24, v51
  v_lshl_or_b32 v44, v8, 27, v16
  v_lshrrev_b32 v16, 12, v16
  v_lshl_or_b32 v45, v45, 4, v16
  v_lshl_or_b32 v45, v45, 24, v52
  v_lshrrev_b32 v3, 3, v0
  s_movk_i32 s3, 128
  v_mul_u32_u24 v3, s3, v3
  v_and_b32 v1, 7, v0
  v_lshl_add_u32 v3, v1, 4, v3
  s_mul_i32 s3, s2, 32896
  s_add_u32 s4, s3, 10240
  s_add_u32 s5, s3, 20480
  s_add_u32 s6, s3, 30720
  s_mul_i32 s7, s2, 58368
  s_mov_b32 s33, 0
  s_mov_b32 s34, 0xfff20000
  v_mov_b32 v1, 60416
  v_lshlrev_b32 v4, 5, v20
  v_lshlrev_b32 v5, 5, v21
  v_lshlrev_b32 v6, 5, v22
  v_lshlrev_b32 v7, 5, v23
  v_lshlrev_b32 v8, 5, v24
  s_waitcnt lgkmcnt(4)
  v_cmp_gt_u32 s[40:41], 15, v28
  v_lshl_add_u32 v12, v28, 3, v4
  s_waitcnt lgkmcnt(3)
  v_cmp_gt_u32 s[42:43], 15, v29
  v_lshl_add_u32 v13, v29, 3, v5
  s_waitcnt lgkmcnt(2)
  v_cmp_gt_u32 s[44:45], 15, v30
  v_lshl_add_u32 v14, v30, 3, v6
  s_waitcnt lgkmcnt(1)
  v_cmp_gt_u32 s[46:47], 15, v31
  v_lshl_add_u32 v15, v31, 3, v7
  s_waitcnt lgkmcnt(0)
  v_cmp_gt_u32 s[48:49], 15, v32
  v_lshl_add_u32 v16, v32, 3, v8
  v_max3_u32 v48, v28, v29, v30
  v_max3_u32 v48, v48, v31, v32
  v_cmp_le_u32 s[50:51], 31, v48
  s_mov_b64 exec, s[40:41]
  ds_write_b64 v12, v[36:37]
  s_mov_b64 exec, s[42:43]
  ds_write_b64 v13, v[38:39]
  s_mov_b64 exec, s[44:45]
  ds_write_b64 v14, v[40:41]
  s_mov_b64 exec, s[46:47]
  ds_write_b64 v15, v[42:43]
  s_mov_b64 exec, s[48:49]
  ds_write_b64 v16, v[44:45]
  s_not_b64 exec, s[40:41]
  s_cbranch_scc0 K1N0
  v_lshl_add_u32 v48, v20, 2, s34
  v_lshl_add_u32 v48, v28, 16, v48
  ds_max_u32 v4, v48 offset:120
  v_cmpx_gt_u32 vcc, 31, v28
  ds_write_b64 v12, v[36:37] offset:60424
K1N0:
  s_not_b64 exec, s[42:43]
  s_cbranch_scc0 K1N1
  v_lshl_add_u32 v48, v21, 2, s34
  v_lshl_add_u32 v48, v29, 16, v48
  ds_max_u32 v5, v48 offset:120
  v_cmpx_gt_u32 vcc, 31, v29
  ds_write_b64 v13, v[38:39] offset:60424
K1N1:
  s_not_b64 exec, s[44:45]
  s_cbranch_scc0 K1N2
  v_lshl_add_u32 v48, v22, 2, s34
  v_lshl_add_u32 v48, v30, 16, v48
  ds_max_u32 v6, v48 offset:120
  v_cmpx_gt_u32 vcc, 31, v30
  ds_write_b64 v14, v[40:41] offset:60424
K1N2:
  s_not_b64 exec, s[46:47]
  s_cbranch_scc0 K1N3
  v_lshl_add_u32 v48, v23, 2, s34
  v_lshl_add_u32 v48, v31, 16, v48
  ds_max_u32 v7, v48 offset:120
  v_cmpx_gt_u32 vcc, 31, v31
  ds_write_b64 v15, v[42:43] offset:60424
K1N3:
  s_not_b64 exec, s[48:49]
  s_cbranch_scc0 K1N4
  v_lshl_add_u32 v48, v24, 2, s34
  v_lshl_add_u32 v48, v32, 16, v48
  ds_max_u32 v8, v48 offset:120
  v_cmpx_gt_u32 vcc, 31, v32
  ds_write_b64 v16, v[44:45] offset:60424
K1N4:
  s_mov_b64 exec, s[50:51]
  ds_write_b32 v1, v50
  s_mov_b64 exec, -1
  s_waitcnt lgkmcnt(0)
  s_barrier
  ds_read_b32 v48, v1
  ds_read2_b32 v[56:57], v55 offset0:0 offset1:80
  ds_read2_b32 v[58:59], v55 offset0:160 offset1:240
K1RD:
  ds_read_b128 v[4:7], v2
  ds_read_b128 v[8:11], v2 offset:10240
  ds_read_b128 v[12:15], v2 offset:20480
  ds_read_b128 v[16:19], v2 offset:30720
  s_waitcnt lgkmcnt(3)
  v_cmp_ne_u32 vcc, 0, v48
  s_cbranch_vccnz K1SLOW
  v_cmp_lt_u32 s[40:41], v61, v56
  v_cmp_lt_u32 s[42:43], v61, v57
  v_cmp_lt_u32 s[44:45], v61, v58
  s_mov_b64 exec, s[40:41]
  ds_read_b128 v[64:67], v60
  s_mov_b64 exec, s[42:43]
  ds_read_b128 v[68:71], v60 offset:10240
  s_mov_b64 exec, s[44:45]
  ds_read_b128 v[72:75], v60 offset:20480
  s_mov_b64 exec, -1
  buffer_store_dwordx4 v[4:7], v3, s[20:23], s3 offen sc1
  s_waitcnt lgkmcnt(5)
  buffer_store_dwordx4 v[8:11], v3, s[20:23], s4 offen sc1
  s_waitcnt lgkmcnt(4)
  buffer_store_dwordx4 v[12:15], v3, s[20:23], s5 offen sc1
  s_add_u32 s4, s7, 10240
  s_add_u32 s5, s7, 20480
  s_mov_b64 exec, s[40:41]
  s_waitcnt lgkmcnt(2)
  buffer_store_dwordx4 v[64:67], v2, s[24:27], s7 offen offset:120 sc1
  s_mov_b64 exec, s[42:43]
  s_waitcnt lgkmcnt(1)
  buffer_store_dwordx4 v[68:71], v2, s[24:27], s4 offen offset:120 sc1
  s_mov_b64 exec, s[44:45]
  s_waitcnt lgkmcnt(0)
  buffer_store_dwordx4 v[72:75], v2, s[24:27], s5 offen offset:120 sc1
  s_mov_b64 exec, -1
  s_add_u32 s5, s7, 30720
  s_add_u32 s7, s7, 32888
  s_cmp_ge_u32 s31, 128
  s_cbranch_scc1 K1OV
  ds_read_b128 v[76:79], v60 offset:30720
  buffer_store_dwordx4 v[16:19], v3, s[20:23], s6 offen sc1
  v_cmpx_lt_u32 vcc, v61, v59
  s_waitcnt lgkmcnt(0)
  buffer_store_dwordx4 v[76:79], v2, s[24:27], s5 offen offset:120 sc1
  s_mov_b64 exec, -1
K1OV:
  v_cmpx_gt_u32 vcc, s33, v2
  s_cbranch_execz K1FIN
  ds_read_b128 v[20:23], v2 offset:32768
  s_waitcnt lgkmcnt(0)
  buffer_store_dwordx4 v[20:23], v2, s[24:27], s7 offen sc1
  v_add_u32 v2, 10240, v2
  s_waitcnt vmcnt(0)
  s_branch K1OV
K1FIN:
K1END:
  s_endpgm
K1SLOW:
  v_and_b32 v1, 63, v0
  v_lshlrev_b32 v53, 9, v1
  v_lshlrev_b32 v1, 4, v1
  v_mov_b32 v48, 0xffff0000
  v_mov_b32 v49, 0xf0ff1
  s_waitcnt lgkmcnt(0)
  ds_read_b128 v[4:7], v1 offset:58368
  s_waitcnt lgkmcnt(0)
  v_cmp_lt_u32 s[40:41], 31, v4
  v_subrev_u32 v4, 15, v4
  v_cmp_lt_u32 s[42:43], 31, v5
  v_subrev_u32 v5, 15, v5
  v_cmp_lt_u32 s[44:45], 31, v6
  v_subrev_u32 v6, 15, v6
  v_cmp_lt_u32 s[46:47], 31, v7
  v_subrev_u32 v7, 15, v7
  v_cndmask_b32 v4, 0, v4, s[40:41]
  v_cndmask_b32 v5, 0, v5, s[42:43]
  v_cndmask_b32 v6, 0, v6, s[44:45]
  v_cndmask_b32 v7, 0, v7, s[46:47]
  v_add_u32 v8, v4, v5
  v_add_u32 v9, v8, v6
  v_add_u32 v10, v9, v7
  v_mov_b32 v11, v10
  s_nop 1
  v_add_u32_dpp v11, v11, v11 row_shr:1 row_mask:0xf bank_mask:0xf
  s_nop 1
  v_add_u32_dpp v11, v11, v11 row_shr:2 row_mask:0xf bank_mask:0xf
  s_nop 1
  v_add_u32_dpp v11, v11, v11 row_shr:4 row_mask:0xf bank_mask:0xf
  s_nop 1
  v_add_u32_dpp v11, v11, v11 row_shr:8 row_mask:0xf bank_mask:0xf
  s_nop 1
  v_add_u32_dpp v11, v11, v11 row_bcast:15 row_mask:0xa bank_mask:0xf
  s_nop 1
  v_add_u32_dpp v11, v11, v11 row_bcast:31 row_mask:0xc bank_mask:0xf
  v_cndmask_b32 v16, v48, v49, s[40:41]
  v_cndmask_b32 v17, v48, v49, s[42:43]
  v_cndmask_b32 v18, v48, v49, s[44:45]
  v_cndmask_b32 v19, v48, v49, s[46:47]
  v_sub_u32 v12, v11, v10
  v_add_u32 v13, v12, v4
  v_add_u32 v14, v12, v8
  v_add_u32 v15, v12, v9
  v_readlane_b32 s33, v11, 63
  v_add_u32 v16, v16, v12
  v_add_u32 v17, v17, v13
  v_add_u32 v18, v18, v14
  v_add_u32 v19, v19, v15
  ds_write_b128 v1, v[16:19] offset:59392
  ds_read_b32 v20, v20 offset:59392
  ds_read_b32 v21, v21 offset:59392
  ds_read_b32 v22, v22 offset:59392
  ds_read_b32 v23, v23 offset:59392
  ds_read_b32 v24, v24 offset:59392
  v_lshl_or_b32 v4, v4, 16, v12
  v_add_u32 v4, 4096, v4
  s_mov_b64 exec, s[40:41]
  ds_write_b32 v53, v4 offset:120
  s_mov_b64 exec, -1
  v_lshl_or_b32 v5, v5, 16, v13
  v_add_u32 v5, 4096, v5
  s_mov_b64 exec, s[42:43]
  ds_write_b32 v53, v5 offset:248
  s_mov_b64 exec, -1
  v_lshl_or_b32 v6, v6, 16, v14
  v_add_u32 v6, 4096, v6
  s_mov_b64 exec, s[44:45]
  ds_write_b32 v53, v6 offset:376
  s_mov_b64 exec, -1
  v_lshl_or_b32 v7, v7, 16, v15
  v_add_u32 v7, 4096, v7
  s_mov_b64 exec, s[46:47]
  ds_write_b32 v53, v7 offset:504
  s_mov_b64 exec, -1
  s_waitcnt lgkmcnt(0)
  v_cmp_ge_u32_sdwa vcc, v28, v20 src0_sel:DWORD src1_sel:WORD_1
  v_and_b32 v20, 0xffff, v20
  v_add_lshl_u32 v20, v20, v28, 3
  s_mov_b64 exec, vcc
  ds_write_b64 v20, v[36:37]
  s_mov_b64 exec, -1
  v_cmp_ge_u32_sdwa vcc, v29, v21 src0_sel:DWORD src1_sel:WORD_1
  v_and_b32 v21, 0xffff, v21
  v_add_lshl_u32 v21, v21, v29, 3
  s_mov_b64 exec, vcc
  ds_write_b64 v21, v[38:39]
  s_mov_b64 exec, -1
  v_cmp_ge_u32_sdwa vcc, v30, v22 src0_sel:DWORD src1_sel:WORD_1
  v_and_b32 v22, 0xffff, v22
  v_add_lshl_u32 v22, v22, v30, 3
  s_mov_b64 exec, vcc
  ds_write_b64 v22, v[40:41]
  s_mov_b64 exec, -1
  v_cmp_ge_u32_sdwa vcc, v31, v23 src0_sel:DWORD src1_sel:WORD_1
  v_and_b32 v23, 0xffff, v23
  v_add_lshl_u32 v23, v23, v31, 3
  s_mov_b64 exec, vcc
  ds_write_b64 v23, v[42:43]
  s_mov_b64 exec, -1
  v_cmp_ge_u32_sdwa vcc, v32, v24 src0_sel:DWORD src1_sel:WORD_1
  v_and_b32 v24, 0xffff, v24
  v_add_lshl_u32 v24, v24, v32, 3
  s_mov_b64 exec, vcc
  ds_write_b64 v24, v[44:45]
  s_mov_b64 exec, -1
  s_lshl_b32 s33, s33, 3
  v_mov_b32 v48, 0
  s_waitcnt lgkmcnt(0)
  s_barrier
  s_branch K1RD
WPREP:
  s_load_dwordx4 s[4:7], s[0:1], 40
  v_lshrrev_b32 v2, 6, v0
  v_and_b32 v1, 63, v0
  v_readfirstlane_b32 s31, v2
  s_mov_b32 s28, 0xbfb8aa3b
  s_mov_b32 s29, 0xbfb8aa3b
  s_mov_b32 s30, 0xffff0000
  s_waitcnt lgkmcnt(0)
  s_mov_b32 s12, s4
  s_mov_b32 s13, s5
  s_mov_b32 s14, 18560
  s_mov_b32 s15, 0x20000
  s_mov_b32 s16, s6
  s_mov_b32 s17, s7
  s_mov_b32 s18, 128
  s_mov_b32 s19, 0x20000
  s_add_u32 s20, s8, 23068672
  s_addc_u32 s21, s9, 0
  s_mov_b32 s22, 24576
  s_mov_b32 s23, 0x20000
  v_and_b32 v2, 7, v1
  v_bfe_u32 v3, v1, 4, 1
  v_lshlrev_b32 v4, 2, v3
  v_xor_b32 v4, v4, v2
  v_lshlrev_b32 v4, 4, v4
  v_lshrrev_b32 v5, 3, v1
  v_lshl_or_b32 v4, v5, 7, v4
  s_lshl_b32 s3, s31, 10
  s_add_u32 s4, s3, 10240
  v_add_u32 v4, s3, v4
  s_mov_b32 m0, s3
  s_nop 0
  buffer_load_dwordx4 v4, s[12:15], 0 offen lds
  v_add_u32 v4, 10240, v4
  s_mov_b32 m0, s4
  s_nop 0
  buffer_load_dwordx4 v4, s[12:15], 0 offen lds
  v_lshrrev_b32 v5, 5, v1
  v_lshlrev_b32 v7, 3, v5
  buffer_load_dwordx2 v[28:29], v7, s[16:19], 0 offen offset:0
  buffer_load_dwordx2 v[30:31], v7, s[16:19], 0 offen offset:16
  buffer_load_dwordx2 v[32:33], v7, s[16:19], 0 offen offset:32
  buffer_load_dwordx2 v[34:35], v7, s[16:19], 0 offen offset:48
  buffer_load_dwordx2 v[36:37], v7, s[16:19], 0 offen offset:64
  buffer_load_dwordx2 v[38:39], v7, s[16:19], 0 offen offset:80
  buffer_load_dwordx2 v[40:41], v7, s[16:19], 0 offen offset:96
  buffer_load_dwordx2 v[42:43], v7, s[16:19], 0 offen offset:112
  v_and_b32 v2, 3, v1
  v_bfe_u32 v4, v1, 2, 2
  v_lshlrev_b32 v2, 3, v2
  v_lshl_add_u32 v2, v3, 5, v2
  v_lshl_add_u32 v2, v4, 7, v2
  v_lshl_add_u32 v6, v5, 12, v2
  v_lshrrev_b32 v3, 1, v4
  v_lshl_add_u32 v6, v3, 6, v6
  v_lshl_add_u32 v8, v5, 10, v2
  v_add_u32 v3, 1, v4
  v_bfe_u32 v3, v3, 1, 1
  v_lshl_add_u32 v8, v3, 6, v8
  v_xor_b32 v9, 64, v8
  s_and_b32 s3, s31, 1
  s_lshl_b32 s3, s3, 6
  v_xor_b32 v6, s3, v6
  s_lshr_b32 s3, s31, 1
  s_lshl_b32 s3, s3, 13
  v_add_u32 v6, s3, v6
  v_lshlrev_b32 v10, 4, v1
  s_lshl_b32 s3, s31, 12
  s_waitcnt vmcnt(0)
  s_barrier
  s_cmp_eq_u32 s31, 4
  s_cbranch_scc1 WP4
  s_cmp_eq_u32 s31, 5
  s_cbranch_scc1 WP5
  s_cmp_gt_u32 s31, 5
  s_cbranch_scc1 WPEND
  ds_read_b64_tr_b16 v[12:13], v6 offset:0
  ds_read_b64_tr_b16 v[14:15], v6 offset:512
  ds_read_b64_tr_b16 v[16:17], v6 offset:1024
  ds_read_b64_tr_b16 v[18:19], v6 offset:1536
  ds_read_b64_tr_b16 v[20:21], v6 offset:2048
  ds_read_b64_tr_b16 v[22:23], v6 offset:2560
  ds_read_b64_tr_b16 v[24:25], v6 offset:3072
  ds_read_b64_tr_b16 v[26:27], v6 offset:3584
  s_waitcnt lgkmcnt(0)
  s_cmp_lt_u32 s31, 2
  s_cbranch_scc1 WPST
  v_lshlrev_b32 v2, 16, v12
  v_and_b32 v3, s30, v12
  v_pk_mul_f32 v[2:3], v[2:3], s[28:29]
  v_cvt_pk_bf16_f32 v12, v2, v3
  v_lshlrev_b32 v2, 16, v13
  v_and_b32 v3, s30, v13
  v_pk_mul_f32 v[2:3], v[2:3], s[28:29]
  v_cvt_pk_bf16_f32 v13, v2, v3
  v_lshlrev_b32 v2, 16, v14
  v_and_b32 v3, s30, v14
  v_pk_mul_f32 v[2:3], v[2:3], s[28:29]
  v_cvt_pk_bf16_f32 v14, v2, v3
  v_lshlrev_b32 v2, 16, v15
  v_and_b32 v3, s30, v15
  v_pk_mul_f32 v[2:3], v[2:3], s[28:29]
  v_cvt_pk_bf16_f32 v15, v2, v3
  v_lshlrev_b32 v2, 16, v16
  v_and_b32 v3, s30, v16
  v_pk_mul_f32 v[2:3], v[2:3], s[28:29]
  v_cvt_pk_bf16_f32 v16, v2, v3
  v_lshlrev_b32 v2, 16, v17
  v_and_b32 v3, s30, v17
  v_pk_mul_f32 v[2:3], v[2:3], s[28:29]
  v_cvt_pk_bf16_f32 v17, v2, v3
  v_lshlrev_b32 v2, 16, v18
  v_and_b32 v3, s30, v18
  v_pk_mul_f32 v[2:3], v[2:3], s[28:29]
  v_cvt_pk_bf16_f32 v18, v2, v3
  v_lshlrev_b32 v2, 16, v19
  v_and_b32 v3, s30, v19
  v_pk_mul_f32 v[2:3], v[2:3], s[28:29]
  v_cvt_pk_bf16_f32 v19, v2, v3
  v_lshlrev_b32 v2, 16, v20
  v_and_b32 v3, s30, v20
  v_pk_mul_f32 v[2:3], v[2:3], s[28:29]
  v_cvt_pk_bf16_f32 v20, v2, v3
  v_lshlrev_b32 v2, 16, v21
  v_and_b32 v3, s30, v21
  v_pk_mul_f32 v[2:3], v[2:3], s[28:29]
  v_cvt_pk_bf16_f32 v21, v2, v3
  v_lshlrev_b32 v2, 16, v22
  v_and_b32 v3, s30, v22
  v_pk_mul_f32 v[2:3], v[2:3], s[28:29]
  v_cvt_pk_bf16_f32 v22, v2, v3
  v_lshlrev_b32 v2, 16, v23
  v_and_b32 v3, s30, v23
  v_pk_mul_f32 v[2:3], v[2:3], s[28:29]
  v_cvt_pk_bf16_f32 v23, v2, v3
  v_lshlrev_b32 v2, 16, v24
  v_and_b32 v3, s30, v24
  v_pk_mul_f32 v[2:3], v[2:3], s[28:29]
  v_cvt_pk_bf16_f32 v24, v2, v3
  v_lshlrev_b32 v2, 16, v25
  v_and_b32 v3, s30, v25
  v_pk_mul_f32 v[2:3], v[2:3], s[28:29]
  v_cvt_pk_bf16_f32 v25, v2, v3
  v_lshlrev_b32 v2, 16, v26
  v_and_b32 v3, s30, v26
  v_pk_mul_f32 v[2:3], v[2:3], s[28:29]
  v_cvt_pk_bf16_f32 v26, v2, v3
  v_lshlrev_b32 v2, 16, v27
  v_and_b32 v3, s30, v27
  v_pk_mul_f32 v[2:3], v[2:3], s[28:29]
  v_cvt_pk_bf16_f32 v27, v2, v3
WPST:
  buffer_store_dwordx4 v[12:15], v10, s[20:23], s3 offen offset:0
  buffer_store_dwordx4 v[16:19], v10, s[20:23], s3 offen offset:1024
  buffer_store_dwordx4 v[20:23], v10, s[20:23], s3 offen offset:2048
  buffer_store_dwordx4 v[24:27], v10, s[20:23], s3 offen offset:3072
  s_endpgm
WP4:
  ds_read_b64_tr_b16 v[12:13], v8 offset:16512
  ds_read_b64_tr_b16 v[14:15], v8 offset:17024
  ds_read_b64_tr_b16 v[16:17], v9 offset:16512
  ds_read_b64_tr_b16 v[18:19], v9 offset:17024
  v_and_b32 v2, 31, v1
  v_lshlrev_b32 v2, 1, v2
  ds_read_u16 v20, v2 offset:16384
  ds_read_u16 v21, v2 offset:16448
  v_subrev_u32 v5, 1, v5
  s_waitcnt lgkmcnt(0)
  v_lshlrev_b32 v2, 16, v12
  v_and_b32 v3, s30, v12
  v_pk_mul_f32 v[2:3], v[2:3], s[28:29]
  v_cvt_pk_bf16_f32 v12, v2, v3
  v_lshlrev_b32 v2, 16, v13
  v_and_b32 v3, s30, v13
  v_pk_mul_f32 v[2:3], v[2:3], s[28:29]
  v_cvt_pk_bf16_f32 v13, v2, v3
  v_lshlrev_b32 v2, 16, v14
  v_and_b32 v3, s30, v14
  v_pk_mul_f32 v[2:3], v[2:3], s[28:29]
  v_cvt_pk_bf16_f32 v14, v2, v3
  v_lshlrev_b32 v2, 16, v15
  v_and_b32 v3, s30, v15
  v_pk_mul_f32 v[2:3], v[2:3], s[28:29]
  v_cvt_pk_bf16_f32 v15, v2, v3
  v_lshlrev_b32 v2, 16, v16
  v_and_b32 v3, s30, v16
  v_pk_mul_f32 v[2:3], v[2:3], s[28:29]
  v_cvt_pk_bf16_f32 v16, v2, v3
  v_lshlrev_b32 v2, 16, v17
  v_and_b32 v3, s30, v17
  v_pk_mul_f32 v[2:3], v[2:3], s[28:29]
  v_cvt_pk_bf16_f32 v17, v2, v3
  v_lshlrev_b32 v2, 16, v18
  v_and_b32 v3, s30, v18
  v_pk_mul_f32 v[2:3], v[2:3], s[28:29]
  v_cvt_pk_bf16_f32 v18, v2, v3
  v_lshlrev_b32 v2, 16, v19
  v_and_b32 v3, s30, v19
  v_pk_mul_f32 v[2:3], v[2:3], s[28:29]
  v_cvt_pk_bf16_f32 v19, v2, v3
  v_lshlrev_b32 v20, 16, v20
  v_mul_f32 v20, s28, v20
  v_cvt_pk_f16_f32 v20, v20, 0
  v_and_b32 v20, v5, v20
  v_mov_b32 v22, 0
  v_lshlrev_b32 v21, 16, v21
  v_mul_f32 v21, s28, v21
  v_cvt_pk_f16_f32 v21, v21, 0
  v_and_b32 v21, v5, v21
  v_mov_b32 v23, 0
  buffer_store_dwordx4 v[12:15], v10, s[20:23], s3 offen offset:0
  buffer_store_dwordx4 v[16:19], v10, s[20:23], s3 offen offset:1024
  buffer_store_dwordx4 v[20:23], v10, s[20:23], s3 offen offset:2048
  buffer_store_dwordx4 v[20:23], v10, s[20:23], s3 offen offset:3072
  s_endpgm
WP5:
  v_lshrrev_b32 v4, 2, v1
  v_lshrrev_b32 v8, 4, v1
  v_xor_b32 v4, v4, v8
  v_and_b32 v4, 1, v4
  v_subrev_u32 v4, 1, v4
  v_lshlrev_b32 v2, 16, v28
  v_and_b32 v3, s30, v28
  v_cvt_pk_f16_f32 v2, v2, v3
  v_and_b32 v12, v4, v2
  v_lshlrev_b32 v2, 16, v29
  v_and_b32 v3, s30, v29
  v_cvt_pk_f16_f32 v2, v2, v3
  v_and_b32 v13, v4, v2
  v_lshlrev_b32 v2, 16, v30
  v_and_b32 v3, s30, v30
  v_cvt_pk_f16_f32 v2, v2, v3
  v_and_b32 v14, v4, v2
  v_lshlrev_b32 v2, 16, v31
  v_and_b32 v3, s30, v31
  v_cvt_pk_f16_f32 v2, v2, v3
  v_and_b32 v15, v4, v2
  v_lshlrev_b32 v2, 16, v32
  v_and_b32 v3, s30, v32
  v_cvt_pk_f16_f32 v2, v2, v3
  v_and_b32 v16, v4, v2
  v_lshlrev_b32 v2, 16, v33
  v_and_b32 v3, s30, v33
  v_cvt_pk_f16_f32 v2, v2, v3
  v_and_b32 v17, v4, v2
  v_lshlrev_b32 v2, 16, v34
  v_and_b32 v3, s30, v34
  v_cvt_pk_f16_f32 v2, v2, v3
  v_and_b32 v18, v4, v2
  v_lshlrev_b32 v2, 16, v35
  v_and_b32 v3, s30, v35
  v_cvt_pk_f16_f32 v2, v2, v3
  v_and_b32 v19, v4, v2
  v_lshlrev_b32 v2, 16, v36
  v_and_b32 v3, s30, v36
  v_cvt_pk_f16_f32 v2, v2, v3
  v_and_b32 v20, v4, v2
  v_lshlrev_b32 v2, 16, v37
  v_and_b32 v3, s30, v37
  v_cvt_pk_f16_f32 v2, v2, v3
  v_and_b32 v21, v4, v2
  v_lshlrev_b32 v2, 16, v38
  v_and_b32 v3, s30, v38
  v_cvt_pk_f16_f32 v2, v2, v3
  v_and_b32 v22, v4, v2
  v_lshlrev_b32 v2, 16, v39
  v_and_b32 v3, s30, v39
  v_cvt_pk_f16_f32 v2, v2, v3
  v_and_b32 v23, v4, v2
  v_lshlrev_b32 v2, 16, v40
  v_and_b32 v3, s30, v40
  v_cvt_pk_f16_f32 v2, v2, v3
  v_and_b32 v24, v4, v2
  v_lshlrev_b32 v2, 16, v41
  v_and_b32 v3, s30, v41
  v_cvt_pk_f16_f32 v2, v2, v3
  v_and_b32 v25, v4, v2
  v_lshlrev_b32 v2, 16, v42
  v_and_b32 v3, s30, v42
  v_cvt_pk_f16_f32 v2, v2, v3
  v_and_b32 v26, v4, v2
  v_lshlrev_b32 v2, 16, v43
  v_and_b32 v3, s30, v43
  v_cvt_pk_f16_f32 v2, v2, v3
  v_and_b32 v27, v4, v2
  s_branch WPST
WPEND:
  s_endpgm
.globl main_kernel
.p2align 8
.type main_kernel,@function
main_kernel:
  s_cmp_ge_u32 s2, 256
  s_cbranch_scc1 K2END
  s_load_dwordx2 s[52:53], s[0:1], 80
  s_load_dwordx8 s[32:39], s[0:1], 0
  s_load_dwordx4 s[48:51], s[0:1], 56
  s_and_b32 s3, s2, 7
  s_lshl_b32 s3, s3, 5
  s_lshr_b32 s56, s2, 3
  s_add_u32 s56, s56, s3
  v_lshrrev_b32 v2, 6, v0
  v_and_b32 v0, 63, v0
  v_readfirstlane_b32 s57, v2
  s_mov_b32 s60, 47
  s_mov_b32 s61, 0
  s_mov_b32 s63, 1
  s_mov_b32 s54, 1
  s_movk_i32 s55, 2176
  s_movk_i32 s94, 17404
  s_movk_i32 s95, 0xf0
  s_movk_i32 s64, 128
  s_mov_b32 s65, 0xffff0000
  s_mov_b32 s70, 0xbfb8aa3b
  s_mov_b32 s71, 0xbfb8aa3b
  s_mov_b32 s72, 1.0
  s_mov_b32 s73, 1.0
  s_mov_b32 s74, -1
  s_mov_b32 s75, 0
  s_lshl_b32 s66, s57, 12
  s_add_u32 s66, s66, 81408
  s_lshl_b32 s67, s57, 10
  s_add_u32 s67, s67, 36352
  s_mul_i32 s3, s56, 128
  s_mov_b32 s18, 8191232
  s_mov_b32 s19, 0x20000
  s_waitcnt lgkmcnt(0)
  s_add_u32 s16, s52, s3
  s_addc_u32 s17, s53, 0
ROUND:
  s_lshl_b32 s3, s57, 12
  v_lshl_add_u32 v2, v0, 4, s3
  v_lshrrev_b32 v3, 7, v2
  v_lshl_add_u32 v2, v3, 15, v2
  buffer_load_dwordx4 v[128:131], v2, s[16:19], 0 offen offset:0
  v_add_u32 v2, 262144, v2
  buffer_load_dwordx4 v[132:135], v2, s[16:19], 0 offen offset:1024
  v_add_u32 v2, 262144, v2
  buffer_load_dwordx4 v[136:139], v2, s[16:19], 0 offen offset:2048
  v_add_u32 v2, 262144, v2
  buffer_load_dwordx4 v[140:143], v2, s[16:19], 0 offen offset:3072
  s_and_b32 s3, s57, 3
  s_lshl_b32 s3, s3, 8
  v_lshl_add_u32 v4, v0, 2, s3
  v_mov_b32 v5, 0
  ds_write_b32 v4, v5 offset:34816
  s_cmp_eq_u32 s63, 0
  s_cbranch_scc1 NOTFIRST1
  s_mov_b32 s4, s32
  s_mov_b32 s5, s33
  s_mov_b32 s6, 6400000
  s_mov_b32 s7, 0x20000
  s_mov_b32 s12, s34
  s_mov_b32 s13, s35
  s_mov_b32 s14, 300000
  s_mov_b32 s15, 0x20000
  v_and_b32 v2, 7, v0
  v_bfe_u32 v3, v0, 4, 1
  v_lshrrev_b32 v5, 3, v0
  v_lshrrev_b32 v6, 5, v0
  v_lshl_add_u32 v233, v6, 2, 0
  v_xor_b32 v233, v233, v2
  v_lshlrev_b32 v233, 4, v233
  v_lshl_add_u32 v234, v6, 2, 1
  v_xor_b32 v234, v234, v2
  v_lshlrev_b32 v234, 4, v234
  v_lshl_add_u32 v235, v6, 2, 2
  v_xor_b32 v235, v235, v2
  v_lshlrev_b32 v235, 4, v235
  v_lshl_add_u32 v236, v6, 2, 3
  v_xor_b32 v236, v236, v2
  v_lshlrev_b32 v236, 4, v236
  v_lshl_add_u32 v7, v5, 2, 0
  v_mad_u32_u24 v56, v7, s64, v233
  v_lshl_add_u32 v7, v5, 2, 1
  v_mad_u32_u24 v57, v7, s64, v234
  v_lshl_add_u32 v7, v5, 2, 2
  v_mad_u32_u24 v58, v7, s64, v235
  v_lshl_add_u32 v7, v5, 2, 3
  v_mad_u32_u24 v59, v7, s64, v236
  s_mov_b32 s8, s36
  s_mov_b32 s9, s37
  s_mov_b32 s10, 25600000
  s_mov_b32 s11, 0x20000
  s_mov_b32 s28, s50
  s_mov_b32 s29, s51
  s_mov_b32 s30, 6700000
  s_mov_b32 s31, 0x20000
  s_mov_b32 s24, s48
  s_mov_b32 s25, s49
  s_mov_b32 s26, 16384
  s_mov_b32 s27, 0x20000
  s_add_u32 s20, s52, 8388608
  s_addc_u32 s21, s53, 0
  s_mov_b32 s22, 14704640
  s_mov_b32 s23, 0x20000
  v_lshlrev_b32 v13, 1, v3
  v_xor_b32 v13, v13, v2
  v_lshlrev_b32 v13, 4, v13
  v_lshl_or_b32 v13, v5, 7, v13
  s_lshl_b32 s3, s57, 10
  v_lshl_add_u32 v10, v0, 4, s3
  v_add_u32 v10, 14680064, v10
  v_add_u32 v13, s3, v13
  v_lshlrev_b32 v250, 4, v6
  v_and_b32 v2, 3, v0
  v_bfe_u32 v4, v0, 2, 3
  v_lshl_add_u32 v4, v2, 3, v4
  v_xor_b32 v7, v3, v6
  v_lshlrev_b32 v7, 6, v7
  v_lshl_add_u32 v4, v4, 7, v7
  v_add_u32 v4, s66, v4
  v_xor_b32 v7, 0, v2
  v_lshl_add_u32 v237, v7, 4, v4
  v_xor_b32 v7, 1, v2
  v_lshl_add_u32 v238, v7, 4, v4
  v_xor_b32 v7, 2, v2
  v_lshl_add_u32 v239, v7, 4, v4
  v_xor_b32 v7, 3, v2
  v_lshl_add_u32 v240, v7, 4, v4
  s_add_u32 s3, s67, 32
  v_lshlrev_b32 v7, 5, v6
  v_sub_u32 v241, s3, v7
  s_add_u32 s3, s67, 224
  v_lshl_add_u32 v7, v3, 2, v2
  v_lshlrev_b32 v7, 5, v7
  v_sub_u32 v243, s3, v7
  s_mul_i32 s3, s57, 4608
  s_add_u32 s3, s3, 44544
  v_and_b32 v7, 31, v0
  s_movk_i32 s68, 144
  v_mul_u32_u24 v8, s68, v7
  v_add_u32 v8, s3, v8
  v_lshl_add_u32 v242, v6, 5, v8
  v_bfe_u32 v4, v0, 2, 2
  v_lshl_add_u32 v8, v6, 2, v4
  s_movk_i32 s68, 576
  v_mul_u32_u24 v9, s68, v8
  v_add_u32 v9, s3, v9
  v_xor_b32 v245, v3, v0
  v_and_b32 v245, 1, v245
  v_lshl_add_u32 v245, v245, 3, v9
  v_add_u32 v245, 128, v245
  v_lshl_add_u32 v244, v3, 5, v9
  v_lshl_add_u32 v244, v2, 3, v244
  v_xor_b32 v253, v3, v0
  v_and_b32 v253, 1, v253
  v_lshlrev_b32 v253, 4, v253
  v_xor_b32 v254, v5, v6
  v_and_b32 v254, 1, v254
  v_lshlrev_b32 v254, 4, v254
  v_lshl_add_u32 v254, v7, 5, v254
  s_add_u32 s3, s67, 118784
  v_add_u32 v254, s3, v254
  v_mov_b32 v72, 0
  v_mov_b32 v73, 0
  v_mov_b32 v74, 0x3c00
  v_mov_b32 v75, 0x3c000000
  v_cmp_eq_u32 vcc, 28, v0
  s_nop 1
  v_cndmask_b32 v72, v72, v74, vcc
  v_cmp_eq_u32 vcc, 29, v0
  s_nop 1
  v_cndmask_b32 v72, v72, v75, vcc
  v_cmp_eq_u32 vcc, 30, v0
  s_nop 1
  v_cndmask_b32 v73, v73, v74, vcc
  v_cmp_eq_u32 vcc, 31, v0
  s_nop 1
  v_cndmask_b32 v73, v73, v75, vcc
  v_lshl_add_u32 v9, v0, 3, s67
  ds_write_b64 v9, v[72:73]
  v_mov_b32 v88, 0
  v_mov_b32 v89, 0
  v_mov_b32 v90, 0
  v_mov_b32 v91, 0
  v_mov_b32 v92, 0
  v_mov_b32 v93, 0
  v_mov_b32 v94, 0
  v_mov_b32 v95, 0
  v_mov_b32 v96, 0
  v_mov_b32 v97, 0
  v_mov_b32 v98, 0
  v_mov_b32 v99, 0
  v_mov_b32 v100, 0
  v_mov_b32 v101, 0
  v_mov_b32 v102, 0
  v_mov_b32 v103, 0
  v_mov_b32 v104, 0
  v_mov_b32 v105, 0
  v_mov_b32 v106, 0
  v_mov_b32 v107, 0
  v_mov_b32 v108, 0
  v_mov_b32 v109, 0
  v_mov_b32 v110, 0
  v_mov_b32 v111, 0
  v_mov_b32 v112, 0
  v_mov_b32 v113, 0
  v_mov_b32 v114, 0
  v_mov_b32 v115, 0
  v_mov_b32 v116, 0
  v_mov_b32 v117, 0
  v_mov_b32 v118, 0
  v_mov_b32 v119, 0
  v_mov_b32 v120, 0
  v_mov_b32 v121, 0
  v_mov_b32 v122, 0
  v_mov_b32 v123, 0
  s_branch FIRST1
NOTFIRST1:
  s_waitcnt vmcnt(0)
FIRST1:
  s_lshl_b32 s3, s57, 5
  v_lshrrev_b32 v2, 3, v0
  v_add_u32 v2, s3, v2
  s_mov_b32 s3, 58368
  v_mul_u32_u24 v2, s3, v2
  v_and_b32 v3, 7, v0
  v_lshl_add_u32 v2, v3, 4, v2
  v_lshlrev_b32 v3, 1, v3
  s_sub_i32 s68, s61, 15
  s_add_i32 s69, s68, s60
  s_max_i32 s68, s68, 0
  s_lshl_b32 s3, s68, 3
  v_add_u32 v2, s3, v2
  v_add_u32 v4, s68, v3
  v_mov_b32 v9, 1
  s_waitcnt lgkmcnt(0)
  s_barrier
  s_waitcnt vmcnt(3)
  v_ashrrev_i32 v5, 31, v131
  v_bfi_b32 v5, v5, 0, v130
  s_mov_b32 s3, 0
  v_mov_b32_dpp v6, v5 quad_perm:[3,3,3,3] row_mask:0xf bank_mask:0xf
  s_nop 1
  v_or_b32_dpp v6, v6, v6 row_half_mirror row_mask:0xf bank_mask:0xf
  v_lshrrev_b32 v224, 16, v6
  v_and_b32 v6, 0xffff, v6
  v_lshl_add_u32 v6, v6, 3, v2
  v_add_u32 v220, s3, v6
  v_min_i32 v216, s69, v224
  v_sub_u32 v216, v216, v4
  v_cmp_lt_i32 vcc, 0, v216
  s_nop 1
  v_cndmask_b32 v6, -16, v220, vcc
  buffer_load_dwordx4 v[144:147], v6, s[20:23], 0 offen
  s_waitcnt vmcnt(3)
  v_ashrrev_i32 v5, 31, v135
  v_bfi_b32 v5, v5, 0, v134
  s_mov_b32 s3, 466944
  v_mov_b32_dpp v6, v5 quad_perm:[3,3,3,3] row_mask:0xf bank_mask:0xf
  s_nop 1
  v_or_b32_dpp v6, v6, v6 row_half_mirror row_mask:0xf bank_mask:0xf
  v_lshrrev_b32 v225, 16, v6
  v_and_b32 v6, 0xffff, v6
  v_lshl_add_u32 v6, v6, 3, v2
  v_add_u32 v221, s3, v6
  v_min_i32 v217, s69, v225
  v_sub_u32 v217, v217, v4
  v_cmp_lt_i32 vcc, 0, v217
  s_nop 1
  v_cndmask_b32 v6, -16, v221, vcc
  buffer_load_dwordx4 v[148:151], v6, s[20:23], 0 offen
  s_waitcnt vmcnt(3)
  v_ashrrev_i32 v5, 31, v139
  v_bfi_b32 v5, v5, 0, v138
  s_mov_b32 s3, 933888
  v_mov_b32_dpp v6, v5 quad_perm:[3,3,3,3] row_mask:0xf bank_mask:0xf
  s_nop 1
  v_or_b32_dpp v6, v6, v6 row_half_mirror row_mask:0xf bank_mask:0xf
  v_lshrrev_b32 v226, 16, v6
  v_and_b32 v6, 0xffff, v6
  v_lshl_add_u32 v6, v6, 3, v2
  v_add_u32 v222, s3, v6
  v_min_i32 v218, s69, v226
  v_sub_u32 v218, v218, v4
  v_cmp_lt_i32 vcc, 0, v218
  s_nop 1
  v_cndmask_b32 v6, -16, v222, vcc
  buffer_load_dwordx4 v[152:155], v6, s[20:23], 0 offen
  s_waitcnt vmcnt(3)
  v_ashrrev_i32 v5, 31, v143
  v_bfi_b32 v5, v5, 0, v142
  s_mov_b32 s3, 1400832
  v_mov_b32_dpp v6, v5 quad_perm:[3,3,3,3] row_mask:0xf bank_mask:0xf
  s_nop 1
  v_or_b32_dpp v6, v6, v6 row_half_mirror row_mask:0xf bank_mask:0xf
  v_lshrrev_b32 v227, 16, v6
  v_and_b32 v6, 0xffff, v6
  v_lshl_add_u32 v6, v6, 3, v2
  v_add_u32 v223, s3, v6
  v_min_i32 v219, s69, v227
  v_sub_u32 v219, v219, v4
  v_cmp_lt_i32 vcc, 0, v219
  s_nop 1
  v_cndmask_b32 v6, -16, v223, vcc
  buffer_load_dwordx4 v[156:159], v6, s[20:23], 0 offen
  s_cmp_eq_u32 s63, 0
  s_cbranch_scc1 NOLATE1
  s_lshl_b32 m0, s57, 10
  s_add_u32 m0, m0, 130560
  s_nop 0
  buffer_load_dwordx4 v10, s[20:23], 0 offen lds
  v_add_u32 v10, 0x2000, v10
  s_lshl_b32 m0, s57, 10
  s_add_u32 m0, m0, 138752
  s_nop 0
  buffer_load_dwordx4 v10, s[20:23], 0 offen lds
  v_add_u32 v10, 0x2000, v10
  s_lshl_b32 m0, s57, 10
  s_add_u32 m0, m0, 146944
  s_nop 0
  buffer_load_dwordx4 v10, s[20:23], 0 offen lds
NOLATE1:
  v_max3_i32 v5, v216, v217, v218
  v_max_i32 v5, v5, v219
  v_cmp_lt_i32 s[76:77], 16, v5
  v_max3_i32 v5, v224, v225, v226
  v_max_i32 v5, v5, v227
  s_max_i32 s69, s69, 0
  v_cmp_lt_i32 s[68:69], s69, v5
  s_cmp_eq_u64 s[76:77], 0
  s_cbranch_scc1 NOL2A
  v_cmpx_lt_i32 vcc, 16, v216
  buffer_load_dwordx4 v[160:163], v220, s[20:23], 0 offen offset:128
  s_mov_b64 exec, -1
  v_cmpx_lt_i32 vcc, 16, v217
  buffer_load_dwordx4 v[164:167], v221, s[20:23], 0 offen offset:128
  s_mov_b64 exec, -1
  v_cmpx_lt_i32 vcc, 16, v218
  buffer_load_dwordx4 v[168:171], v222, s[20:23], 0 offen offset:128
  s_mov_b64 exec, -1
  v_cmpx_lt_i32 vcc, 16, v219
  buffer_load_dwordx4 v[172:175], v223, s[20:23], 0 offen offset:128
  s_mov_b64 exec, -1
NOL2A:
  s_cmp_lg_u32 s63, 0
  s_cbranch_scc1 FIRST2
  s_add_u32 s3, s61, s60
  v_add_u32 v5, 0, v3
  v_cmp_le_u32 s[32:33], s3, v5
  v_cmp_gt_u32 s[34:35], s61, v5
  s_or_b64 s[34:35], s[34:35], s[32:33]
  v_cmp_gt_i32 vcc, 0, v129
  s_and_b64 vcc, vcc, s[32:33]
  s_or_b64 s[68:69], s[68:69], vcc
  v_cndmask_b32 v129, v129, 0, s[34:35]
  v_cmp_gt_i32 vcc, 0, v133
  s_and_b64 vcc, vcc, s[32:33]
  s_or_b64 s[68:69], s[68:69], vcc
  v_cndmask_b32 v133, v133, 0, s[34:35]
  v_cmp_gt_i32 vcc, 0, v137
  s_and_b64 vcc, vcc, s[32:33]
  s_or_b64 s[68:69], s[68:69], vcc
  v_cndmask_b32 v137, v137, 0, s[34:35]
  v_cmp_gt_i32 vcc, 0, v141
  s_and_b64 vcc, vcc, s[32:33]
  s_or_b64 s[68:69], s[68:69], vcc
  v_cndmask_b32 v141, v141, 0, s[34:35]
  v_add_u32 v5, 1, v3
  v_cmp_le_u32 s[32:33], s3, v5
  v_cmp_gt_u32 s[34:35], s61, v5
  s_or_b64 s[34:35], s[34:35], s[32:33]
  v_cmp_gt_i32 vcc, 0, v131
  s_and_b64 vcc, vcc, s[32:33]
  s_or_b64 s[68:69], s[68:69], vcc
  v_cndmask_b32 v131, v131, 0, s[34:35]
  v_cmp_gt_i32 vcc, 0, v135
  s_and_b64 vcc, vcc, s[32:33]
  s_or_b64 s[68:69], s[68:69], vcc
  v_cndmask_b32 v135, v135, 0, s[34:35]
  v_cmp_gt_i32 vcc, 0, v139
  s_and_b64 vcc, vcc, s[32:33]
  s_or_b64 s[68:69], s[68:69], vcc
  v_cndmask_b32 v139, v139, 0, s[34:35]
  v_cmp_gt_i32 vcc, 0, v143
  s_and_b64 vcc, vcc, s[32:33]
  s_or_b64 s[68:69], s[68:69], vcc
  v_cndmask_b32 v143, v143, 0, s[34:35]
  s_waitcnt vmcnt(0)
FIRST2:
  s_cmp_eq_u64 s[68:69], 0
  s_cbranch_scc1 NOFLAG
  v_mov_b32 v5, 35328
  ds_write_b32 v5, v5
NOFLAG:
  v_cmp_gt_i32 s[32:33], 0, v129
  v_lshlrev_b32_sdwa v200, 2, v129 dst_sel:DWORD dst_unused:UNUSED_PAD src0_sel:DWORD src1_sel:BYTE_3
  v_cmp_gt_i32 s[34:35], 0, v131
  v_lshlrev_b32_sdwa v201, 2, v131 dst_sel:DWORD dst_unused:UNUSED_PAD src0_sel:DWORD src1_sel:BYTE_3
  v_cmp_gt_i32 s[36:37], 0, v133
  v_lshlrev_b32_sdwa v202, 2, v133 dst_sel:DWORD dst_unused:UNUSED_PAD src0_sel:DWORD src1_sel:BYTE_3
  v_cmp_gt_i32 s[38:39], 0, v135
  v_lshlrev_b32_sdwa v203, 2, v135 dst_sel:DWORD dst_unused:UNUSED_PAD src0_sel:DWORD src1_sel:BYTE_3
  v_cmp_gt_i32 s[40:41], 0, v137
  v_lshlrev_b32_sdwa v204, 2, v137 dst_sel:DWORD dst_unused:UNUSED_PAD src0_sel:DWORD src1_sel:BYTE_3
  v_cmp_gt_i32 s[42:43], 0, v139
  v_lshlrev_b32_sdwa v205, 2, v139 dst_sel:DWORD dst_unused:UNUSED_PAD src0_sel:DWORD src1_sel:BYTE_3
  v_cmp_gt_i32 s[44:45], 0, v141
  v_lshlrev_b32_sdwa v206, 2, v141 dst_sel:DWORD dst_unused:UNUSED_PAD src0_sel:DWORD src1_sel:BYTE_3
  v_cmp_gt_i32 s[46:47], 0, v143
  v_lshlrev_b32_sdwa v207, 2, v143 dst_sel:DWORD dst_unused:UNUSED_PAD src0_sel:DWORD src1_sel:BYTE_3
  s_mov_b64 exec, s[32:33]
  ds_add_rtn_u32 v176, v200, v9 offset:34304
  s_mov_b64 exec, s[34:35]
  ds_add_rtn_u32 v177, v201, v9 offset:34304
  s_mov_b64 exec, s[36:37]
  ds_add_rtn_u32 v178, v202, v9 offset:34304
  s_mov_b64 exec, s[38:39]
  ds_add_rtn_u32 v179, v203, v9 offset:34304
  s_mov_b64 exec, s[40:41]
  ds_add_rtn_u32 v180, v204, v9 offset:34304
  s_mov_b64 exec, s[42:43]
  ds_add_rtn_u32 v181, v205, v9 offset:34304
  s_mov_b64 exec, s[44:45]
  ds_add_rtn_u32 v182, v206, v9 offset:34304
  s_mov_b64 exec, s[46:47]
  ds_add_rtn_u32 v183, v207, v9 offset:34304
  s_mov_b64 exec, -1
  s_cmp_eq_u32 s63, 0
  s_cbranch_scc1 NOLATE2
  s_lshl_b32 m0, s57, 10
  s_add_u32 m0, m0, 114176
  s_nop 0
  buffer_load_dwordx4 v13, s[24:27], 0 offen lds
  v_add_u32 v13, 0x2000, v13
  s_lshl_b32 m0, s57, 10
  s_add_u32 m0, m0, 122368
  s_nop 0
  buffer_load_dwordx4 v13, s[24:27], 0 offen lds
NOLATE2:
  v_lshlrev_b32 v2, 2, v0
  v_lshrrev_b32 v8, 4, v0
  v_mul_u32_u24 v8, 544, v8
  v_and_b32 v3, 0x30, v0
  v_add_u32 v3, 35456, v3
  v_cmp_lt_i32 s[48:49], 0, v216
  v_cmp_lt_i32 s[50:51], 1, v216
  v_cmp_lt_i32 s[52:53], 0, v217
  v_cmp_lt_i32 s[96:97], 1, v217
  v_cmp_lt_i32 s[98:99], 0, v218
  v_cmp_lt_i32 s[100:101], 1, v218
  v_cmp_lt_i32 s[68:69], 0, v219
  s_waitcnt lgkmcnt(0)
  s_barrier
  ds_read2st64_b32 v[4:5], v2 offset0:136 offset1:137
  s_waitcnt lgkmcnt(0)
  v_mov_b32 v6, v4
  v_mov_b32 v7, v5
  s_nop 0
  v_add_u32_dpp v6, v6, v6 row_shr:1 row_mask:0xf bank_mask:0xf
  v_add_u32_dpp v7, v7, v7 row_shr:1 row_mask:0xf bank_mask:0xf
  s_nop 0
  v_add_u32_dpp v6, v6, v6 row_shr:2 row_mask:0xf bank_mask:0xf
  v_add_u32_dpp v7, v7, v7 row_shr:2 row_mask:0xf bank_mask:0xf
  s_nop 0
  v_add_u32_dpp v6, v6, v6 row_shr:4 row_mask:0xf bank_mask:0xf
  v_add_u32_dpp v7, v7, v7 row_shr:4 row_mask:0xf bank_mask:0xf
  s_nop 0
  v_add_u32_dpp v6, v6, v6 row_shr:8 row_mask:0xf bank_mask:0xf
  v_add_u32_dpp v7, v7, v7 row_shr:8 row_mask:0xf bank_mask:0xf
  v_sub_u32 v6, v6, v4
  v_sub_u32 v7, v7, v5
  v_add_u32 v4, v6, v8
  v_add3_u32 v5, v7, v8, s55
  ds_write2st64_b32 v2, v4, v5 offset0:140 offset1:141
  v_max_u32 v8, v6, v7
  v_cmp_lt_u32 vcc, 0x200, v8
  s_mov_b32 exec_lo, 0x80008000
  s_mov_b32 exec_hi, 0x80008000
  ds_write2_b32 v3, v4, v5 offset0:1 offset1:17
  s_mov_b64 exec, -1
  v_mov_b32 v8, 1
  v_mov_b32 v9, 0
  s_cbranch_vccz NOOVF1
  s_mov_b64 s[32:33], 0
  s_mov_b64 s[34:35], 0
  s_mov_b64 s[36:37], 0
  s_mov_b64 s[38:39], 0
  s_mov_b64 s[40:41], 0
  s_mov_b64 s[42:43], 0
  s_mov_b64 s[44:45], 0
  s_mov_b64 s[46:47], 0
NOOVF1:
  v_cmp_lt_i32 vcc, 1, v219
  s_waitcnt vmcnt(5)
  v_and_b32_sdwa v208, s95, v145 dst_sel:DWORD dst_unused:UNUSED_PAD src0_sel:DWORD src1_sel:BYTE_3
  v_and_b32_sdwa v209, s95, v147 dst_sel:DWORD dst_unused:UNUSED_PAD src0_sel:DWORD src1_sel:BYTE_3
  v_and_b32_sdwa v210, s95, v149 dst_sel:DWORD dst_unused:UNUSED_PAD src0_sel:DWORD src1_sel:BYTE_3
  v_and_b32_sdwa v211, s95, v151 dst_sel:DWORD dst_unused:UNUSED_PAD src0_sel:DWORD src1_sel:BYTE_3
  v_and_b32_sdwa v212, s95, v153 dst_sel:DWORD dst_unused:UNUSED_PAD src0_sel:DWORD src1_sel:BYTE_3
  v_and_b32_sdwa v213, s95, v155 dst_sel:DWORD dst_unused:UNUSED_PAD src0_sel:DWORD src1_sel:BYTE_3
  v_and_b32_sdwa v214, s95, v157 dst_sel:DWORD dst_unused:UNUSED_PAD src0_sel:DWORD src1_sel:BYTE_3
  v_and_b32_sdwa v215, s95, v159 dst_sel:DWORD dst_unused:UNUSED_PAD src0_sel:DWORD src1_sel:BYTE_3
  s_mov_b64 exec, s[48:49]
  ds_add_rtn_u64 v[184:185], v208, v[8:9] offset:35328
  s_mov_b64 exec, s[50:51]
  ds_add_rtn_u64 v[186:187], v209, v[8:9] offset:35328
  s_mov_b64 exec, s[52:53]
  ds_add_rtn_u64 v[188:189], v210, v[8:9] offset:35328
  s_mov_b64 exec, s[96:97]
  ds_add_rtn_u64 v[190:191], v211, v[8:9] offset:35328
  s_mov_b64 exec, s[98:99]
  ds_add_rtn_u64 v[192:193], v212, v[8:9] offset:35328
  s_mov_b64 exec, s[100:101]
  ds_add_rtn_u64 v[194:195], v213, v[8:9] offset:35328
  s_mov_b64 exec, s[68:69]
  ds_add_rtn_u64 v[196:197], v214, v[8:9] offset:35328
  s_mov_b64 exec, vcc
  ds_add_rtn_u64 v[198:199], v215, v[8:9] offset:35328
  s_mov_b64 exec, -1
  ds_read_b32 v200, v200 offset:35328
  ds_read_b32 v201, v201 offset:35328
  ds_read_b32 v202, v202 offset:35328
  ds_read_b32 v203, v203 offset:35328
  ds_read_b32 v204, v204 offset:35328
  ds_read_b32 v205, v205 offset:35328
  ds_read_b32 v206, v206 offset:35328
  ds_read_b32 v207, v207 offset:35328
  s_cmp_eq_u32 s63, 0
  s_cbranch_scc1 NOPERM
  v_mov_b32 v2, v6
  s_sub_u32 s3, 11, s57
  s_nop 0
  v_mov_b32_dpp v2, v7 row_shl:1 row_mask:0xf bank_mask:0xf
  s_cmp_lt_u32 s57, 4
  v_lshl_or_b32 v2, v2, 6, v0
  s_cselect_b32 s3, s57, s3
  s_mov_b32 s2, 7
  v_readlane_b32 s80, v2, 15
  v_readlane_b32 s82, v2, 31
  v_readlane_b32 s84, v2, 47
  v_readlane_b32 s86, v2, 63
  v_readlane_b32 s88, v2, 14
  v_readlane_b32 s90, v2, 30
  v_readlane_b32 s92, v2, 46
  s_mov_b32 exec_lo, 0xc000c000
  s_mov_b32 exec_hi, 0xc000c000
  v_cmp_lt_u32 s[80:81], s80, v2
  v_cmp_lt_u32 s[82:83], s82, v2
  v_cmp_lt_u32 s[84:85], s84, v2
  v_cmp_lt_u32 s[86:87], s86, v2
  v_cmp_lt_u32 s[88:89], s88, v2
  v_cmp_lt_u32 s[90:91], s90, v2
  v_cmp_lt_u32 s[92:93], s92, v2
  s_mov_b64 exec, -1
  s_bcnt1_i32_b64 s80, s[80:81]
  s_cmp_eq_u32 s80, s3
  s_cselect_b32 s2, 0, s2
  s_bcnt1_i32_b64 s82, s[82:83]
  s_cmp_eq_u32 s82, s3
  s_cselect_b32 s2, 1, s2
  s_bcnt1_i32_b64 s84, s[84:85]
  s_cmp_eq_u32 s84, s3
  s_cselect_b32 s2, 2, s2
  s_bcnt1_i32_b64 s86, s[86:87]
  s_cmp_eq_u32 s86, s3
  s_cselect_b32 s2, 3, s2
  s_bcnt1_i32_b64 s88, s[88:89]
  s_cmp_eq_u32 s88, s3
  s_cselect_b32 s2, 4, s2
  s_bcnt1_i32_b64 s90, s[90:91]
  s_cmp_eq_u32 s90, s3
  s_cselect_b32 s2, 5, s2
  s_bcnt1_i32_b64 s92, s[92:93]
  s_cmp_eq_u32 s92, s3
  s_cselect_b32 s2, 6, s2
  s_lshl_b32 s3, s56, 3
  s_add_u32 s3, s3, s2
  s_mul_i32 s3, s3, 3125
  s_add_u32 s58, s3, 127
  s_lshr_b32 s58, s58, 7
  s_add_u32 s3, s3, 3252
  s_lshr_b32 s3, s3, 7
  s_sub_u32 s3, s3, s58
  s_bfm_b32 s78, s3, 0
  s_lshl_b32 s3, s58, 7
  v_add_u32 v12, s58, v0
  v_add_u32 v56, s3, v56
  v_add_u32 v57, s3, v57
  v_add_u32 v58, s3, v58
  v_add_u32 v59, s3, v59
  v_mul_u32_u24 v11, 6, v12
  v_and_b32 v11, -4, v11
NOPERM:
  s_cmp_eq_u32 s63, 0
  s_cbranch_scc1 NOLATE4
  s_mul_i32 m0, s57, 4608
  s_add_u32 m0, m0, 44544
  s_nop 0
  buffer_load_dwordx4 v56, s[4:7], 0 offen lds
  s_mul_i32 m0, s57, 4608
  s_add_u32 m0, m0, 45568
  s_nop 0
  buffer_load_dwordx4 v57, s[4:7], 0 offen lds
NOLATE4:
  s_mul_i32 s3, s2, 2176
  v_lshrrev_b32 v2, 3, v0
  v_lshl_add_u32 v246, v2, 4, s3
  v_and_b32 v2, 31, v0
  v_lshl_add_u32 v247, v2, 2, s3
  v_bfe_u32 v2, v0, 2, 2
  v_lshl_add_u32 v2, v2, 4, s3
  v_lshl_add_u32 v248, v250, 2, v2
  v_lshrrev_b32 v2, 1, v0
  v_lshl_add_u32 v252, v2, 2, s3
  v_mov_b32 v2, 35328
  s_waitcnt lgkmcnt(8)
  v_add_lshl_u32 v208, v184, v185, 2
  v_min_u32 v208, s94, v208
  v_add_lshl_u32 v209, v186, v187, 2
  v_min_u32 v209, s94, v209
  v_add_lshl_u32 v210, v188, v189, 2
  v_min_u32 v210, s94, v210
  v_add_lshl_u32 v211, v190, v191, 2
  v_min_u32 v211, s94, v211
  v_add_lshl_u32 v212, v192, v193, 2
  v_min_u32 v212, s94, v212
  v_add_lshl_u32 v213, v194, v195, 2
  v_min_u32 v213, s94, v213
  v_add_lshl_u32 v214, v196, v197, 2
  v_min_u32 v214, s94, v214
  v_add_lshl_u32 v215, v198, v199, 2
  v_min_u32 v215, s94, v215
  s_waitcnt lgkmcnt(6)
  v_add_lshl_u32 v200, v200, v176, 2
  v_add_lshl_u32 v201, v201, v177, 2
  s_waitcnt lgkmcnt(4)
  v_add_lshl_u32 v202, v202, v178, 2
  v_add_lshl_u32 v203, v203, v179, 2
  s_waitcnt lgkmcnt(2)
  v_add_lshl_u32 v204, v204, v180, 2
  v_add_lshl_u32 v205, v205, v181, 2
  s_waitcnt lgkmcnt(0)
  v_add_lshl_u32 v206, v206, v182, 2
  v_add_lshl_u32 v207, v207, v183, 2
  s_mov_b64 exec, s[32:33]
  ds_write2st64_b32 v200, v128, v129 offset0:0 offset1:68
  s_mov_b64 exec, s[34:35]
  ds_write2st64_b32 v201, v130, v131 offset0:0 offset1:68
  s_mov_b64 exec, s[36:37]
  ds_write2st64_b32 v202, v132, v133 offset0:0 offset1:68
  s_mov_b64 exec, s[38:39]
  ds_write2st64_b32 v203, v134, v135 offset0:0 offset1:68
  s_mov_b64 exec, -1
  s_cmp_eq_u32 s63, 0
  s_cbranch_scc1 NOLATE5
  s_mul_i32 m0, s57, 4608
  s_add_u32 m0, m0, 46592
  s_nop 0
  buffer_load_dwordx4 v58, s[4:7], 0 offen lds
NOLATE5:
  s_mov_b64 exec, s[40:41]
  ds_write2st64_b32 v204, v136, v137 offset0:0 offset1:68
  s_mov_b64 exec, s[42:43]
  ds_write2st64_b32 v205, v138, v139 offset0:0 offset1:68
  s_mov_b64 exec, s[44:45]
  ds_write2st64_b32 v206, v140, v141 offset0:0 offset1:68
  s_mov_b64 exec, s[46:47]
  ds_write2st64_b32 v207, v142, v143 offset0:0 offset1:68
  s_mov_b64 exec, -1
  s_cmp_eq_u32 s63, 0
  s_cbranch_scc1 NOLATE6
  s_mul_i32 m0, s57, 4608
  s_add_u32 m0, m0, 47616
  s_nop 0
  buffer_load_dwordx4 v59, s[4:7], 0 offen lds
NOLATE6:
  s_mov_b64 exec, s[48:49]
  ds_write2st64_b32 v208, v144, v145 offset0:0 offset1:68
  s_mov_b64 exec, s[50:51]
  ds_write2st64_b32 v209, v146, v147 offset0:0 offset1:68
  s_mov_b64 exec, s[52:53]
  ds_write2st64_b32 v210, v148, v149 offset0:0 offset1:68
  s_mov_b64 exec, s[96:97]
  ds_write2st64_b32 v211, v150, v151 offset0:0 offset1:68
  s_mov_b64 exec, s[98:99]
  ds_write2st64_b32 v212, v152, v153 offset0:0 offset1:68
  s_mov_b64 exec, s[100:101]
  ds_write2st64_b32 v213, v154, v155 offset0:0 offset1:68
  s_mov_b64 exec, s[68:69]
  ds_write2st64_b32 v214, v156, v157 offset0:0 offset1:68
  s_mov_b64 exec, vcc
  ds_write2st64_b32 v215, v158, v159 offset0:0 offset1:68
  s_mov_b64 exec, -1
  s_cmp_eq_u64 s[76:77], 0
  s_cbranch_scc1 NOL2B
  s_waitcnt vmcnt(0) lgkmcnt(0)
  v_cmpx_lt_i32 vcc, 16, v216
  v_and_b32_sdwa v208, s95, v161 dst_sel:DWORD dst_unused:UNUSED_PAD src0_sel:DWORD src1_sel:BYTE_3
  ds_add_rtn_u64 v[184:185], v208, v[8:9] offset:35328
  v_cmpx_lt_i32 vcc, 17, v216
  v_and_b32_sdwa v209, s95, v163 dst_sel:DWORD dst_unused:UNUSED_PAD src0_sel:DWORD src1_sel:BYTE_3
  ds_add_rtn_u64 v[186:187], v209, v[8:9] offset:35328
  s_mov_b64 exec, -1
  v_cmpx_lt_i32 vcc, 16, v217
  v_and_b32_sdwa v210, s95, v165 dst_sel:DWORD dst_unused:UNUSED_PAD src0_sel:DWORD src1_sel:BYTE_3
  ds_add_rtn_u64 v[188:189], v210, v[8:9] offset:35328
  v_cmpx_lt_i32 vcc, 17, v217
  v_and_b32_sdwa v211, s95, v167 dst_sel:DWORD dst_unused:UNUSED_PAD src0_sel:DWORD src1_sel:BYTE_3
  ds_add_rtn_u64 v[190:191], v211, v[8:9] offset:35328
  s_mov_b64 exec, -1
  v_cmpx_lt_i32 vcc, 16, v218
  v_and_b32_sdwa v212, s95, v169 dst_sel:DWORD dst_unused:UNUSED_PAD src0_sel:DWORD src1_sel:BYTE_3
  ds_add_rtn_u64 v[192:193], v212, v[8:9] offset:35328
  v_cmpx_lt_i32 vcc, 17, v218
  v_and_b32_sdwa v213, s95, v171 dst_sel:DWORD dst_unused:UNUSED_PAD src0_sel:DWORD src1_sel:BYTE_3
  ds_add_rtn_u64 v[194:195], v213, v[8:9] offset:35328
  s_mov_b64 exec, -1
  v_cmpx_lt_i32 vcc, 16, v219
  v_and_b32_sdwa v214, s95, v173 dst_sel:DWORD dst_unused:UNUSED_PAD src0_sel:DWORD src1_sel:BYTE_3
  ds_add_rtn_u64 v[196:197], v214, v[8:9] offset:35328
  v_cmpx_lt_i32 vcc, 17, v219
  v_and_b32_sdwa v215, s95, v175 dst_sel:DWORD dst_unused:UNUSED_PAD src0_sel:DWORD src1_sel:BYTE_3
  ds_add_rtn_u64 v[198:199], v215, v[8:9] offset:35328
  s_mov_b64 exec, -1
  s_waitcnt lgkmcnt(0)
  v_cmpx_lt_i32 vcc, 16, v216
  v_add_lshl_u32 v208, v184, v185, 2
  v_min_u32 v208, s94, v208
  ds_write2st64_b32 v208, v160, v161 offset0:0 offset1:68
  v_cmpx_lt_i32 vcc, 17, v216
  v_add_lshl_u32 v209, v186, v187, 2
  v_min_u32 v209, s94, v209
  ds_write2st64_b32 v209, v162, v163 offset0:0 offset1:68
  s_mov_b64 exec, -1
  v_cmpx_lt_i32 vcc, 16, v217
  v_add_lshl_u32 v210, v188, v189, 2
  v_min_u32 v210, s94, v210
  ds_write2st64_b32 v210, v164, v165 offset0:0 offset1:68
  v_cmpx_lt_i32 vcc, 17, v217
  v_add_lshl_u32 v211, v190, v191, 2
  v_min_u32 v211, s94, v211
  ds_write2st64_b32 v211, v166, v167 offset0:0 offset1:68
  s_mov_b64 exec, -1
  v_cmpx_lt_i32 vcc, 16, v218
  v_add_lshl_u32 v212, v192, v193, 2
  v_min_u32 v212, s94, v212
  ds_write2st64_b32 v212, v168, v169 offset0:0 offset1:68
  v_cmpx_lt_i32 vcc, 17, v218
  v_add_lshl_u32 v213, v194, v195, 2
  v_min_u32 v213, s94, v213
  ds_write2st64_b32 v213, v170, v171 offset0:0 offset1:68
  s_mov_b64 exec, -1
  v_cmpx_lt_i32 vcc, 16, v219
  v_add_lshl_u32 v214, v196, v197, 2
  v_min_u32 v214, s94, v214
  ds_write2st64_b32 v214, v172, v173 offset0:0 offset1:68
  v_cmpx_lt_i32 vcc, 17, v219
  v_add_lshl_u32 v215, v198, v199, 2
  v_min_u32 v215, s94, v215
  ds_write2st64_b32 v215, v174, v175 offset0:0 offset1:68
  s_mov_b64 exec, -1
NOL2B:
  s_cmp_eq_u32 s63, 0
  s_cbranch_scc1 NOLATE7
  buffer_load_dwordx2 v[124:125], v11, s[12:15], 0 offen
NOLATE7:
  s_mov_b32 s63, 0
  v_mov_b32 v224, 0
  v_mov_b32 v225, 0
  v_mov_b32 v226, 0
  v_mov_b32 v227, 0
  s_and_b32 s62, s2, 3
  s_lshl_b32 s62, s62, 4
  s_add_u32 s62, s62, 15
  s_waitcnt vmcnt(5) lgkmcnt(0)
  s_barrier
  ds_read2_b32 v[4:5], v3 offset0:0 offset1:16
  ds_read_b32 v8, v2
  ds_read_b128 v[220:223], v246 offset:0
  ds_read_b32 v228, v247 offset:0
  ds_read_b32 v1, v252 offset:17408
  s_waitcnt lgkmcnt(3)
  v_add_u32 v6, v6, v4
  v_add_u32 v7, v7, v5
  v_max_u32 v4, v6, v7
  v_cmp_lt_u32 vcc, 0x200, v4
  v_readlane_b32 s68, v6, s62
  v_readlane_b32 s69, v7, s62
  v_readfirstlane_b32 s62, v8
  s_cbranch_vccz NOOVF
  s_lshr_b32 s60, s60, 1
  s_waitcnt vmcnt(0) lgkmcnt(0)
  s_barrier
  s_branch ROUND
NOOVF:
  s_cmp_ge_u32 s2, 4
  s_cselect_b32 s68, s69, s68
  s_add_u32 s59, s68, 31
  s_lshr_b32 s59, s59, 5
  v_add_u32 v2, s68, v0
  s_lshl_b32 s69, s59, 5
  v_lshl_add_u32 v3, v2, 2, s3
  s_sub_u32 s3, s58, s69
  v_add_u32 v4, s3, v2
  v_mov_b32 v5, 0xffff
  v_cmp_gt_u32 vcc, s69, v2
  s_nop 1
  v_cndmask_b32 v4, v4, v5, vcc
  v_or_b32 v4, 0xf8000000, v4
  v_mov_b32 v5, 0x00ffffff
  s_add_u32 s69, s69, 32
  v_cmpx_gt_u32 vcc, s69, v2
  ds_write2st64_b32 v3, v4, v5 offset0:0 offset1:68
  s_mov_b64 exec, -1
  s_cmp_ge_u32 s68, 32
  s_cbranch_scc1 FULL0
  ds_read_b128 v[220:223], v246 offset:0
  ds_read_b32 v228, v247 offset:0
  ds_read_b32 v1, v252 offset:17408
  s_waitcnt lgkmcnt(0)
FULL0:
  s_waitcnt lgkmcnt(1)
  s_cmp_gt_i32 s59, -1
  s_cselect_b32 s6, 6400000, 0
  s_cselect_b32 s10, 25600000, 0
  s_cselect_b32 s14, 300000, 0
  s_add_u32 m0, s67, 118784
  v_mad_u32_u24 v1, v1, 32, v253
  buffer_load_dwordx4 v1, s[8:11], 0 offen  lds
  s_add_u32 m0, s66, 0
  v_mad_u32_u24 v220, v220, s64, v233
  buffer_load_dwordx4 v220, s[4:7], 0 offen  lds
  s_add_u32 m0, s66, 1024
  v_mad_u32_u24 v221, v221, s64, v234
  buffer_load_dwordx4 v221, s[4:7], 0 offen  lds
  s_add_u32 m0, s66, 2048
  v_mad_u32_u24 v222, v222, s64, v235
  buffer_load_dwordx4 v222, s[4:7], 0 offen  lds
  s_add_u32 m0, s66, 3072
  v_mad_u32_u24 v223, v223, s64, v236
  buffer_load_dwordx4 v223, s[4:7], 0 offen  lds
  v_mul_u32_u24 v1, 6, v228
  v_and_b32 v1, -4, v1
  s_mov_b64 exec, s[74:75]
  buffer_load_dwordx2 v[224:225], v1, s[12:15], 0 offen
  s_mov_b64 exec, -1
  ds_read_b128 v[220:223], v246 offset:128
  ds_read_b32 v229, v247 offset:128
  ds_read_b32 v1, v252 offset:17536
  s_waitcnt lgkmcnt(0)
  s_cmp_eq_u32 s54, 0
  s_cbranch_scc1 NOINIT2
  v_lshlrev_b32 v2, 4, v0
  v_add_u32 v2, 130560, v2
  s_lshl_b32 s3, s57, 9
  s_sub_u32 s3, s3, 36864
  s_waitcnt vmcnt(6)
  v_add_u32 v6, s3, v237
  ds_read_b128 v[200:203], v6
  v_add_u32 v7, s3, v238
  ds_read_b128 v[204:207], v7
  v_add_u32 v8, s3, v239
  ds_read_b128 v[208:211], v8
  v_add_u32 v9, s3, v240
  ds_read_b128 v[212:215], v9
  ds_read_b128 v[128:131], v2 offset:0
  ds_read_b128 v[132:135], v2 offset:1024
  ds_read_b128 v[136:139], v2 offset:2048
  ds_read_b128 v[140:143], v2 offset:3072
  ds_read_b128 v[144:147], v2 offset:4096
  ds_read_b128 v[148:151], v2 offset:5120
  ds_read_b128 v[152:155], v2 offset:6144
  ds_read_b128 v[156:159], v2 offset:7168
  ds_read_b64 v[4:5], v2 offset:18432
  ds_read_b128 v[16:19], v2 offset:8192
  ds_read_b128 v[20:23], v2 offset:9216
  ds_read_b128 v[24:27], v2 offset:10240
  ds_read_b128 v[28:31], v2 offset:11264
  ds_read_b128 v[32:35], v2 offset:12288
  ds_read_b128 v[36:39], v2 offset:13312
  ds_read_b128 v[40:43], v2 offset:14336
  ds_read_b128 v[44:47], v2 offset:15360
  ds_read_b128 v[48:51], v2 offset:16384
  ds_read_b128 v[52:55], v2 offset:17408
  ds_read_b128 v[72:75], v2 offset:20480
  ds_read_b128 v[76:79], v2 offset:21504
  ds_read_b128 v[80:83], v2 offset:22528
  ds_read_b128 v[84:87], v2 offset:23552
  v_lshlrev_b32 v7, 4, v12
  v_alignbit_b32 v8, v125, v124, v7
  v_lshrrev_b32 v9, v7, v125
  v_lshlrev_b32 v6, 16, v8
  v_and_b32 v7, s65, v8
  v_lshlrev_b32 v8, 16, v9
  v_lshl_add_u32 v9, v0, 3, s67
  s_mov_b64 exec, s[74:75]
  ds_write_b64 v9, v[6:7] offset:512
  ds_write_b32 v9, v8 offset:768
  s_mov_b64 exec, -1
  s_waitcnt lgkmcnt(15)
  v_mfma_f32_32x32x16_bf16 v[160:175], v[200:203], v[128:131], 0
  v_mfma_f32_32x32x16_bf16 v[176:191], v[200:203], v[144:147], 0
  v_mfma_f32_32x32x16_bf16 v[160:175], v[204:207], v[132:135], v[160:175]
  v_mfma_f32_32x32x16_bf16 v[176:191], v[204:207], v[148:151], v[176:191]
  v_mfma_f32_32x32x16_bf16 v[160:175], v[208:211], v[136:139], v[160:175]
  v_mfma_f32_32x32x16_bf16 v[176:191], v[208:211], v[152:155], v[176:191]
  v_mfma_f32_32x32x16_bf16 v[160:175], v[212:215], v[140:143], v[160:175]
  v_mfma_f32_32x32x16_bf16 v[176:191], v[212:215], v[156:159], v[176:191]
  s_waitcnt lgkmcnt(0)
  s_mov_b32 s54, 0
  s_nop 7
  s_nop 0
  v_pk_mul_f32 v[160:161], v[160:161], s[70:71]
  v_cvt_pk_f16_f32 v56, v160, v161
  v_pk_mul_f32 v[162:163], v[162:163], s[70:71]
  v_cvt_pk_f16_f32 v57, v162, v163
  v_pk_mul_f32 v[164:165], v[164:165], s[70:71]
  v_cvt_pk_f16_f32 v58, v164, v165
  v_pk_mul_f32 v[166:167], v[166:167], s[70:71]
  v_cvt_pk_f16_f32 v59, v166, v167
  v_pk_mul_f32 v[168:169], v[168:169], s[70:71]
  v_cvt_pk_f16_f32 v60, v168, v169
  v_pk_mul_f32 v[170:171], v[170:171], s[70:71]
  v_cvt_pk_f16_f32 v61, v170, v171
  v_pk_mul_f32 v[172:173], v[172:173], s[70:71]
  v_cvt_pk_f16_f32 v62, v172, v173
  v_pk_mul_f32 v[176:177], v[176:177], s[70:71]
  v_cvt_pk_f16_f32 v64, v176, v177
  v_pk_mul_f32 v[178:179], v[178:179], s[70:71]
  v_cvt_pk_f16_f32 v65, v178, v179
  v_pk_mul_f32 v[180:181], v[180:181], s[70:71]
  v_cvt_pk_f16_f32 v66, v180, v181
  v_pk_mul_f32 v[182:183], v[182:183], s[70:71]
  v_cvt_pk_f16_f32 v67, v182, v183
  v_pk_mul_f32 v[184:185], v[184:185], s[70:71]
  v_cvt_pk_f16_f32 v68, v184, v185
  v_pk_mul_f32 v[186:187], v[186:187], s[70:71]
  v_cvt_pk_f16_f32 v69, v186, v187
  v_pk_mul_f32 v[188:189], v[188:189], s[70:71]
  v_cvt_pk_f16_f32 v70, v188, v189
  v_mov_b32 v63, v4
  v_mov_b32 v71, v5
NOINIT2:
  v_mov_b32 v184, 0
  v_mov_b32 v168, 0
  v_mov_b32 v185, 0
  v_mov_b32 v169, 0
  v_mov_b32 v186, 0
  v_mov_b32 v170, 0
  v_mov_b32 v187, 0
  v_mov_b32 v171, 0
  v_mov_b32 v188, 0
  v_mov_b32 v172, 0
  v_mov_b32 v189, 0
  v_mov_b32 v173, 0
  v_mov_b32 v190, 0
  v_mov_b32 v174, 0
  v_mov_b32 v191, 0
  v_mov_b32 v175, 0
  v_mov_b32 v124, 0
  v_mov_b32 v125, 0
  v_mov_b32 v126, 0
  v_mov_b32 v127, 0
  v_mov_b32 v13, 0
  v_mov_b32 v14, 0
  v_mov_b32 v15, 0
  s_mul_i32 s3, s57, 4608
  s_add_u32 s3, s3, 44544
  v_lshl_add_u32 v2, v0, 3, s3
  ds_write_b64 v2, v[184:185] offset:0
  ds_write_b64 v2, v[184:185] offset:512
  ds_write_b64 v2, v[184:185] offset:1024
  ds_write_b64 v2, v[184:185] offset:1536
  ds_write_b64 v2, v[184:185] offset:2048
  ds_write_b64 v2, v[184:185] offset:2560
  ds_write_b64 v2, v[184:185] offset:3072
  ds_write_b64 v2, v[184:185] offset:3584
  ds_write_b64 v2, v[184:185] offset:4096
  s_waitcnt vmcnt(0)
  ds_read_b128 v[216:219], v254
  ds_read_b128 v[200:203], v237
  ds_read_b128 v[204:207], v238
  ds_read_b128 v[208:211], v239
  ds_read_b128 v[212:215], v240
  v_add_u32_sdwa v249, v241, v228 dst_sel:DWORD dst_unused:UNUSED_PAD src0_sel:DWORD src1_sel:BYTE_3
  ds_read_b64 v[230:231], v249 offset:480
  ds_read_b32 v232, v249 offset:736
  v_lshlrev_b32 v125, 4, v228
  v_alignbit_b32 v126, v225, v224, v125
  v_lshrrev_b32 v127, v125, v225
  ds_read_b64 v[176:177], v249 offset:192
  ds_read_b64 v[178:179], v249 offset:128
  ds_read_b64 v[180:181], v249 offset:64
  ds_read_b32 v182, v249
  s_waitcnt lgkmcnt(10)
  v_mfma_f32_32x32x16_bf16 v[128:143], v[48:51], v[216:219], 0
  v_mfma_f32_32x32x16_bf16 v[144:159], v[52:55], v[216:219], 0
  v_lshlrev_b32 v125, 16, v126
  v_and_b32 v126, s65, v126
  v_lshlrev_b32 v127, 16, v127
  s_waitcnt lgkmcnt(5)
  v_sub_f32 v230, v230, v125
  v_sub_f32 v231, v231, v126
  s_waitcnt lgkmcnt(4)
  v_sub_f32 v232, v232, v127
  v_cvt_pk_bf16_f32 v230, v230, v231
  v_cvt_pk_bf16_f32 v232, v232, v232
  v_lshlrev_b32 v10, 16, v230
  v_and_b32 v11, s65, v230
  v_lshlrev_b32 v12, 16, v232
  v_mul_f32 v230, v10, v10
  v_fmac_f32 v230, v11, v11
  v_fmac_f32 v230, v12, v12
  v_cvt_pk_f16_f32 v183, v230, v230
  v_mfma_f32_32x32x16_bf16 v[128:143], v[16:19], v[200:203], v[128:143]
  v_mfma_f32_32x32x16_bf16 v[128:143], v[20:23], v[204:207], v[128:143]
  v_mfma_f32_32x32x16_bf16 v[128:143], v[24:27], v[208:211], v[128:143]
  v_mfma_f32_32x32x16_bf16 v[128:143], v[28:31], v[212:215], v[128:143]
  s_waitcnt lgkmcnt(2)
  v_mfma_f32_32x32x16_f16 v[128:143], v[56:59], v[176:179], v[128:143]
  s_waitcnt lgkmcnt(0)
  v_mfma_f32_32x32x16_f16 v[128:143], v[60:63], v[180:183], v[128:143]
  s_cmp_gt_i32 s59, 0
  s_cselect_b32 s6, 6400000, 0
  s_cselect_b32 s10, 25600000, 0
  s_cselect_b32 s14, 300000, 0
  s_add_u32 m0, s67, 118784
  v_mad_u32_u24 v1, v1, 32, v253
  buffer_load_dwordx4 v1, s[8:11], 0 offen  lds
  s_add_u32 m0, s66, 0
  v_mad_u32_u24 v220, v220, s64, v233
  buffer_load_dwordx4 v220, s[4:7], 0 offen  lds
  s_add_u32 m0, s66, 1024
  v_mad_u32_u24 v221, v221, s64, v234
  buffer_load_dwordx4 v221, s[4:7], 0 offen  lds
  s_add_u32 m0, s66, 2048
  v_mad_u32_u24 v222, v222, s64, v235
  buffer_load_dwordx4 v222, s[4:7], 0 offen  lds
  s_add_u32 m0, s66, 3072
  v_mad_u32_u24 v223, v223, s64, v236
  buffer_load_dwordx4 v223, s[4:7], 0 offen  lds
  v_mul_u32_u24 v1, 6, v229
  v_and_b32 v1, -4, v1
  s_mov_b64 exec, s[74:75]
  buffer_load_dwordx2 v[226:227], v1, s[12:15], 0 offen
  s_mov_b64 exec, -1
  s_waitcnt lgkmcnt(0)
  s_cmp_eq_u32 s59, 0
  s_cbranch_scc1 LOOPEND
  s_cmp_ge_u32 s57, 4
  s_movk_i32 s79, 80
  s_cmovk_i32 s79, 80
LOOP:
  ds_read_b64_tr_b16 v[192:193], v244 offset:64
  ds_read_b64_tr_b16 v[194:195], v244 offset:208
  ds_read_b64_tr_b16 v[196:197], v244 offset:352
  ds_read_b64_tr_b16 v[198:199], v244 offset:496
  v_cvt_pk_f16_f32 v160, v128, v129
  v_cvt_pk_f16_f32 v161, v130, v131
  v_cvt_pk_f16_f32 v162, v132, v133
  v_cvt_pk_f16_f32 v163, v134, v135
  v_cvt_pk_f16_f32 v164, v136, v137
  v_cvt_pk_f16_f32 v165, v138, v139
  v_cvt_pk_f16_f32 v166, v140, v141
  v_cvt_pk_f16_f32 v167, v142, v143
  v_mfma_f32_16x16x32_f16 v[124:127], v[80:83], v[168:171], v[124:127]
  v_exp_f16_sdwa v2, v160 dst_sel:WORD_0 dst_unused:UNUSED_PAD src0_sel:WORD_0
  s_mov_b64 exec, 1
  ds_add_rtn_u32 v251, v0, v234 offset:35336
  s_mov_b64 exec, -1
  v_exp_f16_sdwa v3, v161 dst_sel:WORD_0 dst_unused:UNUSED_PAD src0_sel:WORD_0
  v_mfma_f32_16x16x32_f16 v[124:127], v[84:87], v[172:175], v[124:127]
  v_exp_f16_sdwa v4, v162 dst_sel:WORD_0 dst_unused:UNUSED_PAD src0_sel:WORD_0
  v_exp_f16_sdwa v5, v163 dst_sel:WORD_0 dst_unused:UNUSED_PAD src0_sel:WORD_0
  v_mfma_f32_32x32x16_bf16 v[144:159], v[32:35], v[200:203], v[144:159]
  v_exp_f16_sdwa v2, v160 dst_sel:WORD_1 dst_unused:UNUSED_PRESERVE src0_sel:WORD_1
  v_exp_f16_sdwa v3, v161 dst_sel:WORD_1 dst_unused:UNUSED_PRESERVE src0_sel:WORD_1
  v_exp_f16_sdwa v4, v162 dst_sel:WORD_1 dst_unused:UNUSED_PRESERVE src0_sel:WORD_1
  s_waitcnt lgkmcnt(3)
  v_mfma_f32_32x32x16_f16 v[104:119], v[192:195], v[184:187], v[104:119]
  v_exp_f16_sdwa v5, v163 dst_sel:WORD_1 dst_unused:UNUSED_PRESERVE src0_sel:WORD_1
  v_pk_add_f16 v2, v2, 1.0 op_sel_hi:[1,0]
  v_pk_add_f16 v3, v3, 1.0 op_sel_hi:[1,0]
  v_pk_add_f16 v4, v4, 1.0 op_sel_hi:[1,0]
  v_pk_add_f16 v5, v5, 1.0 op_sel_hi:[1,0]
  v_mul_f32 v230, v13, v124
  v_mul_f32 v231, v14, v124
  v_mul_f32 v232, v15, v124
  v_cvt_pk_f16_f32 v230, v230, v231
  v_cvt_pk_f16_f32 v231, v232, v232
  s_mov_b64 exec, s[74:75]
  ds_write_b64 v242, v[230:231] offset:128
  s_mov_b64 exec, -1
  v_rcp_f16_sdwa v6, v2 dst_sel:WORD_0 dst_unused:UNUSED_PAD src0_sel:WORD_0
  v_rcp_f16_sdwa v7, v3 dst_sel:WORD_0 dst_unused:UNUSED_PAD src0_sel:WORD_0
  s_waitcnt lgkmcnt(2)
  v_mfma_f32_32x32x16_f16 v[104:119], v[196:199], v[188:191], v[104:119]
  ds_read_b64_tr_b16 v[192:193], v245 offset:0
  ds_read_b64_tr_b16 v[194:195], v245 offset:144
  ds_read_b64_tr_b16 v[196:197], v245 offset:288
  ds_read_b64_tr_b16 v[198:199], v245 offset:432
  v_rcp_f16_sdwa v8, v4 dst_sel:WORD_0 dst_unused:UNUSED_PAD src0_sel:WORD_0
  s_waitcnt lgkmcnt(5)
  v_readfirstlane_b32 s68, v251
  s_setprio 1
  s_cmp_lt_i32 s68, s79
  s_cbranch_scc0 PRI0
  s_setprio 0
PRI0:
  s_add_u32 s79, s79, 128
  v_rcp_f16_sdwa v9, v5 dst_sel:WORD_0 dst_unused:UNUSED_PAD src0_sel:WORD_0
  v_rcp_f16_sdwa v6, v2 dst_sel:WORD_1 dst_unused:UNUSED_PRESERVE src0_sel:WORD_1
  v_mfma_f32_32x32x16_bf16 v[144:159], v[36:39], v[204:207], v[144:159]
  v_rcp_f16_sdwa v7, v3 dst_sel:WORD_1 dst_unused:UNUSED_PRESERVE src0_sel:WORD_1
  v_rcp_f16_sdwa v8, v4 dst_sel:WORD_1 dst_unused:UNUSED_PRESERVE src0_sel:WORD_1
  v_rcp_f16_sdwa v9, v5 dst_sel:WORD_1 dst_unused:UNUSED_PRESERVE src0_sel:WORD_1
  v_pk_mul_f16 v160, v160, v6
  v_pk_mul_f16 v161, v161, v7
  v_pk_mul_f16 v162, v162, v8
  v_pk_mul_f16 v163, v163, v9
  ds_write_b128 v242, v[160:163] offset:0
  v_mfma_f32_32x32x16_bf16 v[144:159], v[40:43], v[208:211], v[144:159]
  v_exp_f16_sdwa v2, v164 dst_sel:WORD_0 dst_unused:UNUSED_PAD src0_sel:WORD_0
  v_exp_f16_sdwa v3, v165 dst_sel:WORD_0 dst_unused:UNUSED_PAD src0_sel:WORD_0
  v_exp_f16_sdwa v4, v166 dst_sel:WORD_0 dst_unused:UNUSED_PAD src0_sel:WORD_0
  v_mfma_f32_32x32x16_bf16 v[144:159], v[44:47], v[212:215], v[144:159]
  v_exp_f16_sdwa v5, v167 dst_sel:WORD_0 dst_unused:UNUSED_PAD src0_sel:WORD_0
  v_exp_f16_sdwa v2, v164 dst_sel:WORD_1 dst_unused:UNUSED_PRESERVE src0_sel:WORD_1
  v_exp_f16_sdwa v3, v165 dst_sel:WORD_1 dst_unused:UNUSED_PRESERVE src0_sel:WORD_1
  v_mfma_f32_32x32x16_f16 v[144:159], v[64:67], v[176:179], v[144:159]
  v_exp_f16_sdwa v4, v166 dst_sel:WORD_1 dst_unused:UNUSED_PRESERVE src0_sel:WORD_1
  v_exp_f16_sdwa v5, v167 dst_sel:WORD_1 dst_unused:UNUSED_PRESERVE src0_sel:WORD_1
  v_pk_add_f16 v2, v2, 1.0 op_sel_hi:[1,0]
  v_pk_add_f16 v3, v3, 1.0 op_sel_hi:[1,0]
  v_pk_add_f16 v4, v4, 1.0 op_sel_hi:[1,0]
  v_pk_add_f16 v5, v5, 1.0 op_sel_hi:[1,0]
  v_rcp_f16_sdwa v6, v2 dst_sel:WORD_0 dst_unused:UNUSED_PAD src0_sel:WORD_0
  v_mfma_f32_32x32x16_f16 v[144:159], v[68:71], v[180:183], v[144:159]
  v_rcp_f16_sdwa v7, v3 dst_sel:WORD_0 dst_unused:UNUSED_PAD src0_sel:WORD_0
  s_waitcnt vmcnt(0)
  ds_read_b128 v[216:219], v254
  ds_read_b128 v[200:203], v237
  ds_read_b128 v[204:207], v238
  v_rcp_f16_sdwa v8, v4 dst_sel:WORD_0 dst_unused:UNUSED_PAD src0_sel:WORD_0
  v_rcp_f16_sdwa v9, v5 dst_sel:WORD_0 dst_unused:UNUSED_PAD src0_sel:WORD_0
  s_waitcnt lgkmcnt(6)
  v_mfma_f32_16x16x32_f16 v[120:123], v[192:195], v[184:187], v[120:123]
  ds_read_b128 v[208:211], v239
  ds_read_b128 v[212:215], v240
  v_rcp_f16_sdwa v6, v2 dst_sel:WORD_1 dst_unused:UNUSED_PRESERVE src0_sel:WORD_1
  v_add_u32_sdwa v249, v241, v229 dst_sel:DWORD dst_unused:UNUSED_PAD src0_sel:DWORD src1_sel:BYTE_3
  ds_read_b64 v[230:231], v249 offset:480
  ds_read_b32 v232, v249 offset:736
  v_lshlrev_b32 v125, 4, v229
  v_alignbit_b32 v126, v227, v226, v125
  v_lshrrev_b32 v127, v125, v227
  v_rcp_f16_sdwa v7, v3 dst_sel:WORD_1 dst_unused:UNUSED_PRESERVE src0_sel:WORD_1
  s_waitcnt lgkmcnt(8)
  v_mfma_f32_16x16x32_f16 v[120:123], v[196:199], v[188:191], v[120:123]
  ds_read_b64 v[176:177], v249 offset:192
  ds_read_b64 v[178:179], v249 offset:128
  ds_read_b64 v[180:181], v249 offset:64
  ds_read_b32 v182, v249
  ds_read_b128 v[184:187], v248 offset:0
  v_rcp_f16_sdwa v8, v4 dst_sel:WORD_1 dst_unused:UNUSED_PRESERVE src0_sel:WORD_1
  ds_read_b128 v[220:223], v246 offset:256
  ds_read_b32 v228, v247 offset:256
  ds_read_b32 v1, v252 offset:17664
  v_rcp_f16_sdwa v9, v5 dst_sel:WORD_1 dst_unused:UNUSED_PRESERVE src0_sel:WORD_1
  v_pk_mul_f16 v164, v164, v6
  v_pk_mul_f16 v165, v165, v7
  v_pk_mul_f16 v166, v166, v8
  v_pk_mul_f16 v167, v167, v9
  ds_write_b128 v242, v[164:167] offset:16
  v_cvt_pk_f16_f32 v168, v144, v145
  v_cvt_pk_f16_f32 v169, v146, v147
  v_cvt_pk_f16_f32 v170, v148, v149
  v_cvt_pk_f16_f32 v171, v150, v151
  v_cvt_pk_f16_f32 v172, v152, v153
  v_cvt_pk_f16_f32 v173, v154, v155
  v_cvt_pk_f16_f32 v174, v156, v157
  v_cvt_pk_f16_f32 v175, v158, v159
  s_waitcnt lgkmcnt(15)
  v_mfma_f32_32x32x16_bf16 v[128:143], v[48:51], v[216:219], 0
  ds_read_b64_tr_b16 v[192:193], v244 offset:0
  ds_read_b64_tr_b16 v[194:195], v244 offset:144
  ds_read_b64_tr_b16 v[196:197], v244 offset:288
  ds_read_b64_tr_b16 v[198:199], v244 offset:432
  v_exp_f16_sdwa v2, v168 dst_sel:WORD_0 dst_unused:UNUSED_PAD src0_sel:WORD_0
  v_exp_f16_sdwa v3, v169 dst_sel:WORD_0 dst_unused:UNUSED_PAD src0_sel:WORD_0
  v_exp_f16_sdwa v4, v170 dst_sel:WORD_0 dst_unused:UNUSED_PAD src0_sel:WORD_0
  v_mfma_f32_32x32x16_bf16 v[144:159], v[52:55], v[216:219], 0
  v_lshlrev_b32 v125, 16, v126
  v_and_b32 v126, s65, v126
  v_lshlrev_b32 v127, 16, v127
  v_exp_f16_sdwa v5, v171 dst_sel:WORD_0 dst_unused:UNUSED_PAD src0_sel:WORD_0
  v_exp_f16_sdwa v2, v168 dst_sel:WORD_1 dst_unused:UNUSED_PRESERVE src0_sel:WORD_1
  s_waitcnt lgkmcnt(15)
  v_mfma_f32_32x32x16_bf16 v[128:143], v[16:19], v[200:203], v[128:143]
  v_exp_f16_sdwa v3, v169 dst_sel:WORD_1 dst_unused:UNUSED_PRESERVE src0_sel:WORD_1
  v_exp_f16_sdwa v4, v170 dst_sel:WORD_1 dst_unused:UNUSED_PRESERVE src0_sel:WORD_1
  s_waitcnt lgkmcnt(8)
  v_add_u32_sdwa v184, v243, v184 dst_sel:DWORD dst_unused:UNUSED_PAD src0_sel:DWORD src1_sel:BYTE_3
  v_add_u32_sdwa v185, v243, v185 dst_sel:DWORD dst_unused:UNUSED_PAD src0_sel:DWORD src1_sel:BYTE_3
  v_add_u32_sdwa v186, v243, v186 dst_sel:DWORD dst_unused:UNUSED_PAD src0_sel:DWORD src1_sel:BYTE_3
  v_add_u32_sdwa v187, v243, v187 dst_sel:DWORD dst_unused:UNUSED_PAD src0_sel:DWORD src1_sel:BYTE_3
  ds_read_b64_tr_b16 v[190:191], v187
  ds_read_b64_tr_b16 v[188:189], v186
  ds_read_b64_tr_b16 v[186:187], v185
  ds_read_b64_tr_b16 v[184:185], v184
  s_cmp_gt_i32 s59, 1
  s_cselect_b32 s6, 6400000, 0
  s_cselect_b32 s10, 25600000, 0
  s_cselect_b32 s14, 300000, 0
  s_add_u32 m0, s67, 118784
  s_waitcnt lgkmcnt(9)
  v_mad_u32_u24 v1, v1, 32, v253
  buffer_load_dwordx4 v1, s[8:11], 0 offen  lds
  v_exp_f16_sdwa v5, v171 dst_sel:WORD_1 dst_unused:UNUSED_PRESERVE src0_sel:WORD_1
  v_pk_add_f16 v2, v2, 1.0 op_sel_hi:[1,0]
  v_pk_add_f16 v3, v3, 1.0 op_sel_hi:[1,0]
  v_pk_add_f16 v4, v4, 1.0 op_sel_hi:[1,0]
  v_pk_add_f16 v5, v5, 1.0 op_sel_hi:[1,0]
  v_mfma_f32_32x32x16_bf16 v[128:143], v[20:23], v[204:207], v[128:143]
  v_sub_f32 v230, v230, v125
  v_sub_f32 v231, v231, v126
  v_sub_f32 v232, v232, v127
  v_cvt_pk_bf16_f32 v230, v230, v231
  v_cvt_pk_bf16_f32 v232, v232, v232
  v_lshlrev_b32 v13, 16, v230
  v_and_b32 v14, s65, v230
  v_lshlrev_b32 v15, 16, v232
  v_rcp_f16_sdwa v6, v2 dst_sel:WORD_0 dst_unused:UNUSED_PAD src0_sel:WORD_0
  v_rcp_f16_sdwa v7, v3 dst_sel:WORD_0 dst_unused:UNUSED_PAD src0_sel:WORD_0
  v_rcp_f16_sdwa v8, v4 dst_sel:WORD_0 dst_unused:UNUSED_PAD src0_sel:WORD_0
  v_mfma_f32_32x32x16_bf16 v[128:143], v[24:27], v[208:211], v[128:143]
  s_add_u32 m0, s66, 0
  v_mad_u32_u24 v220, v220, s64, v233
  buffer_load_dwordx4 v220, s[4:7], 0 offen  lds
  v_rcp_f16_sdwa v9, v5 dst_sel:WORD_0 dst_unused:UNUSED_PAD src0_sel:WORD_0
  v_rcp_f16_sdwa v6, v2 dst_sel:WORD_1 dst_unused:UNUSED_PRESERVE src0_sel:WORD_1
  v_mfma_f32_32x32x16_bf16 v[128:143], v[28:31], v[212:215], v[128:143]
  s_add_u32 m0, s66, 1024
  v_mad_u32_u24 v221, v221, s64, v234
  buffer_load_dwordx4 v221, s[4:7], 0 offen  lds
  v_rcp_f16_sdwa v7, v3 dst_sel:WORD_1 dst_unused:UNUSED_PRESERVE src0_sel:WORD_1
  v_rcp_f16_sdwa v8, v4 dst_sel:WORD_1 dst_unused:UNUSED_PRESERVE src0_sel:WORD_1
  v_mul_f32 v230, v13, v13
  v_fmac_f32 v230, v14, v14
  v_fmac_f32 v230, v15, v15
  v_cvt_pk_f16_f32 v183, v230, v230
  v_rcp_f16_sdwa v9, v5 dst_sel:WORD_1 dst_unused:UNUSED_PRESERVE src0_sel:WORD_1
  v_pk_mul_f16 v168, v168, v6
  v_pk_mul_f16 v169, v169, v7
  v_pk_mul_f16 v170, v170, v8
  v_pk_mul_f16 v171, v171, v9
  ds_write_b128 v242, v[168:171] offset:64
  v_mfma_f32_16x16x32_f16 v[124:127], v[72:75], v[160:163], 0
  s_add_u32 m0, s66, 2048
  v_mad_u32_u24 v222, v222, s64, v235
  buffer_load_dwordx4 v222, s[4:7], 0 offen  lds
  v_exp_f16_sdwa v2, v172 dst_sel:WORD_0 dst_unused:UNUSED_PAD src0_sel:WORD_0
  v_exp_f16_sdwa v3, v173 dst_sel:WORD_0 dst_unused:UNUSED_PAD src0_sel:WORD_0
  v_mfma_f32_16x16x32_f16 v[124:127], v[76:79], v[164:167], v[124:127]
  s_add_u32 m0, s66, 3072
  v_mad_u32_u24 v223, v223, s64, v236
  buffer_load_dwordx4 v223, s[4:7], 0 offen  lds
  v_exp_f16_sdwa v4, v174 dst_sel:WORD_0 dst_unused:UNUSED_PAD src0_sel:WORD_0
  v_exp_f16_sdwa v5, v175 dst_sel:WORD_0 dst_unused:UNUSED_PAD src0_sel:WORD_0
  v_mfma_f32_32x32x16_f16 v[128:143], v[56:59], v[176:179], v[128:143]
  v_exp_f16_sdwa v2, v172 dst_sel:WORD_1 dst_unused:UNUSED_PRESERVE src0_sel:WORD_1
  v_exp_f16_sdwa v3, v173 dst_sel:WORD_1 dst_unused:UNUSED_PRESERVE src0_sel:WORD_1
  v_exp_f16_sdwa v4, v174 dst_sel:WORD_1 dst_unused:UNUSED_PRESERVE src0_sel:WORD_1
  v_mfma_f32_32x32x16_f16 v[128:143], v[60:63], v[180:183], v[128:143]
  v_mul_u32_u24 v1, 6, v228
  v_and_b32 v1, -4, v1
  s_mov_b64 exec, s[74:75]
  buffer_load_dwordx2 v[224:225], v1, s[12:15], 0 offen
  s_mov_b64 exec, -1
  v_exp_f16_sdwa v5, v175 dst_sel:WORD_1 dst_unused:UNUSED_PRESERVE src0_sel:WORD_1
  v_pk_add_f16 v2, v2, 1.0 op_sel_hi:[1,0]
  v_pk_add_f16 v3, v3, 1.0 op_sel_hi:[1,0]
  v_pk_add_f16 v4, v4, 1.0 op_sel_hi:[1,0]
  v_pk_add_f16 v5, v5, 1.0 op_sel_hi:[1,0]
  v_rcp_f16_sdwa v6, v2 dst_sel:WORD_0 dst_unused:UNUSED_PAD src0_sel:WORD_0
  v_rcp_f16_sdwa v7, v3 dst_sel:WORD_0 dst_unused:UNUSED_PAD src0_sel:WORD_0
  s_waitcnt lgkmcnt(1)
  v_mfma_f32_32x32x16_f16 v[88:103], v[192:195], v[184:187], v[88:103]
  v_rcp_f16_sdwa v8, v4 dst_sel:WORD_0 dst_unused:UNUSED_PAD src0_sel:WORD_0
  v_rcp_f16_sdwa v9, v5 dst_sel:WORD_0 dst_unused:UNUSED_PAD src0_sel:WORD_0
  v_rcp_f16_sdwa v6, v2 dst_sel:WORD_1 dst_unused:UNUSED_PRESERVE src0_sel:WORD_1
  v_mfma_f32_32x32x16_f16 v[88:103], v[196:199], v[188:191], v[88:103]
  v_rcp_f16_sdwa v7, v3 dst_sel:WORD_1 dst_unused:UNUSED_PRESERVE src0_sel:WORD_1
  v_rcp_f16_sdwa v8, v4 dst_sel:WORD_1 dst_unused:UNUSED_PRESERVE src0_sel:WORD_1
  v_rcp_f16_sdwa v9, v5 dst_sel:WORD_1 dst_unused:UNUSED_PRESERVE src0_sel:WORD_1
  v_pk_mul_f16 v172, v172, v6
  v_pk_mul_f16 v173, v173, v7
  v_pk_mul_f16 v174, v174, v8
  v_pk_mul_f16 v175, v175, v9
  ds_write_b128 v242, v[172:175] offset:80
  s_sub_u32 s59, s59, 1
  s_cmp_eq_u32 s59, 0
  s_cbranch_scc1 TAIL0
  ds_read_b64_tr_b16 v[192:193], v244 offset:64
  ds_read_b64_tr_b16 v[194:195], v244 offset:208
  ds_read_b64_tr_b16 v[196:197], v244 offset:352
  ds_read_b64_tr_b16 v[198:199], v244 offset:496
  v_cvt_pk_f16_f32 v160, v128, v129
  v_cvt_pk_f16_f32 v161, v130, v131
  v_cvt_pk_f16_f32 v162, v132, v133
  v_cvt_pk_f16_f32 v163, v134, v135
  v_cvt_pk_f16_f32 v164, v136, v137
  v_cvt_pk_f16_f32 v165, v138, v139
  v_cvt_pk_f16_f32 v166, v140, v141
  v_cvt_pk_f16_f32 v167, v142, v143
  v_mfma_f32_16x16x32_f16 v[124:127], v[80:83], v[168:171], v[124:127]
  v_exp_f16_sdwa v2, v160 dst_sel:WORD_0 dst_unused:UNUSED_PAD src0_sel:WORD_0
  s_mov_b64 exec, 1
  ds_add_rtn_u32 v251, v0, v234 offset:35336
  s_mov_b64 exec, -1
  v_exp_f16_sdwa v3, v161 dst_sel:WORD_0 dst_unused:UNUSED_PAD src0_sel:WORD_0
  v_mfma_f32_16x16x32_f16 v[124:127], v[84:87], v[172:175], v[124:127]
  v_exp_f16_sdwa v4, v162 dst_sel:WORD_0 dst_unused:UNUSED_PAD src0_sel:WORD_0
  v_exp_f16_sdwa v5, v163 dst_sel:WORD_0 dst_unused:UNUSED_PAD src0_sel:WORD_0
  v_mfma_f32_32x32x16_bf16 v[144:159], v[32:35], v[200:203], v[144:159]
  v_exp_f16_sdwa v2, v160 dst_sel:WORD_1 dst_unused:UNUSED_PRESERVE src0_sel:WORD_1
  v_exp_f16_sdwa v3, v161 dst_sel:WORD_1 dst_unused:UNUSED_PRESERVE src0_sel:WORD_1
  v_exp_f16_sdwa v4, v162 dst_sel:WORD_1 dst_unused:UNUSED_PRESERVE src0_sel:WORD_1
  s_waitcnt lgkmcnt(3)
  v_mfma_f32_32x32x16_f16 v[104:119], v[192:195], v[184:187], v[104:119]
  v_exp_f16_sdwa v5, v163 dst_sel:WORD_1 dst_unused:UNUSED_PRESERVE src0_sel:WORD_1
  v_pk_add_f16 v2, v2, 1.0 op_sel_hi:[1,0]
  v_pk_add_f16 v3, v3, 1.0 op_sel_hi:[1,0]
  v_pk_add_f16 v4, v4, 1.0 op_sel_hi:[1,0]
  v_pk_add_f16 v5, v5, 1.0 op_sel_hi:[1,0]
  v_mul_f32 v230, v10, v124
  v_mul_f32 v231, v11, v124
  v_mul_f32 v232, v12, v124
  v_cvt_pk_f16_f32 v230, v230, v231
  v_cvt_pk_f16_f32 v231, v232, v232
  s_mov_b64 exec, s[74:75]
  ds_write_b64 v242, v[230:231] offset:128
  s_mov_b64 exec, -1
  v_rcp_f16_sdwa v6, v2 dst_sel:WORD_0 dst_unused:UNUSED_PAD src0_sel:WORD_0
  v_rcp_f16_sdwa v7, v3 dst_sel:WORD_0 dst_unused:UNUSED_PAD src0_sel:WORD_0
  s_waitcnt lgkmcnt(2)
  v_mfma_f32_32x32x16_f16 v[104:119], v[196:199], v[188:191], v[104:119]
  ds_read_b64_tr_b16 v[192:193], v245 offset:0
  ds_read_b64_tr_b16 v[194:195], v245 offset:144
  ds_read_b64_tr_b16 v[196:197], v245 offset:288
  ds_read_b64_tr_b16 v[198:199], v245 offset:432
  v_rcp_f16_sdwa v8, v4 dst_sel:WORD_0 dst_unused:UNUSED_PAD src0_sel:WORD_0
  s_waitcnt lgkmcnt(5)
  v_readfirstlane_b32 s68, v251
  s_setprio 1
  s_cmp_lt_i32 s68, s79
  s_cbranch_scc0 PRI1
  s_setprio 0
PRI1:
  s_add_u32 s79, s79, 128
  v_rcp_f16_sdwa v9, v5 dst_sel:WORD_0 dst_unused:UNUSED_PAD src0_sel:WORD_0
  v_rcp_f16_sdwa v6, v2 dst_sel:WORD_1 dst_unused:UNUSED_PRESERVE src0_sel:WORD_1
  v_mfma_f32_32x32x16_bf16 v[144:159], v[36:39], v[204:207], v[144:159]
  v_rcp_f16_sdwa v7, v3 dst_sel:WORD_1 dst_unused:UNUSED_PRESERVE src0_sel:WORD_1
  v_rcp_f16_sdwa v8, v4 dst_sel:WORD_1 dst_unused:UNUSED_PRESERVE src0_sel:WORD_1
  v_rcp_f16_sdwa v9, v5 dst_sel:WORD_1 dst_unused:UNUSED_PRESERVE src0_sel:WORD_1
  v_pk_mul_f16 v160, v160, v6
  v_pk_mul_f16 v161, v161, v7
  v_pk_mul_f16 v162, v162, v8
  v_pk_mul_f16 v163, v163, v9
  ds_write_b128 v242, v[160:163] offset:0
  v_mfma_f32_32x32x16_bf16 v[144:159], v[40:43], v[208:211], v[144:159]
  v_exp_f16_sdwa v2, v164 dst_sel:WORD_0 dst_unused:UNUSED_PAD src0_sel:WORD_0
  v_exp_f16_sdwa v3, v165 dst_sel:WORD_0 dst_unused:UNUSED_PAD src0_sel:WORD_0
  v_exp_f16_sdwa v4, v166 dst_sel:WORD_0 dst_unused:UNUSED_PAD src0_sel:WORD_0
  v_mfma_f32_32x32x16_bf16 v[144:159], v[44:47], v[212:215], v[144:159]
  v_exp_f16_sdwa v5, v167 dst_sel:WORD_0 dst_unused:UNUSED_PAD src0_sel:WORD_0
  v_exp_f16_sdwa v2, v164 dst_sel:WORD_1 dst_unused:UNUSED_PRESERVE src0_sel:WORD_1
  v_exp_f16_sdwa v3, v165 dst_sel:WORD_1 dst_unused:UNUSED_PRESERVE src0_sel:WORD_1
  v_mfma_f32_32x32x16_f16 v[144:159], v[64:67], v[176:179], v[144:159]
  v_exp_f16_sdwa v4, v166 dst_sel:WORD_1 dst_unused:UNUSED_PRESERVE src0_sel:WORD_1
  v_exp_f16_sdwa v5, v167 dst_sel:WORD_1 dst_unused:UNUSED_PRESERVE src0_sel:WORD_1
  v_pk_add_f16 v2, v2, 1.0 op_sel_hi:[1,0]
  v_pk_add_f16 v3, v3, 1.0 op_sel_hi:[1,0]
  v_pk_add_f16 v4, v4, 1.0 op_sel_hi:[1,0]
  v_pk_add_f16 v5, v5, 1.0 op_sel_hi:[1,0]
  v_rcp_f16_sdwa v6, v2 dst_sel:WORD_0 dst_unused:UNUSED_PAD src0_sel:WORD_0
  v_mfma_f32_32x32x16_f16 v[144:159], v[68:71], v[180:183], v[144:159]
  v_rcp_f16_sdwa v7, v3 dst_sel:WORD_0 dst_unused:UNUSED_PAD src0_sel:WORD_0
  s_waitcnt vmcnt(0)
  ds_read_b128 v[216:219], v254
  ds_read_b128 v[200:203], v237
  ds_read_b128 v[204:207], v238
  v_rcp_f16_sdwa v8, v4 dst_sel:WORD_0 dst_unused:UNUSED_PAD src0_sel:WORD_0
  v_rcp_f16_sdwa v9, v5 dst_sel:WORD_0 dst_unused:UNUSED_PAD src0_sel:WORD_0
  s_waitcnt lgkmcnt(6)
  v_mfma_f32_16x16x32_f16 v[120:123], v[192:195], v[184:187], v[120:123]
  ds_read_b128 v[208:211], v239
  ds_read_b128 v[212:215], v240
  v_rcp_f16_sdwa v6, v2 dst_sel:WORD_1 dst_unused:UNUSED_PRESERVE src0_sel:WORD_1
  v_add_u32_sdwa v249, v241, v228 dst_sel:DWORD dst_unused:UNUSED_PAD src0_sel:DWORD src1_sel:BYTE_3
  ds_read_b64 v[230:231], v249 offset:480
  ds_read_b32 v232, v249 offset:736
  v_lshlrev_b32 v125, 4, v228
  v_alignbit_b32 v126, v225, v224, v125
  v_lshrrev_b32 v127, v125, v225
  v_rcp_f16_sdwa v7, v3 dst_sel:WORD_1 dst_unused:UNUSED_PRESERVE src0_sel:WORD_1
  s_waitcnt lgkmcnt(8)
  v_mfma_f32_16x16x32_f16 v[120:123], v[196:199], v[188:191], v[120:123]
  ds_read_b64 v[176:177], v249 offset:192
  ds_read_b64 v[178:179], v249 offset:128
  ds_read_b64 v[180:181], v249 offset:64
  ds_read_b32 v182, v249
  ds_read_b128 v[184:187], v248 offset:128
  v_rcp_f16_sdwa v8, v4 dst_sel:WORD_1 dst_unused:UNUSED_PRESERVE src0_sel:WORD_1
  ds_read_b128 v[220:223], v246 offset:384
  ds_read_b32 v229, v247 offset:384
  ds_read_b32 v1, v252 offset:17792
  v_rcp_f16_sdwa v9, v5 dst_sel:WORD_1 dst_unused:UNUSED_PRESERVE src0_sel:WORD_1
  v_pk_mul_f16 v164, v164, v6
  v_pk_mul_f16 v165, v165, v7
  v_pk_mul_f16 v166, v166, v8
  v_pk_mul_f16 v167, v167, v9
  ds_write_b128 v242, v[164:167] offset:16
  v_cvt_pk_f16_f32 v168, v144, v145
  v_cvt_pk_f16_f32 v169, v146, v147
  v_cvt_pk_f16_f32 v170, v148, v149
  v_cvt_pk_f16_f32 v171, v150, v151
  v_cvt_pk_f16_f32 v172, v152, v153
  v_cvt_pk_f16_f32 v173, v154, v155
  v_cvt_pk_f16_f32 v174, v156, v157
  v_cvt_pk_f16_f32 v175, v158, v159
  s_waitcnt lgkmcnt(15)
  v_mfma_f32_32x32x16_bf16 v[128:143], v[48:51], v[216:219], 0
  ds_read_b64_tr_b16 v[192:193], v244 offset:0
  ds_read_b64_tr_b16 v[194:195], v244 offset:144
  ds_read_b64_tr_b16 v[196:197], v244 offset:288
  ds_read_b64_tr_b16 v[198:199], v244 offset:432
  v_exp_f16_sdwa v2, v168 dst_sel:WORD_0 dst_unused:UNUSED_PAD src0_sel:WORD_0
  v_exp_f16_sdwa v3, v169 dst_sel:WORD_0 dst_unused:UNUSED_PAD src0_sel:WORD_0
  v_exp_f16_sdwa v4, v170 dst_sel:WORD_0 dst_unused:UNUSED_PAD src0_sel:WORD_0
  v_mfma_f32_32x32x16_bf16 v[144:159], v[52:55], v[216:219], 0
  v_lshlrev_b32 v125, 16, v126
  v_and_b32 v126, s65, v126
  v_lshlrev_b32 v127, 16, v127
  v_exp_f16_sdwa v5, v171 dst_sel:WORD_0 dst_unused:UNUSED_PAD src0_sel:WORD_0
  v_exp_f16_sdwa v2, v168 dst_sel:WORD_1 dst_unused:UNUSED_PRESERVE src0_sel:WORD_1
  s_waitcnt lgkmcnt(15)
  v_mfma_f32_32x32x16_bf16 v[128:143], v[16:19], v[200:203], v[128:143]
  v_exp_f16_sdwa v3, v169 dst_sel:WORD_1 dst_unused:UNUSED_PRESERVE src0_sel:WORD_1
  v_exp_f16_sdwa v4, v170 dst_sel:WORD_1 dst_unused:UNUSED_PRESERVE src0_sel:WORD_1
  s_waitcnt lgkmcnt(8)
  v_add_u32_sdwa v184, v243, v184 dst_sel:DWORD dst_unused:UNUSED_PAD src0_sel:DWORD src1_sel:BYTE_3
  v_add_u32_sdwa v185, v243, v185 dst_sel:DWORD dst_unused:UNUSED_PAD src0_sel:DWORD src1_sel:BYTE_3
  v_add_u32_sdwa v186, v243, v186 dst_sel:DWORD dst_unused:UNUSED_PAD src0_sel:DWORD src1_sel:BYTE_3
  v_add_u32_sdwa v187, v243, v187 dst_sel:DWORD dst_unused:UNUSED_PAD src0_sel:DWORD src1_sel:BYTE_3
  ds_read_b64_tr_b16 v[190:191], v187
  ds_read_b64_tr_b16 v[188:189], v186
  ds_read_b64_tr_b16 v[186:187], v185
  ds_read_b64_tr_b16 v[184:185], v184
  s_cmp_gt_i32 s59, 1
  s_cselect_b32 s6, 6400000, 0
  s_cselect_b32 s10, 25600000, 0
  s_cselect_b32 s14, 300000, 0
  s_add_u32 m0, s67, 118784
  s_waitcnt lgkmcnt(9)
  v_mad_u32_u24 v1, v1, 32, v253
  buffer_load_dwordx4 v1, s[8:11], 0 offen  lds
  v_exp_f16_sdwa v5, v171 dst_sel:WORD_1 dst_unused:UNUSED_PRESERVE src0_sel:WORD_1
  v_pk_add_f16 v2, v2, 1.0 op_sel_hi:[1,0]
  v_pk_add_f16 v3, v3, 1.0 op_sel_hi:[1,0]
  v_pk_add_f16 v4, v4, 1.0 op_sel_hi:[1,0]
  v_pk_add_f16 v5, v5, 1.0 op_sel_hi:[1,0]
  v_mfma_f32_32x32x16_bf16 v[128:143], v[20:23], v[204:207], v[128:143]
  v_sub_f32 v230, v230, v125
  v_sub_f32 v231, v231, v126
  v_sub_f32 v232, v232, v127
  v_cvt_pk_bf16_f32 v230, v230, v231
  v_cvt_pk_bf16_f32 v232, v232, v232
  v_lshlrev_b32 v10, 16, v230
  v_and_b32 v11, s65, v230
  v_lshlrev_b32 v12, 16, v232
  v_rcp_f16_sdwa v6, v2 dst_sel:WORD_0 dst_unused:UNUSED_PAD src0_sel:WORD_0
  v_rcp_f16_sdwa v7, v3 dst_sel:WORD_0 dst_unused:UNUSED_PAD src0_sel:WORD_0
  v_rcp_f16_sdwa v8, v4 dst_sel:WORD_0 dst_unused:UNUSED_PAD src0_sel:WORD_0
  v_mfma_f32_32x32x16_bf16 v[128:143], v[24:27], v[208:211], v[128:143]
  s_add_u32 m0, s66, 0
  v_mad_u32_u24 v220, v220, s64, v233
  buffer_load_dwordx4 v220, s[4:7], 0 offen  lds
  v_rcp_f16_sdwa v9, v5 dst_sel:WORD_0 dst_unused:UNUSED_PAD src0_sel:WORD_0
  v_rcp_f16_sdwa v6, v2 dst_sel:WORD_1 dst_unused:UNUSED_PRESERVE src0_sel:WORD_1
  v_mfma_f32_32x32x16_bf16 v[128:143], v[28:31], v[212:215], v[128:143]
  s_add_u32 m0, s66, 1024
  v_mad_u32_u24 v221, v221, s64, v234
  buffer_load_dwordx4 v221, s[4:7], 0 offen  lds
  v_rcp_f16_sdwa v7, v3 dst_sel:WORD_1 dst_unused:UNUSED_PRESERVE src0_sel:WORD_1
  v_rcp_f16_sdwa v8, v4 dst_sel:WORD_1 dst_unused:UNUSED_PRESERVE src0_sel:WORD_1
  v_mul_f32 v230, v10, v10
  v_fmac_f32 v230, v11, v11
  v_fmac_f32 v230, v12, v12
  v_cvt_pk_f16_f32 v183, v230, v230
  v_rcp_f16_sdwa v9, v5 dst_sel:WORD_1 dst_unused:UNUSED_PRESERVE src0_sel:WORD_1
  v_pk_mul_f16 v168, v168, v6
  v_pk_mul_f16 v169, v169, v7
  v_pk_mul_f16 v170, v170, v8
  v_pk_mul_f16 v171, v171, v9
  ds_write_b128 v242, v[168:171] offset:64
  v_mfma_f32_16x16x32_f16 v[124:127], v[72:75], v[160:163], 0
  s_add_u32 m0, s66, 2048
  v_mad_u32_u24 v222, v222, s64, v235
  buffer_load_dwordx4 v222, s[4:7], 0 offen  lds
  v_exp_f16_sdwa v2, v172 dst_sel:WORD_0 dst_unused:UNUSED_PAD src0_sel:WORD_0
  v_exp_f16_sdwa v3, v173 dst_sel:WORD_0 dst_unused:UNUSED_PAD src0_sel:WORD_0
  v_mfma_f32_16x16x32_f16 v[124:127], v[76:79], v[164:167], v[124:127]
  s_add_u32 m0, s66, 3072
  v_mad_u32_u24 v223, v223, s64, v236
  buffer_load_dwordx4 v223, s[4:7], 0 offen  lds
  v_exp_f16_sdwa v4, v174 dst_sel:WORD_0 dst_unused:UNUSED_PAD src0_sel:WORD_0
  v_exp_f16_sdwa v5, v175 dst_sel:WORD_0 dst_unused:UNUSED_PAD src0_sel:WORD_0
  v_mfma_f32_32x32x16_f16 v[128:143], v[56:59], v[176:179], v[128:143]
  v_exp_f16_sdwa v2, v172 dst_sel:WORD_1 dst_unused:UNUSED_PRESERVE src0_sel:WORD_1
  v_exp_f16_sdwa v3, v173 dst_sel:WORD_1 dst_unused:UNUSED_PRESERVE src0_sel:WORD_1
  v_exp_f16_sdwa v4, v174 dst_sel:WORD_1 dst_unused:UNUSED_PRESERVE src0_sel:WORD_1
  v_mfma_f32_32x32x16_f16 v[128:143], v[60:63], v[180:183], v[128:143]
  v_mul_u32_u24 v1, 6, v229
  v_and_b32 v1, -4, v1
  s_mov_b64 exec, s[74:75]
  buffer_load_dwordx2 v[226:227], v1, s[12:15], 0 offen
  s_mov_b64 exec, -1
  v_exp_f16_sdwa v5, v175 dst_sel:WORD_1 dst_unused:UNUSED_PRESERVE src0_sel:WORD_1
  v_pk_add_f16 v2, v2, 1.0 op_sel_hi:[1,0]
  v_pk_add_f16 v3, v3, 1.0 op_sel_hi:[1,0]
  v_pk_add_f16 v4, v4, 1.0 op_sel_hi:[1,0]
  v_pk_add_f16 v5, v5, 1.0 op_sel_hi:[1,0]
  v_rcp_f16_sdwa v6, v2 dst_sel:WORD_0 dst_unused:UNUSED_PAD src0_sel:WORD_0
  v_rcp_f16_sdwa v7, v3 dst_sel:WORD_0 dst_unused:UNUSED_PAD src0_sel:WORD_0
  s_waitcnt lgkmcnt(1)
  v_mfma_f32_32x32x16_f16 v[88:103], v[192:195], v[184:187], v[88:103]
  v_rcp_f16_sdwa v8, v4 dst_sel:WORD_0 dst_unused:UNUSED_PAD src0_sel:WORD_0
  v_rcp_f16_sdwa v9, v5 dst_sel:WORD_0 dst_unused:UNUSED_PAD src0_sel:WORD_0
  v_rcp_f16_sdwa v6, v2 dst_sel:WORD_1 dst_unused:UNUSED_PRESERVE src0_sel:WORD_1
  v_mfma_f32_32x32x16_f16 v[88:103], v[196:199], v[188:191], v[88:103]
  v_rcp_f16_sdwa v7, v3 dst_sel:WORD_1 dst_unused:UNUSED_PRESERVE src0_sel:WORD_1
  v_rcp_f16_sdwa v8, v4 dst_sel:WORD_1 dst_unused:UNUSED_PRESERVE src0_sel:WORD_1
  v_rcp_f16_sdwa v9, v5 dst_sel:WORD_1 dst_unused:UNUSED_PRESERVE src0_sel:WORD_1
  v_pk_mul_f16 v172, v172, v6
  v_pk_mul_f16 v173, v173, v7
  v_pk_mul_f16 v174, v174, v8
  v_pk_mul_f16 v175, v175, v9
  ds_write_b128 v242, v[172:175] offset:80
  s_sub_u32 s59, s59, 1
  s_cmp_eq_u32 s59, 0
  v_add_u32 v246, 0x100, v246
  v_add_u32 v247, 0x100, v247
  v_add_u32 v248, 0x100, v248
  v_add_u32 v252, 0x100, v252
  s_cbranch_scc0 LOOP
  v_mov_b32 v10, v13
  v_mov_b32 v11, v14
  v_mov_b32 v12, v15
TAIL0:
  s_waitcnt lgkmcnt(0)
  ds_read_b64_tr_b16 v[192:193], v244 offset:64
  ds_read_b64_tr_b16 v[194:195], v244 offset:208
  ds_read_b64_tr_b16 v[196:197], v244 offset:352
  ds_read_b64_tr_b16 v[198:199], v244 offset:496
  v_mfma_f32_16x16x32_f16 v[124:127], v[80:83], v[168:171], v[124:127]
  v_mfma_f32_16x16x32_f16 v[124:127], v[84:87], v[172:175], v[124:127]
  s_waitcnt lgkmcnt(2)
  v_mfma_f32_32x32x16_f16 v[104:119], v[192:195], v[184:187], v[104:119]
  s_waitcnt lgkmcnt(0)
  v_mfma_f32_32x32x16_f16 v[104:119], v[196:199], v[188:191], v[104:119]
  s_nop 3
  v_mul_f32 v230, v10, v124
  v_mul_f32 v231, v11, v124
  v_mul_f32 v232, v12, v124
  v_cvt_pk_f16_f32 v230, v230, v231
  v_cvt_pk_f16_f32 v231, v232, v232
  s_mov_b64 exec, s[74:75]
  ds_write_b64 v242, v[230:231] offset:128
  s_mov_b64 exec, -1
  ds_read_b64_tr_b16 v[192:193], v245 offset:0
  ds_read_b64_tr_b16 v[194:195], v245 offset:144
  ds_read_b64_tr_b16 v[196:197], v245 offset:288
  ds_read_b64_tr_b16 v[198:199], v245 offset:432
  s_waitcnt lgkmcnt(2)
  v_mfma_f32_16x16x32_f16 v[120:123], v[192:195], v[184:187], v[120:123]
  s_waitcnt lgkmcnt(0)
  v_mfma_f32_16x16x32_f16 v[120:123], v[196:199], v[188:191], v[120:123]
LOOPEND:
  s_cmp_eq_u32 s62, 0
  s_cbranch_scc1 EPI
  s_add_u32 s61, s61, s60
  s_min_u32 s60, s60, 32
  s_waitcnt vmcnt(0)
  s_barrier
  s_branch ROUND
EPI:
  v_and_b32 v2, 1, v0
  v_bfe_u32 v3, v0, 1, 1
  v_bfe_u32 v4, v0, 2, 2
  v_bfe_u32 v5, v0, 4, 1
  v_lshlrev_b32 v2, 6, v2
  v_lshl_add_u32 v2, v3, 3, v2
  v_lshl_add_u32 v2, v5, 4, v2
  v_lshrrev_b32 v3, 1, v4
  v_lshl_add_u32 v2, v3, 5, v2
  v_lshl_add_u32 v2, v4, 7, v2
  v_add_u32 v2, 114176, v2
  v_lshl_add_u32 v6, v250, 8, v2
  v_xor_b32 v7, 32, v6
  v_lshl_add_u32 v8, v250, 6, v2
  v_xor_b32 v9, 32, v8
  v_lshl_add_u32 v249, v0, 3, s67
  ds_read_b64 v[220:221], v249 offset:512
  ds_read_b32 v222, v249 offset:768
  ds_read_b64_tr_b16 v[16:17], v6 offset:0
  ds_read_b64_tr_b16 v[18:19], v6 offset:512
  ds_read_b64_tr_b16 v[20:21], v6 offset:1024
  ds_read_b64_tr_b16 v[22:23], v6 offset:1536
  ds_read_b64_tr_b16 v[24:25], v6 offset:2048
  ds_read_b64_tr_b16 v[26:27], v6 offset:2560
  ds_read_b64_tr_b16 v[28:29], v6 offset:3072
  ds_read_b64_tr_b16 v[30:31], v6 offset:3584
  ds_read_b64_tr_b16 v[32:33], v8 offset:8192
  ds_read_b64_tr_b16 v[34:35], v8 offset:10240
  ds_read_b64_tr_b16 v[36:37], v8 offset:8704
  ds_read_b64_tr_b16 v[38:39], v8 offset:10752
  ds_read_b64_tr_b16 v[40:41], v8 offset:12288
  ds_read_b64_tr_b16 v[42:43], v8 offset:14336
  ds_read_b64_tr_b16 v[44:45], v8 offset:12800
  ds_read_b64_tr_b16 v[46:47], v8 offset:14848
  s_mov_b32 s68, 0xbf317218
  s_mov_b32 s69, 0xbf317218
  v_pk_mul_f32 v[88:89], v[88:89], s[68:69]
  v_pk_mul_f32 v[90:91], v[90:91], s[68:69]
  v_pk_mul_f32 v[92:93], v[92:93], s[68:69]
  v_pk_mul_f32 v[94:95], v[94:95], s[68:69]
  v_pk_mul_f32 v[96:97], v[96:97], s[68:69]
  v_pk_mul_f32 v[98:99], v[98:99], s[68:69]
  v_pk_mul_f32 v[100:101], v[100:101], s[68:69]
  v_pk_mul_f32 v[102:103], v[102:103], s[68:69]
  v_pk_mul_f32 v[104:105], v[104:105], s[68:69]
  v_pk_mul_f32 v[106:107], v[106:107], s[68:69]
  v_pk_mul_f32 v[108:109], v[108:109], s[68:69]
  v_pk_mul_f32 v[110:111], v[110:111], s[68:69]
  v_pk_mul_f32 v[112:113], v[112:113], s[68:69]
  v_pk_mul_f32 v[114:115], v[114:115], s[68:69]
  v_pk_mul_f32 v[116:117], v[116:117], s[68:69]
  v_pk_mul_f32 v[118:119], v[118:119], s[68:69]
  v_pk_mul_f32 v[120:121], v[120:121], s[68:69]
  v_pk_mul_f32 v[122:123], v[122:123], s[68:69]
  s_waitcnt lgkmcnt(8)
  v_mfma_f32_32x32x16_bf16 v[128:143], v[16:19], v[200:203], 0
  v_cvt_pk_bf16_f32 v160, v88, v89
  v_cvt_pk_bf16_f32 v161, v90, v91
  v_cvt_pk_bf16_f32 v162, v92, v93
  v_cvt_pk_bf16_f32 v163, v94, v95
  v_cvt_pk_bf16_f32 v164, v96, v97
  v_mfma_f32_32x32x16_bf16 v[128:143], v[20:23], v[204:207], v[128:143]
  v_cvt_pk_bf16_f32 v165, v98, v99
  v_cvt_pk_bf16_f32 v166, v100, v101
  v_cvt_pk_bf16_f32 v167, v102, v103
  v_cvt_pk_bf16_f32 v168, v104, v105
  v_cvt_pk_bf16_f32 v169, v106, v107
  v_mfma_f32_32x32x16_bf16 v[128:143], v[24:27], v[208:211], v[128:143]
  v_cvt_pk_bf16_f32 v170, v108, v109
  v_cvt_pk_bf16_f32 v171, v110, v111
  v_cvt_pk_bf16_f32 v172, v112, v113
  v_cvt_pk_bf16_f32 v173, v114, v115
  v_cvt_pk_bf16_f32 v174, v116, v117
  v_mfma_f32_32x32x16_bf16 v[128:143], v[28:31], v[212:215], v[128:143]
  v_cvt_pk_bf16_f32 v175, v118, v119
  s_waitcnt lgkmcnt(0)
  ds_read_b64_tr_b16 v[48:49], v7 offset:0
  ds_read_b64_tr_b16 v[50:51], v7 offset:512
  ds_read_b64_tr_b16 v[52:53], v7 offset:1024
  ds_read_b64_tr_b16 v[54:55], v7 offset:1536
  ds_read_b64_tr_b16 v[56:57], v7 offset:2048
  ds_read_b64_tr_b16 v[58:59], v7 offset:2560
  ds_read_b64_tr_b16 v[60:61], v7 offset:3072
  ds_read_b64_tr_b16 v[62:63], v7 offset:3584
  ds_read_b64_tr_b16 v[64:65], v9 offset:8192
  ds_read_b64_tr_b16 v[66:67], v9 offset:10240
  ds_read_b64_tr_b16 v[68:69], v9 offset:8704
  ds_read_b64_tr_b16 v[70:71], v9 offset:10752
  ds_read_b64_tr_b16 v[72:73], v9 offset:12288
  ds_read_b64_tr_b16 v[74:75], v9 offset:14336
  ds_read_b64_tr_b16 v[76:77], v9 offset:12800
  ds_read_b64_tr_b16 v[78:79], v9 offset:14848
  v_mfma_f32_32x32x16_bf16 v[128:143], v[32:35], v[160:163], v[128:143]
  v_add_f32 v220, v220, v120
  v_add_f32 v221, v221, v121
  v_add_f32 v222, v222, v122
  v_cvt_pk_bf16_f32 v220, v220, v221
  v_cvt_pk_bf16_f32 v222, v222, v222
  v_add_u32 v230, s58, v0
  v_mfma_f32_32x32x16_bf16 v[128:143], v[36:39], v[164:167], v[128:143]
  v_mul_u32_u24 v230, 6, v230
  v_add_u32 v230, 6400000, v230
  v_lshl_add_u32 v242, v250, 1, v242
  v_lshrrev_b32 v246, 3, v0
  v_and_b32 v247, 7, v0
  s_mul_i32 s3, s57, 4608
  v_mfma_f32_32x32x16_bf16 v[128:143], v[40:43], v[168:171], v[128:143]
  s_add_u32 s3, s3, 44544
  v_mul_u32_u24 v248, 144, v246
  v_lshl_add_u32 v248, v247, 4, v248
  v_add_u32 v248, s3, v248
  s_lshl_b32 s3, s58, 7
  v_lshl_add_u32 v231, v0, 4, s3
  v_mfma_f32_32x32x16_bf16 v[128:143], v[44:47], v[172:175], v[128:143]
  s_bfe_u32 s68, s78, 0x10018
  s_mul_i32 s68, s68, 255
  s_mov_b32 s69, 0
  s_mov_b32 exec_lo, s78
  s_mov_b32 exec_hi, 0
  buffer_store_short v220, v230, s[28:31], 0 offen
  buffer_store_short_d16_hi v220, v230, s[28:31], 0 offen offset:2
  buffer_store_short v222, v230, s[28:31], 0 offen offset:4
  s_mov_b64 exec, -1
  s_waitcnt lgkmcnt(0)
  v_mfma_f32_32x32x16_bf16 v[144:159], v[48:51], v[200:203], 0
  s_nop 0
  v_pk_mul_f32 v[2:3], v[128:129], s[70:71]
  v_pk_mul_f32 v[4:5], v[130:131], s[70:71]
  v_pk_mul_f32 v[6:7], v[132:133], s[70:71]
  v_pk_mul_f32 v[8:9], v[134:135], s[70:71]
  v_exp_f32 v2, v2
  v_mfma_f32_32x32x16_bf16 v[144:159], v[52:55], v[204:207], v[144:159]
  v_exp_f32 v3, v3
  v_exp_f32 v4, v4
  v_exp_f32 v5, v5
  v_exp_f32 v6, v6
  v_exp_f32 v7, v7
  v_exp_f32 v8, v8
  v_exp_f32 v9, v9
  v_mfma_f32_32x32x16_bf16 v[144:159], v[56:59], v[208:211], v[144:159]
  v_pk_add_f32 v[2:3], v[2:3], s[72:73]
  v_pk_add_f32 v[4:5], v[4:5], s[72:73]
  v_pk_add_f32 v[6:7], v[6:7], s[72:73]
  v_pk_add_f32 v[8:9], v[8:9], s[72:73]
  v_rcp_f32 v2, v2
  v_rcp_f32 v3, v3
  v_rcp_f32 v4, v4
  v_mfma_f32_32x32x16_bf16 v[144:159], v[60:63], v[212:215], v[144:159]
  v_rcp_f32 v5, v5
  v_rcp_f32 v6, v6
  v_rcp_f32 v7, v7
  v_rcp_f32 v8, v8
  v_rcp_f32 v9, v9
  v_pk_mul_f32 v[2:3], v[2:3], v[128:129]
  v_pk_mul_f32 v[4:5], v[4:5], v[130:131]
  v_mfma_f32_32x32x16_bf16 v[144:159], v[64:67], v[160:163], v[144:159]
  v_pk_mul_f32 v[6:7], v[6:7], v[132:133]
  v_pk_mul_f32 v[8:9], v[8:9], v[134:135]
  v_cvt_pk_bf16_f32 v176, v2, v3
  v_cvt_pk_bf16_f32 v177, v4, v5
  v_cvt_pk_bf16_f32 v178, v6, v7
  v_cvt_pk_bf16_f32 v179, v8, v9
  v_lshlrev_b32 v2, 16, v176
  v_mfma_f32_32x32x16_bf16 v[144:159], v[68:71], v[164:167], v[144:159]
  v_and_b32 v3, s65, v176
  v_lshlrev_b32 v4, 16, v200
  v_and_b32 v5, s65, v200
  v_pk_add_f32 v[2:3], v[2:3], v[4:5]
  v_cvt_pk_bf16_f32 v88, v2, v3
  v_lshlrev_b32 v6, 16, v177
  v_and_b32 v7, s65, v177
  v_mfma_f32_32x32x16_bf16 v[144:159], v[72:75], v[168:171], v[144:159]
  v_lshlrev_b32 v8, 16, v201
  v_and_b32 v9, s65, v201
  v_pk_add_f32 v[6:7], v[6:7], v[8:9]
  v_cvt_pk_bf16_f32 v89, v6, v7
  v_lshlrev_b32 v2, 16, v178
  v_and_b32 v3, s65, v178
  v_lshlrev_b32 v4, 16, v202
  v_mfma_f32_32x32x16_bf16 v[144:159], v[76:79], v[172:175], v[144:159]
  v_and_b32 v5, s65, v202
  v_pk_add_f32 v[2:3], v[2:3], v[4:5]
  v_cvt_pk_bf16_f32 v90, v2, v3
  v_lshlrev_b32 v6, 16, v179
  v_and_b32 v7, s65, v179
  v_lshlrev_b32 v8, 16, v203
  v_and_b32 v9, s65, v203
  v_pk_add_f32 v[6:7], v[6:7], v[8:9]
  v_cvt_pk_bf16_f32 v91, v6, v7
  ds_write_b128 v242, v[88:91] offset:0
  v_pk_mul_f32 v[2:3], v[136:137], s[70:71]
  v_pk_mul_f32 v[4:5], v[138:139], s[70:71]
  v_pk_mul_f32 v[6:7], v[140:141], s[70:71]
  v_pk_mul_f32 v[8:9], v[142:143], s[70:71]
  v_exp_f32 v2, v2
  v_exp_f32 v3, v3
  v_exp_f32 v4, v4
  v_exp_f32 v5, v5
  v_exp_f32 v6, v6
  v_exp_f32 v7, v7
  v_exp_f32 v8, v8
  v_exp_f32 v9, v9
  v_pk_add_f32 v[2:3], v[2:3], s[72:73]
  v_pk_add_f32 v[4:5], v[4:5], s[72:73]
  v_pk_add_f32 v[6:7], v[6:7], s[72:73]
  v_pk_add_f32 v[8:9], v[8:9], s[72:73]
  v_rcp_f32 v2, v2
  v_rcp_f32 v3, v3
  v_rcp_f32 v4, v4
  v_rcp_f32 v5, v5
  v_rcp_f32 v6, v6
  v_rcp_f32 v7, v7
  v_rcp_f32 v8, v8
  v_rcp_f32 v9, v9
  v_pk_mul_f32 v[2:3], v[2:3], v[136:137]
  v_pk_mul_f32 v[4:5], v[4:5], v[138:139]
  v_pk_mul_f32 v[6:7], v[6:7], v[140:141]
  v_pk_mul_f32 v[8:9], v[8:9], v[142:143]
  v_cvt_pk_bf16_f32 v176, v2, v3
  v_cvt_pk_bf16_f32 v177, v4, v5
  v_cvt_pk_bf16_f32 v178, v6, v7
  v_cvt_pk_bf16_f32 v179, v8, v9
  v_lshlrev_b32 v2, 16, v176
  v_and_b32 v3, s65, v176
  v_lshlrev_b32 v4, 16, v204
  v_and_b32 v5, s65, v204
  v_pk_add_f32 v[2:3], v[2:3], v[4:5]
  v_cvt_pk_bf16_f32 v92, v2, v3
  v_lshlrev_b32 v6, 16, v177
  v_and_b32 v7, s65, v177
  v_lshlrev_b32 v8, 16, v205
  v_and_b32 v9, s65, v205
  v_pk_add_f32 v[6:7], v[6:7], v[8:9]
  v_cvt_pk_bf16_f32 v93, v6, v7
  v_lshlrev_b32 v2, 16, v178
  v_and_b32 v3, s65, v178
  v_lshlrev_b32 v4, 16, v206
  v_and_b32 v5, s65, v206
  v_pk_add_f32 v[2:3], v[2:3], v[4:5]
  v_cvt_pk_bf16_f32 v94, v2, v3
  v_lshlrev_b32 v6, 16, v179
  v_and_b32 v7, s65, v179
  v_lshlrev_b32 v8, 16, v207
  v_and_b32 v9, s65, v207
  v_pk_add_f32 v[6:7], v[6:7], v[8:9]
  v_cvt_pk_bf16_f32 v95, v6, v7
  ds_write_b128 v242, v[92:95] offset:16
  v_pk_mul_f32 v[2:3], v[144:145], s[70:71]
  v_pk_mul_f32 v[4:5], v[146:147], s[70:71]
  v_pk_mul_f32 v[6:7], v[148:149], s[70:71]
  v_pk_mul_f32 v[8:9], v[150:151], s[70:71]
  v_exp_f32 v2, v2
  v_exp_f32 v3, v3
  v_exp_f32 v4, v4
  v_exp_f32 v5, v5
  v_exp_f32 v6, v6
  v_exp_f32 v7, v7
  v_exp_f32 v8, v8
  v_exp_f32 v9, v9
  v_pk_add_f32 v[2:3], v[2:3], s[72:73]
  v_pk_add_f32 v[4:5], v[4:5], s[72:73]
  v_pk_add_f32 v[6:7], v[6:7], s[72:73]
  v_pk_add_f32 v[8:9], v[8:9], s[72:73]
  v_rcp_f32 v2, v2
  v_rcp_f32 v3, v3
  v_rcp_f32 v4, v4
  v_rcp_f32 v5, v5
  v_rcp_f32 v6, v6
  v_rcp_f32 v7, v7
  v_rcp_f32 v8, v8
  v_rcp_f32 v9, v9
  v_pk_mul_f32 v[2:3], v[2:3], v[144:145]
  v_pk_mul_f32 v[4:5], v[4:5], v[146:147]
  v_pk_mul_f32 v[6:7], v[6:7], v[148:149]
  v_pk_mul_f32 v[8:9], v[8:9], v[150:151]
  v_cvt_pk_bf16_f32 v176, v2, v3
  v_cvt_pk_bf16_f32 v177, v4, v5
  v_cvt_pk_bf16_f32 v178, v6, v7
  v_cvt_pk_bf16_f32 v179, v8, v9
  v_lshlrev_b32 v2, 16, v176
  v_and_b32 v3, s65, v176
  v_lshlrev_b32 v4, 16, v208
  v_and_b32 v5, s65, v208
  v_pk_add_f32 v[2:3], v[2:3], v[4:5]
  v_cvt_pk_bf16_f32 v96, v2, v3
  v_lshlrev_b32 v6, 16, v177
  v_and_b32 v7, s65, v177
  v_lshlrev_b32 v8, 16, v209
  v_and_b32 v9, s65, v209
  v_pk_add_f32 v[6:7], v[6:7], v[8:9]
  v_cvt_pk_bf16_f32 v97, v6, v7
  v_lshlrev_b32 v2, 16, v178
  v_and_b32 v3, s65, v178
  v_lshlrev_b32 v4, 16, v210
  v_and_b32 v5, s65, v210
  v_pk_add_f32 v[2:3], v[2:3], v[4:5]
  v_cvt_pk_bf16_f32 v98, v2, v3
  v_lshlrev_b32 v6, 16, v179
  v_and_b32 v7, s65, v179
  v_lshlrev_b32 v8, 16, v211
  v_and_b32 v9, s65, v211
  v_pk_add_f32 v[6:7], v[6:7], v[8:9]
  v_cvt_pk_bf16_f32 v99, v6, v7
  ds_write_b128 v242, v[96:99] offset:32
  v_pk_mul_f32 v[2:3], v[152:153], s[70:71]
  v_pk_mul_f32 v[4:5], v[154:155], s[70:71]
  v_pk_mul_f32 v[6:7], v[156:157], s[70:71]
  v_pk_mul_f32 v[8:9], v[158:159], s[70:71]
  v_exp_f32 v2, v2
  v_exp_f32 v3, v3
  v_exp_f32 v4, v4
  v_exp_f32 v5, v5
  v_exp_f32 v6, v6
  v_exp_f32 v7, v7
  v_exp_f32 v8, v8
  v_exp_f32 v9, v9
  v_pk_add_f32 v[2:3], v[2:3], s[72:73]
  v_pk_add_f32 v[4:5], v[4:5], s[72:73]
  v_pk_add_f32 v[6:7], v[6:7], s[72:73]
  v_pk_add_f32 v[8:9], v[8:9], s[72:73]
  v_rcp_f32 v2, v2
  v_rcp_f32 v3, v3
  v_rcp_f32 v4, v4
  v_rcp_f32 v5, v5
  v_rcp_f32 v6, v6
  v_rcp_f32 v7, v7
  v_rcp_f32 v8, v8
  v_rcp_f32 v9, v9
  v_pk_mul_f32 v[2:3], v[2:3], v[152:153]
  v_pk_mul_f32 v[4:5], v[4:5], v[154:155]
  v_pk_mul_f32 v[6:7], v[6:7], v[156:157]
  v_pk_mul_f32 v[8:9], v[8:9], v[158:159]
  v_cvt_pk_bf16_f32 v176, v2, v3
  v_cvt_pk_bf16_f32 v177, v4, v5
  v_cvt_pk_bf16_f32 v178, v6, v7
  v_cvt_pk_bf16_f32 v179, v8, v9
  v_lshlrev_b32 v2, 16, v176
  v_and_b32 v3, s65, v176
  v_lshlrev_b32 v4, 16, v212
  v_and_b32 v5, s65, v212
  v_pk_add_f32 v[2:3], v[2:3], v[4:5]
  v_cvt_pk_bf16_f32 v100, v2, v3
  v_lshlrev_b32 v6, 16, v177
  v_and_b32 v7, s65, v177
  v_lshlrev_b32 v8, 16, v213
  v_and_b32 v9, s65, v213
  v_pk_add_f32 v[6:7], v[6:7], v[8:9]
  v_cvt_pk_bf16_f32 v101, v6, v7
  v_lshlrev_b32 v2, 16, v178
  v_and_b32 v3, s65, v178
  v_lshlrev_b32 v4, 16, v214
  v_and_b32 v5, s65, v214
  v_pk_add_f32 v[2:3], v[2:3], v[4:5]
  v_cvt_pk_bf16_f32 v102, v2, v3
  v_lshlrev_b32 v6, 16, v179
  v_and_b32 v7, s65, v179
  v_lshlrev_b32 v8, 16, v215
  v_and_b32 v9, s65, v215
  v_pk_add_f32 v[6:7], v[6:7], v[8:9]
  v_cvt_pk_bf16_f32 v103, v6, v7
  ds_write_b128 v242, v[100:103] offset:48
  ds_read_b128 v[128:131], v248 offset:0
  ds_read_b128 v[132:135], v248 offset:1152
  ds_read_b128 v[136:139], v248 offset:2304
  ds_read_b128 v[140:143], v248 offset:3456
  s_waitcnt lgkmcnt(3)
  buffer_store_dwordx4 v[128:131], v231, s[28:31], 0 offen offset:0
  s_waitcnt lgkmcnt(2)
  buffer_store_dwordx4 v[132:135], v231, s[28:31], 0 offen offset:1024
  s_waitcnt lgkmcnt(1)
  buffer_store_dwordx4 v[136:139], v231, s[28:31], 0 offen offset:2048
  s_waitcnt lgkmcnt(0)
  s_cmp_eq_u32 s68, 0
  s_cbranch_scc1 NO25
  s_mov_b64 exec, s[68:69]
  buffer_store_dwordx4 v[140:143], v231, s[28:31], 0 offen offset:3072
  s_mov_b64 exec, -1
NO25:
K2END:
  s_endpgm
.section .rodata,"a"
.p2align 6
.amdhsa_kernel part_kernel
  .amdhsa_next_free_vgpr 80
  .amdhsa_next_free_sgpr 102
  .amdhsa_accum_offset 80
  .amdhsa_group_segment_fixed_size 0
  .amdhsa_kernarg_size 88
  .amdhsa_user_sgpr_count 2
  .amdhsa_user_sgpr_kernarg_segment_ptr 1
  .amdhsa_system_sgpr_workgroup_id_x 1
.end_amdhsa_kernel
.p2align 6
.amdhsa_kernel main_kernel
  .amdhsa_next_free_vgpr 256
  .amdhsa_next_free_sgpr 102
  .amdhsa_accum_offset 256
  .amdhsa_group_segment_fixed_size 0
  .amdhsa_kernarg_size 88
  .amdhsa_user_sgpr_count 2
  .amdhsa_user_sgpr_kernarg_segment_ptr 1
  .amdhsa_system_sgpr_workgroup_id_x 1
.end_amdhsa_kernel
```

```asm
; @launch kernel=part_kernel grid=(251,1,1) block=(640,1,1) lds=93312
; @launch kernel=main_kernel grid=(256,1,1) block=(512,1,1) lds=163328
.amdgcn_target "amdgcn-amd-amdhsa--gfx950"
.text
.globl part_kernel
.p2align 8
.type part_kernel,@function
part_kernel:
  s_cmp_gt_u32 s2, 250
  s_cbranch_scc1 K1END
  s_load_dwordx2 s[8:9], s[0:1], 80
  s_sub_u32 s2, s2, 1
  s_cbranch_scc1 WPREP
  s_load_dwordx4 s[4:7], s[0:1], 24
  s_load_dwordx2 s[32:33], s[0:1], 16
  s_mul_i32 s3, s2, 12800
  v_lshlrev_b32 v2, 4, v0
  v_lshlrev_b32 v3, 2, v0
  v_add_u32 v3, 10240, v3
  v_and_b32 v1, 255, v0
  v_lshlrev_b32 v1, 2, v1
  v_mov_b32 v20, 0
  v_mov_b32 v21, 0
  v_mov_b32 v22, 0
  v_mov_b32 v23, 0
  s_waitcnt lgkmcnt(0)
  s_mov_b32 s12, s4
  s_mov_b32 s13, s5
  s_mov_b32 s14, 3200000
  s_mov_b32 s15, 0x20000
  s_mov_b32 s16, s6
  s_mov_b32 s17, s7
  s_mov_b32 s18, 3200000
  s_mov_b32 s19, 0x20000
  buffer_load_dwordx4 v[4:7], v2, s[16:19], s3 offen
  buffer_load_dword v8, v3, s[16:19], s3 offen
  buffer_load_dwordx4 v[12:15], v2, s[12:15], s3 offen
  buffer_load_dword v16, v3, s[12:15], s3 offen
  ds_write_b32 v1, v20 offset:58368
  ds_write_b32 v20, v20 offset:60416
  ds_write_b128 v2, v[20:23] offset:0
  ds_write_b128 v2, v[20:23] offset:10240
  ds_write_b128 v2, v[20:23] offset:20480
  ds_write_b128 v2, v[20:23] offset:30720
  s_mov_b32 s20, s8
  s_mov_b32 s21, s9
  s_mov_b32 s22, 8388608
  s_mov_b32 s23, 0x20000
  s_add_u32 s24, s8, 8388488
  s_addc_u32 s25, s9, 0
  s_mov_b32 s26, 14592120
  s_mov_b32 s27, 0x20000
  s_mov_b32 s28, 175921861
  s_movk_i32 s29, 3125
  s_mul_i32 s30, s2, 3200
  s_or_b32 s30, s30, 0x80000000
  v_mov_b32 v50, 1
  v_mov_b32 v49, 127
  v_lshl_add_u32 v51, v0, 2, s30
  s_add_u32 s30, s30, 2560
  v_add_u32 v52, s30, v0
  v_readfirstlane_b32 s31, v0
  v_lshrrev_b32 v55, 3, v0
  v_lshlrev_b32 v55, 2, v55
  v_add_u32 v55, 58368, v55
  v_add_u32 v60, 60544, v2
  v_and_b32 v61, 0, v0
  v_lshl_add_u32 v61, v61, 1, 15
  s_waitcnt lgkmcnt(0)
  s_barrier
  s_waitcnt vmcnt(2)
  v_mul_hi_u32 v37, s28, v4
  v_lshrrev_b32 v20, 1, v37
  v_and_b32 v20, 0x3fc, v20
  ds_add_rtn_u32 v28, v20, v50 offset:58368
  v_mul_hi_u32 v39, s28, v5
  v_lshrrev_b32 v21, 1, v39
  v_and_b32 v21, 0x3fc, v21
  ds_add_rtn_u32 v29, v21, v50 offset:58368
  v_mul_hi_u32 v41, s28, v6
  v_lshrrev_b32 v22, 1, v41
  v_and_b32 v22, 0x3fc, v22
  ds_add_rtn_u32 v30, v22, v50 offset:58368
  v_mul_hi_u32 v43, s28, v7
  v_lshrrev_b32 v23, 1, v43
  v_and_b32 v23, 0x3fc, v23
  ds_add_rtn_u32 v31, v23, v50 offset:58368
  v_mul_hi_u32 v45, s28, v8
  v_lshrrev_b32 v24, 1, v45
  v_and_b32 v24, 0x3fc, v24
  ds_add_rtn_u32 v32, v24, v50 offset:58368
  v_mad_u32_u24 v36, v37, s29, v49
  v_lshrrev_b32 v36, 7, v36
  v_sub_u32 v4, v4, v36
  v_and_b32 v37, 7, v37
  v_mad_u32_u24 v38, v39, s29, v49
  v_lshrrev_b32 v38, 7, v38
  v_sub_u32 v5, v5, v38
  v_and_b32 v39, 7, v39
  v_mad_u32_u24 v40, v41, s29, v49
  v_lshrrev_b32 v40, 7, v40
  v_sub_u32 v6, v6, v40
  v_and_b32 v41, 7, v41
  v_mad_u32_u24 v42, v43, s29, v49
  v_lshrrev_b32 v42, 7, v42
  v_sub_u32 v7, v7, v42
  v_and_b32 v43, 7, v43
  v_mad_u32_u24 v44, v45, s29, v49
  v_lshrrev_b32 v44, 7, v44
  v_sub_u32 v8, v8, v44
  v_and_b32 v45, 7, v45
  s_waitcnt vmcnt(0)
  v_lshl_or_b32 v36, v4, 27, v12
  v_lshrrev_b32 v12, 12, v12
  v_lshl_or_b32 v37, v37, 4, v12
  v_lshl_or_b32 v37, v37, 24, v51
  v_lshl_or_b32 v38, v5, 27, v13
  v_lshrrev_b32 v13, 12, v13
  v_lshl_or_b32 v39, v39, 4, v13
  v_add_u32 v51, 1, v51
  v_lshl_or_b32 v39, v39, 24, v51
  v_lshl_or_b32 v40, v6, 27, v14
  v_lshrrev_b32 v14, 12, v14
  v_lshl_or_b32 v41, v41, 4, v14
  v_add_u32 v51, 1, v51
  v_lshl_or_b32 v41, v41, 24, v51
  v_lshl_or_b32 v42, v7, 27, v15
  v_lshrrev_b32 v15, 12, v15
  v_lshl_or_b32 v43, v43, 4, v15
  v_add_u32 v51, 1, v51
  v_lshl_or_b32 v43, v43, 24, v51
  v_lshl_or_b32 v44, v8, 27, v16
  v_lshrrev_b32 v16, 12, v16
  v_lshl_or_b32 v45, v45, 4, v16
  v_lshl_or_b32 v45, v45, 24, v52
  v_lshrrev_b32 v3, 3, v0
  s_movk_i32 s3, 128
  v_mul_u32_u24 v3, s3, v3
  v_and_b32 v1, 7, v0
  v_lshl_add_u32 v3, v1, 4, v3
  s_mul_i32 s3, s2, 32896
  s_add_u32 s4, s3, 10240
  s_add_u32 s5, s3, 20480
  s_add_u32 s6, s3, 30720
  s_mul_i32 s7, s2, 58368
  s_mov_b32 s33, 0
  s_mov_b32 s34, 0xfff20000
  v_mov_b32 v1, 60416
  v_lshlrev_b32 v4, 5, v20
  v_lshlrev_b32 v5, 5, v21
  v_lshlrev_b32 v6, 5, v22
  v_lshlrev_b32 v7, 5, v23
  v_lshlrev_b32 v8, 5, v24
  s_waitcnt lgkmcnt(4)
  v_cmp_gt_u32 s[40:41], 15, v28
  v_lshl_add_u32 v12, v28, 3, v4
  s_waitcnt lgkmcnt(3)
  v_cmp_gt_u32 s[42:43], 15, v29
  v_lshl_add_u32 v13, v29, 3, v5
  s_waitcnt lgkmcnt(2)
  v_cmp_gt_u32 s[44:45], 15, v30
  v_lshl_add_u32 v14, v30, 3, v6
  s_waitcnt lgkmcnt(1)
  v_cmp_gt_u32 s[46:47], 15, v31
  v_lshl_add_u32 v15, v31, 3, v7
  s_waitcnt lgkmcnt(0)
  v_cmp_gt_u32 s[48:49], 15, v32
  v_lshl_add_u32 v16, v32, 3, v8
  v_max3_u32 v48, v28, v29, v30
  v_max3_u32 v48, v48, v31, v32
  v_cmp_le_u32 s[50:51], 31, v48
  s_mov_b64 exec, s[40:41]
  ds_write_b64 v12, v[36:37]
  s_mov_b64 exec, s[42:43]
  ds_write_b64 v13, v[38:39]
  s_mov_b64 exec, s[44:45]
  ds_write_b64 v14, v[40:41]
  s_mov_b64 exec, s[46:47]
  ds_write_b64 v15, v[42:43]
  s_mov_b64 exec, s[48:49]
  ds_write_b64 v16, v[44:45]
  s_not_b64 exec, s[40:41]
  s_cbranch_scc0 K1N0
  v_lshl_add_u32 v48, v20, 2, s34
  v_lshl_add_u32 v48, v28, 16, v48
  ds_max_u32 v4, v48 offset:120
  v_cmpx_gt_u32 vcc, 31, v28
  ds_write_b64 v12, v[36:37] offset:60424
K1N0:
  s_not_b64 exec, s[42:43]
  s_cbranch_scc0 K1N1
  v_lshl_add_u32 v48, v21, 2, s34
  v_lshl_add_u32 v48, v29, 16, v48
  ds_max_u32 v5, v48 offset:120
  v_cmpx_gt_u32 vcc, 31, v29
  ds_write_b64 v13, v[38:39] offset:60424
K1N1:
  s_not_b64 exec, s[44:45]
  s_cbranch_scc0 K1N2
  v_lshl_add_u32 v48, v22, 2, s34
  v_lshl_add_u32 v48, v30, 16, v48
  ds_max_u32 v6, v48 offset:120
  v_cmpx_gt_u32 vcc, 31, v30
  ds_write_b64 v14, v[40:41] offset:60424
K1N2:
  s_not_b64 exec, s[46:47]
  s_cbranch_scc0 K1N3
  v_lshl_add_u32 v48, v23, 2, s34
  v_lshl_add_u32 v48, v31, 16, v48
  ds_max_u32 v7, v48 offset:120
  v_cmpx_gt_u32 vcc, 31, v31
  ds_write_b64 v15, v[42:43] offset:60424
K1N3:
  s_not_b64 exec, s[48:49]
  s_cbranch_scc0 K1N4
  v_lshl_add_u32 v48, v24, 2, s34
  v_lshl_add_u32 v48, v32, 16, v48
  ds_max_u32 v8, v48 offset:120
  v_cmpx_gt_u32 vcc, 31, v32
  ds_write_b64 v16, v[44:45] offset:60424
K1N4:
  s_mov_b64 exec, s[50:51]
  ds_write_b32 v1, v50
  s_mov_b64 exec, -1
  s_waitcnt lgkmcnt(0)
  s_barrier
  ds_read_b32 v48, v1
  ds_read2_b32 v[56:57], v55 offset0:0 offset1:80
  ds_read2_b32 v[58:59], v55 offset0:160 offset1:240
K1RD:
  ds_read_b128 v[4:7], v2
  ds_read_b128 v[8:11], v2 offset:10240
  ds_read_b128 v[12:15], v2 offset:20480
  ds_read_b128 v[16:19], v2 offset:30720
  s_waitcnt lgkmcnt(3)
  v_cmp_ne_u32 vcc, 0, v48
  s_cbranch_vccnz K1SLOW
  v_cmp_lt_u32 s[40:41], v61, v56
  v_cmp_lt_u32 s[42:43], v61, v57
  v_cmp_lt_u32 s[44:45], v61, v58
  s_mov_b64 exec, s[40:41]
  ds_read_b128 v[64:67], v60
  s_mov_b64 exec, s[42:43]
  ds_read_b128 v[68:71], v60 offset:10240
  s_mov_b64 exec, s[44:45]
  ds_read_b128 v[72:75], v60 offset:20480
  s_mov_b64 exec, -1
  buffer_store_dwordx4 v[4:7], v3, s[20:23], s3 offen sc1
  s_waitcnt lgkmcnt(5)
  buffer_store_dwordx4 v[8:11], v3, s[20:23], s4 offen sc1
  s_waitcnt lgkmcnt(4)
  buffer_store_dwordx4 v[12:15], v3, s[20:23], s5 offen sc1
  s_add_u32 s4, s7, 10240
  s_add_u32 s5, s7, 20480
  s_mov_b64 exec, s[40:41]
  s_waitcnt lgkmcnt(2)
  buffer_store_dwordx4 v[64:67], v2, s[24:27], s7 offen offset:120 sc1
  s_mov_b64 exec, s[42:43]
  s_waitcnt lgkmcnt(1)
  buffer_store_dwordx4 v[68:71], v2, s[24:27], s4 offen offset:120 sc1
  s_mov_b64 exec, s[44:45]
  s_waitcnt lgkmcnt(0)
  buffer_store_dwordx4 v[72:75], v2, s[24:27], s5 offen offset:120 sc1
  s_mov_b64 exec, -1
  s_add_u32 s5, s7, 30720
  s_add_u32 s7, s7, 32888
  s_cmp_ge_u32 s31, 128
  s_cbranch_scc1 K1OV
  ds_read_b128 v[76:79], v60 offset:30720
  buffer_store_dwordx4 v[16:19], v3, s[20:23], s6 offen sc1
  v_cmpx_lt_u32 vcc, v61, v59
  s_waitcnt lgkmcnt(0)
  buffer_store_dwordx4 v[76:79], v2, s[24:27], s5 offen offset:120 sc1
  s_mov_b64 exec, -1
K1OV:
  v_cmpx_gt_u32 vcc, s33, v2
  s_cbranch_execz K1FIN
  ds_read_b128 v[20:23], v2 offset:32768
  s_waitcnt lgkmcnt(0)
  buffer_store_dwordx4 v[20:23], v2, s[24:27], s7 offen sc1
  v_add_u32 v2, 10240, v2
  s_waitcnt vmcnt(0)
  s_branch K1OV
K1FIN:
K1END:
  s_endpgm
K1SLOW:
  v_and_b32 v1, 63, v0
  v_lshlrev_b32 v53, 9, v1
  v_lshlrev_b32 v1, 4, v1
  v_mov_b32 v48, 0xffff0000
  v_mov_b32 v49, 0xf0ff1
  s_waitcnt lgkmcnt(0)
  ds_read_b128 v[4:7], v1 offset:58368
  s_waitcnt lgkmcnt(0)
  v_cmp_lt_u32 s[40:41], 31, v4
  v_subrev_u32 v4, 15, v4
  v_cmp_lt_u32 s[42:43], 31, v5
  v_subrev_u32 v5, 15, v5
  v_cmp_lt_u32 s[44:45], 31, v6
  v_subrev_u32 v6, 15, v6
  v_cmp_lt_u32 s[46:47], 31, v7
  v_subrev_u32 v7, 15, v7
  v_cndmask_b32 v4, 0, v4, s[40:41]
  v_cndmask_b32 v5, 0, v5, s[42:43]
  v_cndmask_b32 v6, 0, v6, s[44:45]
  v_cndmask_b32 v7, 0, v7, s[46:47]
  v_add_u32 v8, v4, v5
  v_add_u32 v9, v8, v6
  v_add_u32 v10, v9, v7
  v_mov_b32 v11, v10
  s_nop 1
  v_add_u32_dpp v11, v11, v11 row_shr:1 row_mask:0xf bank_mask:0xf
  s_nop 1
  v_add_u32_dpp v11, v11, v11 row_shr:2 row_mask:0xf bank_mask:0xf
  s_nop 1
  v_add_u32_dpp v11, v11, v11 row_shr:4 row_mask:0xf bank_mask:0xf
  s_nop 1
  v_add_u32_dpp v11, v11, v11 row_shr:8 row_mask:0xf bank_mask:0xf
  s_nop 1
  v_add_u32_dpp v11, v11, v11 row_bcast:15 row_mask:0xa bank_mask:0xf
  s_nop 1
  v_add_u32_dpp v11, v11, v11 row_bcast:31 row_mask:0xc bank_mask:0xf
  v_cndmask_b32 v16, v48, v49, s[40:41]
  v_cndmask_b32 v17, v48, v49, s[42:43]
  v_cndmask_b32 v18, v48, v49, s[44:45]
  v_cndmask_b32 v19, v48, v49, s[46:47]
  v_sub_u32 v12, v11, v10
  v_add_u32 v13, v12, v4
  v_add_u32 v14, v12, v8
  v_add_u32 v15, v12, v9
  v_readlane_b32 s33, v11, 63
  v_add_u32 v16, v16, v12
  v_add_u32 v17, v17, v13
  v_add_u32 v18, v18, v14
  v_add_u32 v19, v19, v15
  ds_write_b128 v1, v[16:19] offset:59392
  ds_read_b32 v20, v20 offset:59392
  ds_read_b32 v21, v21 offset:59392
  ds_read_b32 v22, v22 offset:59392
  ds_read_b32 v23, v23 offset:59392
  ds_read_b32 v24, v24 offset:59392
  v_lshl_or_b32 v4, v4, 16, v12
  v_add_u32 v4, 4096, v4
  s_mov_b64 exec, s[40:41]
  ds_write_b32 v53, v4 offset:120
  s_mov_b64 exec, -1
  v_lshl_or_b32 v5, v5, 16, v13
  v_add_u32 v5, 4096, v5
  s_mov_b64 exec, s[42:43]
  ds_write_b32 v53, v5 offset:248
  s_mov_b64 exec, -1
  v_lshl_or_b32 v6, v6, 16, v14
  v_add_u32 v6, 4096, v6
  s_mov_b64 exec, s[44:45]
  ds_write_b32 v53, v6 offset:376
  s_mov_b64 exec, -1
  v_lshl_or_b32 v7, v7, 16, v15
  v_add_u32 v7, 4096, v7
  s_mov_b64 exec, s[46:47]
  ds_write_b32 v53, v7 offset:504
  s_mov_b64 exec, -1
  s_waitcnt lgkmcnt(0)
  v_cmp_ge_u32_sdwa vcc, v28, v20 src0_sel:DWORD src1_sel:WORD_1
  v_and_b32 v20, 0xffff, v20
  v_add_lshl_u32 v20, v20, v28, 3
  s_mov_b64 exec, vcc
  ds_write_b64 v20, v[36:37]
  s_mov_b64 exec, -1
  v_cmp_ge_u32_sdwa vcc, v29, v21 src0_sel:DWORD src1_sel:WORD_1
  v_and_b32 v21, 0xffff, v21
  v_add_lshl_u32 v21, v21, v29, 3
  s_mov_b64 exec, vcc
  ds_write_b64 v21, v[38:39]
  s_mov_b64 exec, -1
  v_cmp_ge_u32_sdwa vcc, v30, v22 src0_sel:DWORD src1_sel:WORD_1
  v_and_b32 v22, 0xffff, v22
  v_add_lshl_u32 v22, v22, v30, 3
  s_mov_b64 exec, vcc
  ds_write_b64 v22, v[40:41]
  s_mov_b64 exec, -1
  v_cmp_ge_u32_sdwa vcc, v31, v23 src0_sel:DWORD src1_sel:WORD_1
  v_and_b32 v23, 0xffff, v23
  v_add_lshl_u32 v23, v23, v31, 3
  s_mov_b64 exec, vcc
  ds_write_b64 v23, v[42:43]
  s_mov_b64 exec, -1
  v_cmp_ge_u32_sdwa vcc, v32, v24 src0_sel:DWORD src1_sel:WORD_1
  v_and_b32 v24, 0xffff, v24
  v_add_lshl_u32 v24, v24, v32, 3
  s_mov_b64 exec, vcc
  ds_write_b64 v24, v[44:45]
  s_mov_b64 exec, -1
  s_lshl_b32 s33, s33, 3
  v_mov_b32 v48, 0
  s_waitcnt lgkmcnt(0)
  s_barrier
  s_branch K1RD
WPREP:
  s_load_dwordx4 s[4:7], s[0:1], 40
  v_lshrrev_b32 v2, 6, v0
  v_and_b32 v1, 63, v0
  v_readfirstlane_b32 s31, v2
  s_mov_b32 s28, 0xbfb8aa3b
  s_mov_b32 s29, 0xbfb8aa3b
  s_mov_b32 s30, 0xffff0000
  s_waitcnt lgkmcnt(0)
  s_mov_b32 s12, s4
  s_mov_b32 s13, s5
  s_mov_b32 s14, 18560
  s_mov_b32 s15, 0x20000
  s_mov_b32 s16, s6
  s_mov_b32 s17, s7
  s_mov_b32 s18, 128
  s_mov_b32 s19, 0x20000
  s_add_u32 s20, s8, 23068672
  s_addc_u32 s21, s9, 0
  s_mov_b32 s22, 24576
  s_mov_b32 s23, 0x20000
  v_and_b32 v2, 7, v1
  v_bfe_u32 v3, v1, 4, 1
  v_lshlrev_b32 v4, 2, v3
  v_xor_b32 v4, v4, v2
  v_lshlrev_b32 v4, 4, v4
  v_lshrrev_b32 v5, 3, v1
  v_lshl_or_b32 v4, v5, 7, v4
  s_lshl_b32 s3, s31, 10
  s_add_u32 s4, s3, 10240
  v_add_u32 v4, s3, v4
  s_mov_b32 m0, s3
  s_nop 0
  buffer_load_dwordx4 v4, s[12:15], 0 offen lds
  v_add_u32 v4, 10240, v4
  s_mov_b32 m0, s4
  s_nop 0
  buffer_load_dwordx4 v4, s[12:15], 0 offen lds
  v_lshrrev_b32 v5, 5, v1
  v_lshlrev_b32 v7, 3, v5
  buffer_load_dwordx2 v[28:29], v7, s[16:19], 0 offen offset:0
  buffer_load_dwordx2 v[30:31], v7, s[16:19], 0 offen offset:16
  buffer_load_dwordx2 v[32:33], v7, s[16:19], 0 offen offset:32
  buffer_load_dwordx2 v[34:35], v7, s[16:19], 0 offen offset:48
  buffer_load_dwordx2 v[36:37], v7, s[16:19], 0 offen offset:64
  buffer_load_dwordx2 v[38:39], v7, s[16:19], 0 offen offset:80
  buffer_load_dwordx2 v[40:41], v7, s[16:19], 0 offen offset:96
  buffer_load_dwordx2 v[42:43], v7, s[16:19], 0 offen offset:112
  v_and_b32 v2, 3, v1
  v_bfe_u32 v4, v1, 2, 2
  v_lshlrev_b32 v2, 3, v2
  v_lshl_add_u32 v2, v3, 5, v2
  v_lshl_add_u32 v2, v4, 7, v2
  v_lshl_add_u32 v6, v5, 12, v2
  v_lshrrev_b32 v3, 1, v4
  v_lshl_add_u32 v6, v3, 6, v6
  v_lshl_add_u32 v8, v5, 10, v2
  v_add_u32 v3, 1, v4
  v_bfe_u32 v3, v3, 1, 1
  v_lshl_add_u32 v8, v3, 6, v8
  v_xor_b32 v9, 64, v8
  s_and_b32 s3, s31, 1
  s_lshl_b32 s3, s3, 6
  v_xor_b32 v6, s3, v6
  s_lshr_b32 s3, s31, 1
  s_lshl_b32 s3, s3, 13
  v_add_u32 v6, s3, v6
  v_lshlrev_b32 v10, 4, v1
  s_lshl_b32 s3, s31, 12
  s_mov_b64 exec, 0
WPGO:
  s_cmp_eq_u32 s31, 4
  s_cbranch_scc1 WP4
  s_cmp_eq_u32 s31, 5
  s_cbranch_scc1 WP5
  s_cmp_gt_u32 s31, 5
  s_cbranch_scc1 WPEND
  ds_read_b64_tr_b16 v[12:13], v6 offset:0
  ds_read_b64_tr_b16 v[14:15], v6 offset:512
  ds_read_b64_tr_b16 v[16:17], v6 offset:1024
  ds_read_b64_tr_b16 v[18:19], v6 offset:1536
  ds_read_b64_tr_b16 v[20:21], v6 offset:2048
  ds_read_b64_tr_b16 v[22:23], v6 offset:2560
  ds_read_b64_tr_b16 v[24:25], v6 offset:3072
  ds_read_b64_tr_b16 v[26:27], v6 offset:3584
  s_waitcnt lgkmcnt(0)
  s_cmp_lt_u32 s31, 2
  s_cbranch_scc1 WPST
  v_lshlrev_b32 v2, 16, v12
  v_and_b32 v3, s30, v12
  v_pk_mul_f32 v[2:3], v[2:3], s[28:29]
  v_cvt_pk_bf16_f32 v12, v2, v3
  v_lshlrev_b32 v2, 16, v13
  v_and_b32 v3, s30, v13
  v_pk_mul_f32 v[2:3], v[2:3], s[28:29]
  v_cvt_pk_bf16_f32 v13, v2, v3
  v_lshlrev_b32 v2, 16, v14
  v_and_b32 v3, s30, v14
  v_pk_mul_f32 v[2:3], v[2:3], s[28:29]
  v_cvt_pk_bf16_f32 v14, v2, v3
  v_lshlrev_b32 v2, 16, v15
  v_and_b32 v3, s30, v15
  v_pk_mul_f32 v[2:3], v[2:3], s[28:29]
  v_cvt_pk_bf16_f32 v15, v2, v3
  v_lshlrev_b32 v2, 16, v16
  v_and_b32 v3, s30, v16
  v_pk_mul_f32 v[2:3], v[2:3], s[28:29]
  v_cvt_pk_bf16_f32 v16, v2, v3
  v_lshlrev_b32 v2, 16, v17
  v_and_b32 v3, s30, v17
  v_pk_mul_f32 v[2:3], v[2:3], s[28:29]
  v_cvt_pk_bf16_f32 v17, v2, v3
  v_lshlrev_b32 v2, 16, v18
  v_and_b32 v3, s30, v18
  v_pk_mul_f32 v[2:3], v[2:3], s[28:29]
  v_cvt_pk_bf16_f32 v18, v2, v3
  v_lshlrev_b32 v2, 16, v19
  v_and_b32 v3, s30, v19
  v_pk_mul_f32 v[2:3], v[2:3], s[28:29]
  v_cvt_pk_bf16_f32 v19, v2, v3
  v_lshlrev_b32 v2, 16, v20
  v_and_b32 v3, s30, v20
  v_pk_mul_f32 v[2:3], v[2:3], s[28:29]
  v_cvt_pk_bf16_f32 v20, v2, v3
  v_lshlrev_b32 v2, 16, v21
  v_and_b32 v3, s30, v21
  v_pk_mul_f32 v[2:3], v[2:3], s[28:29]
  v_cvt_pk_bf16_f32 v21, v2, v3
  v_lshlrev_b32 v2, 16, v22
  v_and_b32 v3, s30, v22
  v_pk_mul_f32 v[2:3], v[2:3], s[28:29]
  v_cvt_pk_bf16_f32 v22, v2, v3
  v_lshlrev_b32 v2, 16, v23
  v_and_b32 v3, s30, v23
  v_pk_mul_f32 v[2:3], v[2:3], s[28:29]
  v_cvt_pk_bf16_f32 v23, v2, v3
  v_lshlrev_b32 v2, 16, v24
  v_and_b32 v3, s30, v24
  v_pk_mul_f32 v[2:3], v[2:3], s[28:29]
  v_cvt_pk_bf16_f32 v24, v2, v3
  v_lshlrev_b32 v2, 16, v25
  v_and_b32 v3, s30, v25
  v_pk_mul_f32 v[2:3], v[2:3], s[28:29]
  v_cvt_pk_bf16_f32 v25, v2, v3
  v_lshlrev_b32 v2, 16, v26
  v_and_b32 v3, s30, v26
  v_pk_mul_f32 v[2:3], v[2:3], s[28:29]
  v_cvt_pk_bf16_f32 v26, v2, v3
  v_lshlrev_b32 v2, 16, v27
  v_and_b32 v3, s30, v27
  v_pk_mul_f32 v[2:3], v[2:3], s[28:29]
  v_cvt_pk_bf16_f32 v27, v2, v3
WPST:
  buffer_store_dwordx4 v[12:15], v10, s[20:23], s3 offen offset:0
  buffer_store_dwordx4 v[16:19], v10, s[20:23], s3 offen offset:1024
  buffer_store_dwordx4 v[20:23], v10, s[20:23], s3 offen offset:2048
  buffer_store_dwordx4 v[24:27], v10, s[20:23], s3 offen offset:3072
  s_branch WPEND
WP4:
  ds_read_b64_tr_b16 v[12:13], v8 offset:16512
  ds_read_b64_tr_b16 v[14:15], v8 offset:17024
  ds_read_b64_tr_b16 v[16:17], v9 offset:16512
  ds_read_b64_tr_b16 v[18:19], v9 offset:17024
  v_and_b32 v2, 31, v1
  v_lshlrev_b32 v2, 1, v2
  ds_read_u16 v20, v2 offset:16384
  ds_read_u16 v21, v2 offset:16448
  v_subrev_u32 v5, 1, v5
  s_waitcnt lgkmcnt(0)
  v_lshlrev_b32 v2, 16, v12
  v_and_b32 v3, s30, v12
  v_pk_mul_f32 v[2:3], v[2:3], s[28:29]
  v_cvt_pk_bf16_f32 v12, v2, v3
  v_lshlrev_b32 v2, 16, v13
  v_and_b32 v3, s30, v13
  v_pk_mul_f32 v[2:3], v[2:3], s[28:29]
  v_cvt_pk_bf16_f32 v13, v2, v3
  v_lshlrev_b32 v2, 16, v14
  v_and_b32 v3, s30, v14
  v_pk_mul_f32 v[2:3], v[2:3], s[28:29]
  v_cvt_pk_bf16_f32 v14, v2, v3
  v_lshlrev_b32 v2, 16, v15
  v_and_b32 v3, s30, v15
  v_pk_mul_f32 v[2:3], v[2:3], s[28:29]
  v_cvt_pk_bf16_f32 v15, v2, v3
  v_lshlrev_b32 v2, 16, v16
  v_and_b32 v3, s30, v16
  v_pk_mul_f32 v[2:3], v[2:3], s[28:29]
  v_cvt_pk_bf16_f32 v16, v2, v3
  v_lshlrev_b32 v2, 16, v17
  v_and_b32 v3, s30, v17
  v_pk_mul_f32 v[2:3], v[2:3], s[28:29]
  v_cvt_pk_bf16_f32 v17, v2, v3
  v_lshlrev_b32 v2, 16, v18
  v_and_b32 v3, s30, v18
  v_pk_mul_f32 v[2:3], v[2:3], s[28:29]
  v_cvt_pk_bf16_f32 v18, v2, v3
  v_lshlrev_b32 v2, 16, v19
  v_and_b32 v3, s30, v19
  v_pk_mul_f32 v[2:3], v[2:3], s[28:29]
  v_cvt_pk_bf16_f32 v19, v2, v3
  v_lshlrev_b32 v20, 16, v20
  v_mul_f32 v20, s28, v20
  v_cvt_pk_f16_f32 v20, v20, 0
  v_and_b32 v20, v5, v20
  v_mov_b32 v22, 0
  v_lshlrev_b32 v21, 16, v21
  v_mul_f32 v21, s28, v21
  v_cvt_pk_f16_f32 v21, v21, 0
  v_and_b32 v21, v5, v21
  v_mov_b32 v23, 0
  buffer_store_dwordx4 v[12:15], v10, s[20:23], s3 offen offset:0
  buffer_store_dwordx4 v[16:19], v10, s[20:23], s3 offen offset:1024
  buffer_store_dwordx4 v[20:23], v10, s[20:23], s3 offen offset:2048
  buffer_store_dwordx4 v[20:23], v10, s[20:23], s3 offen offset:3072
  s_branch WPEND
WP5:
  v_lshrrev_b32 v4, 2, v1
  v_lshrrev_b32 v8, 4, v1
  v_xor_b32 v4, v4, v8
  v_and_b32 v4, 1, v4
  v_subrev_u32 v4, 1, v4
  v_lshlrev_b32 v2, 16, v28
  v_and_b32 v3, s30, v28
  v_cvt_pk_f16_f32 v2, v2, v3
  v_and_b32 v12, v4, v2
  v_lshlrev_b32 v2, 16, v29
  v_and_b32 v3, s30, v29
  v_cvt_pk_f16_f32 v2, v2, v3
  v_and_b32 v13, v4, v2
  v_lshlrev_b32 v2, 16, v30
  v_and_b32 v3, s30, v30
  v_cvt_pk_f16_f32 v2, v2, v3
  v_and_b32 v14, v4, v2
  v_lshlrev_b32 v2, 16, v31
  v_and_b32 v3, s30, v31
  v_cvt_pk_f16_f32 v2, v2, v3
  v_and_b32 v15, v4, v2
  v_lshlrev_b32 v2, 16, v32
  v_and_b32 v3, s30, v32
  v_cvt_pk_f16_f32 v2, v2, v3
  v_and_b32 v16, v4, v2
  v_lshlrev_b32 v2, 16, v33
  v_and_b32 v3, s30, v33
  v_cvt_pk_f16_f32 v2, v2, v3
  v_and_b32 v17, v4, v2
  v_lshlrev_b32 v2, 16, v34
  v_and_b32 v3, s30, v34
  v_cvt_pk_f16_f32 v2, v2, v3
  v_and_b32 v18, v4, v2
  v_lshlrev_b32 v2, 16, v35
  v_and_b32 v3, s30, v35
  v_cvt_pk_f16_f32 v2, v2, v3
  v_and_b32 v19, v4, v2
  v_lshlrev_b32 v2, 16, v36
  v_and_b32 v3, s30, v36
  v_cvt_pk_f16_f32 v2, v2, v3
  v_and_b32 v20, v4, v2
  v_lshlrev_b32 v2, 16, v37
  v_and_b32 v3, s30, v37
  v_cvt_pk_f16_f32 v2, v2, v3
  v_and_b32 v21, v4, v2
  v_lshlrev_b32 v2, 16, v38
  v_and_b32 v3, s30, v38
  v_cvt_pk_f16_f32 v2, v2, v3
  v_and_b32 v22, v4, v2
  v_lshlrev_b32 v2, 16, v39
  v_and_b32 v3, s30, v39
  v_cvt_pk_f16_f32 v2, v2, v3
  v_and_b32 v23, v4, v2
  v_lshlrev_b32 v2, 16, v40
  v_and_b32 v3, s30, v40
  v_cvt_pk_f16_f32 v2, v2, v3
  v_and_b32 v24, v4, v2
  v_lshlrev_b32 v2, 16, v41
  v_and_b32 v3, s30, v41
  v_cvt_pk_f16_f32 v2, v2, v3
  v_and_b32 v25, v4, v2
  v_lshlrev_b32 v2, 16, v42
  v_and_b32 v3, s30, v42
  v_cvt_pk_f16_f32 v2, v2, v3
  v_and_b32 v26, v4, v2
  v_lshlrev_b32 v2, 16, v43
  v_and_b32 v3, s30, v43
  v_cvt_pk_f16_f32 v2, v2, v3
  v_and_b32 v27, v4, v2
  s_branch WPST
WPEND:
  s_cbranch_execnz WPX
  s_mov_b64 exec, -1
  s_waitcnt vmcnt(0)
  s_barrier
  s_branch WPGO
WPX:
  s_endpgm
.globl main_kernel
.p2align 8
.type main_kernel,@function
main_kernel:
  s_cmp_ge_u32 s2, 256
  s_cbranch_scc1 K2END
  s_load_dwordx2 s[52:53], s[0:1], 80
  s_load_dwordx8 s[32:39], s[0:1], 0
  s_load_dwordx4 s[48:51], s[0:1], 56
  s_and_b32 s3, s2, 7
  s_lshl_b32 s3, s3, 5
  s_lshr_b32 s56, s2, 3
  s_add_u32 s56, s56, s3
  v_lshrrev_b32 v2, 6, v0
  v_and_b32 v0, 63, v0
  v_readfirstlane_b32 s57, v2
  s_mov_b32 s60, 47
  s_mov_b32 s61, 0
  s_mov_b32 s63, 1
  s_mov_b32 s54, 1
  s_movk_i32 s55, 2176
  s_movk_i32 s94, 17404
  s_movk_i32 s95, 0xf0
  s_movk_i32 s64, 128
  s_mov_b32 s65, 0xffff0000
  s_mov_b32 s70, 0xbfb8aa3b
  s_mov_b32 s71, 0xbfb8aa3b
  s_mov_b32 s72, 1.0
  s_mov_b32 s73, 1.0
  s_mov_b32 s74, -1
  s_mov_b32 s75, 0
  s_lshl_b32 s66, s57, 12
  s_add_u32 s66, s66, 81408
  s_lshl_b32 s67, s57, 10
  s_add_u32 s67, s67, 36352
  s_mul_i32 s3, s56, 128
  s_mov_b32 s18, 8191232
  s_mov_b32 s19, 0x20000
  s_waitcnt lgkmcnt(0)
  s_add_u32 s16, s52, s3
  s_addc_u32 s17, s53, 0
ROUND:
  s_lshl_b32 s3, s57, 12
  v_lshl_add_u32 v2, v0, 4, s3
  v_lshrrev_b32 v3, 7, v2
  v_lshl_add_u32 v2, v3, 15, v2
  buffer_load_dwordx4 v[128:131], v2, s[16:19], 0 offen offset:0
  v_add_u32 v2, 262144, v2
  buffer_load_dwordx4 v[132:135], v2, s[16:19], 0 offen offset:1024
  v_add_u32 v2, 262144, v2
  buffer_load_dwordx4 v[136:139], v2, s[16:19], 0 offen offset:2048
  v_add_u32 v2, 262144, v2
  buffer_load_dwordx4 v[140:143], v2, s[16:19], 0 offen offset:3072
  s_and_b32 s3, s57, 3
  s_lshl_b32 s3, s3, 8
  v_lshl_add_u32 v4, v0, 2, s3
  v_mov_b32 v5, 0
  ds_write_b32 v4, v5 offset:34816
  s_cmp_eq_u32 s63, 0
  s_cbranch_scc1 NOTFIRST1
  s_mov_b32 s4, s32
  s_mov_b32 s5, s33
  s_mov_b32 s6, 6400000
  s_mov_b32 s7, 0x20000
  s_mov_b32 s12, s34
  s_mov_b32 s13, s35
  s_mov_b32 s14, 300000
  s_mov_b32 s15, 0x20000
  v_and_b32 v2, 7, v0
  v_bfe_u32 v3, v0, 4, 1
  v_lshrrev_b32 v5, 3, v0
  v_lshrrev_b32 v6, 5, v0
  v_lshl_add_u32 v233, v6, 2, 0
  v_xor_b32 v233, v233, v2
  v_lshlrev_b32 v233, 4, v233
  v_lshl_add_u32 v234, v6, 2, 1
  v_xor_b32 v234, v234, v2
  v_lshlrev_b32 v234, 4, v234
  v_lshl_add_u32 v235, v6, 2, 2
  v_xor_b32 v235, v235, v2
  v_lshlrev_b32 v235, 4, v235
  v_lshl_add_u32 v236, v6, 2, 3
  v_xor_b32 v236, v236, v2
  v_lshlrev_b32 v236, 4, v236
  v_lshl_add_u32 v7, v5, 2, 0
  v_mad_u32_u24 v56, v7, s64, v233
  v_lshl_add_u32 v7, v5, 2, 1
  v_mad_u32_u24 v57, v7, s64, v234
  v_lshl_add_u32 v7, v5, 2, 2
  v_mad_u32_u24 v58, v7, s64, v235
  v_lshl_add_u32 v7, v5, 2, 3
  v_mad_u32_u24 v59, v7, s64, v236
  s_mov_b32 s8, s36
  s_mov_b32 s9, s37
  s_mov_b32 s10, 25600000
  s_mov_b32 s11, 0x20000
  s_mov_b32 s28, s50
  s_mov_b32 s29, s51
  s_mov_b32 s30, 6700000
  s_mov_b32 s31, 0x20000
  s_mov_b32 s24, s48
  s_mov_b32 s25, s49
  s_mov_b32 s26, 16384
  s_mov_b32 s27, 0x20000
  s_add_u32 s20, s52, 8388608
  s_addc_u32 s21, s53, 0
  s_mov_b32 s22, 14704640
  s_mov_b32 s23, 0x20000
  v_lshlrev_b32 v13, 1, v3
  v_xor_b32 v13, v13, v2
  v_lshlrev_b32 v13, 4, v13
  v_lshl_or_b32 v13, v5, 7, v13
  s_lshl_b32 s3, s57, 10
  v_lshl_add_u32 v10, v0, 4, s3
  v_add_u32 v10, 14680064, v10
  v_add_u32 v13, s3, v13
  v_lshlrev_b32 v250, 4, v6
  v_and_b32 v2, 3, v0
  v_bfe_u32 v4, v0, 2, 3
  v_lshl_add_u32 v4, v2, 3, v4
  v_xor_b32 v7, v3, v6
  v_lshlrev_b32 v7, 6, v7
  v_lshl_add_u32 v4, v4, 7, v7
  v_add_u32 v4, s66, v4
  v_xor_b32 v7, 0, v2
  v_lshl_add_u32 v237, v7, 4, v4
  v_xor_b32 v7, 1, v2
  v_lshl_add_u32 v238, v7, 4, v4
  v_xor_b32 v7, 2, v2
  v_lshl_add_u32 v239, v7, 4, v4
  v_xor_b32 v7, 3, v2
  v_lshl_add_u32 v240, v7, 4, v4
  s_add_u32 s3, s67, 32
  v_lshlrev_b32 v7, 5, v6
  v_sub_u32 v241, s3, v7
  s_add_u32 s3, s67, 224
  v_lshl_add_u32 v7, v3, 2, v2
  v_lshlrev_b32 v7, 5, v7
  v_sub_u32 v243, s3, v7
  s_mul_i32 s3, s57, 4608
  s_add_u32 s3, s3, 44544
  v_and_b32 v7, 31, v0
  s_movk_i32 s68, 144
  v_mul_u32_u24 v8, s68, v7
  v_add_u32 v8, s3, v8
  v_lshl_add_u32 v242, v6, 5, v8
  v_bfe_u32 v4, v0, 2, 2
  v_lshl_add_u32 v8, v6, 2, v4
  s_movk_i32 s68, 576
  v_mul_u32_u24 v9, s68, v8
  v_add_u32 v9, s3, v9
  v_xor_b32 v245, v3, v0
  v_and_b32 v245, 1, v245
  v_lshl_add_u32 v245, v245, 3, v9
  v_add_u32 v245, 128, v245
  v_lshl_add_u32 v244, v3, 5, v9
  v_lshl_add_u32 v244, v2, 3, v244
  v_xor_b32 v253, v3, v0
  v_and_b32 v253, 1, v253
  v_lshlrev_b32 v253, 4, v253
  v_xor_b32 v254, v5, v6
  v_and_b32 v254, 1, v254
  v_lshlrev_b32 v254, 4, v254
  v_lshl_add_u32 v254, v7, 5, v254
  s_add_u32 s3, s67, 118784
  v_add_u32 v254, s3, v254
  v_mov_b32 v72, 0
  v_mov_b32 v73, 0
  v_mov_b32 v74, 0x3c00
  v_mov_b32 v75, 0x3c000000
  v_cmp_eq_u32 vcc, 28, v0
  s_nop 1
  v_cndmask_b32 v72, v72, v74, vcc
  v_cmp_eq_u32 vcc, 29, v0
  s_nop 1
  v_cndmask_b32 v72, v72, v75, vcc
  v_cmp_eq_u32 vcc, 30, v0
  s_nop 1
  v_cndmask_b32 v73, v73, v74, vcc
  v_cmp_eq_u32 vcc, 31, v0
  s_nop 1
  v_cndmask_b32 v73, v73, v75, vcc
  v_lshl_add_u32 v9, v0, 3, s67
  ds_write_b64 v9, v[72:73]
  v_mov_b32 v88, 0
  v_mov_b32 v89, 0
  v_mov_b32 v90, 0
  v_mov_b32 v91, 0
  v_mov_b32 v92, 0
  v_mov_b32 v93, 0
  v_mov_b32 v94, 0
  v_mov_b32 v95, 0
  v_mov_b32 v96, 0
  v_mov_b32 v97, 0
  v_mov_b32 v98, 0
  v_mov_b32 v99, 0
  v_mov_b32 v100, 0
  v_mov_b32 v101, 0
  v_mov_b32 v102, 0
  v_mov_b32 v103, 0
  v_mov_b32 v104, 0
  v_mov_b32 v105, 0
  v_mov_b32 v106, 0
  v_mov_b32 v107, 0
  v_mov_b32 v108, 0
  v_mov_b32 v109, 0
  v_mov_b32 v110, 0
  v_mov_b32 v111, 0
  v_mov_b32 v112, 0
  v_mov_b32 v113, 0
  v_mov_b32 v114, 0
  v_mov_b32 v115, 0
  v_mov_b32 v116, 0
  v_mov_b32 v117, 0
  v_mov_b32 v118, 0
  v_mov_b32 v119, 0
  v_mov_b32 v120, 0
  v_mov_b32 v121, 0
  v_mov_b32 v122, 0
  v_mov_b32 v123, 0
  s_branch FIRST1
NOTFIRST1:
  s_waitcnt vmcnt(0)
FIRST1:
  s_lshl_b32 s3, s57, 5
  v_lshrrev_b32 v2, 3, v0
  v_add_u32 v2, s3, v2
  s_mov_b32 s3, 58368
  v_mul_u32_u24 v2, s3, v2
  v_and_b32 v3, 7, v0
  v_lshl_add_u32 v2, v3, 4, v2
  v_lshlrev_b32 v3, 1, v3
  s_sub_i32 s68, s61, 15
  s_add_i32 s69, s68, s60
  s_max_i32 s68, s68, 0
  s_lshl_b32 s3, s68, 3
  v_add_u32 v2, s3, v2
  v_add_u32 v4, s68, v3
  v_mov_b32 v9, 1
  s_waitcnt lgkmcnt(0)
  s_barrier
  s_waitcnt vmcnt(3)
  v_ashrrev_i32 v5, 31, v131
  v_bfi_b32 v5, v5, 0, v130
  s_mov_b32 s3, 0
  v_mov_b32_dpp v6, v5 quad_perm:[3,3,3,3] row_mask:0xf bank_mask:0xf
  s_nop 1
  v_or_b32_dpp v6, v6, v6 row_half_mirror row_mask:0xf bank_mask:0xf
  v_lshrrev_b32 v224, 16, v6
  v_and_b32 v6, 0xffff, v6
  v_lshl_add_u32 v6, v6, 3, v2
  v_add_u32 v220, s3, v6
  v_min_i32 v216, s69, v224
  v_sub_u32 v216, v216, v4
  v_cmp_lt_i32 vcc, 0, v216
  s_nop 1
  v_cndmask_b32 v6, -16, v220, vcc
  buffer_load_dwordx4 v[144:147], v6, s[20:23], 0 offen
  s_waitcnt vmcnt(3)
  v_ashrrev_i32 v5, 31, v135
  v_bfi_b32 v5, v5, 0, v134
  s_mov_b32 s3, 466944
  v_mov_b32_dpp v6, v5 quad_perm:[3,3,3,3] row_mask:0xf bank_mask:0xf
  s_nop 1
  v_or_b32_dpp v6, v6, v6 row_half_mirror row_mask:0xf bank_mask:0xf
  v_lshrrev_b32 v225, 16, v6
  v_and_b32 v6, 0xffff, v6
  v_lshl_add_u32 v6, v6, 3, v2
  v_add_u32 v221, s3, v6
  v_min_i32 v217, s69, v225
  v_sub_u32 v217, v217, v4
  v_cmp_lt_i32 vcc, 0, v217
  s_nop 1
  v_cndmask_b32 v6, -16, v221, vcc
  buffer_load_dwordx4 v[148:151], v6, s[20:23], 0 offen
  s_waitcnt vmcnt(3)
  v_ashrrev_i32 v5, 31, v139
  v_bfi_b32 v5, v5, 0, v138
  s_mov_b32 s3, 933888
  v_mov_b32_dpp v6, v5 quad_perm:[3,3,3,3] row_mask:0xf bank_mask:0xf
  s_nop 1
  v_or_b32_dpp v6, v6, v6 row_half_mirror row_mask:0xf bank_mask:0xf
  v_lshrrev_b32 v226, 16, v6
  v_and_b32 v6, 0xffff, v6
  v_lshl_add_u32 v6, v6, 3, v2
  v_add_u32 v222, s3, v6
  v_min_i32 v218, s69, v226
  v_sub_u32 v218, v218, v4
  v_cmp_lt_i32 vcc, 0, v218
  s_nop 1
  v_cndmask_b32 v6, -16, v222, vcc
  buffer_load_dwordx4 v[152:155], v6, s[20:23], 0 offen
  s_waitcnt vmcnt(3)
  v_ashrrev_i32 v5, 31, v143
  v_bfi_b32 v5, v5, 0, v142
  s_mov_b32 s3, 1400832
  v_mov_b32_dpp v6, v5 quad_perm:[3,3,3,3] row_mask:0xf bank_mask:0xf
  s_nop 1
  v_or_b32_dpp v6, v6, v6 row_half_mirror row_mask:0xf bank_mask:0xf
  v_lshrrev_b32 v227, 16, v6
  v_and_b32 v6, 0xffff, v6
  v_lshl_add_u32 v6, v6, 3, v2
  v_add_u32 v223, s3, v6
  v_min_i32 v219, s69, v227
  v_sub_u32 v219, v219, v4
  v_cmp_lt_i32 vcc, 0, v219
  s_nop 1
  v_cndmask_b32 v6, -16, v223, vcc
  buffer_load_dwordx4 v[156:159], v6, s[20:23], 0 offen
  s_cmp_eq_u32 s63, 0
  s_cbranch_scc1 NOLATE1
  s_lshl_b32 m0, s57, 10
  s_add_u32 m0, m0, 130560
  s_nop 0
  buffer_load_dwordx4 v10, s[20:23], 0 offen lds
  v_add_u32 v10, 0x2000, v10
  s_lshl_b32 m0, s57, 10
  s_add_u32 m0, m0, 138752
  s_nop 0
  buffer_load_dwordx4 v10, s[20:23], 0 offen lds
  v_add_u32 v10, 0x2000, v10
  s_lshl_b32 m0, s57, 10
  s_add_u32 m0, m0, 146944
  s_nop 0
  buffer_load_dwordx4 v10, s[20:23], 0 offen lds
NOLATE1:
  v_max3_i32 v5, v216, v217, v218
  v_max_i32 v5, v5, v219
  v_cmp_lt_i32 s[76:77], 16, v5
  v_max3_i32 v5, v224, v225, v226
  v_max_i32 v5, v5, v227
  s_max_i32 s69, s69, 0
  v_cmp_lt_i32 s[68:69], s69, v5
  s_cmp_eq_u64 s[76:77], 0
  s_cbranch_scc1 NOL2A
  v_cmpx_lt_i32 vcc, 16, v216
  buffer_load_dwordx4 v[160:163], v220, s[20:23], 0 offen offset:128
  s_mov_b64 exec, -1
  v_cmpx_lt_i32 vcc, 16, v217
  buffer_load_dwordx4 v[164:167], v221, s[20:23], 0 offen offset:128
  s_mov_b64 exec, -1
  v_cmpx_lt_i32 vcc, 16, v218
  buffer_load_dwordx4 v[168:171], v222, s[20:23], 0 offen offset:128
  s_mov_b64 exec, -1
  v_cmpx_lt_i32 vcc, 16, v219
  buffer_load_dwordx4 v[172:175], v223, s[20:23], 0 offen offset:128
  s_mov_b64 exec, -1
NOL2A:
  s_cmp_lg_u32 s63, 0
  s_cbranch_scc1 FIRST2
  s_add_u32 s3, s61, s60
  v_add_u32 v5, 0, v3
  v_cmp_le_u32 s[32:33], s3, v5
  v_cmp_gt_u32 s[34:35], s61, v5
  s_or_b64 s[34:35], s[34:35], s[32:33]
  v_cmp_gt_i32 vcc, 0, v129
  s_and_b64 vcc, vcc, s[32:33]
  s_or_b64 s[68:69], s[68:69], vcc
  v_cndmask_b32 v129, v129, 0, s[34:35]
  v_cmp_gt_i32 vcc, 0, v133
  s_and_b64 vcc, vcc, s[32:33]
  s_or_b64 s[68:69], s[68:69], vcc
  v_cndmask_b32 v133, v133, 0, s[34:35]
  v_cmp_gt_i32 vcc, 0, v137
  s_and_b64 vcc, vcc, s[32:33]
  s_or_b64 s[68:69], s[68:69], vcc
  v_cndmask_b32 v137, v137, 0, s[34:35]
  v_cmp_gt_i32 vcc, 0, v141
  s_and_b64 vcc, vcc, s[32:33]
  s_or_b64 s[68:69], s[68:69], vcc
  v_cndmask_b32 v141, v141, 0, s[34:35]
  v_add_u32 v5, 1, v3
  v_cmp_le_u32 s[32:33], s3, v5
  v_cmp_gt_u32 s[34:35], s61, v5
  s_or_b64 s[34:35], s[34:35], s[32:33]
  v_cmp_gt_i32 vcc, 0, v131
  s_and_b64 vcc, vcc, s[32:33]
  s_or_b64 s[68:69], s[68:69], vcc
  v_cndmask_b32 v131, v131, 0, s[34:35]
  v_cmp_gt_i32 vcc, 0, v135
  s_and_b64 vcc, vcc, s[32:33]
  s_or_b64 s[68:69], s[68:69], vcc
  v_cndmask_b32 v135, v135, 0, s[34:35]
  v_cmp_gt_i32 vcc, 0, v139
  s_and_b64 vcc, vcc, s[32:33]
  s_or_b64 s[68:69], s[68:69], vcc
  v_cndmask_b32 v139, v139, 0, s[34:35]
  v_cmp_gt_i32 vcc, 0, v143
  s_and_b64 vcc, vcc, s[32:33]
  s_or_b64 s[68:69], s[68:69], vcc
  v_cndmask_b32 v143, v143, 0, s[34:35]
  s_waitcnt vmcnt(0)
FIRST2:
  s_cmp_eq_u64 s[68:69], 0
  s_cbranch_scc1 NOFLAG
  v_mov_b32 v5, 35328
  ds_write_b32 v5, v5
NOFLAG:
  v_cmp_gt_i32 s[32:33], 0, v129
  v_lshlrev_b32_sdwa v200, 2, v129 dst_sel:DWORD dst_unused:UNUSED_PAD src0_sel:DWORD src1_sel:BYTE_3
  v_cmp_gt_i32 s[34:35], 0, v131
  v_lshlrev_b32_sdwa v201, 2, v131 dst_sel:DWORD dst_unused:UNUSED_PAD src0_sel:DWORD src1_sel:BYTE_3
  v_cmp_gt_i32 s[36:37], 0, v133
  v_lshlrev_b32_sdwa v202, 2, v133 dst_sel:DWORD dst_unused:UNUSED_PAD src0_sel:DWORD src1_sel:BYTE_3
  v_cmp_gt_i32 s[38:39], 0, v135
  v_lshlrev_b32_sdwa v203, 2, v135 dst_sel:DWORD dst_unused:UNUSED_PAD src0_sel:DWORD src1_sel:BYTE_3
  v_cmp_gt_i32 s[40:41], 0, v137
  v_lshlrev_b32_sdwa v204, 2, v137 dst_sel:DWORD dst_unused:UNUSED_PAD src0_sel:DWORD src1_sel:BYTE_3
  v_cmp_gt_i32 s[42:43], 0, v139
  v_lshlrev_b32_sdwa v205, 2, v139 dst_sel:DWORD dst_unused:UNUSED_PAD src0_sel:DWORD src1_sel:BYTE_3
  v_cmp_gt_i32 s[44:45], 0, v141
  v_lshlrev_b32_sdwa v206, 2, v141 dst_sel:DWORD dst_unused:UNUSED_PAD src0_sel:DWORD src1_sel:BYTE_3
  v_cmp_gt_i32 s[46:47], 0, v143
  v_lshlrev_b32_sdwa v207, 2, v143 dst_sel:DWORD dst_unused:UNUSED_PAD src0_sel:DWORD src1_sel:BYTE_3
  s_mov_b64 exec, s[32:33]
  ds_add_rtn_u32 v176, v200, v9 offset:34304
  s_mov_b64 exec, s[34:35]
  ds_add_rtn_u32 v177, v201, v9 offset:34304
  s_mov_b64 exec, s[36:37]
  ds_add_rtn_u32 v178, v202, v9 offset:34304
  s_mov_b64 exec, s[38:39]
  ds_add_rtn_u32 v179, v203, v9 offset:34304
  s_mov_b64 exec, s[40:41]
  ds_add_rtn_u32 v180, v204, v9 offset:34304
  s_mov_b64 exec, s[42:43]
  ds_add_rtn_u32 v181, v205, v9 offset:34304
  s_mov_b64 exec, s[44:45]
  ds_add_rtn_u32 v182, v206, v9 offset:34304
  s_mov_b64 exec, s[46:47]
  ds_add_rtn_u32 v183, v207, v9 offset:34304
  s_mov_b64 exec, -1
  s_cmp_eq_u32 s63, 0
  s_cbranch_scc1 NOLATE2
  s_lshl_b32 m0, s57, 10
  s_add_u32 m0, m0, 114176
  s_nop 0
  buffer_load_dwordx4 v13, s[24:27], 0 offen lds
  v_add_u32 v13, 0x2000, v13
  s_lshl_b32 m0, s57, 10
  s_add_u32 m0, m0, 122368
  s_nop 0
  buffer_load_dwordx4 v13, s[24:27], 0 offen lds
NOLATE2:
  v_lshlrev_b32 v2, 2, v0
  v_lshrrev_b32 v8, 4, v0
  v_mul_u32_u24 v8, 544, v8
  v_and_b32 v3, 0x30, v0
  v_add_u32 v3, 35456, v3
  v_cmp_lt_i32 s[48:49], 0, v216
  v_cmp_lt_i32 s[50:51], 1, v216
  v_cmp_lt_i32 s[52:53], 0, v217
  v_cmp_lt_i32 s[96:97], 1, v217
  v_cmp_lt_i32 s[98:99], 0, v218
  v_cmp_lt_i32 s[100:101], 1, v218
  v_cmp_lt_i32 s[68:69], 0, v219
  s_waitcnt lgkmcnt(0)
  s_barrier
  ds_read2st64_b32 v[4:5], v2 offset0:136 offset1:137
  s_waitcnt lgkmcnt(0)
  v_mov_b32 v6, v4
  v_mov_b32 v7, v5
  s_nop 0
  v_add_u32_dpp v6, v6, v6 row_shr:1 row_mask:0xf bank_mask:0xf
  v_add_u32_dpp v7, v7, v7 row_shr:1 row_mask:0xf bank_mask:0xf
  s_nop 0
  v_add_u32_dpp v6, v6, v6 row_shr:2 row_mask:0xf bank_mask:0xf
  v_add_u32_dpp v7, v7, v7 row_shr:2 row_mask:0xf bank_mask:0xf
  s_nop 0
  v_add_u32_dpp v6, v6, v6 row_shr:4 row_mask:0xf bank_mask:0xf
  v_add_u32_dpp v7, v7, v7 row_shr:4 row_mask:0xf bank_mask:0xf
  s_nop 0
  v_add_u32_dpp v6, v6, v6 row_shr:8 row_mask:0xf bank_mask:0xf
  v_add_u32_dpp v7, v7, v7 row_shr:8 row_mask:0xf bank_mask:0xf
  v_sub_u32 v6, v6, v4
  v_sub_u32 v7, v7, v5
  v_add_u32 v4, v6, v8
  v_add3_u32 v5, v7, v8, s55
  ds_write2st64_b32 v2, v4, v5 offset0:140 offset1:141
  v_max_u32 v8, v6, v7
  v_cmp_lt_u32 vcc, 0x200, v8
  s_mov_b32 exec_lo, 0x80008000
  s_mov_b32 exec_hi, 0x80008000
  ds_write2_b32 v3, v4, v5 offset0:1 offset1:17
  s_mov_b64 exec, -1
  v_mov_b32 v8, 1
  v_mov_b32 v9, 0
  s_cbranch_vccz NOOVF1
  s_mov_b64 s[32:33], 0
  s_mov_b64 s[34:35], 0
  s_mov_b64 s[36:37], 0
  s_mov_b64 s[38:39], 0
  s_mov_b64 s[40:41], 0
  s_mov_b64 s[42:43], 0
  s_mov_b64 s[44:45], 0
  s_mov_b64 s[46:47], 0
NOOVF1:
  v_cmp_lt_i32 vcc, 1, v219
  s_waitcnt vmcnt(5)
  v_and_b32_sdwa v208, s95, v145 dst_sel:DWORD dst_unused:UNUSED_PAD src0_sel:DWORD src1_sel:BYTE_3
  v_and_b32_sdwa v209, s95, v147 dst_sel:DWORD dst_unused:UNUSED_PAD src0_sel:DWORD src1_sel:BYTE_3
  v_and_b32_sdwa v210, s95, v149 dst_sel:DWORD dst_unused:UNUSED_PAD src0_sel:DWORD src1_sel:BYTE_3
  v_and_b32_sdwa v211, s95, v151 dst_sel:DWORD dst_unused:UNUSED_PAD src0_sel:DWORD src1_sel:BYTE_3
  v_and_b32_sdwa v212, s95, v153 dst_sel:DWORD dst_unused:UNUSED_PAD src0_sel:DWORD src1_sel:BYTE_3
  v_and_b32_sdwa v213, s95, v155 dst_sel:DWORD dst_unused:UNUSED_PAD src0_sel:DWORD src1_sel:BYTE_3
  v_and_b32_sdwa v214, s95, v157 dst_sel:DWORD dst_unused:UNUSED_PAD src0_sel:DWORD src1_sel:BYTE_3
  v_and_b32_sdwa v215, s95, v159 dst_sel:DWORD dst_unused:UNUSED_PAD src0_sel:DWORD src1_sel:BYTE_3
  s_mov_b64 exec, s[48:49]
  ds_add_rtn_u64 v[184:185], v208, v[8:9] offset:35328
  s_mov_b64 exec, s[50:51]
  ds_add_rtn_u64 v[186:187], v209, v[8:9] offset:35328
  s_mov_b64 exec, s[52:53]
  ds_add_rtn_u64 v[188:189], v210, v[8:9] offset:35328
  s_mov_b64 exec, s[96:97]
  ds_add_rtn_u64 v[190:191], v211, v[8:9] offset:35328
  s_mov_b64 exec, s[98:99]
  ds_add_rtn_u64 v[192:193], v212, v[8:9] offset:35328
  s_mov_b64 exec, s[100:101]
  ds_add_rtn_u64 v[194:195], v213, v[8:9] offset:35328
  s_mov_b64 exec, s[68:69]
  ds_add_rtn_u64 v[196:197], v214, v[8:9] offset:35328
  s_mov_b64 exec, vcc
  ds_add_rtn_u64 v[198:199], v215, v[8:9] offset:35328
  s_mov_b64 exec, -1
  ds_read_b32 v200, v200 offset:35328
  ds_read_b32 v201, v201 offset:35328
  ds_read_b32 v202, v202 offset:35328
  ds_read_b32 v203, v203 offset:35328
  ds_read_b32 v204, v204 offset:35328
  ds_read_b32 v205, v205 offset:35328
  ds_read_b32 v206, v206 offset:35328
  ds_read_b32 v207, v207 offset:35328
  s_cmp_eq_u32 s63, 0
  s_cbranch_scc1 NOPERM
  v_mov_b32 v2, v6
  s_sub_u32 s3, 11, s57
  s_nop 0
  v_mov_b32_dpp v2, v7 row_shl:1 row_mask:0xf bank_mask:0xf
  s_cmp_lt_u32 s57, 4
  v_lshl_or_b32 v2, v2, 6, v0
  s_cselect_b32 s3, s57, s3
  s_mov_b32 s2, 7
  v_readlane_b32 s80, v2, 15
  v_readlane_b32 s82, v2, 31
  v_readlane_b32 s84, v2, 47
  v_readlane_b32 s86, v2, 63
  v_readlane_b32 s88, v2, 14
  v_readlane_b32 s90, v2, 30
  v_readlane_b32 s92, v2, 46
  s_mov_b32 exec_lo, 0xc000c000
  s_mov_b32 exec_hi, 0xc000c000
  v_cmp_lt_u32 s[80:81], s80, v2
  v_cmp_lt_u32 s[82:83], s82, v2
  v_cmp_lt_u32 s[84:85], s84, v2
  v_cmp_lt_u32 s[86:87], s86, v2
  v_cmp_lt_u32 s[88:89], s88, v2
  v_cmp_lt_u32 s[90:91], s90, v2
  v_cmp_lt_u32 s[92:93], s92, v2
  s_mov_b64 exec, -1
  s_bcnt1_i32_b64 s80, s[80:81]
  s_cmp_eq_u32 s80, s3
  s_cselect_b32 s2, 0, s2
  s_bcnt1_i32_b64 s82, s[82:83]
  s_cmp_eq_u32 s82, s3
  s_cselect_b32 s2, 1, s2
  s_bcnt1_i32_b64 s84, s[84:85]
  s_cmp_eq_u32 s84, s3
  s_cselect_b32 s2, 2, s2
  s_bcnt1_i32_b64 s86, s[86:87]
  s_cmp_eq_u32 s86, s3
  s_cselect_b32 s2, 3, s2
  s_bcnt1_i32_b64 s88, s[88:89]
  s_cmp_eq_u32 s88, s3
  s_cselect_b32 s2, 4, s2
  s_bcnt1_i32_b64 s90, s[90:91]
  s_cmp_eq_u32 s90, s3
  s_cselect_b32 s2, 5, s2
  s_bcnt1_i32_b64 s92, s[92:93]
  s_cmp_eq_u32 s92, s3
  s_cselect_b32 s2, 6, s2
  s_lshl_b32 s3, s56, 3
  s_add_u32 s3, s3, s2
  s_mul_i32 s3, s3, 3125
  s_add_u32 s58, s3, 127
  s_lshr_b32 s58, s58, 7
  s_add_u32 s3, s3, 3252
  s_lshr_b32 s3, s3, 7
  s_sub_u32 s3, s3, s58
  s_bfm_b32 s78, s3, 0
  s_lshl_b32 s3, s58, 7
  v_add_u32 v12, s58, v0
  v_add_u32 v56, s3, v56
  v_add_u32 v57, s3, v57
  v_add_u32 v58, s3, v58
  v_add_u32 v59, s3, v59
  v_mul_u32_u24 v11, 6, v12
  v_and_b32 v11, -4, v11
NOPERM:
  s_cmp_eq_u32 s63, 0
  s_cbranch_scc1 NOLATE4
  s_mul_i32 m0, s57, 4608
  s_add_u32 m0, m0, 44544
  s_nop 0
  buffer_load_dwordx4 v56, s[4:7], 0 offen lds
  s_mul_i32 m0, s57, 4608
  s_add_u32 m0, m0, 45568
  s_nop 0
  buffer_load_dwordx4 v57, s[4:7], 0 offen lds
NOLATE4:
  s_mul_i32 s3, s2, 2176
  v_lshrrev_b32 v2, 3, v0
  v_lshl_add_u32 v246, v2, 4, s3
  v_and_b32 v2, 31, v0
  v_lshl_add_u32 v247, v2, 2, s3
  v_bfe_u32 v2, v0, 2, 2
  v_lshl_add_u32 v2, v2, 4, s3
  v_lshl_add_u32 v248, v250, 2, v2
  v_lshrrev_b32 v2, 1, v0
  v_lshl_add_u32 v252, v2, 2, s3
  v_mov_b32 v2, 35328
  s_waitcnt lgkmcnt(8)
  v_add_lshl_u32 v208, v184, v185, 2
  v_min_u32 v208, s94, v208
  v_add_lshl_u32 v209, v186, v187, 2
  v_min_u32 v209, s94, v209
  v_add_lshl_u32 v210, v188, v189, 2
  v_min_u32 v210, s94, v210
  v_add_lshl_u32 v211, v190, v191, 2
  v_min_u32 v211, s94, v211
  v_add_lshl_u32 v212, v192, v193, 2
  v_min_u32 v212, s94, v212
  v_add_lshl_u32 v213, v194, v195, 2
  v_min_u32 v213, s94, v213
  v_add_lshl_u32 v214, v196, v197, 2
  v_min_u32 v214, s94, v214
  v_add_lshl_u32 v215, v198, v199, 2
  v_min_u32 v215, s94, v215
  s_waitcnt lgkmcnt(6)
  v_add_lshl_u32 v200, v200, v176, 2
  v_add_lshl_u32 v201, v201, v177, 2
  s_waitcnt lgkmcnt(4)
  v_add_lshl_u32 v202, v202, v178, 2
  v_add_lshl_u32 v203, v203, v179, 2
  s_waitcnt lgkmcnt(2)
  v_add_lshl_u32 v204, v204, v180, 2
  v_add_lshl_u32 v205, v205, v181, 2
  s_waitcnt lgkmcnt(0)
  v_add_lshl_u32 v206, v206, v182, 2
  v_add_lshl_u32 v207, v207, v183, 2
  s_mov_b64 exec, s[32:33]
  ds_write2st64_b32 v200, v128, v129 offset0:0 offset1:68
  s_mov_b64 exec, s[34:35]
  ds_write2st64_b32 v201, v130, v131 offset0:0 offset1:68
  s_mov_b64 exec, s[36:37]
  ds_write2st64_b32 v202, v132, v133 offset0:0 offset1:68
  s_mov_b64 exec, s[38:39]
  ds_write2st64_b32 v203, v134, v135 offset0:0 offset1:68
  s_mov_b64 exec, -1
  s_cmp_eq_u32 s63, 0
  s_cbranch_scc1 NOLATE5
  s_mul_i32 m0, s57, 4608
  s_add_u32 m0, m0, 46592
  s_nop 0
  buffer_load_dwordx4 v58, s[4:7], 0 offen lds
NOLATE5:
  s_mov_b64 exec, s[40:41]
  ds_write2st64_b32 v204, v136, v137 offset0:0 offset1:68
  s_mov_b64 exec, s[42:43]
  ds_write2st64_b32 v205, v138, v139 offset0:0 offset1:68
  s_mov_b64 exec, s[44:45]
  ds_write2st64_b32 v206, v140, v141 offset0:0 offset1:68
  s_mov_b64 exec, s[46:47]
  ds_write2st64_b32 v207, v142, v143 offset0:0 offset1:68
  s_mov_b64 exec, -1
  s_cmp_eq_u32 s63, 0
  s_cbranch_scc1 NOLATE6
  s_mul_i32 m0, s57, 4608
  s_add_u32 m0, m0, 47616
  s_nop 0
  buffer_load_dwordx4 v59, s[4:7], 0 offen lds
NOLATE6:
  s_mov_b64 exec, s[48:49]
  ds_write2st64_b32 v208, v144, v145 offset0:0 offset1:68
  s_mov_b64 exec, s[50:51]
  ds_write2st64_b32 v209, v146, v147 offset0:0 offset1:68
  s_mov_b64 exec, s[52:53]
  ds_write2st64_b32 v210, v148, v149 offset0:0 offset1:68
  s_mov_b64 exec, s[96:97]
  ds_write2st64_b32 v211, v150, v151 offset0:0 offset1:68
  s_mov_b64 exec, s[98:99]
  ds_write2st64_b32 v212, v152, v153 offset0:0 offset1:68
  s_mov_b64 exec, s[100:101]
  ds_write2st64_b32 v213, v154, v155 offset0:0 offset1:68
  s_mov_b64 exec, s[68:69]
  ds_write2st64_b32 v214, v156, v157 offset0:0 offset1:68
  s_mov_b64 exec, vcc
  ds_write2st64_b32 v215, v158, v159 offset0:0 offset1:68
  s_mov_b64 exec, -1
  s_cmp_eq_u64 s[76:77], 0
  s_cbranch_scc1 NOL2B
  s_waitcnt vmcnt(0) lgkmcnt(0)
  v_cmpx_lt_i32 vcc, 16, v216
  v_and_b32_sdwa v208, s95, v161 dst_sel:DWORD dst_unused:UNUSED_PAD src0_sel:DWORD src1_sel:BYTE_3
  ds_add_rtn_u64 v[184:185], v208, v[8:9] offset:35328
  v_cmpx_lt_i32 vcc, 17, v216
  v_and_b32_sdwa v209, s95, v163 dst_sel:DWORD dst_unused:UNUSED_PAD src0_sel:DWORD src1_sel:BYTE_3
  ds_add_rtn_u64 v[186:187], v209, v[8:9] offset:35328
  s_mov_b64 exec, -1
  v_cmpx_lt_i32 vcc, 16, v217
  v_and_b32_sdwa v210, s95, v165 dst_sel:DWORD dst_unused:UNUSED_PAD src0_sel:DWORD src1_sel:BYTE_3
  ds_add_rtn_u64 v[188:189], v210, v[8:9] offset:35328
  v_cmpx_lt_i32 vcc, 17, v217
  v_and_b32_sdwa v211, s95, v167 dst_sel:DWORD dst_unused:UNUSED_PAD src0_sel:DWORD src1_sel:BYTE_3
  ds_add_rtn_u64 v[190:191], v211, v[8:9] offset:35328
  s_mov_b64 exec, -1
  v_cmpx_lt_i32 vcc, 16, v218
  v_and_b32_sdwa v212, s95, v169 dst_sel:DWORD dst_unused:UNUSED_PAD src0_sel:DWORD src1_sel:BYTE_3
  ds_add_rtn_u64 v[192:193], v212, v[8:9] offset:35328
  v_cmpx_lt_i32 vcc, 17, v218
  v_and_b32_sdwa v213, s95, v171 dst_sel:DWORD dst_unused:UNUSED_PAD src0_sel:DWORD src1_sel:BYTE_3
  ds_add_rtn_u64 v[194:195], v213, v[8:9] offset:35328
  s_mov_b64 exec, -1
  v_cmpx_lt_i32 vcc, 16, v219
  v_and_b32_sdwa v214, s95, v173 dst_sel:DWORD dst_unused:UNUSED_PAD src0_sel:DWORD src1_sel:BYTE_3
  ds_add_rtn_u64 v[196:197], v214, v[8:9] offset:35328
  v_cmpx_lt_i32 vcc, 17, v219
  v_and_b32_sdwa v215, s95, v175 dst_sel:DWORD dst_unused:UNUSED_PAD src0_sel:DWORD src1_sel:BYTE_3
  ds_add_rtn_u64 v[198:199], v215, v[8:9] offset:35328
  s_mov_b64 exec, -1
  s_waitcnt lgkmcnt(0)
  v_cmpx_lt_i32 vcc, 16, v216
  v_add_lshl_u32 v208, v184, v185, 2
  v_min_u32 v208, s94, v208
  ds_write2st64_b32 v208, v160, v161 offset0:0 offset1:68
  v_cmpx_lt_i32 vcc, 17, v216
  v_add_lshl_u32 v209, v186, v187, 2
  v_min_u32 v209, s94, v209
  ds_write2st64_b32 v209, v162, v163 offset0:0 offset1:68
  s_mov_b64 exec, -1
  v_cmpx_lt_i32 vcc, 16, v217
  v_add_lshl_u32 v210, v188, v189, 2
  v_min_u32 v210, s94, v210
  ds_write2st64_b32 v210, v164, v165 offset0:0 offset1:68
  v_cmpx_lt_i32 vcc, 17, v217
  v_add_lshl_u32 v211, v190, v191, 2
  v_min_u32 v211, s94, v211
  ds_write2st64_b32 v211, v166, v167 offset0:0 offset1:68
  s_mov_b64 exec, -1
  v_cmpx_lt_i32 vcc, 16, v218
  v_add_lshl_u32 v212, v192, v193, 2
  v_min_u32 v212, s94, v212
  ds_write2st64_b32 v212, v168, v169 offset0:0 offset1:68
  v_cmpx_lt_i32 vcc, 17, v218
  v_add_lshl_u32 v213, v194, v195, 2
  v_min_u32 v213, s94, v213
  ds_write2st64_b32 v213, v170, v171 offset0:0 offset1:68
  s_mov_b64 exec, -1
  v_cmpx_lt_i32 vcc, 16, v219
  v_add_lshl_u32 v214, v196, v197, 2
  v_min_u32 v214, s94, v214
  ds_write2st64_b32 v214, v172, v173 offset0:0 offset1:68
  v_cmpx_lt_i32 vcc, 17, v219
  v_add_lshl_u32 v215, v198, v199, 2
  v_min_u32 v215, s94, v215
  ds_write2st64_b32 v215, v174, v175 offset0:0 offset1:68
  s_mov_b64 exec, -1
NOL2B:
  s_cmp_eq_u32 s63, 0
  s_cbranch_scc1 NOLATE7
  buffer_load_dwordx2 v[124:125], v11, s[12:15], 0 offen
NOLATE7:
  s_mov_b32 s63, 0
  v_mov_b32 v224, 0
  v_mov_b32 v225, 0
  v_mov_b32 v226, 0
  v_mov_b32 v227, 0
  s_and_b32 s62, s2, 3
  s_lshl_b32 s62, s62, 4
  s_add_u32 s62, s62, 15
  s_waitcnt vmcnt(5) lgkmcnt(0)
  s_barrier
  ds_read2_b32 v[4:5], v3 offset0:0 offset1:16
  ds_read_b32 v8, v2
  ds_read_b128 v[220:223], v246 offset:0
  ds_read_b32 v228, v247 offset:0
  ds_read_b32 v1, v252 offset:17408
  s_waitcnt lgkmcnt(3)
  v_add_u32 v6, v6, v4
  v_add_u32 v7, v7, v5
  v_max_u32 v4, v6, v7
  v_cmp_lt_u32 vcc, 0x200, v4
  v_readlane_b32 s68, v6, s62
  v_readlane_b32 s69, v7, s62
  v_readfirstlane_b32 s62, v8
  s_cbranch_vccz NOOVF
  s_lshr_b32 s60, s60, 1
  s_waitcnt vmcnt(0) lgkmcnt(0)
  s_barrier
  s_branch ROUND
NOOVF:
  s_cmp_ge_u32 s2, 4
  s_cselect_b32 s68, s69, s68
  s_add_u32 s59, s68, 31
  s_lshr_b32 s59, s59, 5
  v_add_u32 v2, s68, v0
  s_lshl_b32 s69, s59, 5
  v_lshl_add_u32 v3, v2, 2, s3
  s_sub_u32 s3, s58, s69
  v_add_u32 v4, s3, v2
  v_mov_b32 v5, 0xffff
  v_cmp_gt_u32 vcc, s69, v2
  s_nop 1
  v_cndmask_b32 v4, v4, v5, vcc
  v_or_b32 v4, 0xf8000000, v4
  v_mov_b32 v5, 0x00ffffff
  s_add_u32 s69, s69, 32
  v_cmpx_gt_u32 vcc, s69, v2
  ds_write2st64_b32 v3, v4, v5 offset0:0 offset1:68
  s_mov_b64 exec, -1
  s_cmp_ge_u32 s68, 32
  s_cbranch_scc1 FULL0
  ds_read_b128 v[220:223], v246 offset:0
  ds_read_b32 v228, v247 offset:0
  ds_read_b32 v1, v252 offset:17408
  s_waitcnt lgkmcnt(0)
FULL0:
  s_waitcnt lgkmcnt(1)
  s_cmp_gt_i32 s59, -1
  s_cselect_b32 s6, 6400000, 0
  s_cselect_b32 s10, 25600000, 0
  s_cselect_b32 s14, 300000, 0
  s_add_u32 m0, s67, 118784
  v_mad_u32_u24 v1, v1, 32, v253
  buffer_load_dwordx4 v1, s[8:11], 0 offen  lds
  s_add_u32 m0, s66, 0
  v_mad_u32_u24 v220, v220, s64, v233
  buffer_load_dwordx4 v220, s[4:7], 0 offen  lds
  s_add_u32 m0, s66, 1024
  v_mad_u32_u24 v221, v221, s64, v234
  buffer_load_dwordx4 v221, s[4:7], 0 offen  lds
  s_add_u32 m0, s66, 2048
  v_mad_u32_u24 v222, v222, s64, v235
  buffer_load_dwordx4 v222, s[4:7], 0 offen  lds
  s_add_u32 m0, s66, 3072
  v_mad_u32_u24 v223, v223, s64, v236
  buffer_load_dwordx4 v223, s[4:7], 0 offen  lds
  v_mul_u32_u24 v1, 6, v228
  v_and_b32 v1, -4, v1
  s_mov_b64 exec, s[74:75]
  buffer_load_dwordx2 v[224:225], v1, s[12:15], 0 offen
  s_mov_b64 exec, -1
  ds_read_b128 v[220:223], v246 offset:128
  ds_read_b32 v229, v247 offset:128
  ds_read_b32 v1, v252 offset:17536
  s_waitcnt lgkmcnt(0)
  s_cmp_eq_u32 s54, 0
  s_cbranch_scc1 NOINIT2
  v_lshlrev_b32 v2, 4, v0
  v_add_u32 v2, 130560, v2
  s_lshl_b32 s3, s57, 9
  s_sub_u32 s3, s3, 36864
  s_waitcnt vmcnt(6)
  v_add_u32 v6, s3, v237
  ds_read_b128 v[200:203], v6
  v_add_u32 v7, s3, v238
  ds_read_b128 v[204:207], v7
  v_add_u32 v8, s3, v239
  ds_read_b128 v[208:211], v8
  v_add_u32 v9, s3, v240
  ds_read_b128 v[212:215], v9
  ds_read_b128 v[128:131], v2 offset:0
  ds_read_b128 v[132:135], v2 offset:1024
  ds_read_b128 v[136:139], v2 offset:2048
  ds_read_b128 v[140:143], v2 offset:3072
  ds_read_b128 v[144:147], v2 offset:4096
  ds_read_b128 v[148:151], v2 offset:5120
  ds_read_b128 v[152:155], v2 offset:6144
  ds_read_b128 v[156:159], v2 offset:7168
  ds_read_b64 v[4:5], v2 offset:18432
  ds_read_b128 v[16:19], v2 offset:8192
  ds_read_b128 v[20:23], v2 offset:9216
  ds_read_b128 v[24:27], v2 offset:10240
  ds_read_b128 v[28:31], v2 offset:11264
  ds_read_b128 v[32:35], v2 offset:12288
  ds_read_b128 v[36:39], v2 offset:13312
  ds_read_b128 v[40:43], v2 offset:14336
  ds_read_b128 v[44:47], v2 offset:15360
  ds_read_b128 v[48:51], v2 offset:16384
  ds_read_b128 v[52:55], v2 offset:17408
  ds_read_b128 v[72:75], v2 offset:20480
  ds_read_b128 v[76:79], v2 offset:21504
  ds_read_b128 v[80:83], v2 offset:22528
  ds_read_b128 v[84:87], v2 offset:23552
  v_lshlrev_b32 v7, 4, v12
  v_alignbit_b32 v8, v125, v124, v7
  v_lshrrev_b32 v9, v7, v125
  v_lshlrev_b32 v6, 16, v8
  v_and_b32 v7, s65, v8
  v_lshlrev_b32 v8, 16, v9
  v_lshl_add_u32 v9, v0, 3, s67
  s_mov_b64 exec, s[74:75]
  ds_write_b64 v9, v[6:7] offset:512
  ds_write_b32 v9, v8 offset:768
  s_mov_b64 exec, -1
  s_waitcnt lgkmcnt(15)
  v_mfma_f32_32x32x16_bf16 v[160:175], v[200:203], v[128:131], 0
  v_mfma_f32_32x32x16_bf16 v[176:191], v[200:203], v[144:147], 0
  v_mfma_f32_32x32x16_bf16 v[160:175], v[204:207], v[132:135], v[160:175]
  v_mfma_f32_32x32x16_bf16 v[176:191], v[204:207], v[148:151], v[176:191]
  v_mfma_f32_32x32x16_bf16 v[160:175], v[208:211], v[136:139], v[160:175]
  v_mfma_f32_32x32x16_bf16 v[176:191], v[208:211], v[152:155], v[176:191]
  v_mfma_f32_32x32x16_bf16 v[160:175], v[212:215], v[140:143], v[160:175]
  v_mfma_f32_32x32x16_bf16 v[176:191], v[212:215], v[156:159], v[176:191]
  s_waitcnt lgkmcnt(0)
  s_mov_b32 s54, 0
  s_nop 7
  s_nop 0
  v_pk_mul_f32 v[160:161], v[160:161], s[70:71]
  v_cvt_pk_f16_f32 v56, v160, v161
  v_pk_mul_f32 v[162:163], v[162:163], s[70:71]
  v_cvt_pk_f16_f32 v57, v162, v163
  v_pk_mul_f32 v[164:165], v[164:165], s[70:71]
  v_cvt_pk_f16_f32 v58, v164, v165
  v_pk_mul_f32 v[166:167], v[166:167], s[70:71]
  v_cvt_pk_f16_f32 v59, v166, v167
  v_pk_mul_f32 v[168:169], v[168:169], s[70:71]
  v_cvt_pk_f16_f32 v60, v168, v169
  v_pk_mul_f32 v[170:171], v[170:171], s[70:71]
  v_cvt_pk_f16_f32 v61, v170, v171
  v_pk_mul_f32 v[172:173], v[172:173], s[70:71]
  v_cvt_pk_f16_f32 v62, v172, v173
  v_pk_mul_f32 v[176:177], v[176:177], s[70:71]
  v_cvt_pk_f16_f32 v64, v176, v177
  v_pk_mul_f32 v[178:179], v[178:179], s[70:71]
  v_cvt_pk_f16_f32 v65, v178, v179
  v_pk_mul_f32 v[180:181], v[180:181], s[70:71]
  v_cvt_pk_f16_f32 v66, v180, v181
  v_pk_mul_f32 v[182:183], v[182:183], s[70:71]
  v_cvt_pk_f16_f32 v67, v182, v183
  v_pk_mul_f32 v[184:185], v[184:185], s[70:71]
  v_cvt_pk_f16_f32 v68, v184, v185
  v_pk_mul_f32 v[186:187], v[186:187], s[70:71]
  v_cvt_pk_f16_f32 v69, v186, v187
  v_pk_mul_f32 v[188:189], v[188:189], s[70:71]
  v_cvt_pk_f16_f32 v70, v188, v189
  v_mov_b32 v63, v4
  v_mov_b32 v71, v5
NOINIT2:
  v_mov_b32 v184, 0
  v_mov_b32 v168, 0
  v_mov_b32 v185, 0
  v_mov_b32 v169, 0
  v_mov_b32 v186, 0
  v_mov_b32 v170, 0
  v_mov_b32 v187, 0
  v_mov_b32 v171, 0
  v_mov_b32 v188, 0
  v_mov_b32 v172, 0
  v_mov_b32 v189, 0
  v_mov_b32 v173, 0
  v_mov_b32 v190, 0
  v_mov_b32 v174, 0
  v_mov_b32 v191, 0
  v_mov_b32 v175, 0
  v_mov_b32 v124, 0
  v_mov_b32 v125, 0
  v_mov_b32 v126, 0
  v_mov_b32 v127, 0
  v_mov_b32 v13, 0
  v_mov_b32 v14, 0
  v_mov_b32 v15, 0
  s_mul_i32 s3, s57, 4608
  s_add_u32 s3, s3, 44544
  v_lshl_add_u32 v2, v0, 3, s3
  ds_write_b64 v2, v[184:185] offset:0
  ds_write_b64 v2, v[184:185] offset:512
  ds_write_b64 v2, v[184:185] offset:1024
  ds_write_b64 v2, v[184:185] offset:1536
  ds_write_b64 v2, v[184:185] offset:2048
  ds_write_b64 v2, v[184:185] offset:2560
  ds_write_b64 v2, v[184:185] offset:3072
  ds_write_b64 v2, v[184:185] offset:3584
  ds_write_b64 v2, v[184:185] offset:4096
  s_waitcnt vmcnt(0)
  ds_read_b128 v[216:219], v254
  ds_read_b128 v[200:203], v237
  ds_read_b128 v[204:207], v238
  ds_read_b128 v[208:211], v239
  ds_read_b128 v[212:215], v240
  v_add_u32_sdwa v249, v241, v228 dst_sel:DWORD dst_unused:UNUSED_PAD src0_sel:DWORD src1_sel:BYTE_3
  ds_read_b64 v[230:231], v249 offset:480
  ds_read_b32 v232, v249 offset:736
  v_lshlrev_b32 v125, 4, v228
  v_alignbit_b32 v126, v225, v224, v125
  v_lshrrev_b32 v127, v125, v225
  ds_read_b64 v[176:177], v249 offset:192
  ds_read_b64 v[178:179], v249 offset:128
  ds_read_b64 v[180:181], v249 offset:64
  ds_read_b32 v182, v249
  s_waitcnt lgkmcnt(10)
  v_mfma_f32_32x32x16_bf16 v[128:143], v[48:51], v[216:219], 0
  v_mfma_f32_32x32x16_bf16 v[144:159], v[52:55], v[216:219], 0
  v_lshlrev_b32 v125, 16, v126
  v_and_b32 v126, s65, v126
  v_lshlrev_b32 v127, 16, v127
  s_waitcnt lgkmcnt(5)
  v_sub_f32 v230, v230, v125
  v_sub_f32 v231, v231, v126
  s_waitcnt lgkmcnt(4)
  v_sub_f32 v232, v232, v127
  v_cvt_pk_bf16_f32 v230, v230, v231
  v_cvt_pk_bf16_f32 v232, v232, v232
  v_lshlrev_b32 v10, 16, v230
  v_and_b32 v11, s65, v230
  v_lshlrev_b32 v12, 16, v232
  v_mul_f32 v230, v10, v10
  v_fmac_f32 v230, v11, v11
  v_fmac_f32 v230, v12, v12
  v_cvt_pk_f16_f32 v183, v230, v230
  v_mfma_f32_32x32x16_bf16 v[128:143], v[16:19], v[200:203], v[128:143]
  v_mfma_f32_32x32x16_bf16 v[128:143], v[20:23], v[204:207], v[128:143]
  v_mfma_f32_32x32x16_bf16 v[128:143], v[24:27], v[208:211], v[128:143]
  v_mfma_f32_32x32x16_bf16 v[128:143], v[28:31], v[212:215], v[128:143]
  s_waitcnt lgkmcnt(2)
  v_mfma_f32_32x32x16_f16 v[128:143], v[56:59], v[176:179], v[128:143]
  s_waitcnt lgkmcnt(0)
  v_mfma_f32_32x32x16_f16 v[128:143], v[60:63], v[180:183], v[128:143]
  s_cmp_gt_i32 s59, 0
  s_cselect_b32 s6, 6400000, 0
  s_cselect_b32 s10, 25600000, 0
  s_cselect_b32 s14, 300000, 0
  s_add_u32 m0, s67, 118784
  v_mad_u32_u24 v1, v1, 32, v253
  buffer_load_dwordx4 v1, s[8:11], 0 offen  lds
  s_add_u32 m0, s66, 0
  v_mad_u32_u24 v220, v220, s64, v233
  buffer_load_dwordx4 v220, s[4:7], 0 offen  lds
  s_add_u32 m0, s66, 1024
  v_mad_u32_u24 v221, v221, s64, v234
  buffer_load_dwordx4 v221, s[4:7], 0 offen  lds
  s_add_u32 m0, s66, 2048
  v_mad_u32_u24 v222, v222, s64, v235
  buffer_load_dwordx4 v222, s[4:7], 0 offen  lds
  s_add_u32 m0, s66, 3072
  v_mad_u32_u24 v223, v223, s64, v236
  buffer_load_dwordx4 v223, s[4:7], 0 offen  lds
  v_mul_u32_u24 v1, 6, v229
  v_and_b32 v1, -4, v1
  s_mov_b64 exec, s[74:75]
  buffer_load_dwordx2 v[226:227], v1, s[12:15], 0 offen
  s_mov_b64 exec, -1
  s_waitcnt lgkmcnt(0)
  s_cmp_eq_u32 s59, 0
  s_cbranch_scc1 LOOPEND
  s_cmp_ge_u32 s57, 4
  s_movk_i32 s79, 80
  s_cmovk_i32 s79, 80
LOOP:
  ds_read_b64_tr_b16 v[192:193], v244 offset:64
  ds_read_b64_tr_b16 v[194:195], v244 offset:208
  ds_read_b64_tr_b16 v[196:197], v244 offset:352
  ds_read_b64_tr_b16 v[198:199], v244 offset:496
  v_cvt_pk_f16_f32 v160, v128, v129
  v_cvt_pk_f16_f32 v161, v130, v131
  v_cvt_pk_f16_f32 v162, v132, v133
  v_cvt_pk_f16_f32 v163, v134, v135
  v_cvt_pk_f16_f32 v164, v136, v137
  v_cvt_pk_f16_f32 v165, v138, v139
  v_cvt_pk_f16_f32 v166, v140, v141
  v_cvt_pk_f16_f32 v167, v142, v143
  v_mfma_f32_16x16x32_f16 v[124:127], v[80:83], v[168:171], v[124:127]
  v_exp_f16_sdwa v2, v160 dst_sel:WORD_0 dst_unused:UNUSED_PAD src0_sel:WORD_0
  s_mov_b64 exec, 1
  ds_add_rtn_u32 v251, v0, v234 offset:35336
  s_mov_b64 exec, -1
  v_exp_f16_sdwa v3, v161 dst_sel:WORD_0 dst_unused:UNUSED_PAD src0_sel:WORD_0
  v_mfma_f32_16x16x32_f16 v[124:127], v[84:87], v[172:175], v[124:127]
  v_exp_f16_sdwa v4, v162 dst_sel:WORD_0 dst_unused:UNUSED_PAD src0_sel:WORD_0
  v_exp_f16_sdwa v5, v163 dst_sel:WORD_0 dst_unused:UNUSED_PAD src0_sel:WORD_0
  v_mfma_f32_32x32x16_bf16 v[144:159], v[32:35], v[200:203], v[144:159]
  v_exp_f16_sdwa v2, v160 dst_sel:WORD_1 dst_unused:UNUSED_PRESERVE src0_sel:WORD_1
  v_exp_f16_sdwa v3, v161 dst_sel:WORD_1 dst_unused:UNUSED_PRESERVE src0_sel:WORD_1
  v_exp_f16_sdwa v4, v162 dst_sel:WORD_1 dst_unused:UNUSED_PRESERVE src0_sel:WORD_1
  s_waitcnt lgkmcnt(3)
  v_mfma_f32_32x32x16_f16 v[104:119], v[192:195], v[184:187], v[104:119]
  v_exp_f16_sdwa v5, v163 dst_sel:WORD_1 dst_unused:UNUSED_PRESERVE src0_sel:WORD_1
  v_pk_add_f16 v2, v2, 1.0 op_sel_hi:[1,0]
  v_pk_add_f16 v3, v3, 1.0 op_sel_hi:[1,0]
  v_pk_add_f16 v4, v4, 1.0 op_sel_hi:[1,0]
  v_pk_add_f16 v5, v5, 1.0 op_sel_hi:[1,0]
  v_mul_f32 v230, v13, v124
  v_mul_f32 v231, v14, v124
  v_mul_f32 v232, v15, v124
  v_cvt_pk_f16_f32 v230, v230, v231
  v_cvt_pk_f16_f32 v231, v232, v232
  s_mov_b64 exec, s[74:75]
  ds_write_b64 v242, v[230:231] offset:128
  s_mov_b64 exec, -1
  v_rcp_f16_sdwa v6, v2 dst_sel:WORD_0 dst_unused:UNUSED_PAD src0_sel:WORD_0
  v_rcp_f16_sdwa v7, v3 dst_sel:WORD_0 dst_unused:UNUSED_PAD src0_sel:WORD_0
  s_waitcnt lgkmcnt(2)
  v_mfma_f32_32x32x16_f16 v[104:119], v[196:199], v[188:191], v[104:119]
  ds_read_b64_tr_b16 v[192:193], v245 offset:0
  ds_read_b64_tr_b16 v[194:195], v245 offset:144
  ds_read_b64_tr_b16 v[196:197], v245 offset:288
  ds_read_b64_tr_b16 v[198:199], v245 offset:432
  v_rcp_f16_sdwa v8, v4 dst_sel:WORD_0 dst_unused:UNUSED_PAD src0_sel:WORD_0
  s_waitcnt lgkmcnt(5)
  v_readfirstlane_b32 s68, v251
  s_setprio 1
  s_cmp_lt_i32 s68, s79
  s_cbranch_scc0 PRI0
  s_setprio 0
PRI0:
  s_add_u32 s79, s79, 128
  v_rcp_f16_sdwa v9, v5 dst_sel:WORD_0 dst_unused:UNUSED_PAD src0_sel:WORD_0
  v_rcp_f16_sdwa v6, v2 dst_sel:WORD_1 dst_unused:UNUSED_PRESERVE src0_sel:WORD_1
  v_mfma_f32_32x32x16_bf16 v[144:159], v[36:39], v[204:207], v[144:159]
  v_rcp_f16_sdwa v7, v3 dst_sel:WORD_1 dst_unused:UNUSED_PRESERVE src0_sel:WORD_1
  v_rcp_f16_sdwa v8, v4 dst_sel:WORD_1 dst_unused:UNUSED_PRESERVE src0_sel:WORD_1
  v_rcp_f16_sdwa v9, v5 dst_sel:WORD_1 dst_unused:UNUSED_PRESERVE src0_sel:WORD_1
  v_pk_mul_f16 v160, v160, v6
  v_pk_mul_f16 v161, v161, v7
  v_pk_mul_f16 v162, v162, v8
  v_pk_mul_f16 v163, v163, v9
  ds_write_b128 v242, v[160:163] offset:0
  v_mfma_f32_32x32x16_bf16 v[144:159], v[40:43], v[208:211], v[144:159]
  v_exp_f16_sdwa v2, v164 dst_sel:WORD_0 dst_unused:UNUSED_PAD src0_sel:WORD_0
  v_exp_f16_sdwa v3, v165 dst_sel:WORD_0 dst_unused:UNUSED_PAD src0_sel:WORD_0
  v_exp_f16_sdwa v4, v166 dst_sel:WORD_0 dst_unused:UNUSED_PAD src0_sel:WORD_0
  v_mfma_f32_32x32x16_bf16 v[144:159], v[44:47], v[212:215], v[144:159]
  v_exp_f16_sdwa v5, v167 dst_sel:WORD_0 dst_unused:UNUSED_PAD src0_sel:WORD_0
  v_exp_f16_sdwa v2, v164 dst_sel:WORD_1 dst_unused:UNUSED_PRESERVE src0_sel:WORD_1
  v_exp_f16_sdwa v3, v165 dst_sel:WORD_1 dst_unused:UNUSED_PRESERVE src0_sel:WORD_1
  v_mfma_f32_32x32x16_f16 v[144:159], v[64:67], v[176:179], v[144:159]
  v_exp_f16_sdwa v4, v166 dst_sel:WORD_1 dst_unused:UNUSED_PRESERVE src0_sel:WORD_1
  v_exp_f16_sdwa v5, v167 dst_sel:WORD_1 dst_unused:UNUSED_PRESERVE src0_sel:WORD_1
  v_pk_add_f16 v2, v2, 1.0 op_sel_hi:[1,0]
  v_pk_add_f16 v3, v3, 1.0 op_sel_hi:[1,0]
  v_pk_add_f16 v4, v4, 1.0 op_sel_hi:[1,0]
  v_pk_add_f16 v5, v5, 1.0 op_sel_hi:[1,0]
  v_rcp_f16_sdwa v6, v2 dst_sel:WORD_0 dst_unused:UNUSED_PAD src0_sel:WORD_0
  v_mfma_f32_32x32x16_f16 v[144:159], v[68:71], v[180:183], v[144:159]
  v_rcp_f16_sdwa v7, v3 dst_sel:WORD_0 dst_unused:UNUSED_PAD src0_sel:WORD_0
  s_waitcnt vmcnt(0)
  ds_read_b128 v[216:219], v254
  ds_read_b128 v[200:203], v237
  ds_read_b128 v[204:207], v238
  v_rcp_f16_sdwa v8, v4 dst_sel:WORD_0 dst_unused:UNUSED_PAD src0_sel:WORD_0
  v_rcp_f16_sdwa v9, v5 dst_sel:WORD_0 dst_unused:UNUSED_PAD src0_sel:WORD_0
  s_waitcnt lgkmcnt(6)
  v_mfma_f32_16x16x32_f16 v[120:123], v[192:195], v[184:187], v[120:123]
  ds_read_b128 v[208:211], v239
  ds_read_b128 v[212:215], v240
  v_rcp_f16_sdwa v6, v2 dst_sel:WORD_1 dst_unused:UNUSED_PRESERVE src0_sel:WORD_1
  v_add_u32_sdwa v249, v241, v229 dst_sel:DWORD dst_unused:UNUSED_PAD src0_sel:DWORD src1_sel:BYTE_3
  ds_read_b64 v[230:231], v249 offset:480
  ds_read_b32 v232, v249 offset:736
  v_lshlrev_b32 v125, 4, v229
  v_alignbit_b32 v126, v227, v226, v125
  v_lshrrev_b32 v127, v125, v227
  v_rcp_f16_sdwa v7, v3 dst_sel:WORD_1 dst_unused:UNUSED_PRESERVE src0_sel:WORD_1
  s_waitcnt lgkmcnt(8)
  v_mfma_f32_16x16x32_f16 v[120:123], v[196:199], v[188:191], v[120:123]
  ds_read_b64 v[176:177], v249 offset:192
  ds_read_b64 v[178:179], v249 offset:128
  ds_read_b64 v[180:181], v249 offset:64
  ds_read_b32 v182, v249
  ds_read_b128 v[184:187], v248 offset:0
  v_rcp_f16_sdwa v8, v4 dst_sel:WORD_1 dst_unused:UNUSED_PRESERVE src0_sel:WORD_1
  ds_read_b128 v[220:223], v246 offset:256
  ds_read_b32 v228, v247 offset:256
  ds_read_b32 v1, v252 offset:17664
  v_rcp_f16_sdwa v9, v5 dst_sel:WORD_1 dst_unused:UNUSED_PRESERVE src0_sel:WORD_1
  v_pk_mul_f16 v164, v164, v6
  v_pk_mul_f16 v165, v165, v7
  v_pk_mul_f16 v166, v166, v8
  v_pk_mul_f16 v167, v167, v9
  ds_write_b128 v242, v[164:167] offset:16
  v_cvt_pk_f16_f32 v168, v144, v145
  v_cvt_pk_f16_f32 v169, v146, v147
  v_cvt_pk_f16_f32 v170, v148, v149
  v_cvt_pk_f16_f32 v171, v150, v151
  v_cvt_pk_f16_f32 v172, v152, v153
  v_cvt_pk_f16_f32 v173, v154, v155
  v_cvt_pk_f16_f32 v174, v156, v157
  v_cvt_pk_f16_f32 v175, v158, v159
  s_waitcnt lgkmcnt(15)
  v_mfma_f32_32x32x16_bf16 v[128:143], v[48:51], v[216:219], 0
  ds_read_b64_tr_b16 v[192:193], v244 offset:0
  ds_read_b64_tr_b16 v[194:195], v244 offset:144
  ds_read_b64_tr_b16 v[196:197], v244 offset:288
  ds_read_b64_tr_b16 v[198:199], v244 offset:432
  v_exp_f16_sdwa v2, v168 dst_sel:WORD_0 dst_unused:UNUSED_PAD src0_sel:WORD_0
  v_exp_f16_sdwa v3, v169 dst_sel:WORD_0 dst_unused:UNUSED_PAD src0_sel:WORD_0
  v_exp_f16_sdwa v4, v170 dst_sel:WORD_0 dst_unused:UNUSED_PAD src0_sel:WORD_0
  v_mfma_f32_32x32x16_bf16 v[144:159], v[52:55], v[216:219], 0
  v_lshlrev_b32 v125, 16, v126
  v_and_b32 v126, s65, v126
  v_lshlrev_b32 v127, 16, v127
  v_exp_f16_sdwa v5, v171 dst_sel:WORD_0 dst_unused:UNUSED_PAD src0_sel:WORD_0
  v_exp_f16_sdwa v2, v168 dst_sel:WORD_1 dst_unused:UNUSED_PRESERVE src0_sel:WORD_1
  s_waitcnt lgkmcnt(15)
  v_mfma_f32_32x32x16_bf16 v[128:143], v[16:19], v[200:203], v[128:143]
  v_exp_f16_sdwa v3, v169 dst_sel:WORD_1 dst_unused:UNUSED_PRESERVE src0_sel:WORD_1
  v_exp_f16_sdwa v4, v170 dst_sel:WORD_1 dst_unused:UNUSED_PRESERVE src0_sel:WORD_1
  s_waitcnt lgkmcnt(8)
  v_add_u32_sdwa v184, v243, v184 dst_sel:DWORD dst_unused:UNUSED_PAD src0_sel:DWORD src1_sel:BYTE_3
  v_add_u32_sdwa v185, v243, v185 dst_sel:DWORD dst_unused:UNUSED_PAD src0_sel:DWORD src1_sel:BYTE_3
  v_add_u32_sdwa v186, v243, v186 dst_sel:DWORD dst_unused:UNUSED_PAD src0_sel:DWORD src1_sel:BYTE_3
  v_add_u32_sdwa v187, v243, v187 dst_sel:DWORD dst_unused:UNUSED_PAD src0_sel:DWORD src1_sel:BYTE_3
  ds_read_b64_tr_b16 v[190:191], v187
  ds_read_b64_tr_b16 v[188:189], v186
  ds_read_b64_tr_b16 v[186:187], v185
  ds_read_b64_tr_b16 v[184:185], v184
  s_cmp_gt_i32 s59, 1
  s_cselect_b32 s6, 6400000, 0
  s_cselect_b32 s10, 25600000, 0
  s_cselect_b32 s14, 300000, 0
  s_add_u32 m0, s67, 118784
  s_waitcnt lgkmcnt(9)
  v_mad_u32_u24 v1, v1, 32, v253
  buffer_load_dwordx4 v1, s[8:11], 0 offen  lds
  v_exp_f16_sdwa v5, v171 dst_sel:WORD_1 dst_unused:UNUSED_PRESERVE src0_sel:WORD_1
  v_pk_add_f16 v2, v2, 1.0 op_sel_hi:[1,0]
  v_pk_add_f16 v3, v3, 1.0 op_sel_hi:[1,0]
  v_pk_add_f16 v4, v4, 1.0 op_sel_hi:[1,0]
  v_pk_add_f16 v5, v5, 1.0 op_sel_hi:[1,0]
  v_mfma_f32_32x32x16_bf16 v[128:143], v[20:23], v[204:207], v[128:143]
  v_sub_f32 v230, v230, v125
  v_sub_f32 v231, v231, v126
  v_sub_f32 v232, v232, v127
  v_cvt_pk_bf16_f32 v230, v230, v231
  v_cvt_pk_bf16_f32 v232, v232, v232
  v_lshlrev_b32 v13, 16, v230
  v_and_b32 v14, s65, v230
  v_lshlrev_b32 v15, 16, v232
  v_rcp_f16_sdwa v6, v2 dst_sel:WORD_0 dst_unused:UNUSED_PAD src0_sel:WORD_0
  v_rcp_f16_sdwa v7, v3 dst_sel:WORD_0 dst_unused:UNUSED_PAD src0_sel:WORD_0
  v_rcp_f16_sdwa v8, v4 dst_sel:WORD_0 dst_unused:UNUSED_PAD src0_sel:WORD_0
  v_mfma_f32_32x32x16_bf16 v[128:143], v[24:27], v[208:211], v[128:143]
  s_add_u32 m0, s66, 0
  v_mad_u32_u24 v220, v220, s64, v233
  buffer_load_dwordx4 v220, s[4:7], 0 offen  lds
  v_rcp_f16_sdwa v9, v5 dst_sel:WORD_0 dst_unused:UNUSED_PAD src0_sel:WORD_0
  v_rcp_f16_sdwa v6, v2 dst_sel:WORD_1 dst_unused:UNUSED_PRESERVE src0_sel:WORD_1
  v_mfma_f32_32x32x16_bf16 v[128:143], v[28:31], v[212:215], v[128:143]
  s_add_u32 m0, s66, 1024
  v_mad_u32_u24 v221, v221, s64, v234
  buffer_load_dwordx4 v221, s[4:7], 0 offen  lds
  v_rcp_f16_sdwa v7, v3 dst_sel:WORD_1 dst_unused:UNUSED_PRESERVE src0_sel:WORD_1
  v_rcp_f16_sdwa v8, v4 dst_sel:WORD_1 dst_unused:UNUSED_PRESERVE src0_sel:WORD_1
  v_mul_f32 v230, v13, v13
  v_fmac_f32 v230, v14, v14
  v_fmac_f32 v230, v15, v15
  v_cvt_pk_f16_f32 v183, v230, v230
  v_rcp_f16_sdwa v9, v5 dst_sel:WORD_1 dst_unused:UNUSED_PRESERVE src0_sel:WORD_1
  v_pk_mul_f16 v168, v168, v6
  v_pk_mul_f16 v169, v169, v7
  v_pk_mul_f16 v170, v170, v8
  v_pk_mul_f16 v171, v171, v9
  ds_write_b128 v242, v[168:171] offset:64
  v_mfma_f32_16x16x32_f16 v[124:127], v[72:75], v[160:163], 0
  s_add_u32 m0, s66, 2048
  v_mad_u32_u24 v222, v222, s64, v235
  buffer_load_dwordx4 v222, s[4:7], 0 offen  lds
  v_exp_f16_sdwa v2, v172 dst_sel:WORD_0 dst_unused:UNUSED_PAD src0_sel:WORD_0
  v_exp_f16_sdwa v3, v173 dst_sel:WORD_0 dst_unused:UNUSED_PAD src0_sel:WORD_0
  v_mfma_f32_16x16x32_f16 v[124:127], v[76:79], v[164:167], v[124:127]
  s_add_u32 m0, s66, 3072
  v_mad_u32_u24 v223, v223, s64, v236
  buffer_load_dwordx4 v223, s[4:7], 0 offen  lds
  v_exp_f16_sdwa v4, v174 dst_sel:WORD_0 dst_unused:UNUSED_PAD src0_sel:WORD_0
  v_exp_f16_sdwa v5, v175 dst_sel:WORD_0 dst_unused:UNUSED_PAD src0_sel:WORD_0
  v_mfma_f32_32x32x16_f16 v[128:143], v[56:59], v[176:179], v[128:143]
  v_exp_f16_sdwa v2, v172 dst_sel:WORD_1 dst_unused:UNUSED_PRESERVE src0_sel:WORD_1
  v_exp_f16_sdwa v3, v173 dst_sel:WORD_1 dst_unused:UNUSED_PRESERVE src0_sel:WORD_1
  v_exp_f16_sdwa v4, v174 dst_sel:WORD_1 dst_unused:UNUSED_PRESERVE src0_sel:WORD_1
  v_mfma_f32_32x32x16_f16 v[128:143], v[60:63], v[180:183], v[128:143]
  v_mul_u32_u24 v1, 6, v228
  v_and_b32 v1, -4, v1
  s_mov_b64 exec, s[74:75]
  buffer_load_dwordx2 v[224:225], v1, s[12:15], 0 offen
  s_mov_b64 exec, -1
  v_exp_f16_sdwa v5, v175 dst_sel:WORD_1 dst_unused:UNUSED_PRESERVE src0_sel:WORD_1
  v_pk_add_f16 v2, v2, 1.0 op_sel_hi:[1,0]
  v_pk_add_f16 v3, v3, 1.0 op_sel_hi:[1,0]
  v_pk_add_f16 v4, v4, 1.0 op_sel_hi:[1,0]
  v_pk_add_f16 v5, v5, 1.0 op_sel_hi:[1,0]
  v_rcp_f16_sdwa v6, v2 dst_sel:WORD_0 dst_unused:UNUSED_PAD src0_sel:WORD_0
  v_rcp_f16_sdwa v7, v3 dst_sel:WORD_0 dst_unused:UNUSED_PAD src0_sel:WORD_0
  s_waitcnt lgkmcnt(1)
  v_mfma_f32_32x32x16_f16 v[88:103], v[192:195], v[184:187], v[88:103]
  v_rcp_f16_sdwa v8, v4 dst_sel:WORD_0 dst_unused:UNUSED_PAD src0_sel:WORD_0
  v_rcp_f16_sdwa v9, v5 dst_sel:WORD_0 dst_unused:UNUSED_PAD src0_sel:WORD_0
  v_rcp_f16_sdwa v6, v2 dst_sel:WORD_1 dst_unused:UNUSED_PRESERVE src0_sel:WORD_1
  v_mfma_f32_32x32x16_f16 v[88:103], v[196:199], v[188:191], v[88:103]
  v_rcp_f16_sdwa v7, v3 dst_sel:WORD_1 dst_unused:UNUSED_PRESERVE src0_sel:WORD_1
  v_rcp_f16_sdwa v8, v4 dst_sel:WORD_1 dst_unused:UNUSED_PRESERVE src0_sel:WORD_1
  v_rcp_f16_sdwa v9, v5 dst_sel:WORD_1 dst_unused:UNUSED_PRESERVE src0_sel:WORD_1
  v_pk_mul_f16 v172, v172, v6
  v_pk_mul_f16 v173, v173, v7
  v_pk_mul_f16 v174, v174, v8
  v_pk_mul_f16 v175, v175, v9
  ds_write_b128 v242, v[172:175] offset:80
  s_sub_u32 s59, s59, 1
  s_cmp_eq_u32 s59, 0
  s_cbranch_scc1 TAIL0
  ds_read_b64_tr_b16 v[192:193], v244 offset:64
  ds_read_b64_tr_b16 v[194:195], v244 offset:208
  ds_read_b64_tr_b16 v[196:197], v244 offset:352
  ds_read_b64_tr_b16 v[198:199], v244 offset:496
  v_cvt_pk_f16_f32 v160, v128, v129
  v_cvt_pk_f16_f32 v161, v130, v131
  v_cvt_pk_f16_f32 v162, v132, v133
  v_cvt_pk_f16_f32 v163, v134, v135
  v_cvt_pk_f16_f32 v164, v136, v137
  v_cvt_pk_f16_f32 v165, v138, v139
  v_cvt_pk_f16_f32 v166, v140, v141
  v_cvt_pk_f16_f32 v167, v142, v143
  v_mfma_f32_16x16x32_f16 v[124:127], v[80:83], v[168:171], v[124:127]
  v_exp_f16_sdwa v2, v160 dst_sel:WORD_0 dst_unused:UNUSED_PAD src0_sel:WORD_0
  s_mov_b64 exec, 1
  ds_add_rtn_u32 v251, v0, v234 offset:35336
  s_mov_b64 exec, -1
  v_exp_f16_sdwa v3, v161 dst_sel:WORD_0 dst_unused:UNUSED_PAD src0_sel:WORD_0
  v_mfma_f32_16x16x32_f16 v[124:127], v[84:87], v[172:175], v[124:127]
  v_exp_f16_sdwa v4, v162 dst_sel:WORD_0 dst_unused:UNUSED_PAD src0_sel:WORD_0
  v_exp_f16_sdwa v5, v163 dst_sel:WORD_0 dst_unused:UNUSED_PAD src0_sel:WORD_0
  v_mfma_f32_32x32x16_bf16 v[144:159], v[32:35], v[200:203], v[144:159]
  v_exp_f16_sdwa v2, v160 dst_sel:WORD_1 dst_unused:UNUSED_PRESERVE src0_sel:WORD_1
  v_exp_f16_sdwa v3, v161 dst_sel:WORD_1 dst_unused:UNUSED_PRESERVE src0_sel:WORD_1
  v_exp_f16_sdwa v4, v162 dst_sel:WORD_1 dst_unused:UNUSED_PRESERVE src0_sel:WORD_1
  s_waitcnt lgkmcnt(3)
  v_mfma_f32_32x32x16_f16 v[104:119], v[192:195], v[184:187], v[104:119]
  v_exp_f16_sdwa v5, v163 dst_sel:WORD_1 dst_unused:UNUSED_PRESERVE src0_sel:WORD_1
  v_pk_add_f16 v2, v2, 1.0 op_sel_hi:[1,0]
  v_pk_add_f16 v3, v3, 1.0 op_sel_hi:[1,0]
  v_pk_add_f16 v4, v4, 1.0 op_sel_hi:[1,0]
  v_pk_add_f16 v5, v5, 1.0 op_sel_hi:[1,0]
  v_mul_f32 v230, v10, v124
  v_mul_f32 v231, v11, v124
  v_mul_f32 v232, v12, v124
  v_cvt_pk_f16_f32 v230, v230, v231
  v_cvt_pk_f16_f32 v231, v232, v232
  s_mov_b64 exec, s[74:75]
  ds_write_b64 v242, v[230:231] offset:128
  s_mov_b64 exec, -1
  v_rcp_f16_sdwa v6, v2 dst_sel:WORD_0 dst_unused:UNUSED_PAD src0_sel:WORD_0
  v_rcp_f16_sdwa v7, v3 dst_sel:WORD_0 dst_unused:UNUSED_PAD src0_sel:WORD_0
  s_waitcnt lgkmcnt(2)
  v_mfma_f32_32x32x16_f16 v[104:119], v[196:199], v[188:191], v[104:119]
  ds_read_b64_tr_b16 v[192:193], v245 offset:0
  ds_read_b64_tr_b16 v[194:195], v245 offset:144
  ds_read_b64_tr_b16 v[196:197], v245 offset:288
  ds_read_b64_tr_b16 v[198:199], v245 offset:432
  v_rcp_f16_sdwa v8, v4 dst_sel:WORD_0 dst_unused:UNUSED_PAD src0_sel:WORD_0
  s_waitcnt lgkmcnt(5)
  v_readfirstlane_b32 s68, v251
  s_setprio 1
  s_cmp_lt_i32 s68, s79
  s_cbranch_scc0 PRI1
  s_setprio 0
PRI1:
  s_add_u32 s79, s79, 128
  v_rcp_f16_sdwa v9, v5 dst_sel:WORD_0 dst_unused:UNUSED_PAD src0_sel:WORD_0
  v_rcp_f16_sdwa v6, v2 dst_sel:WORD_1 dst_unused:UNUSED_PRESERVE src0_sel:WORD_1
  v_mfma_f32_32x32x16_bf16 v[144:159], v[36:39], v[204:207], v[144:159]
  v_rcp_f16_sdwa v7, v3 dst_sel:WORD_1 dst_unused:UNUSED_PRESERVE src0_sel:WORD_1
  v_rcp_f16_sdwa v8, v4 dst_sel:WORD_1 dst_unused:UNUSED_PRESERVE src0_sel:WORD_1
  v_rcp_f16_sdwa v9, v5 dst_sel:WORD_1 dst_unused:UNUSED_PRESERVE src0_sel:WORD_1
  v_pk_mul_f16 v160, v160, v6
  v_pk_mul_f16 v161, v161, v7
  v_pk_mul_f16 v162, v162, v8
  v_pk_mul_f16 v163, v163, v9
  ds_write_b128 v242, v[160:163] offset:0
  v_mfma_f32_32x32x16_bf16 v[144:159], v[40:43], v[208:211], v[144:159]
  v_exp_f16_sdwa v2, v164 dst_sel:WORD_0 dst_unused:UNUSED_PAD src0_sel:WORD_0
  v_exp_f16_sdwa v3, v165 dst_sel:WORD_0 dst_unused:UNUSED_PAD src0_sel:WORD_0
  v_exp_f16_sdwa v4, v166 dst_sel:WORD_0 dst_unused:UNUSED_PAD src0_sel:WORD_0
  v_mfma_f32_32x32x16_bf16 v[144:159], v[44:47], v[212:215], v[144:159]
  v_exp_f16_sdwa v5, v167 dst_sel:WORD_0 dst_unused:UNUSED_PAD src0_sel:WORD_0
  v_exp_f16_sdwa v2, v164 dst_sel:WORD_1 dst_unused:UNUSED_PRESERVE src0_sel:WORD_1
  v_exp_f16_sdwa v3, v165 dst_sel:WORD_1 dst_unused:UNUSED_PRESERVE src0_sel:WORD_1
  v_mfma_f32_32x32x16_f16 v[144:159], v[64:67], v[176:179], v[144:159]
  v_exp_f16_sdwa v4, v166 dst_sel:WORD_1 dst_unused:UNUSED_PRESERVE src0_sel:WORD_1
  v_exp_f16_sdwa v5, v167 dst_sel:WORD_1 dst_unused:UNUSED_PRESERVE src0_sel:WORD_1
  v_pk_add_f16 v2, v2, 1.0 op_sel_hi:[1,0]
  v_pk_add_f16 v3, v3, 1.0 op_sel_hi:[1,0]
  v_pk_add_f16 v4, v4, 1.0 op_sel_hi:[1,0]
  v_pk_add_f16 v5, v5, 1.0 op_sel_hi:[1,0]
  v_rcp_f16_sdwa v6, v2 dst_sel:WORD_0 dst_unused:UNUSED_PAD src0_sel:WORD_0
  v_mfma_f32_32x32x16_f16 v[144:159], v[68:71], v[180:183], v[144:159]
  v_rcp_f16_sdwa v7, v3 dst_sel:WORD_0 dst_unused:UNUSED_PAD src0_sel:WORD_0
  s_waitcnt vmcnt(0)
  ds_read_b128 v[216:219], v254
  ds_read_b128 v[200:203], v237
  ds_read_b128 v[204:207], v238
  v_rcp_f16_sdwa v8, v4 dst_sel:WORD_0 dst_unused:UNUSED_PAD src0_sel:WORD_0
  v_rcp_f16_sdwa v9, v5 dst_sel:WORD_0 dst_unused:UNUSED_PAD src0_sel:WORD_0
  s_waitcnt lgkmcnt(6)
  v_mfma_f32_16x16x32_f16 v[120:123], v[192:195], v[184:187], v[120:123]
  ds_read_b128 v[208:211], v239
  ds_read_b128 v[212:215], v240
  v_rcp_f16_sdwa v6, v2 dst_sel:WORD_1 dst_unused:UNUSED_PRESERVE src0_sel:WORD_1
  v_add_u32_sdwa v249, v241, v228 dst_sel:DWORD dst_unused:UNUSED_PAD src0_sel:DWORD src1_sel:BYTE_3
  ds_read_b64 v[230:231], v249 offset:480
  ds_read_b32 v232, v249 offset:736
  v_lshlrev_b32 v125, 4, v228
  v_alignbit_b32 v126, v225, v224, v125
  v_lshrrev_b32 v127, v125, v225
  v_rcp_f16_sdwa v7, v3 dst_sel:WORD_1 dst_unused:UNUSED_PRESERVE src0_sel:WORD_1
  s_waitcnt lgkmcnt(8)
  v_mfma_f32_16x16x32_f16 v[120:123], v[196:199], v[188:191], v[120:123]
  ds_read_b64 v[176:177], v249 offset:192
  ds_read_b64 v[178:179], v249 offset:128
  ds_read_b64 v[180:181], v249 offset:64
  ds_read_b32 v182, v249
  ds_read_b128 v[184:187], v248 offset:128
  v_rcp_f16_sdwa v8, v4 dst_sel:WORD_1 dst_unused:UNUSED_PRESERVE src0_sel:WORD_1
  ds_read_b128 v[220:223], v246 offset:384
  ds_read_b32 v229, v247 offset:384
  ds_read_b32 v1, v252 offset:17792
  v_rcp_f16_sdwa v9, v5 dst_sel:WORD_1 dst_unused:UNUSED_PRESERVE src0_sel:WORD_1
  v_pk_mul_f16 v164, v164, v6
  v_pk_mul_f16 v165, v165, v7
  v_pk_mul_f16 v166, v166, v8
  v_pk_mul_f16 v167, v167, v9
  ds_write_b128 v242, v[164:167] offset:16
  v_cvt_pk_f16_f32 v168, v144, v145
  v_cvt_pk_f16_f32 v169, v146, v147
  v_cvt_pk_f16_f32 v170, v148, v149
  v_cvt_pk_f16_f32 v171, v150, v151
  v_cvt_pk_f16_f32 v172, v152, v153
  v_cvt_pk_f16_f32 v173, v154, v155
  v_cvt_pk_f16_f32 v174, v156, v157
  v_cvt_pk_f16_f32 v175, v158, v159
  s_waitcnt lgkmcnt(15)
  v_mfma_f32_32x32x16_bf16 v[128:143], v[48:51], v[216:219], 0
  ds_read_b64_tr_b16 v[192:193], v244 offset:0
  ds_read_b64_tr_b16 v[194:195], v244 offset:144
  ds_read_b64_tr_b16 v[196:197], v244 offset:288
  ds_read_b64_tr_b16 v[198:199], v244 offset:432
  v_exp_f16_sdwa v2, v168 dst_sel:WORD_0 dst_unused:UNUSED_PAD src0_sel:WORD_0
  v_exp_f16_sdwa v3, v169 dst_sel:WORD_0 dst_unused:UNUSED_PAD src0_sel:WORD_0
  v_exp_f16_sdwa v4, v170 dst_sel:WORD_0 dst_unused:UNUSED_PAD src0_sel:WORD_0
  v_mfma_f32_32x32x16_bf16 v[144:159], v[52:55], v[216:219], 0
  v_lshlrev_b32 v125, 16, v126
  v_and_b32 v126, s65, v126
  v_lshlrev_b32 v127, 16, v127
  v_exp_f16_sdwa v5, v171 dst_sel:WORD_0 dst_unused:UNUSED_PAD src0_sel:WORD_0
  v_exp_f16_sdwa v2, v168 dst_sel:WORD_1 dst_unused:UNUSED_PRESERVE src0_sel:WORD_1
  s_waitcnt lgkmcnt(15)
  v_mfma_f32_32x32x16_bf16 v[128:143], v[16:19], v[200:203], v[128:143]
  v_exp_f16_sdwa v3, v169 dst_sel:WORD_1 dst_unused:UNUSED_PRESERVE src0_sel:WORD_1
  v_exp_f16_sdwa v4, v170 dst_sel:WORD_1 dst_unused:UNUSED_PRESERVE src0_sel:WORD_1
  s_waitcnt lgkmcnt(8)
  v_add_u32_sdwa v184, v243, v184 dst_sel:DWORD dst_unused:UNUSED_PAD src0_sel:DWORD src1_sel:BYTE_3
  v_add_u32_sdwa v185, v243, v185 dst_sel:DWORD dst_unused:UNUSED_PAD src0_sel:DWORD src1_sel:BYTE_3
  v_add_u32_sdwa v186, v243, v186 dst_sel:DWORD dst_unused:UNUSED_PAD src0_sel:DWORD src1_sel:BYTE_3
  v_add_u32_sdwa v187, v243, v187 dst_sel:DWORD dst_unused:UNUSED_PAD src0_sel:DWORD src1_sel:BYTE_3
  ds_read_b64_tr_b16 v[190:191], v187
  ds_read_b64_tr_b16 v[188:189], v186
  ds_read_b64_tr_b16 v[186:187], v185
  ds_read_b64_tr_b16 v[184:185], v184
  s_cmp_gt_i32 s59, 1
  s_cselect_b32 s6, 6400000, 0
  s_cselect_b32 s10, 25600000, 0
  s_cselect_b32 s14, 300000, 0
  s_add_u32 m0, s67, 118784
  s_waitcnt lgkmcnt(9)
  v_mad_u32_u24 v1, v1, 32, v253
  buffer_load_dwordx4 v1, s[8:11], 0 offen  lds
  v_exp_f16_sdwa v5, v171 dst_sel:WORD_1 dst_unused:UNUSED_PRESERVE src0_sel:WORD_1
  v_pk_add_f16 v2, v2, 1.0 op_sel_hi:[1,0]
  v_pk_add_f16 v3, v3, 1.0 op_sel_hi:[1,0]
  v_pk_add_f16 v4, v4, 1.0 op_sel_hi:[1,0]
  v_pk_add_f16 v5, v5, 1.0 op_sel_hi:[1,0]
  v_mfma_f32_32x32x16_bf16 v[128:143], v[20:23], v[204:207], v[128:143]
  v_sub_f32 v230, v230, v125
  v_sub_f32 v231, v231, v126
  v_sub_f32 v232, v232, v127
  v_cvt_pk_bf16_f32 v230, v230, v231
  v_cvt_pk_bf16_f32 v232, v232, v232
  v_lshlrev_b32 v10, 16, v230
  v_and_b32 v11, s65, v230
  v_lshlrev_b32 v12, 16, v232
  v_rcp_f16_sdwa v6, v2 dst_sel:WORD_0 dst_unused:UNUSED_PAD src0_sel:WORD_0
  v_rcp_f16_sdwa v7, v3 dst_sel:WORD_0 dst_unused:UNUSED_PAD src0_sel:WORD_0
  v_rcp_f16_sdwa v8, v4 dst_sel:WORD_0 dst_unused:UNUSED_PAD src0_sel:WORD_0
  v_mfma_f32_32x32x16_bf16 v[128:143], v[24:27], v[208:211], v[128:143]
  s_add_u32 m0, s66, 0
  v_mad_u32_u24 v220, v220, s64, v233
  buffer_load_dwordx4 v220, s[4:7], 0 offen  lds
  v_rcp_f16_sdwa v9, v5 dst_sel:WORD_0 dst_unused:UNUSED_PAD src0_sel:WORD_0
  v_rcp_f16_sdwa v6, v2 dst_sel:WORD_1 dst_unused:UNUSED_PRESERVE src0_sel:WORD_1
  v_mfma_f32_32x32x16_bf16 v[128:143], v[28:31], v[212:215], v[128:143]
  s_add_u32 m0, s66, 1024
  v_mad_u32_u24 v221, v221, s64, v234
  buffer_load_dwordx4 v221, s[4:7], 0 offen  lds
  v_rcp_f16_sdwa v7, v3 dst_sel:WORD_1 dst_unused:UNUSED_PRESERVE src0_sel:WORD_1
  v_rcp_f16_sdwa v8, v4 dst_sel:WORD_1 dst_unused:UNUSED_PRESERVE src0_sel:WORD_1
  v_mul_f32 v230, v10, v10
  v_fmac_f32 v230, v11, v11
  v_fmac_f32 v230, v12, v12
  v_cvt_pk_f16_f32 v183, v230, v230
  v_rcp_f16_sdwa v9, v5 dst_sel:WORD_1 dst_unused:UNUSED_PRESERVE src0_sel:WORD_1
  v_pk_mul_f16 v168, v168, v6
  v_pk_mul_f16 v169, v169, v7
  v_pk_mul_f16 v170, v170, v8
  v_pk_mul_f16 v171, v171, v9
  ds_write_b128 v242, v[168:171] offset:64
  v_mfma_f32_16x16x32_f16 v[124:127], v[72:75], v[160:163], 0
  s_add_u32 m0, s66, 2048
  v_mad_u32_u24 v222, v222, s64, v235
  buffer_load_dwordx4 v222, s[4:7], 0 offen  lds
  v_exp_f16_sdwa v2, v172 dst_sel:WORD_0 dst_unused:UNUSED_PAD src0_sel:WORD_0
  v_exp_f16_sdwa v3, v173 dst_sel:WORD_0 dst_unused:UNUSED_PAD src0_sel:WORD_0
  v_mfma_f32_16x16x32_f16 v[124:127], v[76:79], v[164:167], v[124:127]
  s_add_u32 m0, s66, 3072
  v_mad_u32_u24 v223, v223, s64, v236
  buffer_load_dwordx4 v223, s[4:7], 0 offen  lds
  v_exp_f16_sdwa v4, v174 dst_sel:WORD_0 dst_unused:UNUSED_PAD src0_sel:WORD_0
  v_exp_f16_sdwa v5, v175 dst_sel:WORD_0 dst_unused:UNUSED_PAD src0_sel:WORD_0
  v_mfma_f32_32x32x16_f16 v[128:143], v[56:59], v[176:179], v[128:143]
  v_exp_f16_sdwa v2, v172 dst_sel:WORD_1 dst_unused:UNUSED_PRESERVE src0_sel:WORD_1
  v_exp_f16_sdwa v3, v173 dst_sel:WORD_1 dst_unused:UNUSED_PRESERVE src0_sel:WORD_1
  v_exp_f16_sdwa v4, v174 dst_sel:WORD_1 dst_unused:UNUSED_PRESERVE src0_sel:WORD_1
  v_mfma_f32_32x32x16_f16 v[128:143], v[60:63], v[180:183], v[128:143]
  v_mul_u32_u24 v1, 6, v229
  v_and_b32 v1, -4, v1
  s_mov_b64 exec, s[74:75]
  buffer_load_dwordx2 v[226:227], v1, s[12:15], 0 offen
  s_mov_b64 exec, -1
  v_exp_f16_sdwa v5, v175 dst_sel:WORD_1 dst_unused:UNUSED_PRESERVE src0_sel:WORD_1
  v_pk_add_f16 v2, v2, 1.0 op_sel_hi:[1,0]
  v_pk_add_f16 v3, v3, 1.0 op_sel_hi:[1,0]
  v_pk_add_f16 v4, v4, 1.0 op_sel_hi:[1,0]
  v_pk_add_f16 v5, v5, 1.0 op_sel_hi:[1,0]
  v_rcp_f16_sdwa v6, v2 dst_sel:WORD_0 dst_unused:UNUSED_PAD src0_sel:WORD_0
  v_rcp_f16_sdwa v7, v3 dst_sel:WORD_0 dst_unused:UNUSED_PAD src0_sel:WORD_0
  s_waitcnt lgkmcnt(1)
  v_mfma_f32_32x32x16_f16 v[88:103], v[192:195], v[184:187], v[88:103]
  v_rcp_f16_sdwa v8, v4 dst_sel:WORD_0 dst_unused:UNUSED_PAD src0_sel:WORD_0
  v_rcp_f16_sdwa v9, v5 dst_sel:WORD_0 dst_unused:UNUSED_PAD src0_sel:WORD_0
  v_rcp_f16_sdwa v6, v2 dst_sel:WORD_1 dst_unused:UNUSED_PRESERVE src0_sel:WORD_1
  v_mfma_f32_32x32x16_f16 v[88:103], v[196:199], v[188:191], v[88:103]
  v_rcp_f16_sdwa v7, v3 dst_sel:WORD_1 dst_unused:UNUSED_PRESERVE src0_sel:WORD_1
  v_rcp_f16_sdwa v8, v4 dst_sel:WORD_1 dst_unused:UNUSED_PRESERVE src0_sel:WORD_1
  v_rcp_f16_sdwa v9, v5 dst_sel:WORD_1 dst_unused:UNUSED_PRESERVE src0_sel:WORD_1
  v_pk_mul_f16 v172, v172, v6
  v_pk_mul_f16 v173, v173, v7
  v_pk_mul_f16 v174, v174, v8
  v_pk_mul_f16 v175, v175, v9
  ds_write_b128 v242, v[172:175] offset:80
  s_sub_u32 s59, s59, 1
  s_cmp_eq_u32 s59, 0
  v_add_u32 v246, 0x100, v246
  v_add_u32 v247, 0x100, v247
  v_add_u32 v248, 0x100, v248
  v_add_u32 v252, 0x100, v252
  s_cbranch_scc0 LOOP
  v_mov_b32 v10, v13
  v_mov_b32 v11, v14
  v_mov_b32 v12, v15
TAIL0:
  s_waitcnt lgkmcnt(0)
  ds_read_b64_tr_b16 v[192:193], v244 offset:64
  ds_read_b64_tr_b16 v[194:195], v244 offset:208
  ds_read_b64_tr_b16 v[196:197], v244 offset:352
  ds_read_b64_tr_b16 v[198:199], v244 offset:496
  v_mfma_f32_16x16x32_f16 v[124:127], v[80:83], v[168:171], v[124:127]
  v_mfma_f32_16x16x32_f16 v[124:127], v[84:87], v[172:175], v[124:127]
  s_waitcnt lgkmcnt(2)
  v_mfma_f32_32x32x16_f16 v[104:119], v[192:195], v[184:187], v[104:119]
  s_waitcnt lgkmcnt(0)
  v_mfma_f32_32x32x16_f16 v[104:119], v[196:199], v[188:191], v[104:119]
  s_nop 3
  v_mul_f32 v230, v10, v124
  v_mul_f32 v231, v11, v124
  v_mul_f32 v232, v12, v124
  v_cvt_pk_f16_f32 v230, v230, v231
  v_cvt_pk_f16_f32 v231, v232, v232
  s_mov_b64 exec, s[74:75]
  ds_write_b64 v242, v[230:231] offset:128
  s_mov_b64 exec, -1
  ds_read_b64_tr_b16 v[192:193], v245 offset:0
  ds_read_b64_tr_b16 v[194:195], v245 offset:144
  ds_read_b64_tr_b16 v[196:197], v245 offset:288
  ds_read_b64_tr_b16 v[198:199], v245 offset:432
  s_waitcnt lgkmcnt(2)
  v_mfma_f32_16x16x32_f16 v[120:123], v[192:195], v[184:187], v[120:123]
  s_waitcnt lgkmcnt(0)
  v_mfma_f32_16x16x32_f16 v[120:123], v[196:199], v[188:191], v[120:123]
LOOPEND:
  s_cmp_eq_u32 s62, 0
  s_cbranch_scc1 EPI
  s_add_u32 s61, s61, s60
  s_min_u32 s60, s60, 32
  s_waitcnt vmcnt(0)
  s_barrier
  s_branch ROUND
EPI:
  v_and_b32 v2, 1, v0
  v_bfe_u32 v3, v0, 1, 1
  v_bfe_u32 v4, v0, 2, 2
  v_bfe_u32 v5, v0, 4, 1
  v_lshlrev_b32 v2, 6, v2
  v_lshl_add_u32 v2, v3, 3, v2
  v_lshl_add_u32 v2, v5, 4, v2
  v_lshrrev_b32 v3, 1, v4
  v_lshl_add_u32 v2, v3, 5, v2
  v_lshl_add_u32 v2, v4, 7, v2
  v_add_u32 v2, 114176, v2
  v_lshl_add_u32 v6, v250, 8, v2
  v_xor_b32 v7, 32, v6
  v_lshl_add_u32 v8, v250, 6, v2
  v_xor_b32 v9, 32, v8
  v_lshl_add_u32 v249, v0, 3, s67
  ds_read_b64 v[220:221], v249 offset:512
  ds_read_b32 v222, v249 offset:768
  ds_read_b64_tr_b16 v[16:17], v6 offset:0
  ds_read_b64_tr_b16 v[18:19], v6 offset:512
  ds_read_b64_tr_b16 v[20:21], v6 offset:1024
  ds_read_b64_tr_b16 v[22:23], v6 offset:1536
  ds_read_b64_tr_b16 v[24:25], v6 offset:2048
  ds_read_b64_tr_b16 v[26:27], v6 offset:2560
  ds_read_b64_tr_b16 v[28:29], v6 offset:3072
  ds_read_b64_tr_b16 v[30:31], v6 offset:3584
  ds_read_b64_tr_b16 v[32:33], v8 offset:8192
  ds_read_b64_tr_b16 v[34:35], v8 offset:10240
  ds_read_b64_tr_b16 v[36:37], v8 offset:8704
  ds_read_b64_tr_b16 v[38:39], v8 offset:10752
  ds_read_b64_tr_b16 v[40:41], v8 offset:12288
  ds_read_b64_tr_b16 v[42:43], v8 offset:14336
  ds_read_b64_tr_b16 v[44:45], v8 offset:12800
  ds_read_b64_tr_b16 v[46:47], v8 offset:14848
  s_mov_b32 s68, 0xbf317218
  s_mov_b32 s69, 0xbf317218
  v_pk_mul_f32 v[88:89], v[88:89], s[68:69]
  v_pk_mul_f32 v[90:91], v[90:91], s[68:69]
  v_pk_mul_f32 v[92:93], v[92:93], s[68:69]
  v_pk_mul_f32 v[94:95], v[94:95], s[68:69]
  v_pk_mul_f32 v[96:97], v[96:97], s[68:69]
  v_pk_mul_f32 v[98:99], v[98:99], s[68:69]
  v_pk_mul_f32 v[100:101], v[100:101], s[68:69]
  v_pk_mul_f32 v[102:103], v[102:103], s[68:69]
  v_pk_mul_f32 v[104:105], v[104:105], s[68:69]
  v_pk_mul_f32 v[106:107], v[106:107], s[68:69]
  v_pk_mul_f32 v[108:109], v[108:109], s[68:69]
  v_pk_mul_f32 v[110:111], v[110:111], s[68:69]
  v_pk_mul_f32 v[112:113], v[112:113], s[68:69]
  v_pk_mul_f32 v[114:115], v[114:115], s[68:69]
  v_pk_mul_f32 v[116:117], v[116:117], s[68:69]
  v_pk_mul_f32 v[118:119], v[118:119], s[68:69]
  v_pk_mul_f32 v[120:121], v[120:121], s[68:69]
  v_pk_mul_f32 v[122:123], v[122:123], s[68:69]
  s_waitcnt lgkmcnt(8)
  v_mfma_f32_32x32x16_bf16 v[128:143], v[16:19], v[200:203], 0
  v_cvt_pk_bf16_f32 v160, v88, v89
  v_cvt_pk_bf16_f32 v161, v90, v91
  v_cvt_pk_bf16_f32 v162, v92, v93
  v_cvt_pk_bf16_f32 v163, v94, v95
  v_cvt_pk_bf16_f32 v164, v96, v97
  v_mfma_f32_32x32x16_bf16 v[128:143], v[20:23], v[204:207], v[128:143]
  v_cvt_pk_bf16_f32 v165, v98, v99
  v_cvt_pk_bf16_f32 v166, v100, v101
  v_cvt_pk_bf16_f32 v167, v102, v103
  v_cvt_pk_bf16_f32 v168, v104, v105
  v_cvt_pk_bf16_f32 v169, v106, v107
  v_mfma_f32_32x32x16_bf16 v[128:143], v[24:27], v[208:211], v[128:143]
  v_cvt_pk_bf16_f32 v170, v108, v109
  v_cvt_pk_bf16_f32 v171, v110, v111
  v_cvt_pk_bf16_f32 v172, v112, v113
  v_cvt_pk_bf16_f32 v173, v114, v115
  v_cvt_pk_bf16_f32 v174, v116, v117
  v_mfma_f32_32x32x16_bf16 v[128:143], v[28:31], v[212:215], v[128:143]
  v_cvt_pk_bf16_f32 v175, v118, v119
  s_waitcnt lgkmcnt(0)
  ds_read_b64_tr_b16 v[48:49], v7 offset:0
  ds_read_b64_tr_b16 v[50:51], v7 offset:512
  ds_read_b64_tr_b16 v[52:53], v7 offset:1024
  ds_read_b64_tr_b16 v[54:55], v7 offset:1536
  ds_read_b64_tr_b16 v[56:57], v7 offset:2048
  ds_read_b64_tr_b16 v[58:59], v7 offset:2560
  ds_read_b64_tr_b16 v[60:61], v7 offset:3072
  ds_read_b64_tr_b16 v[62:63], v7 offset:3584
  ds_read_b64_tr_b16 v[64:65], v9 offset:8192
  ds_read_b64_tr_b16 v[66:67], v9 offset:10240
  ds_read_b64_tr_b16 v[68:69], v9 offset:8704
  ds_read_b64_tr_b16 v[70:71], v9 offset:10752
  ds_read_b64_tr_b16 v[72:73], v9 offset:12288
  ds_read_b64_tr_b16 v[74:75], v9 offset:14336
  ds_read_b64_tr_b16 v[76:77], v9 offset:12800
  ds_read_b64_tr_b16 v[78:79], v9 offset:14848
  v_mfma_f32_32x32x16_bf16 v[128:143], v[32:35], v[160:163], v[128:143]
  v_add_f32 v220, v220, v120
  v_add_f32 v221, v221, v121
  v_add_f32 v222, v222, v122
  v_cvt_pk_bf16_f32 v220, v220, v221
  v_cvt_pk_bf16_f32 v222, v222, v222
  v_add_u32 v230, s58, v0
  v_mfma_f32_32x32x16_bf16 v[128:143], v[36:39], v[164:167], v[128:143]
  v_mul_u32_u24 v230, 6, v230
  v_add_u32 v230, 6400000, v230
  v_lshl_add_u32 v242, v250, 1, v242
  v_lshrrev_b32 v246, 3, v0
  v_and_b32 v247, 7, v0
  s_mul_i32 s3, s57, 4608
  v_mfma_f32_32x32x16_bf16 v[128:143], v[40:43], v[168:171], v[128:143]
  s_add_u32 s3, s3, 44544
  v_mul_u32_u24 v248, 144, v246
  v_lshl_add_u32 v248, v247, 4, v248
  v_add_u32 v248, s3, v248
  s_lshl_b32 s3, s58, 7
  v_lshl_add_u32 v231, v0, 4, s3
  v_mfma_f32_32x32x16_bf16 v[128:143], v[44:47], v[172:175], v[128:143]
  s_bfe_u32 s68, s78, 0x10018
  s_mul_i32 s68, s68, 255
  s_mov_b32 s69, 0
  s_mov_b32 exec_lo, s78
  s_mov_b32 exec_hi, 0
  buffer_store_short v220, v230, s[28:31], 0 offen
  buffer_store_short_d16_hi v220, v230, s[28:31], 0 offen offset:2
  buffer_store_short v222, v230, s[28:31], 0 offen offset:4
  s_mov_b64 exec, -1
  s_waitcnt lgkmcnt(0)
  v_mfma_f32_32x32x16_bf16 v[144:159], v[48:51], v[200:203], 0
  s_nop 0
  v_pk_mul_f32 v[2:3], v[128:129], s[70:71]
  v_pk_mul_f32 v[4:5], v[130:131], s[70:71]
  v_pk_mul_f32 v[6:7], v[132:133], s[70:71]
  v_pk_mul_f32 v[8:9], v[134:135], s[70:71]
  v_exp_f32 v2, v2
  v_mfma_f32_32x32x16_bf16 v[144:159], v[52:55], v[204:207], v[144:159]
  v_exp_f32 v3, v3
  v_exp_f32 v4, v4
  v_exp_f32 v5, v5
  v_exp_f32 v6, v6
  v_exp_f32 v7, v7
  v_exp_f32 v8, v8
  v_exp_f32 v9, v9
  v_mfma_f32_32x32x16_bf16 v[144:159], v[56:59], v[208:211], v[144:159]
  v_pk_add_f32 v[2:3], v[2:3], s[72:73]
  v_pk_add_f32 v[4:5], v[4:5], s[72:73]
  v_pk_add_f32 v[6:7], v[6:7], s[72:73]
  v_pk_add_f32 v[8:9], v[8:9], s[72:73]
  v_rcp_f32 v2, v2
  v_rcp_f32 v3, v3
  v_rcp_f32 v4, v4
  v_mfma_f32_32x32x16_bf16 v[144:159], v[60:63], v[212:215], v[144:159]
  v_rcp_f32 v5, v5
  v_rcp_f32 v6, v6
  v_rcp_f32 v7, v7
  v_rcp_f32 v8, v8
  v_rcp_f32 v9, v9
  v_pk_mul_f32 v[2:3], v[2:3], v[128:129]
  v_pk_mul_f32 v[4:5], v[4:5], v[130:131]
  v_mfma_f32_32x32x16_bf16 v[144:159], v[64:67], v[160:163], v[144:159]
  v_pk_mul_f32 v[6:7], v[6:7], v[132:133]
  v_pk_mul_f32 v[8:9], v[8:9], v[134:135]
  v_cvt_pk_bf16_f32 v176, v2, v3
  v_cvt_pk_bf16_f32 v177, v4, v5
  v_cvt_pk_bf16_f32 v178, v6, v7
  v_cvt_pk_bf16_f32 v179, v8, v9
  v_lshlrev_b32 v2, 16, v176
  v_mfma_f32_32x32x16_bf16 v[144:159], v[68:71], v[164:167], v[144:159]
  v_and_b32 v3, s65, v176
  v_lshlrev_b32 v4, 16, v200
  v_and_b32 v5, s65, v200
  v_pk_add_f32 v[2:3], v[2:3], v[4:5]
  v_cvt_pk_bf16_f32 v88, v2, v3
  v_lshlrev_b32 v6, 16, v177
  v_and_b32 v7, s65, v177
  v_mfma_f32_32x32x16_bf16 v[144:159], v[72:75], v[168:171], v[144:159]
  v_lshlrev_b32 v8, 16, v201
  v_and_b32 v9, s65, v201
  v_pk_add_f32 v[6:7], v[6:7], v[8:9]
  v_cvt_pk_bf16_f32 v89, v6, v7
  v_lshlrev_b32 v2, 16, v178
  v_and_b32 v3, s65, v178
  v_lshlrev_b32 v4, 16, v202
  v_mfma_f32_32x32x16_bf16 v[144:159], v[76:79], v[172:175], v[144:159]
  v_and_b32 v5, s65, v202
  v_pk_add_f32 v[2:3], v[2:3], v[4:5]
  v_cvt_pk_bf16_f32 v90, v2, v3
  v_lshlrev_b32 v6, 16, v179
  v_and_b32 v7, s65, v179
  v_lshlrev_b32 v8, 16, v203
  v_and_b32 v9, s65, v203
  v_pk_add_f32 v[6:7], v[6:7], v[8:9]
  v_cvt_pk_bf16_f32 v91, v6, v7
  ds_write_b128 v242, v[88:91] offset:0
  v_pk_mul_f32 v[2:3], v[136:137], s[70:71]
  v_pk_mul_f32 v[4:5], v[138:139], s[70:71]
  v_pk_mul_f32 v[6:7], v[140:141], s[70:71]
  v_pk_mul_f32 v[8:9], v[142:143], s[70:71]
  v_exp_f32 v2, v2
  v_exp_f32 v3, v3
  v_exp_f32 v4, v4
  v_exp_f32 v5, v5
  v_exp_f32 v6, v6
  v_exp_f32 v7, v7
  v_exp_f32 v8, v8
  v_exp_f32 v9, v9
  v_pk_add_f32 v[2:3], v[2:3], s[72:73]
  v_pk_add_f32 v[4:5], v[4:5], s[72:73]
  v_pk_add_f32 v[6:7], v[6:7], s[72:73]
  v_pk_add_f32 v[8:9], v[8:9], s[72:73]
  v_rcp_f32 v2, v2
  v_rcp_f32 v3, v3
  v_rcp_f32 v4, v4
  v_rcp_f32 v5, v5
  v_rcp_f32 v6, v6
  v_rcp_f32 v7, v7
  v_rcp_f32 v8, v8
  v_rcp_f32 v9, v9
  v_pk_mul_f32 v[2:3], v[2:3], v[136:137]
  v_pk_mul_f32 v[4:5], v[4:5], v[138:139]
  v_pk_mul_f32 v[6:7], v[6:7], v[140:141]
  v_pk_mul_f32 v[8:9], v[8:9], v[142:143]
  v_cvt_pk_bf16_f32 v176, v2, v3
  v_cvt_pk_bf16_f32 v177, v4, v5
  v_cvt_pk_bf16_f32 v178, v6, v7
  v_cvt_pk_bf16_f32 v179, v8, v9
  v_lshlrev_b32 v2, 16, v176
  v_and_b32 v3, s65, v176
  v_lshlrev_b32 v4, 16, v204
  v_and_b32 v5, s65, v204
  v_pk_add_f32 v[2:3], v[2:3], v[4:5]
  v_cvt_pk_bf16_f32 v92, v2, v3
  v_lshlrev_b32 v6, 16, v177
  v_and_b32 v7, s65, v177
  v_lshlrev_b32 v8, 16, v205
  v_and_b32 v9, s65, v205
  v_pk_add_f32 v[6:7], v[6:7], v[8:9]
  v_cvt_pk_bf16_f32 v93, v6, v7
  v_lshlrev_b32 v2, 16, v178
  v_and_b32 v3, s65, v178
  v_lshlrev_b32 v4, 16, v206
  v_and_b32 v5, s65, v206
  v_pk_add_f32 v[2:3], v[2:3], v[4:5]
  v_cvt_pk_bf16_f32 v94, v2, v3
  v_lshlrev_b32 v6, 16, v179
  v_and_b32 v7, s65, v179
  v_lshlrev_b32 v8, 16, v207
  v_and_b32 v9, s65, v207
  v_pk_add_f32 v[6:7], v[6:7], v[8:9]
  v_cvt_pk_bf16_f32 v95, v6, v7
  ds_write_b128 v242, v[92:95] offset:16
  v_pk_mul_f32 v[2:3], v[144:145], s[70:71]
  v_pk_mul_f32 v[4:5], v[146:147], s[70:71]
  v_pk_mul_f32 v[6:7], v[148:149], s[70:71]
  v_pk_mul_f32 v[8:9], v[150:151], s[70:71]
  v_exp_f32 v2, v2
  v_exp_f32 v3, v3
  v_exp_f32 v4, v4
  v_exp_f32 v5, v5
  v_exp_f32 v6, v6
  v_exp_f32 v7, v7
  v_exp_f32 v8, v8
  v_exp_f32 v9, v9
  v_pk_add_f32 v[2:3], v[2:3], s[72:73]
  v_pk_add_f32 v[4:5], v[4:5], s[72:73]
  v_pk_add_f32 v[6:7], v[6:7], s[72:73]
  v_pk_add_f32 v[8:9], v[8:9], s[72:73]
  v_rcp_f32 v2, v2
  v_rcp_f32 v3, v3
  v_rcp_f32 v4, v4
  v_rcp_f32 v5, v5
  v_rcp_f32 v6, v6
  v_rcp_f32 v7, v7
  v_rcp_f32 v8, v8
  v_rcp_f32 v9, v9
  v_pk_mul_f32 v[2:3], v[2:3], v[144:145]
  v_pk_mul_f32 v[4:5], v[4:5], v[146:147]
  v_pk_mul_f32 v[6:7], v[6:7], v[148:149]
  v_pk_mul_f32 v[8:9], v[8:9], v[150:151]
  v_cvt_pk_bf16_f32 v176, v2, v3
  v_cvt_pk_bf16_f32 v177, v4, v5
  v_cvt_pk_bf16_f32 v178, v6, v7
  v_cvt_pk_bf16_f32 v179, v8, v9
  v_lshlrev_b32 v2, 16, v176
  v_and_b32 v3, s65, v176
  v_lshlrev_b32 v4, 16, v208
  v_and_b32 v5, s65, v208
  v_pk_add_f32 v[2:3], v[2:3], v[4:5]
  v_cvt_pk_bf16_f32 v96, v2, v3
  v_lshlrev_b32 v6, 16, v177
  v_and_b32 v7, s65, v177
  v_lshlrev_b32 v8, 16, v209
  v_and_b32 v9, s65, v209
  v_pk_add_f32 v[6:7], v[6:7], v[8:9]
  v_cvt_pk_bf16_f32 v97, v6, v7
  v_lshlrev_b32 v2, 16, v178
  v_and_b32 v3, s65, v178
  v_lshlrev_b32 v4, 16, v210
  v_and_b32 v5, s65, v210
  v_pk_add_f32 v[2:3], v[2:3], v[4:5]
  v_cvt_pk_bf16_f32 v98, v2, v3
  v_lshlrev_b32 v6, 16, v179
  v_and_b32 v7, s65, v179
  v_lshlrev_b32 v8, 16, v211
  v_and_b32 v9, s65, v211
  v_pk_add_f32 v[6:7], v[6:7], v[8:9]
  v_cvt_pk_bf16_f32 v99, v6, v7
  ds_write_b128 v242, v[96:99] offset:32
  v_pk_mul_f32 v[2:3], v[152:153], s[70:71]
  v_pk_mul_f32 v[4:5], v[154:155], s[70:71]
  v_pk_mul_f32 v[6:7], v[156:157], s[70:71]
  v_pk_mul_f32 v[8:9], v[158:159], s[70:71]
  v_exp_f32 v2, v2
  v_exp_f32 v3, v3
  v_exp_f32 v4, v4
  v_exp_f32 v5, v5
  v_exp_f32 v6, v6
  v_exp_f32 v7, v7
  v_exp_f32 v8, v8
  v_exp_f32 v9, v9
  v_pk_add_f32 v[2:3], v[2:3], s[72:73]
  v_pk_add_f32 v[4:5], v[4:5], s[72:73]
  v_pk_add_f32 v[6:7], v[6:7], s[72:73]
  v_pk_add_f32 v[8:9], v[8:9], s[72:73]
  v_rcp_f32 v2, v2
  v_rcp_f32 v3, v3
  v_rcp_f32 v4, v4
  v_rcp_f32 v5, v5
  v_rcp_f32 v6, v6
  v_rcp_f32 v7, v7
  v_rcp_f32 v8, v8
  v_rcp_f32 v9, v9
  v_pk_mul_f32 v[2:3], v[2:3], v[152:153]
  v_pk_mul_f32 v[4:5], v[4:5], v[154:155]
  v_pk_mul_f32 v[6:7], v[6:7], v[156:157]
  v_pk_mul_f32 v[8:9], v[8:9], v[158:159]
  v_cvt_pk_bf16_f32 v176, v2, v3
  v_cvt_pk_bf16_f32 v177, v4, v5
  v_cvt_pk_bf16_f32 v178, v6, v7
  v_cvt_pk_bf16_f32 v179, v8, v9
  v_lshlrev_b32 v2, 16, v176
  v_and_b32 v3, s65, v176
  v_lshlrev_b32 v4, 16, v212
  v_and_b32 v5, s65, v212
  v_pk_add_f32 v[2:3], v[2:3], v[4:5]
  v_cvt_pk_bf16_f32 v100, v2, v3
  v_lshlrev_b32 v6, 16, v177
  v_and_b32 v7, s65, v177
  v_lshlrev_b32 v8, 16, v213
  v_and_b32 v9, s65, v213
  v_pk_add_f32 v[6:7], v[6:7], v[8:9]
  v_cvt_pk_bf16_f32 v101, v6, v7
  v_lshlrev_b32 v2, 16, v178
  v_and_b32 v3, s65, v178
  v_lshlrev_b32 v4, 16, v214
  v_and_b32 v5, s65, v214
  v_pk_add_f32 v[2:3], v[2:3], v[4:5]
  v_cvt_pk_bf16_f32 v102, v2, v3
  v_lshlrev_b32 v6, 16, v179
  v_and_b32 v7, s65, v179
  v_lshlrev_b32 v8, 16, v215
  v_and_b32 v9, s65, v215
  v_pk_add_f32 v[6:7], v[6:7], v[8:9]
  v_cvt_pk_bf16_f32 v103, v6, v7
  ds_write_b128 v242, v[100:103] offset:48
  ds_read_b128 v[128:131], v248 offset:0
  ds_read_b128 v[132:135], v248 offset:1152
  ds_read_b128 v[136:139], v248 offset:2304
  ds_read_b128 v[140:143], v248 offset:3456
  s_waitcnt lgkmcnt(3)
  buffer_store_dwordx4 v[128:131], v231, s[28:31], 0 offen offset:0 sc1
  s_waitcnt lgkmcnt(2)
  buffer_store_dwordx4 v[132:135], v231, s[28:31], 0 offen offset:1024 sc1
  s_waitcnt lgkmcnt(1)
  buffer_store_dwordx4 v[136:139], v231, s[28:31], 0 offen offset:2048 sc1
  s_waitcnt lgkmcnt(0)
  s_cmp_eq_u32 s68, 0
  s_cbranch_scc1 NO25
  s_mov_b64 exec, s[68:69]
  buffer_store_dwordx4 v[140:143], v231, s[28:31], 0 offen offset:3072 sc1
  s_mov_b64 exec, -1
NO25:
K2END:
  s_endpgm
.section .rodata,"a"
.p2align 6
.amdhsa_kernel part_kernel
  .amdhsa_next_free_vgpr 80
  .amdhsa_next_free_sgpr 102
  .amdhsa_accum_offset 80
  .amdhsa_group_segment_fixed_size 0
  .amdhsa_kernarg_size 88
  .amdhsa_user_sgpr_count 2
  .amdhsa_user_sgpr_kernarg_segment_ptr 1
  .amdhsa_system_sgpr_workgroup_id_x 1
.end_amdhsa_kernel
.p2align 6
.amdhsa_kernel main_kernel
  .amdhsa_next_free_vgpr 256
  .amdhsa_next_free_sgpr 102
  .amdhsa_accum_offset 256
  .amdhsa_group_segment_fixed_size 0
  .amdhsa_kernarg_size 88
  .amdhsa_user_sgpr_count 2
  .amdhsa_user_sgpr_kernarg_segment_ptr 1
  .amdhsa_system_sgpr_workgroup_id_x 1
.end_amdhsa_kernel
```

```asm
; @launch kernel=part_kernel grid=(251,1,1) block=(640,1,1) lds=93312
; @launch kernel=main_kernel grid=(256,1,1) block=(512,1,1) lds=163328
.amdgcn_target "amdgcn-amd-amdhsa--gfx950"
.text
.globl part_kernel
.p2align 8
.type part_kernel,@function
part_kernel:
  s_cmp_gt_u32 s2, 250
  s_cbranch_scc1 K1END
  s_load_dwordx2 s[8:9], s[0:1], 80
  s_sub_u32 s2, s2, 1
  s_cbranch_scc1 WPREP
  s_load_dwordx4 s[4:7], s[0:1], 24
  s_load_dwordx2 s[32:33], s[0:1], 16
  s_mul_i32 s3, s2, 12800
  v_lshlrev_b32 v2, 4, v0
  v_lshlrev_b32 v3, 2, v0
  v_add_u32 v3, 10240, v3
  v_and_b32 v1, 255, v0
  v_lshlrev_b32 v1, 2, v1
  v_mov_b32 v20, 0
  v_mov_b32 v21, 0
  v_mov_b32 v22, 0
  v_mov_b32 v23, 0
  s_waitcnt lgkmcnt(0)
  s_mov_b32 s12, s4
  s_mov_b32 s13, s5
  s_mov_b32 s14, 3200000
  s_mov_b32 s15, 0x20000
  s_mov_b32 s16, s6
  s_mov_b32 s17, s7
  s_mov_b32 s18, 3200000
  s_mov_b32 s19, 0x20000
  buffer_load_dwordx4 v[4:7], v2, s[16:19], s3 offen
  buffer_load_dword v8, v3, s[16:19], s3 offen
  buffer_load_dwordx4 v[12:15], v2, s[12:15], s3 offen
  buffer_load_dword v16, v3, s[12:15], s3 offen
  ds_write_b32 v1, v20 offset:58368
  ds_write_b32 v20, v20 offset:60416
  ds_write_b128 v2, v[20:23] offset:0
  ds_write_b128 v2, v[20:23] offset:10240
  ds_write_b128 v2, v[20:23] offset:20480
  ds_write_b128 v2, v[20:23] offset:30720
  s_mov_b32 s20, s8
  s_mov_b32 s21, s9
  s_mov_b32 s22, 8388608
  s_mov_b32 s23, 0x20000
  s_add_u32 s24, s8, 8388488
  s_addc_u32 s25, s9, 0
  s_mov_b32 s26, 14592120
  s_mov_b32 s27, 0x20000
  s_mov_b32 s28, 175921861
  s_movk_i32 s29, 3125
  s_mul_i32 s30, s2, 3200
  s_or_b32 s30, s30, 0x80000000
  v_mov_b32 v50, 1
  v_mov_b32 v49, 127
  v_lshl_add_u32 v51, v0, 2, s30
  s_add_u32 s30, s30, 2560
  v_add_u32 v52, s30, v0
  v_readfirstlane_b32 s31, v0
  v_lshrrev_b32 v55, 3, v0
  v_lshlrev_b32 v55, 2, v55
  v_add_u32 v55, 58368, v55
  v_add_u32 v60, 60544, v2
  v_and_b32 v61, 0, v0
  v_lshl_add_u32 v61, v61, 1, 15
  s_waitcnt lgkmcnt(0)
  s_barrier
  s_waitcnt vmcnt(2)
  v_mul_hi_u32 v37, s28, v4
  v_lshrrev_b32 v20, 1, v37
  v_and_b32 v20, 0x3fc, v20
  ds_add_rtn_u32 v28, v20, v50 offset:58368
  v_mul_hi_u32 v39, s28, v5
  v_lshrrev_b32 v21, 1, v39
  v_and_b32 v21, 0x3fc, v21
  ds_add_rtn_u32 v29, v21, v50 offset:58368
  v_mul_hi_u32 v41, s28, v6
  v_lshrrev_b32 v22, 1, v41
  v_and_b32 v22, 0x3fc, v22
  ds_add_rtn_u32 v30, v22, v50 offset:58368
  v_mul_hi_u32 v43, s28, v7
  v_lshrrev_b32 v23, 1, v43
  v_and_b32 v23, 0x3fc, v23
  ds_add_rtn_u32 v31, v23, v50 offset:58368
  v_mul_hi_u32 v45, s28, v8
  v_lshrrev_b32 v24, 1, v45
  v_and_b32 v24, 0x3fc, v24
  ds_add_rtn_u32 v32, v24, v50 offset:58368
  v_mad_u32_u24 v36, v37, s29, v49
  v_lshrrev_b32 v36, 7, v36
  v_sub_u32 v4, v4, v36
  v_and_b32 v37, 7, v37
  v_mad_u32_u24 v38, v39, s29, v49
  v_lshrrev_b32 v38, 7, v38
  v_sub_u32 v5, v5, v38
  v_and_b32 v39, 7, v39
  v_mad_u32_u24 v40, v41, s29, v49
  v_lshrrev_b32 v40, 7, v40
  v_sub_u32 v6, v6, v40
  v_and_b32 v41, 7, v41
  v_mad_u32_u24 v42, v43, s29, v49
  v_lshrrev_b32 v42, 7, v42
  v_sub_u32 v7, v7, v42
  v_and_b32 v43, 7, v43
  v_mad_u32_u24 v44, v45, s29, v49
  v_lshrrev_b32 v44, 7, v44
  v_sub_u32 v8, v8, v44
  v_and_b32 v45, 7, v45
  s_waitcnt vmcnt(0)
  v_lshl_or_b32 v36, v4, 27, v12
  v_lshrrev_b32 v12, 12, v12
  v_lshl_or_b32 v37, v37, 4, v12
  v_lshl_or_b32 v37, v37, 24, v51
  v_lshl_or_b32 v38, v5, 27, v13
  v_lshrrev_b32 v13, 12, v13
  v_lshl_or_b32 v39, v39, 4, v13
  v_add_u32 v51, 1, v51
  v_lshl_or_b32 v39, v39, 24, v51
  v_lshl_or_b32 v40, v6, 27, v14
  v_lshrrev_b32 v14, 12, v14
  v_lshl_or_b32 v41, v41, 4, v14
  v_add_u32 v51, 1, v51
  v_lshl_or_b32 v41, v41, 24, v51
  v_lshl_or_b32 v42, v7, 27, v15
  v_lshrrev_b32 v15, 12, v15
  v_lshl_or_b32 v43, v43, 4, v15
  v_add_u32 v51, 1, v51
  v_lshl_or_b32 v43, v43, 24, v51
  v_lshl_or_b32 v44, v8, 27, v16
  v_lshrrev_b32 v16, 12, v16
  v_lshl_or_b32 v45, v45, 4, v16
  v_lshl_or_b32 v45, v45, 24, v52
  v_lshrrev_b32 v3, 3, v0
  s_movk_i32 s3, 128
  v_mul_u32_u24 v3, s3, v3
  v_and_b32 v1, 7, v0
  v_lshl_add_u32 v3, v1, 4, v3
  s_mul_i32 s3, s2, 32896
  s_add_u32 s4, s3, 10240
  s_add_u32 s5, s3, 20480
  s_add_u32 s6, s3, 30720
  s_mul_i32 s7, s2, 58368
  s_mov_b32 s33, 0
  s_mov_b32 s34, 0xfff20000
  v_mov_b32 v1, 60416
  v_lshlrev_b32 v4, 5, v20
  v_lshlrev_b32 v5, 5, v21
  v_lshlrev_b32 v6, 5, v22
  v_lshlrev_b32 v7, 5, v23
  v_lshlrev_b32 v8, 5, v24
  s_waitcnt lgkmcnt(4)
  v_cmp_gt_u32 s[40:41], 15, v28
  v_lshl_add_u32 v12, v28, 3, v4
  s_waitcnt lgkmcnt(3)
  v_cmp_gt_u32 s[42:43], 15, v29
  v_lshl_add_u32 v13, v29, 3, v5
  s_waitcnt lgkmcnt(2)
  v_cmp_gt_u32 s[44:45], 15, v30
  v_lshl_add_u32 v14, v30, 3, v6
  s_waitcnt lgkmcnt(1)
  v_cmp_gt_u32 s[46:47], 15, v31
  v_lshl_add_u32 v15, v31, 3, v7
  s_waitcnt lgkmcnt(0)
  v_cmp_gt_u32 s[48:49], 15, v32
  v_lshl_add_u32 v16, v32, 3, v8
  v_max3_u32 v48, v28, v29, v30
  v_max3_u32 v48, v48, v31, v32
  v_cmp_le_u32 s[50:51], 31, v48
  s_mov_b64 exec, s[40:41]
  ds_write_b64 v12, v[36:37]
  s_mov_b64 exec, s[42:43]
  ds_write_b64 v13, v[38:39]
  s_mov_b64 exec, s[44:45]
  ds_write_b64 v14, v[40:41]
  s_mov_b64 exec, s[46:47]
  ds_write_b64 v15, v[42:43]
  s_mov_b64 exec, s[48:49]
  ds_write_b64 v16, v[44:45]
  s_not_b64 exec, s[40:41]
  s_cbranch_scc0 K1N0
  v_lshl_add_u32 v48, v20, 2, s34
  v_lshl_add_u32 v48, v28, 16, v48
  ds_max_u32 v4, v48 offset:120
  v_cmpx_gt_u32 vcc, 31, v28
  ds_write_b64 v12, v[36:37] offset:60424
K1N0:
  s_not_b64 exec, s[42:43]
  s_cbranch_scc0 K1N1
  v_lshl_add_u32 v48, v21, 2, s34
  v_lshl_add_u32 v48, v29, 16, v48
  ds_max_u32 v5, v48 offset:120
  v_cmpx_gt_u32 vcc, 31, v29
  ds_write_b64 v13, v[38:39] offset:60424
K1N1:
  s_not_b64 exec, s[44:45]
  s_cbranch_scc0 K1N2
  v_lshl_add_u32 v48, v22, 2, s34
  v_lshl_add_u32 v48, v30, 16, v48
  ds_max_u32 v6, v48 offset:120
  v_cmpx_gt_u32 vcc, 31, v30
  ds_write_b64 v14, v[40:41] offset:60424
K1N2:
  s_not_b64 exec, s[46:47]
  s_cbranch_scc0 K1N3
  v_lshl_add_u32 v48, v23, 2, s34
  v_lshl_add_u32 v48, v31, 16, v48
  ds_max_u32 v7, v48 offset:120
  v_cmpx_gt_u32 vcc, 31, v31
  ds_write_b64 v15, v[42:43] offset:60424
K1N3:
  s_not_b64 exec, s[48:49]
  s_cbranch_scc0 K1N4
  v_lshl_add_u32 v48, v24, 2, s34
  v_lshl_add_u32 v48, v32, 16, v48
  ds_max_u32 v8, v48 offset:120
  v_cmpx_gt_u32 vcc, 31, v32
  ds_write_b64 v16, v[44:45] offset:60424
K1N4:
  s_mov_b64 exec, s[50:51]
  ds_write_b32 v1, v50
  s_mov_b64 exec, -1
  s_waitcnt lgkmcnt(0)
  s_barrier
  ds_read_b32 v48, v1
  ds_read2_b32 v[56:57], v55 offset0:0 offset1:80
  ds_read2_b32 v[58:59], v55 offset0:160 offset1:240
K1RD:
  ds_read_b128 v[4:7], v2
  ds_read_b128 v[8:11], v2 offset:10240
  ds_read_b128 v[12:15], v2 offset:20480
  ds_read_b128 v[16:19], v2 offset:30720
  s_waitcnt lgkmcnt(3)
  v_cmp_ne_u32 vcc, 0, v48
  s_cbranch_vccnz K1SLOW
  v_cmp_lt_u32 s[40:41], v61, v56
  v_cmp_lt_u32 s[42:43], v61, v57
  v_cmp_lt_u32 s[44:45], v61, v58
  s_mov_b64 exec, s[40:41]
  ds_read_b128 v[64:67], v60
  s_mov_b64 exec, s[42:43]
  ds_read_b128 v[68:71], v60 offset:10240
  s_mov_b64 exec, s[44:45]
  ds_read_b128 v[72:75], v60 offset:20480
  s_mov_b64 exec, -1
  buffer_store_dwordx4 v[4:7], v3, s[20:23], s3 offen sc1
  s_waitcnt lgkmcnt(5)
  buffer_store_dwordx4 v[8:11], v3, s[20:23], s4 offen sc1
  s_waitcnt lgkmcnt(4)
  buffer_store_dwordx4 v[12:15], v3, s[20:23], s5 offen sc1
  s_add_u32 s4, s7, 10240
  s_add_u32 s5, s7, 20480
  s_mov_b64 exec, s[40:41]
  s_waitcnt lgkmcnt(2)
  buffer_store_dwordx4 v[64:67], v2, s[24:27], s7 offen offset:120 sc1
  s_mov_b64 exec, s[42:43]
  s_waitcnt lgkmcnt(1)
  buffer_store_dwordx4 v[68:71], v2, s[24:27], s4 offen offset:120 sc1
  s_mov_b64 exec, s[44:45]
  s_waitcnt lgkmcnt(0)
  buffer_store_dwordx4 v[72:75], v2, s[24:27], s5 offen offset:120 sc1
  s_mov_b64 exec, -1
  s_add_u32 s5, s7, 30720
  s_add_u32 s7, s7, 32888
  s_cmp_ge_u32 s31, 128
  s_cbranch_scc1 K1OV
  ds_read_b128 v[76:79], v60 offset:30720
  buffer_store_dwordx4 v[16:19], v3, s[20:23], s6 offen sc1
  v_cmpx_lt_u32 vcc, v61, v59
  s_waitcnt lgkmcnt(0)
  buffer_store_dwordx4 v[76:79], v2, s[24:27], s5 offen offset:120 sc1
  s_mov_b64 exec, -1
K1OV:
  v_cmpx_gt_u32 vcc, s33, v2
  s_cbranch_execz K1FIN
  ds_read_b128 v[20:23], v2 offset:32768
  s_waitcnt lgkmcnt(0)
  buffer_store_dwordx4 v[20:23], v2, s[24:27], s7 offen sc1
  v_add_u32 v2, 10240, v2
  s_waitcnt vmcnt(0)
  s_branch K1OV
K1FIN:
K1END:
  s_endpgm
K1SLOW:
  v_and_b32 v1, 63, v0
  v_lshlrev_b32 v53, 9, v1
  v_lshlrev_b32 v1, 4, v1
  v_mov_b32 v48, 0xffff0000
  v_mov_b32 v49, 0xf0ff1
  s_waitcnt lgkmcnt(0)
  ds_read_b128 v[4:7], v1 offset:58368
  s_waitcnt lgkmcnt(0)
  v_cmp_lt_u32 s[40:41], 31, v4
  v_subrev_u32 v4, 15, v4
  v_cmp_lt_u32 s[42:43], 31, v5
  v_subrev_u32 v5, 15, v5
  v_cmp_lt_u32 s[44:45], 31, v6
  v_subrev_u32 v6, 15, v6
  v_cmp_lt_u32 s[46:47], 31, v7
  v_subrev_u32 v7, 15, v7
  v_cndmask_b32 v4, 0, v4, s[40:41]
  v_cndmask_b32 v5, 0, v5, s[42:43]
  v_cndmask_b32 v6, 0, v6, s[44:45]
  v_cndmask_b32 v7, 0, v7, s[46:47]
  v_add_u32 v8, v4, v5
  v_add_u32 v9, v8, v6
  v_add_u32 v10, v9, v7
  v_mov_b32 v11, v10
  s_nop 1
  v_add_u32_dpp v11, v11, v11 row_shr:1 row_mask:0xf bank_mask:0xf
  s_nop 1
  v_add_u32_dpp v11, v11, v11 row_shr:2 row_mask:0xf bank_mask:0xf
  s_nop 1
  v_add_u32_dpp v11, v11, v11 row_shr:4 row_mask:0xf bank_mask:0xf
  s_nop 1
  v_add_u32_dpp v11, v11, v11 row_shr:8 row_mask:0xf bank_mask:0xf
  s_nop 1
  v_add_u32_dpp v11, v11, v11 row_bcast:15 row_mask:0xa bank_mask:0xf
  s_nop 1
  v_add_u32_dpp v11, v11, v11 row_bcast:31 row_mask:0xc bank_mask:0xf
  v_cndmask_b32 v16, v48, v49, s[40:41]
  v_cndmask_b32 v17, v48, v49, s[42:43]
  v_cndmask_b32 v18, v48, v49, s[44:45]
  v_cndmask_b32 v19, v48, v49, s[46:47]
  v_sub_u32 v12, v11, v10
  v_add_u32 v13, v12, v4
  v_add_u32 v14, v12, v8
  v_add_u32 v15, v12, v9
  v_readlane_b32 s33, v11, 63
  v_add_u32 v16, v16, v12
  v_add_u32 v17, v17, v13
  v_add_u32 v18, v18, v14
  v_add_u32 v19, v19, v15
  ds_write_b128 v1, v[16:19] offset:59392
  ds_read_b32 v20, v20 offset:59392
  ds_read_b32 v21, v21 offset:59392
  ds_read_b32 v22, v22 offset:59392
  ds_read_b32 v23, v23 offset:59392
  ds_read_b32 v24, v24 offset:59392
  v_lshl_or_b32 v4, v4, 16, v12
  v_add_u32 v4, 4096, v4
  s_mov_b64 exec, s[40:41]
  ds_write_b32 v53, v4 offset:120
  s_mov_b64 exec, -1
  v_lshl_or_b32 v5, v5, 16, v13
  v_add_u32 v5, 4096, v5
  s_mov_b64 exec, s[42:43]
  ds_write_b32 v53, v5 offset:248
  s_mov_b64 exec, -1
  v_lshl_or_b32 v6, v6, 16, v14
  v_add_u32 v6, 4096, v6
  s_mov_b64 exec, s[44:45]
  ds_write_b32 v53, v6 offset:376
  s_mov_b64 exec, -1
  v_lshl_or_b32 v7, v7, 16, v15
  v_add_u32 v7, 4096, v7
  s_mov_b64 exec, s[46:47]
  ds_write_b32 v53, v7 offset:504
  s_mov_b64 exec, -1
  s_waitcnt lgkmcnt(0)
  v_cmp_ge_u32_sdwa vcc, v28, v20 src0_sel:DWORD src1_sel:WORD_1
  v_and_b32 v20, 0xffff, v20
  v_add_lshl_u32 v20, v20, v28, 3
  s_mov_b64 exec, vcc
  ds_write_b64 v20, v[36:37]
  s_mov_b64 exec, -1
  v_cmp_ge_u32_sdwa vcc, v29, v21 src0_sel:DWORD src1_sel:WORD_1
  v_and_b32 v21, 0xffff, v21
  v_add_lshl_u32 v21, v21, v29, 3
  s_mov_b64 exec, vcc
  ds_write_b64 v21, v[38:39]
  s_mov_b64 exec, -1
  v_cmp_ge_u32_sdwa vcc, v30, v22 src0_sel:DWORD src1_sel:WORD_1
  v_and_b32 v22, 0xffff, v22
  v_add_lshl_u32 v22, v22, v30, 3
  s_mov_b64 exec, vcc
  ds_write_b64 v22, v[40:41]
  s_mov_b64 exec, -1
  v_cmp_ge_u32_sdwa vcc, v31, v23 src0_sel:DWORD src1_sel:WORD_1
  v_and_b32 v23, 0xffff, v23
  v_add_lshl_u32 v23, v23, v31, 3
  s_mov_b64 exec, vcc
  ds_write_b64 v23, v[42:43]
  s_mov_b64 exec, -1
  v_cmp_ge_u32_sdwa vcc, v32, v24 src0_sel:DWORD src1_sel:WORD_1
  v_and_b32 v24, 0xffff, v24
  v_add_lshl_u32 v24, v24, v32, 3
  s_mov_b64 exec, vcc
  ds_write_b64 v24, v[44:45]
  s_mov_b64 exec, -1
  s_lshl_b32 s33, s33, 3
  v_mov_b32 v48, 0
  s_waitcnt lgkmcnt(0)
  s_barrier
  s_branch K1RD
WPREP:
  s_load_dwordx4 s[4:7], s[0:1], 40
  v_lshrrev_b32 v2, 6, v0
  v_and_b32 v1, 63, v0
  v_readfirstlane_b32 s31, v2
  s_mov_b32 s28, 0xbfb8aa3b
  s_mov_b32 s29, 0xbfb8aa3b
  s_mov_b32 s30, 0xffff0000
  s_waitcnt lgkmcnt(0)
  s_mov_b32 s12, s4
  s_mov_b32 s13, s5
  s_mov_b32 s14, 18560
  s_mov_b32 s15, 0x20000
  s_mov_b32 s16, s6
  s_mov_b32 s17, s7
  s_mov_b32 s18, 128
  s_mov_b32 s19, 0x20000
  s_add_u32 s20, s8, 23068672
  s_addc_u32 s21, s9, 0
  s_mov_b32 s22, 24576
  s_mov_b32 s23, 0x20000
  v_and_b32 v2, 7, v1
  v_bfe_u32 v3, v1, 4, 1
  v_lshlrev_b32 v4, 2, v3
  v_xor_b32 v4, v4, v2
  v_lshlrev_b32 v4, 4, v4
  v_lshrrev_b32 v5, 3, v1
  v_lshl_or_b32 v4, v5, 7, v4
  s_lshl_b32 s3, s31, 10
  s_add_u32 s4, s3, 10240
  v_add_u32 v4, s3, v4
  s_mov_b32 m0, s3
  s_nop 0
  buffer_load_dwordx4 v4, s[12:15], 0 offen lds
  v_add_u32 v4, 10240, v4
  s_mov_b32 m0, s4
  s_nop 0
  buffer_load_dwordx4 v4, s[12:15], 0 offen lds
  v_lshrrev_b32 v5, 5, v1
  v_lshlrev_b32 v7, 3, v5
  buffer_load_dwordx2 v[28:29], v7, s[16:19], 0 offen offset:0
  buffer_load_dwordx2 v[30:31], v7, s[16:19], 0 offen offset:16
  buffer_load_dwordx2 v[32:33], v7, s[16:19], 0 offen offset:32
  buffer_load_dwordx2 v[34:35], v7, s[16:19], 0 offen offset:48
  buffer_load_dwordx2 v[36:37], v7, s[16:19], 0 offen offset:64
  buffer_load_dwordx2 v[38:39], v7, s[16:19], 0 offen offset:80
  buffer_load_dwordx2 v[40:41], v7, s[16:19], 0 offen offset:96
  buffer_load_dwordx2 v[42:43], v7, s[16:19], 0 offen offset:112
  v_and_b32 v2, 3, v1
  v_bfe_u32 v4, v1, 2, 2
  v_lshlrev_b32 v2, 3, v2
  v_lshl_add_u32 v2, v3, 5, v2
  v_lshl_add_u32 v2, v4, 7, v2
  v_lshl_add_u32 v6, v5, 12, v2
  v_lshrrev_b32 v3, 1, v4
  v_lshl_add_u32 v6, v3, 6, v6
  v_lshl_add_u32 v8, v5, 10, v2
  v_add_u32 v3, 1, v4
  v_bfe_u32 v3, v3, 1, 1
  v_lshl_add_u32 v8, v3, 6, v8
  v_xor_b32 v9, 64, v8
  s_and_b32 s3, s31, 1
  s_lshl_b32 s3, s3, 6
  v_xor_b32 v6, s3, v6
  s_lshr_b32 s3, s31, 1
  s_lshl_b32 s3, s3, 13
  v_add_u32 v6, s3, v6
  v_lshlrev_b32 v10, 4, v1
  s_lshl_b32 s3, s31, 12
  s_mov_b64 exec, 0
WPGO:
  s_cmp_eq_u32 s31, 4
  s_cbranch_scc1 WP4
  s_cmp_eq_u32 s31, 5
  s_cbranch_scc1 WP5
  s_cmp_gt_u32 s31, 5
  s_cbranch_scc1 WPEND
  ds_read_b64_tr_b16 v[12:13], v6 offset:0
  ds_read_b64_tr_b16 v[14:15], v6 offset:512
  ds_read_b64_tr_b16 v[16:17], v6 offset:1024
  ds_read_b64_tr_b16 v[18:19], v6 offset:1536
  ds_read_b64_tr_b16 v[20:21], v6 offset:2048
  ds_read_b64_tr_b16 v[22:23], v6 offset:2560
  ds_read_b64_tr_b16 v[24:25], v6 offset:3072
  ds_read_b64_tr_b16 v[26:27], v6 offset:3584
  s_waitcnt lgkmcnt(0)
  s_cmp_lt_u32 s31, 2
  s_cbranch_scc1 WPST
  v_lshlrev_b32 v2, 16, v12
  v_and_b32 v3, s30, v12
  v_pk_mul_f32 v[2:3], v[2:3], s[28:29]
  v_cvt_pk_bf16_f32 v12, v2, v3
  v_lshlrev_b32 v2, 16, v13
  v_and_b32 v3, s30, v13
  v_pk_mul_f32 v[2:3], v[2:3], s[28:29]
  v_cvt_pk_bf16_f32 v13, v2, v3
  v_lshlrev_b32 v2, 16, v14
  v_and_b32 v3, s30, v14
  v_pk_mul_f32 v[2:3], v[2:3], s[28:29]
  v_cvt_pk_bf16_f32 v14, v2, v3
  v_lshlrev_b32 v2, 16, v15
  v_and_b32 v3, s30, v15
  v_pk_mul_f32 v[2:3], v[2:3], s[28:29]
  v_cvt_pk_bf16_f32 v15, v2, v3
  v_lshlrev_b32 v2, 16, v16
  v_and_b32 v3, s30, v16
  v_pk_mul_f32 v[2:3], v[2:3], s[28:29]
  v_cvt_pk_bf16_f32 v16, v2, v3
  v_lshlrev_b32 v2, 16, v17
  v_and_b32 v3, s30, v17
  v_pk_mul_f32 v[2:3], v[2:3], s[28:29]
  v_cvt_pk_bf16_f32 v17, v2, v3
  v_lshlrev_b32 v2, 16, v18
  v_and_b32 v3, s30, v18
  v_pk_mul_f32 v[2:3], v[2:3], s[28:29]
  v_cvt_pk_bf16_f32 v18, v2, v3
  v_lshlrev_b32 v2, 16, v19
  v_and_b32 v3, s30, v19
  v_pk_mul_f32 v[2:3], v[2:3], s[28:29]
  v_cvt_pk_bf16_f32 v19, v2, v3
  v_lshlrev_b32 v2, 16, v20
  v_and_b32 v3, s30, v20
  v_pk_mul_f32 v[2:3], v[2:3], s[28:29]
  v_cvt_pk_bf16_f32 v20, v2, v3
  v_lshlrev_b32 v2, 16, v21
  v_and_b32 v3, s30, v21
  v_pk_mul_f32 v[2:3], v[2:3], s[28:29]
  v_cvt_pk_bf16_f32 v21, v2, v3
  v_lshlrev_b32 v2, 16, v22
  v_and_b32 v3, s30, v22
  v_pk_mul_f32 v[2:3], v[2:3], s[28:29]
  v_cvt_pk_bf16_f32 v22, v2, v3
  v_lshlrev_b32 v2, 16, v23
  v_and_b32 v3, s30, v23
  v_pk_mul_f32 v[2:3], v[2:3], s[28:29]
  v_cvt_pk_bf16_f32 v23, v2, v3
  v_lshlrev_b32 v2, 16, v24
  v_and_b32 v3, s30, v24
  v_pk_mul_f32 v[2:3], v[2:3], s[28:29]
  v_cvt_pk_bf16_f32 v24, v2, v3
  v_lshlrev_b32 v2, 16, v25
  v_and_b32 v3, s30, v25
  v_pk_mul_f32 v[2:3], v[2:3], s[28:29]
  v_cvt_pk_bf16_f32 v25, v2, v3
  v_lshlrev_b32 v2, 16, v26
  v_and_b32 v3, s30, v26
  v_pk_mul_f32 v[2:3], v[2:3], s[28:29]
  v_cvt_pk_bf16_f32 v26, v2, v3
  v_lshlrev_b32 v2, 16, v27
  v_and_b32 v3, s30, v27
  v_pk_mul_f32 v[2:3], v[2:3], s[28:29]
  v_cvt_pk_bf16_f32 v27, v2, v3
WPST:
  buffer_store_dwordx4 v[12:15], v10, s[20:23], s3 offen offset:0
  buffer_store_dwordx4 v[16:19], v10, s[20:23], s3 offen offset:1024
  buffer_store_dwordx4 v[20:23], v10, s[20:23], s3 offen offset:2048
  buffer_store_dwordx4 v[24:27], v10, s[20:23], s3 offen offset:3072
  s_branch WPEND
WP4:
  ds_read_b64_tr_b16 v[12:13], v8 offset:16512
  ds_read_b64_tr_b16 v[14:15], v8 offset:17024
  ds_read_b64_tr_b16 v[16:17], v9 offset:16512
  ds_read_b64_tr_b16 v[18:19], v9 offset:17024
  v_and_b32 v2, 31, v1
  v_lshlrev_b32 v2, 1, v2
  ds_read_u16 v20, v2 offset:16384
  ds_read_u16 v21, v2 offset:16448
  v_subrev_u32 v5, 1, v5
  s_waitcnt lgkmcnt(0)
  v_lshlrev_b32 v2, 16, v12
  v_and_b32 v3, s30, v12
  v_pk_mul_f32 v[2:3], v[2:3], s[28:29]
  v_cvt_pk_bf16_f32 v12, v2, v3
  v_lshlrev_b32 v2, 16, v13
  v_and_b32 v3, s30, v13
  v_pk_mul_f32 v[2:3], v[2:3], s[28:29]
  v_cvt_pk_bf16_f32 v13, v2, v3
  v_lshlrev_b32 v2, 16, v14
  v_and_b32 v3, s30, v14
  v_pk_mul_f32 v[2:3], v[2:3], s[28:29]
  v_cvt_pk_bf16_f32 v14, v2, v3
  v_lshlrev_b32 v2, 16, v15
  v_and_b32 v3, s30, v15
  v_pk_mul_f32 v[2:3], v[2:3], s[28:29]
  v_cvt_pk_bf16_f32 v15, v2, v3
  v_lshlrev_b32 v2, 16, v16
  v_and_b32 v3, s30, v16
  v_pk_mul_f32 v[2:3], v[2:3], s[28:29]
  v_cvt_pk_bf16_f32 v16, v2, v3
  v_lshlrev_b32 v2, 16, v17
  v_and_b32 v3, s30, v17
  v_pk_mul_f32 v[2:3], v[2:3], s[28:29]
  v_cvt_pk_bf16_f32 v17, v2, v3
  v_lshlrev_b32 v2, 16, v18
  v_and_b32 v3, s30, v18
  v_pk_mul_f32 v[2:3], v[2:3], s[28:29]
  v_cvt_pk_bf16_f32 v18, v2, v3
  v_lshlrev_b32 v2, 16, v19
  v_and_b32 v3, s30, v19
  v_pk_mul_f32 v[2:3], v[2:3], s[28:29]
  v_cvt_pk_bf16_f32 v19, v2, v3
  v_lshlrev_b32 v20, 16, v20
  v_mul_f32 v20, s28, v20
  v_cvt_pk_f16_f32 v20, v20, 0
  v_and_b32 v20, v5, v20
  v_mov_b32 v22, 0
  v_lshlrev_b32 v21, 16, v21
  v_mul_f32 v21, s28, v21
  v_cvt_pk_f16_f32 v21, v21, 0
  v_and_b32 v21, v5, v21
  v_mov_b32 v23, 0
  buffer_store_dwordx4 v[12:15], v10, s[20:23], s3 offen offset:0
  buffer_store_dwordx4 v[16:19], v10, s[20:23], s3 offen offset:1024
  buffer_store_dwordx4 v[20:23], v10, s[20:23], s3 offen offset:2048
  buffer_store_dwordx4 v[20:23], v10, s[20:23], s3 offen offset:3072
  s_branch WPEND
WP5:
  v_lshrrev_b32 v4, 2, v1
  v_lshrrev_b32 v8, 4, v1
  v_xor_b32 v4, v4, v8
  v_and_b32 v4, 1, v4
  v_subrev_u32 v4, 1, v4
  v_lshlrev_b32 v2, 16, v28
  v_and_b32 v3, s30, v28
  v_cvt_pk_f16_f32 v2, v2, v3
  v_and_b32 v12, v4, v2
  v_lshlrev_b32 v2, 16, v29
  v_and_b32 v3, s30, v29
  v_cvt_pk_f16_f32 v2, v2, v3
  v_and_b32 v13, v4, v2
  v_lshlrev_b32 v2, 16, v30
  v_and_b32 v3, s30, v30
  v_cvt_pk_f16_f32 v2, v2, v3
  v_and_b32 v14, v4, v2
  v_lshlrev_b32 v2, 16, v31
  v_and_b32 v3, s30, v31
  v_cvt_pk_f16_f32 v2, v2, v3
  v_and_b32 v15, v4, v2
  v_lshlrev_b32 v2, 16, v32
  v_and_b32 v3, s30, v32
  v_cvt_pk_f16_f32 v2, v2, v3
  v_and_b32 v16, v4, v2
  v_lshlrev_b32 v2, 16, v33
  v_and_b32 v3, s30, v33
  v_cvt_pk_f16_f32 v2, v2, v3
  v_and_b32 v17, v4, v2
  v_lshlrev_b32 v2, 16, v34
  v_and_b32 v3, s30, v34
  v_cvt_pk_f16_f32 v2, v2, v3
  v_and_b32 v18, v4, v2
  v_lshlrev_b32 v2, 16, v35
  v_and_b32 v3, s30, v35
  v_cvt_pk_f16_f32 v2, v2, v3
  v_and_b32 v19, v4, v2
  v_lshlrev_b32 v2, 16, v36
  v_and_b32 v3, s30, v36
  v_cvt_pk_f16_f32 v2, v2, v3
  v_and_b32 v20, v4, v2
  v_lshlrev_b32 v2, 16, v37
  v_and_b32 v3, s30, v37
  v_cvt_pk_f16_f32 v2, v2, v3
  v_and_b32 v21, v4, v2
  v_lshlrev_b32 v2, 16, v38
  v_and_b32 v3, s30, v38
  v_cvt_pk_f16_f32 v2, v2, v3
  v_and_b32 v22, v4, v2
  v_lshlrev_b32 v2, 16, v39
  v_and_b32 v3, s30, v39
  v_cvt_pk_f16_f32 v2, v2, v3
  v_and_b32 v23, v4, v2
  v_lshlrev_b32 v2, 16, v40
  v_and_b32 v3, s30, v40
  v_cvt_pk_f16_f32 v2, v2, v3
  v_and_b32 v24, v4, v2
  v_lshlrev_b32 v2, 16, v41
  v_and_b32 v3, s30, v41
  v_cvt_pk_f16_f32 v2, v2, v3
  v_and_b32 v25, v4, v2
  v_lshlrev_b32 v2, 16, v42
  v_and_b32 v3, s30, v42
  v_cvt_pk_f16_f32 v2, v2, v3
  v_and_b32 v26, v4, v2
  v_lshlrev_b32 v2, 16, v43
  v_and_b32 v3, s30, v43
  v_cvt_pk_f16_f32 v2, v2, v3
  v_and_b32 v27, v4, v2
  s_branch WPST
WPEND:
  s_cbranch_execnz WPX
  s_mov_b64 exec, -1
  s_waitcnt vmcnt(0)
  s_barrier
  s_branch WPGO
WPX:
  s_endpgm
.globl main_kernel
.p2align 8
.type main_kernel,@function
main_kernel:
  s_cmp_ge_u32 s2, 256
  s_cbranch_scc1 K2END
  s_load_dwordx2 s[52:53], s[0:1], 80
  s_load_dwordx8 s[32:39], s[0:1], 0
  s_load_dwordx4 s[48:51], s[0:1], 56
  s_and_b32 s3, s2, 7
  s_lshl_b32 s3, s3, 5
  s_lshr_b32 s56, s2, 3
  s_add_u32 s56, s56, s3
  v_lshrrev_b32 v2, 6, v0
  v_and_b32 v0, 63, v0
  v_readfirstlane_b32 s57, v2
  s_mov_b32 s60, 47
  s_mov_b32 s61, 0
  s_mov_b32 s63, 1
  s_mov_b32 s54, 1
  s_movk_i32 s55, 2176
  s_movk_i32 s94, 17404
  s_movk_i32 s95, 0xf0
  s_movk_i32 s64, 128
  s_mov_b32 s65, 0xffff0000
  s_mov_b32 s70, 0xbfb8aa3b
  s_mov_b32 s71, 0xbfb8aa3b
  s_mov_b32 s72, 1.0
  s_mov_b32 s73, 1.0
  s_mov_b32 s74, -1
  s_mov_b32 s75, 0
  s_lshl_b32 s66, s57, 12
  s_add_u32 s66, s66, 81408
  s_lshl_b32 s67, s57, 10
  s_add_u32 s67, s67, 36352
  s_mul_i32 s3, s56, 128
  s_mov_b32 s18, 8191232
  s_mov_b32 s19, 0x20000
  s_waitcnt lgkmcnt(0)
  s_add_u32 s16, s52, s3
  s_addc_u32 s17, s53, 0
ROUND:
  s_lshl_b32 s3, s57, 12
  v_lshl_add_u32 v2, v0, 4, s3
  v_lshrrev_b32 v3, 7, v2
  v_lshl_add_u32 v2, v3, 15, v2
  buffer_load_dwordx4 v[128:131], v2, s[16:19], 0 offen offset:0
  v_add_u32 v2, 262144, v2
  buffer_load_dwordx4 v[132:135], v2, s[16:19], 0 offen offset:1024
  v_add_u32 v2, 262144, v2
  buffer_load_dwordx4 v[136:139], v2, s[16:19], 0 offen offset:2048
  v_add_u32 v2, 262144, v2
  buffer_load_dwordx4 v[140:143], v2, s[16:19], 0 offen offset:3072
  s_and_b32 s3, s57, 3
  s_lshl_b32 s3, s3, 8
  v_lshl_add_u32 v4, v0, 2, s3
  v_mov_b32 v5, 0
  ds_write_b32 v4, v5 offset:34816
  s_cmp_eq_u32 s63, 0
  s_cbranch_scc1 NOTFIRST1
  s_mov_b32 s4, s32
  s_mov_b32 s5, s33
  s_mov_b32 s6, 6400000
  s_mov_b32 s7, 0x20000
  s_mov_b32 s12, s34
  s_mov_b32 s13, s35
  s_mov_b32 s14, 300000
  s_mov_b32 s15, 0x20000
  v_and_b32 v2, 7, v0
  v_bfe_u32 v3, v0, 4, 1
  v_lshrrev_b32 v5, 3, v0
  v_lshrrev_b32 v6, 5, v0
  v_lshl_add_u32 v233, v6, 2, 0
  v_xor_b32 v233, v233, v2
  v_lshlrev_b32 v233, 4, v233
  v_lshl_add_u32 v234, v6, 2, 1
  v_xor_b32 v234, v234, v2
  v_lshlrev_b32 v234, 4, v234
  v_lshl_add_u32 v235, v6, 2, 2
  v_xor_b32 v235, v235, v2
  v_lshlrev_b32 v235, 4, v235
  v_lshl_add_u32 v236, v6, 2, 3
  v_xor_b32 v236, v236, v2
  v_lshlrev_b32 v236, 4, v236
  v_lshl_add_u32 v7, v5, 2, 0
  v_mad_u32_u24 v56, v7, s64, v233
  v_lshl_add_u32 v7, v5, 2, 1
  v_mad_u32_u24 v57, v7, s64, v234
  v_lshl_add_u32 v7, v5, 2, 2
  v_mad_u32_u24 v58, v7, s64, v235
  v_lshl_add_u32 v7, v5, 2, 3
  v_mad_u32_u24 v59, v7, s64, v236
  s_mov_b32 s8, s36
  s_mov_b32 s9, s37
  s_mov_b32 s10, 25600000
  s_mov_b32 s11, 0x20000
  s_mov_b32 s28, s50
  s_mov_b32 s29, s51
  s_mov_b32 s30, 6700000
  s_mov_b32 s31, 0x20000
  s_mov_b32 s24, s48
  s_mov_b32 s25, s49
  s_mov_b32 s26, 16384
  s_mov_b32 s27, 0x20000
  s_add_u32 s20, s52, 8388608
  s_addc_u32 s21, s53, 0
  s_mov_b32 s22, 14704640
  s_mov_b32 s23, 0x20000
  v_lshlrev_b32 v13, 1, v3
  v_xor_b32 v13, v13, v2
  v_lshlrev_b32 v13, 4, v13
  v_lshl_or_b32 v13, v5, 7, v13
  s_lshl_b32 s3, s57, 10
  v_lshl_add_u32 v10, v0, 4, s3
  v_add_u32 v10, 14680064, v10
  v_add_u32 v13, s3, v13
  v_lshlrev_b32 v250, 4, v6
  v_and_b32 v2, 3, v0
  v_bfe_u32 v4, v0, 2, 3
  v_lshl_add_u32 v4, v2, 3, v4
  v_xor_b32 v7, v3, v6
  v_lshlrev_b32 v7, 6, v7
  v_lshl_add_u32 v4, v4, 7, v7
  v_add_u32 v4, s66, v4
  v_xor_b32 v7, 0, v2
  v_lshl_add_u32 v237, v7, 4, v4
  v_xor_b32 v7, 1, v2
  v_lshl_add_u32 v238, v7, 4, v4
  v_xor_b32 v7, 2, v2
  v_lshl_add_u32 v239, v7, 4, v4
  v_xor_b32 v7, 3, v2
  v_lshl_add_u32 v240, v7, 4, v4
  s_add_u32 s3, s67, 32
  v_lshlrev_b32 v7, 5, v6
  v_sub_u32 v241, s3, v7
  s_add_u32 s3, s67, 224
  v_lshl_add_u32 v7, v3, 2, v2
  v_lshlrev_b32 v7, 5, v7
  v_sub_u32 v243, s3, v7
  s_mul_i32 s3, s57, 4608
  s_add_u32 s3, s3, 44544
  v_and_b32 v7, 31, v0
  s_movk_i32 s68, 144
  v_mul_u32_u24 v8, s68, v7
  v_add_u32 v8, s3, v8
  v_lshl_add_u32 v242, v6, 5, v8
  v_bfe_u32 v4, v0, 2, 2
  v_lshl_add_u32 v8, v6, 2, v4
  s_movk_i32 s68, 576
  v_mul_u32_u24 v9, s68, v8
  v_add_u32 v9, s3, v9
  v_xor_b32 v245, v3, v0
  v_and_b32 v245, 1, v245
  v_lshl_add_u32 v245, v245, 3, v9
  v_add_u32 v245, 128, v245
  v_lshl_add_u32 v244, v3, 5, v9
  v_lshl_add_u32 v244, v2, 3, v244
  v_xor_b32 v253, v3, v0
  v_and_b32 v253, 1, v253
  v_lshlrev_b32 v253, 4, v253
  v_xor_b32 v254, v5, v6
  v_and_b32 v254, 1, v254
  v_lshlrev_b32 v254, 4, v254
  v_lshl_add_u32 v254, v7, 5, v254
  s_add_u32 s3, s67, 118784
  v_add_u32 v254, s3, v254
  v_mov_b32 v72, 0
  v_mov_b32 v73, 0
  v_mov_b32 v74, 0x3c00
  v_mov_b32 v75, 0x3c000000
  v_cmp_eq_u32 vcc, 28, v0
  s_nop 1
  v_cndmask_b32 v72, v72, v74, vcc
  v_cmp_eq_u32 vcc, 29, v0
  s_nop 1
  v_cndmask_b32 v72, v72, v75, vcc
  v_cmp_eq_u32 vcc, 30, v0
  s_nop 1
  v_cndmask_b32 v73, v73, v74, vcc
  v_cmp_eq_u32 vcc, 31, v0
  s_nop 1
  v_cndmask_b32 v73, v73, v75, vcc
  v_lshl_add_u32 v9, v0, 3, s67
  ds_write_b64 v9, v[72:73]
  v_mov_b32 v88, 0
  v_mov_b32 v89, 0
  v_mov_b32 v90, 0
  v_mov_b32 v91, 0
  v_mov_b32 v92, 0
  v_mov_b32 v93, 0
  v_mov_b32 v94, 0
  v_mov_b32 v95, 0
  v_mov_b32 v96, 0
  v_mov_b32 v97, 0
  v_mov_b32 v98, 0
  v_mov_b32 v99, 0
  v_mov_b32 v100, 0
  v_mov_b32 v101, 0
  v_mov_b32 v102, 0
  v_mov_b32 v103, 0
  v_mov_b32 v104, 0
  v_mov_b32 v105, 0
  v_mov_b32 v106, 0
  v_mov_b32 v107, 0
  v_mov_b32 v108, 0
  v_mov_b32 v109, 0
  v_mov_b32 v110, 0
  v_mov_b32 v111, 0
  v_mov_b32 v112, 0
  v_mov_b32 v113, 0
  v_mov_b32 v114, 0
  v_mov_b32 v115, 0
  v_mov_b32 v116, 0
  v_mov_b32 v117, 0
  v_mov_b32 v118, 0
  v_mov_b32 v119, 0
  v_mov_b32 v120, 0
  v_mov_b32 v121, 0
  v_mov_b32 v122, 0
  v_mov_b32 v123, 0
  s_branch FIRST1
NOTFIRST1:
  s_waitcnt vmcnt(0)
FIRST1:
  s_lshl_b32 s3, s57, 5
  v_lshrrev_b32 v2, 3, v0
  v_add_u32 v2, s3, v2
  s_mov_b32 s3, 58368
  v_mul_u32_u24 v2, s3, v2
  v_and_b32 v3, 7, v0
  v_lshl_add_u32 v2, v3, 4, v2
  v_lshlrev_b32 v3, 1, v3
  s_sub_i32 s68, s61, 15
  s_add_i32 s69, s68, s60
  s_max_i32 s68, s68, 0
  s_lshl_b32 s3, s68, 3
  v_add_u32 v2, s3, v2
  v_add_u32 v4, s68, v3
  v_mov_b32 v9, 1
  s_waitcnt lgkmcnt(0)
  s_barrier
  s_waitcnt vmcnt(3)
  v_ashrrev_i32 v5, 31, v131
  v_bfi_b32 v5, v5, 0, v130
  s_mov_b32 s3, 0
  v_mov_b32_dpp v6, v5 quad_perm:[3,3,3,3] row_mask:0xf bank_mask:0xf
  s_nop 1
  v_or_b32_dpp v6, v6, v6 row_half_mirror row_mask:0xf bank_mask:0xf
  v_lshrrev_b32 v224, 16, v6
  v_and_b32 v6, 0xffff, v6
  v_lshl_add_u32 v6, v6, 3, v2
  v_add_u32 v220, s3, v6
  v_min_i32 v216, s69, v224
  v_sub_u32 v216, v216, v4
  v_cmp_lt_i32 vcc, 0, v216
  s_nop 1
  v_cndmask_b32 v6, -16, v220, vcc
  buffer_load_dwordx4 v[144:147], v6, s[20:23], 0 offen
  s_waitcnt vmcnt(3)
  v_ashrrev_i32 v5, 31, v135
  v_bfi_b32 v5, v5, 0, v134
  s_mov_b32 s3, 466944
  v_mov_b32_dpp v6, v5 quad_perm:[3,3,3,3] row_mask:0xf bank_mask:0xf
  s_nop 1
  v_or_b32_dpp v6, v6, v6 row_half_mirror row_mask:0xf bank_mask:0xf
  v_lshrrev_b32 v225, 16, v6
  v_and_b32 v6, 0xffff, v6
  v_lshl_add_u32 v6, v6, 3, v2
  v_add_u32 v221, s3, v6
  v_min_i32 v217, s69, v225
  v_sub_u32 v217, v217, v4
  v_cmp_lt_i32 vcc, 0, v217
  s_nop 1
  v_cndmask_b32 v6, -16, v221, vcc
  buffer_load_dwordx4 v[148:151], v6, s[20:23], 0 offen
  s_waitcnt vmcnt(3)
  v_ashrrev_i32 v5, 31, v139
  v_bfi_b32 v5, v5, 0, v138
  s_mov_b32 s3, 933888
  v_mov_b32_dpp v6, v5 quad_perm:[3,3,3,3] row_mask:0xf bank_mask:0xf
  s_nop 1
  v_or_b32_dpp v6, v6, v6 row_half_mirror row_mask:0xf bank_mask:0xf
  v_lshrrev_b32 v226, 16, v6
  v_and_b32 v6, 0xffff, v6
  v_lshl_add_u32 v6, v6, 3, v2
  v_add_u32 v222, s3, v6
  v_min_i32 v218, s69, v226
  v_sub_u32 v218, v218, v4
  v_cmp_lt_i32 vcc, 0, v218
  s_nop 1
  v_cndmask_b32 v6, -16, v222, vcc
  buffer_load_dwordx4 v[152:155], v6, s[20:23], 0 offen
  s_waitcnt vmcnt(3)
  v_ashrrev_i32 v5, 31, v143
  v_bfi_b32 v5, v5, 0, v142
  s_mov_b32 s3, 1400832
  v_mov_b32_dpp v6, v5 quad_perm:[3,3,3,3] row_mask:0xf bank_mask:0xf
  s_nop 1
  v_or_b32_dpp v6, v6, v6 row_half_mirror row_mask:0xf bank_mask:0xf
  v_lshrrev_b32 v227, 16, v6
  v_and_b32 v6, 0xffff, v6
  v_lshl_add_u32 v6, v6, 3, v2
  v_add_u32 v223, s3, v6
  v_min_i32 v219, s69, v227
  v_sub_u32 v219, v219, v4
  v_cmp_lt_i32 vcc, 0, v219
  s_nop 1
  v_cndmask_b32 v6, -16, v223, vcc
  buffer_load_dwordx4 v[156:159], v6, s[20:23], 0 offen
  s_cmp_eq_u32 s63, 0
  s_cbranch_scc1 NOLATE1
  s_lshl_b32 m0, s57, 10
  s_add_u32 m0, m0, 130560
  s_nop 0
  buffer_load_dwordx4 v10, s[20:23], 0 offen lds
  v_add_u32 v10, 0x2000, v10
  s_lshl_b32 m0, s57, 10
  s_add_u32 m0, m0, 138752
  s_nop 0
  buffer_load_dwordx4 v10, s[20:23], 0 offen lds
  v_add_u32 v10, 0x2000, v10
  s_lshl_b32 m0, s57, 10
  s_add_u32 m0, m0, 146944
  s_nop 0
  buffer_load_dwordx4 v10, s[20:23], 0 offen lds
NOLATE1:
  v_max3_i32 v5, v216, v217, v218
  v_max_i32 v5, v5, v219
  v_cmp_lt_i32 s[76:77], 16, v5
  v_max3_i32 v5, v224, v225, v226
  v_max_i32 v5, v5, v227
  s_max_i32 s69, s69, 0
  v_cmp_lt_i32 s[68:69], s69, v5
  s_cmp_eq_u64 s[76:77], 0
  s_cbranch_scc1 NOL2A
  v_cmpx_lt_i32 vcc, 16, v216
  buffer_load_dwordx4 v[160:163], v220, s[20:23], 0 offen offset:128
  s_mov_b64 exec, -1
  v_cmpx_lt_i32 vcc, 16, v217
  buffer_load_dwordx4 v[164:167], v221, s[20:23], 0 offen offset:128
  s_mov_b64 exec, -1
  v_cmpx_lt_i32 vcc, 16, v218
  buffer_load_dwordx4 v[168:171], v222, s[20:23], 0 offen offset:128
  s_mov_b64 exec, -1
  v_cmpx_lt_i32 vcc, 16, v219
  buffer_load_dwordx4 v[172:175], v223, s[20:23], 0 offen offset:128
  s_mov_b64 exec, -1
NOL2A:
  s_cmp_lg_u32 s63, 0
  s_cbranch_scc1 FIRST2
  s_add_u32 s3, s61, s60
  v_add_u32 v5, 0, v3
  v_cmp_le_u32 s[32:33], s3, v5
  v_cmp_gt_u32 s[34:35], s61, v5
  s_or_b64 s[34:35], s[34:35], s[32:33]
  v_cmp_gt_i32 vcc, 0, v129
  s_and_b64 vcc, vcc, s[32:33]
  s_or_b64 s[68:69], s[68:69], vcc
  v_cndmask_b32 v129, v129, 0, s[34:35]
  v_cmp_gt_i32 vcc, 0, v133
  s_and_b64 vcc, vcc, s[32:33]
  s_or_b64 s[68:69], s[68:69], vcc
  v_cndmask_b32 v133, v133, 0, s[34:35]
  v_cmp_gt_i32 vcc, 0, v137
  s_and_b64 vcc, vcc, s[32:33]
  s_or_b64 s[68:69], s[68:69], vcc
  v_cndmask_b32 v137, v137, 0, s[34:35]
  v_cmp_gt_i32 vcc, 0, v141
  s_and_b64 vcc, vcc, s[32:33]
  s_or_b64 s[68:69], s[68:69], vcc
  v_cndmask_b32 v141, v141, 0, s[34:35]
  v_add_u32 v5, 1, v3
  v_cmp_le_u32 s[32:33], s3, v5
  v_cmp_gt_u32 s[34:35], s61, v5
  s_or_b64 s[34:35], s[34:35], s[32:33]
  v_cmp_gt_i32 vcc, 0, v131
  s_and_b64 vcc, vcc, s[32:33]
  s_or_b64 s[68:69], s[68:69], vcc
  v_cndmask_b32 v131, v131, 0, s[34:35]
  v_cmp_gt_i32 vcc, 0, v135
  s_and_b64 vcc, vcc, s[32:33]
  s_or_b64 s[68:69], s[68:69], vcc
  v_cndmask_b32 v135, v135, 0, s[34:35]
  v_cmp_gt_i32 vcc, 0, v139
  s_and_b64 vcc, vcc, s[32:33]
  s_or_b64 s[68:69], s[68:69], vcc
  v_cndmask_b32 v139, v139, 0, s[34:35]
  v_cmp_gt_i32 vcc, 0, v143
  s_and_b64 vcc, vcc, s[32:33]
  s_or_b64 s[68:69], s[68:69], vcc
  v_cndmask_b32 v143, v143, 0, s[34:35]
  s_waitcnt vmcnt(0)
FIRST2:
  s_cmp_eq_u64 s[68:69], 0
  s_cbranch_scc1 NOFLAG
  v_mov_b32 v5, 35328
  ds_write_b32 v5, v5
NOFLAG:
  v_cmp_gt_i32 s[32:33], 0, v129
  v_lshlrev_b32_sdwa v200, 2, v129 dst_sel:DWORD dst_unused:UNUSED_PAD src0_sel:DWORD src1_sel:BYTE_3
  v_cmp_gt_i32 s[34:35], 0, v131
  v_lshlrev_b32_sdwa v201, 2, v131 dst_sel:DWORD dst_unused:UNUSED_PAD src0_sel:DWORD src1_sel:BYTE_3
  v_cmp_gt_i32 s[36:37], 0, v133
  v_lshlrev_b32_sdwa v202, 2, v133 dst_sel:DWORD dst_unused:UNUSED_PAD src0_sel:DWORD src1_sel:BYTE_3
  v_cmp_gt_i32 s[38:39], 0, v135
  v_lshlrev_b32_sdwa v203, 2, v135 dst_sel:DWORD dst_unused:UNUSED_PAD src0_sel:DWORD src1_sel:BYTE_3
  v_cmp_gt_i32 s[40:41], 0, v137
  v_lshlrev_b32_sdwa v204, 2, v137 dst_sel:DWORD dst_unused:UNUSED_PAD src0_sel:DWORD src1_sel:BYTE_3
  v_cmp_gt_i32 s[42:43], 0, v139
  v_lshlrev_b32_sdwa v205, 2, v139 dst_sel:DWORD dst_unused:UNUSED_PAD src0_sel:DWORD src1_sel:BYTE_3
  v_cmp_gt_i32 s[44:45], 0, v141
  v_lshlrev_b32_sdwa v206, 2, v141 dst_sel:DWORD dst_unused:UNUSED_PAD src0_sel:DWORD src1_sel:BYTE_3
  v_cmp_gt_i32 s[46:47], 0, v143
  v_lshlrev_b32_sdwa v207, 2, v143 dst_sel:DWORD dst_unused:UNUSED_PAD src0_sel:DWORD src1_sel:BYTE_3
  s_mov_b64 exec, s[32:33]
  ds_add_rtn_u32 v176, v200, v9 offset:34304
  s_mov_b64 exec, s[34:35]
  ds_add_rtn_u32 v177, v201, v9 offset:34304
  s_mov_b64 exec, s[36:37]
  ds_add_rtn_u32 v178, v202, v9 offset:34304
  s_mov_b64 exec, s[38:39]
  ds_add_rtn_u32 v179, v203, v9 offset:34304
  s_mov_b64 exec, s[40:41]
  ds_add_rtn_u32 v180, v204, v9 offset:34304
  s_mov_b64 exec, s[42:43]
  ds_add_rtn_u32 v181, v205, v9 offset:34304
  s_mov_b64 exec, s[44:45]
  ds_add_rtn_u32 v182, v206, v9 offset:34304
  s_mov_b64 exec, s[46:47]
  ds_add_rtn_u32 v183, v207, v9 offset:34304
  s_mov_b64 exec, -1
  s_cmp_eq_u32 s63, 0
  s_cbranch_scc1 NOLATE2
  s_lshl_b32 m0, s57, 10
  s_add_u32 m0, m0, 114176
  s_nop 0
  buffer_load_dwordx4 v13, s[24:27], 0 offen lds
  v_add_u32 v13, 0x2000, v13
  s_lshl_b32 m0, s57, 10
  s_add_u32 m0, m0, 122368
  s_nop 0
  buffer_load_dwordx4 v13, s[24:27], 0 offen lds
NOLATE2:
  v_lshlrev_b32 v2, 2, v0
  v_lshrrev_b32 v8, 4, v0
  v_mul_u32_u24 v8, 544, v8
  v_and_b32 v3, 0x30, v0
  v_add_u32 v3, 35456, v3
  v_cmp_lt_i32 s[48:49], 0, v216
  v_cmp_lt_i32 s[50:51], 1, v216
  v_cmp_lt_i32 s[52:53], 0, v217
  v_cmp_lt_i32 s[96:97], 1, v217
  v_cmp_lt_i32 s[98:99], 0, v218
  v_cmp_lt_i32 s[100:101], 1, v218
  v_cmp_lt_i32 s[68:69], 0, v219
  s_waitcnt lgkmcnt(0)
  s_barrier
  ds_read2st64_b32 v[4:5], v2 offset0:136 offset1:137
  s_waitcnt lgkmcnt(0)
  v_mov_b32 v6, v4
  v_mov_b32 v7, v5
  s_nop 0
  v_add_u32_dpp v6, v6, v6 row_shr:1 row_mask:0xf bank_mask:0xf
  v_add_u32_dpp v7, v7, v7 row_shr:1 row_mask:0xf bank_mask:0xf
  s_nop 0
  v_add_u32_dpp v6, v6, v6 row_shr:2 row_mask:0xf bank_mask:0xf
  v_add_u32_dpp v7, v7, v7 row_shr:2 row_mask:0xf bank_mask:0xf
  s_nop 0
  v_add_u32_dpp v6, v6, v6 row_shr:4 row_mask:0xf bank_mask:0xf
  v_add_u32_dpp v7, v7, v7 row_shr:4 row_mask:0xf bank_mask:0xf
  s_nop 0
  v_add_u32_dpp v6, v6, v6 row_shr:8 row_mask:0xf bank_mask:0xf
  v_add_u32_dpp v7, v7, v7 row_shr:8 row_mask:0xf bank_mask:0xf
  v_sub_u32 v6, v6, v4
  v_sub_u32 v7, v7, v5
  v_add_u32 v4, v6, v8
  v_add3_u32 v5, v7, v8, s55
  ds_write2st64_b32 v2, v4, v5 offset0:140 offset1:141
  v_max_u32 v8, v6, v7
  v_cmp_lt_u32 vcc, 0x200, v8
  s_mov_b32 exec_lo, 0x80008000
  s_mov_b32 exec_hi, 0x80008000
  ds_write2_b32 v3, v4, v5 offset0:1 offset1:17
  s_mov_b64 exec, -1
  v_mov_b32 v8, 1
  v_mov_b32 v9, 0
  s_cbranch_vccz NOOVF1
  s_mov_b64 s[32:33], 0
  s_mov_b64 s[34:35], 0
  s_mov_b64 s[36:37], 0
  s_mov_b64 s[38:39], 0
  s_mov_b64 s[40:41], 0
  s_mov_b64 s[42:43], 0
  s_mov_b64 s[44:45], 0
  s_mov_b64 s[46:47], 0
NOOVF1:
  v_cmp_lt_i32 vcc, 1, v219
  s_waitcnt vmcnt(5)
  v_and_b32_sdwa v208, s95, v145 dst_sel:DWORD dst_unused:UNUSED_PAD src0_sel:DWORD src1_sel:BYTE_3
  v_and_b32_sdwa v209, s95, v147 dst_sel:DWORD dst_unused:UNUSED_PAD src0_sel:DWORD src1_sel:BYTE_3
  v_and_b32_sdwa v210, s95, v149 dst_sel:DWORD dst_unused:UNUSED_PAD src0_sel:DWORD src1_sel:BYTE_3
  v_and_b32_sdwa v211, s95, v151 dst_sel:DWORD dst_unused:UNUSED_PAD src0_sel:DWORD src1_sel:BYTE_3
  v_and_b32_sdwa v212, s95, v153 dst_sel:DWORD dst_unused:UNUSED_PAD src0_sel:DWORD src1_sel:BYTE_3
  v_and_b32_sdwa v213, s95, v155 dst_sel:DWORD dst_unused:UNUSED_PAD src0_sel:DWORD src1_sel:BYTE_3
  v_and_b32_sdwa v214, s95, v157 dst_sel:DWORD dst_unused:UNUSED_PAD src0_sel:DWORD src1_sel:BYTE_3
  v_and_b32_sdwa v215, s95, v159 dst_sel:DWORD dst_unused:UNUSED_PAD src0_sel:DWORD src1_sel:BYTE_3
  s_mov_b64 exec, s[48:49]
  ds_add_rtn_u64 v[184:185], v208, v[8:9] offset:35328
  s_mov_b64 exec, s[50:51]
  ds_add_rtn_u64 v[186:187], v209, v[8:9] offset:35328
  s_mov_b64 exec, s[52:53]
  ds_add_rtn_u64 v[188:189], v210, v[8:9] offset:35328
  s_mov_b64 exec, s[96:97]
  ds_add_rtn_u64 v[190:191], v211, v[8:9] offset:35328
  s_mov_b64 exec, s[98:99]
  ds_add_rtn_u64 v[192:193], v212, v[8:9] offset:35328
  s_mov_b64 exec, s[100:101]
  ds_add_rtn_u64 v[194:195], v213, v[8:9] offset:35328
  s_mov_b64 exec, s[68:69]
  ds_add_rtn_u64 v[196:197], v214, v[8:9] offset:35328
  s_mov_b64 exec, vcc
  ds_add_rtn_u64 v[198:199], v215, v[8:9] offset:35328
  s_mov_b64 exec, -1
  ds_read_b32 v200, v200 offset:35328
  ds_read_b32 v201, v201 offset:35328
  ds_read_b32 v202, v202 offset:35328
  ds_read_b32 v203, v203 offset:35328
  ds_read_b32 v204, v204 offset:35328
  ds_read_b32 v205, v205 offset:35328
  ds_read_b32 v206, v206 offset:35328
  ds_read_b32 v207, v207 offset:35328
  s_cmp_eq_u32 s63, 0
  s_cbranch_scc1 NOPERM
  v_mov_b32 v2, v6
  s_sub_u32 s3, 11, s57
  s_nop 0
  v_mov_b32_dpp v2, v7 row_shl:1 row_mask:0xf bank_mask:0xf
  s_cmp_lt_u32 s57, 4
  v_lshl_or_b32 v2, v2, 6, v0
  s_cselect_b32 s3, s57, s3
  s_mov_b32 s2, 7
  v_readlane_b32 s80, v2, 15
  v_readlane_b32 s82, v2, 31
  v_readlane_b32 s84, v2, 47
  v_readlane_b32 s86, v2, 63
  v_readlane_b32 s88, v2, 14
  v_readlane_b32 s90, v2, 30
  v_readlane_b32 s92, v2, 46
  s_mov_b32 exec_lo, 0xc000c000
  s_mov_b32 exec_hi, 0xc000c000
  v_cmp_lt_u32 s[80:81], s80, v2
  v_cmp_lt_u32 s[82:83], s82, v2
  v_cmp_lt_u32 s[84:85], s84, v2
  v_cmp_lt_u32 s[86:87], s86, v2
  v_cmp_lt_u32 s[88:89], s88, v2
  v_cmp_lt_u32 s[90:91], s90, v2
  v_cmp_lt_u32 s[92:93], s92, v2
  s_mov_b64 exec, -1
  s_bcnt1_i32_b64 s80, s[80:81]
  s_cmp_eq_u32 s80, s3
  s_cselect_b32 s2, 0, s2
  s_bcnt1_i32_b64 s82, s[82:83]
  s_cmp_eq_u32 s82, s3
  s_cselect_b32 s2, 1, s2
  s_bcnt1_i32_b64 s84, s[84:85]
  s_cmp_eq_u32 s84, s3
  s_cselect_b32 s2, 2, s2
  s_bcnt1_i32_b64 s86, s[86:87]
  s_cmp_eq_u32 s86, s3
  s_cselect_b32 s2, 3, s2
  s_bcnt1_i32_b64 s88, s[88:89]
  s_cmp_eq_u32 s88, s3
  s_cselect_b32 s2, 4, s2
  s_bcnt1_i32_b64 s90, s[90:91]
  s_cmp_eq_u32 s90, s3
  s_cselect_b32 s2, 5, s2
  s_bcnt1_i32_b64 s92, s[92:93]
  s_cmp_eq_u32 s92, s3
  s_cselect_b32 s2, 6, s2
  s_lshl_b32 s3, s56, 3
  s_add_u32 s3, s3, s2
  s_mul_i32 s3, s3, 3125
  s_add_u32 s58, s3, 127
  s_lshr_b32 s58, s58, 7
  s_add_u32 s3, s3, 3252
  s_lshr_b32 s3, s3, 7
  s_sub_u32 s3, s3, s58
  s_bfm_b32 s78, s3, 0
  s_lshl_b32 s3, s58, 7
  v_add_u32 v12, s58, v0
  v_add_u32 v56, s3, v56
  v_add_u32 v57, s3, v57
  v_add_u32 v58, s3, v58
  v_add_u32 v59, s3, v59
  v_mul_u32_u24 v11, 6, v12
  v_and_b32 v11, -4, v11
NOPERM:
  s_cmp_eq_u32 s63, 0
  s_cbranch_scc1 NOLATE4
  s_mul_i32 m0, s57, 4608
  s_add_u32 m0, m0, 44544
  s_nop 0
  buffer_load_dwordx4 v56, s[4:7], 0 offen lds
  s_mul_i32 m0, s57, 4608
  s_add_u32 m0, m0, 45568
  s_nop 0
  buffer_load_dwordx4 v57, s[4:7], 0 offen lds
NOLATE4:
  s_mul_i32 s3, s2, 2176
  v_lshrrev_b32 v2, 3, v0
  v_lshl_add_u32 v246, v2, 4, s3
  v_and_b32 v2, 31, v0
  v_lshl_add_u32 v247, v2, 2, s3
  v_bfe_u32 v2, v0, 2, 2
  v_lshl_add_u32 v2, v2, 4, s3
  v_lshl_add_u32 v248, v250, 2, v2
  v_lshrrev_b32 v2, 1, v0
  v_lshl_add_u32 v252, v2, 2, s3
  v_mov_b32 v2, 35328
  s_waitcnt lgkmcnt(8)
  v_add_lshl_u32 v208, v184, v185, 2
  v_min_u32 v208, s94, v208
  v_add_lshl_u32 v209, v186, v187, 2
  v_min_u32 v209, s94, v209
  v_add_lshl_u32 v210, v188, v189, 2
  v_min_u32 v210, s94, v210
  v_add_lshl_u32 v211, v190, v191, 2
  v_min_u32 v211, s94, v211
  v_add_lshl_u32 v212, v192, v193, 2
  v_min_u32 v212, s94, v212
  v_add_lshl_u32 v213, v194, v195, 2
  v_min_u32 v213, s94, v213
  v_add_lshl_u32 v214, v196, v197, 2
  v_min_u32 v214, s94, v214
  v_add_lshl_u32 v215, v198, v199, 2
  v_min_u32 v215, s94, v215
  s_waitcnt lgkmcnt(6)
  v_add_lshl_u32 v200, v200, v176, 2
  v_add_lshl_u32 v201, v201, v177, 2
  s_waitcnt lgkmcnt(4)
  v_add_lshl_u32 v202, v202, v178, 2
  v_add_lshl_u32 v203, v203, v179, 2
  s_waitcnt lgkmcnt(2)
  v_add_lshl_u32 v204, v204, v180, 2
  v_add_lshl_u32 v205, v205, v181, 2
  s_waitcnt lgkmcnt(0)
  v_add_lshl_u32 v206, v206, v182, 2
  v_add_lshl_u32 v207, v207, v183, 2
  s_mov_b64 exec, s[32:33]
  ds_write2st64_b32 v200, v128, v129 offset0:0 offset1:68
  s_mov_b64 exec, s[34:35]
  ds_write2st64_b32 v201, v130, v131 offset0:0 offset1:68
  s_mov_b64 exec, s[36:37]
  ds_write2st64_b32 v202, v132, v133 offset0:0 offset1:68
  s_mov_b64 exec, s[38:39]
  ds_write2st64_b32 v203, v134, v135 offset0:0 offset1:68
  s_mov_b64 exec, -1
  s_cmp_eq_u32 s63, 0
  s_cbranch_scc1 NOLATE5
  s_mul_i32 m0, s57, 4608
  s_add_u32 m0, m0, 46592
  s_nop 0
  buffer_load_dwordx4 v58, s[4:7], 0 offen lds
NOLATE5:
  s_mov_b64 exec, s[40:41]
  ds_write2st64_b32 v204, v136, v137 offset0:0 offset1:68
  s_mov_b64 exec, s[42:43]
  ds_write2st64_b32 v205, v138, v139 offset0:0 offset1:68
  s_mov_b64 exec, s[44:45]
  ds_write2st64_b32 v206, v140, v141 offset0:0 offset1:68
  s_mov_b64 exec, s[46:47]
  ds_write2st64_b32 v207, v142, v143 offset0:0 offset1:68
  s_mov_b64 exec, -1
  s_cmp_eq_u32 s63, 0
  s_cbranch_scc1 NOLATE6
  s_mul_i32 m0, s57, 4608
  s_add_u32 m0, m0, 47616
  s_nop 0
  buffer_load_dwordx4 v59, s[4:7], 0 offen lds
NOLATE6:
  s_mov_b64 exec, s[48:49]
  ds_write2st64_b32 v208, v144, v145 offset0:0 offset1:68
  s_mov_b64 exec, s[50:51]
  ds_write2st64_b32 v209, v146, v147 offset0:0 offset1:68
  s_mov_b64 exec, s[52:53]
  ds_write2st64_b32 v210, v148, v149 offset0:0 offset1:68
  s_mov_b64 exec, s[96:97]
  ds_write2st64_b32 v211, v150, v151 offset0:0 offset1:68
  s_mov_b64 exec, s[98:99]
  ds_write2st64_b32 v212, v152, v153 offset0:0 offset1:68
  s_mov_b64 exec, s[100:101]
  ds_write2st64_b32 v213, v154, v155 offset0:0 offset1:68
  s_mov_b64 exec, s[68:69]
  ds_write2st64_b32 v214, v156, v157 offset0:0 offset1:68
  s_mov_b64 exec, vcc
  ds_write2st64_b32 v215, v158, v159 offset0:0 offset1:68
  s_mov_b64 exec, -1
  s_cmp_eq_u64 s[76:77], 0
  s_cbranch_scc1 NOL2B
  s_waitcnt vmcnt(0) lgkmcnt(0)
  v_cmpx_lt_i32 vcc, 16, v216
  v_and_b32_sdwa v208, s95, v161 dst_sel:DWORD dst_unused:UNUSED_PAD src0_sel:DWORD src1_sel:BYTE_3
  ds_add_rtn_u64 v[184:185], v208, v[8:9] offset:35328
  v_cmpx_lt_i32 vcc, 17, v216
  v_and_b32_sdwa v209, s95, v163 dst_sel:DWORD dst_unused:UNUSED_PAD src0_sel:DWORD src1_sel:BYTE_3
  ds_add_rtn_u64 v[186:187], v209, v[8:9] offset:35328
  s_mov_b64 exec, -1
  v_cmpx_lt_i32 vcc, 16, v217
  v_and_b32_sdwa v210, s95, v165 dst_sel:DWORD dst_unused:UNUSED_PAD src0_sel:DWORD src1_sel:BYTE_3
  ds_add_rtn_u64 v[188:189], v210, v[8:9] offset:35328
  v_cmpx_lt_i32 vcc, 17, v217
  v_and_b32_sdwa v211, s95, v167 dst_sel:DWORD dst_unused:UNUSED_PAD src0_sel:DWORD src1_sel:BYTE_3
  ds_add_rtn_u64 v[190:191], v211, v[8:9] offset:35328
  s_mov_b64 exec, -1
  v_cmpx_lt_i32 vcc, 16, v218
  v_and_b32_sdwa v212, s95, v169 dst_sel:DWORD dst_unused:UNUSED_PAD src0_sel:DWORD src1_sel:BYTE_3
  ds_add_rtn_u64 v[192:193], v212, v[8:9] offset:35328
  v_cmpx_lt_i32 vcc, 17, v218
  v_and_b32_sdwa v213, s95, v171 dst_sel:DWORD dst_unused:UNUSED_PAD src0_sel:DWORD src1_sel:BYTE_3
  ds_add_rtn_u64 v[194:195], v213, v[8:9] offset:35328
  s_mov_b64 exec, -1
  v_cmpx_lt_i32 vcc, 16, v219
  v_and_b32_sdwa v214, s95, v173 dst_sel:DWORD dst_unused:UNUSED_PAD src0_sel:DWORD src1_sel:BYTE_3
  ds_add_rtn_u64 v[196:197], v214, v[8:9] offset:35328
  v_cmpx_lt_i32 vcc, 17, v219
  v_and_b32_sdwa v215, s95, v175 dst_sel:DWORD dst_unused:UNUSED_PAD src0_sel:DWORD src1_sel:BYTE_3
  ds_add_rtn_u64 v[198:199], v215, v[8:9] offset:35328
  s_mov_b64 exec, -1
  s_waitcnt lgkmcnt(0)
  v_cmpx_lt_i32 vcc, 16, v216
  v_add_lshl_u32 v208, v184, v185, 2
  v_min_u32 v208, s94, v208
  ds_write2st64_b32 v208, v160, v161 offset0:0 offset1:68
  v_cmpx_lt_i32 vcc, 17, v216
  v_add_lshl_u32 v209, v186, v187, 2
  v_min_u32 v209, s94, v209
  ds_write2st64_b32 v209, v162, v163 offset0:0 offset1:68
  s_mov_b64 exec, -1
  v_cmpx_lt_i32 vcc, 16, v217
  v_add_lshl_u32 v210, v188, v189, 2
  v_min_u32 v210, s94, v210
  ds_write2st64_b32 v210, v164, v165 offset0:0 offset1:68
  v_cmpx_lt_i32 vcc, 17, v217
  v_add_lshl_u32 v211, v190, v191, 2
  v_min_u32 v211, s94, v211
  ds_write2st64_b32 v211, v166, v167 offset0:0 offset1:68
  s_mov_b64 exec, -1
  v_cmpx_lt_i32 vcc, 16, v218
  v_add_lshl_u32 v212, v192, v193, 2
  v_min_u32 v212, s94, v212
  ds_write2st64_b32 v212, v168, v169 offset0:0 offset1:68
  v_cmpx_lt_i32 vcc, 17, v218
  v_add_lshl_u32 v213, v194, v195, 2
  v_min_u32 v213, s94, v213
  ds_write2st64_b32 v213, v170, v171 offset0:0 offset1:68
  s_mov_b64 exec, -1
  v_cmpx_lt_i32 vcc, 16, v219
  v_add_lshl_u32 v214, v196, v197, 2
  v_min_u32 v214, s94, v214
  ds_write2st64_b32 v214, v172, v173 offset0:0 offset1:68
  v_cmpx_lt_i32 vcc, 17, v219
  v_add_lshl_u32 v215, v198, v199, 2
  v_min_u32 v215, s94, v215
  ds_write2st64_b32 v215, v174, v175 offset0:0 offset1:68
  s_mov_b64 exec, -1
NOL2B:
  s_cmp_eq_u32 s63, 0
  s_cbranch_scc1 NOLATE7
  buffer_load_dwordx2 v[124:125], v11, s[12:15], 0 offen
NOLATE7:
  s_mov_b32 s63, 0
  v_mov_b32 v224, 0
  v_mov_b32 v225, 0
  v_mov_b32 v226, 0
  v_mov_b32 v227, 0
  s_and_b32 s62, s2, 3
  s_lshl_b32 s62, s62, 4
  s_add_u32 s62, s62, 15
  s_waitcnt vmcnt(5) lgkmcnt(0)
  s_barrier
  s_setprio 3
  ds_read2_b32 v[4:5], v3 offset0:0 offset1:16
  ds_read_b32 v8, v2
  ds_read_b128 v[220:223], v246 offset:0
  ds_read_b32 v228, v247 offset:0
  ds_read_b32 v1, v252 offset:17408
  s_waitcnt lgkmcnt(3)
  v_add_u32 v6, v6, v4
  v_add_u32 v7, v7, v5
  v_max_u32 v4, v6, v7
  v_cmp_lt_u32 vcc, 0x200, v4
  v_readlane_b32 s68, v6, s62
  v_readlane_b32 s69, v7, s62
  v_readfirstlane_b32 s62, v8
  s_cbranch_vccz NOOVF
  s_lshr_b32 s60, s60, 1
  s_waitcnt vmcnt(0) lgkmcnt(0)
  s_barrier
  s_branch ROUND
NOOVF:
  s_cmp_ge_u32 s2, 4
  s_cselect_b32 s68, s69, s68
  s_add_u32 s59, s68, 31
  s_lshr_b32 s59, s59, 5
  v_add_u32 v2, s68, v0
  s_lshl_b32 s69, s59, 5
  v_lshl_add_u32 v3, v2, 2, s3
  s_sub_u32 s3, s58, s69
  v_add_u32 v4, s3, v2
  v_mov_b32 v5, 0xffff
  v_cmp_gt_u32 vcc, s69, v2
  s_nop 1
  v_cndmask_b32 v4, v4, v5, vcc
  v_or_b32 v4, 0xf8000000, v4
  v_mov_b32 v5, 0x00ffffff
  s_add_u32 s69, s69, 32
  v_cmpx_gt_u32 vcc, s69, v2
  ds_write2st64_b32 v3, v4, v5 offset0:0 offset1:68
  s_mov_b64 exec, -1
  s_cmp_ge_u32 s68, 32
  s_cbranch_scc1 FULL0
  ds_read_b128 v[220:223], v246 offset:0
  ds_read_b32 v228, v247 offset:0
  ds_read_b32 v1, v252 offset:17408
  s_waitcnt lgkmcnt(0)
FULL0:
  s_waitcnt lgkmcnt(1)
  s_cmp_gt_i32 s59, -1
  s_cselect_b32 s6, 6400000, 0
  s_cselect_b32 s10, 25600000, 0
  s_cselect_b32 s14, 300000, 0
  s_add_u32 m0, s67, 118784
  v_mad_u32_u24 v1, v1, 32, v253
  buffer_load_dwordx4 v1, s[8:11], 0 offen  lds
  s_add_u32 m0, s66, 0
  v_mad_u32_u24 v220, v220, s64, v233
  buffer_load_dwordx4 v220, s[4:7], 0 offen  lds
  s_add_u32 m0, s66, 1024
  v_mad_u32_u24 v221, v221, s64, v234
  buffer_load_dwordx4 v221, s[4:7], 0 offen  lds
  s_add_u32 m0, s66, 2048
  v_mad_u32_u24 v222, v222, s64, v235
  buffer_load_dwordx4 v222, s[4:7], 0 offen  lds
  s_add_u32 m0, s66, 3072
  v_mad_u32_u24 v223, v223, s64, v236
  buffer_load_dwordx4 v223, s[4:7], 0 offen  lds
  v_mul_u32_u24 v1, 6, v228
  v_and_b32 v1, -4, v1
  s_mov_b64 exec, s[74:75]
  buffer_load_dwordx2 v[224:225], v1, s[12:15], 0 offen
  s_mov_b64 exec, -1
  ds_read_b128 v[220:223], v246 offset:128
  ds_read_b32 v229, v247 offset:128
  ds_read_b32 v1, v252 offset:17536
  s_waitcnt lgkmcnt(0)
  s_cmp_eq_u32 s54, 0
  s_cbranch_scc1 NOINIT2
  v_lshlrev_b32 v2, 4, v0
  v_add_u32 v2, 130560, v2
  s_lshl_b32 s3, s57, 9
  s_sub_u32 s3, s3, 36864
  s_waitcnt vmcnt(6)
  v_add_u32 v6, s3, v237
  ds_read_b128 v[200:203], v6
  v_add_u32 v7, s3, v238
  ds_read_b128 v[204:207], v7
  v_add_u32 v8, s3, v239
  ds_read_b128 v[208:211], v8
  v_add_u32 v9, s3, v240
  ds_read_b128 v[212:215], v9
  ds_read_b128 v[128:131], v2 offset:0
  ds_read_b128 v[132:135], v2 offset:1024
  ds_read_b128 v[136:139], v2 offset:2048
  ds_read_b128 v[140:143], v2 offset:3072
  ds_read_b128 v[144:147], v2 offset:4096
  ds_read_b128 v[148:151], v2 offset:5120
  ds_read_b128 v[152:155], v2 offset:6144
  ds_read_b128 v[156:159], v2 offset:7168
  ds_read_b64 v[4:5], v2 offset:18432
  ds_read_b128 v[16:19], v2 offset:8192
  ds_read_b128 v[20:23], v2 offset:9216
  ds_read_b128 v[24:27], v2 offset:10240
  ds_read_b128 v[28:31], v2 offset:11264
  ds_read_b128 v[32:35], v2 offset:12288
  ds_read_b128 v[36:39], v2 offset:13312
  ds_read_b128 v[40:43], v2 offset:14336
  ds_read_b128 v[44:47], v2 offset:15360
  ds_read_b128 v[48:51], v2 offset:16384
  ds_read_b128 v[52:55], v2 offset:17408
  ds_read_b128 v[72:75], v2 offset:20480
  ds_read_b128 v[76:79], v2 offset:21504
  ds_read_b128 v[80:83], v2 offset:22528
  ds_read_b128 v[84:87], v2 offset:23552
  v_lshlrev_b32 v7, 4, v12
  v_alignbit_b32 v8, v125, v124, v7
  v_lshrrev_b32 v9, v7, v125
  v_lshlrev_b32 v6, 16, v8
  v_and_b32 v7, s65, v8
  v_lshlrev_b32 v8, 16, v9
  v_lshl_add_u32 v9, v0, 3, s67
  s_mov_b64 exec, s[74:75]
  ds_write_b64 v9, v[6:7] offset:512
  ds_write_b32 v9, v8 offset:768
  s_mov_b64 exec, -1
  s_waitcnt lgkmcnt(15)
  v_mfma_f32_32x32x16_bf16 v[160:175], v[200:203], v[128:131], 0
  v_mfma_f32_32x32x16_bf16 v[176:191], v[200:203], v[144:147], 0
  v_mfma_f32_32x32x16_bf16 v[160:175], v[204:207], v[132:135], v[160:175]
  v_mfma_f32_32x32x16_bf16 v[176:191], v[204:207], v[148:151], v[176:191]
  v_mfma_f32_32x32x16_bf16 v[160:175], v[208:211], v[136:139], v[160:175]
  v_mfma_f32_32x32x16_bf16 v[176:191], v[208:211], v[152:155], v[176:191]
  v_mfma_f32_32x32x16_bf16 v[160:175], v[212:215], v[140:143], v[160:175]
  v_mfma_f32_32x32x16_bf16 v[176:191], v[212:215], v[156:159], v[176:191]
  s_waitcnt lgkmcnt(0)
  s_mov_b32 s54, 0
  s_nop 7
  s_nop 0
  v_pk_mul_f32 v[160:161], v[160:161], s[70:71]
  v_cvt_pk_f16_f32 v56, v160, v161
  v_pk_mul_f32 v[162:163], v[162:163], s[70:71]
  v_cvt_pk_f16_f32 v57, v162, v163
  v_pk_mul_f32 v[164:165], v[164:165], s[70:71]
  v_cvt_pk_f16_f32 v58, v164, v165
  v_pk_mul_f32 v[166:167], v[166:167], s[70:71]
  v_cvt_pk_f16_f32 v59, v166, v167
  v_pk_mul_f32 v[168:169], v[168:169], s[70:71]
  v_cvt_pk_f16_f32 v60, v168, v169
  v_pk_mul_f32 v[170:171], v[170:171], s[70:71]
  v_cvt_pk_f16_f32 v61, v170, v171
  v_pk_mul_f32 v[172:173], v[172:173], s[70:71]
  v_cvt_pk_f16_f32 v62, v172, v173
  v_pk_mul_f32 v[176:177], v[176:177], s[70:71]
  v_cvt_pk_f16_f32 v64, v176, v177
  v_pk_mul_f32 v[178:179], v[178:179], s[70:71]
  v_cvt_pk_f16_f32 v65, v178, v179
  v_pk_mul_f32 v[180:181], v[180:181], s[70:71]
  v_cvt_pk_f16_f32 v66, v180, v181
  v_pk_mul_f32 v[182:183], v[182:183], s[70:71]
  v_cvt_pk_f16_f32 v67, v182, v183
  v_pk_mul_f32 v[184:185], v[184:185], s[70:71]
  v_cvt_pk_f16_f32 v68, v184, v185
  v_pk_mul_f32 v[186:187], v[186:187], s[70:71]
  v_cvt_pk_f16_f32 v69, v186, v187
  v_pk_mul_f32 v[188:189], v[188:189], s[70:71]
  v_cvt_pk_f16_f32 v70, v188, v189
  v_mov_b32 v63, v4
  v_mov_b32 v71, v5
NOINIT2:
  v_mov_b32 v184, 0
  v_mov_b32 v168, 0
  v_mov_b32 v185, 0
  v_mov_b32 v169, 0
  v_mov_b32 v186, 0
  v_mov_b32 v170, 0
  v_mov_b32 v187, 0
  v_mov_b32 v171, 0
  v_mov_b32 v188, 0
  v_mov_b32 v172, 0
  v_mov_b32 v189, 0
  v_mov_b32 v173, 0
  v_mov_b32 v190, 0
  v_mov_b32 v174, 0
  v_mov_b32 v191, 0
  v_mov_b32 v175, 0
  v_mov_b32 v124, 0
  v_mov_b32 v125, 0
  v_mov_b32 v126, 0
  v_mov_b32 v127, 0
  v_mov_b32 v13, 0
  v_mov_b32 v14, 0
  v_mov_b32 v15, 0
  s_mul_i32 s3, s57, 4608
  s_add_u32 s3, s3, 44544
  v_lshl_add_u32 v2, v0, 3, s3
  ds_write_b64 v2, v[184:185] offset:0
  ds_write_b64 v2, v[184:185] offset:512
  ds_write_b64 v2, v[184:185] offset:1024
  ds_write_b64 v2, v[184:185] offset:1536
  ds_write_b64 v2, v[184:185] offset:2048
  ds_write_b64 v2, v[184:185] offset:2560
  ds_write_b64 v2, v[184:185] offset:3072
  ds_write_b64 v2, v[184:185] offset:3584
  ds_write_b64 v2, v[184:185] offset:4096
  s_waitcnt vmcnt(0)
  ds_read_b128 v[216:219], v254
  ds_read_b128 v[200:203], v237
  ds_read_b128 v[204:207], v238
  ds_read_b128 v[208:211], v239
  ds_read_b128 v[212:215], v240
  v_add_u32_sdwa v249, v241, v228 dst_sel:DWORD dst_unused:UNUSED_PAD src0_sel:DWORD src1_sel:BYTE_3
  ds_read_b64 v[230:231], v249 offset:480
  ds_read_b32 v232, v249 offset:736
  v_lshlrev_b32 v125, 4, v228
  v_alignbit_b32 v126, v225, v224, v125
  v_lshrrev_b32 v127, v125, v225
  ds_read_b64 v[176:177], v249 offset:192
  ds_read_b64 v[178:179], v249 offset:128
  ds_read_b64 v[180:181], v249 offset:64
  ds_read_b32 v182, v249
  s_waitcnt lgkmcnt(10)
  v_mfma_f32_32x32x16_bf16 v[128:143], v[48:51], v[216:219], 0
  v_mfma_f32_32x32x16_bf16 v[144:159], v[52:55], v[216:219], 0
  v_lshlrev_b32 v125, 16, v126
  v_and_b32 v126, s65, v126
  v_lshlrev_b32 v127, 16, v127
  s_waitcnt lgkmcnt(5)
  v_sub_f32 v230, v230, v125
  v_sub_f32 v231, v231, v126
  s_waitcnt lgkmcnt(4)
  v_sub_f32 v232, v232, v127
  v_cvt_pk_bf16_f32 v230, v230, v231
  v_cvt_pk_bf16_f32 v232, v232, v232
  v_lshlrev_b32 v10, 16, v230
  v_and_b32 v11, s65, v230
  v_lshlrev_b32 v12, 16, v232
  v_mul_f32 v230, v10, v10
  v_fmac_f32 v230, v11, v11
  v_fmac_f32 v230, v12, v12
  v_cvt_pk_f16_f32 v183, v230, v230
  v_mfma_f32_32x32x16_bf16 v[128:143], v[16:19], v[200:203], v[128:143]
  v_mfma_f32_32x32x16_bf16 v[128:143], v[20:23], v[204:207], v[128:143]
  v_mfma_f32_32x32x16_bf16 v[128:143], v[24:27], v[208:211], v[128:143]
  v_mfma_f32_32x32x16_bf16 v[128:143], v[28:31], v[212:215], v[128:143]
  s_waitcnt lgkmcnt(2)
  v_mfma_f32_32x32x16_f16 v[128:143], v[56:59], v[176:179], v[128:143]
  s_waitcnt lgkmcnt(0)
  v_mfma_f32_32x32x16_f16 v[128:143], v[60:63], v[180:183], v[128:143]
  s_cmp_gt_i32 s59, 0
  s_cselect_b32 s6, 6400000, 0
  s_cselect_b32 s10, 25600000, 0
  s_cselect_b32 s14, 300000, 0
  s_add_u32 m0, s67, 118784
  v_mad_u32_u24 v1, v1, 32, v253
  buffer_load_dwordx4 v1, s[8:11], 0 offen  lds
  s_add_u32 m0, s66, 0
  v_mad_u32_u24 v220, v220, s64, v233
  buffer_load_dwordx4 v220, s[4:7], 0 offen  lds
  s_add_u32 m0, s66, 1024
  v_mad_u32_u24 v221, v221, s64, v234
  buffer_load_dwordx4 v221, s[4:7], 0 offen  lds
  s_add_u32 m0, s66, 2048
  v_mad_u32_u24 v222, v222, s64, v235
  buffer_load_dwordx4 v222, s[4:7], 0 offen  lds
  s_add_u32 m0, s66, 3072
  v_mad_u32_u24 v223, v223, s64, v236
  buffer_load_dwordx4 v223, s[4:7], 0 offen  lds
  v_mul_u32_u24 v1, 6, v229
  v_and_b32 v1, -4, v1
  s_mov_b64 exec, s[74:75]
  buffer_load_dwordx2 v[226:227], v1, s[12:15], 0 offen
  s_mov_b64 exec, -1
  s_waitcnt lgkmcnt(0)
  s_cmp_eq_u32 s59, 0
  s_cbranch_scc1 LOOPEND
  s_cmp_ge_u32 s57, 4
  s_movk_i32 s79, 80
  s_cmovk_i32 s79, 80
LOOP:
  ds_read_b64_tr_b16 v[192:193], v244 offset:64
  ds_read_b64_tr_b16 v[194:195], v244 offset:208
  ds_read_b64_tr_b16 v[196:197], v244 offset:352
  ds_read_b64_tr_b16 v[198:199], v244 offset:496
  v_cvt_pk_f16_f32 v160, v128, v129
  v_cvt_pk_f16_f32 v161, v130, v131
  v_cvt_pk_f16_f32 v162, v132, v133
  v_cvt_pk_f16_f32 v163, v134, v135
  v_cvt_pk_f16_f32 v164, v136, v137
  v_cvt_pk_f16_f32 v165, v138, v139
  v_cvt_pk_f16_f32 v166, v140, v141
  v_cvt_pk_f16_f32 v167, v142, v143
  v_mfma_f32_16x16x32_f16 v[124:127], v[80:83], v[168:171], v[124:127]
  v_exp_f16_sdwa v2, v160 dst_sel:WORD_0 dst_unused:UNUSED_PAD src0_sel:WORD_0
  s_mov_b64 exec, 1
  ds_add_rtn_u32 v251, v0, v234 offset:35336
  s_mov_b64 exec, -1
  v_exp_f16_sdwa v3, v161 dst_sel:WORD_0 dst_unused:UNUSED_PAD src0_sel:WORD_0
  v_mfma_f32_16x16x32_f16 v[124:127], v[84:87], v[172:175], v[124:127]
  v_exp_f16_sdwa v4, v162 dst_sel:WORD_0 dst_unused:UNUSED_PAD src0_sel:WORD_0
  v_exp_f16_sdwa v5, v163 dst_sel:WORD_0 dst_unused:UNUSED_PAD src0_sel:WORD_0
  v_mfma_f32_32x32x16_bf16 v[144:159], v[32:35], v[200:203], v[144:159]
  v_exp_f16_sdwa v2, v160 dst_sel:WORD_1 dst_unused:UNUSED_PRESERVE src0_sel:WORD_1
  v_exp_f16_sdwa v3, v161 dst_sel:WORD_1 dst_unused:UNUSED_PRESERVE src0_sel:WORD_1
  v_exp_f16_sdwa v4, v162 dst_sel:WORD_1 dst_unused:UNUSED_PRESERVE src0_sel:WORD_1
  s_waitcnt lgkmcnt(3)
  v_mfma_f32_32x32x16_f16 v[104:119], v[192:195], v[184:187], v[104:119]
  v_exp_f16_sdwa v5, v163 dst_sel:WORD_1 dst_unused:UNUSED_PRESERVE src0_sel:WORD_1
  v_pk_add_f16 v2, v2, 1.0 op_sel_hi:[1,0]
  v_pk_add_f16 v3, v3, 1.0 op_sel_hi:[1,0]
  v_pk_add_f16 v4, v4, 1.0 op_sel_hi:[1,0]
  v_pk_add_f16 v5, v5, 1.0 op_sel_hi:[1,0]
  v_mul_f32 v230, v13, v124
  v_mul_f32 v231, v14, v124
  v_mul_f32 v232, v15, v124
  v_cvt_pk_f16_f32 v230, v230, v231
  v_cvt_pk_f16_f32 v231, v232, v232
  s_mov_b64 exec, s[74:75]
  ds_write_b64 v242, v[230:231] offset:128
  s_mov_b64 exec, -1
  v_rcp_f16_sdwa v6, v2 dst_sel:WORD_0 dst_unused:UNUSED_PAD src0_sel:WORD_0
  v_rcp_f16_sdwa v7, v3 dst_sel:WORD_0 dst_unused:UNUSED_PAD src0_sel:WORD_0
  s_waitcnt lgkmcnt(2)
  v_mfma_f32_32x32x16_f16 v[104:119], v[196:199], v[188:191], v[104:119]
  ds_read_b64_tr_b16 v[192:193], v245 offset:0
  ds_read_b64_tr_b16 v[194:195], v245 offset:144
  ds_read_b64_tr_b16 v[196:197], v245 offset:288
  ds_read_b64_tr_b16 v[198:199], v245 offset:432
  v_rcp_f16_sdwa v8, v4 dst_sel:WORD_0 dst_unused:UNUSED_PAD src0_sel:WORD_0
  s_waitcnt lgkmcnt(5)
  v_readfirstlane_b32 s68, v251
  s_setprio 2
  s_cmp_lt_i32 s68, s79
  s_cbranch_scc0 PRI0
  s_setprio 1
PRI0:
  s_add_u32 s79, s79, 128
  v_rcp_f16_sdwa v9, v5 dst_sel:WORD_0 dst_unused:UNUSED_PAD src0_sel:WORD_0
  v_rcp_f16_sdwa v6, v2 dst_sel:WORD_1 dst_unused:UNUSED_PRESERVE src0_sel:WORD_1
  v_mfma_f32_32x32x16_bf16 v[144:159], v[36:39], v[204:207], v[144:159]
  v_rcp_f16_sdwa v7, v3 dst_sel:WORD_1 dst_unused:UNUSED_PRESERVE src0_sel:WORD_1
  v_rcp_f16_sdwa v8, v4 dst_sel:WORD_1 dst_unused:UNUSED_PRESERVE src0_sel:WORD_1
  v_rcp_f16_sdwa v9, v5 dst_sel:WORD_1 dst_unused:UNUSED_PRESERVE src0_sel:WORD_1
  v_pk_mul_f16 v160, v160, v6
  v_pk_mul_f16 v161, v161, v7
  v_pk_mul_f16 v162, v162, v8
  v_pk_mul_f16 v163, v163, v9
  ds_write_b128 v242, v[160:163] offset:0
  v_mfma_f32_32x32x16_bf16 v[144:159], v[40:43], v[208:211], v[144:159]
  v_exp_f16_sdwa v2, v164 dst_sel:WORD_0 dst_unused:UNUSED_PAD src0_sel:WORD_0
  v_exp_f16_sdwa v3, v165 dst_sel:WORD_0 dst_unused:UNUSED_PAD src0_sel:WORD_0
  v_exp_f16_sdwa v4, v166 dst_sel:WORD_0 dst_unused:UNUSED_PAD src0_sel:WORD_0
  v_mfma_f32_32x32x16_bf16 v[144:159], v[44:47], v[212:215], v[144:159]
  v_exp_f16_sdwa v5, v167 dst_sel:WORD_0 dst_unused:UNUSED_PAD src0_sel:WORD_0
  v_exp_f16_sdwa v2, v164 dst_sel:WORD_1 dst_unused:UNUSED_PRESERVE src0_sel:WORD_1
  v_exp_f16_sdwa v3, v165 dst_sel:WORD_1 dst_unused:UNUSED_PRESERVE src0_sel:WORD_1
  v_mfma_f32_32x32x16_f16 v[144:159], v[64:67], v[176:179], v[144:159]
  v_exp_f16_sdwa v4, v166 dst_sel:WORD_1 dst_unused:UNUSED_PRESERVE src0_sel:WORD_1
  v_exp_f16_sdwa v5, v167 dst_sel:WORD_1 dst_unused:UNUSED_PRESERVE src0_sel:WORD_1
  v_pk_add_f16 v2, v2, 1.0 op_sel_hi:[1,0]
  v_pk_add_f16 v3, v3, 1.0 op_sel_hi:[1,0]
  v_pk_add_f16 v4, v4, 1.0 op_sel_hi:[1,0]
  v_pk_add_f16 v5, v5, 1.0 op_sel_hi:[1,0]
  v_rcp_f16_sdwa v6, v2 dst_sel:WORD_0 dst_unused:UNUSED_PAD src0_sel:WORD_0
  v_mfma_f32_32x32x16_f16 v[144:159], v[68:71], v[180:183], v[144:159]
  v_rcp_f16_sdwa v7, v3 dst_sel:WORD_0 dst_unused:UNUSED_PAD src0_sel:WORD_0
  s_waitcnt vmcnt(0)
  ds_read_b128 v[216:219], v254
  ds_read_b128 v[200:203], v237
  ds_read_b128 v[204:207], v238
  v_rcp_f16_sdwa v8, v4 dst_sel:WORD_0 dst_unused:UNUSED_PAD src0_sel:WORD_0
  v_rcp_f16_sdwa v9, v5 dst_sel:WORD_0 dst_unused:UNUSED_PAD src0_sel:WORD_0
  s_waitcnt lgkmcnt(6)
  v_mfma_f32_16x16x32_f16 v[120:123], v[192:195], v[184:187], v[120:123]
  ds_read_b128 v[208:211], v239
  ds_read_b128 v[212:215], v240
  v_rcp_f16_sdwa v6, v2 dst_sel:WORD_1 dst_unused:UNUSED_PRESERVE src0_sel:WORD_1
  v_add_u32_sdwa v249, v241, v229 dst_sel:DWORD dst_unused:UNUSED_PAD src0_sel:DWORD src1_sel:BYTE_3
  ds_read_b64 v[230:231], v249 offset:480
  ds_read_b32 v232, v249 offset:736
  v_lshlrev_b32 v125, 4, v229
  v_alignbit_b32 v126, v227, v226, v125
  v_lshrrev_b32 v127, v125, v227
  v_rcp_f16_sdwa v7, v3 dst_sel:WORD_1 dst_unused:UNUSED_PRESERVE src0_sel:WORD_1
  s_waitcnt lgkmcnt(8)
  v_mfma_f32_16x16x32_f16 v[120:123], v[196:199], v[188:191], v[120:123]
  ds_read_b64 v[176:177], v249 offset:192
  ds_read_b64 v[178:179], v249 offset:128
  ds_read_b64 v[180:181], v249 offset:64
  ds_read_b32 v182, v249
  ds_read_b128 v[184:187], v248 offset:0
  v_rcp_f16_sdwa v8, v4 dst_sel:WORD_1 dst_unused:UNUSED_PRESERVE src0_sel:WORD_1
  ds_read_b128 v[220:223], v246 offset:256
  ds_read_b32 v228, v247 offset:256
  ds_read_b32 v1, v252 offset:17664
  v_rcp_f16_sdwa v9, v5 dst_sel:WORD_1 dst_unused:UNUSED_PRESERVE src0_sel:WORD_1
  v_pk_mul_f16 v164, v164, v6
  v_pk_mul_f16 v165, v165, v7
  v_pk_mul_f16 v166, v166, v8
  v_pk_mul_f16 v167, v167, v9
  ds_write_b128 v242, v[164:167] offset:16
  v_cvt_pk_f16_f32 v168, v144, v145
  v_cvt_pk_f16_f32 v169, v146, v147
  v_cvt_pk_f16_f32 v170, v148, v149
  v_cvt_pk_f16_f32 v171, v150, v151
  v_cvt_pk_f16_f32 v172, v152, v153
  v_cvt_pk_f16_f32 v173, v154, v155
  v_cvt_pk_f16_f32 v174, v156, v157
  v_cvt_pk_f16_f32 v175, v158, v159
  s_waitcnt lgkmcnt(15)
  v_mfma_f32_32x32x16_bf16 v[128:143], v[48:51], v[216:219], 0
  ds_read_b64_tr_b16 v[192:193], v244 offset:0
  ds_read_b64_tr_b16 v[194:195], v244 offset:144
  ds_read_b64_tr_b16 v[196:197], v244 offset:288
  ds_read_b64_tr_b16 v[198:199], v244 offset:432
  v_exp_f16_sdwa v2, v168 dst_sel:WORD_0 dst_unused:UNUSED_PAD src0_sel:WORD_0
  v_exp_f16_sdwa v3, v169 dst_sel:WORD_0 dst_unused:UNUSED_PAD src0_sel:WORD_0
  v_exp_f16_sdwa v4, v170 dst_sel:WORD_0 dst_unused:UNUSED_PAD src0_sel:WORD_0
  v_mfma_f32_32x32x16_bf16 v[144:159], v[52:55], v[216:219], 0
  v_lshlrev_b32 v125, 16, v126
  v_and_b32 v126, s65, v126
  v_lshlrev_b32 v127, 16, v127
  v_exp_f16_sdwa v5, v171 dst_sel:WORD_0 dst_unused:UNUSED_PAD src0_sel:WORD_0
  v_exp_f16_sdwa v2, v168 dst_sel:WORD_1 dst_unused:UNUSED_PRESERVE src0_sel:WORD_1
  s_waitcnt lgkmcnt(15)
  v_mfma_f32_32x32x16_bf16 v[128:143], v[16:19], v[200:203], v[128:143]
  v_exp_f16_sdwa v3, v169 dst_sel:WORD_1 dst_unused:UNUSED_PRESERVE src0_sel:WORD_1
  v_exp_f16_sdwa v4, v170 dst_sel:WORD_1 dst_unused:UNUSED_PRESERVE src0_sel:WORD_1
  s_waitcnt lgkmcnt(8)
  v_add_u32_sdwa v184, v243, v184 dst_sel:DWORD dst_unused:UNUSED_PAD src0_sel:DWORD src1_sel:BYTE_3
  v_add_u32_sdwa v185, v243, v185 dst_sel:DWORD dst_unused:UNUSED_PAD src0_sel:DWORD src1_sel:BYTE_3
  v_add_u32_sdwa v186, v243, v186 dst_sel:DWORD dst_unused:UNUSED_PAD src0_sel:DWORD src1_sel:BYTE_3
  v_add_u32_sdwa v187, v243, v187 dst_sel:DWORD dst_unused:UNUSED_PAD src0_sel:DWORD src1_sel:BYTE_3
  ds_read_b64_tr_b16 v[190:191], v187
  ds_read_b64_tr_b16 v[188:189], v186
  ds_read_b64_tr_b16 v[186:187], v185
  ds_read_b64_tr_b16 v[184:185], v184
  s_cmp_gt_i32 s59, 1
  s_cselect_b32 s6, 6400000, 0
  s_cselect_b32 s10, 25600000, 0
  s_cselect_b32 s14, 300000, 0
  s_add_u32 m0, s67, 118784
  s_waitcnt lgkmcnt(9)
  v_mad_u32_u24 v1, v1, 32, v253
  buffer_load_dwordx4 v1, s[8:11], 0 offen  lds
  v_exp_f16_sdwa v5, v171 dst_sel:WORD_1 dst_unused:UNUSED_PRESERVE src0_sel:WORD_1
  v_pk_add_f16 v2, v2, 1.0 op_sel_hi:[1,0]
  v_pk_add_f16 v3, v3, 1.0 op_sel_hi:[1,0]
  v_pk_add_f16 v4, v4, 1.0 op_sel_hi:[1,0]
  v_pk_add_f16 v5, v5, 1.0 op_sel_hi:[1,0]
  v_mfma_f32_32x32x16_bf16 v[128:143], v[20:23], v[204:207], v[128:143]
  v_sub_f32 v230, v230, v125
  v_sub_f32 v231, v231, v126
  v_sub_f32 v232, v232, v127
  v_cvt_pk_bf16_f32 v230, v230, v231
  v_cvt_pk_bf16_f32 v232, v232, v232
  v_lshlrev_b32 v13, 16, v230
  v_and_b32 v14, s65, v230
  v_lshlrev_b32 v15, 16, v232
  v_rcp_f16_sdwa v6, v2 dst_sel:WORD_0 dst_unused:UNUSED_PAD src0_sel:WORD_0
  v_rcp_f16_sdwa v7, v3 dst_sel:WORD_0 dst_unused:UNUSED_PAD src0_sel:WORD_0
  v_rcp_f16_sdwa v8, v4 dst_sel:WORD_0 dst_unused:UNUSED_PAD src0_sel:WORD_0
  v_mfma_f32_32x32x16_bf16 v[128:143], v[24:27], v[208:211], v[128:143]
  s_add_u32 m0, s66, 0
  v_mad_u32_u24 v220, v220, s64, v233
  buffer_load_dwordx4 v220, s[4:7], 0 offen  lds
  v_rcp_f16_sdwa v9, v5 dst_sel:WORD_0 dst_unused:UNUSED_PAD src0_sel:WORD_0
  v_rcp_f16_sdwa v6, v2 dst_sel:WORD_1 dst_unused:UNUSED_PRESERVE src0_sel:WORD_1
  v_mfma_f32_32x32x16_bf16 v[128:143], v[28:31], v[212:215], v[128:143]
  s_add_u32 m0, s66, 1024
  v_mad_u32_u24 v221, v221, s64, v234
  buffer_load_dwordx4 v221, s[4:7], 0 offen  lds
  v_rcp_f16_sdwa v7, v3 dst_sel:WORD_1 dst_unused:UNUSED_PRESERVE src0_sel:WORD_1
  v_rcp_f16_sdwa v8, v4 dst_sel:WORD_1 dst_unused:UNUSED_PRESERVE src0_sel:WORD_1
  v_mul_f32 v230, v13, v13
  v_fmac_f32 v230, v14, v14
  v_fmac_f32 v230, v15, v15
  v_cvt_pk_f16_f32 v183, v230, v230
  v_rcp_f16_sdwa v9, v5 dst_sel:WORD_1 dst_unused:UNUSED_PRESERVE src0_sel:WORD_1
  v_pk_mul_f16 v168, v168, v6
  v_pk_mul_f16 v169, v169, v7
  v_pk_mul_f16 v170, v170, v8
  v_pk_mul_f16 v171, v171, v9
  ds_write_b128 v242, v[168:171] offset:64
  v_mfma_f32_16x16x32_f16 v[124:127], v[72:75], v[160:163], 0
  s_add_u32 m0, s66, 2048
  v_mad_u32_u24 v222, v222, s64, v235
  buffer_load_dwordx4 v222, s[4:7], 0 offen  lds
  v_exp_f16_sdwa v2, v172 dst_sel:WORD_0 dst_unused:UNUSED_PAD src0_sel:WORD_0
  v_exp_f16_sdwa v3, v173 dst_sel:WORD_0 dst_unused:UNUSED_PAD src0_sel:WORD_0
  v_mfma_f32_16x16x32_f16 v[124:127], v[76:79], v[164:167], v[124:127]
  s_add_u32 m0, s66, 3072
  v_mad_u32_u24 v223, v223, s64, v236
  buffer_load_dwordx4 v223, s[4:7], 0 offen  lds
  v_exp_f16_sdwa v4, v174 dst_sel:WORD_0 dst_unused:UNUSED_PAD src0_sel:WORD_0
  v_exp_f16_sdwa v5, v175 dst_sel:WORD_0 dst_unused:UNUSED_PAD src0_sel:WORD_0
  v_mfma_f32_32x32x16_f16 v[128:143], v[56:59], v[176:179], v[128:143]
  v_exp_f16_sdwa v2, v172 dst_sel:WORD_1 dst_unused:UNUSED_PRESERVE src0_sel:WORD_1
  v_exp_f16_sdwa v3, v173 dst_sel:WORD_1 dst_unused:UNUSED_PRESERVE src0_sel:WORD_1
  v_exp_f16_sdwa v4, v174 dst_sel:WORD_1 dst_unused:UNUSED_PRESERVE src0_sel:WORD_1
  v_mfma_f32_32x32x16_f16 v[128:143], v[60:63], v[180:183], v[128:143]
  v_mul_u32_u24 v1, 6, v228
  v_and_b32 v1, -4, v1
  s_mov_b64 exec, s[74:75]
  buffer_load_dwordx2 v[224:225], v1, s[12:15], 0 offen
  s_mov_b64 exec, -1
  v_exp_f16_sdwa v5, v175 dst_sel:WORD_1 dst_unused:UNUSED_PRESERVE src0_sel:WORD_1
  v_pk_add_f16 v2, v2, 1.0 op_sel_hi:[1,0]
  v_pk_add_f16 v3, v3, 1.0 op_sel_hi:[1,0]
  v_pk_add_f16 v4, v4, 1.0 op_sel_hi:[1,0]
  v_pk_add_f16 v5, v5, 1.0 op_sel_hi:[1,0]
  v_rcp_f16_sdwa v6, v2 dst_sel:WORD_0 dst_unused:UNUSED_PAD src0_sel:WORD_0
  v_rcp_f16_sdwa v7, v3 dst_sel:WORD_0 dst_unused:UNUSED_PAD src0_sel:WORD_0
  s_waitcnt lgkmcnt(1)
  v_mfma_f32_32x32x16_f16 v[88:103], v[192:195], v[184:187], v[88:103]
  v_rcp_f16_sdwa v8, v4 dst_sel:WORD_0 dst_unused:UNUSED_PAD src0_sel:WORD_0
  v_rcp_f16_sdwa v9, v5 dst_sel:WORD_0 dst_unused:UNUSED_PAD src0_sel:WORD_0
  v_rcp_f16_sdwa v6, v2 dst_sel:WORD_1 dst_unused:UNUSED_PRESERVE src0_sel:WORD_1
  v_mfma_f32_32x32x16_f16 v[88:103], v[196:199], v[188:191], v[88:103]
  v_rcp_f16_sdwa v7, v3 dst_sel:WORD_1 dst_unused:UNUSED_PRESERVE src0_sel:WORD_1
  v_rcp_f16_sdwa v8, v4 dst_sel:WORD_1 dst_unused:UNUSED_PRESERVE src0_sel:WORD_1
  v_rcp_f16_sdwa v9, v5 dst_sel:WORD_1 dst_unused:UNUSED_PRESERVE src0_sel:WORD_1
  v_pk_mul_f16 v172, v172, v6
  v_pk_mul_f16 v173, v173, v7
  v_pk_mul_f16 v174, v174, v8
  v_pk_mul_f16 v175, v175, v9
  ds_write_b128 v242, v[172:175] offset:80
  s_sub_u32 s59, s59, 1
  s_cmp_eq_u32 s59, 0
  s_cbranch_scc1 TAIL0
  ds_read_b64_tr_b16 v[192:193], v244 offset:64
  ds_read_b64_tr_b16 v[194:195], v244 offset:208
  ds_read_b64_tr_b16 v[196:197], v244 offset:352
  ds_read_b64_tr_b16 v[198:199], v244 offset:496
  v_cvt_pk_f16_f32 v160, v128, v129
  v_cvt_pk_f16_f32 v161, v130, v131
  v_cvt_pk_f16_f32 v162, v132, v133
  v_cvt_pk_f16_f32 v163, v134, v135
  v_cvt_pk_f16_f32 v164, v136, v137
  v_cvt_pk_f16_f32 v165, v138, v139
  v_cvt_pk_f16_f32 v166, v140, v141
  v_cvt_pk_f16_f32 v167, v142, v143
  v_mfma_f32_16x16x32_f16 v[124:127], v[80:83], v[168:171], v[124:127]
  v_exp_f16_sdwa v2, v160 dst_sel:WORD_0 dst_unused:UNUSED_PAD src0_sel:WORD_0
  s_mov_b64 exec, 1
  ds_add_rtn_u32 v251, v0, v234 offset:35336
  s_mov_b64 exec, -1
  v_exp_f16_sdwa v3, v161 dst_sel:WORD_0 dst_unused:UNUSED_PAD src0_sel:WORD_0
  v_mfma_f32_16x16x32_f16 v[124:127], v[84:87], v[172:175], v[124:127]
  v_exp_f16_sdwa v4, v162 dst_sel:WORD_0 dst_unused:UNUSED_PAD src0_sel:WORD_0
  v_exp_f16_sdwa v5, v163 dst_sel:WORD_0 dst_unused:UNUSED_PAD src0_sel:WORD_0
  v_mfma_f32_32x32x16_bf16 v[144:159], v[32:35], v[200:203], v[144:159]
  v_exp_f16_sdwa v2, v160 dst_sel:WORD_1 dst_unused:UNUSED_PRESERVE src0_sel:WORD_1
  v_exp_f16_sdwa v3, v161 dst_sel:WORD_1 dst_unused:UNUSED_PRESERVE src0_sel:WORD_1
  v_exp_f16_sdwa v4, v162 dst_sel:WORD_1 dst_unused:UNUSED_PRESERVE src0_sel:WORD_1
  s_waitcnt lgkmcnt(3)
  v_mfma_f32_32x32x16_f16 v[104:119], v[192:195], v[184:187], v[104:119]
  v_exp_f16_sdwa v5, v163 dst_sel:WORD_1 dst_unused:UNUSED_PRESERVE src0_sel:WORD_1
  v_pk_add_f16 v2, v2, 1.0 op_sel_hi:[1,0]
  v_pk_add_f16 v3, v3, 1.0 op_sel_hi:[1,0]
  v_pk_add_f16 v4, v4, 1.0 op_sel_hi:[1,0]
  v_pk_add_f16 v5, v5, 1.0 op_sel_hi:[1,0]
  v_mul_f32 v230, v10, v124
  v_mul_f32 v231, v11, v124
  v_mul_f32 v232, v12, v124
  v_cvt_pk_f16_f32 v230, v230, v231
  v_cvt_pk_f16_f32 v231, v232, v232
  s_mov_b64 exec, s[74:75]
  ds_write_b64 v242, v[230:231] offset:128
  s_mov_b64 exec, -1
  v_rcp_f16_sdwa v6, v2 dst_sel:WORD_0 dst_unused:UNUSED_PAD src0_sel:WORD_0
  v_rcp_f16_sdwa v7, v3 dst_sel:WORD_0 dst_unused:UNUSED_PAD src0_sel:WORD_0
  s_waitcnt lgkmcnt(2)
  v_mfma_f32_32x32x16_f16 v[104:119], v[196:199], v[188:191], v[104:119]
  ds_read_b64_tr_b16 v[192:193], v245 offset:0
  ds_read_b64_tr_b16 v[194:195], v245 offset:144
  ds_read_b64_tr_b16 v[196:197], v245 offset:288
  ds_read_b64_tr_b16 v[198:199], v245 offset:432
  v_rcp_f16_sdwa v8, v4 dst_sel:WORD_0 dst_unused:UNUSED_PAD src0_sel:WORD_0
  s_waitcnt lgkmcnt(5)
  v_readfirstlane_b32 s68, v251
  s_setprio 2
  s_cmp_lt_i32 s68, s79
  s_cbranch_scc0 PRI1
  s_setprio 1
PRI1:
  s_add_u32 s79, s79, 128
  v_rcp_f16_sdwa v9, v5 dst_sel:WORD_0 dst_unused:UNUSED_PAD src0_sel:WORD_0
  v_rcp_f16_sdwa v6, v2 dst_sel:WORD_1 dst_unused:UNUSED_PRESERVE src0_sel:WORD_1
  v_mfma_f32_32x32x16_bf16 v[144:159], v[36:39], v[204:207], v[144:159]
  v_rcp_f16_sdwa v7, v3 dst_sel:WORD_1 dst_unused:UNUSED_PRESERVE src0_sel:WORD_1
  v_rcp_f16_sdwa v8, v4 dst_sel:WORD_1 dst_unused:UNUSED_PRESERVE src0_sel:WORD_1
  v_rcp_f16_sdwa v9, v5 dst_sel:WORD_1 dst_unused:UNUSED_PRESERVE src0_sel:WORD_1
  v_pk_mul_f16 v160, v160, v6
  v_pk_mul_f16 v161, v161, v7
  v_pk_mul_f16 v162, v162, v8
  v_pk_mul_f16 v163, v163, v9
  ds_write_b128 v242, v[160:163] offset:0
  v_mfma_f32_32x32x16_bf16 v[144:159], v[40:43], v[208:211], v[144:159]
  v_exp_f16_sdwa v2, v164 dst_sel:WORD_0 dst_unused:UNUSED_PAD src0_sel:WORD_0
  v_exp_f16_sdwa v3, v165 dst_sel:WORD_0 dst_unused:UNUSED_PAD src0_sel:WORD_0
  v_exp_f16_sdwa v4, v166 dst_sel:WORD_0 dst_unused:UNUSED_PAD src0_sel:WORD_0
  v_mfma_f32_32x32x16_bf16 v[144:159], v[44:47], v[212:215], v[144:159]
  v_exp_f16_sdwa v5, v167 dst_sel:WORD_0 dst_unused:UNUSED_PAD src0_sel:WORD_0
  v_exp_f16_sdwa v2, v164 dst_sel:WORD_1 dst_unused:UNUSED_PRESERVE src0_sel:WORD_1
  v_exp_f16_sdwa v3, v165 dst_sel:WORD_1 dst_unused:UNUSED_PRESERVE src0_sel:WORD_1
  v_mfma_f32_32x32x16_f16 v[144:159], v[64:67], v[176:179], v[144:159]
  v_exp_f16_sdwa v4, v166 dst_sel:WORD_1 dst_unused:UNUSED_PRESERVE src0_sel:WORD_1
  v_exp_f16_sdwa v5, v167 dst_sel:WORD_1 dst_unused:UNUSED_PRESERVE src0_sel:WORD_1
  v_pk_add_f16 v2, v2, 1.0 op_sel_hi:[1,0]
  v_pk_add_f16 v3, v3, 1.0 op_sel_hi:[1,0]
  v_pk_add_f16 v4, v4, 1.0 op_sel_hi:[1,0]
  v_pk_add_f16 v5, v5, 1.0 op_sel_hi:[1,0]
  v_rcp_f16_sdwa v6, v2 dst_sel:WORD_0 dst_unused:UNUSED_PAD src0_sel:WORD_0
  v_mfma_f32_32x32x16_f16 v[144:159], v[68:71], v[180:183], v[144:159]
  v_rcp_f16_sdwa v7, v3 dst_sel:WORD_0 dst_unused:UNUSED_PAD src0_sel:WORD_0
  s_waitcnt vmcnt(0)
  ds_read_b128 v[216:219], v254
  ds_read_b128 v[200:203], v237
  ds_read_b128 v[204:207], v238
  v_rcp_f16_sdwa v8, v4 dst_sel:WORD_0 dst_unused:UNUSED_PAD src0_sel:WORD_0
  v_rcp_f16_sdwa v9, v5 dst_sel:WORD_0 dst_unused:UNUSED_PAD src0_sel:WORD_0
  s_waitcnt lgkmcnt(6)
  v_mfma_f32_16x16x32_f16 v[120:123], v[192:195], v[184:187], v[120:123]
  ds_read_b128 v[208:211], v239
  ds_read_b128 v[212:215], v240
  v_rcp_f16_sdwa v6, v2 dst_sel:WORD_1 dst_unused:UNUSED_PRESERVE src0_sel:WORD_1
  v_add_u32_sdwa v249, v241, v228 dst_sel:DWORD dst_unused:UNUSED_PAD src0_sel:DWORD src1_sel:BYTE_3
  ds_read_b64 v[230:231], v249 offset:480
  ds_read_b32 v232, v249 offset:736
  v_lshlrev_b32 v125, 4, v228
  v_alignbit_b32 v126, v225, v224, v125
  v_lshrrev_b32 v127, v125, v225
  v_rcp_f16_sdwa v7, v3 dst_sel:WORD_1 dst_unused:UNUSED_PRESERVE src0_sel:WORD_1
  s_waitcnt lgkmcnt(8)
  v_mfma_f32_16x16x32_f16 v[120:123], v[196:199], v[188:191], v[120:123]
  ds_read_b64 v[176:177], v249 offset:192
  ds_read_b64 v[178:179], v249 offset:128
  ds_read_b64 v[180:181], v249 offset:64
  ds_read_b32 v182, v249
  ds_read_b128 v[184:187], v248 offset:128
  v_rcp_f16_sdwa v8, v4 dst_sel:WORD_1 dst_unused:UNUSED_PRESERVE src0_sel:WORD_1
  ds_read_b128 v[220:223], v246 offset:384
  ds_read_b32 v229, v247 offset:384
  ds_read_b32 v1, v252 offset:17792
  v_rcp_f16_sdwa v9, v5 dst_sel:WORD_1 dst_unused:UNUSED_PRESERVE src0_sel:WORD_1
  v_pk_mul_f16 v164, v164, v6
  v_pk_mul_f16 v165, v165, v7
  v_pk_mul_f16 v166, v166, v8
  v_pk_mul_f16 v167, v167, v9
  ds_write_b128 v242, v[164:167] offset:16
  v_cvt_pk_f16_f32 v168, v144, v145
  v_cvt_pk_f16_f32 v169, v146, v147
  v_cvt_pk_f16_f32 v170, v148, v149
  v_cvt_pk_f16_f32 v171, v150, v151
  v_cvt_pk_f16_f32 v172, v152, v153
  v_cvt_pk_f16_f32 v173, v154, v155
  v_cvt_pk_f16_f32 v174, v156, v157
  v_cvt_pk_f16_f32 v175, v158, v159
  s_waitcnt lgkmcnt(15)
  v_mfma_f32_32x32x16_bf16 v[128:143], v[48:51], v[216:219], 0
  ds_read_b64_tr_b16 v[192:193], v244 offset:0
  ds_read_b64_tr_b16 v[194:195], v244 offset:144
  ds_read_b64_tr_b16 v[196:197], v244 offset:288
  ds_read_b64_tr_b16 v[198:199], v244 offset:432
  v_exp_f16_sdwa v2, v168 dst_sel:WORD_0 dst_unused:UNUSED_PAD src0_sel:WORD_0
  v_exp_f16_sdwa v3, v169 dst_sel:WORD_0 dst_unused:UNUSED_PAD src0_sel:WORD_0
  v_exp_f16_sdwa v4, v170 dst_sel:WORD_0 dst_unused:UNUSED_PAD src0_sel:WORD_0
  v_mfma_f32_32x32x16_bf16 v[144:159], v[52:55], v[216:219], 0
  v_lshlrev_b32 v125, 16, v126
  v_and_b32 v126, s65, v126
  v_lshlrev_b32 v127, 16, v127
  v_exp_f16_sdwa v5, v171 dst_sel:WORD_0 dst_unused:UNUSED_PAD src0_sel:WORD_0
  v_exp_f16_sdwa v2, v168 dst_sel:WORD_1 dst_unused:UNUSED_PRESERVE src0_sel:WORD_1
  s_waitcnt lgkmcnt(15)
  v_mfma_f32_32x32x16_bf16 v[128:143], v[16:19], v[200:203], v[128:143]
  v_exp_f16_sdwa v3, v169 dst_sel:WORD_1 dst_unused:UNUSED_PRESERVE src0_sel:WORD_1
  v_exp_f16_sdwa v4, v170 dst_sel:WORD_1 dst_unused:UNUSED_PRESERVE src0_sel:WORD_1
  s_waitcnt lgkmcnt(8)
  v_add_u32_sdwa v184, v243, v184 dst_sel:DWORD dst_unused:UNUSED_PAD src0_sel:DWORD src1_sel:BYTE_3
  v_add_u32_sdwa v185, v243, v185 dst_sel:DWORD dst_unused:UNUSED_PAD src0_sel:DWORD src1_sel:BYTE_3
  v_add_u32_sdwa v186, v243, v186 dst_sel:DWORD dst_unused:UNUSED_PAD src0_sel:DWORD src1_sel:BYTE_3
  v_add_u32_sdwa v187, v243, v187 dst_sel:DWORD dst_unused:UNUSED_PAD src0_sel:DWORD src1_sel:BYTE_3
  ds_read_b64_tr_b16 v[190:191], v187
  ds_read_b64_tr_b16 v[188:189], v186
  ds_read_b64_tr_b16 v[186:187], v185
  ds_read_b64_tr_b16 v[184:185], v184
  s_cmp_gt_i32 s59, 1
  s_cselect_b32 s6, 6400000, 0
  s_cselect_b32 s10, 25600000, 0
  s_cselect_b32 s14, 300000, 0
  s_add_u32 m0, s67, 118784
  s_waitcnt lgkmcnt(9)
  v_mad_u32_u24 v1, v1, 32, v253
  buffer_load_dwordx4 v1, s[8:11], 0 offen  lds
  v_exp_f16_sdwa v5, v171 dst_sel:WORD_1 dst_unused:UNUSED_PRESERVE src0_sel:WORD_1
  v_pk_add_f16 v2, v2, 1.0 op_sel_hi:[1,0]
  v_pk_add_f16 v3, v3, 1.0 op_sel_hi:[1,0]
  v_pk_add_f16 v4, v4, 1.0 op_sel_hi:[1,0]
  v_pk_add_f16 v5, v5, 1.0 op_sel_hi:[1,0]
  v_mfma_f32_32x32x16_bf16 v[128:143], v[20:23], v[204:207], v[128:143]
  v_sub_f32 v230, v230, v125
  v_sub_f32 v231, v231, v126
  v_sub_f32 v232, v232, v127
  v_cvt_pk_bf16_f32 v230, v230, v231
  v_cvt_pk_bf16_f32 v232, v232, v232
  v_lshlrev_b32 v10, 16, v230
  v_and_b32 v11, s65, v230
  v_lshlrev_b32 v12, 16, v232
  v_rcp_f16_sdwa v6, v2 dst_sel:WORD_0 dst_unused:UNUSED_PAD src0_sel:WORD_0
  v_rcp_f16_sdwa v7, v3 dst_sel:WORD_0 dst_unused:UNUSED_PAD src0_sel:WORD_0
  v_rcp_f16_sdwa v8, v4 dst_sel:WORD_0 dst_unused:UNUSED_PAD src0_sel:WORD_0
  v_mfma_f32_32x32x16_bf16 v[128:143], v[24:27], v[208:211], v[128:143]
  s_add_u32 m0, s66, 0
  v_mad_u32_u24 v220, v220, s64, v233
  buffer_load_dwordx4 v220, s[4:7], 0 offen  lds
  v_rcp_f16_sdwa v9, v5 dst_sel:WORD_0 dst_unused:UNUSED_PAD src0_sel:WORD_0
  v_rcp_f16_sdwa v6, v2 dst_sel:WORD_1 dst_unused:UNUSED_PRESERVE src0_sel:WORD_1
  v_mfma_f32_32x32x16_bf16 v[128:143], v[28:31], v[212:215], v[128:143]
  s_add_u32 m0, s66, 1024
  v_mad_u32_u24 v221, v221, s64, v234
  buffer_load_dwordx4 v221, s[4:7], 0 offen  lds
  v_rcp_f16_sdwa v7, v3 dst_sel:WORD_1 dst_unused:UNUSED_PRESERVE src0_sel:WORD_1
  v_rcp_f16_sdwa v8, v4 dst_sel:WORD_1 dst_unused:UNUSED_PRESERVE src0_sel:WORD_1
  v_mul_f32 v230, v10, v10
  v_fmac_f32 v230, v11, v11
  v_fmac_f32 v230, v12, v12
  v_cvt_pk_f16_f32 v183, v230, v230
  v_rcp_f16_sdwa v9, v5 dst_sel:WORD_1 dst_unused:UNUSED_PRESERVE src0_sel:WORD_1
  v_pk_mul_f16 v168, v168, v6
  v_pk_mul_f16 v169, v169, v7
  v_pk_mul_f16 v170, v170, v8
  v_pk_mul_f16 v171, v171, v9
  ds_write_b128 v242, v[168:171] offset:64
  v_mfma_f32_16x16x32_f16 v[124:127], v[72:75], v[160:163], 0
  s_add_u32 m0, s66, 2048
  v_mad_u32_u24 v222, v222, s64, v235
  buffer_load_dwordx4 v222, s[4:7], 0 offen  lds
  v_exp_f16_sdwa v2, v172 dst_sel:WORD_0 dst_unused:UNUSED_PAD src0_sel:WORD_0
  v_exp_f16_sdwa v3, v173 dst_sel:WORD_0 dst_unused:UNUSED_PAD src0_sel:WORD_0
  v_mfma_f32_16x16x32_f16 v[124:127], v[76:79], v[164:167], v[124:127]
  s_add_u32 m0, s66, 3072
  v_mad_u32_u24 v223, v223, s64, v236
  buffer_load_dwordx4 v223, s[4:7], 0 offen  lds
  v_exp_f16_sdwa v4, v174 dst_sel:WORD_0 dst_unused:UNUSED_PAD src0_sel:WORD_0
  v_exp_f16_sdwa v5, v175 dst_sel:WORD_0 dst_unused:UNUSED_PAD src0_sel:WORD_0
  v_mfma_f32_32x32x16_f16 v[128:143], v[56:59], v[176:179], v[128:143]
  v_exp_f16_sdwa v2, v172 dst_sel:WORD_1 dst_unused:UNUSED_PRESERVE src0_sel:WORD_1
  v_exp_f16_sdwa v3, v173 dst_sel:WORD_1 dst_unused:UNUSED_PRESERVE src0_sel:WORD_1
  v_exp_f16_sdwa v4, v174 dst_sel:WORD_1 dst_unused:UNUSED_PRESERVE src0_sel:WORD_1
  v_mfma_f32_32x32x16_f16 v[128:143], v[60:63], v[180:183], v[128:143]
  v_mul_u32_u24 v1, 6, v229
  v_and_b32 v1, -4, v1
  s_mov_b64 exec, s[74:75]
  buffer_load_dwordx2 v[226:227], v1, s[12:15], 0 offen
  s_mov_b64 exec, -1
  v_exp_f16_sdwa v5, v175 dst_sel:WORD_1 dst_unused:UNUSED_PRESERVE src0_sel:WORD_1
  v_pk_add_f16 v2, v2, 1.0 op_sel_hi:[1,0]
  v_pk_add_f16 v3, v3, 1.0 op_sel_hi:[1,0]
  v_pk_add_f16 v4, v4, 1.0 op_sel_hi:[1,0]
  v_pk_add_f16 v5, v5, 1.0 op_sel_hi:[1,0]
  v_rcp_f16_sdwa v6, v2 dst_sel:WORD_0 dst_unused:UNUSED_PAD src0_sel:WORD_0
  v_rcp_f16_sdwa v7, v3 dst_sel:WORD_0 dst_unused:UNUSED_PAD src0_sel:WORD_0
  s_waitcnt lgkmcnt(1)
  v_mfma_f32_32x32x16_f16 v[88:103], v[192:195], v[184:187], v[88:103]
  v_rcp_f16_sdwa v8, v4 dst_sel:WORD_0 dst_unused:UNUSED_PAD src0_sel:WORD_0
  v_rcp_f16_sdwa v9, v5 dst_sel:WORD_0 dst_unused:UNUSED_PAD src0_sel:WORD_0
  v_rcp_f16_sdwa v6, v2 dst_sel:WORD_1 dst_unused:UNUSED_PRESERVE src0_sel:WORD_1
  v_mfma_f32_32x32x16_f16 v[88:103], v[196:199], v[188:191], v[88:103]
  v_rcp_f16_sdwa v7, v3 dst_sel:WORD_1 dst_unused:UNUSED_PRESERVE src0_sel:WORD_1
  v_rcp_f16_sdwa v8, v4 dst_sel:WORD_1 dst_unused:UNUSED_PRESERVE src0_sel:WORD_1
  v_rcp_f16_sdwa v9, v5 dst_sel:WORD_1 dst_unused:UNUSED_PRESERVE src0_sel:WORD_1
  v_pk_mul_f16 v172, v172, v6
  v_pk_mul_f16 v173, v173, v7
  v_pk_mul_f16 v174, v174, v8
  v_pk_mul_f16 v175, v175, v9
  ds_write_b128 v242, v[172:175] offset:80
  s_sub_u32 s59, s59, 1
  s_cmp_eq_u32 s59, 0
  v_add_u32 v246, 0x100, v246
  v_add_u32 v247, 0x100, v247
  v_add_u32 v248, 0x100, v248
  v_add_u32 v252, 0x100, v252
  s_cbranch_scc0 LOOP
  v_mov_b32 v10, v13
  v_mov_b32 v11, v14
  v_mov_b32 v12, v15
TAIL0:
  s_waitcnt lgkmcnt(0)
  ds_read_b64_tr_b16 v[192:193], v244 offset:64
  ds_read_b64_tr_b16 v[194:195], v244 offset:208
  ds_read_b64_tr_b16 v[196:197], v244 offset:352
  ds_read_b64_tr_b16 v[198:199], v244 offset:496
  v_mfma_f32_16x16x32_f16 v[124:127], v[80:83], v[168:171], v[124:127]
  v_mfma_f32_16x16x32_f16 v[124:127], v[84:87], v[172:175], v[124:127]
  s_waitcnt lgkmcnt(2)
  v_mfma_f32_32x32x16_f16 v[104:119], v[192:195], v[184:187], v[104:119]
  s_waitcnt lgkmcnt(0)
  v_mfma_f32_32x32x16_f16 v[104:119], v[196:199], v[188:191], v[104:119]
  s_nop 3
  v_mul_f32 v230, v10, v124
  v_mul_f32 v231, v11, v124
  v_mul_f32 v232, v12, v124
  v_cvt_pk_f16_f32 v230, v230, v231
  v_cvt_pk_f16_f32 v231, v232, v232
  s_mov_b64 exec, s[74:75]
  ds_write_b64 v242, v[230:231] offset:128
  s_mov_b64 exec, -1
  ds_read_b64_tr_b16 v[192:193], v245 offset:0
  ds_read_b64_tr_b16 v[194:195], v245 offset:144
  ds_read_b64_tr_b16 v[196:197], v245 offset:288
  ds_read_b64_tr_b16 v[198:199], v245 offset:432
  s_waitcnt lgkmcnt(2)
  v_mfma_f32_16x16x32_f16 v[120:123], v[192:195], v[184:187], v[120:123]
  s_waitcnt lgkmcnt(0)
  v_mfma_f32_16x16x32_f16 v[120:123], v[196:199], v[188:191], v[120:123]
LOOPEND:
  s_cmp_eq_u32 s62, 0
  s_cbranch_scc1 EPI
  s_add_u32 s61, s61, s60
  s_min_u32 s60, s60, 32
  s_waitcnt vmcnt(0)
  s_barrier
  s_branch ROUND
EPI:
  s_setprio 0
  v_and_b32 v2, 1, v0
  v_bfe_u32 v3, v0, 1, 1
  v_bfe_u32 v4, v0, 2, 2
  v_bfe_u32 v5, v0, 4, 1
  v_lshlrev_b32 v2, 6, v2
  v_lshl_add_u32 v2, v3, 3, v2
  v_lshl_add_u32 v2, v5, 4, v2
  v_lshrrev_b32 v3, 1, v4
  v_lshl_add_u32 v2, v3, 5, v2
  v_lshl_add_u32 v2, v4, 7, v2
  v_add_u32 v2, 114176, v2
  v_lshl_add_u32 v6, v250, 8, v2
  v_xor_b32 v7, 32, v6
  v_lshl_add_u32 v8, v250, 6, v2
  v_xor_b32 v9, 32, v8
  v_lshl_add_u32 v249, v0, 3, s67
  ds_read_b64 v[220:221], v249 offset:512
  ds_read_b32 v222, v249 offset:768
  ds_read_b64_tr_b16 v[16:17], v6 offset:0
  ds_read_b64_tr_b16 v[18:19], v6 offset:512
  ds_read_b64_tr_b16 v[20:21], v6 offset:1024
  ds_read_b64_tr_b16 v[22:23], v6 offset:1536
  ds_read_b64_tr_b16 v[24:25], v6 offset:2048
  ds_read_b64_tr_b16 v[26:27], v6 offset:2560
  ds_read_b64_tr_b16 v[28:29], v6 offset:3072
  ds_read_b64_tr_b16 v[30:31], v6 offset:3584
  ds_read_b64_tr_b16 v[32:33], v8 offset:8192
  ds_read_b64_tr_b16 v[34:35], v8 offset:10240
  ds_read_b64_tr_b16 v[36:37], v8 offset:8704
  ds_read_b64_tr_b16 v[38:39], v8 offset:10752
  ds_read_b64_tr_b16 v[40:41], v8 offset:12288
  ds_read_b64_tr_b16 v[42:43], v8 offset:14336
  ds_read_b64_tr_b16 v[44:45], v8 offset:12800
  ds_read_b64_tr_b16 v[46:47], v8 offset:14848
  s_mov_b32 s68, 0xbf317218
  s_mov_b32 s69, 0xbf317218
  v_pk_mul_f32 v[88:89], v[88:89], s[68:69]
  v_pk_mul_f32 v[90:91], v[90:91], s[68:69]
  v_pk_mul_f32 v[92:93], v[92:93], s[68:69]
  v_pk_mul_f32 v[94:95], v[94:95], s[68:69]
  v_pk_mul_f32 v[96:97], v[96:97], s[68:69]
  v_pk_mul_f32 v[98:99], v[98:99], s[68:69]
  v_pk_mul_f32 v[100:101], v[100:101], s[68:69]
  v_pk_mul_f32 v[102:103], v[102:103], s[68:69]
  v_pk_mul_f32 v[104:105], v[104:105], s[68:69]
  v_pk_mul_f32 v[106:107], v[106:107], s[68:69]
  v_pk_mul_f32 v[108:109], v[108:109], s[68:69]
  v_pk_mul_f32 v[110:111], v[110:111], s[68:69]
  v_pk_mul_f32 v[112:113], v[112:113], s[68:69]
  v_pk_mul_f32 v[114:115], v[114:115], s[68:69]
  v_pk_mul_f32 v[116:117], v[116:117], s[68:69]
  v_pk_mul_f32 v[118:119], v[118:119], s[68:69]
  v_pk_mul_f32 v[120:121], v[120:121], s[68:69]
  v_pk_mul_f32 v[122:123], v[122:123], s[68:69]
  s_waitcnt lgkmcnt(8)
  v_mfma_f32_32x32x16_bf16 v[128:143], v[16:19], v[200:203], 0
  v_cvt_pk_bf16_f32 v160, v88, v89
  v_cvt_pk_bf16_f32 v161, v90, v91
  v_cvt_pk_bf16_f32 v162, v92, v93
  v_cvt_pk_bf16_f32 v163, v94, v95
  v_cvt_pk_bf16_f32 v164, v96, v97
  v_mfma_f32_32x32x16_bf16 v[128:143], v[20:23], v[204:207], v[128:143]
  v_cvt_pk_bf16_f32 v165, v98, v99
  v_cvt_pk_bf16_f32 v166, v100, v101
  v_cvt_pk_bf16_f32 v167, v102, v103
  v_cvt_pk_bf16_f32 v168, v104, v105
  v_cvt_pk_bf16_f32 v169, v106, v107
  v_mfma_f32_32x32x16_bf16 v[128:143], v[24:27], v[208:211], v[128:143]
  v_cvt_pk_bf16_f32 v170, v108, v109
  v_cvt_pk_bf16_f32 v171, v110, v111
  v_cvt_pk_bf16_f32 v172, v112, v113
  v_cvt_pk_bf16_f32 v173, v114, v115
  v_cvt_pk_bf16_f32 v174, v116, v117
  v_mfma_f32_32x32x16_bf16 v[128:143], v[28:31], v[212:215], v[128:143]
  v_cvt_pk_bf16_f32 v175, v118, v119
  s_waitcnt lgkmcnt(0)
  ds_read_b64_tr_b16 v[48:49], v7 offset:0
  ds_read_b64_tr_b16 v[50:51], v7 offset:512
  ds_read_b64_tr_b16 v[52:53], v7 offset:1024
  ds_read_b64_tr_b16 v[54:55], v7 offset:1536
  ds_read_b64_tr_b16 v[56:57], v7 offset:2048
  ds_read_b64_tr_b16 v[58:59], v7 offset:2560
  ds_read_b64_tr_b16 v[60:61], v7 offset:3072
  ds_read_b64_tr_b16 v[62:63], v7 offset:3584
  ds_read_b64_tr_b16 v[64:65], v9 offset:8192
  ds_read_b64_tr_b16 v[66:67], v9 offset:10240
  ds_read_b64_tr_b16 v[68:69], v9 offset:8704
  ds_read_b64_tr_b16 v[70:71], v9 offset:10752
  ds_read_b64_tr_b16 v[72:73], v9 offset:12288
  ds_read_b64_tr_b16 v[74:75], v9 offset:14336
  ds_read_b64_tr_b16 v[76:77], v9 offset:12800
  ds_read_b64_tr_b16 v[78:79], v9 offset:14848
  v_mfma_f32_32x32x16_bf16 v[128:143], v[32:35], v[160:163], v[128:143]
  v_add_f32 v220, v220, v120
  v_add_f32 v221, v221, v121
  v_add_f32 v222, v222, v122
  v_cvt_pk_bf16_f32 v220, v220, v221
  v_cvt_pk_bf16_f32 v222, v222, v222
  v_add_u32 v230, s58, v0
  v_mfma_f32_32x32x16_bf16 v[128:143], v[36:39], v[164:167], v[128:143]
  v_mul_u32_u24 v230, 6, v230
  v_add_u32 v230, 6400000, v230
  v_lshl_add_u32 v242, v250, 1, v242
  v_lshrrev_b32 v246, 3, v0
  v_and_b32 v247, 7, v0
  s_mul_i32 s3, s57, 4608
  v_mfma_f32_32x32x16_bf16 v[128:143], v[40:43], v[168:171], v[128:143]
  s_add_u32 s3, s3, 44544
  v_mul_u32_u24 v248, 144, v246
  v_lshl_add_u32 v248, v247, 4, v248
  v_add_u32 v248, s3, v248
  s_lshl_b32 s3, s58, 7
  v_lshl_add_u32 v231, v0, 4, s3
  v_mfma_f32_32x32x16_bf16 v[128:143], v[44:47], v[172:175], v[128:143]
  s_bfe_u32 s68, s78, 0x10018
  s_mul_i32 s68, s68, 255
  s_mov_b32 s69, 0
  s_mov_b32 exec_lo, s78
  s_mov_b32 exec_hi, 0
  buffer_store_short v220, v230, s[28:31], 0 offen
  buffer_store_short_d16_hi v220, v230, s[28:31], 0 offen offset:2
  buffer_store_short v222, v230, s[28:31], 0 offen offset:4
  s_mov_b64 exec, -1
  s_waitcnt lgkmcnt(0)
  v_mfma_f32_32x32x16_bf16 v[144:159], v[48:51], v[200:203], 0
  s_nop 0
  v_pk_mul_f32 v[2:3], v[128:129], s[70:71]
  v_pk_mul_f32 v[4:5], v[130:131], s[70:71]
  v_pk_mul_f32 v[6:7], v[132:133], s[70:71]
  v_pk_mul_f32 v[8:9], v[134:135], s[70:71]
  v_exp_f32 v2, v2
  v_mfma_f32_32x32x16_bf16 v[144:159], v[52:55], v[204:207], v[144:159]
  v_exp_f32 v3, v3
  v_exp_f32 v4, v4
  v_exp_f32 v5, v5
  v_exp_f32 v6, v6
  v_exp_f32 v7, v7
  v_exp_f32 v8, v8
  v_exp_f32 v9, v9
  v_mfma_f32_32x32x16_bf16 v[144:159], v[56:59], v[208:211], v[144:159]
  v_pk_add_f32 v[2:3], v[2:3], s[72:73]
  v_pk_add_f32 v[4:5], v[4:5], s[72:73]
  v_pk_add_f32 v[6:7], v[6:7], s[72:73]
  v_pk_add_f32 v[8:9], v[8:9], s[72:73]
  v_rcp_f32 v2, v2
  v_rcp_f32 v3, v3
  v_rcp_f32 v4, v4
  v_mfma_f32_32x32x16_bf16 v[144:159], v[60:63], v[212:215], v[144:159]
  v_rcp_f32 v5, v5
  v_rcp_f32 v6, v6
  v_rcp_f32 v7, v7
  v_rcp_f32 v8, v8
  v_rcp_f32 v9, v9
  v_pk_mul_f32 v[2:3], v[2:3], v[128:129]
  v_pk_mul_f32 v[4:5], v[4:5], v[130:131]
  v_mfma_f32_32x32x16_bf16 v[144:159], v[64:67], v[160:163], v[144:159]
  v_pk_mul_f32 v[6:7], v[6:7], v[132:133]
  v_pk_mul_f32 v[8:9], v[8:9], v[134:135]
  v_cvt_pk_bf16_f32 v176, v2, v3
  v_cvt_pk_bf16_f32 v177, v4, v5
  v_cvt_pk_bf16_f32 v178, v6, v7
  v_cvt_pk_bf16_f32 v179, v8, v9
  v_lshlrev_b32 v2, 16, v176
  v_mfma_f32_32x32x16_bf16 v[144:159], v[68:71], v[164:167], v[144:159]
  v_and_b32 v3, s65, v176
  v_lshlrev_b32 v4, 16, v200
  v_and_b32 v5, s65, v200
  v_pk_add_f32 v[2:3], v[2:3], v[4:5]
  v_cvt_pk_bf16_f32 v88, v2, v3
  v_lshlrev_b32 v6, 16, v177
  v_and_b32 v7, s65, v177
  v_mfma_f32_32x32x16_bf16 v[144:159], v[72:75], v[168:171], v[144:159]
  v_lshlrev_b32 v8, 16, v201
  v_and_b32 v9, s65, v201
  v_pk_add_f32 v[6:7], v[6:7], v[8:9]
  v_cvt_pk_bf16_f32 v89, v6, v7
  v_lshlrev_b32 v2, 16, v178
  v_and_b32 v3, s65, v178
  v_lshlrev_b32 v4, 16, v202
  v_mfma_f32_32x32x16_bf16 v[144:159], v[76:79], v[172:175], v[144:159]
  v_and_b32 v5, s65, v202
  v_pk_add_f32 v[2:3], v[2:3], v[4:5]
  v_cvt_pk_bf16_f32 v90, v2, v3
  v_lshlrev_b32 v6, 16, v179
  v_and_b32 v7, s65, v179
  v_lshlrev_b32 v8, 16, v203
  v_and_b32 v9, s65, v203
  v_pk_add_f32 v[6:7], v[6:7], v[8:9]
  v_cvt_pk_bf16_f32 v91, v6, v7
  ds_write_b128 v242, v[88:91] offset:0
  v_pk_mul_f32 v[2:3], v[136:137], s[70:71]
  v_pk_mul_f32 v[4:5], v[138:139], s[70:71]
  v_pk_mul_f32 v[6:7], v[140:141], s[70:71]
  v_pk_mul_f32 v[8:9], v[142:143], s[70:71]
  v_exp_f32 v2, v2
  v_exp_f32 v3, v3
  v_exp_f32 v4, v4
  v_exp_f32 v5, v5
  v_exp_f32 v6, v6
  v_exp_f32 v7, v7
  v_exp_f32 v8, v8
  v_exp_f32 v9, v9
  v_pk_add_f32 v[2:3], v[2:3], s[72:73]
  v_pk_add_f32 v[4:5], v[4:5], s[72:73]
  v_pk_add_f32 v[6:7], v[6:7], s[72:73]
  v_pk_add_f32 v[8:9], v[8:9], s[72:73]
  v_rcp_f32 v2, v2
  v_rcp_f32 v3, v3
  v_rcp_f32 v4, v4
  v_rcp_f32 v5, v5
  v_rcp_f32 v6, v6
  v_rcp_f32 v7, v7
  v_rcp_f32 v8, v8
  v_rcp_f32 v9, v9
  v_pk_mul_f32 v[2:3], v[2:3], v[136:137]
  v_pk_mul_f32 v[4:5], v[4:5], v[138:139]
  v_pk_mul_f32 v[6:7], v[6:7], v[140:141]
  v_pk_mul_f32 v[8:9], v[8:9], v[142:143]
  v_cvt_pk_bf16_f32 v176, v2, v3
  v_cvt_pk_bf16_f32 v177, v4, v5
  v_cvt_pk_bf16_f32 v178, v6, v7
  v_cvt_pk_bf16_f32 v179, v8, v9
  v_lshlrev_b32 v2, 16, v176
  v_and_b32 v3, s65, v176
  v_lshlrev_b32 v4, 16, v204
  v_and_b32 v5, s65, v204
  v_pk_add_f32 v[2:3], v[2:3], v[4:5]
  v_cvt_pk_bf16_f32 v92, v2, v3
  v_lshlrev_b32 v6, 16, v177
  v_and_b32 v7, s65, v177
  v_lshlrev_b32 v8, 16, v205
  v_and_b32 v9, s65, v205
  v_pk_add_f32 v[6:7], v[6:7], v[8:9]
  v_cvt_pk_bf16_f32 v93, v6, v7
  v_lshlrev_b32 v2, 16, v178
  v_and_b32 v3, s65, v178
  v_lshlrev_b32 v4, 16, v206
  v_and_b32 v5, s65, v206
  v_pk_add_f32 v[2:3], v[2:3], v[4:5]
  v_cvt_pk_bf16_f32 v94, v2, v3
  v_lshlrev_b32 v6, 16, v179
  v_and_b32 v7, s65, v179
  v_lshlrev_b32 v8, 16, v207
  v_and_b32 v9, s65, v207
  v_pk_add_f32 v[6:7], v[6:7], v[8:9]
  v_cvt_pk_bf16_f32 v95, v6, v7
  ds_write_b128 v242, v[92:95] offset:16
  v_pk_mul_f32 v[2:3], v[144:145], s[70:71]
  v_pk_mul_f32 v[4:5], v[146:147], s[70:71]
  v_pk_mul_f32 v[6:7], v[148:149], s[70:71]
  v_pk_mul_f32 v[8:9], v[150:151], s[70:71]
  v_exp_f32 v2, v2
  v_exp_f32 v3, v3
  v_exp_f32 v4, v4
  v_exp_f32 v5, v5
  v_exp_f32 v6, v6
  v_exp_f32 v7, v7
  v_exp_f32 v8, v8
  v_exp_f32 v9, v9
  v_pk_add_f32 v[2:3], v[2:3], s[72:73]
  v_pk_add_f32 v[4:5], v[4:5], s[72:73]
  v_pk_add_f32 v[6:7], v[6:7], s[72:73]
  v_pk_add_f32 v[8:9], v[8:9], s[72:73]
  v_rcp_f32 v2, v2
  v_rcp_f32 v3, v3
  v_rcp_f32 v4, v4
  v_rcp_f32 v5, v5
  v_rcp_f32 v6, v6
  v_rcp_f32 v7, v7
  v_rcp_f32 v8, v8
  v_rcp_f32 v9, v9
  v_pk_mul_f32 v[2:3], v[2:3], v[144:145]
  v_pk_mul_f32 v[4:5], v[4:5], v[146:147]
  v_pk_mul_f32 v[6:7], v[6:7], v[148:149]
  v_pk_mul_f32 v[8:9], v[8:9], v[150:151]
  v_cvt_pk_bf16_f32 v176, v2, v3
  v_cvt_pk_bf16_f32 v177, v4, v5
  v_cvt_pk_bf16_f32 v178, v6, v7
  v_cvt_pk_bf16_f32 v179, v8, v9
  v_lshlrev_b32 v2, 16, v176
  v_and_b32 v3, s65, v176
  v_lshlrev_b32 v4, 16, v208
  v_and_b32 v5, s65, v208
  v_pk_add_f32 v[2:3], v[2:3], v[4:5]
  v_cvt_pk_bf16_f32 v96, v2, v3
  v_lshlrev_b32 v6, 16, v177
  v_and_b32 v7, s65, v177
  v_lshlrev_b32 v8, 16, v209
  v_and_b32 v9, s65, v209
  v_pk_add_f32 v[6:7], v[6:7], v[8:9]
  v_cvt_pk_bf16_f32 v97, v6, v7
  v_lshlrev_b32 v2, 16, v178
  v_and_b32 v3, s65, v178
  v_lshlrev_b32 v4, 16, v210
  v_and_b32 v5, s65, v210
  v_pk_add_f32 v[2:3], v[2:3], v[4:5]
  v_cvt_pk_bf16_f32 v98, v2, v3
  v_lshlrev_b32 v6, 16, v179
  v_and_b32 v7, s65, v179
  v_lshlrev_b32 v8, 16, v211
  v_and_b32 v9, s65, v211
  v_pk_add_f32 v[6:7], v[6:7], v[8:9]
  v_cvt_pk_bf16_f32 v99, v6, v7
  ds_write_b128 v242, v[96:99] offset:32
  v_pk_mul_f32 v[2:3], v[152:153], s[70:71]
  v_pk_mul_f32 v[4:5], v[154:155], s[70:71]
  v_pk_mul_f32 v[6:7], v[156:157], s[70:71]
  v_pk_mul_f32 v[8:9], v[158:159], s[70:71]
  v_exp_f32 v2, v2
  v_exp_f32 v3, v3
  v_exp_f32 v4, v4
  v_exp_f32 v5, v5
  v_exp_f32 v6, v6
  v_exp_f32 v7, v7
  v_exp_f32 v8, v8
  v_exp_f32 v9, v9
  v_pk_add_f32 v[2:3], v[2:3], s[72:73]
  v_pk_add_f32 v[4:5], v[4:5], s[72:73]
  v_pk_add_f32 v[6:7], v[6:7], s[72:73]
  v_pk_add_f32 v[8:9], v[8:9], s[72:73]
  v_rcp_f32 v2, v2
  v_rcp_f32 v3, v3
  v_rcp_f32 v4, v4
  v_rcp_f32 v5, v5
  v_rcp_f32 v6, v6
  v_rcp_f32 v7, v7
  v_rcp_f32 v8, v8
  v_rcp_f32 v9, v9
  v_pk_mul_f32 v[2:3], v[2:3], v[152:153]
  v_pk_mul_f32 v[4:5], v[4:5], v[154:155]
  v_pk_mul_f32 v[6:7], v[6:7], v[156:157]
  v_pk_mul_f32 v[8:9], v[8:9], v[158:159]
  v_cvt_pk_bf16_f32 v176, v2, v3
  v_cvt_pk_bf16_f32 v177, v4, v5
  v_cvt_pk_bf16_f32 v178, v6, v7
  v_cvt_pk_bf16_f32 v179, v8, v9
  v_lshlrev_b32 v2, 16, v176
  v_and_b32 v3, s65, v176
  v_lshlrev_b32 v4, 16, v212
  v_and_b32 v5, s65, v212
  v_pk_add_f32 v[2:3], v[2:3], v[4:5]
  v_cvt_pk_bf16_f32 v100, v2, v3
  v_lshlrev_b32 v6, 16, v177
  v_and_b32 v7, s65, v177
  v_lshlrev_b32 v8, 16, v213
  v_and_b32 v9, s65, v213
  v_pk_add_f32 v[6:7], v[6:7], v[8:9]
  v_cvt_pk_bf16_f32 v101, v6, v7
  v_lshlrev_b32 v2, 16, v178
  v_and_b32 v3, s65, v178
  v_lshlrev_b32 v4, 16, v214
  v_and_b32 v5, s65, v214
  v_pk_add_f32 v[2:3], v[2:3], v[4:5]
  v_cvt_pk_bf16_f32 v102, v2, v3
  v_lshlrev_b32 v6, 16, v179
  v_and_b32 v7, s65, v179
  v_lshlrev_b32 v8, 16, v215
  v_and_b32 v9, s65, v215
  v_pk_add_f32 v[6:7], v[6:7], v[8:9]
  v_cvt_pk_bf16_f32 v103, v6, v7
  ds_write_b128 v242, v[100:103] offset:48
  ds_read_b128 v[128:131], v248 offset:0
  ds_read_b128 v[132:135], v248 offset:1152
  ds_read_b128 v[136:139], v248 offset:2304
  ds_read_b128 v[140:143], v248 offset:3456
  s_waitcnt lgkmcnt(3)
  buffer_store_dwordx4 v[128:131], v231, s[28:31], 0 offen offset:0 sc1
  s_waitcnt lgkmcnt(2)
  buffer_store_dwordx4 v[132:135], v231, s[28:31], 0 offen offset:1024 sc1
  s_waitcnt lgkmcnt(1)
  buffer_store_dwordx4 v[136:139], v231, s[28:31], 0 offen offset:2048 sc1
  s_waitcnt lgkmcnt(0)
  s_cmp_eq_u32 s68, 0
  s_cbranch_scc1 NO25
  s_mov_b64 exec, s[68:69]
  buffer_store_dwordx4 v[140:143], v231, s[28:31], 0 offen offset:3072 sc1
  s_mov_b64 exec, -1
NO25:
K2END:
  s_endpgm
.section .rodata,"a"
.p2align 6
.amdhsa_kernel part_kernel
  .amdhsa_next_free_vgpr 80
  .amdhsa_next_free_sgpr 102
  .amdhsa_accum_offset 80
  .amdhsa_group_segment_fixed_size 0
  .amdhsa_kernarg_size 88
  .amdhsa_user_sgpr_count 2
  .amdhsa_user_sgpr_kernarg_segment_ptr 1
  .amdhsa_system_sgpr_workgroup_id_x 1
.end_amdhsa_kernel
.p2align 6
.amdhsa_kernel main_kernel
  .amdhsa_next_free_vgpr 256
  .amdhsa_next_free_sgpr 102
  .amdhsa_accum_offset 256
  .amdhsa_group_segment_fixed_size 0
  .amdhsa_kernarg_size 88
  .amdhsa_user_sgpr_count 2
  .amdhsa_user_sgpr_kernarg_segment_ptr 1
  .amdhsa_system_sgpr_workgroup_id_x 1
.end_amdhsa_kernel
```

```asm
; @launch kernel=part_kernel grid=(251,1,1) block=(640,1,1) lds=93312
; @launch kernel=main_kernel grid=(256,1,1) block=(512,1,1) lds=163328
.amdgcn_target "amdgcn-amd-amdhsa--gfx950"
.text
.globl part_kernel
.p2align 8
.type part_kernel,@function
part_kernel:
  s_cmp_gt_u32 s2, 250
  s_cbranch_scc1 K1END
  s_load_dwordx2 s[8:9], s[0:1], 80
  s_sub_u32 s2, s2, 1
  s_cbranch_scc1 WPREP
  s_load_dwordx4 s[4:7], s[0:1], 24
  s_load_dwordx2 s[32:33], s[0:1], 16
  s_mul_i32 s3, s2, 12800
  v_lshlrev_b32 v2, 4, v0
  v_lshlrev_b32 v3, 2, v0
  v_add_u32 v3, 10240, v3
  v_and_b32 v1, 255, v0
  v_lshlrev_b32 v1, 2, v1
  v_mov_b32 v20, 0
  v_mov_b32 v21, 0
  v_mov_b32 v22, 0
  v_mov_b32 v23, 0
  s_waitcnt lgkmcnt(0)
  s_mov_b32 s12, s4
  s_mov_b32 s13, s5
  s_mov_b32 s14, 3200000
  s_mov_b32 s15, 0x20000
  s_mov_b32 s16, s6
  s_mov_b32 s17, s7
  s_mov_b32 s18, 3200000
  s_mov_b32 s19, 0x20000
  buffer_load_dwordx4 v[4:7], v2, s[16:19], s3 offen
  buffer_load_dword v8, v3, s[16:19], s3 offen
  buffer_load_dwordx4 v[12:15], v2, s[12:15], s3 offen
  buffer_load_dword v16, v3, s[12:15], s3 offen
  ds_write_b32 v1, v20 offset:58368
  ds_write_b32 v20, v20 offset:60416
  ds_write_b128 v2, v[20:23] offset:0
  ds_write_b128 v2, v[20:23] offset:10240
  ds_write_b128 v2, v[20:23] offset:20480
  ds_write_b128 v2, v[20:23] offset:30720
  s_mov_b32 s20, s8
  s_mov_b32 s21, s9
  s_mov_b32 s22, 8388608
  s_mov_b32 s23, 0x20000
  s_add_u32 s24, s8, 8388488
  s_addc_u32 s25, s9, 0
  s_mov_b32 s26, 14592120
  s_mov_b32 s27, 0x20000
  s_mov_b32 s28, 175921861
  s_movk_i32 s29, 3125
  s_mul_i32 s30, s2, 3200
  s_or_b32 s30, s30, 0x80000000
  v_mov_b32 v50, 1
  v_mov_b32 v49, 127
  v_lshl_add_u32 v51, v0, 2, s30
  s_add_u32 s30, s30, 2560
  v_add_u32 v52, s30, v0
  v_readfirstlane_b32 s31, v0
  v_lshrrev_b32 v55, 3, v0
  v_lshlrev_b32 v55, 2, v55
  v_add_u32 v55, 58368, v55
  v_add_u32 v60, 60544, v2
  v_and_b32 v61, 0, v0
  v_lshl_add_u32 v61, v61, 1, 15
  s_waitcnt lgkmcnt(0)
  s_barrier
  s_waitcnt vmcnt(2)
  v_mul_hi_u32 v37, s28, v4
  v_lshrrev_b32 v20, 1, v37
  v_and_b32 v20, 0x3fc, v20
  ds_add_rtn_u32 v28, v20, v50 offset:58368
  v_mul_hi_u32 v39, s28, v5
  v_lshrrev_b32 v21, 1, v39
  v_and_b32 v21, 0x3fc, v21
  ds_add_rtn_u32 v29, v21, v50 offset:58368
  v_mul_hi_u32 v41, s28, v6
  v_lshrrev_b32 v22, 1, v41
  v_and_b32 v22, 0x3fc, v22
  ds_add_rtn_u32 v30, v22, v50 offset:58368
  v_mul_hi_u32 v43, s28, v7
  v_lshrrev_b32 v23, 1, v43
  v_and_b32 v23, 0x3fc, v23
  ds_add_rtn_u32 v31, v23, v50 offset:58368
  v_mul_hi_u32 v45, s28, v8
  v_lshrrev_b32 v24, 1, v45
  v_and_b32 v24, 0x3fc, v24
  ds_add_rtn_u32 v32, v24, v50 offset:58368
  v_mad_u32_u24 v36, v37, s29, v49
  v_lshrrev_b32 v36, 7, v36
  v_sub_u32 v4, v4, v36
  v_and_b32 v37, 7, v37
  v_mad_u32_u24 v38, v39, s29, v49
  v_lshrrev_b32 v38, 7, v38
  v_sub_u32 v5, v5, v38
  v_and_b32 v39, 7, v39
  v_mad_u32_u24 v40, v41, s29, v49
  v_lshrrev_b32 v40, 7, v40
  v_sub_u32 v6, v6, v40
  v_and_b32 v41, 7, v41
  v_mad_u32_u24 v42, v43, s29, v49
  v_lshrrev_b32 v42, 7, v42
  v_sub_u32 v7, v7, v42
  v_and_b32 v43, 7, v43
  v_mad_u32_u24 v44, v45, s29, v49
  v_lshrrev_b32 v44, 7, v44
  v_sub_u32 v8, v8, v44
  v_and_b32 v45, 7, v45
  s_waitcnt vmcnt(0)
  v_lshl_or_b32 v36, v4, 27, v12
  v_lshrrev_b32 v12, 12, v12
  v_lshl_or_b32 v37, v37, 4, v12
  v_lshl_or_b32 v37, v37, 24, v51
  v_lshl_or_b32 v38, v5, 27, v13
  v_lshrrev_b32 v13, 12, v13
  v_lshl_or_b32 v39, v39, 4, v13
  v_add_u32 v51, 1, v51
  v_lshl_or_b32 v39, v39, 24, v51
  v_lshl_or_b32 v40, v6, 27, v14
  v_lshrrev_b32 v14, 12, v14
  v_lshl_or_b32 v41, v41, 4, v14
  v_add_u32 v51, 1, v51
  v_lshl_or_b32 v41, v41, 24, v51
  v_lshl_or_b32 v42, v7, 27, v15
  v_lshrrev_b32 v15, 12, v15
  v_lshl_or_b32 v43, v43, 4, v15
  v_add_u32 v51, 1, v51
  v_lshl_or_b32 v43, v43, 24, v51
  v_lshl_or_b32 v44, v8, 27, v16
  v_lshrrev_b32 v16, 12, v16
  v_lshl_or_b32 v45, v45, 4, v16
  v_lshl_or_b32 v45, v45, 24, v52
  v_lshrrev_b32 v3, 3, v0
  s_movk_i32 s3, 128
  v_mul_u32_u24 v3, s3, v3
  v_and_b32 v1, 7, v0
  v_lshl_add_u32 v3, v1, 4, v3
  s_mul_i32 s3, s2, 32896
  s_add_u32 s4, s3, 10240
  s_add_u32 s5, s3, 20480
  s_add_u32 s6, s3, 30720
  s_mul_i32 s7, s2, 58368
  s_mov_b32 s33, 0
  s_mov_b32 s34, 0xfff20000
  v_mov_b32 v1, 60416
  v_lshlrev_b32 v4, 5, v20
  v_lshlrev_b32 v5, 5, v21
  v_lshlrev_b32 v6, 5, v22
  v_lshlrev_b32 v7, 5, v23
  v_lshlrev_b32 v8, 5, v24
  s_waitcnt lgkmcnt(4)
  v_cmp_gt_u32 s[40:41], 15, v28
  v_lshl_add_u32 v12, v28, 3, v4
  s_waitcnt lgkmcnt(3)
  v_cmp_gt_u32 s[42:43], 15, v29
  v_lshl_add_u32 v13, v29, 3, v5
  s_waitcnt lgkmcnt(2)
  v_cmp_gt_u32 s[44:45], 15, v30
  v_lshl_add_u32 v14, v30, 3, v6
  s_waitcnt lgkmcnt(1)
  v_cmp_gt_u32 s[46:47], 15, v31
  v_lshl_add_u32 v15, v31, 3, v7
  s_waitcnt lgkmcnt(0)
  v_cmp_gt_u32 s[48:49], 15, v32
  v_lshl_add_u32 v16, v32, 3, v8
  v_max3_u32 v48, v28, v29, v30
  v_max3_u32 v48, v48, v31, v32
  v_cmp_le_u32 s[50:51], 31, v48
  s_mov_b64 exec, s[40:41]
  ds_write_b64 v12, v[36:37]
  s_mov_b64 exec, s[42:43]
  ds_write_b64 v13, v[38:39]
  s_mov_b64 exec, s[44:45]
  ds_write_b64 v14, v[40:41]
  s_mov_b64 exec, s[46:47]
  ds_write_b64 v15, v[42:43]
  s_mov_b64 exec, s[48:49]
  ds_write_b64 v16, v[44:45]
  s_not_b64 exec, s[40:41]
  s_cbranch_scc0 K1N0
  v_lshl_add_u32 v48, v20, 2, s34
  v_lshl_add_u32 v48, v28, 16, v48
  ds_max_u32 v4, v48 offset:120
  v_cmpx_gt_u32 vcc, 31, v28
  ds_write_b64 v12, v[36:37] offset:60424
K1N0:
  s_not_b64 exec, s[42:43]
  s_cbranch_scc0 K1N1
  v_lshl_add_u32 v48, v21, 2, s34
  v_lshl_add_u32 v48, v29, 16, v48
  ds_max_u32 v5, v48 offset:120
  v_cmpx_gt_u32 vcc, 31, v29
  ds_write_b64 v13, v[38:39] offset:60424
K1N1:
  s_not_b64 exec, s[44:45]
  s_cbranch_scc0 K1N2
  v_lshl_add_u32 v48, v22, 2, s34
  v_lshl_add_u32 v48, v30, 16, v48
  ds_max_u32 v6, v48 offset:120
  v_cmpx_gt_u32 vcc, 31, v30
  ds_write_b64 v14, v[40:41] offset:60424
K1N2:
  s_not_b64 exec, s[46:47]
  s_cbranch_scc0 K1N3
  v_lshl_add_u32 v48, v23, 2, s34
  v_lshl_add_u32 v48, v31, 16, v48
  ds_max_u32 v7, v48 offset:120
  v_cmpx_gt_u32 vcc, 31, v31
  ds_write_b64 v15, v[42:43] offset:60424
K1N3:
  s_not_b64 exec, s[48:49]
  s_cbranch_scc0 K1N4
  v_lshl_add_u32 v48, v24, 2, s34
  v_lshl_add_u32 v48, v32, 16, v48
  ds_max_u32 v8, v48 offset:120
  v_cmpx_gt_u32 vcc, 31, v32
  ds_write_b64 v16, v[44:45] offset:60424
K1N4:
  s_mov_b64 exec, s[50:51]
  ds_write_b32 v1, v50
  s_mov_b64 exec, -1
  s_waitcnt lgkmcnt(0)
  s_barrier
  ds_read_b32 v48, v1
  ds_read2_b32 v[56:57], v55 offset0:0 offset1:80
  ds_read2_b32 v[58:59], v55 offset0:160 offset1:240
K1RD:
  ds_read_b128 v[4:7], v2
  ds_read_b128 v[8:11], v2 offset:10240
  ds_read_b128 v[12:15], v2 offset:20480
  ds_read_b128 v[16:19], v2 offset:30720
  s_waitcnt lgkmcnt(3)
  v_cmp_ne_u32 vcc, 0, v48
  s_cbranch_vccnz K1SLOW
  v_cmp_lt_u32 s[40:41], v61, v56
  v_cmp_lt_u32 s[42:43], v61, v57
  v_cmp_lt_u32 s[44:45], v61, v58
  s_mov_b64 exec, s[40:41]
  ds_read_b128 v[64:67], v60
  s_mov_b64 exec, s[42:43]
  ds_read_b128 v[68:71], v60 offset:10240
  s_mov_b64 exec, s[44:45]
  ds_read_b128 v[72:75], v60 offset:20480
  s_mov_b64 exec, -1
  buffer_store_dwordx4 v[4:7], v3, s[20:23], s3 offen sc1
  s_waitcnt lgkmcnt(5)
  buffer_store_dwordx4 v[8:11], v3, s[20:23], s4 offen sc1
  s_waitcnt lgkmcnt(4)
  buffer_store_dwordx4 v[12:15], v3, s[20:23], s5 offen sc1
  s_add_u32 s4, s7, 10240
  s_add_u32 s5, s7, 20480
  s_mov_b64 exec, s[40:41]
  s_waitcnt lgkmcnt(2)
  buffer_store_dwordx4 v[64:67], v2, s[24:27], s7 offen offset:120 sc1
  s_mov_b64 exec, s[42:43]
  s_waitcnt lgkmcnt(1)
  buffer_store_dwordx4 v[68:71], v2, s[24:27], s4 offen offset:120 sc1
  s_mov_b64 exec, s[44:45]
  s_waitcnt lgkmcnt(0)
  buffer_store_dwordx4 v[72:75], v2, s[24:27], s5 offen offset:120 sc1
  s_mov_b64 exec, -1
  s_add_u32 s5, s7, 30720
  s_add_u32 s7, s7, 32888
  s_cmp_ge_u32 s31, 128
  s_cbranch_scc1 K1OV
  ds_read_b128 v[76:79], v60 offset:30720
  buffer_store_dwordx4 v[16:19], v3, s[20:23], s6 offen sc1
  v_cmpx_lt_u32 vcc, v61, v59
  s_waitcnt lgkmcnt(0)
  buffer_store_dwordx4 v[76:79], v2, s[24:27], s5 offen offset:120 sc1
  s_mov_b64 exec, -1
K1OV:
  v_cmpx_gt_u32 vcc, s33, v2
  s_cbranch_execz K1FIN
  ds_read_b128 v[20:23], v2 offset:32768
  s_waitcnt lgkmcnt(0)
  buffer_store_dwordx4 v[20:23], v2, s[24:27], s7 offen sc1
  v_add_u32 v2, 10240, v2
  s_waitcnt vmcnt(0)
  s_branch K1OV
K1FIN:
K1END:
  s_endpgm
K1SLOW:
  v_and_b32 v1, 63, v0
  v_lshlrev_b32 v53, 9, v1
  v_lshlrev_b32 v1, 4, v1
  v_mov_b32 v48, 0xffff0000
  v_mov_b32 v49, 0xf0ff1
  s_waitcnt lgkmcnt(0)
  ds_read_b128 v[4:7], v1 offset:58368
  s_waitcnt lgkmcnt(0)
  v_cmp_lt_u32 s[40:41], 31, v4
  v_subrev_u32 v4, 15, v4
  v_cmp_lt_u32 s[42:43], 31, v5
  v_subrev_u32 v5, 15, v5
  v_cmp_lt_u32 s[44:45], 31, v6
  v_subrev_u32 v6, 15, v6
  v_cmp_lt_u32 s[46:47], 31, v7
  v_subrev_u32 v7, 15, v7
  v_cndmask_b32 v4, 0, v4, s[40:41]
  v_cndmask_b32 v5, 0, v5, s[42:43]
  v_cndmask_b32 v6, 0, v6, s[44:45]
  v_cndmask_b32 v7, 0, v7, s[46:47]
  v_add_u32 v8, v4, v5
  v_add_u32 v9, v8, v6
  v_add_u32 v10, v9, v7
  v_mov_b32 v11, v10
  s_nop 1
  v_add_u32_dpp v11, v11, v11 row_shr:1 row_mask:0xf bank_mask:0xf
  s_nop 1
  v_add_u32_dpp v11, v11, v11 row_shr:2 row_mask:0xf bank_mask:0xf
  s_nop 1
  v_add_u32_dpp v11, v11, v11 row_shr:4 row_mask:0xf bank_mask:0xf
  s_nop 1
  v_add_u32_dpp v11, v11, v11 row_shr:8 row_mask:0xf bank_mask:0xf
  s_nop 1
  v_add_u32_dpp v11, v11, v11 row_bcast:15 row_mask:0xa bank_mask:0xf
  s_nop 1
  v_add_u32_dpp v11, v11, v11 row_bcast:31 row_mask:0xc bank_mask:0xf
  v_cndmask_b32 v16, v48, v49, s[40:41]
  v_cndmask_b32 v17, v48, v49, s[42:43]
  v_cndmask_b32 v18, v48, v49, s[44:45]
  v_cndmask_b32 v19, v48, v49, s[46:47]
  v_sub_u32 v12, v11, v10
  v_add_u32 v13, v12, v4
  v_add_u32 v14, v12, v8
  v_add_u32 v15, v12, v9
  v_readlane_b32 s33, v11, 63
  v_add_u32 v16, v16, v12
  v_add_u32 v17, v17, v13
  v_add_u32 v18, v18, v14
  v_add_u32 v19, v19, v15
  ds_write_b128 v1, v[16:19] offset:59392
  ds_read_b32 v20, v20 offset:59392
  ds_read_b32 v21, v21 offset:59392
  ds_read_b32 v22, v22 offset:59392
  ds_read_b32 v23, v23 offset:59392
  ds_read_b32 v24, v24 offset:59392
  v_lshl_or_b32 v4, v4, 16, v12
  v_add_u32 v4, 4096, v4
  s_mov_b64 exec, s[40:41]
  ds_write_b32 v53, v4 offset:120
  s_mov_b64 exec, -1
  v_lshl_or_b32 v5, v5, 16, v13
  v_add_u32 v5, 4096, v5
  s_mov_b64 exec, s[42:43]
  ds_write_b32 v53, v5 offset:248
  s_mov_b64 exec, -1
  v_lshl_or_b32 v6, v6, 16, v14
  v_add_u32 v6, 4096, v6
  s_mov_b64 exec, s[44:45]
  ds_write_b32 v53, v6 offset:376
  s_mov_b64 exec, -1
  v_lshl_or_b32 v7, v7, 16, v15
  v_add_u32 v7, 4096, v7
  s_mov_b64 exec, s[46:47]
  ds_write_b32 v53, v7 offset:504
  s_mov_b64 exec, -1
  s_waitcnt lgkmcnt(0)
  v_cmp_ge_u32_sdwa vcc, v28, v20 src0_sel:DWORD src1_sel:WORD_1
  v_and_b32 v20, 0xffff, v20
  v_add_lshl_u32 v20, v20, v28, 3
  s_mov_b64 exec, vcc
  ds_write_b64 v20, v[36:37]
  s_mov_b64 exec, -1
  v_cmp_ge_u32_sdwa vcc, v29, v21 src0_sel:DWORD src1_sel:WORD_1
  v_and_b32 v21, 0xffff, v21
  v_add_lshl_u32 v21, v21, v29, 3
  s_mov_b64 exec, vcc
  ds_write_b64 v21, v[38:39]
  s_mov_b64 exec, -1
  v_cmp_ge_u32_sdwa vcc, v30, v22 src0_sel:DWORD src1_sel:WORD_1
  v_and_b32 v22, 0xffff, v22
  v_add_lshl_u32 v22, v22, v30, 3
  s_mov_b64 exec, vcc
  ds_write_b64 v22, v[40:41]
  s_mov_b64 exec, -1
  v_cmp_ge_u32_sdwa vcc, v31, v23 src0_sel:DWORD src1_sel:WORD_1
  v_and_b32 v23, 0xffff, v23
  v_add_lshl_u32 v23, v23, v31, 3
  s_mov_b64 exec, vcc
  ds_write_b64 v23, v[42:43]
  s_mov_b64 exec, -1
  v_cmp_ge_u32_sdwa vcc, v32, v24 src0_sel:DWORD src1_sel:WORD_1
  v_and_b32 v24, 0xffff, v24
  v_add_lshl_u32 v24, v24, v32, 3
  s_mov_b64 exec, vcc
  ds_write_b64 v24, v[44:45]
  s_mov_b64 exec, -1
  s_lshl_b32 s33, s33, 3
  v_mov_b32 v48, 0
  s_waitcnt lgkmcnt(0)
  s_barrier
  s_branch K1RD
WPREP:
  s_load_dwordx4 s[4:7], s[0:1], 40
  v_lshrrev_b32 v2, 6, v0
  v_and_b32 v1, 63, v0
  v_readfirstlane_b32 s31, v2
  s_mov_b32 s28, 0xbfb8aa3b
  s_mov_b32 s29, 0xbfb8aa3b
  s_mov_b32 s30, 0xffff0000
  s_waitcnt lgkmcnt(0)
  s_mov_b32 s12, s4
  s_mov_b32 s13, s5
  s_mov_b32 s14, 18560
  s_mov_b32 s15, 0x20000
  s_mov_b32 s16, s6
  s_mov_b32 s17, s7
  s_mov_b32 s18, 128
  s_mov_b32 s19, 0x20000
  s_add_u32 s20, s8, 23068672
  s_addc_u32 s21, s9, 0
  s_mov_b32 s22, 24576
  s_mov_b32 s23, 0x20000
  v_and_b32 v2, 7, v1
  v_bfe_u32 v3, v1, 4, 1
  v_lshlrev_b32 v4, 2, v3
  v_xor_b32 v4, v4, v2
  v_lshlrev_b32 v4, 4, v4
  v_lshrrev_b32 v5, 3, v1
  v_lshl_or_b32 v4, v5, 7, v4
  s_lshl_b32 s3, s31, 10
  s_add_u32 s4, s3, 10240
  v_add_u32 v4, s3, v4
  s_mov_b32 m0, s3
  s_nop 0
  buffer_load_dwordx4 v4, s[12:15], 0 offen lds
  v_add_u32 v4, 10240, v4
  s_mov_b32 m0, s4
  s_nop 0
  buffer_load_dwordx4 v4, s[12:15], 0 offen lds
  v_lshrrev_b32 v5, 5, v1
  v_lshlrev_b32 v7, 3, v5
  buffer_load_dwordx2 v[28:29], v7, s[16:19], 0 offen offset:0
  buffer_load_dwordx2 v[30:31], v7, s[16:19], 0 offen offset:16
  buffer_load_dwordx2 v[32:33], v7, s[16:19], 0 offen offset:32
  buffer_load_dwordx2 v[34:35], v7, s[16:19], 0 offen offset:48
  buffer_load_dwordx2 v[36:37], v7, s[16:19], 0 offen offset:64
  buffer_load_dwordx2 v[38:39], v7, s[16:19], 0 offen offset:80
  buffer_load_dwordx2 v[40:41], v7, s[16:19], 0 offen offset:96
  buffer_load_dwordx2 v[42:43], v7, s[16:19], 0 offen offset:112
  v_and_b32 v2, 3, v1
  v_bfe_u32 v4, v1, 2, 2
  v_lshlrev_b32 v2, 3, v2
  v_lshl_add_u32 v2, v3, 5, v2
  v_lshl_add_u32 v2, v4, 7, v2
  v_lshl_add_u32 v6, v5, 12, v2
  v_lshrrev_b32 v3, 1, v4
  v_lshl_add_u32 v6, v3, 6, v6
  v_lshl_add_u32 v8, v5, 10, v2
  v_add_u32 v3, 1, v4
  v_bfe_u32 v3, v3, 1, 1
  v_lshl_add_u32 v8, v3, 6, v8
  v_xor_b32 v9, 64, v8
  s_and_b32 s3, s31, 1
  s_lshl_b32 s3, s3, 6
  v_xor_b32 v6, s3, v6
  s_lshr_b32 s3, s31, 1
  s_lshl_b32 s3, s3, 13
  v_add_u32 v6, s3, v6
  v_lshlrev_b32 v10, 4, v1
  s_lshl_b32 s3, s31, 12
  s_mov_b64 exec, 0
WPGO:
  s_cmp_eq_u32 s31, 4
  s_cbranch_scc1 WP4
  s_cmp_eq_u32 s31, 5
  s_cbranch_scc1 WP5
  s_cmp_gt_u32 s31, 5
  s_cbranch_scc1 WPEND
  ds_read_b64_tr_b16 v[12:13], v6 offset:0
  ds_read_b64_tr_b16 v[14:15], v6 offset:512
  ds_read_b64_tr_b16 v[16:17], v6 offset:1024
  ds_read_b64_tr_b16 v[18:19], v6 offset:1536
  ds_read_b64_tr_b16 v[20:21], v6 offset:2048
  ds_read_b64_tr_b16 v[22:23], v6 offset:2560
  ds_read_b64_tr_b16 v[24:25], v6 offset:3072
  ds_read_b64_tr_b16 v[26:27], v6 offset:3584
  s_waitcnt lgkmcnt(0)
  s_cmp_lt_u32 s31, 2
  s_cbranch_scc1 WPST
  v_lshlrev_b32 v2, 16, v12
  v_and_b32 v3, s30, v12
  v_pk_mul_f32 v[2:3], v[2:3], s[28:29]
  v_cvt_pk_bf16_f32 v12, v2, v3
  v_lshlrev_b32 v2, 16, v13
  v_and_b32 v3, s30, v13
  v_pk_mul_f32 v[2:3], v[2:3], s[28:29]
  v_cvt_pk_bf16_f32 v13, v2, v3
  v_lshlrev_b32 v2, 16, v14
  v_and_b32 v3, s30, v14
  v_pk_mul_f32 v[2:3], v[2:3], s[28:29]
  v_cvt_pk_bf16_f32 v14, v2, v3
  v_lshlrev_b32 v2, 16, v15
  v_and_b32 v3, s30, v15
  v_pk_mul_f32 v[2:3], v[2:3], s[28:29]
  v_cvt_pk_bf16_f32 v15, v2, v3
  v_lshlrev_b32 v2, 16, v16
  v_and_b32 v3, s30, v16
  v_pk_mul_f32 v[2:3], v[2:3], s[28:29]
  v_cvt_pk_bf16_f32 v16, v2, v3
  v_lshlrev_b32 v2, 16, v17
  v_and_b32 v3, s30, v17
  v_pk_mul_f32 v[2:3], v[2:3], s[28:29]
  v_cvt_pk_bf16_f32 v17, v2, v3
  v_lshlrev_b32 v2, 16, v18
  v_and_b32 v3, s30, v18
  v_pk_mul_f32 v[2:3], v[2:3], s[28:29]
  v_cvt_pk_bf16_f32 v18, v2, v3
  v_lshlrev_b32 v2, 16, v19
  v_and_b32 v3, s30, v19
  v_pk_mul_f32 v[2:3], v[2:3], s[28:29]
  v_cvt_pk_bf16_f32 v19, v2, v3
  v_lshlrev_b32 v2, 16, v20
  v_and_b32 v3, s30, v20
  v_pk_mul_f32 v[2:3], v[2:3], s[28:29]
  v_cvt_pk_bf16_f32 v20, v2, v3
  v_lshlrev_b32 v2, 16, v21
  v_and_b32 v3, s30, v21
  v_pk_mul_f32 v[2:3], v[2:3], s[28:29]
  v_cvt_pk_bf16_f32 v21, v2, v3
  v_lshlrev_b32 v2, 16, v22
  v_and_b32 v3, s30, v22
  v_pk_mul_f32 v[2:3], v[2:3], s[28:29]
  v_cvt_pk_bf16_f32 v22, v2, v3
  v_lshlrev_b32 v2, 16, v23
  v_and_b32 v3, s30, v23
  v_pk_mul_f32 v[2:3], v[2:3], s[28:29]
  v_cvt_pk_bf16_f32 v23, v2, v3
  v_lshlrev_b32 v2, 16, v24
  v_and_b32 v3, s30, v24
  v_pk_mul_f32 v[2:3], v[2:3], s[28:29]
  v_cvt_pk_bf16_f32 v24, v2, v3
  v_lshlrev_b32 v2, 16, v25
  v_and_b32 v3, s30, v25
  v_pk_mul_f32 v[2:3], v[2:3], s[28:29]
  v_cvt_pk_bf16_f32 v25, v2, v3
  v_lshlrev_b32 v2, 16, v26
  v_and_b32 v3, s30, v26
  v_pk_mul_f32 v[2:3], v[2:3], s[28:29]
  v_cvt_pk_bf16_f32 v26, v2, v3
  v_lshlrev_b32 v2, 16, v27
  v_and_b32 v3, s30, v27
  v_pk_mul_f32 v[2:3], v[2:3], s[28:29]
  v_cvt_pk_bf16_f32 v27, v2, v3
WPST:
  buffer_store_dwordx4 v[12:15], v10, s[20:23], s3 offen offset:0
  buffer_store_dwordx4 v[16:19], v10, s[20:23], s3 offen offset:1024
  buffer_store_dwordx4 v[20:23], v10, s[20:23], s3 offen offset:2048
  buffer_store_dwordx4 v[24:27], v10, s[20:23], s3 offen offset:3072
  s_branch WPEND
WP4:
  ds_read_b64_tr_b16 v[12:13], v8 offset:16512
  ds_read_b64_tr_b16 v[14:15], v8 offset:17024
  ds_read_b64_tr_b16 v[16:17], v9 offset:16512
  ds_read_b64_tr_b16 v[18:19], v9 offset:17024
  v_and_b32 v2, 31, v1
  v_lshlrev_b32 v2, 1, v2
  ds_read_u16 v20, v2 offset:16384
  ds_read_u16 v21, v2 offset:16448
  v_subrev_u32 v5, 1, v5
  s_waitcnt lgkmcnt(0)
  v_lshlrev_b32 v2, 16, v12
  v_and_b32 v3, s30, v12
  v_pk_mul_f32 v[2:3], v[2:3], s[28:29]
  v_cvt_pk_bf16_f32 v12, v2, v3
  v_lshlrev_b32 v2, 16, v13
  v_and_b32 v3, s30, v13
  v_pk_mul_f32 v[2:3], v[2:3], s[28:29]
  v_cvt_pk_bf16_f32 v13, v2, v3
  v_lshlrev_b32 v2, 16, v14
  v_and_b32 v3, s30, v14
  v_pk_mul_f32 v[2:3], v[2:3], s[28:29]
  v_cvt_pk_bf16_f32 v14, v2, v3
  v_lshlrev_b32 v2, 16, v15
  v_and_b32 v3, s30, v15
  v_pk_mul_f32 v[2:3], v[2:3], s[28:29]
  v_cvt_pk_bf16_f32 v15, v2, v3
  v_lshlrev_b32 v2, 16, v16
  v_and_b32 v3, s30, v16
  v_pk_mul_f32 v[2:3], v[2:3], s[28:29]
  v_cvt_pk_bf16_f32 v16, v2, v3
  v_lshlrev_b32 v2, 16, v17
  v_and_b32 v3, s30, v17
  v_pk_mul_f32 v[2:3], v[2:3], s[28:29]
  v_cvt_pk_bf16_f32 v17, v2, v3
  v_lshlrev_b32 v2, 16, v18
  v_and_b32 v3, s30, v18
  v_pk_mul_f32 v[2:3], v[2:3], s[28:29]
  v_cvt_pk_bf16_f32 v18, v2, v3
  v_lshlrev_b32 v2, 16, v19
  v_and_b32 v3, s30, v19
  v_pk_mul_f32 v[2:3], v[2:3], s[28:29]
  v_cvt_pk_bf16_f32 v19, v2, v3
  v_lshlrev_b32 v20, 16, v20
  v_mul_f32 v20, s28, v20
  v_cvt_pk_f16_f32 v20, v20, 0
  v_and_b32 v20, v5, v20
  v_mov_b32 v22, 0
  v_lshlrev_b32 v21, 16, v21
  v_mul_f32 v21, s28, v21
  v_cvt_pk_f16_f32 v21, v21, 0
  v_and_b32 v21, v5, v21
  v_mov_b32 v23, 0
  buffer_store_dwordx4 v[12:15], v10, s[20:23], s3 offen offset:0
  buffer_store_dwordx4 v[16:19], v10, s[20:23], s3 offen offset:1024
  buffer_store_dwordx4 v[20:23], v10, s[20:23], s3 offen offset:2048
  buffer_store_dwordx4 v[20:23], v10, s[20:23], s3 offen offset:3072
  s_branch WPEND
WP5:
  v_lshrrev_b32 v4, 2, v1
  v_lshrrev_b32 v8, 4, v1
  v_xor_b32 v4, v4, v8
  v_and_b32 v4, 1, v4
  v_subrev_u32 v4, 1, v4
  v_lshlrev_b32 v2, 16, v28
  v_and_b32 v3, s30, v28
  v_cvt_pk_f16_f32 v2, v2, v3
  v_and_b32 v12, v4, v2
  v_lshlrev_b32 v2, 16, v29
  v_and_b32 v3, s30, v29
  v_cvt_pk_f16_f32 v2, v2, v3
  v_and_b32 v13, v4, v2
  v_lshlrev_b32 v2, 16, v30
  v_and_b32 v3, s30, v30
  v_cvt_pk_f16_f32 v2, v2, v3
  v_and_b32 v14, v4, v2
  v_lshlrev_b32 v2, 16, v31
  v_and_b32 v3, s30, v31
  v_cvt_pk_f16_f32 v2, v2, v3
  v_and_b32 v15, v4, v2
  v_lshlrev_b32 v2, 16, v32
  v_and_b32 v3, s30, v32
  v_cvt_pk_f16_f32 v2, v2, v3
  v_and_b32 v16, v4, v2
  v_lshlrev_b32 v2, 16, v33
  v_and_b32 v3, s30, v33
  v_cvt_pk_f16_f32 v2, v2, v3
  v_and_b32 v17, v4, v2
  v_lshlrev_b32 v2, 16, v34
  v_and_b32 v3, s30, v34
  v_cvt_pk_f16_f32 v2, v2, v3
  v_and_b32 v18, v4, v2
  v_lshlrev_b32 v2, 16, v35
  v_and_b32 v3, s30, v35
  v_cvt_pk_f16_f32 v2, v2, v3
  v_and_b32 v19, v4, v2
  v_lshlrev_b32 v2, 16, v36
  v_and_b32 v3, s30, v36
  v_cvt_pk_f16_f32 v2, v2, v3
  v_and_b32 v20, v4, v2
  v_lshlrev_b32 v2, 16, v37
  v_and_b32 v3, s30, v37
  v_cvt_pk_f16_f32 v2, v2, v3
  v_and_b32 v21, v4, v2
  v_lshlrev_b32 v2, 16, v38
  v_and_b32 v3, s30, v38
  v_cvt_pk_f16_f32 v2, v2, v3
  v_and_b32 v22, v4, v2
  v_lshlrev_b32 v2, 16, v39
  v_and_b32 v3, s30, v39
  v_cvt_pk_f16_f32 v2, v2, v3
  v_and_b32 v23, v4, v2
  v_lshlrev_b32 v2, 16, v40
  v_and_b32 v3, s30, v40
  v_cvt_pk_f16_f32 v2, v2, v3
  v_and_b32 v24, v4, v2
  v_lshlrev_b32 v2, 16, v41
  v_and_b32 v3, s30, v41
  v_cvt_pk_f16_f32 v2, v2, v3
  v_and_b32 v25, v4, v2
  v_lshlrev_b32 v2, 16, v42
  v_and_b32 v3, s30, v42
  v_cvt_pk_f16_f32 v2, v2, v3
  v_and_b32 v26, v4, v2
  v_lshlrev_b32 v2, 16, v43
  v_and_b32 v3, s30, v43
  v_cvt_pk_f16_f32 v2, v2, v3
  v_and_b32 v27, v4, v2
  s_branch WPST
WPEND:
  s_cbranch_execnz WPX
  s_mov_b64 exec, -1
  s_waitcnt vmcnt(0)
  s_barrier
  s_branch WPGO
WPX:
  s_endpgm
.globl main_kernel
.p2align 8
.type main_kernel,@function
main_kernel:
  s_cmp_ge_u32 s2, 256
  s_cbranch_scc1 K2END
  s_load_dwordx2 s[52:53], s[0:1], 80
  s_load_dwordx8 s[32:39], s[0:1], 0
  s_load_dwordx4 s[48:51], s[0:1], 56
  s_and_b32 s3, s2, 7
  s_lshl_b32 s3, s3, 5
  s_lshr_b32 s56, s2, 3
  s_add_u32 s56, s56, s3
  v_lshrrev_b32 v2, 6, v0
  v_and_b32 v0, 63, v0
  v_readfirstlane_b32 s57, v2
  s_mov_b32 s60, 47
  s_mov_b32 s61, 0
  s_mov_b32 s63, 1
  s_mov_b32 s54, 1
  s_movk_i32 s55, 2176
  s_movk_i32 s94, 17404
  s_movk_i32 s95, 0xf0
  s_movk_i32 s64, 128
  s_mov_b32 s65, 0xffff0000
  s_mov_b32 s70, 0xbfb8aa3b
  s_mov_b32 s71, 0xbfb8aa3b
  s_mov_b32 s72, 1.0
  s_mov_b32 s73, 1.0
  s_mov_b32 s74, -1
  s_mov_b32 s75, 0
  s_lshl_b32 s66, s57, 12
  s_add_u32 s66, s66, 81408
  s_lshl_b32 s67, s57, 10
  s_add_u32 s67, s67, 36352
  s_mul_i32 s3, s56, 128
  s_mov_b32 s18, 8191232
  s_mov_b32 s19, 0x20000
  s_waitcnt lgkmcnt(0)
  s_add_u32 s16, s52, s3
  s_addc_u32 s17, s53, 0
ROUND:
  s_lshl_b32 s3, s57, 12
  v_lshl_add_u32 v2, v0, 4, s3
  v_lshrrev_b32 v3, 7, v2
  v_lshl_add_u32 v2, v3, 15, v2
  buffer_load_dwordx4 v[128:131], v2, s[16:19], 0 offen offset:0
  v_add_u32 v2, 262144, v2
  buffer_load_dwordx4 v[132:135], v2, s[16:19], 0 offen offset:1024
  v_add_u32 v2, 262144, v2
  buffer_load_dwordx4 v[136:139], v2, s[16:19], 0 offen offset:2048
  v_add_u32 v2, 262144, v2
  buffer_load_dwordx4 v[140:143], v2, s[16:19], 0 offen offset:3072
  s_and_b32 s3, s57, 3
  s_lshl_b32 s3, s3, 8
  v_lshl_add_u32 v4, v0, 2, s3
  v_mov_b32 v5, 0
  ds_write_b32 v4, v5 offset:34816
  s_cmp_eq_u32 s63, 0
  s_cbranch_scc1 NOTFIRST1
  s_mov_b32 s4, s32
  s_mov_b32 s5, s33
  s_mov_b32 s6, 6400000
  s_mov_b32 s7, 0x20000
  s_mov_b32 s12, s34
  s_mov_b32 s13, s35
  s_mov_b32 s14, 300000
  s_mov_b32 s15, 0x20000
  v_and_b32 v2, 7, v0
  v_bfe_u32 v3, v0, 4, 1
  v_lshrrev_b32 v5, 3, v0
  v_lshrrev_b32 v6, 5, v0
  v_lshl_add_u32 v233, v6, 2, 0
  v_xor_b32 v233, v233, v2
  v_lshlrev_b32 v233, 4, v233
  v_lshl_add_u32 v234, v6, 2, 1
  v_xor_b32 v234, v234, v2
  v_lshlrev_b32 v234, 4, v234
  v_lshl_add_u32 v235, v6, 2, 2
  v_xor_b32 v235, v235, v2
  v_lshlrev_b32 v235, 4, v235
  v_lshl_add_u32 v236, v6, 2, 3
  v_xor_b32 v236, v236, v2
  v_lshlrev_b32 v236, 4, v236
  v_lshl_add_u32 v7, v5, 2, 0
  v_mad_u32_u24 v56, v7, s64, v233
  v_lshl_add_u32 v7, v5, 2, 1
  v_mad_u32_u24 v57, v7, s64, v234
  v_lshl_add_u32 v7, v5, 2, 2
  v_mad_u32_u24 v58, v7, s64, v235
  v_lshl_add_u32 v7, v5, 2, 3
  v_mad_u32_u24 v59, v7, s64, v236
  s_mov_b32 s8, s36
  s_mov_b32 s9, s37
  s_mov_b32 s10, 25600000
  s_mov_b32 s11, 0x20000
  s_mov_b32 s28, s50
  s_mov_b32 s29, s51
  s_mov_b32 s30, 6700000
  s_mov_b32 s31, 0x20000
  s_mov_b32 s24, s48
  s_mov_b32 s25, s49
  s_mov_b32 s26, 16384
  s_mov_b32 s27, 0x20000
  s_add_u32 s20, s52, 8388608
  s_addc_u32 s21, s53, 0
  s_mov_b32 s22, 14704640
  s_mov_b32 s23, 0x20000
  v_lshlrev_b32 v13, 1, v3
  v_xor_b32 v13, v13, v2
  v_lshlrev_b32 v13, 4, v13
  v_lshl_or_b32 v13, v5, 7, v13
  s_lshl_b32 s3, s57, 10
  v_lshl_add_u32 v10, v0, 4, s3
  v_add_u32 v10, 14680064, v10
  v_add_u32 v13, s3, v13
  v_lshlrev_b32 v250, 4, v6
  v_and_b32 v2, 3, v0
  v_bfe_u32 v4, v0, 2, 3
  v_lshl_add_u32 v4, v2, 3, v4
  v_xor_b32 v7, v3, v6
  v_lshlrev_b32 v7, 6, v7
  v_lshl_add_u32 v4, v4, 7, v7
  v_add_u32 v4, s66, v4
  v_xor_b32 v7, 0, v2
  v_lshl_add_u32 v237, v7, 4, v4
  v_xor_b32 v7, 1, v2
  v_lshl_add_u32 v238, v7, 4, v4
  v_xor_b32 v7, 2, v2
  v_lshl_add_u32 v239, v7, 4, v4
  v_xor_b32 v7, 3, v2
  v_lshl_add_u32 v240, v7, 4, v4
  s_add_u32 s3, s67, 32
  v_lshlrev_b32 v7, 5, v6
  v_sub_u32 v241, s3, v7
  s_add_u32 s3, s67, 224
  v_lshl_add_u32 v7, v3, 2, v2
  v_lshlrev_b32 v7, 5, v7
  v_sub_u32 v243, s3, v7
  s_mul_i32 s3, s57, 4608
  s_add_u32 s3, s3, 44544
  v_and_b32 v7, 31, v0
  s_movk_i32 s68, 144
  v_mul_u32_u24 v8, s68, v7
  v_add_u32 v8, s3, v8
  v_lshl_add_u32 v242, v6, 5, v8
  v_bfe_u32 v4, v0, 2, 2
  v_lshl_add_u32 v8, v6, 2, v4
  s_movk_i32 s68, 576
  v_mul_u32_u24 v9, s68, v8
  v_add_u32 v9, s3, v9
  v_xor_b32 v245, v3, v0
  v_and_b32 v245, 1, v245
  v_lshl_add_u32 v245, v245, 3, v9
  v_add_u32 v245, 128, v245
  v_lshl_add_u32 v244, v3, 5, v9
  v_lshl_add_u32 v244, v2, 3, v244
  v_xor_b32 v253, v3, v0
  v_and_b32 v253, 1, v253
  v_lshlrev_b32 v253, 4, v253
  v_xor_b32 v254, v5, v6
  v_and_b32 v254, 1, v254
  v_lshlrev_b32 v254, 4, v254
  v_lshl_add_u32 v254, v7, 5, v254
  s_add_u32 s3, s67, 118784
  v_add_u32 v254, s3, v254
  v_mov_b32 v72, 0
  v_mov_b32 v73, 0
  v_mov_b32 v74, 0x3c00
  v_mov_b32 v75, 0x3c000000
  v_cmp_eq_u32 vcc, 28, v0
  s_nop 1
  v_cndmask_b32 v72, v72, v74, vcc
  v_cmp_eq_u32 vcc, 29, v0
  s_nop 1
  v_cndmask_b32 v72, v72, v75, vcc
  v_cmp_eq_u32 vcc, 30, v0
  s_nop 1
  v_cndmask_b32 v73, v73, v74, vcc
  v_cmp_eq_u32 vcc, 31, v0
  s_nop 1
  v_cndmask_b32 v73, v73, v75, vcc
  v_lshl_add_u32 v9, v0, 3, s67
  ds_write_b64 v9, v[72:73]
  v_mov_b32 v88, 0
  v_mov_b32 v89, 0
  v_mov_b32 v90, 0
  v_mov_b32 v91, 0
  v_mov_b32 v92, 0
  v_mov_b32 v93, 0
  v_mov_b32 v94, 0
  v_mov_b32 v95, 0
  v_mov_b32 v96, 0
  v_mov_b32 v97, 0
  v_mov_b32 v98, 0
  v_mov_b32 v99, 0
  v_mov_b32 v100, 0
  v_mov_b32 v101, 0
  v_mov_b32 v102, 0
  v_mov_b32 v103, 0
  v_mov_b32 v104, 0
  v_mov_b32 v105, 0
  v_mov_b32 v106, 0
  v_mov_b32 v107, 0
  v_mov_b32 v108, 0
  v_mov_b32 v109, 0
  v_mov_b32 v110, 0
  v_mov_b32 v111, 0
  v_mov_b32 v112, 0
  v_mov_b32 v113, 0
  v_mov_b32 v114, 0
  v_mov_b32 v115, 0
  v_mov_b32 v116, 0
  v_mov_b32 v117, 0
  v_mov_b32 v118, 0
  v_mov_b32 v119, 0
  v_mov_b32 v120, 0
  v_mov_b32 v121, 0
  v_mov_b32 v122, 0
  v_mov_b32 v123, 0
  s_branch FIRST1
NOTFIRST1:
  s_waitcnt vmcnt(0)
FIRST1:
  s_lshl_b32 s3, s57, 5
  v_lshrrev_b32 v2, 3, v0
  v_add_u32 v2, s3, v2
  s_mov_b32 s3, 58368
  v_mul_u32_u24 v2, s3, v2
  v_and_b32 v3, 7, v0
  v_lshl_add_u32 v2, v3, 4, v2
  v_lshlrev_b32 v3, 1, v3
  s_sub_i32 s68, s61, 15
  s_add_i32 s69, s68, s60
  s_max_i32 s68, s68, 0
  s_lshl_b32 s3, s68, 3
  v_add_u32 v2, s3, v2
  v_add_u32 v4, s68, v3
  v_mov_b32 v9, 1
  s_waitcnt lgkmcnt(0)
  s_barrier
  s_waitcnt vmcnt(3)
  v_ashrrev_i32 v5, 31, v131
  v_bfi_b32 v5, v5, 0, v130
  s_mov_b32 s3, 0
  v_mov_b32_dpp v6, v5 quad_perm:[3,3,3,3] row_mask:0xf bank_mask:0xf
  s_nop 1
  v_or_b32_dpp v6, v6, v6 row_half_mirror row_mask:0xf bank_mask:0xf
  v_lshrrev_b32 v224, 16, v6
  v_and_b32 v6, 0xffff, v6
  v_lshl_add_u32 v6, v6, 3, v2
  v_add_u32 v220, s3, v6
  v_min_i32 v216, s69, v224
  v_sub_u32 v216, v216, v4
  v_cmp_lt_i32 vcc, 0, v216
  s_nop 1
  v_cndmask_b32 v6, -16, v220, vcc
  buffer_load_dwordx4 v[144:147], v6, s[20:23], 0 offen
  s_waitcnt vmcnt(3)
  v_ashrrev_i32 v5, 31, v135
  v_bfi_b32 v5, v5, 0, v134
  s_mov_b32 s3, 466944
  v_mov_b32_dpp v6, v5 quad_perm:[3,3,3,3] row_mask:0xf bank_mask:0xf
  s_nop 1
  v_or_b32_dpp v6, v6, v6 row_half_mirror row_mask:0xf bank_mask:0xf
  v_lshrrev_b32 v225, 16, v6
  v_and_b32 v6, 0xffff, v6
  v_lshl_add_u32 v6, v6, 3, v2
  v_add_u32 v221, s3, v6
  v_min_i32 v217, s69, v225
  v_sub_u32 v217, v217, v4
  v_cmp_lt_i32 vcc, 0, v217
  s_nop 1
  v_cndmask_b32 v6, -16, v221, vcc
  buffer_load_dwordx4 v[148:151], v6, s[20:23], 0 offen
  s_waitcnt vmcnt(3)
  v_ashrrev_i32 v5, 31, v139
  v_bfi_b32 v5, v5, 0, v138
  s_mov_b32 s3, 933888
  v_mov_b32_dpp v6, v5 quad_perm:[3,3,3,3] row_mask:0xf bank_mask:0xf
  s_nop 1
  v_or_b32_dpp v6, v6, v6 row_half_mirror row_mask:0xf bank_mask:0xf
  v_lshrrev_b32 v226, 16, v6
  v_and_b32 v6, 0xffff, v6
  v_lshl_add_u32 v6, v6, 3, v2
  v_add_u32 v222, s3, v6
  v_min_i32 v218, s69, v226
  v_sub_u32 v218, v218, v4
  v_cmp_lt_i32 vcc, 0, v218
  s_nop 1
  v_cndmask_b32 v6, -16, v222, vcc
  buffer_load_dwordx4 v[152:155], v6, s[20:23], 0 offen
  s_waitcnt vmcnt(3)
  v_ashrrev_i32 v5, 31, v143
  v_bfi_b32 v5, v5, 0, v142
  s_mov_b32 s3, 1400832
  v_mov_b32_dpp v6, v5 quad_perm:[3,3,3,3] row_mask:0xf bank_mask:0xf
  s_nop 1
  v_or_b32_dpp v6, v6, v6 row_half_mirror row_mask:0xf bank_mask:0xf
  v_lshrrev_b32 v227, 16, v6
  v_and_b32 v6, 0xffff, v6
  v_lshl_add_u32 v6, v6, 3, v2
  v_add_u32 v223, s3, v6
  v_min_i32 v219, s69, v227
  v_sub_u32 v219, v219, v4
  v_cmp_lt_i32 vcc, 0, v219
  s_nop 1
  v_cndmask_b32 v6, -16, v223, vcc
  buffer_load_dwordx4 v[156:159], v6, s[20:23], 0 offen
  s_cmp_eq_u32 s63, 0
  s_cbranch_scc1 NOLATE1
  s_lshl_b32 m0, s57, 10
  s_add_u32 m0, m0, 130560
  s_nop 0
  buffer_load_dwordx4 v10, s[20:23], 0 offen lds
  v_add_u32 v10, 0x2000, v10
  s_lshl_b32 m0, s57, 10
  s_add_u32 m0, m0, 138752
  s_nop 0
  buffer_load_dwordx4 v10, s[20:23], 0 offen lds
  v_add_u32 v10, 0x2000, v10
  s_lshl_b32 m0, s57, 10
  s_add_u32 m0, m0, 146944
  s_nop 0
  buffer_load_dwordx4 v10, s[20:23], 0 offen lds
NOLATE1:
  v_max3_i32 v5, v216, v217, v218
  v_max_i32 v5, v5, v219
  v_cmp_lt_i32 s[76:77], 16, v5
  v_max3_i32 v5, v224, v225, v226
  v_max_i32 v5, v5, v227
  s_max_i32 s69, s69, 0
  v_cmp_lt_i32 s[68:69], s69, v5
  s_cmp_eq_u64 s[76:77], 0
  s_cbranch_scc1 NOL2A
  v_cmpx_lt_i32 vcc, 16, v216
  buffer_load_dwordx4 v[160:163], v220, s[20:23], 0 offen offset:128
  s_mov_b64 exec, -1
  v_cmpx_lt_i32 vcc, 16, v217
  buffer_load_dwordx4 v[164:167], v221, s[20:23], 0 offen offset:128
  s_mov_b64 exec, -1
  v_cmpx_lt_i32 vcc, 16, v218
  buffer_load_dwordx4 v[168:171], v222, s[20:23], 0 offen offset:128
  s_mov_b64 exec, -1
  v_cmpx_lt_i32 vcc, 16, v219
  buffer_load_dwordx4 v[172:175], v223, s[20:23], 0 offen offset:128
  s_mov_b64 exec, -1
NOL2A:
  s_cmp_lg_u32 s63, 0
  s_cbranch_scc1 FIRST2
  s_add_u32 s3, s61, s60
  v_add_u32 v5, 0, v3
  v_cmp_le_u32 s[32:33], s3, v5
  v_cmp_gt_u32 s[34:35], s61, v5
  s_or_b64 s[34:35], s[34:35], s[32:33]
  v_cmp_gt_i32 vcc, 0, v129
  s_and_b64 vcc, vcc, s[32:33]
  s_or_b64 s[68:69], s[68:69], vcc
  v_cndmask_b32 v129, v129, 0, s[34:35]
  v_cmp_gt_i32 vcc, 0, v133
  s_and_b64 vcc, vcc, s[32:33]
  s_or_b64 s[68:69], s[68:69], vcc
  v_cndmask_b32 v133, v133, 0, s[34:35]
  v_cmp_gt_i32 vcc, 0, v137
  s_and_b64 vcc, vcc, s[32:33]
  s_or_b64 s[68:69], s[68:69], vcc
  v_cndmask_b32 v137, v137, 0, s[34:35]
  v_cmp_gt_i32 vcc, 0, v141
  s_and_b64 vcc, vcc, s[32:33]
  s_or_b64 s[68:69], s[68:69], vcc
  v_cndmask_b32 v141, v141, 0, s[34:35]
  v_add_u32 v5, 1, v3
  v_cmp_le_u32 s[32:33], s3, v5
  v_cmp_gt_u32 s[34:35], s61, v5
  s_or_b64 s[34:35], s[34:35], s[32:33]
  v_cmp_gt_i32 vcc, 0, v131
  s_and_b64 vcc, vcc, s[32:33]
  s_or_b64 s[68:69], s[68:69], vcc
  v_cndmask_b32 v131, v131, 0, s[34:35]
  v_cmp_gt_i32 vcc, 0, v135
  s_and_b64 vcc, vcc, s[32:33]
  s_or_b64 s[68:69], s[68:69], vcc
  v_cndmask_b32 v135, v135, 0, s[34:35]
  v_cmp_gt_i32 vcc, 0, v139
  s_and_b64 vcc, vcc, s[32:33]
  s_or_b64 s[68:69], s[68:69], vcc
  v_cndmask_b32 v139, v139, 0, s[34:35]
  v_cmp_gt_i32 vcc, 0, v143
  s_and_b64 vcc, vcc, s[32:33]
  s_or_b64 s[68:69], s[68:69], vcc
  v_cndmask_b32 v143, v143, 0, s[34:35]
  s_waitcnt vmcnt(0)
FIRST2:
  s_cmp_eq_u64 s[68:69], 0
  s_cbranch_scc1 NOFLAG
  v_mov_b32 v5, 35328
  ds_write_b32 v5, v5
NOFLAG:
  v_cmp_gt_i32 s[32:33], 0, v129
  v_lshlrev_b32_sdwa v200, 2, v129 dst_sel:DWORD dst_unused:UNUSED_PAD src0_sel:DWORD src1_sel:BYTE_3
  v_cmp_gt_i32 s[34:35], 0, v131
  v_lshlrev_b32_sdwa v201, 2, v131 dst_sel:DWORD dst_unused:UNUSED_PAD src0_sel:DWORD src1_sel:BYTE_3
  v_cmp_gt_i32 s[36:37], 0, v133
  v_lshlrev_b32_sdwa v202, 2, v133 dst_sel:DWORD dst_unused:UNUSED_PAD src0_sel:DWORD src1_sel:BYTE_3
  v_cmp_gt_i32 s[38:39], 0, v135
  v_lshlrev_b32_sdwa v203, 2, v135 dst_sel:DWORD dst_unused:UNUSED_PAD src0_sel:DWORD src1_sel:BYTE_3
  v_cmp_gt_i32 s[40:41], 0, v137
  v_lshlrev_b32_sdwa v204, 2, v137 dst_sel:DWORD dst_unused:UNUSED_PAD src0_sel:DWORD src1_sel:BYTE_3
  v_cmp_gt_i32 s[42:43], 0, v139
  v_lshlrev_b32_sdwa v205, 2, v139 dst_sel:DWORD dst_unused:UNUSED_PAD src0_sel:DWORD src1_sel:BYTE_3
  v_cmp_gt_i32 s[44:45], 0, v141
  v_lshlrev_b32_sdwa v206, 2, v141 dst_sel:DWORD dst_unused:UNUSED_PAD src0_sel:DWORD src1_sel:BYTE_3
  v_cmp_gt_i32 s[46:47], 0, v143
  v_lshlrev_b32_sdwa v207, 2, v143 dst_sel:DWORD dst_unused:UNUSED_PAD src0_sel:DWORD src1_sel:BYTE_3
  s_mov_b64 exec, s[32:33]
  ds_add_rtn_u32 v176, v200, v9 offset:34304
  s_mov_b64 exec, s[34:35]
  ds_add_rtn_u32 v177, v201, v9 offset:34304
  s_mov_b64 exec, s[36:37]
  ds_add_rtn_u32 v178, v202, v9 offset:34304
  s_mov_b64 exec, s[38:39]
  ds_add_rtn_u32 v179, v203, v9 offset:34304
  s_mov_b64 exec, s[40:41]
  ds_add_rtn_u32 v180, v204, v9 offset:34304
  s_mov_b64 exec, s[42:43]
  ds_add_rtn_u32 v181, v205, v9 offset:34304
  s_mov_b64 exec, s[44:45]
  ds_add_rtn_u32 v182, v206, v9 offset:34304
  s_mov_b64 exec, s[46:47]
  ds_add_rtn_u32 v183, v207, v9 offset:34304
  s_mov_b64 exec, -1
  s_cmp_eq_u32 s63, 0
  s_cbranch_scc1 NOLATE2
  s_lshl_b32 m0, s57, 10
  s_add_u32 m0, m0, 114176
  s_nop 0
  buffer_load_dwordx4 v13, s[24:27], 0 offen lds
  v_add_u32 v13, 0x2000, v13
  s_lshl_b32 m0, s57, 10
  s_add_u32 m0, m0, 122368
  s_nop 0
  buffer_load_dwordx4 v13, s[24:27], 0 offen lds
NOLATE2:
  v_lshlrev_b32 v2, 2, v0
  v_lshrrev_b32 v8, 4, v0
  v_mul_u32_u24 v8, 544, v8
  v_and_b32 v3, 0x30, v0
  v_add_u32 v3, 35456, v3
  v_cmp_lt_i32 s[48:49], 0, v216
  v_cmp_lt_i32 s[50:51], 1, v216
  v_cmp_lt_i32 s[52:53], 0, v217
  v_cmp_lt_i32 s[96:97], 1, v217
  v_cmp_lt_i32 s[98:99], 0, v218
  v_cmp_lt_i32 s[100:101], 1, v218
  v_cmp_lt_i32 s[68:69], 0, v219
  s_waitcnt lgkmcnt(0)
  s_barrier
  ds_read2st64_b32 v[4:5], v2 offset0:136 offset1:137
  s_waitcnt lgkmcnt(0)
  v_mov_b32 v6, v4
  v_mov_b32 v7, v5
  s_nop 0
  v_add_u32_dpp v6, v6, v6 row_shr:1 row_mask:0xf bank_mask:0xf
  v_add_u32_dpp v7, v7, v7 row_shr:1 row_mask:0xf bank_mask:0xf
  s_nop 0
  v_add_u32_dpp v6, v6, v6 row_shr:2 row_mask:0xf bank_mask:0xf
  v_add_u32_dpp v7, v7, v7 row_shr:2 row_mask:0xf bank_mask:0xf
  s_nop 0
  v_add_u32_dpp v6, v6, v6 row_shr:4 row_mask:0xf bank_mask:0xf
  v_add_u32_dpp v7, v7, v7 row_shr:4 row_mask:0xf bank_mask:0xf
  s_nop 0
  v_add_u32_dpp v6, v6, v6 row_shr:8 row_mask:0xf bank_mask:0xf
  v_add_u32_dpp v7, v7, v7 row_shr:8 row_mask:0xf bank_mask:0xf
  v_sub_u32 v6, v6, v4
  v_sub_u32 v7, v7, v5
  v_add_u32 v4, v6, v8
  v_add3_u32 v5, v7, v8, s55
  ds_write2st64_b32 v2, v4, v5 offset0:140 offset1:141
  v_max_u32 v8, v6, v7
  v_cmp_lt_u32 vcc, 0x200, v8
  s_mov_b32 exec_lo, 0x80008000
  s_mov_b32 exec_hi, 0x80008000
  ds_write2_b32 v3, v4, v5 offset0:1 offset1:17
  s_mov_b64 exec, -1
  v_mov_b32 v8, 1
  v_mov_b32 v9, 0
  s_cbranch_vccz NOOVF1
  s_mov_b64 s[32:33], 0
  s_mov_b64 s[34:35], 0
  s_mov_b64 s[36:37], 0
  s_mov_b64 s[38:39], 0
  s_mov_b64 s[40:41], 0
  s_mov_b64 s[42:43], 0
  s_mov_b64 s[44:45], 0
  s_mov_b64 s[46:47], 0
NOOVF1:
  v_cmp_lt_i32 vcc, 1, v219
  s_waitcnt vmcnt(5)
  v_and_b32_sdwa v208, s95, v145 dst_sel:DWORD dst_unused:UNUSED_PAD src0_sel:DWORD src1_sel:BYTE_3
  v_and_b32_sdwa v209, s95, v147 dst_sel:DWORD dst_unused:UNUSED_PAD src0_sel:DWORD src1_sel:BYTE_3
  v_and_b32_sdwa v210, s95, v149 dst_sel:DWORD dst_unused:UNUSED_PAD src0_sel:DWORD src1_sel:BYTE_3
  v_and_b32_sdwa v211, s95, v151 dst_sel:DWORD dst_unused:UNUSED_PAD src0_sel:DWORD src1_sel:BYTE_3
  v_and_b32_sdwa v212, s95, v153 dst_sel:DWORD dst_unused:UNUSED_PAD src0_sel:DWORD src1_sel:BYTE_3
  v_and_b32_sdwa v213, s95, v155 dst_sel:DWORD dst_unused:UNUSED_PAD src0_sel:DWORD src1_sel:BYTE_3
  v_and_b32_sdwa v214, s95, v157 dst_sel:DWORD dst_unused:UNUSED_PAD src0_sel:DWORD src1_sel:BYTE_3
  v_and_b32_sdwa v215, s95, v159 dst_sel:DWORD dst_unused:UNUSED_PAD src0_sel:DWORD src1_sel:BYTE_3
  s_mov_b64 exec, s[48:49]
  ds_add_rtn_u64 v[184:185], v208, v[8:9] offset:35328
  s_mov_b64 exec, s[50:51]
  ds_add_rtn_u64 v[186:187], v209, v[8:9] offset:35328
  s_mov_b64 exec, s[52:53]
  ds_add_rtn_u64 v[188:189], v210, v[8:9] offset:35328
  s_mov_b64 exec, s[96:97]
  ds_add_rtn_u64 v[190:191], v211, v[8:9] offset:35328
  s_mov_b64 exec, s[98:99]
  ds_add_rtn_u64 v[192:193], v212, v[8:9] offset:35328
  s_mov_b64 exec, s[100:101]
  ds_add_rtn_u64 v[194:195], v213, v[8:9] offset:35328
  s_mov_b64 exec, s[68:69]
  ds_add_rtn_u64 v[196:197], v214, v[8:9] offset:35328
  s_mov_b64 exec, vcc
  ds_add_rtn_u64 v[198:199], v215, v[8:9] offset:35328
  s_mov_b64 exec, -1
  ds_read_b32 v200, v200 offset:35328
  ds_read_b32 v201, v201 offset:35328
  ds_read_b32 v202, v202 offset:35328
  ds_read_b32 v203, v203 offset:35328
  ds_read_b32 v204, v204 offset:35328
  ds_read_b32 v205, v205 offset:35328
  ds_read_b32 v206, v206 offset:35328
  ds_read_b32 v207, v207 offset:35328
  s_cmp_eq_u32 s63, 0
  s_cbranch_scc1 NOPERM
  v_mov_b32 v2, v6
  s_sub_u32 s3, 11, s57
  s_nop 0
  v_mov_b32_dpp v2, v7 row_shl:1 row_mask:0xf bank_mask:0xf
  s_cmp_lt_u32 s57, 4
  v_lshl_or_b32 v2, v2, 6, v0
  s_cselect_b32 s3, s57, s3
  s_mov_b32 s2, 7
  v_readlane_b32 s80, v2, 15
  v_readlane_b32 s82, v2, 31
  v_readlane_b32 s84, v2, 47
  v_readlane_b32 s86, v2, 63
  v_readlane_b32 s88, v2, 14
  v_readlane_b32 s90, v2, 30
  v_readlane_b32 s92, v2, 46
  s_mov_b32 exec_lo, 0xc000c000
  s_mov_b32 exec_hi, 0xc000c000
  v_cmp_lt_u32 s[80:81], s80, v2
  v_cmp_lt_u32 s[82:83], s82, v2
  v_cmp_lt_u32 s[84:85], s84, v2
  v_cmp_lt_u32 s[86:87], s86, v2
  v_cmp_lt_u32 s[88:89], s88, v2
  v_cmp_lt_u32 s[90:91], s90, v2
  v_cmp_lt_u32 s[92:93], s92, v2
  s_mov_b64 exec, -1
  s_bcnt1_i32_b64 s80, s[80:81]
  s_cmp_eq_u32 s80, s3
  s_cselect_b32 s2, 0, s2
  s_bcnt1_i32_b64 s82, s[82:83]
  s_cmp_eq_u32 s82, s3
  s_cselect_b32 s2, 1, s2
  s_bcnt1_i32_b64 s84, s[84:85]
  s_cmp_eq_u32 s84, s3
  s_cselect_b32 s2, 2, s2
  s_bcnt1_i32_b64 s86, s[86:87]
  s_cmp_eq_u32 s86, s3
  s_cselect_b32 s2, 3, s2
  s_bcnt1_i32_b64 s88, s[88:89]
  s_cmp_eq_u32 s88, s3
  s_cselect_b32 s2, 4, s2
  s_bcnt1_i32_b64 s90, s[90:91]
  s_cmp_eq_u32 s90, s3
  s_cselect_b32 s2, 5, s2
  s_bcnt1_i32_b64 s92, s[92:93]
  s_cmp_eq_u32 s92, s3
  s_cselect_b32 s2, 6, s2
  s_lshl_b32 s3, s56, 3
  s_add_u32 s3, s3, s2
  s_mul_i32 s3, s3, 3125
  s_add_u32 s58, s3, 127
  s_lshr_b32 s58, s58, 7
  s_add_u32 s3, s3, 3252
  s_lshr_b32 s3, s3, 7
  s_sub_u32 s3, s3, s58
  s_bfm_b32 s78, s3, 0
  s_lshl_b32 s3, s58, 7
  v_add_u32 v12, s58, v0
  v_add_u32 v56, s3, v56
  v_add_u32 v57, s3, v57
  v_add_u32 v58, s3, v58
  v_add_u32 v59, s3, v59
  v_mul_u32_u24 v11, 6, v12
  v_and_b32 v11, -4, v11
NOPERM:
  s_cmp_eq_u32 s63, 0
  s_cbranch_scc1 NOLATE4
  s_mul_i32 m0, s57, 4608
  s_add_u32 m0, m0, 44544
  s_nop 0
  buffer_load_dwordx4 v56, s[4:7], 0 offen lds
  s_mul_i32 m0, s57, 4608
  s_add_u32 m0, m0, 45568
  s_nop 0
  buffer_load_dwordx4 v57, s[4:7], 0 offen lds
NOLATE4:
  s_mul_i32 s3, s2, 2176
  v_lshrrev_b32 v2, 3, v0
  v_lshl_add_u32 v246, v2, 4, s3
  v_and_b32 v2, 31, v0
  v_lshl_add_u32 v247, v2, 2, s3
  v_bfe_u32 v2, v0, 2, 2
  v_lshl_add_u32 v2, v2, 4, s3
  v_lshl_add_u32 v248, v250, 2, v2
  v_lshrrev_b32 v2, 1, v0
  v_lshl_add_u32 v252, v2, 2, s3
  v_mov_b32 v2, 35328
  s_waitcnt lgkmcnt(8)
  v_add_lshl_u32 v208, v184, v185, 2
  v_min_u32 v208, s94, v208
  v_add_lshl_u32 v209, v186, v187, 2
  v_min_u32 v209, s94, v209
  v_add_lshl_u32 v210, v188, v189, 2
  v_min_u32 v210, s94, v210
  v_add_lshl_u32 v211, v190, v191, 2
  v_min_u32 v211, s94, v211
  v_add_lshl_u32 v212, v192, v193, 2
  v_min_u32 v212, s94, v212
  v_add_lshl_u32 v213, v194, v195, 2
  v_min_u32 v213, s94, v213
  v_add_lshl_u32 v214, v196, v197, 2
  v_min_u32 v214, s94, v214
  v_add_lshl_u32 v215, v198, v199, 2
  v_min_u32 v215, s94, v215
  s_waitcnt lgkmcnt(6)
  v_add_lshl_u32 v200, v200, v176, 2
  v_add_lshl_u32 v201, v201, v177, 2
  s_waitcnt lgkmcnt(4)
  v_add_lshl_u32 v202, v202, v178, 2
  v_add_lshl_u32 v203, v203, v179, 2
  s_waitcnt lgkmcnt(2)
  v_add_lshl_u32 v204, v204, v180, 2
  v_add_lshl_u32 v205, v205, v181, 2
  s_waitcnt lgkmcnt(0)
  v_add_lshl_u32 v206, v206, v182, 2
  v_add_lshl_u32 v207, v207, v183, 2
  s_mov_b64 exec, s[32:33]
  ds_write2st64_b32 v200, v128, v129 offset0:0 offset1:68
  s_mov_b64 exec, s[34:35]
  ds_write2st64_b32 v201, v130, v131 offset0:0 offset1:68
  s_mov_b64 exec, s[36:37]
  ds_write2st64_b32 v202, v132, v133 offset0:0 offset1:68
  s_mov_b64 exec, s[38:39]
  ds_write2st64_b32 v203, v134, v135 offset0:0 offset1:68
  s_mov_b64 exec, -1
  s_cmp_eq_u32 s63, 0
  s_cbranch_scc1 NOLATE5
  s_mul_i32 m0, s57, 4608
  s_add_u32 m0, m0, 46592
  s_nop 0
  buffer_load_dwordx4 v58, s[4:7], 0 offen lds
NOLATE5:
  s_mov_b64 exec, s[40:41]
  ds_write2st64_b32 v204, v136, v137 offset0:0 offset1:68
  s_mov_b64 exec, s[42:43]
  ds_write2st64_b32 v205, v138, v139 offset0:0 offset1:68
  s_mov_b64 exec, s[44:45]
  ds_write2st64_b32 v206, v140, v141 offset0:0 offset1:68
  s_mov_b64 exec, s[46:47]
  ds_write2st64_b32 v207, v142, v143 offset0:0 offset1:68
  s_mov_b64 exec, -1
  s_cmp_eq_u32 s63, 0
  s_cbranch_scc1 NOLATE6
  s_mul_i32 m0, s57, 4608
  s_add_u32 m0, m0, 47616
  s_nop 0
  buffer_load_dwordx4 v59, s[4:7], 0 offen lds
NOLATE6:
  s_mov_b64 exec, s[48:49]
  ds_write2st64_b32 v208, v144, v145 offset0:0 offset1:68
  s_mov_b64 exec, s[50:51]
  ds_write2st64_b32 v209, v146, v147 offset0:0 offset1:68
  s_mov_b64 exec, s[52:53]
  ds_write2st64_b32 v210, v148, v149 offset0:0 offset1:68
  s_mov_b64 exec, s[96:97]
  ds_write2st64_b32 v211, v150, v151 offset0:0 offset1:68
  s_mov_b64 exec, s[98:99]
  ds_write2st64_b32 v212, v152, v153 offset0:0 offset1:68
  s_mov_b64 exec, s[100:101]
  ds_write2st64_b32 v213, v154, v155 offset0:0 offset1:68
  s_mov_b64 exec, s[68:69]
  ds_write2st64_b32 v214, v156, v157 offset0:0 offset1:68
  s_mov_b64 exec, vcc
  ds_write2st64_b32 v215, v158, v159 offset0:0 offset1:68
  s_mov_b64 exec, -1
  s_cmp_eq_u64 s[76:77], 0
  s_cbranch_scc1 NOL2B
  s_waitcnt vmcnt(0) lgkmcnt(0)
  v_cmpx_lt_i32 vcc, 16, v216
  v_and_b32_sdwa v208, s95, v161 dst_sel:DWORD dst_unused:UNUSED_PAD src0_sel:DWORD src1_sel:BYTE_3
  ds_add_rtn_u64 v[184:185], v208, v[8:9] offset:35328
  v_cmpx_lt_i32 vcc, 17, v216
  v_and_b32_sdwa v209, s95, v163 dst_sel:DWORD dst_unused:UNUSED_PAD src0_sel:DWORD src1_sel:BYTE_3
  ds_add_rtn_u64 v[186:187], v209, v[8:9] offset:35328
  s_mov_b64 exec, -1
  v_cmpx_lt_i32 vcc, 16, v217
  v_and_b32_sdwa v210, s95, v165 dst_sel:DWORD dst_unused:UNUSED_PAD src0_sel:DWORD src1_sel:BYTE_3
  ds_add_rtn_u64 v[188:189], v210, v[8:9] offset:35328
  v_cmpx_lt_i32 vcc, 17, v217
  v_and_b32_sdwa v211, s95, v167 dst_sel:DWORD dst_unused:UNUSED_PAD src0_sel:DWORD src1_sel:BYTE_3
  ds_add_rtn_u64 v[190:191], v211, v[8:9] offset:35328
  s_mov_b64 exec, -1
  v_cmpx_lt_i32 vcc, 16, v218
  v_and_b32_sdwa v212, s95, v169 dst_sel:DWORD dst_unused:UNUSED_PAD src0_sel:DWORD src1_sel:BYTE_3
  ds_add_rtn_u64 v[192:193], v212, v[8:9] offset:35328
  v_cmpx_lt_i32 vcc, 17, v218
  v_and_b32_sdwa v213, s95, v171 dst_sel:DWORD dst_unused:UNUSED_PAD src0_sel:DWORD src1_sel:BYTE_3
  ds_add_rtn_u64 v[194:195], v213, v[8:9] offset:35328
  s_mov_b64 exec, -1
  v_cmpx_lt_i32 vcc, 16, v219
  v_and_b32_sdwa v214, s95, v173 dst_sel:DWORD dst_unused:UNUSED_PAD src0_sel:DWORD src1_sel:BYTE_3
  ds_add_rtn_u64 v[196:197], v214, v[8:9] offset:35328
  v_cmpx_lt_i32 vcc, 17, v219
  v_and_b32_sdwa v215, s95, v175 dst_sel:DWORD dst_unused:UNUSED_PAD src0_sel:DWORD src1_sel:BYTE_3
  ds_add_rtn_u64 v[198:199], v215, v[8:9] offset:35328
  s_mov_b64 exec, -1
  s_waitcnt lgkmcnt(0)
  v_cmpx_lt_i32 vcc, 16, v216
  v_add_lshl_u32 v208, v184, v185, 2
  v_min_u32 v208, s94, v208
  ds_write2st64_b32 v208, v160, v161 offset0:0 offset1:68
  v_cmpx_lt_i32 vcc, 17, v216
  v_add_lshl_u32 v209, v186, v187, 2
  v_min_u32 v209, s94, v209
  ds_write2st64_b32 v209, v162, v163 offset0:0 offset1:68
  s_mov_b64 exec, -1
  v_cmpx_lt_i32 vcc, 16, v217
  v_add_lshl_u32 v210, v188, v189, 2
  v_min_u32 v210, s94, v210
  ds_write2st64_b32 v210, v164, v165 offset0:0 offset1:68
  v_cmpx_lt_i32 vcc, 17, v217
  v_add_lshl_u32 v211, v190, v191, 2
  v_min_u32 v211, s94, v211
  ds_write2st64_b32 v211, v166, v167 offset0:0 offset1:68
  s_mov_b64 exec, -1
  v_cmpx_lt_i32 vcc, 16, v218
  v_add_lshl_u32 v212, v192, v193, 2
  v_min_u32 v212, s94, v212
  ds_write2st64_b32 v212, v168, v169 offset0:0 offset1:68
  v_cmpx_lt_i32 vcc, 17, v218
  v_add_lshl_u32 v213, v194, v195, 2
  v_min_u32 v213, s94, v213
  ds_write2st64_b32 v213, v170, v171 offset0:0 offset1:68
  s_mov_b64 exec, -1
  v_cmpx_lt_i32 vcc, 16, v219
  v_add_lshl_u32 v214, v196, v197, 2
  v_min_u32 v214, s94, v214
  ds_write2st64_b32 v214, v172, v173 offset0:0 offset1:68
  v_cmpx_lt_i32 vcc, 17, v219
  v_add_lshl_u32 v215, v198, v199, 2
  v_min_u32 v215, s94, v215
  ds_write2st64_b32 v215, v174, v175 offset0:0 offset1:68
  s_mov_b64 exec, -1
NOL2B:
  s_cmp_eq_u32 s63, 0
  s_cbranch_scc1 NOLATE7
  buffer_load_dwordx2 v[124:125], v11, s[12:15], 0 offen
NOLATE7:
  s_mov_b32 s63, 0
  v_mov_b32 v224, 0
  v_mov_b32 v225, 0
  v_mov_b32 v226, 0
  v_mov_b32 v227, 0
  s_and_b32 s62, s2, 3
  s_lshl_b32 s62, s62, 4
  s_add_u32 s62, s62, 15
  s_waitcnt vmcnt(5) lgkmcnt(0)
  s_barrier
  s_setprio 3
  ds_read2_b32 v[4:5], v3 offset0:0 offset1:16
  ds_read_b32 v8, v2
  ds_read_b128 v[220:223], v246 offset:0
  ds_read_b32 v228, v247 offset:0
  ds_read_b32 v1, v252 offset:17408
  s_waitcnt lgkmcnt(3)
  v_add_u32 v6, v6, v4
  v_add_u32 v7, v7, v5
  v_max_u32 v4, v6, v7
  v_cmp_lt_u32 vcc, 0x200, v4
  v_readlane_b32 s68, v6, s62
  v_readlane_b32 s69, v7, s62
  v_readfirstlane_b32 s62, v8
  s_cbranch_vccz NOOVF
  s_lshr_b32 s60, s60, 1
  s_waitcnt vmcnt(0) lgkmcnt(0)
  s_barrier
  s_branch ROUND
NOOVF:
  s_cmp_ge_u32 s2, 4
  s_cselect_b32 s68, s69, s68
  s_add_u32 s59, s68, 31
  s_lshr_b32 s59, s59, 5
  v_add_u32 v2, s68, v0
  s_lshl_b32 s69, s59, 5
  v_lshl_add_u32 v3, v2, 2, s3
  s_sub_u32 s3, s58, s69
  v_add_u32 v4, s3, v2
  v_mov_b32 v5, 0xffff
  v_cmp_gt_u32 vcc, s69, v2
  s_nop 1
  v_cndmask_b32 v4, v4, v5, vcc
  v_or_b32 v4, 0xf8000000, v4
  v_mov_b32 v5, 0x00ffffff
  s_add_u32 s69, s69, 32
  v_cmpx_gt_u32 vcc, s69, v2
  ds_write2st64_b32 v3, v4, v5 offset0:0 offset1:68
  s_mov_b64 exec, -1
  s_cmp_ge_u32 s68, 32
  s_cbranch_scc1 FULL0
  ds_read_b128 v[220:223], v246 offset:0
  ds_read_b32 v228, v247 offset:0
  ds_read_b32 v1, v252 offset:17408
  s_waitcnt lgkmcnt(0)
FULL0:
  s_waitcnt lgkmcnt(1)
  s_cmp_gt_i32 s59, -1
  s_cselect_b32 s6, 6400000, 0
  s_cselect_b32 s10, 25600000, 0
  s_cselect_b32 s14, 300000, 0
  s_add_u32 m0, s67, 118784
  v_mad_u32_u24 v1, v1, 32, v253
  buffer_load_dwordx4 v1, s[8:11], 0 offen  lds
  s_add_u32 m0, s66, 0
  v_mad_u32_u24 v220, v220, s64, v233
  buffer_load_dwordx4 v220, s[4:7], 0 offen  lds
  s_add_u32 m0, s66, 1024
  v_mad_u32_u24 v221, v221, s64, v234
  buffer_load_dwordx4 v221, s[4:7], 0 offen  lds
  s_add_u32 m0, s66, 2048
  v_mad_u32_u24 v222, v222, s64, v235
  buffer_load_dwordx4 v222, s[4:7], 0 offen  lds
  s_add_u32 m0, s66, 3072
  v_mad_u32_u24 v223, v223, s64, v236
  buffer_load_dwordx4 v223, s[4:7], 0 offen  lds
  v_mul_u32_u24 v1, 6, v228
  v_and_b32 v1, -4, v1
  s_mov_b64 exec, s[74:75]
  buffer_load_dwordx2 v[224:225], v1, s[12:15], 0 offen
  s_mov_b64 exec, -1
  ds_read_b128 v[220:223], v246 offset:128
  ds_read_b32 v229, v247 offset:128
  ds_read_b32 v1, v252 offset:17536
  s_waitcnt lgkmcnt(0)
  s_cmp_eq_u32 s54, 0
  s_cbranch_scc1 NOINIT2
  v_lshlrev_b32 v2, 4, v0
  v_add_u32 v2, 130560, v2
  s_lshl_b32 s3, s57, 9
  s_sub_u32 s3, s3, 36864
  s_waitcnt vmcnt(6)
  v_add_u32 v6, s3, v237
  ds_read_b128 v[200:203], v6
  v_add_u32 v7, s3, v238
  ds_read_b128 v[204:207], v7
  v_add_u32 v8, s3, v239
  ds_read_b128 v[208:211], v8
  v_add_u32 v9, s3, v240
  ds_read_b128 v[212:215], v9
  ds_read_b128 v[128:131], v2 offset:0
  ds_read_b128 v[132:135], v2 offset:1024
  ds_read_b128 v[136:139], v2 offset:2048
  ds_read_b128 v[140:143], v2 offset:3072
  ds_read_b128 v[144:147], v2 offset:4096
  ds_read_b128 v[148:151], v2 offset:5120
  ds_read_b128 v[152:155], v2 offset:6144
  ds_read_b128 v[156:159], v2 offset:7168
  ds_read_b64 v[4:5], v2 offset:18432
  ds_read_b128 v[16:19], v2 offset:8192
  ds_read_b128 v[20:23], v2 offset:9216
  ds_read_b128 v[24:27], v2 offset:10240
  ds_read_b128 v[28:31], v2 offset:11264
  ds_read_b128 v[32:35], v2 offset:12288
  ds_read_b128 v[36:39], v2 offset:13312
  ds_read_b128 v[40:43], v2 offset:14336
  ds_read_b128 v[44:47], v2 offset:15360
  ds_read_b128 v[48:51], v2 offset:16384
  ds_read_b128 v[52:55], v2 offset:17408
  ds_read_b128 v[72:75], v2 offset:20480
  ds_read_b128 v[76:79], v2 offset:21504
  ds_read_b128 v[80:83], v2 offset:22528
  ds_read_b128 v[84:87], v2 offset:23552
  v_lshlrev_b32 v7, 4, v12
  v_alignbit_b32 v8, v125, v124, v7
  v_lshrrev_b32 v9, v7, v125
  v_lshlrev_b32 v6, 16, v8
  v_and_b32 v7, s65, v8
  v_lshlrev_b32 v8, 16, v9
  v_lshl_add_u32 v9, v0, 3, s67
  s_mov_b64 exec, s[74:75]
  ds_write_b64 v9, v[6:7] offset:512
  ds_write_b32 v9, v8 offset:768
  s_mov_b64 exec, -1
  s_waitcnt lgkmcnt(15)
  v_mfma_f32_32x32x16_bf16 v[160:175], v[200:203], v[128:131], 0
  v_mfma_f32_32x32x16_bf16 v[176:191], v[200:203], v[144:147], 0
  v_mfma_f32_32x32x16_bf16 v[160:175], v[204:207], v[132:135], v[160:175]
  v_mfma_f32_32x32x16_bf16 v[176:191], v[204:207], v[148:151], v[176:191]
  v_mfma_f32_32x32x16_bf16 v[160:175], v[208:211], v[136:139], v[160:175]
  v_mfma_f32_32x32x16_bf16 v[176:191], v[208:211], v[152:155], v[176:191]
  v_mfma_f32_32x32x16_bf16 v[160:175], v[212:215], v[140:143], v[160:175]
  v_mfma_f32_32x32x16_bf16 v[176:191], v[212:215], v[156:159], v[176:191]
  s_waitcnt lgkmcnt(0)
  s_mov_b32 s54, 0
  s_nop 7
  s_nop 0
  v_pk_mul_f32 v[160:161], v[160:161], s[70:71]
  v_cvt_pk_f16_f32 v56, v160, v161
  v_pk_mul_f32 v[162:163], v[162:163], s[70:71]
  v_cvt_pk_f16_f32 v57, v162, v163
  v_pk_mul_f32 v[164:165], v[164:165], s[70:71]
  v_cvt_pk_f16_f32 v58, v164, v165
  v_pk_mul_f32 v[166:167], v[166:167], s[70:71]
  v_cvt_pk_f16_f32 v59, v166, v167
  v_pk_mul_f32 v[168:169], v[168:169], s[70:71]
  v_cvt_pk_f16_f32 v60, v168, v169
  v_pk_mul_f32 v[170:171], v[170:171], s[70:71]
  v_cvt_pk_f16_f32 v61, v170, v171
  v_pk_mul_f32 v[172:173], v[172:173], s[70:71]
  v_cvt_pk_f16_f32 v62, v172, v173
  v_pk_mul_f32 v[176:177], v[176:177], s[70:71]
  v_cvt_pk_f16_f32 v64, v176, v177
  v_pk_mul_f32 v[178:179], v[178:179], s[70:71]
  v_cvt_pk_f16_f32 v65, v178, v179
  v_pk_mul_f32 v[180:181], v[180:181], s[70:71]
  v_cvt_pk_f16_f32 v66, v180, v181
  v_pk_mul_f32 v[182:183], v[182:183], s[70:71]
  v_cvt_pk_f16_f32 v67, v182, v183
  v_pk_mul_f32 v[184:185], v[184:185], s[70:71]
  v_cvt_pk_f16_f32 v68, v184, v185
  v_pk_mul_f32 v[186:187], v[186:187], s[70:71]
  v_cvt_pk_f16_f32 v69, v186, v187
  v_pk_mul_f32 v[188:189], v[188:189], s[70:71]
  v_cvt_pk_f16_f32 v70, v188, v189
  v_mov_b32 v63, v4
  v_mov_b32 v71, v5
NOINIT2:
  v_mov_b32 v184, 0
  v_mov_b32 v168, 0
  v_mov_b32 v185, 0
  v_mov_b32 v169, 0
  v_mov_b32 v186, 0
  v_mov_b32 v170, 0
  v_mov_b32 v187, 0
  v_mov_b32 v171, 0
  v_mov_b32 v188, 0
  v_mov_b32 v172, 0
  v_mov_b32 v189, 0
  v_mov_b32 v173, 0
  v_mov_b32 v190, 0
  v_mov_b32 v174, 0
  v_mov_b32 v191, 0
  v_mov_b32 v175, 0
  v_mov_b32 v124, 0
  v_mov_b32 v125, 0
  v_mov_b32 v126, 0
  v_mov_b32 v127, 0
  v_mov_b32 v13, 0
  v_mov_b32 v14, 0
  v_mov_b32 v15, 0
  s_mul_i32 s3, s57, 4608
  s_add_u32 s3, s3, 44544
  v_lshl_add_u32 v2, v0, 3, s3
  ds_write_b64 v2, v[184:185] offset:0
  ds_write_b64 v2, v[184:185] offset:512
  ds_write_b64 v2, v[184:185] offset:1024
  ds_write_b64 v2, v[184:185] offset:1536
  ds_write_b64 v2, v[184:185] offset:2048
  ds_write_b64 v2, v[184:185] offset:2560
  ds_write_b64 v2, v[184:185] offset:3072
  ds_write_b64 v2, v[184:185] offset:3584
  ds_write_b64 v2, v[184:185] offset:4096
  s_waitcnt vmcnt(0)
  ds_read_b128 v[216:219], v254
  ds_read_b128 v[200:203], v237
  ds_read_b128 v[204:207], v238
  ds_read_b128 v[208:211], v239
  ds_read_b128 v[212:215], v240
  v_add_u32_sdwa v249, v241, v228 dst_sel:DWORD dst_unused:UNUSED_PAD src0_sel:DWORD src1_sel:BYTE_3
  ds_read_b64 v[230:231], v249 offset:480
  ds_read_b32 v232, v249 offset:736
  v_lshlrev_b32 v125, 4, v228
  v_alignbit_b32 v126, v225, v224, v125
  v_lshrrev_b32 v127, v125, v225
  ds_read_b64 v[176:177], v249 offset:192
  ds_read_b64 v[178:179], v249 offset:128
  ds_read_b64 v[180:181], v249 offset:64
  ds_read_b32 v182, v249
  s_waitcnt lgkmcnt(10)
  v_mfma_f32_32x32x16_bf16 v[128:143], v[48:51], v[216:219], 0
  v_mfma_f32_32x32x16_bf16 v[144:159], v[52:55], v[216:219], 0
  v_lshlrev_b32 v125, 16, v126
  v_and_b32 v126, s65, v126
  v_lshlrev_b32 v127, 16, v127
  s_waitcnt lgkmcnt(5)
  v_sub_f32 v230, v230, v125
  v_sub_f32 v231, v231, v126
  s_waitcnt lgkmcnt(4)
  v_sub_f32 v232, v232, v127
  v_cvt_pk_bf16_f32 v230, v230, v231
  v_cvt_pk_bf16_f32 v232, v232, v232
  v_lshlrev_b32 v10, 16, v230
  v_and_b32 v11, s65, v230
  v_lshlrev_b32 v12, 16, v232
  v_mul_f32 v230, v10, v10
  v_fmac_f32 v230, v11, v11
  v_fmac_f32 v230, v12, v12
  v_cvt_pk_f16_f32 v183, v230, v230
  v_mfma_f32_32x32x16_bf16 v[128:143], v[16:19], v[200:203], v[128:143]
  v_mfma_f32_32x32x16_bf16 v[128:143], v[20:23], v[204:207], v[128:143]
  v_mfma_f32_32x32x16_bf16 v[128:143], v[24:27], v[208:211], v[128:143]
  v_mfma_f32_32x32x16_bf16 v[128:143], v[28:31], v[212:215], v[128:143]
  s_waitcnt lgkmcnt(2)
  v_mfma_f32_32x32x16_f16 v[128:143], v[56:59], v[176:179], v[128:143]
  s_waitcnt lgkmcnt(0)
  v_mfma_f32_32x32x16_f16 v[128:143], v[60:63], v[180:183], v[128:143]
  s_cmp_gt_i32 s59, 0
  s_cselect_b32 s6, 6400000, 0
  s_cselect_b32 s10, 25600000, 0
  s_cselect_b32 s14, 300000, 0
  s_add_u32 m0, s67, 118784
  v_mad_u32_u24 v1, v1, 32, v253
  buffer_load_dwordx4 v1, s[8:11], 0 offen  lds
  s_add_u32 m0, s66, 0
  v_mad_u32_u24 v220, v220, s64, v233
  buffer_load_dwordx4 v220, s[4:7], 0 offen  lds
  s_add_u32 m0, s66, 1024
  v_mad_u32_u24 v221, v221, s64, v234
  buffer_load_dwordx4 v221, s[4:7], 0 offen  lds
  s_add_u32 m0, s66, 2048
  v_mad_u32_u24 v222, v222, s64, v235
  buffer_load_dwordx4 v222, s[4:7], 0 offen  lds
  s_add_u32 m0, s66, 3072
  v_mad_u32_u24 v223, v223, s64, v236
  buffer_load_dwordx4 v223, s[4:7], 0 offen  lds
  v_mul_u32_u24 v1, 6, v229
  v_and_b32 v1, -4, v1
  s_mov_b64 exec, s[74:75]
  buffer_load_dwordx2 v[226:227], v1, s[12:15], 0 offen
  s_mov_b64 exec, -1
  s_waitcnt lgkmcnt(0)
  s_cmp_eq_u32 s59, 0
  s_cbranch_scc1 LOOPEND
  s_cmp_ge_u32 s57, 4
  s_movk_i32 s79, 96
  s_cmovk_i32 s79, 96
LOOP:
  ds_read_b64_tr_b16 v[192:193], v244 offset:64
  ds_read_b64_tr_b16 v[194:195], v244 offset:208
  ds_read_b64_tr_b16 v[196:197], v244 offset:352
  ds_read_b64_tr_b16 v[198:199], v244 offset:496
  v_cvt_pk_f16_f32 v160, v128, v129
  v_cvt_pk_f16_f32 v161, v130, v131
  v_cvt_pk_f16_f32 v162, v132, v133
  v_cvt_pk_f16_f32 v163, v134, v135
  v_cvt_pk_f16_f32 v164, v136, v137
  v_cvt_pk_f16_f32 v165, v138, v139
  v_cvt_pk_f16_f32 v166, v140, v141
  v_cvt_pk_f16_f32 v167, v142, v143
  v_mfma_f32_16x16x32_f16 v[124:127], v[80:83], v[168:171], v[124:127]
  v_exp_f16_sdwa v2, v160 dst_sel:WORD_0 dst_unused:UNUSED_PAD src0_sel:WORD_0
  s_mov_b64 exec, 1
  ds_add_rtn_u32 v251, v0, v234 offset:35336
  s_mov_b64 exec, -1
  v_exp_f16_sdwa v3, v161 dst_sel:WORD_0 dst_unused:UNUSED_PAD src0_sel:WORD_0
  v_mfma_f32_16x16x32_f16 v[124:127], v[84:87], v[172:175], v[124:127]
  v_exp_f16_sdwa v4, v162 dst_sel:WORD_0 dst_unused:UNUSED_PAD src0_sel:WORD_0
  v_exp_f16_sdwa v5, v163 dst_sel:WORD_0 dst_unused:UNUSED_PAD src0_sel:WORD_0
  v_mfma_f32_32x32x16_bf16 v[144:159], v[32:35], v[200:203], v[144:159]
  v_exp_f16_sdwa v2, v160 dst_sel:WORD_1 dst_unused:UNUSED_PRESERVE src0_sel:WORD_1
  v_exp_f16_sdwa v3, v161 dst_sel:WORD_1 dst_unused:UNUSED_PRESERVE src0_sel:WORD_1
  v_exp_f16_sdwa v4, v162 dst_sel:WORD_1 dst_unused:UNUSED_PRESERVE src0_sel:WORD_1
  s_waitcnt lgkmcnt(3)
  v_mfma_f32_32x32x16_f16 v[104:119], v[192:195], v[184:187], v[104:119]
  v_exp_f16_sdwa v5, v163 dst_sel:WORD_1 dst_unused:UNUSED_PRESERVE src0_sel:WORD_1
  v_pk_add_f16 v2, v2, 1.0 op_sel_hi:[1,0]
  v_pk_add_f16 v3, v3, 1.0 op_sel_hi:[1,0]
  v_pk_add_f16 v4, v4, 1.0 op_sel_hi:[1,0]
  v_pk_add_f16 v5, v5, 1.0 op_sel_hi:[1,0]
  v_mul_f32 v230, v13, v124
  v_mul_f32 v231, v14, v124
  v_mul_f32 v232, v15, v124
  v_cvt_pk_f16_f32 v230, v230, v231
  v_cvt_pk_f16_f32 v231, v232, v232
  s_mov_b64 exec, s[74:75]
  ds_write_b64 v242, v[230:231] offset:128
  s_mov_b64 exec, -1
  v_rcp_f16_sdwa v6, v2 dst_sel:WORD_0 dst_unused:UNUSED_PAD src0_sel:WORD_0
  v_rcp_f16_sdwa v7, v3 dst_sel:WORD_0 dst_unused:UNUSED_PAD src0_sel:WORD_0
  s_waitcnt lgkmcnt(2)
  v_mfma_f32_32x32x16_f16 v[104:119], v[196:199], v[188:191], v[104:119]
  ds_read_b64_tr_b16 v[192:193], v245 offset:0
  ds_read_b64_tr_b16 v[194:195], v245 offset:144
  ds_read_b64_tr_b16 v[196:197], v245 offset:288
  ds_read_b64_tr_b16 v[198:199], v245 offset:432
  v_rcp_f16_sdwa v8, v4 dst_sel:WORD_0 dst_unused:UNUSED_PAD src0_sel:WORD_0
  s_waitcnt lgkmcnt(5)
  v_readfirstlane_b32 s68, v251
  s_setprio 2
  s_cmp_lt_i32 s68, s79
  s_cbranch_scc0 PRI0
  s_setprio 1
PRI0:
  s_add_u32 s79, s79, 128
  v_rcp_f16_sdwa v9, v5 dst_sel:WORD_0 dst_unused:UNUSED_PAD src0_sel:WORD_0
  v_rcp_f16_sdwa v6, v2 dst_sel:WORD_1 dst_unused:UNUSED_PRESERVE src0_sel:WORD_1
  v_mfma_f32_32x32x16_bf16 v[144:159], v[36:39], v[204:207], v[144:159]
  v_rcp_f16_sdwa v7, v3 dst_sel:WORD_1 dst_unused:UNUSED_PRESERVE src0_sel:WORD_1
  v_rcp_f16_sdwa v8, v4 dst_sel:WORD_1 dst_unused:UNUSED_PRESERVE src0_sel:WORD_1
  v_rcp_f16_sdwa v9, v5 dst_sel:WORD_1 dst_unused:UNUSED_PRESERVE src0_sel:WORD_1
  v_pk_mul_f16 v160, v160, v6
  v_pk_mul_f16 v161, v161, v7
  v_pk_mul_f16 v162, v162, v8
  v_pk_mul_f16 v163, v163, v9
  ds_write_b128 v242, v[160:163] offset:0
  v_mfma_f32_32x32x16_bf16 v[144:159], v[40:43], v[208:211], v[144:159]
  v_exp_f16_sdwa v2, v164 dst_sel:WORD_0 dst_unused:UNUSED_PAD src0_sel:WORD_0
  v_exp_f16_sdwa v3, v165 dst_sel:WORD_0 dst_unused:UNUSED_PAD src0_sel:WORD_0
  v_exp_f16_sdwa v4, v166 dst_sel:WORD_0 dst_unused:UNUSED_PAD src0_sel:WORD_0
  v_mfma_f32_32x32x16_bf16 v[144:159], v[44:47], v[212:215], v[144:159]
  v_exp_f16_sdwa v5, v167 dst_sel:WORD_0 dst_unused:UNUSED_PAD src0_sel:WORD_0
  v_exp_f16_sdwa v2, v164 dst_sel:WORD_1 dst_unused:UNUSED_PRESERVE src0_sel:WORD_1
  v_exp_f16_sdwa v3, v165 dst_sel:WORD_1 dst_unused:UNUSED_PRESERVE src0_sel:WORD_1
  v_mfma_f32_32x32x16_f16 v[144:159], v[64:67], v[176:179], v[144:159]
  v_exp_f16_sdwa v4, v166 dst_sel:WORD_1 dst_unused:UNUSED_PRESERVE src0_sel:WORD_1
  v_exp_f16_sdwa v5, v167 dst_sel:WORD_1 dst_unused:UNUSED_PRESERVE src0_sel:WORD_1
  v_pk_add_f16 v2, v2, 1.0 op_sel_hi:[1,0]
  v_pk_add_f16 v3, v3, 1.0 op_sel_hi:[1,0]
  v_pk_add_f16 v4, v4, 1.0 op_sel_hi:[1,0]
  v_pk_add_f16 v5, v5, 1.0 op_sel_hi:[1,0]
  v_rcp_f16_sdwa v6, v2 dst_sel:WORD_0 dst_unused:UNUSED_PAD src0_sel:WORD_0
  v_mfma_f32_32x32x16_f16 v[144:159], v[68:71], v[180:183], v[144:159]
  v_rcp_f16_sdwa v7, v3 dst_sel:WORD_0 dst_unused:UNUSED_PAD src0_sel:WORD_0
  s_waitcnt vmcnt(0)
  ds_read_b128 v[216:219], v254
  ds_read_b128 v[200:203], v237
  ds_read_b128 v[204:207], v238
  v_rcp_f16_sdwa v8, v4 dst_sel:WORD_0 dst_unused:UNUSED_PAD src0_sel:WORD_0
  v_rcp_f16_sdwa v9, v5 dst_sel:WORD_0 dst_unused:UNUSED_PAD src0_sel:WORD_0
  s_waitcnt lgkmcnt(6)
  v_mfma_f32_16x16x32_f16 v[120:123], v[192:195], v[184:187], v[120:123]
  ds_read_b128 v[208:211], v239
  ds_read_b128 v[212:215], v240
  v_rcp_f16_sdwa v6, v2 dst_sel:WORD_1 dst_unused:UNUSED_PRESERVE src0_sel:WORD_1
  v_add_u32_sdwa v249, v241, v229 dst_sel:DWORD dst_unused:UNUSED_PAD src0_sel:DWORD src1_sel:BYTE_3
  ds_read_b64 v[230:231], v249 offset:480
  ds_read_b32 v232, v249 offset:736
  v_lshlrev_b32 v125, 4, v229
  v_alignbit_b32 v126, v227, v226, v125
  v_lshrrev_b32 v127, v125, v227
  v_rcp_f16_sdwa v7, v3 dst_sel:WORD_1 dst_unused:UNUSED_PRESERVE src0_sel:WORD_1
  s_waitcnt lgkmcnt(8)
  v_mfma_f32_16x16x32_f16 v[120:123], v[196:199], v[188:191], v[120:123]
  ds_read_b64 v[176:177], v249 offset:192
  ds_read_b64 v[178:179], v249 offset:128
  ds_read_b64 v[180:181], v249 offset:64
  ds_read_b32 v182, v249
  ds_read_b128 v[184:187], v248 offset:0
  v_rcp_f16_sdwa v8, v4 dst_sel:WORD_1 dst_unused:UNUSED_PRESERVE src0_sel:WORD_1
  ds_read_b128 v[220:223], v246 offset:256
  ds_read_b32 v228, v247 offset:256
  ds_read_b32 v1, v252 offset:17664
  v_rcp_f16_sdwa v9, v5 dst_sel:WORD_1 dst_unused:UNUSED_PRESERVE src0_sel:WORD_1
  v_pk_mul_f16 v164, v164, v6
  v_pk_mul_f16 v165, v165, v7
  v_pk_mul_f16 v166, v166, v8
  v_pk_mul_f16 v167, v167, v9
  ds_write_b128 v242, v[164:167] offset:16
  v_cvt_pk_f16_f32 v168, v144, v145
  v_cvt_pk_f16_f32 v169, v146, v147
  v_cvt_pk_f16_f32 v170, v148, v149
  v_cvt_pk_f16_f32 v171, v150, v151
  v_cvt_pk_f16_f32 v172, v152, v153
  v_cvt_pk_f16_f32 v173, v154, v155
  v_cvt_pk_f16_f32 v174, v156, v157
  v_cvt_pk_f16_f32 v175, v158, v159
  s_waitcnt lgkmcnt(15)
  v_mfma_f32_32x32x16_bf16 v[128:143], v[48:51], v[216:219], 0
  ds_read_b64_tr_b16 v[192:193], v244 offset:0
  ds_read_b64_tr_b16 v[194:195], v244 offset:144
  ds_read_b64_tr_b16 v[196:197], v244 offset:288
  ds_read_b64_tr_b16 v[198:199], v244 offset:432
  v_exp_f16_sdwa v2, v168 dst_sel:WORD_0 dst_unused:UNUSED_PAD src0_sel:WORD_0
  v_exp_f16_sdwa v3, v169 dst_sel:WORD_0 dst_unused:UNUSED_PAD src0_sel:WORD_0
  v_exp_f16_sdwa v4, v170 dst_sel:WORD_0 dst_unused:UNUSED_PAD src0_sel:WORD_0
  v_mfma_f32_32x32x16_bf16 v[144:159], v[52:55], v[216:219], 0
  v_lshlrev_b32 v125, 16, v126
  v_and_b32 v126, s65, v126
  v_lshlrev_b32 v127, 16, v127
  v_exp_f16_sdwa v5, v171 dst_sel:WORD_0 dst_unused:UNUSED_PAD src0_sel:WORD_0
  v_exp_f16_sdwa v2, v168 dst_sel:WORD_1 dst_unused:UNUSED_PRESERVE src0_sel:WORD_1
  s_waitcnt lgkmcnt(15)
  v_mfma_f32_32x32x16_bf16 v[128:143], v[16:19], v[200:203], v[128:143]
  v_exp_f16_sdwa v3, v169 dst_sel:WORD_1 dst_unused:UNUSED_PRESERVE src0_sel:WORD_1
  v_exp_f16_sdwa v4, v170 dst_sel:WORD_1 dst_unused:UNUSED_PRESERVE src0_sel:WORD_1
  s_waitcnt lgkmcnt(8)
  v_add_u32_sdwa v184, v243, v184 dst_sel:DWORD dst_unused:UNUSED_PAD src0_sel:DWORD src1_sel:BYTE_3
  v_add_u32_sdwa v185, v243, v185 dst_sel:DWORD dst_unused:UNUSED_PAD src0_sel:DWORD src1_sel:BYTE_3
  v_add_u32_sdwa v186, v243, v186 dst_sel:DWORD dst_unused:UNUSED_PAD src0_sel:DWORD src1_sel:BYTE_3
  v_add_u32_sdwa v187, v243, v187 dst_sel:DWORD dst_unused:UNUSED_PAD src0_sel:DWORD src1_sel:BYTE_3
  ds_read_b64_tr_b16 v[190:191], v187
  ds_read_b64_tr_b16 v[188:189], v186
  ds_read_b64_tr_b16 v[186:187], v185
  ds_read_b64_tr_b16 v[184:185], v184
  s_cmp_gt_i32 s59, 1
  s_cselect_b32 s6, 6400000, 0
  s_cselect_b32 s10, 25600000, 0
  s_cselect_b32 s14, 300000, 0
  s_add_u32 m0, s67, 118784
  s_waitcnt lgkmcnt(9)
  v_mad_u32_u24 v1, v1, 32, v253
  buffer_load_dwordx4 v1, s[8:11], 0 offen  lds
  v_exp_f16_sdwa v5, v171 dst_sel:WORD_1 dst_unused:UNUSED_PRESERVE src0_sel:WORD_1
  v_pk_add_f16 v2, v2, 1.0 op_sel_hi:[1,0]
  v_pk_add_f16 v3, v3, 1.0 op_sel_hi:[1,0]
  v_pk_add_f16 v4, v4, 1.0 op_sel_hi:[1,0]
  v_pk_add_f16 v5, v5, 1.0 op_sel_hi:[1,0]
  v_mfma_f32_32x32x16_bf16 v[128:143], v[20:23], v[204:207], v[128:143]
  v_sub_f32 v230, v230, v125
  v_sub_f32 v231, v231, v126
  v_sub_f32 v232, v232, v127
  v_cvt_pk_bf16_f32 v230, v230, v231
  v_cvt_pk_bf16_f32 v232, v232, v232
  v_lshlrev_b32 v13, 16, v230
  v_and_b32 v14, s65, v230
  v_lshlrev_b32 v15, 16, v232
  v_rcp_f16_sdwa v6, v2 dst_sel:WORD_0 dst_unused:UNUSED_PAD src0_sel:WORD_0
  v_rcp_f16_sdwa v7, v3 dst_sel:WORD_0 dst_unused:UNUSED_PAD src0_sel:WORD_0
  v_rcp_f16_sdwa v8, v4 dst_sel:WORD_0 dst_unused:UNUSED_PAD src0_sel:WORD_0
  v_mfma_f32_32x32x16_bf16 v[128:143], v[24:27], v[208:211], v[128:143]
  s_add_u32 m0, s66, 0
  v_mad_u32_u24 v220, v220, s64, v233
  buffer_load_dwordx4 v220, s[4:7], 0 offen  lds
  v_rcp_f16_sdwa v9, v5 dst_sel:WORD_0 dst_unused:UNUSED_PAD src0_sel:WORD_0
  v_rcp_f16_sdwa v6, v2 dst_sel:WORD_1 dst_unused:UNUSED_PRESERVE src0_sel:WORD_1
  v_mfma_f32_32x32x16_bf16 v[128:143], v[28:31], v[212:215], v[128:143]
  s_add_u32 m0, s66, 1024
  v_mad_u32_u24 v221, v221, s64, v234
  buffer_load_dwordx4 v221, s[4:7], 0 offen  lds
  v_rcp_f16_sdwa v7, v3 dst_sel:WORD_1 dst_unused:UNUSED_PRESERVE src0_sel:WORD_1
  v_rcp_f16_sdwa v8, v4 dst_sel:WORD_1 dst_unused:UNUSED_PRESERVE src0_sel:WORD_1
  v_mul_f32 v230, v13, v13
  v_fmac_f32 v230, v14, v14
  v_fmac_f32 v230, v15, v15
  v_cvt_pk_f16_f32 v183, v230, v230
  v_rcp_f16_sdwa v9, v5 dst_sel:WORD_1 dst_unused:UNUSED_PRESERVE src0_sel:WORD_1
  v_pk_mul_f16 v168, v168, v6
  v_pk_mul_f16 v169, v169, v7
  v_pk_mul_f16 v170, v170, v8
  v_pk_mul_f16 v171, v171, v9
  ds_write_b128 v242, v[168:171] offset:64
  v_mfma_f32_16x16x32_f16 v[124:127], v[72:75], v[160:163], 0
  s_add_u32 m0, s66, 2048
  v_mad_u32_u24 v222, v222, s64, v235
  buffer_load_dwordx4 v222, s[4:7], 0 offen  lds
  v_exp_f16_sdwa v2, v172 dst_sel:WORD_0 dst_unused:UNUSED_PAD src0_sel:WORD_0
  v_exp_f16_sdwa v3, v173 dst_sel:WORD_0 dst_unused:UNUSED_PAD src0_sel:WORD_0
  v_mfma_f32_16x16x32_f16 v[124:127], v[76:79], v[164:167], v[124:127]
  s_add_u32 m0, s66, 3072
  v_mad_u32_u24 v223, v223, s64, v236
  buffer_load_dwordx4 v223, s[4:7], 0 offen  lds
  v_exp_f16_sdwa v4, v174 dst_sel:WORD_0 dst_unused:UNUSED_PAD src0_sel:WORD_0
  v_exp_f16_sdwa v5, v175 dst_sel:WORD_0 dst_unused:UNUSED_PAD src0_sel:WORD_0
  v_mfma_f32_32x32x16_f16 v[128:143], v[56:59], v[176:179], v[128:143]
  v_exp_f16_sdwa v2, v172 dst_sel:WORD_1 dst_unused:UNUSED_PRESERVE src0_sel:WORD_1
  v_exp_f16_sdwa v3, v173 dst_sel:WORD_1 dst_unused:UNUSED_PRESERVE src0_sel:WORD_1
  v_exp_f16_sdwa v4, v174 dst_sel:WORD_1 dst_unused:UNUSED_PRESERVE src0_sel:WORD_1
  v_mfma_f32_32x32x16_f16 v[128:143], v[60:63], v[180:183], v[128:143]
  v_mul_u32_u24 v1, 6, v228
  v_and_b32 v1, -4, v1
  s_mov_b64 exec, s[74:75]
  buffer_load_dwordx2 v[224:225], v1, s[12:15], 0 offen
  s_mov_b64 exec, -1
  v_exp_f16_sdwa v5, v175 dst_sel:WORD_1 dst_unused:UNUSED_PRESERVE src0_sel:WORD_1
  v_pk_add_f16 v2, v2, 1.0 op_sel_hi:[1,0]
  v_pk_add_f16 v3, v3, 1.0 op_sel_hi:[1,0]
  v_pk_add_f16 v4, v4, 1.0 op_sel_hi:[1,0]
  v_pk_add_f16 v5, v5, 1.0 op_sel_hi:[1,0]
  v_rcp_f16_sdwa v6, v2 dst_sel:WORD_0 dst_unused:UNUSED_PAD src0_sel:WORD_0
  v_rcp_f16_sdwa v7, v3 dst_sel:WORD_0 dst_unused:UNUSED_PAD src0_sel:WORD_0
  s_waitcnt lgkmcnt(1)
  v_mfma_f32_32x32x16_f16 v[88:103], v[192:195], v[184:187], v[88:103]
  v_rcp_f16_sdwa v8, v4 dst_sel:WORD_0 dst_unused:UNUSED_PAD src0_sel:WORD_0
  v_rcp_f16_sdwa v9, v5 dst_sel:WORD_0 dst_unused:UNUSED_PAD src0_sel:WORD_0
  v_rcp_f16_sdwa v6, v2 dst_sel:WORD_1 dst_unused:UNUSED_PRESERVE src0_sel:WORD_1
  v_mfma_f32_32x32x16_f16 v[88:103], v[196:199], v[188:191], v[88:103]
  v_rcp_f16_sdwa v7, v3 dst_sel:WORD_1 dst_unused:UNUSED_PRESERVE src0_sel:WORD_1
  v_rcp_f16_sdwa v8, v4 dst_sel:WORD_1 dst_unused:UNUSED_PRESERVE src0_sel:WORD_1
  v_rcp_f16_sdwa v9, v5 dst_sel:WORD_1 dst_unused:UNUSED_PRESERVE src0_sel:WORD_1
  v_pk_mul_f16 v172, v172, v6
  v_pk_mul_f16 v173, v173, v7
  v_pk_mul_f16 v174, v174, v8
  v_pk_mul_f16 v175, v175, v9
  ds_write_b128 v242, v[172:175] offset:80
  s_sub_u32 s59, s59, 1
  s_cmp_eq_u32 s59, 0
  s_cbranch_scc1 TAIL0
  ds_read_b64_tr_b16 v[192:193], v244 offset:64
  ds_read_b64_tr_b16 v[194:195], v244 offset:208
  ds_read_b64_tr_b16 v[196:197], v244 offset:352
  ds_read_b64_tr_b16 v[198:199], v244 offset:496
  v_cvt_pk_f16_f32 v160, v128, v129
  v_cvt_pk_f16_f32 v161, v130, v131
  v_cvt_pk_f16_f32 v162, v132, v133
  v_cvt_pk_f16_f32 v163, v134, v135
  v_cvt_pk_f16_f32 v164, v136, v137
  v_cvt_pk_f16_f32 v165, v138, v139
  v_cvt_pk_f16_f32 v166, v140, v141
  v_cvt_pk_f16_f32 v167, v142, v143
  v_mfma_f32_16x16x32_f16 v[124:127], v[80:83], v[168:171], v[124:127]
  v_exp_f16_sdwa v2, v160 dst_sel:WORD_0 dst_unused:UNUSED_PAD src0_sel:WORD_0
  s_mov_b64 exec, 1
  ds_add_rtn_u32 v251, v0, v234 offset:35336
  s_mov_b64 exec, -1
  v_exp_f16_sdwa v3, v161 dst_sel:WORD_0 dst_unused:UNUSED_PAD src0_sel:WORD_0
  v_mfma_f32_16x16x32_f16 v[124:127], v[84:87], v[172:175], v[124:127]
  v_exp_f16_sdwa v4, v162 dst_sel:WORD_0 dst_unused:UNUSED_PAD src0_sel:WORD_0
  v_exp_f16_sdwa v5, v163 dst_sel:WORD_0 dst_unused:UNUSED_PAD src0_sel:WORD_0
  v_mfma_f32_32x32x16_bf16 v[144:159], v[32:35], v[200:203], v[144:159]
  v_exp_f16_sdwa v2, v160 dst_sel:WORD_1 dst_unused:UNUSED_PRESERVE src0_sel:WORD_1
  v_exp_f16_sdwa v3, v161 dst_sel:WORD_1 dst_unused:UNUSED_PRESERVE src0_sel:WORD_1
  v_exp_f16_sdwa v4, v162 dst_sel:WORD_1 dst_unused:UNUSED_PRESERVE src0_sel:WORD_1
  s_waitcnt lgkmcnt(3)
  v_mfma_f32_32x32x16_f16 v[104:119], v[192:195], v[184:187], v[104:119]
  v_exp_f16_sdwa v5, v163 dst_sel:WORD_1 dst_unused:UNUSED_PRESERVE src0_sel:WORD_1
  v_pk_add_f16 v2, v2, 1.0 op_sel_hi:[1,0]
  v_pk_add_f16 v3, v3, 1.0 op_sel_hi:[1,0]
  v_pk_add_f16 v4, v4, 1.0 op_sel_hi:[1,0]
  v_pk_add_f16 v5, v5, 1.0 op_sel_hi:[1,0]
  v_mul_f32 v230, v10, v124
  v_mul_f32 v231, v11, v124
  v_mul_f32 v232, v12, v124
  v_cvt_pk_f16_f32 v230, v230, v231
  v_cvt_pk_f16_f32 v231, v232, v232
  s_mov_b64 exec, s[74:75]
  ds_write_b64 v242, v[230:231] offset:128
  s_mov_b64 exec, -1
  v_rcp_f16_sdwa v6, v2 dst_sel:WORD_0 dst_unused:UNUSED_PAD src0_sel:WORD_0
  v_rcp_f16_sdwa v7, v3 dst_sel:WORD_0 dst_unused:UNUSED_PAD src0_sel:WORD_0
  s_waitcnt lgkmcnt(2)
  v_mfma_f32_32x32x16_f16 v[104:119], v[196:199], v[188:191], v[104:119]
  ds_read_b64_tr_b16 v[192:193], v245 offset:0
  ds_read_b64_tr_b16 v[194:195], v245 offset:144
  ds_read_b64_tr_b16 v[196:197], v245 offset:288
  ds_read_b64_tr_b16 v[198:199], v245 offset:432
  v_rcp_f16_sdwa v8, v4 dst_sel:WORD_0 dst_unused:UNUSED_PAD src0_sel:WORD_0
  s_waitcnt lgkmcnt(5)
  v_readfirstlane_b32 s68, v251
  s_setprio 2
  s_cmp_lt_i32 s68, s79
  s_cbranch_scc0 PRI1
  s_setprio 1
PRI1:
  s_add_u32 s79, s79, 128
  v_rcp_f16_sdwa v9, v5 dst_sel:WORD_0 dst_unused:UNUSED_PAD src0_sel:WORD_0
  v_rcp_f16_sdwa v6, v2 dst_sel:WORD_1 dst_unused:UNUSED_PRESERVE src0_sel:WORD_1
  v_mfma_f32_32x32x16_bf16 v[144:159], v[36:39], v[204:207], v[144:159]
  v_rcp_f16_sdwa v7, v3 dst_sel:WORD_1 dst_unused:UNUSED_PRESERVE src0_sel:WORD_1
  v_rcp_f16_sdwa v8, v4 dst_sel:WORD_1 dst_unused:UNUSED_PRESERVE src0_sel:WORD_1
  v_rcp_f16_sdwa v9, v5 dst_sel:WORD_1 dst_unused:UNUSED_PRESERVE src0_sel:WORD_1
  v_pk_mul_f16 v160, v160, v6
  v_pk_mul_f16 v161, v161, v7
  v_pk_mul_f16 v162, v162, v8
  v_pk_mul_f16 v163, v163, v9
  ds_write_b128 v242, v[160:163] offset:0
  v_mfma_f32_32x32x16_bf16 v[144:159], v[40:43], v[208:211], v[144:159]
  v_exp_f16_sdwa v2, v164 dst_sel:WORD_0 dst_unused:UNUSED_PAD src0_sel:WORD_0
  v_exp_f16_sdwa v3, v165 dst_sel:WORD_0 dst_unused:UNUSED_PAD src0_sel:WORD_0
  v_exp_f16_sdwa v4, v166 dst_sel:WORD_0 dst_unused:UNUSED_PAD src0_sel:WORD_0
  v_mfma_f32_32x32x16_bf16 v[144:159], v[44:47], v[212:215], v[144:159]
  v_exp_f16_sdwa v5, v167 dst_sel:WORD_0 dst_unused:UNUSED_PAD src0_sel:WORD_0
  v_exp_f16_sdwa v2, v164 dst_sel:WORD_1 dst_unused:UNUSED_PRESERVE src0_sel:WORD_1
  v_exp_f16_sdwa v3, v165 dst_sel:WORD_1 dst_unused:UNUSED_PRESERVE src0_sel:WORD_1
  v_mfma_f32_32x32x16_f16 v[144:159], v[64:67], v[176:179], v[144:159]
  v_exp_f16_sdwa v4, v166 dst_sel:WORD_1 dst_unused:UNUSED_PRESERVE src0_sel:WORD_1
  v_exp_f16_sdwa v5, v167 dst_sel:WORD_1 dst_unused:UNUSED_PRESERVE src0_sel:WORD_1
  v_pk_add_f16 v2, v2, 1.0 op_sel_hi:[1,0]
  v_pk_add_f16 v3, v3, 1.0 op_sel_hi:[1,0]
  v_pk_add_f16 v4, v4, 1.0 op_sel_hi:[1,0]
  v_pk_add_f16 v5, v5, 1.0 op_sel_hi:[1,0]
  v_rcp_f16_sdwa v6, v2 dst_sel:WORD_0 dst_unused:UNUSED_PAD src0_sel:WORD_0
  v_mfma_f32_32x32x16_f16 v[144:159], v[68:71], v[180:183], v[144:159]
  v_rcp_f16_sdwa v7, v3 dst_sel:WORD_0 dst_unused:UNUSED_PAD src0_sel:WORD_0
  s_waitcnt vmcnt(0)
  ds_read_b128 v[216:219], v254
  ds_read_b128 v[200:203], v237
  ds_read_b128 v[204:207], v238
  v_rcp_f16_sdwa v8, v4 dst_sel:WORD_0 dst_unused:UNUSED_PAD src0_sel:WORD_0
  v_rcp_f16_sdwa v9, v5 dst_sel:WORD_0 dst_unused:UNUSED_PAD src0_sel:WORD_0
  s_waitcnt lgkmcnt(6)
  v_mfma_f32_16x16x32_f16 v[120:123], v[192:195], v[184:187], v[120:123]
  ds_read_b128 v[208:211], v239
  ds_read_b128 v[212:215], v240
  v_rcp_f16_sdwa v6, v2 dst_sel:WORD_1 dst_unused:UNUSED_PRESERVE src0_sel:WORD_1
  v_add_u32_sdwa v249, v241, v228 dst_sel:DWORD dst_unused:UNUSED_PAD src0_sel:DWORD src1_sel:BYTE_3
  ds_read_b64 v[230:231], v249 offset:480
  ds_read_b32 v232, v249 offset:736
  v_lshlrev_b32 v125, 4, v228
  v_alignbit_b32 v126, v225, v224, v125
  v_lshrrev_b32 v127, v125, v225
  v_rcp_f16_sdwa v7, v3 dst_sel:WORD_1 dst_unused:UNUSED_PRESERVE src0_sel:WORD_1
  s_waitcnt lgkmcnt(8)
  v_mfma_f32_16x16x32_f16 v[120:123], v[196:199], v[188:191], v[120:123]
  ds_read_b64 v[176:177], v249 offset:192
  ds_read_b64 v[178:179], v249 offset:128
  ds_read_b64 v[180:181], v249 offset:64
  ds_read_b32 v182, v249
  ds_read_b128 v[184:187], v248 offset:128
  v_rcp_f16_sdwa v8, v4 dst_sel:WORD_1 dst_unused:UNUSED_PRESERVE src0_sel:WORD_1
  ds_read_b128 v[220:223], v246 offset:384
  ds_read_b32 v229, v247 offset:384
  ds_read_b32 v1, v252 offset:17792
  v_rcp_f16_sdwa v9, v5 dst_sel:WORD_1 dst_unused:UNUSED_PRESERVE src0_sel:WORD_1
  v_pk_mul_f16 v164, v164, v6
  v_pk_mul_f16 v165, v165, v7
  v_pk_mul_f16 v166, v166, v8
  v_pk_mul_f16 v167, v167, v9
  ds_write_b128 v242, v[164:167] offset:16
  v_cvt_pk_f16_f32 v168, v144, v145
  v_cvt_pk_f16_f32 v169, v146, v147
  v_cvt_pk_f16_f32 v170, v148, v149
  v_cvt_pk_f16_f32 v171, v150, v151
  v_cvt_pk_f16_f32 v172, v152, v153
  v_cvt_pk_f16_f32 v173, v154, v155
  v_cvt_pk_f16_f32 v174, v156, v157
  v_cvt_pk_f16_f32 v175, v158, v159
  s_waitcnt lgkmcnt(15)
  v_mfma_f32_32x32x16_bf16 v[128:143], v[48:51], v[216:219], 0
  ds_read_b64_tr_b16 v[192:193], v244 offset:0
  ds_read_b64_tr_b16 v[194:195], v244 offset:144
  ds_read_b64_tr_b16 v[196:197], v244 offset:288
  ds_read_b64_tr_b16 v[198:199], v244 offset:432
  v_exp_f16_sdwa v2, v168 dst_sel:WORD_0 dst_unused:UNUSED_PAD src0_sel:WORD_0
  v_exp_f16_sdwa v3, v169 dst_sel:WORD_0 dst_unused:UNUSED_PAD src0_sel:WORD_0
  v_exp_f16_sdwa v4, v170 dst_sel:WORD_0 dst_unused:UNUSED_PAD src0_sel:WORD_0
  v_mfma_f32_32x32x16_bf16 v[144:159], v[52:55], v[216:219], 0
  v_lshlrev_b32 v125, 16, v126
  v_and_b32 v126, s65, v126
  v_lshlrev_b32 v127, 16, v127
  v_exp_f16_sdwa v5, v171 dst_sel:WORD_0 dst_unused:UNUSED_PAD src0_sel:WORD_0
  v_exp_f16_sdwa v2, v168 dst_sel:WORD_1 dst_unused:UNUSED_PRESERVE src0_sel:WORD_1
  s_waitcnt lgkmcnt(15)
  v_mfma_f32_32x32x16_bf16 v[128:143], v[16:19], v[200:203], v[128:143]
  v_exp_f16_sdwa v3, v169 dst_sel:WORD_1 dst_unused:UNUSED_PRESERVE src0_sel:WORD_1
  v_exp_f16_sdwa v4, v170 dst_sel:WORD_1 dst_unused:UNUSED_PRESERVE src0_sel:WORD_1
  s_waitcnt lgkmcnt(8)
  v_add_u32_sdwa v184, v243, v184 dst_sel:DWORD dst_unused:UNUSED_PAD src0_sel:DWORD src1_sel:BYTE_3
  v_add_u32_sdwa v185, v243, v185 dst_sel:DWORD dst_unused:UNUSED_PAD src0_sel:DWORD src1_sel:BYTE_3
  v_add_u32_sdwa v186, v243, v186 dst_sel:DWORD dst_unused:UNUSED_PAD src0_sel:DWORD src1_sel:BYTE_3
  v_add_u32_sdwa v187, v243, v187 dst_sel:DWORD dst_unused:UNUSED_PAD src0_sel:DWORD src1_sel:BYTE_3
  ds_read_b64_tr_b16 v[190:191], v187
  ds_read_b64_tr_b16 v[188:189], v186
  ds_read_b64_tr_b16 v[186:187], v185
  ds_read_b64_tr_b16 v[184:185], v184
  s_cmp_gt_i32 s59, 1
  s_cselect_b32 s6, 6400000, 0
  s_cselect_b32 s10, 25600000, 0
  s_cselect_b32 s14, 300000, 0
  s_add_u32 m0, s67, 118784
  s_waitcnt lgkmcnt(9)
  v_mad_u32_u24 v1, v1, 32, v253
  buffer_load_dwordx4 v1, s[8:11], 0 offen  lds
  v_exp_f16_sdwa v5, v171 dst_sel:WORD_1 dst_unused:UNUSED_PRESERVE src0_sel:WORD_1
  v_pk_add_f16 v2, v2, 1.0 op_sel_hi:[1,0]
  v_pk_add_f16 v3, v3, 1.0 op_sel_hi:[1,0]
  v_pk_add_f16 v4, v4, 1.0 op_sel_hi:[1,0]
  v_pk_add_f16 v5, v5, 1.0 op_sel_hi:[1,0]
  v_mfma_f32_32x32x16_bf16 v[128:143], v[20:23], v[204:207], v[128:143]
  v_sub_f32 v230, v230, v125
  v_sub_f32 v231, v231, v126
  v_sub_f32 v232, v232, v127
  v_cvt_pk_bf16_f32 v230, v230, v231
  v_cvt_pk_bf16_f32 v232, v232, v232
  v_lshlrev_b32 v10, 16, v230
  v_and_b32 v11, s65, v230
  v_lshlrev_b32 v12, 16, v232
  v_rcp_f16_sdwa v6, v2 dst_sel:WORD_0 dst_unused:UNUSED_PAD src0_sel:WORD_0
  v_rcp_f16_sdwa v7, v3 dst_sel:WORD_0 dst_unused:UNUSED_PAD src0_sel:WORD_0
  v_rcp_f16_sdwa v8, v4 dst_sel:WORD_0 dst_unused:UNUSED_PAD src0_sel:WORD_0
  v_mfma_f32_32x32x16_bf16 v[128:143], v[24:27], v[208:211], v[128:143]
  s_add_u32 m0, s66, 0
  v_mad_u32_u24 v220, v220, s64, v233
  buffer_load_dwordx4 v220, s[4:7], 0 offen  lds
  v_rcp_f16_sdwa v9, v5 dst_sel:WORD_0 dst_unused:UNUSED_PAD src0_sel:WORD_0
  v_rcp_f16_sdwa v6, v2 dst_sel:WORD_1 dst_unused:UNUSED_PRESERVE src0_sel:WORD_1
  v_mfma_f32_32x32x16_bf16 v[128:143], v[28:31], v[212:215], v[128:143]
  s_add_u32 m0, s66, 1024
  v_mad_u32_u24 v221, v221, s64, v234
  buffer_load_dwordx4 v221, s[4:7], 0 offen  lds
  v_rcp_f16_sdwa v7, v3 dst_sel:WORD_1 dst_unused:UNUSED_PRESERVE src0_sel:WORD_1
  v_rcp_f16_sdwa v8, v4 dst_sel:WORD_1 dst_unused:UNUSED_PRESERVE src0_sel:WORD_1
  v_mul_f32 v230, v10, v10
  v_fmac_f32 v230, v11, v11
  v_fmac_f32 v230, v12, v12
  v_cvt_pk_f16_f32 v183, v230, v230
  v_rcp_f16_sdwa v9, v5 dst_sel:WORD_1 dst_unused:UNUSED_PRESERVE src0_sel:WORD_1
  v_pk_mul_f16 v168, v168, v6
  v_pk_mul_f16 v169, v169, v7
  v_pk_mul_f16 v170, v170, v8
  v_pk_mul_f16 v171, v171, v9
  ds_write_b128 v242, v[168:171] offset:64
  v_mfma_f32_16x16x32_f16 v[124:127], v[72:75], v[160:163], 0
  s_add_u32 m0, s66, 2048
  v_mad_u32_u24 v222, v222, s64, v235
  buffer_load_dwordx4 v222, s[4:7], 0 offen  lds
  v_exp_f16_sdwa v2, v172 dst_sel:WORD_0 dst_unused:UNUSED_PAD src0_sel:WORD_0
  v_exp_f16_sdwa v3, v173 dst_sel:WORD_0 dst_unused:UNUSED_PAD src0_sel:WORD_0
  v_mfma_f32_16x16x32_f16 v[124:127], v[76:79], v[164:167], v[124:127]
  s_add_u32 m0, s66, 3072
  v_mad_u32_u24 v223, v223, s64, v236
  buffer_load_dwordx4 v223, s[4:7], 0 offen  lds
  v_exp_f16_sdwa v4, v174 dst_sel:WORD_0 dst_unused:UNUSED_PAD src0_sel:WORD_0
  v_exp_f16_sdwa v5, v175 dst_sel:WORD_0 dst_unused:UNUSED_PAD src0_sel:WORD_0
  v_mfma_f32_32x32x16_f16 v[128:143], v[56:59], v[176:179], v[128:143]
  v_exp_f16_sdwa v2, v172 dst_sel:WORD_1 dst_unused:UNUSED_PRESERVE src0_sel:WORD_1
  v_exp_f16_sdwa v3, v173 dst_sel:WORD_1 dst_unused:UNUSED_PRESERVE src0_sel:WORD_1
  v_exp_f16_sdwa v4, v174 dst_sel:WORD_1 dst_unused:UNUSED_PRESERVE src0_sel:WORD_1
  v_mfma_f32_32x32x16_f16 v[128:143], v[60:63], v[180:183], v[128:143]
  v_mul_u32_u24 v1, 6, v229
  v_and_b32 v1, -4, v1
  s_mov_b64 exec, s[74:75]
  buffer_load_dwordx2 v[226:227], v1, s[12:15], 0 offen
  s_mov_b64 exec, -1
  v_exp_f16_sdwa v5, v175 dst_sel:WORD_1 dst_unused:UNUSED_PRESERVE src0_sel:WORD_1
  v_pk_add_f16 v2, v2, 1.0 op_sel_hi:[1,0]
  v_pk_add_f16 v3, v3, 1.0 op_sel_hi:[1,0]
  v_pk_add_f16 v4, v4, 1.0 op_sel_hi:[1,0]
  v_pk_add_f16 v5, v5, 1.0 op_sel_hi:[1,0]
  v_rcp_f16_sdwa v6, v2 dst_sel:WORD_0 dst_unused:UNUSED_PAD src0_sel:WORD_0
  v_rcp_f16_sdwa v7, v3 dst_sel:WORD_0 dst_unused:UNUSED_PAD src0_sel:WORD_0
  s_waitcnt lgkmcnt(1)
  v_mfma_f32_32x32x16_f16 v[88:103], v[192:195], v[184:187], v[88:103]
  v_rcp_f16_sdwa v8, v4 dst_sel:WORD_0 dst_unused:UNUSED_PAD src0_sel:WORD_0
  v_rcp_f16_sdwa v9, v5 dst_sel:WORD_0 dst_unused:UNUSED_PAD src0_sel:WORD_0
  v_rcp_f16_sdwa v6, v2 dst_sel:WORD_1 dst_unused:UNUSED_PRESERVE src0_sel:WORD_1
  v_mfma_f32_32x32x16_f16 v[88:103], v[196:199], v[188:191], v[88:103]
  v_rcp_f16_sdwa v7, v3 dst_sel:WORD_1 dst_unused:UNUSED_PRESERVE src0_sel:WORD_1
  v_rcp_f16_sdwa v8, v4 dst_sel:WORD_1 dst_unused:UNUSED_PRESERVE src0_sel:WORD_1
  v_rcp_f16_sdwa v9, v5 dst_sel:WORD_1 dst_unused:UNUSED_PRESERVE src0_sel:WORD_1
  v_pk_mul_f16 v172, v172, v6
  v_pk_mul_f16 v173, v173, v7
  v_pk_mul_f16 v174, v174, v8
  v_pk_mul_f16 v175, v175, v9
  ds_write_b128 v242, v[172:175] offset:80
  s_sub_u32 s59, s59, 1
  s_cmp_eq_u32 s59, 0
  v_add_u32 v246, 0x100, v246
  v_add_u32 v247, 0x100, v247
  v_add_u32 v248, 0x100, v248
  v_add_u32 v252, 0x100, v252
  s_cbranch_scc0 LOOP
  v_mov_b32 v10, v13
  v_mov_b32 v11, v14
  v_mov_b32 v12, v15
TAIL0:
  s_setprio 0
  s_waitcnt lgkmcnt(0)
  ds_read_b64_tr_b16 v[192:193], v244 offset:64
  ds_read_b64_tr_b16 v[194:195], v244 offset:208
  ds_read_b64_tr_b16 v[196:197], v244 offset:352
  ds_read_b64_tr_b16 v[198:199], v244 offset:496
  v_mfma_f32_16x16x32_f16 v[124:127], v[80:83], v[168:171], v[124:127]
  v_mfma_f32_16x16x32_f16 v[124:127], v[84:87], v[172:175], v[124:127]
  s_waitcnt lgkmcnt(2)
  v_mfma_f32_32x32x16_f16 v[104:119], v[192:195], v[184:187], v[104:119]
  s_waitcnt lgkmcnt(0)
  v_mfma_f32_32x32x16_f16 v[104:119], v[196:199], v[188:191], v[104:119]
  s_nop 3
  v_mul_f32 v230, v10, v124
  v_mul_f32 v231, v11, v124
  v_mul_f32 v232, v12, v124
  v_cvt_pk_f16_f32 v230, v230, v231
  v_cvt_pk_f16_f32 v231, v232, v232
  s_mov_b64 exec, s[74:75]
  ds_write_b64 v242, v[230:231] offset:128
  s_mov_b64 exec, -1
  ds_read_b64_tr_b16 v[192:193], v245 offset:0
  ds_read_b64_tr_b16 v[194:195], v245 offset:144
  ds_read_b64_tr_b16 v[196:197], v245 offset:288
  ds_read_b64_tr_b16 v[198:199], v245 offset:432
  s_waitcnt lgkmcnt(2)
  v_mfma_f32_16x16x32_f16 v[120:123], v[192:195], v[184:187], v[120:123]
  s_waitcnt lgkmcnt(0)
  v_mfma_f32_16x16x32_f16 v[120:123], v[196:199], v[188:191], v[120:123]
LOOPEND:
  s_cmp_eq_u32 s62, 0
  s_cbranch_scc1 EPI
  s_add_u32 s61, s61, s60
  s_min_u32 s60, s60, 32
  s_waitcnt vmcnt(0)
  s_barrier
  s_branch ROUND
EPI:
  s_setprio 0
  v_and_b32 v2, 1, v0
  v_bfe_u32 v3, v0, 1, 1
  v_bfe_u32 v4, v0, 2, 2
  v_bfe_u32 v5, v0, 4, 1
  v_lshlrev_b32 v2, 6, v2
  v_lshl_add_u32 v2, v3, 3, v2
  v_lshl_add_u32 v2, v5, 4, v2
  v_lshrrev_b32 v3, 1, v4
  v_lshl_add_u32 v2, v3, 5, v2
  v_lshl_add_u32 v2, v4, 7, v2
  v_add_u32 v2, 114176, v2
  v_lshl_add_u32 v6, v250, 8, v2
  v_xor_b32 v7, 32, v6
  v_lshl_add_u32 v8, v250, 6, v2
  v_xor_b32 v9, 32, v8
  v_lshl_add_u32 v249, v0, 3, s67
  ds_read_b64 v[220:221], v249 offset:512
  ds_read_b32 v222, v249 offset:768
  ds_read_b64_tr_b16 v[16:17], v6 offset:0
  ds_read_b64_tr_b16 v[18:19], v6 offset:512
  ds_read_b64_tr_b16 v[20:21], v6 offset:1024
  ds_read_b64_tr_b16 v[22:23], v6 offset:1536
  ds_read_b64_tr_b16 v[24:25], v6 offset:2048
  ds_read_b64_tr_b16 v[26:27], v6 offset:2560
  ds_read_b64_tr_b16 v[28:29], v6 offset:3072
  ds_read_b64_tr_b16 v[30:31], v6 offset:3584
  ds_read_b64_tr_b16 v[32:33], v8 offset:8192
  ds_read_b64_tr_b16 v[34:35], v8 offset:10240
  ds_read_b64_tr_b16 v[36:37], v8 offset:8704
  ds_read_b64_tr_b16 v[38:39], v8 offset:10752
  ds_read_b64_tr_b16 v[40:41], v8 offset:12288
  ds_read_b64_tr_b16 v[42:43], v8 offset:14336
  ds_read_b64_tr_b16 v[44:45], v8 offset:12800
  ds_read_b64_tr_b16 v[46:47], v8 offset:14848
  s_mov_b32 s68, 0xbf317218
  s_mov_b32 s69, 0xbf317218
  v_pk_mul_f32 v[88:89], v[88:89], s[68:69]
  v_pk_mul_f32 v[90:91], v[90:91], s[68:69]
  v_pk_mul_f32 v[92:93], v[92:93], s[68:69]
  v_pk_mul_f32 v[94:95], v[94:95], s[68:69]
  v_pk_mul_f32 v[96:97], v[96:97], s[68:69]
  v_pk_mul_f32 v[98:99], v[98:99], s[68:69]
  v_pk_mul_f32 v[100:101], v[100:101], s[68:69]
  v_pk_mul_f32 v[102:103], v[102:103], s[68:69]
  v_pk_mul_f32 v[104:105], v[104:105], s[68:69]
  v_pk_mul_f32 v[106:107], v[106:107], s[68:69]
  v_pk_mul_f32 v[108:109], v[108:109], s[68:69]
  v_pk_mul_f32 v[110:111], v[110:111], s[68:69]
  v_pk_mul_f32 v[112:113], v[112:113], s[68:69]
  v_pk_mul_f32 v[114:115], v[114:115], s[68:69]
  v_pk_mul_f32 v[116:117], v[116:117], s[68:69]
  v_pk_mul_f32 v[118:119], v[118:119], s[68:69]
  v_pk_mul_f32 v[120:121], v[120:121], s[68:69]
  v_pk_mul_f32 v[122:123], v[122:123], s[68:69]
  s_waitcnt lgkmcnt(8)
  v_mfma_f32_32x32x16_bf16 v[128:143], v[16:19], v[200:203], 0
  v_cvt_pk_bf16_f32 v160, v88, v89
  v_cvt_pk_bf16_f32 v161, v90, v91
  v_cvt_pk_bf16_f32 v162, v92, v93
  v_cvt_pk_bf16_f32 v163, v94, v95
  v_cvt_pk_bf16_f32 v164, v96, v97
  v_mfma_f32_32x32x16_bf16 v[128:143], v[20:23], v[204:207], v[128:143]
  v_cvt_pk_bf16_f32 v165, v98, v99
  v_cvt_pk_bf16_f32 v166, v100, v101
  v_cvt_pk_bf16_f32 v167, v102, v103
  v_cvt_pk_bf16_f32 v168, v104, v105
  v_cvt_pk_bf16_f32 v169, v106, v107
  v_mfma_f32_32x32x16_bf16 v[128:143], v[24:27], v[208:211], v[128:143]
  v_cvt_pk_bf16_f32 v170, v108, v109
  v_cvt_pk_bf16_f32 v171, v110, v111
  v_cvt_pk_bf16_f32 v172, v112, v113
  v_cvt_pk_bf16_f32 v173, v114, v115
  v_cvt_pk_bf16_f32 v174, v116, v117
  v_mfma_f32_32x32x16_bf16 v[128:143], v[28:31], v[212:215], v[128:143]
  v_cvt_pk_bf16_f32 v175, v118, v119
  s_waitcnt lgkmcnt(0)
  ds_read_b64_tr_b16 v[48:49], v7 offset:0
  ds_read_b64_tr_b16 v[50:51], v7 offset:512
  ds_read_b64_tr_b16 v[52:53], v7 offset:1024
  ds_read_b64_tr_b16 v[54:55], v7 offset:1536
  ds_read_b64_tr_b16 v[56:57], v7 offset:2048
  ds_read_b64_tr_b16 v[58:59], v7 offset:2560
  ds_read_b64_tr_b16 v[60:61], v7 offset:3072
  ds_read_b64_tr_b16 v[62:63], v7 offset:3584
  ds_read_b64_tr_b16 v[64:65], v9 offset:8192
  ds_read_b64_tr_b16 v[66:67], v9 offset:10240
  ds_read_b64_tr_b16 v[68:69], v9 offset:8704
  ds_read_b64_tr_b16 v[70:71], v9 offset:10752
  ds_read_b64_tr_b16 v[72:73], v9 offset:12288
  ds_read_b64_tr_b16 v[74:75], v9 offset:14336
  ds_read_b64_tr_b16 v[76:77], v9 offset:12800
  ds_read_b64_tr_b16 v[78:79], v9 offset:14848
  v_mfma_f32_32x32x16_bf16 v[128:143], v[32:35], v[160:163], v[128:143]
  v_add_f32 v220, v220, v120
  v_add_f32 v221, v221, v121
  v_add_f32 v222, v222, v122
  v_cvt_pk_bf16_f32 v220, v220, v221
  v_cvt_pk_bf16_f32 v222, v222, v222
  v_add_u32 v230, s58, v0
  v_mfma_f32_32x32x16_bf16 v[128:143], v[36:39], v[164:167], v[128:143]
  v_mul_u32_u24 v230, 6, v230
  v_add_u32 v230, 6400000, v230
  v_lshl_add_u32 v242, v250, 1, v242
  v_lshrrev_b32 v246, 3, v0
  v_and_b32 v247, 7, v0
  s_mul_i32 s3, s57, 4608
  v_mfma_f32_32x32x16_bf16 v[128:143], v[40:43], v[168:171], v[128:143]
  s_add_u32 s3, s3, 44544
  v_mul_u32_u24 v248, 144, v246
  v_lshl_add_u32 v248, v247, 4, v248
  v_add_u32 v248, s3, v248
  s_lshl_b32 s3, s58, 7
  v_lshl_add_u32 v231, v0, 4, s3
  v_mfma_f32_32x32x16_bf16 v[128:143], v[44:47], v[172:175], v[128:143]
  s_bfe_u32 s68, s78, 0x10018
  s_mul_i32 s68, s68, 255
  s_mov_b32 s69, 0
  s_mov_b32 exec_lo, s78
  s_mov_b32 exec_hi, 0
  buffer_store_short v220, v230, s[28:31], 0 offen sc1
  buffer_store_short_d16_hi v220, v230, s[28:31], 0 offen offset:2 sc1
  buffer_store_short v222, v230, s[28:31], 0 offen offset:4 sc1
  s_mov_b64 exec, -1
  s_waitcnt lgkmcnt(0)
  v_mfma_f32_32x32x16_bf16 v[144:159], v[48:51], v[200:203], 0
  s_nop 0
  v_pk_mul_f32 v[2:3], v[128:129], s[70:71]
  v_pk_mul_f32 v[4:5], v[130:131], s[70:71]
  v_pk_mul_f32 v[6:7], v[132:133], s[70:71]
  v_pk_mul_f32 v[8:9], v[134:135], s[70:71]
  v_exp_f32 v2, v2
  v_mfma_f32_32x32x16_bf16 v[144:159], v[52:55], v[204:207], v[144:159]
  v_exp_f32 v3, v3
  v_exp_f32 v4, v4
  v_exp_f32 v5, v5
  v_exp_f32 v6, v6
  v_exp_f32 v7, v7
  v_exp_f32 v8, v8
  v_exp_f32 v9, v9
  v_mfma_f32_32x32x16_bf16 v[144:159], v[56:59], v[208:211], v[144:159]
  v_pk_add_f32 v[2:3], v[2:3], s[72:73]
  v_pk_add_f32 v[4:5], v[4:5], s[72:73]
  v_pk_add_f32 v[6:7], v[6:7], s[72:73]
  v_pk_add_f32 v[8:9], v[8:9], s[72:73]
  v_rcp_f32 v2, v2
  v_rcp_f32 v3, v3
  v_rcp_f32 v4, v4
  v_mfma_f32_32x32x16_bf16 v[144:159], v[60:63], v[212:215], v[144:159]
  v_rcp_f32 v5, v5
  v_rcp_f32 v6, v6
  v_rcp_f32 v7, v7
  v_rcp_f32 v8, v8
  v_rcp_f32 v9, v9
  v_pk_mul_f32 v[2:3], v[2:3], v[128:129]
  v_pk_mul_f32 v[4:5], v[4:5], v[130:131]
  v_mfma_f32_32x32x16_bf16 v[144:159], v[64:67], v[160:163], v[144:159]
  v_pk_mul_f32 v[6:7], v[6:7], v[132:133]
  v_pk_mul_f32 v[8:9], v[8:9], v[134:135]
  v_cvt_pk_bf16_f32 v176, v2, v3
  v_cvt_pk_bf16_f32 v177, v4, v5
  v_cvt_pk_bf16_f32 v178, v6, v7
  v_cvt_pk_bf16_f32 v179, v8, v9
  v_lshlrev_b32 v2, 16, v176
  v_mfma_f32_32x32x16_bf16 v[144:159], v[68:71], v[164:167], v[144:159]
  v_and_b32 v3, s65, v176
  v_lshlrev_b32 v4, 16, v200
  v_and_b32 v5, s65, v200
  v_pk_add_f32 v[2:3], v[2:3], v[4:5]
  v_cvt_pk_bf16_f32 v88, v2, v3
  v_lshlrev_b32 v6, 16, v177
  v_and_b32 v7, s65, v177
  v_mfma_f32_32x32x16_bf16 v[144:159], v[72:75], v[168:171], v[144:159]
  v_lshlrev_b32 v8, 16, v201
  v_and_b32 v9, s65, v201
  v_pk_add_f32 v[6:7], v[6:7], v[8:9]
  v_cvt_pk_bf16_f32 v89, v6, v7
  v_lshlrev_b32 v2, 16, v178
  v_and_b32 v3, s65, v178
  v_lshlrev_b32 v4, 16, v202
  v_mfma_f32_32x32x16_bf16 v[144:159], v[76:79], v[172:175], v[144:159]
  v_and_b32 v5, s65, v202
  v_pk_add_f32 v[2:3], v[2:3], v[4:5]
  v_cvt_pk_bf16_f32 v90, v2, v3
  v_lshlrev_b32 v6, 16, v179
  v_and_b32 v7, s65, v179
  v_lshlrev_b32 v8, 16, v203
  v_and_b32 v9, s65, v203
  v_pk_add_f32 v[6:7], v[6:7], v[8:9]
  v_cvt_pk_bf16_f32 v91, v6, v7
  ds_write_b128 v242, v[88:91] offset:0
  v_pk_mul_f32 v[2:3], v[136:137], s[70:71]
  v_pk_mul_f32 v[4:5], v[138:139], s[70:71]
  v_pk_mul_f32 v[6:7], v[140:141], s[70:71]
  v_pk_mul_f32 v[8:9], v[142:143], s[70:71]
  v_exp_f32 v2, v2
  v_exp_f32 v3, v3
  v_exp_f32 v4, v4
  v_exp_f32 v5, v5
  v_exp_f32 v6, v6
  v_exp_f32 v7, v7
  v_exp_f32 v8, v8
  v_exp_f32 v9, v9
  v_pk_add_f32 v[2:3], v[2:3], s[72:73]
  v_pk_add_f32 v[4:5], v[4:5], s[72:73]
  v_pk_add_f32 v[6:7], v[6:7], s[72:73]
  v_pk_add_f32 v[8:9], v[8:9], s[72:73]
  v_rcp_f32 v2, v2
  v_rcp_f32 v3, v3
  v_rcp_f32 v4, v4
  v_rcp_f32 v5, v5
  v_rcp_f32 v6, v6
  v_rcp_f32 v7, v7
  v_rcp_f32 v8, v8
  v_rcp_f32 v9, v9
  v_pk_mul_f32 v[2:3], v[2:3], v[136:137]
  v_pk_mul_f32 v[4:5], v[4:5], v[138:139]
  v_pk_mul_f32 v[6:7], v[6:7], v[140:141]
  v_pk_mul_f32 v[8:9], v[8:9], v[142:143]
  v_cvt_pk_bf16_f32 v176, v2, v3
  v_cvt_pk_bf16_f32 v177, v4, v5
  v_cvt_pk_bf16_f32 v178, v6, v7
  v_cvt_pk_bf16_f32 v179, v8, v9
  v_lshlrev_b32 v2, 16, v176
  v_and_b32 v3, s65, v176
  v_lshlrev_b32 v4, 16, v204
  v_and_b32 v5, s65, v204
  v_pk_add_f32 v[2:3], v[2:3], v[4:5]
  v_cvt_pk_bf16_f32 v92, v2, v3
  v_lshlrev_b32 v6, 16, v177
  v_and_b32 v7, s65, v177
  v_lshlrev_b32 v8, 16, v205
  v_and_b32 v9, s65, v205
  v_pk_add_f32 v[6:7], v[6:7], v[8:9]
  v_cvt_pk_bf16_f32 v93, v6, v7
  v_lshlrev_b32 v2, 16, v178
  v_and_b32 v3, s65, v178
  v_lshlrev_b32 v4, 16, v206
  v_and_b32 v5, s65, v206
  v_pk_add_f32 v[2:3], v[2:3], v[4:5]
  v_cvt_pk_bf16_f32 v94, v2, v3
  v_lshlrev_b32 v6, 16, v179
  v_and_b32 v7, s65, v179
  v_lshlrev_b32 v8, 16, v207
  v_and_b32 v9, s65, v207
  v_pk_add_f32 v[6:7], v[6:7], v[8:9]
  v_cvt_pk_bf16_f32 v95, v6, v7
  ds_write_b128 v242, v[92:95] offset:16
  v_pk_mul_f32 v[2:3], v[144:145], s[70:71]
  v_pk_mul_f32 v[4:5], v[146:147], s[70:71]
  v_pk_mul_f32 v[6:7], v[148:149], s[70:71]
  v_pk_mul_f32 v[8:9], v[150:151], s[70:71]
  v_exp_f32 v2, v2
  v_exp_f32 v3, v3
  v_exp_f32 v4, v4
  v_exp_f32 v5, v5
  v_exp_f32 v6, v6
  v_exp_f32 v7, v7
  v_exp_f32 v8, v8
  v_exp_f32 v9, v9
  v_pk_add_f32 v[2:3], v[2:3], s[72:73]
  v_pk_add_f32 v[4:5], v[4:5], s[72:73]
  v_pk_add_f32 v[6:7], v[6:7], s[72:73]
  v_pk_add_f32 v[8:9], v[8:9], s[72:73]
  v_rcp_f32 v2, v2
  v_rcp_f32 v3, v3
  v_rcp_f32 v4, v4
  v_rcp_f32 v5, v5
  v_rcp_f32 v6, v6
  v_rcp_f32 v7, v7
  v_rcp_f32 v8, v8
  v_rcp_f32 v9, v9
  v_pk_mul_f32 v[2:3], v[2:3], v[144:145]
  v_pk_mul_f32 v[4:5], v[4:5], v[146:147]
  v_pk_mul_f32 v[6:7], v[6:7], v[148:149]
  v_pk_mul_f32 v[8:9], v[8:9], v[150:151]
  v_cvt_pk_bf16_f32 v176, v2, v3
  v_cvt_pk_bf16_f32 v177, v4, v5
  v_cvt_pk_bf16_f32 v178, v6, v7
  v_cvt_pk_bf16_f32 v179, v8, v9
  v_lshlrev_b32 v2, 16, v176
  v_and_b32 v3, s65, v176
  v_lshlrev_b32 v4, 16, v208
  v_and_b32 v5, s65, v208
  v_pk_add_f32 v[2:3], v[2:3], v[4:5]
  v_cvt_pk_bf16_f32 v96, v2, v3
  v_lshlrev_b32 v6, 16, v177
  v_and_b32 v7, s65, v177
  v_lshlrev_b32 v8, 16, v209
  v_and_b32 v9, s65, v209
  v_pk_add_f32 v[6:7], v[6:7], v[8:9]
  v_cvt_pk_bf16_f32 v97, v6, v7
  v_lshlrev_b32 v2, 16, v178
  v_and_b32 v3, s65, v178
  v_lshlrev_b32 v4, 16, v210
  v_and_b32 v5, s65, v210
  v_pk_add_f32 v[2:3], v[2:3], v[4:5]
  v_cvt_pk_bf16_f32 v98, v2, v3
  v_lshlrev_b32 v6, 16, v179
  v_and_b32 v7, s65, v179
  v_lshlrev_b32 v8, 16, v211
  v_and_b32 v9, s65, v211
  v_pk_add_f32 v[6:7], v[6:7], v[8:9]
  v_cvt_pk_bf16_f32 v99, v6, v7
  ds_write_b128 v242, v[96:99] offset:32
  v_pk_mul_f32 v[2:3], v[152:153], s[70:71]
  v_pk_mul_f32 v[4:5], v[154:155], s[70:71]
  v_pk_mul_f32 v[6:7], v[156:157], s[70:71]
  v_pk_mul_f32 v[8:9], v[158:159], s[70:71]
  v_exp_f32 v2, v2
  v_exp_f32 v3, v3
  v_exp_f32 v4, v4
  v_exp_f32 v5, v5
  v_exp_f32 v6, v6
  v_exp_f32 v7, v7
  v_exp_f32 v8, v8
  v_exp_f32 v9, v9
  v_pk_add_f32 v[2:3], v[2:3], s[72:73]
  v_pk_add_f32 v[4:5], v[4:5], s[72:73]
  v_pk_add_f32 v[6:7], v[6:7], s[72:73]
  v_pk_add_f32 v[8:9], v[8:9], s[72:73]
  v_rcp_f32 v2, v2
  v_rcp_f32 v3, v3
  v_rcp_f32 v4, v4
  v_rcp_f32 v5, v5
  v_rcp_f32 v6, v6
  v_rcp_f32 v7, v7
  v_rcp_f32 v8, v8
  v_rcp_f32 v9, v9
  v_pk_mul_f32 v[2:3], v[2:3], v[152:153]
  v_pk_mul_f32 v[4:5], v[4:5], v[154:155]
  v_pk_mul_f32 v[6:7], v[6:7], v[156:157]
  v_pk_mul_f32 v[8:9], v[8:9], v[158:159]
  v_cvt_pk_bf16_f32 v176, v2, v3
  v_cvt_pk_bf16_f32 v177, v4, v5
  v_cvt_pk_bf16_f32 v178, v6, v7
  v_cvt_pk_bf16_f32 v179, v8, v9
  v_lshlrev_b32 v2, 16, v176
  v_and_b32 v3, s65, v176
  v_lshlrev_b32 v4, 16, v212
  v_and_b32 v5, s65, v212
  v_pk_add_f32 v[2:3], v[2:3], v[4:5]
  v_cvt_pk_bf16_f32 v100, v2, v3
  v_lshlrev_b32 v6, 16, v177
  v_and_b32 v7, s65, v177
  v_lshlrev_b32 v8, 16, v213
  v_and_b32 v9, s65, v213
  v_pk_add_f32 v[6:7], v[6:7], v[8:9]
  v_cvt_pk_bf16_f32 v101, v6, v7
  v_lshlrev_b32 v2, 16, v178
  v_and_b32 v3, s65, v178
  v_lshlrev_b32 v4, 16, v214
  v_and_b32 v5, s65, v214
  v_pk_add_f32 v[2:3], v[2:3], v[4:5]
  v_cvt_pk_bf16_f32 v102, v2, v3
  v_lshlrev_b32 v6, 16, v179
  v_and_b32 v7, s65, v179
  v_lshlrev_b32 v8, 16, v215
  v_and_b32 v9, s65, v215
  v_pk_add_f32 v[6:7], v[6:7], v[8:9]
  v_cvt_pk_bf16_f32 v103, v6, v7
  ds_write_b128 v242, v[100:103] offset:48
  ds_read_b128 v[128:131], v248 offset:0
  ds_read_b128 v[132:135], v248 offset:1152
  ds_read_b128 v[136:139], v248 offset:2304
  ds_read_b128 v[140:143], v248 offset:3456
  s_waitcnt lgkmcnt(3)
  buffer_store_dwordx4 v[128:131], v231, s[28:31], 0 offen offset:0 sc1
  s_waitcnt lgkmcnt(2)
  buffer_store_dwordx4 v[132:135], v231, s[28:31], 0 offen offset:1024 sc1
  s_waitcnt lgkmcnt(1)
  buffer_store_dwordx4 v[136:139], v231, s[28:31], 0 offen offset:2048 sc1
  s_waitcnt lgkmcnt(0)
  s_cmp_eq_u32 s68, 0
  s_cbranch_scc1 NO25
  s_mov_b64 exec, s[68:69]
  buffer_store_dwordx4 v[140:143], v231, s[28:31], 0 offen offset:3072 sc1
  s_mov_b64 exec, -1
NO25:
K2END:
  s_endpgm
.section .rodata,"a"
.p2align 6
.amdhsa_kernel part_kernel
  .amdhsa_next_free_vgpr 80
  .amdhsa_next_free_sgpr 102
  .amdhsa_accum_offset 80
  .amdhsa_group_segment_fixed_size 0
  .amdhsa_kernarg_size 88
  .amdhsa_user_sgpr_count 2
  .amdhsa_user_sgpr_kernarg_segment_ptr 1
  .amdhsa_system_sgpr_workgroup_id_x 1
.end_amdhsa_kernel
.p2align 6
.amdhsa_kernel main_kernel
  .amdhsa_next_free_vgpr 256
  .amdhsa_next_free_sgpr 102
  .amdhsa_accum_offset 256
  .amdhsa_group_segment_fixed_size 0
  .amdhsa_kernarg_size 88
  .amdhsa_user_sgpr_count 2
  .amdhsa_user_sgpr_kernarg_segment_ptr 1
  .amdhsa_system_sgpr_workgroup_id_x 1
.end_amdhsa_kernel
```
